```python
import torch

def _softmax(x, axis=-1):
    return torch.softmax(x, dim=axis)

def _gelu(x):
    return torch.nn.functional.gelu(x, approximate='tanh')

def _silu(x):
    return torch.nn.functional.silu(x)

def _sigmoid(x):
    return torch.sigmoid(x)

def _layernorm(x, axis=-1, eps=1e-05):
    m = x.mean(dim=axis, keepdim=True)
    v = x.var(dim=axis, keepdim=True, unbiased=False)
    return (x - m) / torch.sqrt(v + eps)

def _scatter_add(tgt, idx, src, axis=0):
    return tgt.clone().index_add_(axis, idx, src)

def _segment_sum(src, seg, n):
    out = torch.zeros((n,) + src.shape[1:], dtype=src.dtype)
    return out.index_add_(0, seg, src)

def _pad(x, pw):
    flat = tuple((v for pair in reversed(pw) for v in pair))
    return torch.nn.functional.pad(x, flat)
kernel_name = 'adaLN_cond__ssm_conv_h3__mixer_s_mlp__prompt'

def setup_inputs():

    _w = lambda a: (lambda t: t.to(torch.bfloat16) if t.is_floating_point() else t)(torch.as_tensor(a))

    def _A_setup():
        B, S, D = (1, 2048, 640)
        ks = 4
        return {'q': _w((lambda *s: torch.randn(*s, dtype=torch.bfloat16) * 0.05)(B, S, D)), 'k': _w((lambda *s: torch.randn(*s, dtype=torch.bfloat16) * 0.8)(B, S, D)), 'v': _w((lambda *s: torch.randn(*s, dtype=torch.bfloat16) * 0.8)(B, S, D)), 'shift_k': _w((lambda *s: torch.randn(*s, dtype=torch.bfloat16) * 0.8)(D, ks) * 0.5), 'ssm_k': _w((lambda *s: torch.randn(*s, dtype=torch.bfloat16) * 0.8)(D, S) * (1.0 / S ** 0.5)), 'ssm_D': _w((lambda *s: torch.randn(*s, dtype=torch.bfloat16) * 0.8)(D))}
    _A_in = _A_setup()

    def _B_setup():
        B, S, D, F = (1, 2048, 640, 1728)
        return {'x': _w((lambda *s: torch.randn(*s, dtype=torch.bfloat16) * 0.05)(B, S, D)), 'w1': _w((lambda *s: torch.randn(*s, dtype=torch.bfloat16) * 3.2)(D, D) * D ** (-0.5)), 'w2': _w((lambda *s: torch.randn(*s, dtype=torch.bfloat16) * 3.2)(D, D) * D ** (-0.5)), 'w3': _w((lambda *s: torch.randn(*s, dtype=torch.bfloat16) * 3.2)(D, F) * D ** (-0.5)), 'w4': _w((lambda *s: torch.randn(*s, dtype=torch.bfloat16) * 3.2)(F, D) * F ** (-0.5))}
    _B_in = _B_setup()
    return {'A_q': _A_in['q'], 'A_k': _A_in['k'], 'A_v': _A_in['v'], 'A_shift_k': _A_in['shift_k'], 'A_ssm_k': _A_in['ssm_k'], 'A_ssm_D': _A_in['ssm_D'], 'B_x': _B_in['x'], 'B_w1': _B_in['w1'], 'B_w2': _B_in['w2'], 'B_w3': _B_in['w3'], 'B_w4': _B_in['w4'], 'c': _w((lambda *s: torch.randn(*s, dtype=torch.bfloat16) * 0.1)(1, 640) * 8.0), 'w_mod': _w((lambda *s: torch.randn(*s, dtype=torch.bfloat16) * 0.1)(640, 6 * 640) * 640 ** (-0.5) * 8.0)}

def reference(A_q, A_k, A_v, A_shift_k, A_ssm_k, A_ssm_D, B_x, B_w1, B_w2, B_w3, B_w4, c, w_mod):

    def _A_ref(q, k, v, shift_k, ssm_k, ssm_D):
        B, S, D = q.shape
        ks = shift_k.shape[-1]
        k_pad = _pad(k, ((0, 0), (ks - 1, 0), (0, 0)))
        k_shift = torch.zeros_like(k)
        for t in range(ks):
            k_shift = k_shift + k_pad[:, t:t + S, :] * shift_k[:, ks - 1 - t][None, None, :]
        kv = k_shift * v
        L = 2 * S
        kv_pad = _pad(kv, ((0, 0), (0, S), (0, 0)))
        kf_pad = _pad(ssm_k, ((0, 0), (0, S)))
        kv_f = (lambda x, axes=(-2, -1): torch.fft.rfft2(x.float(), dim=axes))(kv_pad[:, None, :, :], axes=(1, 2))
        kf_f = (lambda x, axes=(-2, -1): torch.fft.rfft2(x.float(), dim=axes))(kf_pad[:, None, :], axes=(1, 2))
        kf_f = (lambda x, *d: x.permute(*d))(kf_f, 1, 2, 0)
        y_f = kv_f * kf_f[None, :, :, :]
        y = (lambda x, s, axes=(-2, -1): torch.fft.irfft2(x, s=s, dim=axes).to(torch.bfloat16))(y_f, (1, L), axes=(1, 2))[:, 0, :S, :]
        y = y + kv * ssm_D[None, None, :]
        return q * y

    def _B_ref(x, w1, w2, w3, w4):
        B, S, D = x.shape
        h = _gelu(_layernorm(x, axis=-1) @ w1)
        c = D // 4
        g0 = _pad(h[:, :, 0 * c:1 * c], ((0, 0), (1, 0), (0, 0)))[:, :S, :]
        g1 = _pad(h[:, :, 1 * c:2 * c], ((0, 0), (0, 1), (0, 0)))[:, 1:, :]
        g2 = _pad(h[:, :, 2 * c:3 * c], ((0, 0), (2, 0), (0, 0)))[:, :S, :]
        g3 = _pad(h[:, :, 3 * c:], ((0, 0), (0, 2), (0, 0)))[:, 2:, :]
        hs = torch.concatenate([g0, g1, g2, g3], axis=-1) @ w2
        x1 = x + hs
        h2 = _gelu(_layernorm(x1, axis=-1) @ w3) @ w4
        return x1 + h2
    x = A_q
    mod = (_silu(c) @ w_mod).reshape(c.shape[0], 6, 1, -1)
    sa, ca, ga, sb, cb, gb = (mod[:, 0].clone(), mod[:, 1].clone(), mod[:, 2].clone(), mod[:, 3].clone(), mod[:, 4].clone(), mod[:, 5].clone())
    h = _layernorm(x, axis=-1) * (1 + ca) + sa
    x = x + ga * _A_ref(h, A_k, A_v, A_shift_k, A_ssm_k, A_ssm_D)
    h = _layernorm(x, axis=-1) * (1 + cb) + sb
    x = x + gb * _B_ref(h, B_w1, B_w2, B_w3, B_w4)
    return x
```

```asm
; @launch kernel=k0_kernel grid=(360,1,1) block=(256,1,1) lds=16384
; @launch kernel=k1_kernel grid=(440,1,1) block=(256,1,1) lds=46080
; @launch kernel=k2_kernel grid=(256,1,1) block=(256,1,1) lds=163840
.amdgcn_target "amdgcn-amd-amdhsa--gfx950"
.text
.globl k0_kernel
.p2align 8
.type k0_kernel,@function
k0_kernel:
    s_cmp_ge_u32 s2, 360
    s_cbranch_scc1 k0_end
    s_cmp_ge_u32 s2, 320
    s_cbranch_scc1 k0_pf
    s_load_dwordx4 s[4:7], s[0:1], 8
    s_load_dwordx2 s[8:9], s[0:1], 24
    s_load_dwordx2 s[10:11], s[0:1], 120
    s_waitcnt lgkmcnt(0)
    s_mov_b32 s28, s10
    s_mov_b32 s29, s11
    s_mov_b32 s30, 268435456
    s_mov_b32 s31, 0x00020000
    s_mov_b32 s16, s4
    s_mov_b32 s17, s5
    s_mov_b32 s18, 2621440
    s_mov_b32 s19, 0x00020000
    s_mov_b32 s20, s6
    s_mov_b32 s21, s7
    s_mov_b32 s22, 2621440
    s_mov_b32 s23, 0x00020000
    s_mov_b32 s24, s8
    s_mov_b32 s25, s9
    s_mov_b32 s26, 5120
    s_mov_b32 s27, 0x00020000
    s_mul_i32 s32, s2, 52429
    s_lshr_b32 s32, s32, 19
    s_mul_i32 s33, s32, 10
    s_sub_u32 s33, s2, s33
    v_and_b32 v1, 15, v0
    v_lshrrev_b32 v2, 4, v0
    s_lshl_b32 s34, s32, 6
    v_lshl_add_u32 v3, v2, 2, s34
    v_mul_u32_u24 v4, 1280, v3
    s_lshl_b32 s35, s33, 7
    v_lshl_add_u32 v5, v1, 3, s35
    v_add_u32 v4, v4, v5
    v_subrev_u32 v6, 3840, v4
    v_subrev_u32 v7, 2560, v4
    v_subrev_u32 v8, 1280, v4
    buffer_load_dwordx2 v[10:11], v6, s[16:19], 0 offen
    buffer_load_dwordx2 v[12:13], v7, s[16:19], 0 offen
    buffer_load_dwordx2 v[14:15], v8, s[16:19], 0 offen
    buffer_load_dwordx2 v[16:17], v4, s[16:19], 0 offen offset:0
    buffer_load_dwordx2 v[18:19], v4, s[16:19], 0 offen offset:1280
    buffer_load_dwordx2 v[20:21], v4, s[16:19], 0 offen offset:2560
    buffer_load_dwordx2 v[22:23], v4, s[16:19], 0 offen offset:3840
    v_lshlrev_b32 v100, 2, v5
    buffer_load_dwordx4 v[32:35], v100, s[24:27], 0 offen
    buffer_load_dwordx4 v[36:39], v100, s[24:27], 0 offen offset:16
    buffer_load_dwordx2 v[24:25], v4, s[20:23], 0 offen offset:0
    buffer_load_dwordx2 v[26:27], v4, s[20:23], 0 offen offset:1280
    buffer_load_dwordx2 v[28:29], v4, s[20:23], 0 offen offset:2560
    buffer_load_dwordx2 v[30:31], v4, s[20:23], 0 offen offset:3840
    v_lshlrev_b32 v100, 9, v1
    v_sub_u32 v101, 15, v2
    v_lshl_add_u32 v100, v101, 3, v100
    v_lshrrev_b32 v101, 2, v2
    v_lshlrev_b32 v101, 11, v101
    v_lshl_add_u32 v101, v1, 7, v101
    v_add_u32 v101, 8192, v101
    v_bfe_u32 v102, v1, 1, 3
    v_and_b32 v103, 3, v2
    v_lshlrev_b32 v103, 1, v103
    v_xor_b32 v102, v102, v103
    v_xor_b32 v103, 1, v102
    v_lshl_add_u32 v102, v102, 4, v101
    v_lshl_add_u32 v103, v103, 4, v101
    s_waitcnt vmcnt(4)
    v_lshlrev_b32 v40, 16, v32
    v_and_b32 v44, 0xffff0000, v32
    v_lshlrev_b32 v48, 16, v33
    v_and_b32 v52, 0xffff0000, v33
    v_lshlrev_b32 v41, 16, v34
    v_and_b32 v45, 0xffff0000, v34
    v_lshlrev_b32 v49, 16, v35
    v_and_b32 v53, 0xffff0000, v35
    v_lshlrev_b32 v42, 16, v36
    v_and_b32 v46, 0xffff0000, v36
    v_lshlrev_b32 v50, 16, v37
    v_and_b32 v54, 0xffff0000, v37
    v_lshlrev_b32 v43, 16, v38
    v_and_b32 v47, 0xffff0000, v38
    v_lshlrev_b32 v51, 16, v39
    v_and_b32 v55, 0xffff0000, v39
    v_lshlrev_b32 v56, 16, v10
    v_and_b32 v57, 0xffff0000, v10
    v_lshlrev_b32 v58, 16, v11
    v_and_b32 v59, 0xffff0000, v11
    v_lshlrev_b32 v60, 16, v12
    v_and_b32 v61, 0xffff0000, v12
    v_lshlrev_b32 v62, 16, v13
    v_and_b32 v63, 0xffff0000, v13
    v_lshlrev_b32 v64, 16, v14
    v_and_b32 v65, 0xffff0000, v14
    v_lshlrev_b32 v66, 16, v15
    v_and_b32 v67, 0xffff0000, v15
    v_lshlrev_b32 v68, 16, v16
    v_and_b32 v69, 0xffff0000, v16
    v_lshlrev_b32 v70, 16, v17
    v_and_b32 v71, 0xffff0000, v17
    v_lshlrev_b32 v72, 16, v18
    v_and_b32 v73, 0xffff0000, v18
    v_lshlrev_b32 v74, 16, v19
    v_and_b32 v75, 0xffff0000, v19
    v_lshlrev_b32 v76, 16, v20
    v_and_b32 v77, 0xffff0000, v20
    v_lshlrev_b32 v78, 16, v21
    v_and_b32 v79, 0xffff0000, v21
    v_lshlrev_b32 v80, 16, v22
    v_and_b32 v81, 0xffff0000, v22
    v_lshlrev_b32 v82, 16, v23
    v_and_b32 v83, 0xffff0000, v23
    v_pk_mul_f32 v[84:85], v[56:57], v[52:53]
    v_pk_fma_f32 v[84:85], v[60:61], v[48:49], v[84:85]
    v_pk_fma_f32 v[84:85], v[64:65], v[44:45], v[84:85]
    v_pk_fma_f32 v[84:85], v[68:69], v[40:41], v[84:85]
    v_cvt_pk_bf16_f32 v104, v84, v85
    v_lshlrev_b32 v84, 16, v104
    v_and_b32 v85, 0xffff0000, v104
    v_pk_mul_f32 v[86:87], v[58:59], v[54:55]
    v_pk_fma_f32 v[86:87], v[62:63], v[50:51], v[86:87]
    v_pk_fma_f32 v[86:87], v[66:67], v[46:47], v[86:87]
    v_pk_fma_f32 v[86:87], v[70:71], v[42:43], v[86:87]
    v_cvt_pk_bf16_f32 v104, v86, v87
    v_lshlrev_b32 v86, 16, v104
    v_and_b32 v87, 0xffff0000, v104
    v_pk_mul_f32 v[88:89], v[60:61], v[52:53]
    v_pk_fma_f32 v[88:89], v[64:65], v[48:49], v[88:89]
    v_pk_fma_f32 v[88:89], v[68:69], v[44:45], v[88:89]
    v_pk_fma_f32 v[88:89], v[72:73], v[40:41], v[88:89]
    v_cvt_pk_bf16_f32 v104, v88, v89
    v_lshlrev_b32 v88, 16, v104
    v_and_b32 v89, 0xffff0000, v104
    v_pk_mul_f32 v[90:91], v[62:63], v[54:55]
    v_pk_fma_f32 v[90:91], v[66:67], v[50:51], v[90:91]
    v_pk_fma_f32 v[90:91], v[70:71], v[46:47], v[90:91]
    v_pk_fma_f32 v[90:91], v[74:75], v[42:43], v[90:91]
    v_cvt_pk_bf16_f32 v104, v90, v91
    v_lshlrev_b32 v90, 16, v104
    v_and_b32 v91, 0xffff0000, v104
    v_pk_mul_f32 v[92:93], v[64:65], v[52:53]
    v_pk_fma_f32 v[92:93], v[68:69], v[48:49], v[92:93]
    v_pk_fma_f32 v[92:93], v[72:73], v[44:45], v[92:93]
    v_pk_fma_f32 v[92:93], v[76:77], v[40:41], v[92:93]
    v_cvt_pk_bf16_f32 v104, v92, v93
    v_lshlrev_b32 v92, 16, v104
    v_and_b32 v93, 0xffff0000, v104
    v_pk_mul_f32 v[94:95], v[66:67], v[54:55]
    v_pk_fma_f32 v[94:95], v[70:71], v[50:51], v[94:95]
    v_pk_fma_f32 v[94:95], v[74:75], v[46:47], v[94:95]
    v_pk_fma_f32 v[94:95], v[78:79], v[42:43], v[94:95]
    v_cvt_pk_bf16_f32 v104, v94, v95
    v_lshlrev_b32 v94, 16, v104
    v_and_b32 v95, 0xffff0000, v104
    v_pk_mul_f32 v[96:97], v[68:69], v[52:53]
    v_pk_fma_f32 v[96:97], v[72:73], v[48:49], v[96:97]
    v_pk_fma_f32 v[96:97], v[76:77], v[44:45], v[96:97]
    v_pk_fma_f32 v[96:97], v[80:81], v[40:41], v[96:97]
    v_cvt_pk_bf16_f32 v104, v96, v97
    v_lshlrev_b32 v96, 16, v104
    v_and_b32 v97, 0xffff0000, v104
    v_pk_mul_f32 v[98:99], v[70:71], v[54:55]
    v_pk_fma_f32 v[98:99], v[74:75], v[50:51], v[98:99]
    v_pk_fma_f32 v[98:99], v[78:79], v[46:47], v[98:99]
    v_pk_fma_f32 v[98:99], v[82:83], v[42:43], v[98:99]
    v_cvt_pk_bf16_f32 v104, v98, v99
    v_lshlrev_b32 v98, 16, v104
    v_and_b32 v99, 0xffff0000, v104
    s_waitcnt vmcnt(0)
    v_lshlrev_b32 v104, 16, v24
    v_and_b32 v105, 0xffff0000, v24
    v_pk_mul_f32 v[84:85], v[84:85], v[104:105]
    v_lshlrev_b32 v104, 16, v25
    v_and_b32 v105, 0xffff0000, v25
    v_pk_mul_f32 v[86:87], v[86:87], v[104:105]
    v_lshlrev_b32 v104, 16, v26
    v_and_b32 v105, 0xffff0000, v26
    v_pk_mul_f32 v[88:89], v[88:89], v[104:105]
    v_lshlrev_b32 v104, 16, v27
    v_and_b32 v105, 0xffff0000, v27
    v_pk_mul_f32 v[90:91], v[90:91], v[104:105]
    v_lshlrev_b32 v104, 16, v28
    v_and_b32 v105, 0xffff0000, v28
    v_pk_mul_f32 v[92:93], v[92:93], v[104:105]
    v_lshlrev_b32 v104, 16, v29
    v_and_b32 v105, 0xffff0000, v29
    v_pk_mul_f32 v[94:95], v[94:95], v[104:105]
    v_lshlrev_b32 v104, 16, v30
    v_and_b32 v105, 0xffff0000, v30
    v_pk_mul_f32 v[96:97], v[96:97], v[104:105]
    v_lshlrev_b32 v104, 16, v31
    v_and_b32 v105, 0xffff0000, v31
    v_pk_mul_f32 v[98:99], v[98:99], v[104:105]
    v_cvt_pk_bf16_f32 v56, v84, v85
    v_cvt_pk_bf16_f32 v57, v86, v87
    v_cvt_pk_bf16_f32 v58, v88, v89
    v_cvt_pk_bf16_f32 v59, v90, v91
    v_cvt_pk_bf16_f32 v60, v92, v93
    v_cvt_pk_bf16_f32 v61, v94, v95
    v_cvt_pk_bf16_f32 v62, v96, v97
    v_cvt_pk_bf16_f32 v63, v98, v99
    v_cvt_pk_bf16_f32 v64, v96, v92
    v_cvt_pk_bf16_f32 v65, v88, v84
    v_cvt_pk_bf16_f32 v66, v97, v93
    v_cvt_pk_bf16_f32 v67, v89, v85
    v_cvt_pk_bf16_f32 v68, v98, v94
    v_cvt_pk_bf16_f32 v69, v90, v86
    v_cvt_pk_bf16_f32 v70, v99, v95
    v_cvt_pk_bf16_f32 v71, v91, v87
    ds_write_b64 v100, v[64:65] offset:0
    ds_write_b64 v100, v[66:67] offset:128
    ds_write_b64 v100, v[68:69] offset:256
    ds_write_b64 v100, v[70:71] offset:384
    ds_write_b128 v102, v[56:59]
    ds_write_b128 v103, v[60:63]
    v_lshlrev_b32 v100, 4, v0
    v_lshrrev_b32 v101, 3, v0
    v_mul_u32_u24 v101, 4352, v101
    v_and_b32 v102, 7, v0
    v_lshl_add_u32 v103, v102, 4, v101
    v_lshrrev_b32 v104, 7, v0
    v_mul_u32_u24 v104, 20480, v104
    v_and_b32 v105, 127, v0
    v_lshl_add_u32 v104, v105, 4, v104
    s_mul_i32 s36, s33, 278528
    s_lshr_b32 s37, s32, 1
    s_mul_i32 s37, s37, 272
    s_add_u32 s36, s36, s37
    s_add_u32 s36, s36, 0
    s_and_b32 s37, s32, 1
    s_lshl_b32 s38, s37, 7
    s_sub_u32 s38, 128, s38
    s_add_u32 s38, s38, s36
    s_mul_i32 s39, s32, 81920
    s_lshl_b32 s40, s33, 11
    s_add_u32 s39, s39, s40
    s_add_u32 s39, s39, 2793472
    s_waitcnt lgkmcnt(0)
    s_barrier
    ds_read_b128 v[10:13], v100 offset:0
    ds_read_b128 v[14:17], v100 offset:4096
    ds_read_b128 v[18:21], v100 offset:8192
    ds_read_b128 v[22:25], v100 offset:12288
    s_waitcnt lgkmcnt(3)
    buffer_store_dwordx4 v[10:13], v103, s[28:31], s38 offen sc1
    s_add_u32 s38, s38, 139264
    s_waitcnt lgkmcnt(2)
    buffer_store_dwordx4 v[14:17], v103, s[28:31], s38 offen sc1
    s_add_u32 s38, s38, 139264
    s_waitcnt lgkmcnt(1)
    buffer_store_dwordx4 v[18:21], v104, s[28:31], s39 offen sc1
    s_add_u32 s39, s39, 40960
    s_waitcnt lgkmcnt(0)
    buffer_store_dwordx4 v[22:25], v104, s[28:31], s39 offen sc1
    s_add_u32 s39, s39, 40960
    v_cmp_eq_u32 vcc, 0, v102
    s_and_saveexec_b64 s[42:43], vcc
    s_cmp_eq_u32 s37, 0
    s_cbranch_scc1 k0_kernel_L1
    s_cmp_eq_u32 s32, 31
    s_cbranch_scc1 k0_kernel_L2
    buffer_store_dwordx4 v[10:13], v101, s[28:31], s36 offen offset:528 sc1
    s_add_u32 s36, s36, 139264
    buffer_store_dwordx4 v[14:17], v101, s[28:31], s36 offen offset:528 sc1
    s_add_u32 s36, s36, 139264
    s_branch k0_kernel_L2
k0_kernel_L1:
    s_cmp_lg_u32 s32, 0
    s_cbranch_scc1 k0_kernel_L2
    v_mov_b32 v108, 0
    v_mov_b32 v109, 0
    v_mov_b32 v110, 0
    v_mov_b32 v111, 0
    buffer_store_dwordx4 v[108:111], v101, s[28:31], s36 offen offset:256 sc1
    s_add_u32 s36, s36, 139264
    buffer_store_dwordx4 v[108:111], v101, s[28:31], s36 offen offset:256 sc1
    s_add_u32 s36, s36, 139264
k0_kernel_L2:
    s_endpgm
k0_end:
    s_endpgm
k0_pf:
    s_load_dwordx2 s[4:5], s[0:1], 32
    v_lshrrev_b32 v2, 6, v0
    v_and_b32 v1, 63, v0
    v_readfirstlane_b32 s20, v2
    v_lshlrev_b32 v1, 4, v1
    s_sub_u32 s21, s2, 320
    s_lshr_b32 s21, s21, 3
    s_lshl_b32 s21, s21, 2
    s_add_u32 s21, s21, s20
    s_mul_i32 s23, s21, 3072
    s_lshl_b32 s21, s21, 3
    s_and_b32 s22, s2, 7
    s_add_u32 s21, s21, s22
    s_lshl_b32 s21, s21, 14
    s_waitcnt lgkmcnt(0)
    s_mov_b32 s16, s4
    s_mov_b32 s17, s5
    s_mov_b32 s18, 2621440
    s_mov_b32 s19, 0x00020000
    s_cmp_ge_u32 s2, 336
    s_cbranch_scc1 k0_kernel_zf3
    s_load_dwordx2 s[10:11], s[0:1], 120
    s_sub_u32 s36, s2, 320
    s_lshl_b32 s36, s36, 12
    s_add_u32 s36, s36, 14315520
    v_lshlrev_b32 v3, 4, v0
    v_mov_b32 v4, 0
    v_mov_b32 v5, 0
    v_mov_b32 v6, 0
    v_mov_b32 v7, 0
    s_waitcnt lgkmcnt(0)
    s_mov_b32 s28, s10
    s_mov_b32 s29, s11
    s_mov_b32 s30, 268435456
    s_mov_b32 s31, 0x00020000
    buffer_store_dwordx4 v[4:7], v3, s[28:31], s36 offen sc1
k0_kernel_zf3:
    s_getpc_b64 s[24:25]
k0_pcref:
    s_sub_u32 s24, s24, k0_pcref-k0_kernel
    s_subb_u32 s25, s25, 0
    s_add_u32 s26, s23, 0
    s_min_u32 s26, s26, (CODE_END-k0_kernel-1020)&0xfffffff0
    v_add_u32 v2, s26, v1
    v_mov_b32 v5, s25
    v_add_co_u32 v4, vcc, s24, v2
    v_addc_co_u32 v5, vcc, 0, v5, vcc
    global_load_dwordx4 v[72:75], v[4:5], off
    s_add_u32 s26, s23, 1024
    s_min_u32 s26, s26, (CODE_END-k0_kernel-1020)&0xfffffff0
    v_add_u32 v2, s26, v1
    v_mov_b32 v5, s25
    v_add_co_u32 v4, vcc, s24, v2
    v_addc_co_u32 v5, vcc, 0, v5, vcc
    global_load_dwordx4 v[76:79], v[4:5], off
    s_add_u32 s26, s23, 2048
    s_min_u32 s26, s26, (CODE_END-k0_kernel-1020)&0xfffffff0
    v_add_u32 v2, s26, v1
    v_mov_b32 v5, s25
    v_add_co_u32 v4, vcc, s24, v2
    v_addc_co_u32 v5, vcc, 0, v5, vcc
    global_load_dwordx4 v[80:83], v[4:5], off
    buffer_load_dwordx4 v[8:11], v1, s[16:19], s21 offen offset:0
    buffer_load_dwordx4 v[12:15], v1, s[16:19], s21 offen offset:1024
    buffer_load_dwordx4 v[16:19], v1, s[16:19], s21 offen offset:2048
    buffer_load_dwordx4 v[20:23], v1, s[16:19], s21 offen offset:3072
    s_add_u32 s21, s21, 4096
    buffer_load_dwordx4 v[24:27], v1, s[16:19], s21 offen offset:0
    buffer_load_dwordx4 v[28:31], v1, s[16:19], s21 offen offset:1024
    buffer_load_dwordx4 v[32:35], v1, s[16:19], s21 offen offset:2048
    buffer_load_dwordx4 v[36:39], v1, s[16:19], s21 offen offset:3072
    s_add_u32 s21, s21, 4096
    buffer_load_dwordx4 v[40:43], v1, s[16:19], s21 offen offset:0
    buffer_load_dwordx4 v[44:47], v1, s[16:19], s21 offen offset:1024
    buffer_load_dwordx4 v[48:51], v1, s[16:19], s21 offen offset:2048
    buffer_load_dwordx4 v[52:55], v1, s[16:19], s21 offen offset:3072
    s_add_u32 s21, s21, 4096
    buffer_load_dwordx4 v[56:59], v1, s[16:19], s21 offen offset:0
    buffer_load_dwordx4 v[60:63], v1, s[16:19], s21 offen offset:1024
    buffer_load_dwordx4 v[64:67], v1, s[16:19], s21 offen offset:2048
    buffer_load_dwordx4 v[68:71], v1, s[16:19], s21 offen offset:3072
    s_add_u32 s21, s21, 4096
    s_waitcnt vmcnt(0)
    s_endpgm
.globl k1_kernel
.p2align 8
.type k1_kernel,@function
k1_kernel:
    s_cmp_ge_u32 s2, 440
    s_cbranch_scc1 k1_end
    s_cmp_ge_u32 s2, 376
    s_cbranch_scc1 k1_pf
    s_load_dwordx4 s[4:7], s[0:1], 32
    s_load_dwordx2 s[10:11], s[0:1], 120
    s_load_dwordx2 s[46:47], s[0:1], 112
    v_lshrrev_b32 v2, 6, v0
    v_and_b32 v1, 63, v0
    v_readfirstlane_b32 s20, v2
    s_waitcnt lgkmcnt(0)
    s_mov_b32 s28, s10
    s_mov_b32 s29, s11
    s_mov_b32 s30, 268435456
    s_mov_b32 s31, 0x00020000
    s_mov_b32 s48, s46
    s_mov_b32 s49, s47
    s_mov_b32 s50, 256
    s_mov_b32 s51, 0x00020000
    s_cmp_ge_u32 s2, 374
    s_cbranch_scc1 k1_end
    s_cmp_ge_u32 s2, 220
    s_cbranch_scc1 k1_pack
    s_cmp_ge_u32 s2, 160
    s_cbranch_scc1 k1_modf
    s_setprio 3
    s_mov_b32 s24, s4
    s_mov_b32 s25, s5
    s_mov_b32 s26, 2621440
    s_mov_b32 s27, 0x00020000
    s_lshl_b32 s21, s2, 3
    s_add_u32 s22, s6, s21
    s_addc_u32 s23, s7, 0
    s_load_dwordx2 s[32:33], s[22:23], 0
    s_lshl_b32 s21, s2, 2
    s_add_u32 s21, s21, s20
    s_mul_i32 s34, s20, 9472
    v_lshlrev_b32 v3, 4, v1
    s_lshl_b32 s35, s21, 12
    s_add_u32 s36, s34, 256
    s_mov_b32 m0, s36
    s_mul_i32 s37, s21, 4352
    s_add_u32 s37, s37, 0
    buffer_load_dwordx4 v3, s[24:27], s35 offen offset:0 lds
    buffer_load_dwordx4 v3, s[24:27], s35 offen offset:1024 lds
    buffer_load_dwordx4 v3, s[24:27], s35 offen offset:2048 lds
    buffer_load_dwordx4 v3, s[24:27], s35 offen offset:3072 lds
    v_lshrrev_b32 v4, 3, v0
    v_mul_u32_u24 v4, 20480, v4
    s_lshr_b32 s38, s2, 1
    s_and_b32 s38, s38, 7
    v_and_b32 v5, 7, v0
    v_xor_b32 v5, s38, v5
    v_lshl_add_u32 v4, v5, 4, v4
    s_lshl_b32 s38, s2, 7
    s_add_u32 s39, s38, 2793472
    s_add_u32 s36, s34, 4352
    s_mov_b32 m0, s36
    s_nop 0
    buffer_load_dwordx4 v3, s[28:31], s37 offen offset:0 lds
    buffer_load_dwordx4 v3, s[28:31], s37 offen offset:1024 lds
    buffer_load_dwordx4 v3, s[28:31], s37 offen offset:2048 lds
    buffer_load_dwordx4 v3, s[28:31], s37 offen offset:3072 lds
    s_add_u32 s36, s34, 8448
    s_mov_b32 m0, s36
    s_add_u32 s37, s37, 4096
    buffer_load_dwordx4 v3, s[28:31], s37 offen lds
    buffer_load_dwordx4 v[240:243], v4, s[28:31], s39 offen
    s_add_u32 s39, s39, 655360
    buffer_load_dwordx4 v[244:247], v4, s[28:31], s39 offen
    s_add_u32 s39, s39, 655360
    buffer_load_dwordx4 v[248:251], v4, s[28:31], s39 offen
    s_add_u32 s39, s39, 655360
    buffer_load_dwordx4 v[252:255], v4, s[28:31], s39 offen
    s_add_u32 s39, s39, 655360
    v_lshl_add_u32 v5, v1, 2, s34
    v_mov_b32 v6, 0
    ds_write_b32 v5, v6
    v_and_b32 v7, 15, v1
    v_bfe_u32 v8, v1, 4, 1
    v_lshrrev_b32 v9, 5, v1
    v_mul_u32_u24 v10, 272, v7
    v_lshl_add_u32 v10, v9, 4, v10
    v_add_u32 v10, s34, v10
    v_add_u32 v10, 4356, v10
    v_lshlrev_b32 v11, 2, v8
    v_sub_u32 v10, v10, v11
    v_and_b32 v12, 7, v1
    v_mul_u32_u24 v13, 272, v12
    v_lshl_add_u32 v13, v9, 4, v13
    v_add_u32 v13, s34, v13
    v_add_u32 v13, 4356, v13
    v_sub_u32 v13, v13, v11
    v_bfe_u32 v11, v1, 3, 1
    v_lshlrev_b32 v11, 4, v11
    v_sub_u32 v11, 16, v11
    v_and_b32 v14, 31, v1
    v_lshlrev_b32 v14, 3, v14
    v_lshl_add_u32 v14, v9, 4, v14
    v_add_u32 v14, s34, v14
    v_add_u32 v14, 8, v14
    v_cmp_ne_u32 vcc, 0, v12
    v_mov_b32 v16, 0
    s_nop 1
    v_cndmask_b32 v15, v16, -1, vcc
    s_waitcnt vmcnt(4) lgkmcnt(0)
    ds_read_b64 v[176:177], v14 offset:1792
    ds_read_b64 v[178:179], v14 offset:1800
    ds_read_b64 v[180:181], v14 offset:1824
    ds_read_b64 v[182:183], v14 offset:1832
    ds_read_b64 v[184:185], v14 offset:1856
    ds_read_b64 v[186:187], v14 offset:1864
    ds_read_b64 v[188:189], v14 offset:1888
    ds_read_b64 v[190:191], v14 offset:1896
    ds_read_b64 v[192:193], v14 offset:1920
    ds_read_b64 v[194:195], v14 offset:1928
    ds_read_b64 v[196:197], v14 offset:1952
    ds_read_b64 v[198:199], v14 offset:1960
    ds_read_b64 v[200:201], v14 offset:1984
    ds_read_b64 v[202:203], v14 offset:1992
    ds_read_b64 v[204:205], v14 offset:2016
    ds_read_b64 v[206:207], v14 offset:2024
    ds_read2_b32 v[64:65], v10 offset0:0 offset1:1
    ds_read2_b32 v[66:67], v10 offset0:2 offset1:3
    ds_read2_b32 v[68:69], v10 offset0:8 offset1:9
    ds_read2_b32 v[70:71], v10 offset0:10 offset1:11
    ds_read2_b32 v[72:73], v10 offset0:16 offset1:17
    ds_read2_b32 v[74:75], v10 offset0:18 offset1:19
    ds_read2_b32 v[76:77], v10 offset0:24 offset1:25
    ds_read2_b32 v[78:79], v10 offset0:26 offset1:27
    ds_read2_b32 v[80:81], v10 offset0:32 offset1:33
    ds_read2_b32 v[82:83], v10 offset0:34 offset1:35
    ds_read2_b32 v[84:85], v10 offset0:40 offset1:41
    ds_read2_b32 v[86:87], v10 offset0:42 offset1:43
    ds_read2_b32 v[88:89], v10 offset0:48 offset1:49
    ds_read2_b32 v[90:91], v10 offset0:50 offset1:51
    ds_read2_b32 v[92:93], v10 offset0:56 offset1:57
    ds_read2_b32 v[94:95], v10 offset0:58 offset1:59
    s_waitcnt lgkmcnt(0)
    v_mfma_f32_32x32x16_bf16 v[144:159], v[176:179], v[64:67], 0
    ds_read_b32 v16, v10 offset:16
    ds_read_b32 v17, v10 offset:48
    ds_read_b32 v18, v10 offset:80
    ds_read_b32 v19, v10 offset:112
    ds_read_b32 v20, v10 offset:144
    ds_read_b32 v21, v10 offset:176
    ds_read_b32 v22, v10 offset:208
    ds_read_b32 v23, v10 offset:240
    ds_read2_b32 v[96:97], v13 offset0:0 offset1:1
    ds_read2_b32 v[98:99], v13 offset0:2 offset1:3
    ds_read_b32 v24, v13 offset:16
    ds_read2_b32 v[100:101], v13 offset0:8 offset1:9
    ds_read2_b32 v[102:103], v13 offset0:10 offset1:11
    ds_read_b32 v25, v13 offset:48
    ds_read2_b32 v[104:105], v13 offset0:16 offset1:17
    ds_read2_b32 v[106:107], v13 offset0:18 offset1:19
    v_mfma_f32_32x32x16_bf16 v[144:159], v[180:183], v[68:71], v[144:159]
    ds_read_b32 v26, v13 offset:80
    ds_read2_b32 v[108:109], v13 offset0:24 offset1:25
    ds_read2_b32 v[110:111], v13 offset0:26 offset1:27
    ds_read_b32 v27, v13 offset:112
    ds_read2_b32 v[112:113], v13 offset0:32 offset1:33
    ds_read2_b32 v[114:115], v13 offset0:34 offset1:35
    ds_read_b32 v28, v13 offset:144
    ds_read2_b32 v[116:117], v13 offset0:40 offset1:41
    ds_read2_b32 v[118:119], v13 offset0:42 offset1:43
    ds_read_b32 v29, v13 offset:176
    ds_read2_b32 v[120:121], v13 offset0:48 offset1:49
    ds_read2_b32 v[122:123], v13 offset0:50 offset1:51
    ds_read_b32 v30, v13 offset:208
    ds_read2_b32 v[124:125], v13 offset0:56 offset1:57
    ds_read2_b32 v[126:127], v13 offset0:58 offset1:59
    ds_read_b32 v31, v13 offset:240
    v_mfma_f32_32x32x16_bf16 v[144:159], v[184:187], v[72:75], v[144:159]
    s_waitcnt lgkmcnt(15)
    s_waitcnt lgkmcnt(0)
    v_alignbit_b32 v32, v65, v64, 16
    v_alignbit_b32 v33, v66, v65, 16
    v_alignbit_b32 v34, v67, v66, 16
    v_alignbit_b32 v35, v16, v67, 16
    v_mfma_f32_32x32x16_bf16 v[144:159], v[188:191], v[76:79], v[144:159]
    v_alignbit_b32 v36, v69, v68, 16
    v_alignbit_b32 v37, v70, v69, 16
    v_alignbit_b32 v38, v71, v70, 16
    v_alignbit_b32 v39, v17, v71, 16
    v_alignbit_b32 v40, v73, v72, 16
    v_alignbit_b32 v41, v74, v73, 16
    v_mfma_f32_32x32x16_bf16 v[144:159], v[192:195], v[80:83], v[144:159]
    v_alignbit_b32 v42, v75, v74, 16
    v_alignbit_b32 v43, v18, v75, 16
    v_alignbit_b32 v44, v77, v76, 16
    v_alignbit_b32 v45, v78, v77, 16
    v_alignbit_b32 v46, v79, v78, 16
    v_alignbit_b32 v47, v19, v79, 16
    v_mfma_f32_32x32x16_bf16 v[144:159], v[196:199], v[84:87], v[144:159]
    v_alignbit_b32 v48, v81, v80, 16
    v_alignbit_b32 v49, v82, v81, 16
    v_alignbit_b32 v50, v83, v82, 16
    v_alignbit_b32 v51, v20, v83, 16
    v_alignbit_b32 v52, v85, v84, 16
    v_alignbit_b32 v53, v86, v85, 16
    v_mfma_f32_32x32x16_bf16 v[144:159], v[200:203], v[88:91], v[144:159]
    v_alignbit_b32 v54, v87, v86, 16
    v_alignbit_b32 v55, v21, v87, 16
    v_alignbit_b32 v56, v89, v88, 16
    v_alignbit_b32 v57, v90, v89, 16
    v_alignbit_b32 v58, v91, v90, 16
    v_alignbit_b32 v59, v22, v91, 16
    v_mfma_f32_32x32x16_bf16 v[144:159], v[204:207], v[92:95], v[144:159]
    v_alignbit_b32 v60, v93, v92, 16
    v_alignbit_b32 v61, v94, v93, 16
    v_alignbit_b32 v62, v95, v94, 16
    v_alignbit_b32 v63, v23, v95, 16
    s_nop 0
    v_mfma_f32_32x32x16_bf16 v[128:143], v[176:179], v[32:35], 0
    ds_read_b64 v[208:209], v14 offset:3840
    ds_read_b64 v[210:211], v14 offset:3848
    s_nop 2
    v_mfma_f32_32x32x16_bf16 v[128:143], v[180:183], v[36:39], v[128:143]
    ds_read_b64 v[212:213], v14 offset:3872
    ds_read_b64 v[214:215], v14 offset:3880
    s_nop 2
    v_mfma_f32_32x32x16_bf16 v[128:143], v[184:187], v[40:43], v[128:143]
    ds_read_b64 v[216:217], v14 offset:3904
    ds_read_b64 v[218:219], v14 offset:3912
    v_alignbit_b32 v96, v97, v96, v11
    v_alignbit_b32 v97, v98, v97, v11
    v_alignbit_b32 v98, v99, v98, v11
    v_alignbit_b32 v99, v24, v99, v11
    v_alignbit_b32 v100, v101, v100, v11
    v_alignbit_b32 v101, v102, v101, v11
    v_alignbit_b32 v102, v103, v102, v11
    v_alignbit_b32 v103, v25, v103, v11
    v_alignbit_b32 v104, v105, v104, v11
    v_mfma_f32_32x32x16_bf16 v[128:143], v[188:191], v[44:47], v[128:143]
    ds_read_b64 v[220:221], v14 offset:3936
    ds_read_b64 v[222:223], v14 offset:3944
    v_alignbit_b32 v105, v106, v105, v11
    v_alignbit_b32 v106, v107, v106, v11
    v_alignbit_b32 v107, v26, v107, v11
    v_alignbit_b32 v108, v109, v108, v11
    v_alignbit_b32 v109, v110, v109, v11
    v_alignbit_b32 v110, v111, v110, v11
    v_alignbit_b32 v111, v27, v111, v11
    v_mov_b32_dpp v144, v144 row_shr:1 row_mask:0xf bank_mask:0xf bound_ctrl:0
    v_mfma_f32_32x32x16_bf16 v[128:143], v[192:195], v[48:51], v[128:143]
    ds_read_b64 v[224:225], v14 offset:3968
    ds_read_b64 v[226:227], v14 offset:3976
    v_mov_b32_dpp v145, v145 row_shr:1 row_mask:0xf bank_mask:0xf bound_ctrl:0
    v_mov_b32_dpp v146, v146 row_shr:1 row_mask:0xf bank_mask:0xf bound_ctrl:0
    v_mov_b32_dpp v147, v147 row_shr:1 row_mask:0xf bank_mask:0xf bound_ctrl:0
    v_mov_b32_dpp v148, v148 row_shr:1 row_mask:0xf bank_mask:0xf bound_ctrl:0
    v_mov_b32_dpp v149, v149 row_shr:1 row_mask:0xf bank_mask:0xf bound_ctrl:0
    v_mov_b32_dpp v150, v150 row_shr:1 row_mask:0xf bank_mask:0xf bound_ctrl:0
    v_mov_b32_dpp v151, v151 row_shr:1 row_mask:0xf bank_mask:0xf bound_ctrl:0
    v_mov_b32_dpp v152, v152 row_shr:1 row_mask:0xf bank_mask:0xf bound_ctrl:0
    v_mfma_f32_32x32x16_bf16 v[128:143], v[196:199], v[52:55], v[128:143]
    ds_read_b64 v[228:229], v14 offset:4000
    ds_read_b64 v[230:231], v14 offset:4008
    v_mov_b32_dpp v153, v153 row_shr:1 row_mask:0xf bank_mask:0xf bound_ctrl:0
    v_mov_b32_dpp v154, v154 row_shr:1 row_mask:0xf bank_mask:0xf bound_ctrl:0
    v_mov_b32_dpp v155, v155 row_shr:1 row_mask:0xf bank_mask:0xf bound_ctrl:0
    v_mov_b32_dpp v156, v156 row_shr:1 row_mask:0xf bank_mask:0xf bound_ctrl:0
    v_mov_b32_dpp v157, v157 row_shr:1 row_mask:0xf bank_mask:0xf bound_ctrl:0
    v_mov_b32_dpp v158, v158 row_shr:1 row_mask:0xf bank_mask:0xf bound_ctrl:0
    v_mov_b32_dpp v159, v159 row_shr:1 row_mask:0xf bank_mask:0xf bound_ctrl:0
    v_alignbit_b32 v112, v113, v112, v11
    v_mfma_f32_32x32x16_bf16 v[128:143], v[200:203], v[56:59], v[128:143]
    ds_read_b64 v[232:233], v14 offset:4032
    ds_read_b64 v[234:235], v14 offset:4040
    v_alignbit_b32 v113, v114, v113, v11
    v_alignbit_b32 v114, v115, v114, v11
    v_alignbit_b32 v115, v28, v115, v11
    v_alignbit_b32 v116, v117, v116, v11
    v_alignbit_b32 v117, v118, v117, v11
    v_alignbit_b32 v118, v119, v118, v11
    v_alignbit_b32 v119, v29, v119, v11
    v_alignbit_b32 v120, v121, v120, v11
    v_mfma_f32_32x32x16_bf16 v[128:143], v[204:207], v[60:63], v[128:143]
    ds_read_b64 v[236:237], v14 offset:4064
    ds_read_b64 v[238:239], v14 offset:4072
    v_alignbit_b32 v121, v122, v121, v11
    v_alignbit_b32 v122, v123, v122, v11
    v_alignbit_b32 v123, v30, v123, v11
    v_alignbit_b32 v124, v125, v124, v11
    v_alignbit_b32 v125, v126, v125, v11
    v_alignbit_b32 v126, v127, v126, v11
    v_alignbit_b32 v127, v31, v127, v11
    s_nop 0
    s_waitcnt lgkmcnt(0)
    v_mfma_f32_32x32x16_bf16 v[160:175], v[208:211], v[96:99], 0
    ds_read_b64 v[176:177], v14 offset:1536
    ds_read_b64 v[178:179], v14 offset:1544
    ds_read_b64 v[180:181], v14 offset:1568
    ds_read_b64 v[182:183], v14 offset:1576
    s_nop 0
    v_mfma_f32_32x32x16_bf16 v[160:175], v[212:215], v[100:103], v[160:175]
    ds_read_b64 v[184:185], v14 offset:1600
    ds_read_b64 v[186:187], v14 offset:1608
    ds_read_b64 v[188:189], v14 offset:1632
    s_nop 1
    v_mfma_f32_32x32x16_bf16 v[160:175], v[216:219], v[104:107], v[160:175]
    ds_read_b64 v[190:191], v14 offset:1640
    ds_read_b64 v[192:193], v14 offset:1664
    ds_read_b64 v[194:195], v14 offset:1672
    v_mov_b32_dpp v128, v128 row_shr:1 row_mask:0xf bank_mask:0xf bound_ctrl:0
    v_mov_b32_dpp v129, v129 row_shr:1 row_mask:0xf bank_mask:0xf bound_ctrl:0
    v_mov_b32_dpp v130, v130 row_shr:1 row_mask:0xf bank_mask:0xf bound_ctrl:0
    v_mfma_f32_32x32x16_bf16 v[160:175], v[220:223], v[108:111], v[160:175]
    ds_read_b64 v[196:197], v14 offset:1696
    ds_read_b64 v[198:199], v14 offset:1704
    ds_read_b64 v[200:201], v14 offset:1728
    v_mov_b32_dpp v131, v131 row_shr:1 row_mask:0xf bank_mask:0xf bound_ctrl:0
    v_mov_b32_dpp v132, v132 row_shr:1 row_mask:0xf bank_mask:0xf bound_ctrl:0
    v_mov_b32_dpp v133, v133 row_shr:1 row_mask:0xf bank_mask:0xf bound_ctrl:0
    v_mfma_f32_32x32x16_bf16 v[160:175], v[224:227], v[112:115], v[160:175]
    ds_read_b64 v[202:203], v14 offset:1736
    ds_read_b64 v[204:205], v14 offset:1760
    ds_read_b64 v[206:207], v14 offset:1768
    v_mov_b32_dpp v134, v134 row_shr:1 row_mask:0xf bank_mask:0xf bound_ctrl:0
    v_mov_b32_dpp v135, v135 row_shr:1 row_mask:0xf bank_mask:0xf bound_ctrl:0
    v_mov_b32_dpp v136, v136 row_shr:1 row_mask:0xf bank_mask:0xf bound_ctrl:0
    v_mfma_f32_32x32x16_bf16 v[160:175], v[228:231], v[116:119], v[160:175]
    v_mov_b32_dpp v137, v137 row_shr:1 row_mask:0xf bank_mask:0xf bound_ctrl:0
    v_mov_b32_dpp v138, v138 row_shr:1 row_mask:0xf bank_mask:0xf bound_ctrl:0
    v_mov_b32_dpp v139, v139 row_shr:1 row_mask:0xf bank_mask:0xf bound_ctrl:0
    v_mfma_f32_32x32x16_bf16 v[160:175], v[232:235], v[120:123], v[160:175]
    v_mov_b32_dpp v140, v140 row_shr:1 row_mask:0xf bank_mask:0xf bound_ctrl:0
    v_mov_b32_dpp v141, v141 row_shr:1 row_mask:0xf bank_mask:0xf bound_ctrl:0
    v_mfma_f32_32x32x16_bf16 v[160:175], v[236:239], v[124:127], v[160:175]
    v_mov_b32_dpp v142, v142 row_shr:1 row_mask:0xf bank_mask:0xf bound_ctrl:0
    v_mov_b32_dpp v143, v143 row_shr:1 row_mask:0xf bank_mask:0xf bound_ctrl:0
    s_waitcnt lgkmcnt(0)
    v_mfma_f32_32x32x16_bf16 v[144:159], v[176:179], v[64:67], v[144:159]
    ds_read_b64 v[208:209], v14 offset:3584
    ds_read_b64 v[210:211], v14 offset:3592
    s_nop 2
    v_mfma_f32_32x32x16_bf16 v[144:159], v[180:183], v[68:71], v[144:159]
    ds_read_b64 v[212:213], v14 offset:3616
    ds_read_b64 v[214:215], v14 offset:3624
    s_nop 2
    v_mfma_f32_32x32x16_bf16 v[144:159], v[184:187], v[72:75], v[144:159]
    ds_read_b64 v[216:217], v14 offset:3648
    ds_read_b64 v[218:219], v14 offset:3656
    v_and_b32_dpp v160, v160, v15 row_shr:1 row_mask:0xf bank_mask:0xf bound_ctrl:0
    v_and_b32_dpp v161, v161, v15 row_shr:1 row_mask:0xf bank_mask:0xf bound_ctrl:0
    v_and_b32_dpp v162, v162, v15 row_shr:1 row_mask:0xf bank_mask:0xf bound_ctrl:0
    v_mfma_f32_32x32x16_bf16 v[144:159], v[188:191], v[76:79], v[144:159]
    ds_read_b64 v[220:221], v14 offset:3680
    ds_read_b64 v[222:223], v14 offset:3688
    v_and_b32_dpp v163, v163, v15 row_shr:1 row_mask:0xf bank_mask:0xf bound_ctrl:0
    v_and_b32_dpp v164, v164, v15 row_shr:1 row_mask:0xf bank_mask:0xf bound_ctrl:0
    v_and_b32_dpp v165, v165, v15 row_shr:1 row_mask:0xf bank_mask:0xf bound_ctrl:0
    v_mfma_f32_32x32x16_bf16 v[144:159], v[192:195], v[80:83], v[144:159]
    ds_read_b64 v[224:225], v14 offset:3712
    ds_read_b64 v[226:227], v14 offset:3720
    v_and_b32_dpp v166, v166, v15 row_shr:1 row_mask:0xf bank_mask:0xf bound_ctrl:0
    v_and_b32_dpp v167, v167, v15 row_shr:1 row_mask:0xf bank_mask:0xf bound_ctrl:0
    v_and_b32_dpp v168, v168, v15 row_shr:1 row_mask:0xf bank_mask:0xf bound_ctrl:0
    v_mfma_f32_32x32x16_bf16 v[144:159], v[196:199], v[84:87], v[144:159]
    ds_read_b64 v[228:229], v14 offset:3744
    ds_read_b64 v[230:231], v14 offset:3752
    v_and_b32_dpp v169, v169, v15 row_shr:1 row_mask:0xf bank_mask:0xf bound_ctrl:0
    v_and_b32_dpp v170, v170, v15 row_shr:1 row_mask:0xf bank_mask:0xf bound_ctrl:0
    v_and_b32_dpp v171, v171, v15 row_shr:1 row_mask:0xf bank_mask:0xf bound_ctrl:0
    v_mfma_f32_32x32x16_bf16 v[144:159], v[200:203], v[88:91], v[144:159]
    ds_read_b64 v[232:233], v14 offset:3776
    ds_read_b64 v[234:235], v14 offset:3784
    v_and_b32_dpp v172, v172, v15 row_shr:1 row_mask:0xf bank_mask:0xf bound_ctrl:0
    v_and_b32_dpp v173, v173, v15 row_shr:1 row_mask:0xf bank_mask:0xf bound_ctrl:0
    v_mfma_f32_32x32x16_bf16 v[144:159], v[204:207], v[92:95], v[144:159]
    ds_read_b64 v[236:237], v14 offset:3808
    ds_read_b64 v[238:239], v14 offset:3816
    v_and_b32_dpp v174, v174, v15 row_shr:1 row_mask:0xf bank_mask:0xf bound_ctrl:0
    v_and_b32_dpp v175, v175, v15 row_shr:1 row_mask:0xf bank_mask:0xf bound_ctrl:0
    v_mfma_f32_32x32x16_bf16 v[128:143], v[176:179], v[32:35], v[128:143]
    s_nop 4
    v_mfma_f32_32x32x16_bf16 v[128:143], v[180:183], v[36:39], v[128:143]
    s_nop 4
    v_mfma_f32_32x32x16_bf16 v[128:143], v[184:187], v[40:43], v[128:143]
    v_mov_b32_dpp v144, v144 row_shr:1 row_mask:0xf bank_mask:0xf bound_ctrl:0
    v_mov_b32_dpp v145, v145 row_shr:1 row_mask:0xf bank_mask:0xf bound_ctrl:0
    v_mov_b32_dpp v146, v146 row_shr:1 row_mask:0xf bank_mask:0xf bound_ctrl:0
    v_mfma_f32_32x32x16_bf16 v[128:143], v[188:191], v[44:47], v[128:143]
    v_mov_b32_dpp v147, v147 row_shr:1 row_mask:0xf bank_mask:0xf bound_ctrl:0
    v_mov_b32_dpp v148, v148 row_shr:1 row_mask:0xf bank_mask:0xf bound_ctrl:0
    v_mov_b32_dpp v149, v149 row_shr:1 row_mask:0xf bank_mask:0xf bound_ctrl:0
    v_mfma_f32_32x32x16_bf16 v[128:143], v[192:195], v[48:51], v[128:143]
    v_mov_b32_dpp v150, v150 row_shr:1 row_mask:0xf bank_mask:0xf bound_ctrl:0
    v_mov_b32_dpp v151, v151 row_shr:1 row_mask:0xf bank_mask:0xf bound_ctrl:0
    v_mov_b32_dpp v152, v152 row_shr:1 row_mask:0xf bank_mask:0xf bound_ctrl:0
    v_mfma_f32_32x32x16_bf16 v[128:143], v[196:199], v[52:55], v[128:143]
    v_mov_b32_dpp v153, v153 row_shr:1 row_mask:0xf bank_mask:0xf bound_ctrl:0
    v_mov_b32_dpp v154, v154 row_shr:1 row_mask:0xf bank_mask:0xf bound_ctrl:0
    v_mov_b32_dpp v155, v155 row_shr:1 row_mask:0xf bank_mask:0xf bound_ctrl:0
    v_mfma_f32_32x32x16_bf16 v[128:143], v[200:203], v[56:59], v[128:143]
    v_mov_b32_dpp v156, v156 row_shr:1 row_mask:0xf bank_mask:0xf bound_ctrl:0
    v_mov_b32_dpp v157, v157 row_shr:1 row_mask:0xf bank_mask:0xf bound_ctrl:0
    v_mfma_f32_32x32x16_bf16 v[128:143], v[204:207], v[60:63], v[128:143]
    v_mov_b32_dpp v158, v158 row_shr:1 row_mask:0xf bank_mask:0xf bound_ctrl:0
    v_mov_b32_dpp v159, v159 row_shr:1 row_mask:0xf bank_mask:0xf bound_ctrl:0
    s_waitcnt lgkmcnt(0)
    v_mfma_f32_32x32x16_bf16 v[160:175], v[208:211], v[96:99], v[160:175]
    ds_read_b64 v[176:177], v14 offset:1280
    ds_read_b64 v[178:179], v14 offset:1288
    ds_read_b64 v[180:181], v14 offset:1312
    ds_read_b64 v[182:183], v14 offset:1320
    s_nop 0
    v_mfma_f32_32x32x16_bf16 v[160:175], v[212:215], v[100:103], v[160:175]
    ds_read_b64 v[184:185], v14 offset:1344
    ds_read_b64 v[186:187], v14 offset:1352
    ds_read_b64 v[188:189], v14 offset:1376
    s_nop 1
    v_mfma_f32_32x32x16_bf16 v[160:175], v[216:219], v[104:107], v[160:175]
    ds_read_b64 v[190:191], v14 offset:1384
    ds_read_b64 v[192:193], v14 offset:1408
    ds_read_b64 v[194:195], v14 offset:1416
    v_mov_b32_dpp v128, v128 row_shr:1 row_mask:0xf bank_mask:0xf bound_ctrl:0
    v_mov_b32_dpp v129, v129 row_shr:1 row_mask:0xf bank_mask:0xf bound_ctrl:0
    v_mov_b32_dpp v130, v130 row_shr:1 row_mask:0xf bank_mask:0xf bound_ctrl:0
    v_mfma_f32_32x32x16_bf16 v[160:175], v[220:223], v[108:111], v[160:175]
    ds_read_b64 v[196:197], v14 offset:1440
    ds_read_b64 v[198:199], v14 offset:1448
    ds_read_b64 v[200:201], v14 offset:1472
    v_mov_b32_dpp v131, v131 row_shr:1 row_mask:0xf bank_mask:0xf bound_ctrl:0
    v_mov_b32_dpp v132, v132 row_shr:1 row_mask:0xf bank_mask:0xf bound_ctrl:0
    v_mov_b32_dpp v133, v133 row_shr:1 row_mask:0xf bank_mask:0xf bound_ctrl:0
    v_mfma_f32_32x32x16_bf16 v[160:175], v[224:227], v[112:115], v[160:175]
    ds_read_b64 v[202:203], v14 offset:1480
    ds_read_b64 v[204:205], v14 offset:1504
    ds_read_b64 v[206:207], v14 offset:1512
    v_mov_b32_dpp v134, v134 row_shr:1 row_mask:0xf bank_mask:0xf bound_ctrl:0
    v_mov_b32_dpp v135, v135 row_shr:1 row_mask:0xf bank_mask:0xf bound_ctrl:0
    v_mov_b32_dpp v136, v136 row_shr:1 row_mask:0xf bank_mask:0xf bound_ctrl:0
    v_mfma_f32_32x32x16_bf16 v[160:175], v[228:231], v[116:119], v[160:175]
    v_mov_b32_dpp v137, v137 row_shr:1 row_mask:0xf bank_mask:0xf bound_ctrl:0
    v_mov_b32_dpp v138, v138 row_shr:1 row_mask:0xf bank_mask:0xf bound_ctrl:0
    v_mov_b32_dpp v139, v139 row_shr:1 row_mask:0xf bank_mask:0xf bound_ctrl:0
    v_mfma_f32_32x32x16_bf16 v[160:175], v[232:235], v[120:123], v[160:175]
    v_mov_b32_dpp v140, v140 row_shr:1 row_mask:0xf bank_mask:0xf bound_ctrl:0
    v_mov_b32_dpp v141, v141 row_shr:1 row_mask:0xf bank_mask:0xf bound_ctrl:0
    v_mfma_f32_32x32x16_bf16 v[160:175], v[236:239], v[124:127], v[160:175]
    v_mov_b32_dpp v142, v142 row_shr:1 row_mask:0xf bank_mask:0xf bound_ctrl:0
    v_mov_b32_dpp v143, v143 row_shr:1 row_mask:0xf bank_mask:0xf bound_ctrl:0
    s_waitcnt lgkmcnt(0)
    v_mfma_f32_32x32x16_bf16 v[144:159], v[176:179], v[64:67], v[144:159]
    ds_read_b64 v[208:209], v14 offset:3328
    ds_read_b64 v[210:211], v14 offset:3336
    s_nop 2
    v_mfma_f32_32x32x16_bf16 v[144:159], v[180:183], v[68:71], v[144:159]
    ds_read_b64 v[212:213], v14 offset:3360
    ds_read_b64 v[214:215], v14 offset:3368
    s_nop 2
    v_mfma_f32_32x32x16_bf16 v[144:159], v[184:187], v[72:75], v[144:159]
    ds_read_b64 v[216:217], v14 offset:3392
    ds_read_b64 v[218:219], v14 offset:3400
    v_and_b32_dpp v160, v160, v15 row_shr:1 row_mask:0xf bank_mask:0xf bound_ctrl:0
    v_and_b32_dpp v161, v161, v15 row_shr:1 row_mask:0xf bank_mask:0xf bound_ctrl:0
    v_and_b32_dpp v162, v162, v15 row_shr:1 row_mask:0xf bank_mask:0xf bound_ctrl:0
    v_mfma_f32_32x32x16_bf16 v[144:159], v[188:191], v[76:79], v[144:159]
    ds_read_b64 v[220:221], v14 offset:3424
    ds_read_b64 v[222:223], v14 offset:3432
    v_and_b32_dpp v163, v163, v15 row_shr:1 row_mask:0xf bank_mask:0xf bound_ctrl:0
    v_and_b32_dpp v164, v164, v15 row_shr:1 row_mask:0xf bank_mask:0xf bound_ctrl:0
    v_and_b32_dpp v165, v165, v15 row_shr:1 row_mask:0xf bank_mask:0xf bound_ctrl:0
    v_mfma_f32_32x32x16_bf16 v[144:159], v[192:195], v[80:83], v[144:159]
    ds_read_b64 v[224:225], v14 offset:3456
    ds_read_b64 v[226:227], v14 offset:3464
    v_and_b32_dpp v166, v166, v15 row_shr:1 row_mask:0xf bank_mask:0xf bound_ctrl:0
    v_and_b32_dpp v167, v167, v15 row_shr:1 row_mask:0xf bank_mask:0xf bound_ctrl:0
    v_and_b32_dpp v168, v168, v15 row_shr:1 row_mask:0xf bank_mask:0xf bound_ctrl:0
    v_mfma_f32_32x32x16_bf16 v[144:159], v[196:199], v[84:87], v[144:159]
    ds_read_b64 v[228:229], v14 offset:3488
    ds_read_b64 v[230:231], v14 offset:3496
    v_and_b32_dpp v169, v169, v15 row_shr:1 row_mask:0xf bank_mask:0xf bound_ctrl:0
    v_and_b32_dpp v170, v170, v15 row_shr:1 row_mask:0xf bank_mask:0xf bound_ctrl:0
    v_and_b32_dpp v171, v171, v15 row_shr:1 row_mask:0xf bank_mask:0xf bound_ctrl:0
    v_mfma_f32_32x32x16_bf16 v[144:159], v[200:203], v[88:91], v[144:159]
    ds_read_b64 v[232:233], v14 offset:3520
    ds_read_b64 v[234:235], v14 offset:3528
    v_and_b32_dpp v172, v172, v15 row_shr:1 row_mask:0xf bank_mask:0xf bound_ctrl:0
    v_and_b32_dpp v173, v173, v15 row_shr:1 row_mask:0xf bank_mask:0xf bound_ctrl:0
    v_mfma_f32_32x32x16_bf16 v[144:159], v[204:207], v[92:95], v[144:159]
    ds_read_b64 v[236:237], v14 offset:3552
    ds_read_b64 v[238:239], v14 offset:3560
    v_and_b32_dpp v174, v174, v15 row_shr:1 row_mask:0xf bank_mask:0xf bound_ctrl:0
    v_and_b32_dpp v175, v175, v15 row_shr:1 row_mask:0xf bank_mask:0xf bound_ctrl:0
    v_mfma_f32_32x32x16_bf16 v[128:143], v[176:179], v[32:35], v[128:143]
    s_nop 4
    v_mfma_f32_32x32x16_bf16 v[128:143], v[180:183], v[36:39], v[128:143]
    s_nop 4
    v_mfma_f32_32x32x16_bf16 v[128:143], v[184:187], v[40:43], v[128:143]
    v_mov_b32_dpp v144, v144 row_shr:1 row_mask:0xf bank_mask:0xf bound_ctrl:0
    v_mov_b32_dpp v145, v145 row_shr:1 row_mask:0xf bank_mask:0xf bound_ctrl:0
    v_mov_b32_dpp v146, v146 row_shr:1 row_mask:0xf bank_mask:0xf bound_ctrl:0
    v_mfma_f32_32x32x16_bf16 v[128:143], v[188:191], v[44:47], v[128:143]
    v_mov_b32_dpp v147, v147 row_shr:1 row_mask:0xf bank_mask:0xf bound_ctrl:0
    v_mov_b32_dpp v148, v148 row_shr:1 row_mask:0xf bank_mask:0xf bound_ctrl:0
    v_mov_b32_dpp v149, v149 row_shr:1 row_mask:0xf bank_mask:0xf bound_ctrl:0
    v_mfma_f32_32x32x16_bf16 v[128:143], v[192:195], v[48:51], v[128:143]
    v_mov_b32_dpp v150, v150 row_shr:1 row_mask:0xf bank_mask:0xf bound_ctrl:0
    v_mov_b32_dpp v151, v151 row_shr:1 row_mask:0xf bank_mask:0xf bound_ctrl:0
    v_mov_b32_dpp v152, v152 row_shr:1 row_mask:0xf bank_mask:0xf bound_ctrl:0
    v_mfma_f32_32x32x16_bf16 v[128:143], v[196:199], v[52:55], v[128:143]
    v_mov_b32_dpp v153, v153 row_shr:1 row_mask:0xf bank_mask:0xf bound_ctrl:0
    v_mov_b32_dpp v154, v154 row_shr:1 row_mask:0xf bank_mask:0xf bound_ctrl:0
    v_mov_b32_dpp v155, v155 row_shr:1 row_mask:0xf bank_mask:0xf bound_ctrl:0
    v_mfma_f32_32x32x16_bf16 v[128:143], v[200:203], v[56:59], v[128:143]
    v_mov_b32_dpp v156, v156 row_shr:1 row_mask:0xf bank_mask:0xf bound_ctrl:0
    v_mov_b32_dpp v157, v157 row_shr:1 row_mask:0xf bank_mask:0xf bound_ctrl:0
    v_mfma_f32_32x32x16_bf16 v[128:143], v[204:207], v[60:63], v[128:143]
    v_mov_b32_dpp v158, v158 row_shr:1 row_mask:0xf bank_mask:0xf bound_ctrl:0
    v_mov_b32_dpp v159, v159 row_shr:1 row_mask:0xf bank_mask:0xf bound_ctrl:0
    s_waitcnt lgkmcnt(0)
    v_mfma_f32_32x32x16_bf16 v[160:175], v[208:211], v[96:99], v[160:175]
    ds_read_b64 v[176:177], v14 offset:1024
    ds_read_b64 v[178:179], v14 offset:1032
    ds_read_b64 v[180:181], v14 offset:1056
    ds_read_b64 v[182:183], v14 offset:1064
    s_nop 0
    v_mfma_f32_32x32x16_bf16 v[160:175], v[212:215], v[100:103], v[160:175]
    ds_read_b64 v[184:185], v14 offset:1088
    ds_read_b64 v[186:187], v14 offset:1096
    ds_read_b64 v[188:189], v14 offset:1120
    s_nop 1
    v_mfma_f32_32x32x16_bf16 v[160:175], v[216:219], v[104:107], v[160:175]
    ds_read_b64 v[190:191], v14 offset:1128
    ds_read_b64 v[192:193], v14 offset:1152
    ds_read_b64 v[194:195], v14 offset:1160
    v_mov_b32_dpp v128, v128 row_shr:1 row_mask:0xf bank_mask:0xf bound_ctrl:0
    v_mov_b32_dpp v129, v129 row_shr:1 row_mask:0xf bank_mask:0xf bound_ctrl:0
    v_mov_b32_dpp v130, v130 row_shr:1 row_mask:0xf bank_mask:0xf bound_ctrl:0
    v_mfma_f32_32x32x16_bf16 v[160:175], v[220:223], v[108:111], v[160:175]
    ds_read_b64 v[196:197], v14 offset:1184
    ds_read_b64 v[198:199], v14 offset:1192
    ds_read_b64 v[200:201], v14 offset:1216
    v_mov_b32_dpp v131, v131 row_shr:1 row_mask:0xf bank_mask:0xf bound_ctrl:0
    v_mov_b32_dpp v132, v132 row_shr:1 row_mask:0xf bank_mask:0xf bound_ctrl:0
    v_mov_b32_dpp v133, v133 row_shr:1 row_mask:0xf bank_mask:0xf bound_ctrl:0
    v_mfma_f32_32x32x16_bf16 v[160:175], v[224:227], v[112:115], v[160:175]
    ds_read_b64 v[202:203], v14 offset:1224
    ds_read_b64 v[204:205], v14 offset:1248
    ds_read_b64 v[206:207], v14 offset:1256
    v_mov_b32_dpp v134, v134 row_shr:1 row_mask:0xf bank_mask:0xf bound_ctrl:0
    v_mov_b32_dpp v135, v135 row_shr:1 row_mask:0xf bank_mask:0xf bound_ctrl:0
    v_mov_b32_dpp v136, v136 row_shr:1 row_mask:0xf bank_mask:0xf bound_ctrl:0
    v_mfma_f32_32x32x16_bf16 v[160:175], v[228:231], v[116:119], v[160:175]
    v_mov_b32_dpp v137, v137 row_shr:1 row_mask:0xf bank_mask:0xf bound_ctrl:0
    v_mov_b32_dpp v138, v138 row_shr:1 row_mask:0xf bank_mask:0xf bound_ctrl:0
    v_mov_b32_dpp v139, v139 row_shr:1 row_mask:0xf bank_mask:0xf bound_ctrl:0
    v_mfma_f32_32x32x16_bf16 v[160:175], v[232:235], v[120:123], v[160:175]
    v_mov_b32_dpp v140, v140 row_shr:1 row_mask:0xf bank_mask:0xf bound_ctrl:0
    v_mov_b32_dpp v141, v141 row_shr:1 row_mask:0xf bank_mask:0xf bound_ctrl:0
    v_mfma_f32_32x32x16_bf16 v[160:175], v[236:239], v[124:127], v[160:175]
    v_mov_b32_dpp v142, v142 row_shr:1 row_mask:0xf bank_mask:0xf bound_ctrl:0
    v_mov_b32_dpp v143, v143 row_shr:1 row_mask:0xf bank_mask:0xf bound_ctrl:0
    s_waitcnt lgkmcnt(0)
    v_mfma_f32_32x32x16_bf16 v[144:159], v[176:179], v[64:67], v[144:159]
    ds_read_b64 v[208:209], v14 offset:3072
    ds_read_b64 v[210:211], v14 offset:3080
    s_nop 2
    v_mfma_f32_32x32x16_bf16 v[144:159], v[180:183], v[68:71], v[144:159]
    ds_read_b64 v[212:213], v14 offset:3104
    ds_read_b64 v[214:215], v14 offset:3112
    s_nop 2
    v_mfma_f32_32x32x16_bf16 v[144:159], v[184:187], v[72:75], v[144:159]
    ds_read_b64 v[216:217], v14 offset:3136
    ds_read_b64 v[218:219], v14 offset:3144
    v_and_b32_dpp v160, v160, v15 row_shr:1 row_mask:0xf bank_mask:0xf bound_ctrl:0
    v_and_b32_dpp v161, v161, v15 row_shr:1 row_mask:0xf bank_mask:0xf bound_ctrl:0
    v_and_b32_dpp v162, v162, v15 row_shr:1 row_mask:0xf bank_mask:0xf bound_ctrl:0
    v_mfma_f32_32x32x16_bf16 v[144:159], v[188:191], v[76:79], v[144:159]
    ds_read_b64 v[220:221], v14 offset:3168
    ds_read_b64 v[222:223], v14 offset:3176
    v_and_b32_dpp v163, v163, v15 row_shr:1 row_mask:0xf bank_mask:0xf bound_ctrl:0
    v_and_b32_dpp v164, v164, v15 row_shr:1 row_mask:0xf bank_mask:0xf bound_ctrl:0
    v_and_b32_dpp v165, v165, v15 row_shr:1 row_mask:0xf bank_mask:0xf bound_ctrl:0
    v_mfma_f32_32x32x16_bf16 v[144:159], v[192:195], v[80:83], v[144:159]
    ds_read_b64 v[224:225], v14 offset:3200
    ds_read_b64 v[226:227], v14 offset:3208
    v_and_b32_dpp v166, v166, v15 row_shr:1 row_mask:0xf bank_mask:0xf bound_ctrl:0
    v_and_b32_dpp v167, v167, v15 row_shr:1 row_mask:0xf bank_mask:0xf bound_ctrl:0
    v_and_b32_dpp v168, v168, v15 row_shr:1 row_mask:0xf bank_mask:0xf bound_ctrl:0
    v_mfma_f32_32x32x16_bf16 v[144:159], v[196:199], v[84:87], v[144:159]
    ds_read_b64 v[228:229], v14 offset:3232
    ds_read_b64 v[230:231], v14 offset:3240
    v_and_b32_dpp v169, v169, v15 row_shr:1 row_mask:0xf bank_mask:0xf bound_ctrl:0
    v_and_b32_dpp v170, v170, v15 row_shr:1 row_mask:0xf bank_mask:0xf bound_ctrl:0
    v_and_b32_dpp v171, v171, v15 row_shr:1 row_mask:0xf bank_mask:0xf bound_ctrl:0
    v_mfma_f32_32x32x16_bf16 v[144:159], v[200:203], v[88:91], v[144:159]
    ds_read_b64 v[232:233], v14 offset:3264
    ds_read_b64 v[234:235], v14 offset:3272
    v_and_b32_dpp v172, v172, v15 row_shr:1 row_mask:0xf bank_mask:0xf bound_ctrl:0
    v_and_b32_dpp v173, v173, v15 row_shr:1 row_mask:0xf bank_mask:0xf bound_ctrl:0
    v_mfma_f32_32x32x16_bf16 v[144:159], v[204:207], v[92:95], v[144:159]
    ds_read_b64 v[236:237], v14 offset:3296
    ds_read_b64 v[238:239], v14 offset:3304
    v_and_b32_dpp v174, v174, v15 row_shr:1 row_mask:0xf bank_mask:0xf bound_ctrl:0
    v_and_b32_dpp v175, v175, v15 row_shr:1 row_mask:0xf bank_mask:0xf bound_ctrl:0
    v_mfma_f32_32x32x16_bf16 v[128:143], v[176:179], v[32:35], v[128:143]
    s_nop 4
    v_mfma_f32_32x32x16_bf16 v[128:143], v[180:183], v[36:39], v[128:143]
    s_nop 4
    v_mfma_f32_32x32x16_bf16 v[128:143], v[184:187], v[40:43], v[128:143]
    v_mov_b32_dpp v144, v144 row_shr:1 row_mask:0xf bank_mask:0xf bound_ctrl:0
    v_mov_b32_dpp v145, v145 row_shr:1 row_mask:0xf bank_mask:0xf bound_ctrl:0
    v_mov_b32_dpp v146, v146 row_shr:1 row_mask:0xf bank_mask:0xf bound_ctrl:0
    v_mfma_f32_32x32x16_bf16 v[128:143], v[188:191], v[44:47], v[128:143]
    v_mov_b32_dpp v147, v147 row_shr:1 row_mask:0xf bank_mask:0xf bound_ctrl:0
    v_mov_b32_dpp v148, v148 row_shr:1 row_mask:0xf bank_mask:0xf bound_ctrl:0
    v_mov_b32_dpp v149, v149 row_shr:1 row_mask:0xf bank_mask:0xf bound_ctrl:0
    v_mfma_f32_32x32x16_bf16 v[128:143], v[192:195], v[48:51], v[128:143]
    v_mov_b32_dpp v150, v150 row_shr:1 row_mask:0xf bank_mask:0xf bound_ctrl:0
    v_mov_b32_dpp v151, v151 row_shr:1 row_mask:0xf bank_mask:0xf bound_ctrl:0
    v_mov_b32_dpp v152, v152 row_shr:1 row_mask:0xf bank_mask:0xf bound_ctrl:0
    v_mfma_f32_32x32x16_bf16 v[128:143], v[196:199], v[52:55], v[128:143]
    v_mov_b32_dpp v153, v153 row_shr:1 row_mask:0xf bank_mask:0xf bound_ctrl:0
    v_mov_b32_dpp v154, v154 row_shr:1 row_mask:0xf bank_mask:0xf bound_ctrl:0
    v_mov_b32_dpp v155, v155 row_shr:1 row_mask:0xf bank_mask:0xf bound_ctrl:0
    v_mfma_f32_32x32x16_bf16 v[128:143], v[200:203], v[56:59], v[128:143]
    v_mov_b32_dpp v156, v156 row_shr:1 row_mask:0xf bank_mask:0xf bound_ctrl:0
    v_mov_b32_dpp v157, v157 row_shr:1 row_mask:0xf bank_mask:0xf bound_ctrl:0
    v_mfma_f32_32x32x16_bf16 v[128:143], v[204:207], v[60:63], v[128:143]
    v_mov_b32_dpp v158, v158 row_shr:1 row_mask:0xf bank_mask:0xf bound_ctrl:0
    v_mov_b32_dpp v159, v159 row_shr:1 row_mask:0xf bank_mask:0xf bound_ctrl:0
    s_waitcnt lgkmcnt(0)
    v_mfma_f32_32x32x16_bf16 v[160:175], v[208:211], v[96:99], v[160:175]
    ds_read_b64 v[176:177], v14 offset:768
    ds_read_b64 v[178:179], v14 offset:776
    ds_read_b64 v[180:181], v14 offset:800
    ds_read_b64 v[182:183], v14 offset:808
    s_nop 0
    v_mfma_f32_32x32x16_bf16 v[160:175], v[212:215], v[100:103], v[160:175]
    ds_read_b64 v[184:185], v14 offset:832
    ds_read_b64 v[186:187], v14 offset:840
    ds_read_b64 v[188:189], v14 offset:864
    s_nop 1
    v_mfma_f32_32x32x16_bf16 v[160:175], v[216:219], v[104:107], v[160:175]
    ds_read_b64 v[190:191], v14 offset:872
    ds_read_b64 v[192:193], v14 offset:896
    ds_read_b64 v[194:195], v14 offset:904
    v_mov_b32_dpp v128, v128 row_shr:1 row_mask:0xf bank_mask:0xf bound_ctrl:0
    v_mov_b32_dpp v129, v129 row_shr:1 row_mask:0xf bank_mask:0xf bound_ctrl:0
    v_mov_b32_dpp v130, v130 row_shr:1 row_mask:0xf bank_mask:0xf bound_ctrl:0
    v_mfma_f32_32x32x16_bf16 v[160:175], v[220:223], v[108:111], v[160:175]
    ds_read_b64 v[196:197], v14 offset:928
    ds_read_b64 v[198:199], v14 offset:936
    ds_read_b64 v[200:201], v14 offset:960
    v_mov_b32_dpp v131, v131 row_shr:1 row_mask:0xf bank_mask:0xf bound_ctrl:0
    v_mov_b32_dpp v132, v132 row_shr:1 row_mask:0xf bank_mask:0xf bound_ctrl:0
    v_mov_b32_dpp v133, v133 row_shr:1 row_mask:0xf bank_mask:0xf bound_ctrl:0
    v_mfma_f32_32x32x16_bf16 v[160:175], v[224:227], v[112:115], v[160:175]
    ds_read_b64 v[202:203], v14 offset:968
    ds_read_b64 v[204:205], v14 offset:992
    ds_read_b64 v[206:207], v14 offset:1000
    v_mov_b32_dpp v134, v134 row_shr:1 row_mask:0xf bank_mask:0xf bound_ctrl:0
    v_mov_b32_dpp v135, v135 row_shr:1 row_mask:0xf bank_mask:0xf bound_ctrl:0
    v_mov_b32_dpp v136, v136 row_shr:1 row_mask:0xf bank_mask:0xf bound_ctrl:0
    v_mfma_f32_32x32x16_bf16 v[160:175], v[228:231], v[116:119], v[160:175]
    v_mov_b32_dpp v137, v137 row_shr:1 row_mask:0xf bank_mask:0xf bound_ctrl:0
    v_mov_b32_dpp v138, v138 row_shr:1 row_mask:0xf bank_mask:0xf bound_ctrl:0
    v_mov_b32_dpp v139, v139 row_shr:1 row_mask:0xf bank_mask:0xf bound_ctrl:0
    v_mfma_f32_32x32x16_bf16 v[160:175], v[232:235], v[120:123], v[160:175]
    v_mov_b32_dpp v140, v140 row_shr:1 row_mask:0xf bank_mask:0xf bound_ctrl:0
    v_mov_b32_dpp v141, v141 row_shr:1 row_mask:0xf bank_mask:0xf bound_ctrl:0
    v_mfma_f32_32x32x16_bf16 v[160:175], v[236:239], v[124:127], v[160:175]
    v_mov_b32_dpp v142, v142 row_shr:1 row_mask:0xf bank_mask:0xf bound_ctrl:0
    v_mov_b32_dpp v143, v143 row_shr:1 row_mask:0xf bank_mask:0xf bound_ctrl:0
    s_waitcnt lgkmcnt(0)
    v_mfma_f32_32x32x16_bf16 v[144:159], v[176:179], v[64:67], v[144:159]
    ds_read_b64 v[208:209], v14 offset:2816
    ds_read_b64 v[210:211], v14 offset:2824
    s_nop 2
    v_mfma_f32_32x32x16_bf16 v[144:159], v[180:183], v[68:71], v[144:159]
    ds_read_b64 v[212:213], v14 offset:2848
    ds_read_b64 v[214:215], v14 offset:2856
    s_nop 2
    v_mfma_f32_32x32x16_bf16 v[144:159], v[184:187], v[72:75], v[144:159]
    ds_read_b64 v[216:217], v14 offset:2880
    ds_read_b64 v[218:219], v14 offset:2888
    v_and_b32_dpp v160, v160, v15 row_shr:1 row_mask:0xf bank_mask:0xf bound_ctrl:0
    v_and_b32_dpp v161, v161, v15 row_shr:1 row_mask:0xf bank_mask:0xf bound_ctrl:0
    v_and_b32_dpp v162, v162, v15 row_shr:1 row_mask:0xf bank_mask:0xf bound_ctrl:0
    v_mfma_f32_32x32x16_bf16 v[144:159], v[188:191], v[76:79], v[144:159]
    ds_read_b64 v[220:221], v14 offset:2912
    ds_read_b64 v[222:223], v14 offset:2920
    v_and_b32_dpp v163, v163, v15 row_shr:1 row_mask:0xf bank_mask:0xf bound_ctrl:0
    v_and_b32_dpp v164, v164, v15 row_shr:1 row_mask:0xf bank_mask:0xf bound_ctrl:0
    v_and_b32_dpp v165, v165, v15 row_shr:1 row_mask:0xf bank_mask:0xf bound_ctrl:0
    v_mfma_f32_32x32x16_bf16 v[144:159], v[192:195], v[80:83], v[144:159]
    ds_read_b64 v[224:225], v14 offset:2944
    ds_read_b64 v[226:227], v14 offset:2952
    v_and_b32_dpp v166, v166, v15 row_shr:1 row_mask:0xf bank_mask:0xf bound_ctrl:0
    v_and_b32_dpp v167, v167, v15 row_shr:1 row_mask:0xf bank_mask:0xf bound_ctrl:0
    v_and_b32_dpp v168, v168, v15 row_shr:1 row_mask:0xf bank_mask:0xf bound_ctrl:0
    v_mfma_f32_32x32x16_bf16 v[144:159], v[196:199], v[84:87], v[144:159]
    ds_read_b64 v[228:229], v14 offset:2976
    ds_read_b64 v[230:231], v14 offset:2984
    v_and_b32_dpp v169, v169, v15 row_shr:1 row_mask:0xf bank_mask:0xf bound_ctrl:0
    v_and_b32_dpp v170, v170, v15 row_shr:1 row_mask:0xf bank_mask:0xf bound_ctrl:0
    v_and_b32_dpp v171, v171, v15 row_shr:1 row_mask:0xf bank_mask:0xf bound_ctrl:0
    v_mfma_f32_32x32x16_bf16 v[144:159], v[200:203], v[88:91], v[144:159]
    ds_read_b64 v[232:233], v14 offset:3008
    ds_read_b64 v[234:235], v14 offset:3016
    v_and_b32_dpp v172, v172, v15 row_shr:1 row_mask:0xf bank_mask:0xf bound_ctrl:0
    v_and_b32_dpp v173, v173, v15 row_shr:1 row_mask:0xf bank_mask:0xf bound_ctrl:0
    v_mfma_f32_32x32x16_bf16 v[144:159], v[204:207], v[92:95], v[144:159]
    ds_read_b64 v[236:237], v14 offset:3040
    ds_read_b64 v[238:239], v14 offset:3048
    v_and_b32_dpp v174, v174, v15 row_shr:1 row_mask:0xf bank_mask:0xf bound_ctrl:0
    v_and_b32_dpp v175, v175, v15 row_shr:1 row_mask:0xf bank_mask:0xf bound_ctrl:0
    v_mfma_f32_32x32x16_bf16 v[128:143], v[176:179], v[32:35], v[128:143]
    s_nop 4
    v_mfma_f32_32x32x16_bf16 v[128:143], v[180:183], v[36:39], v[128:143]
    s_nop 4
    v_mfma_f32_32x32x16_bf16 v[128:143], v[184:187], v[40:43], v[128:143]
    v_mov_b32_dpp v144, v144 row_shr:1 row_mask:0xf bank_mask:0xf bound_ctrl:0
    v_mov_b32_dpp v145, v145 row_shr:1 row_mask:0xf bank_mask:0xf bound_ctrl:0
    v_mov_b32_dpp v146, v146 row_shr:1 row_mask:0xf bank_mask:0xf bound_ctrl:0
    v_mfma_f32_32x32x16_bf16 v[128:143], v[188:191], v[44:47], v[128:143]
    v_mov_b32_dpp v147, v147 row_shr:1 row_mask:0xf bank_mask:0xf bound_ctrl:0
    v_mov_b32_dpp v148, v148 row_shr:1 row_mask:0xf bank_mask:0xf bound_ctrl:0
    v_mov_b32_dpp v149, v149 row_shr:1 row_mask:0xf bank_mask:0xf bound_ctrl:0
    v_mfma_f32_32x32x16_bf16 v[128:143], v[192:195], v[48:51], v[128:143]
    v_mov_b32_dpp v150, v150 row_shr:1 row_mask:0xf bank_mask:0xf bound_ctrl:0
    v_mov_b32_dpp v151, v151 row_shr:1 row_mask:0xf bank_mask:0xf bound_ctrl:0
    v_mov_b32_dpp v152, v152 row_shr:1 row_mask:0xf bank_mask:0xf bound_ctrl:0
    v_mfma_f32_32x32x16_bf16 v[128:143], v[196:199], v[52:55], v[128:143]
    v_mov_b32_dpp v153, v153 row_shr:1 row_mask:0xf bank_mask:0xf bound_ctrl:0
    v_mov_b32_dpp v154, v154 row_shr:1 row_mask:0xf bank_mask:0xf bound_ctrl:0
    v_mov_b32_dpp v155, v155 row_shr:1 row_mask:0xf bank_mask:0xf bound_ctrl:0
    v_mfma_f32_32x32x16_bf16 v[128:143], v[200:203], v[56:59], v[128:143]
    v_mov_b32_dpp v156, v156 row_shr:1 row_mask:0xf bank_mask:0xf bound_ctrl:0
    v_mov_b32_dpp v157, v157 row_shr:1 row_mask:0xf bank_mask:0xf bound_ctrl:0
    v_mfma_f32_32x32x16_bf16 v[128:143], v[204:207], v[60:63], v[128:143]
    v_mov_b32_dpp v158, v158 row_shr:1 row_mask:0xf bank_mask:0xf bound_ctrl:0
    v_mov_b32_dpp v159, v159 row_shr:1 row_mask:0xf bank_mask:0xf bound_ctrl:0
    s_waitcnt lgkmcnt(0)
    v_mfma_f32_32x32x16_bf16 v[160:175], v[208:211], v[96:99], v[160:175]
    ds_read_b64 v[176:177], v14 offset:512
    ds_read_b64 v[178:179], v14 offset:520
    ds_read_b64 v[180:181], v14 offset:544
    ds_read_b64 v[182:183], v14 offset:552
    s_nop 0
    v_mfma_f32_32x32x16_bf16 v[160:175], v[212:215], v[100:103], v[160:175]
    ds_read_b64 v[184:185], v14 offset:576
    ds_read_b64 v[186:187], v14 offset:584
    ds_read_b64 v[188:189], v14 offset:608
    s_nop 1
    v_mfma_f32_32x32x16_bf16 v[160:175], v[216:219], v[104:107], v[160:175]
    ds_read_b64 v[190:191], v14 offset:616
    ds_read_b64 v[192:193], v14 offset:640
    ds_read_b64 v[194:195], v14 offset:648
    v_mov_b32_dpp v128, v128 row_shr:1 row_mask:0xf bank_mask:0xf bound_ctrl:0
    v_mov_b32_dpp v129, v129 row_shr:1 row_mask:0xf bank_mask:0xf bound_ctrl:0
    v_mov_b32_dpp v130, v130 row_shr:1 row_mask:0xf bank_mask:0xf bound_ctrl:0
    v_mfma_f32_32x32x16_bf16 v[160:175], v[220:223], v[108:111], v[160:175]
    ds_read_b64 v[196:197], v14 offset:672
    ds_read_b64 v[198:199], v14 offset:680
    ds_read_b64 v[200:201], v14 offset:704
    v_mov_b32_dpp v131, v131 row_shr:1 row_mask:0xf bank_mask:0xf bound_ctrl:0
    v_mov_b32_dpp v132, v132 row_shr:1 row_mask:0xf bank_mask:0xf bound_ctrl:0
    v_mov_b32_dpp v133, v133 row_shr:1 row_mask:0xf bank_mask:0xf bound_ctrl:0
    v_mfma_f32_32x32x16_bf16 v[160:175], v[224:227], v[112:115], v[160:175]
    ds_read_b64 v[202:203], v14 offset:712
    ds_read_b64 v[204:205], v14 offset:736
    ds_read_b64 v[206:207], v14 offset:744
    v_mov_b32_dpp v134, v134 row_shr:1 row_mask:0xf bank_mask:0xf bound_ctrl:0
    v_mov_b32_dpp v135, v135 row_shr:1 row_mask:0xf bank_mask:0xf bound_ctrl:0
    v_mov_b32_dpp v136, v136 row_shr:1 row_mask:0xf bank_mask:0xf bound_ctrl:0
    v_mfma_f32_32x32x16_bf16 v[160:175], v[228:231], v[116:119], v[160:175]
    v_mov_b32_dpp v137, v137 row_shr:1 row_mask:0xf bank_mask:0xf bound_ctrl:0
    v_mov_b32_dpp v138, v138 row_shr:1 row_mask:0xf bank_mask:0xf bound_ctrl:0
    v_mov_b32_dpp v139, v139 row_shr:1 row_mask:0xf bank_mask:0xf bound_ctrl:0
    v_mfma_f32_32x32x16_bf16 v[160:175], v[232:235], v[120:123], v[160:175]
    v_mov_b32_dpp v140, v140 row_shr:1 row_mask:0xf bank_mask:0xf bound_ctrl:0
    v_mov_b32_dpp v141, v141 row_shr:1 row_mask:0xf bank_mask:0xf bound_ctrl:0
    v_mfma_f32_32x32x16_bf16 v[160:175], v[236:239], v[124:127], v[160:175]
    v_mov_b32_dpp v142, v142 row_shr:1 row_mask:0xf bank_mask:0xf bound_ctrl:0
    v_mov_b32_dpp v143, v143 row_shr:1 row_mask:0xf bank_mask:0xf bound_ctrl:0
    s_waitcnt lgkmcnt(0)
    v_mfma_f32_32x32x16_bf16 v[144:159], v[176:179], v[64:67], v[144:159]
    ds_read_b64 v[208:209], v14 offset:2560
    ds_read_b64 v[210:211], v14 offset:2568
    s_nop 2
    v_mfma_f32_32x32x16_bf16 v[144:159], v[180:183], v[68:71], v[144:159]
    ds_read_b64 v[212:213], v14 offset:2592
    ds_read_b64 v[214:215], v14 offset:2600
    s_nop 2
    v_mfma_f32_32x32x16_bf16 v[144:159], v[184:187], v[72:75], v[144:159]
    ds_read_b64 v[216:217], v14 offset:2624
    ds_read_b64 v[218:219], v14 offset:2632
    v_and_b32_dpp v160, v160, v15 row_shr:1 row_mask:0xf bank_mask:0xf bound_ctrl:0
    v_and_b32_dpp v161, v161, v15 row_shr:1 row_mask:0xf bank_mask:0xf bound_ctrl:0
    v_and_b32_dpp v162, v162, v15 row_shr:1 row_mask:0xf bank_mask:0xf bound_ctrl:0
    v_mfma_f32_32x32x16_bf16 v[144:159], v[188:191], v[76:79], v[144:159]
    ds_read_b64 v[220:221], v14 offset:2656
    ds_read_b64 v[222:223], v14 offset:2664
    v_and_b32_dpp v163, v163, v15 row_shr:1 row_mask:0xf bank_mask:0xf bound_ctrl:0
    v_and_b32_dpp v164, v164, v15 row_shr:1 row_mask:0xf bank_mask:0xf bound_ctrl:0
    v_and_b32_dpp v165, v165, v15 row_shr:1 row_mask:0xf bank_mask:0xf bound_ctrl:0
    v_mfma_f32_32x32x16_bf16 v[144:159], v[192:195], v[80:83], v[144:159]
    ds_read_b64 v[224:225], v14 offset:2688
    ds_read_b64 v[226:227], v14 offset:2696
    v_and_b32_dpp v166, v166, v15 row_shr:1 row_mask:0xf bank_mask:0xf bound_ctrl:0
    v_and_b32_dpp v167, v167, v15 row_shr:1 row_mask:0xf bank_mask:0xf bound_ctrl:0
    v_and_b32_dpp v168, v168, v15 row_shr:1 row_mask:0xf bank_mask:0xf bound_ctrl:0
    v_mfma_f32_32x32x16_bf16 v[144:159], v[196:199], v[84:87], v[144:159]
    ds_read_b64 v[228:229], v14 offset:2720
    ds_read_b64 v[230:231], v14 offset:2728
    v_and_b32_dpp v169, v169, v15 row_shr:1 row_mask:0xf bank_mask:0xf bound_ctrl:0
    v_and_b32_dpp v170, v170, v15 row_shr:1 row_mask:0xf bank_mask:0xf bound_ctrl:0
    v_and_b32_dpp v171, v171, v15 row_shr:1 row_mask:0xf bank_mask:0xf bound_ctrl:0
    v_mfma_f32_32x32x16_bf16 v[144:159], v[200:203], v[88:91], v[144:159]
    ds_read_b64 v[232:233], v14 offset:2752
    ds_read_b64 v[234:235], v14 offset:2760
    v_and_b32_dpp v172, v172, v15 row_shr:1 row_mask:0xf bank_mask:0xf bound_ctrl:0
    v_and_b32_dpp v173, v173, v15 row_shr:1 row_mask:0xf bank_mask:0xf bound_ctrl:0
    v_mfma_f32_32x32x16_bf16 v[144:159], v[204:207], v[92:95], v[144:159]
    ds_read_b64 v[236:237], v14 offset:2784
    ds_read_b64 v[238:239], v14 offset:2792
    v_and_b32_dpp v174, v174, v15 row_shr:1 row_mask:0xf bank_mask:0xf bound_ctrl:0
    v_and_b32_dpp v175, v175, v15 row_shr:1 row_mask:0xf bank_mask:0xf bound_ctrl:0
    v_mfma_f32_32x32x16_bf16 v[128:143], v[176:179], v[32:35], v[128:143]
    s_nop 4
    v_mfma_f32_32x32x16_bf16 v[128:143], v[180:183], v[36:39], v[128:143]
    s_nop 4
    v_mfma_f32_32x32x16_bf16 v[128:143], v[184:187], v[40:43], v[128:143]
    v_mov_b32_dpp v144, v144 row_shr:1 row_mask:0xf bank_mask:0xf bound_ctrl:0
    v_mov_b32_dpp v145, v145 row_shr:1 row_mask:0xf bank_mask:0xf bound_ctrl:0
    v_mov_b32_dpp v146, v146 row_shr:1 row_mask:0xf bank_mask:0xf bound_ctrl:0
    v_mfma_f32_32x32x16_bf16 v[128:143], v[188:191], v[44:47], v[128:143]
    v_mov_b32_dpp v147, v147 row_shr:1 row_mask:0xf bank_mask:0xf bound_ctrl:0
    v_mov_b32_dpp v148, v148 row_shr:1 row_mask:0xf bank_mask:0xf bound_ctrl:0
    v_mov_b32_dpp v149, v149 row_shr:1 row_mask:0xf bank_mask:0xf bound_ctrl:0
    v_mfma_f32_32x32x16_bf16 v[128:143], v[192:195], v[48:51], v[128:143]
    v_mov_b32_dpp v150, v150 row_shr:1 row_mask:0xf bank_mask:0xf bound_ctrl:0
    v_mov_b32_dpp v151, v151 row_shr:1 row_mask:0xf bank_mask:0xf bound_ctrl:0
    v_mov_b32_dpp v152, v152 row_shr:1 row_mask:0xf bank_mask:0xf bound_ctrl:0
    v_mfma_f32_32x32x16_bf16 v[128:143], v[196:199], v[52:55], v[128:143]
    v_mov_b32_dpp v153, v153 row_shr:1 row_mask:0xf bank_mask:0xf bound_ctrl:0
    v_mov_b32_dpp v154, v154 row_shr:1 row_mask:0xf bank_mask:0xf bound_ctrl:0
    v_mov_b32_dpp v155, v155 row_shr:1 row_mask:0xf bank_mask:0xf bound_ctrl:0
    v_mfma_f32_32x32x16_bf16 v[128:143], v[200:203], v[56:59], v[128:143]
    v_mov_b32_dpp v156, v156 row_shr:1 row_mask:0xf bank_mask:0xf bound_ctrl:0
    v_mov_b32_dpp v157, v157 row_shr:1 row_mask:0xf bank_mask:0xf bound_ctrl:0
    v_mfma_f32_32x32x16_bf16 v[128:143], v[204:207], v[60:63], v[128:143]
    v_mov_b32_dpp v158, v158 row_shr:1 row_mask:0xf bank_mask:0xf bound_ctrl:0
    v_mov_b32_dpp v159, v159 row_shr:1 row_mask:0xf bank_mask:0xf bound_ctrl:0
    s_waitcnt lgkmcnt(0)
    v_mfma_f32_32x32x16_bf16 v[160:175], v[208:211], v[96:99], v[160:175]
    ds_read_b64 v[176:177], v14 offset:256
    ds_read_b64 v[178:179], v14 offset:264
    ds_read_b64 v[180:181], v14 offset:288
    ds_read_b64 v[182:183], v14 offset:296
    s_nop 0
    v_mfma_f32_32x32x16_bf16 v[160:175], v[212:215], v[100:103], v[160:175]
    ds_read_b64 v[184:185], v14 offset:320
    ds_read_b64 v[186:187], v14 offset:328
    ds_read_b64 v[188:189], v14 offset:352
    s_nop 1
    v_mfma_f32_32x32x16_bf16 v[160:175], v[216:219], v[104:107], v[160:175]
    ds_read_b64 v[190:191], v14 offset:360
    ds_read_b64 v[192:193], v14 offset:384
    ds_read_b64 v[194:195], v14 offset:392
    v_mov_b32_dpp v128, v128 row_shr:1 row_mask:0xf bank_mask:0xf bound_ctrl:0
    v_mov_b32_dpp v129, v129 row_shr:1 row_mask:0xf bank_mask:0xf bound_ctrl:0
    v_mov_b32_dpp v130, v130 row_shr:1 row_mask:0xf bank_mask:0xf bound_ctrl:0
    v_mfma_f32_32x32x16_bf16 v[160:175], v[220:223], v[108:111], v[160:175]
    ds_read_b64 v[196:197], v14 offset:416
    ds_read_b64 v[198:199], v14 offset:424
    ds_read_b64 v[200:201], v14 offset:448
    v_mov_b32_dpp v131, v131 row_shr:1 row_mask:0xf bank_mask:0xf bound_ctrl:0
    v_mov_b32_dpp v132, v132 row_shr:1 row_mask:0xf bank_mask:0xf bound_ctrl:0
    v_mov_b32_dpp v133, v133 row_shr:1 row_mask:0xf bank_mask:0xf bound_ctrl:0
    v_mfma_f32_32x32x16_bf16 v[160:175], v[224:227], v[112:115], v[160:175]
    ds_read_b64 v[202:203], v14 offset:456
    ds_read_b64 v[204:205], v14 offset:480
    ds_read_b64 v[206:207], v14 offset:488
    v_mov_b32_dpp v134, v134 row_shr:1 row_mask:0xf bank_mask:0xf bound_ctrl:0
    v_mov_b32_dpp v135, v135 row_shr:1 row_mask:0xf bank_mask:0xf bound_ctrl:0
    v_mov_b32_dpp v136, v136 row_shr:1 row_mask:0xf bank_mask:0xf bound_ctrl:0
    v_mfma_f32_32x32x16_bf16 v[160:175], v[228:231], v[116:119], v[160:175]
    v_mov_b32_dpp v137, v137 row_shr:1 row_mask:0xf bank_mask:0xf bound_ctrl:0
    v_mov_b32_dpp v138, v138 row_shr:1 row_mask:0xf bank_mask:0xf bound_ctrl:0
    v_mov_b32_dpp v139, v139 row_shr:1 row_mask:0xf bank_mask:0xf bound_ctrl:0
    v_mfma_f32_32x32x16_bf16 v[160:175], v[232:235], v[120:123], v[160:175]
    v_mov_b32_dpp v140, v140 row_shr:1 row_mask:0xf bank_mask:0xf bound_ctrl:0
    v_mov_b32_dpp v141, v141 row_shr:1 row_mask:0xf bank_mask:0xf bound_ctrl:0
    v_mfma_f32_32x32x16_bf16 v[160:175], v[236:239], v[124:127], v[160:175]
    v_mov_b32_dpp v142, v142 row_shr:1 row_mask:0xf bank_mask:0xf bound_ctrl:0
    v_mov_b32_dpp v143, v143 row_shr:1 row_mask:0xf bank_mask:0xf bound_ctrl:0
    s_waitcnt lgkmcnt(0)
    v_mfma_f32_32x32x16_bf16 v[144:159], v[176:179], v[64:67], v[144:159]
    ds_read_b64 v[208:209], v14 offset:2304
    ds_read_b64 v[210:211], v14 offset:2312
    s_nop 2
    v_mfma_f32_32x32x16_bf16 v[144:159], v[180:183], v[68:71], v[144:159]
    ds_read_b64 v[212:213], v14 offset:2336
    ds_read_b64 v[214:215], v14 offset:2344
    s_nop 2
    v_mfma_f32_32x32x16_bf16 v[144:159], v[184:187], v[72:75], v[144:159]
    ds_read_b64 v[216:217], v14 offset:2368
    ds_read_b64 v[218:219], v14 offset:2376
    v_and_b32_dpp v160, v160, v15 row_shr:1 row_mask:0xf bank_mask:0xf bound_ctrl:0
    v_and_b32_dpp v161, v161, v15 row_shr:1 row_mask:0xf bank_mask:0xf bound_ctrl:0
    v_and_b32_dpp v162, v162, v15 row_shr:1 row_mask:0xf bank_mask:0xf bound_ctrl:0
    v_mfma_f32_32x32x16_bf16 v[144:159], v[188:191], v[76:79], v[144:159]
    ds_read_b64 v[220:221], v14 offset:2400
    ds_read_b64 v[222:223], v14 offset:2408
    v_and_b32_dpp v163, v163, v15 row_shr:1 row_mask:0xf bank_mask:0xf bound_ctrl:0
    v_and_b32_dpp v164, v164, v15 row_shr:1 row_mask:0xf bank_mask:0xf bound_ctrl:0
    v_and_b32_dpp v165, v165, v15 row_shr:1 row_mask:0xf bank_mask:0xf bound_ctrl:0
    v_mfma_f32_32x32x16_bf16 v[144:159], v[192:195], v[80:83], v[144:159]
    ds_read_b64 v[224:225], v14 offset:2432
    ds_read_b64 v[226:227], v14 offset:2440
    v_and_b32_dpp v166, v166, v15 row_shr:1 row_mask:0xf bank_mask:0xf bound_ctrl:0
    v_and_b32_dpp v167, v167, v15 row_shr:1 row_mask:0xf bank_mask:0xf bound_ctrl:0
    v_and_b32_dpp v168, v168, v15 row_shr:1 row_mask:0xf bank_mask:0xf bound_ctrl:0
    v_mfma_f32_32x32x16_bf16 v[144:159], v[196:199], v[84:87], v[144:159]
    ds_read_b64 v[228:229], v14 offset:2464
    ds_read_b64 v[230:231], v14 offset:2472
    v_and_b32_dpp v169, v169, v15 row_shr:1 row_mask:0xf bank_mask:0xf bound_ctrl:0
    v_and_b32_dpp v170, v170, v15 row_shr:1 row_mask:0xf bank_mask:0xf bound_ctrl:0
    v_and_b32_dpp v171, v171, v15 row_shr:1 row_mask:0xf bank_mask:0xf bound_ctrl:0
    v_mfma_f32_32x32x16_bf16 v[144:159], v[200:203], v[88:91], v[144:159]
    ds_read_b64 v[232:233], v14 offset:2496
    ds_read_b64 v[234:235], v14 offset:2504
    v_and_b32_dpp v172, v172, v15 row_shr:1 row_mask:0xf bank_mask:0xf bound_ctrl:0
    v_and_b32_dpp v173, v173, v15 row_shr:1 row_mask:0xf bank_mask:0xf bound_ctrl:0
    v_mfma_f32_32x32x16_bf16 v[144:159], v[204:207], v[92:95], v[144:159]
    ds_read_b64 v[236:237], v14 offset:2528
    ds_read_b64 v[238:239], v14 offset:2536
    v_and_b32_dpp v174, v174, v15 row_shr:1 row_mask:0xf bank_mask:0xf bound_ctrl:0
    v_and_b32_dpp v175, v175, v15 row_shr:1 row_mask:0xf bank_mask:0xf bound_ctrl:0
    v_mfma_f32_32x32x16_bf16 v[128:143], v[176:179], v[32:35], v[128:143]
    s_nop 4
    v_mfma_f32_32x32x16_bf16 v[128:143], v[180:183], v[36:39], v[128:143]
    s_nop 4
    v_mfma_f32_32x32x16_bf16 v[128:143], v[184:187], v[40:43], v[128:143]
    v_mov_b32_dpp v144, v144 row_shr:1 row_mask:0xf bank_mask:0xf bound_ctrl:0
    v_mov_b32_dpp v145, v145 row_shr:1 row_mask:0xf bank_mask:0xf bound_ctrl:0
    v_mov_b32_dpp v146, v146 row_shr:1 row_mask:0xf bank_mask:0xf bound_ctrl:0
    v_mfma_f32_32x32x16_bf16 v[128:143], v[188:191], v[44:47], v[128:143]
    v_mov_b32_dpp v147, v147 row_shr:1 row_mask:0xf bank_mask:0xf bound_ctrl:0
    v_mov_b32_dpp v148, v148 row_shr:1 row_mask:0xf bank_mask:0xf bound_ctrl:0
    v_mov_b32_dpp v149, v149 row_shr:1 row_mask:0xf bank_mask:0xf bound_ctrl:0
    v_mfma_f32_32x32x16_bf16 v[128:143], v[192:195], v[48:51], v[128:143]
    v_mov_b32_dpp v150, v150 row_shr:1 row_mask:0xf bank_mask:0xf bound_ctrl:0
    v_mov_b32_dpp v151, v151 row_shr:1 row_mask:0xf bank_mask:0xf bound_ctrl:0
    v_mov_b32_dpp v152, v152 row_shr:1 row_mask:0xf bank_mask:0xf bound_ctrl:0
    v_mfma_f32_32x32x16_bf16 v[128:143], v[196:199], v[52:55], v[128:143]
    v_mov_b32_dpp v153, v153 row_shr:1 row_mask:0xf bank_mask:0xf bound_ctrl:0
    v_mov_b32_dpp v154, v154 row_shr:1 row_mask:0xf bank_mask:0xf bound_ctrl:0
    v_mov_b32_dpp v155, v155 row_shr:1 row_mask:0xf bank_mask:0xf bound_ctrl:0
    v_mfma_f32_32x32x16_bf16 v[128:143], v[200:203], v[56:59], v[128:143]
    v_mov_b32_dpp v156, v156 row_shr:1 row_mask:0xf bank_mask:0xf bound_ctrl:0
    v_mov_b32_dpp v157, v157 row_shr:1 row_mask:0xf bank_mask:0xf bound_ctrl:0
    v_mfma_f32_32x32x16_bf16 v[128:143], v[204:207], v[60:63], v[128:143]
    v_mov_b32_dpp v158, v158 row_shr:1 row_mask:0xf bank_mask:0xf bound_ctrl:0
    v_mov_b32_dpp v159, v159 row_shr:1 row_mask:0xf bank_mask:0xf bound_ctrl:0
    s_waitcnt lgkmcnt(0)
    v_mfma_f32_32x32x16_bf16 v[160:175], v[208:211], v[96:99], v[160:175]
    ds_read_b64 v[176:177], v14 offset:0
    ds_read_b64 v[178:179], v14 offset:8
    ds_read_b64 v[180:181], v14 offset:32
    ds_read_b64 v[182:183], v14 offset:40
    s_nop 0
    v_mfma_f32_32x32x16_bf16 v[160:175], v[212:215], v[100:103], v[160:175]
    ds_read_b64 v[184:185], v14 offset:64
    ds_read_b64 v[186:187], v14 offset:72
    ds_read_b64 v[188:189], v14 offset:96
    s_nop 1
    v_mfma_f32_32x32x16_bf16 v[160:175], v[216:219], v[104:107], v[160:175]
    ds_read_b64 v[190:191], v14 offset:104
    ds_read_b64 v[192:193], v14 offset:128
    ds_read_b64 v[194:195], v14 offset:136
    v_mov_b32_dpp v128, v128 row_shr:1 row_mask:0xf bank_mask:0xf bound_ctrl:0
    v_mov_b32_dpp v129, v129 row_shr:1 row_mask:0xf bank_mask:0xf bound_ctrl:0
    v_mov_b32_dpp v130, v130 row_shr:1 row_mask:0xf bank_mask:0xf bound_ctrl:0
    v_mfma_f32_32x32x16_bf16 v[160:175], v[220:223], v[108:111], v[160:175]
    ds_read_b64 v[196:197], v14 offset:160
    ds_read_b64 v[198:199], v14 offset:168
    ds_read_b64 v[200:201], v14 offset:192
    v_mov_b32_dpp v131, v131 row_shr:1 row_mask:0xf bank_mask:0xf bound_ctrl:0
    v_mov_b32_dpp v132, v132 row_shr:1 row_mask:0xf bank_mask:0xf bound_ctrl:0
    v_mov_b32_dpp v133, v133 row_shr:1 row_mask:0xf bank_mask:0xf bound_ctrl:0
    v_mfma_f32_32x32x16_bf16 v[160:175], v[224:227], v[112:115], v[160:175]
    ds_read_b64 v[202:203], v14 offset:200
    ds_read_b64 v[204:205], v14 offset:224
    ds_read_b64 v[206:207], v14 offset:232
    v_mov_b32_dpp v134, v134 row_shr:1 row_mask:0xf bank_mask:0xf bound_ctrl:0
    v_mov_b32_dpp v135, v135 row_shr:1 row_mask:0xf bank_mask:0xf bound_ctrl:0
    v_mov_b32_dpp v136, v136 row_shr:1 row_mask:0xf bank_mask:0xf bound_ctrl:0
    v_mfma_f32_32x32x16_bf16 v[160:175], v[228:231], v[116:119], v[160:175]
    v_mov_b32_dpp v137, v137 row_shr:1 row_mask:0xf bank_mask:0xf bound_ctrl:0
    v_mov_b32_dpp v138, v138 row_shr:1 row_mask:0xf bank_mask:0xf bound_ctrl:0
    v_mov_b32_dpp v139, v139 row_shr:1 row_mask:0xf bank_mask:0xf bound_ctrl:0
    v_mfma_f32_32x32x16_bf16 v[160:175], v[232:235], v[120:123], v[160:175]
    v_mov_b32_dpp v140, v140 row_shr:1 row_mask:0xf bank_mask:0xf bound_ctrl:0
    v_mov_b32_dpp v141, v141 row_shr:1 row_mask:0xf bank_mask:0xf bound_ctrl:0
    v_mfma_f32_32x32x16_bf16 v[160:175], v[236:239], v[124:127], v[160:175]
    v_mov_b32_dpp v142, v142 row_shr:1 row_mask:0xf bank_mask:0xf bound_ctrl:0
    v_mov_b32_dpp v143, v143 row_shr:1 row_mask:0xf bank_mask:0xf bound_ctrl:0
    s_waitcnt lgkmcnt(0)
    v_mfma_f32_32x32x16_bf16 v[144:159], v[176:179], v[64:67], v[144:159]
    ds_read_b64 v[208:209], v14 offset:2048
    ds_read_b64 v[210:211], v14 offset:2056
    s_nop 2
    v_mfma_f32_32x32x16_bf16 v[144:159], v[180:183], v[68:71], v[144:159]
    ds_read_b64 v[212:213], v14 offset:2080
    ds_read_b64 v[214:215], v14 offset:2088
    s_nop 2
    v_mfma_f32_32x32x16_bf16 v[144:159], v[184:187], v[72:75], v[144:159]
    ds_read_b64 v[216:217], v14 offset:2112
    ds_read_b64 v[218:219], v14 offset:2120
    v_and_b32_dpp v160, v160, v15 row_shr:1 row_mask:0xf bank_mask:0xf bound_ctrl:0
    v_and_b32_dpp v161, v161, v15 row_shr:1 row_mask:0xf bank_mask:0xf bound_ctrl:0
    v_and_b32_dpp v162, v162, v15 row_shr:1 row_mask:0xf bank_mask:0xf bound_ctrl:0
    v_mfma_f32_32x32x16_bf16 v[144:159], v[188:191], v[76:79], v[144:159]
    ds_read_b64 v[220:221], v14 offset:2144
    ds_read_b64 v[222:223], v14 offset:2152
    v_and_b32_dpp v163, v163, v15 row_shr:1 row_mask:0xf bank_mask:0xf bound_ctrl:0
    v_and_b32_dpp v164, v164, v15 row_shr:1 row_mask:0xf bank_mask:0xf bound_ctrl:0
    v_and_b32_dpp v165, v165, v15 row_shr:1 row_mask:0xf bank_mask:0xf bound_ctrl:0
    v_mfma_f32_32x32x16_bf16 v[144:159], v[192:195], v[80:83], v[144:159]
    ds_read_b64 v[224:225], v14 offset:2176
    ds_read_b64 v[226:227], v14 offset:2184
    v_and_b32_dpp v166, v166, v15 row_shr:1 row_mask:0xf bank_mask:0xf bound_ctrl:0
    v_and_b32_dpp v167, v167, v15 row_shr:1 row_mask:0xf bank_mask:0xf bound_ctrl:0
    v_and_b32_dpp v168, v168, v15 row_shr:1 row_mask:0xf bank_mask:0xf bound_ctrl:0
    v_mfma_f32_32x32x16_bf16 v[144:159], v[196:199], v[84:87], v[144:159]
    ds_read_b64 v[228:229], v14 offset:2208
    ds_read_b64 v[230:231], v14 offset:2216
    v_and_b32_dpp v169, v169, v15 row_shr:1 row_mask:0xf bank_mask:0xf bound_ctrl:0
    v_and_b32_dpp v170, v170, v15 row_shr:1 row_mask:0xf bank_mask:0xf bound_ctrl:0
    v_and_b32_dpp v171, v171, v15 row_shr:1 row_mask:0xf bank_mask:0xf bound_ctrl:0
    v_mfma_f32_32x32x16_bf16 v[144:159], v[200:203], v[88:91], v[144:159]
    ds_read_b64 v[232:233], v14 offset:2240
    ds_read_b64 v[234:235], v14 offset:2248
    v_and_b32_dpp v172, v172, v15 row_shr:1 row_mask:0xf bank_mask:0xf bound_ctrl:0
    v_and_b32_dpp v173, v173, v15 row_shr:1 row_mask:0xf bank_mask:0xf bound_ctrl:0
    v_mfma_f32_32x32x16_bf16 v[144:159], v[204:207], v[92:95], v[144:159]
    ds_read_b64 v[236:237], v14 offset:2272
    ds_read_b64 v[238:239], v14 offset:2280
    v_and_b32_dpp v174, v174, v15 row_shr:1 row_mask:0xf bank_mask:0xf bound_ctrl:0
    v_and_b32_dpp v175, v175, v15 row_shr:1 row_mask:0xf bank_mask:0xf bound_ctrl:0
    v_mfma_f32_32x32x16_bf16 v[128:143], v[176:179], v[32:35], v[128:143]
    v_mfma_f32_32x32x16_bf16 v[128:143], v[180:183], v[36:39], v[128:143]
    v_mfma_f32_32x32x16_bf16 v[128:143], v[184:187], v[40:43], v[128:143]
    v_mfma_f32_32x32x16_bf16 v[128:143], v[188:191], v[44:47], v[128:143]
    v_mfma_f32_32x32x16_bf16 v[128:143], v[192:195], v[48:51], v[128:143]
    v_mfma_f32_32x32x16_bf16 v[128:143], v[196:199], v[52:55], v[128:143]
    v_mfma_f32_32x32x16_bf16 v[128:143], v[200:203], v[56:59], v[128:143]
    v_mfma_f32_32x32x16_bf16 v[128:143], v[204:207], v[60:63], v[128:143]
    s_waitcnt lgkmcnt(0)
    v_mfma_f32_32x32x16_bf16 v[160:175], v[208:211], v[96:99], v[160:175]
    v_mfma_f32_32x32x16_bf16 v[160:175], v[212:215], v[100:103], v[160:175]
    v_mfma_f32_32x32x16_bf16 v[160:175], v[216:219], v[104:107], v[160:175]
    v_mfma_f32_32x32x16_bf16 v[160:175], v[220:223], v[108:111], v[160:175]
    v_mfma_f32_32x32x16_bf16 v[160:175], v[224:227], v[112:115], v[160:175]
    v_mfma_f32_32x32x16_bf16 v[160:175], v[228:231], v[116:119], v[160:175]
    v_mfma_f32_32x32x16_bf16 v[160:175], v[232:235], v[120:123], v[160:175]
    v_mfma_f32_32x32x16_bf16 v[160:175], v[236:239], v[124:127], v[160:175]
    s_nop 11
    v_add_f32_dpp v128, v160, v128 row_shr:8 row_mask:0xf bank_mask:0xf bound_ctrl:0
    v_add_f32_dpp v129, v161, v129 row_shr:8 row_mask:0xf bank_mask:0xf bound_ctrl:0
    v_add_f32_dpp v130, v162, v130 row_shr:8 row_mask:0xf bank_mask:0xf bound_ctrl:0
    v_add_f32_dpp v131, v163, v131 row_shr:8 row_mask:0xf bank_mask:0xf bound_ctrl:0
    v_add_f32_dpp v132, v164, v132 row_shr:8 row_mask:0xf bank_mask:0xf bound_ctrl:0
    v_add_f32_dpp v133, v165, v133 row_shr:8 row_mask:0xf bank_mask:0xf bound_ctrl:0
    v_add_f32_dpp v134, v166, v134 row_shr:8 row_mask:0xf bank_mask:0xf bound_ctrl:0
    v_add_f32_dpp v135, v167, v135 row_shr:8 row_mask:0xf bank_mask:0xf bound_ctrl:0
    v_add_f32_dpp v136, v168, v136 row_shr:8 row_mask:0xf bank_mask:0xf bound_ctrl:0
    v_add_f32_dpp v137, v169, v137 row_shr:8 row_mask:0xf bank_mask:0xf bound_ctrl:0
    v_add_f32_dpp v138, v170, v138 row_shr:8 row_mask:0xf bank_mask:0xf bound_ctrl:0
    v_add_f32_dpp v139, v171, v139 row_shr:8 row_mask:0xf bank_mask:0xf bound_ctrl:0
    v_add_f32_dpp v140, v172, v140 row_shr:8 row_mask:0xf bank_mask:0xf bound_ctrl:0
    v_add_f32_dpp v141, v173, v141 row_shr:8 row_mask:0xf bank_mask:0xf bound_ctrl:0
    v_add_f32_dpp v142, v174, v142 row_shr:8 row_mask:0xf bank_mask:0xf bound_ctrl:0
    v_add_f32_dpp v143, v175, v143 row_shr:8 row_mask:0xf bank_mask:0xf bound_ctrl:0
    s_mov_b32 s42, 0xff00ff00
    s_mov_b32 s43, 0xff00ff00
    s_mov_b64 exec, s[42:43]
    v_add_f32 v144, v160, v144
    v_add_f32 v145, v161, v145
    v_add_f32 v146, v162, v146
    v_add_f32 v147, v163, v147
    v_add_f32 v148, v164, v148
    v_add_f32 v149, v165, v149
    v_add_f32 v150, v166, v150
    v_add_f32 v151, v167, v151
    v_add_f32 v152, v168, v152
    v_add_f32 v153, v169, v153
    v_add_f32 v154, v170, v154
    v_add_f32 v155, v171, v155
    v_add_f32 v156, v172, v156
    v_add_f32 v157, v173, v157
    v_add_f32 v158, v174, v158
    v_add_f32 v159, v175, v159
    s_mov_b64 exec, -1
    v_mul_u32_u24 v16, 264, v7
    v_lshl_add_u32 v16, v9, 5, v16
    v_lshl_add_u32 v16, v8, 2, v16
    v_add_u32 v16, s34, v16
    v_cvt_pk_bf16_f32 v32, v128, v144
    v_cvt_pk_bf16_f32 v33, v129, v145
    v_cvt_pk_bf16_f32 v34, v130, v146
    v_cvt_pk_bf16_f32 v35, v131, v147
    v_cvt_pk_bf16_f32 v36, v132, v148
    v_cvt_pk_bf16_f32 v37, v133, v149
    v_cvt_pk_bf16_f32 v38, v134, v150
    v_cvt_pk_bf16_f32 v39, v135, v151
    v_cvt_pk_bf16_f32 v40, v136, v152
    v_cvt_pk_bf16_f32 v41, v137, v153
    v_cvt_pk_bf16_f32 v42, v138, v154
    v_cvt_pk_bf16_f32 v43, v139, v155
    v_cvt_pk_bf16_f32 v44, v140, v156
    v_cvt_pk_bf16_f32 v45, v141, v157
    v_cvt_pk_bf16_f32 v46, v142, v158
    v_cvt_pk_bf16_f32 v47, v143, v159
    ds_write_b32 v16, v32 offset:0
    ds_write_b32 v16, v33 offset:8
    ds_write_b32 v16, v34 offset:16
    ds_write_b32 v16, v35 offset:24
    ds_write_b32 v16, v36 offset:64
    ds_write_b32 v16, v37 offset:72
    ds_write_b32 v16, v38 offset:80
    ds_write_b32 v16, v39 offset:88
    ds_write_b32 v16, v40 offset:128
    ds_write_b32 v16, v41 offset:136
    ds_write_b32 v16, v42 offset:144
    ds_write_b32 v16, v43 offset:152
    ds_write_b32 v16, v44 offset:192
    ds_write_b32 v16, v45 offset:200
    ds_write_b32 v16, v46 offset:208
    ds_write_b32 v16, v47 offset:216
    s_lshl_b32 s44, s32, 16
    s_and_b32 s45, s32, 0xffff0000
    s_lshl_b32 s46, s33, 16
    s_and_b32 s47, s33, 0xffff0000
    v_mul_u32_u24 v17, 264, v2
    v_lshl_add_u32 v17, v1, 2, v17
    s_waitcnt lgkmcnt(0)
    s_barrier
    ds_read_b32 v48, v17 offset:0
    ds_read_b32 v49, v17 offset:9472
    ds_read_b32 v50, v17 offset:18944
    ds_read_b32 v51, v17 offset:28416
    ds_read_b32 v52, v17 offset:1056
    ds_read_b32 v53, v17 offset:10528
    ds_read_b32 v54, v17 offset:20000
    ds_read_b32 v55, v17 offset:29472
    ds_read_b32 v56, v17 offset:2112
    ds_read_b32 v57, v17 offset:11584
    ds_read_b32 v58, v17 offset:21056
    ds_read_b32 v59, v17 offset:30528
    ds_read_b32 v60, v17 offset:3168
    ds_read_b32 v61, v17 offset:12640
    ds_read_b32 v62, v17 offset:22112
    ds_read_b32 v63, v17 offset:31584
    s_waitcnt vmcnt(0) lgkmcnt(0)
    v_mov_b32 v28, s44
    v_mov_b32 v29, s45
    v_mov_b32 v30, s46
    v_mov_b32 v31, s47
    v_lshlrev_b32 v64, 16, v240
    v_and_b32 v65, 0xffff0000, v240
    v_pk_mul_f32 v[64:65], v[64:65], v[28:29]
    v_cvt_pk_bf16_f32 v72, v64, v65
    v_lshlrev_b32 v64, 16, v72
    v_and_b32 v65, 0xffff0000, v72
    v_lshlrev_b32 v66, 16, v241
    v_and_b32 v67, 0xffff0000, v241
    v_pk_mul_f32 v[66:67], v[66:67], v[30:31]
    v_cvt_pk_bf16_f32 v72, v66, v67
    v_lshlrev_b32 v66, 16, v72
    v_and_b32 v67, 0xffff0000, v72
    v_lshlrev_b32 v68, 16, v242
    v_and_b32 v69, 0xffff0000, v242
    v_pk_mul_f32 v[68:69], v[68:69], v[28:29]
    v_cvt_pk_bf16_f32 v72, v68, v69
    v_lshlrev_b32 v68, 16, v72
    v_and_b32 v69, 0xffff0000, v72
    v_lshlrev_b32 v70, 16, v243
    v_and_b32 v71, 0xffff0000, v243
    v_pk_mul_f32 v[70:71], v[70:71], v[30:31]
    v_cvt_pk_bf16_f32 v72, v70, v71
    v_lshlrev_b32 v70, 16, v72
    v_and_b32 v71, 0xffff0000, v72
    v_lshlrev_b32 v74, 16, v48
    v_and_b32 v78, 0xffff0000, v48
    v_lshlrev_b32 v75, 16, v49
    v_and_b32 v79, 0xffff0000, v49
    v_lshlrev_b32 v76, 16, v50
    v_and_b32 v80, 0xffff0000, v50
    v_lshlrev_b32 v77, 16, v51
    v_and_b32 v81, 0xffff0000, v51
    v_pk_add_f32 v[64:65], v[64:65], v[74:75]
    v_cvt_pk_bf16_f32 v96, v64, v65
    v_pk_add_f32 v[66:67], v[66:67], v[76:77]
    v_cvt_pk_bf16_f32 v97, v66, v67
    v_pk_add_f32 v[68:69], v[68:69], v[78:79]
    v_cvt_pk_bf16_f32 v98, v68, v69
    v_pk_add_f32 v[70:71], v[70:71], v[80:81]
    v_cvt_pk_bf16_f32 v99, v70, v71
    v_lshlrev_b32 v64, 16, v244
    v_and_b32 v65, 0xffff0000, v244
    v_pk_mul_f32 v[64:65], v[64:65], v[28:29]
    v_cvt_pk_bf16_f32 v72, v64, v65
    v_lshlrev_b32 v64, 16, v72
    v_and_b32 v65, 0xffff0000, v72
    v_lshlrev_b32 v66, 16, v245
    v_and_b32 v67, 0xffff0000, v245
    v_pk_mul_f32 v[66:67], v[66:67], v[30:31]
    v_cvt_pk_bf16_f32 v72, v66, v67
    v_lshlrev_b32 v66, 16, v72
    v_and_b32 v67, 0xffff0000, v72
    v_lshlrev_b32 v68, 16, v246
    v_and_b32 v69, 0xffff0000, v246
    v_pk_mul_f32 v[68:69], v[68:69], v[28:29]
    v_cvt_pk_bf16_f32 v72, v68, v69
    v_lshlrev_b32 v68, 16, v72
    v_and_b32 v69, 0xffff0000, v72
    v_lshlrev_b32 v70, 16, v247
    v_and_b32 v71, 0xffff0000, v247
    v_pk_mul_f32 v[70:71], v[70:71], v[30:31]
    v_cvt_pk_bf16_f32 v72, v70, v71
    v_lshlrev_b32 v70, 16, v72
    v_and_b32 v71, 0xffff0000, v72
    v_lshlrev_b32 v74, 16, v52
    v_and_b32 v78, 0xffff0000, v52
    v_lshlrev_b32 v75, 16, v53
    v_and_b32 v79, 0xffff0000, v53
    v_lshlrev_b32 v76, 16, v54
    v_and_b32 v80, 0xffff0000, v54
    v_lshlrev_b32 v77, 16, v55
    v_and_b32 v81, 0xffff0000, v55
    v_pk_add_f32 v[64:65], v[64:65], v[74:75]
    v_cvt_pk_bf16_f32 v100, v64, v65
    v_pk_add_f32 v[66:67], v[66:67], v[76:77]
    v_cvt_pk_bf16_f32 v101, v66, v67
    v_pk_add_f32 v[68:69], v[68:69], v[78:79]
    v_cvt_pk_bf16_f32 v102, v68, v69
    v_pk_add_f32 v[70:71], v[70:71], v[80:81]
    v_cvt_pk_bf16_f32 v103, v70, v71
    v_lshlrev_b32 v64, 16, v248
    v_and_b32 v65, 0xffff0000, v248
    v_pk_mul_f32 v[64:65], v[64:65], v[28:29]
    v_cvt_pk_bf16_f32 v72, v64, v65
    v_lshlrev_b32 v64, 16, v72
    v_and_b32 v65, 0xffff0000, v72
    v_lshlrev_b32 v66, 16, v249
    v_and_b32 v67, 0xffff0000, v249
    v_pk_mul_f32 v[66:67], v[66:67], v[30:31]
    v_cvt_pk_bf16_f32 v72, v66, v67
    v_lshlrev_b32 v66, 16, v72
    v_and_b32 v67, 0xffff0000, v72
    v_lshlrev_b32 v68, 16, v250
    v_and_b32 v69, 0xffff0000, v250
    v_pk_mul_f32 v[68:69], v[68:69], v[28:29]
    v_cvt_pk_bf16_f32 v72, v68, v69
    v_lshlrev_b32 v68, 16, v72
    v_and_b32 v69, 0xffff0000, v72
    v_lshlrev_b32 v70, 16, v251
    v_and_b32 v71, 0xffff0000, v251
    v_pk_mul_f32 v[70:71], v[70:71], v[30:31]
    v_cvt_pk_bf16_f32 v72, v70, v71
    v_lshlrev_b32 v70, 16, v72
    v_and_b32 v71, 0xffff0000, v72
    v_lshlrev_b32 v74, 16, v56
    v_and_b32 v78, 0xffff0000, v56
    v_lshlrev_b32 v75, 16, v57
    v_and_b32 v79, 0xffff0000, v57
    v_lshlrev_b32 v76, 16, v58
    v_and_b32 v80, 0xffff0000, v58
    v_lshlrev_b32 v77, 16, v59
    v_and_b32 v81, 0xffff0000, v59
    v_pk_add_f32 v[64:65], v[64:65], v[74:75]
    v_cvt_pk_bf16_f32 v104, v64, v65
    v_pk_add_f32 v[66:67], v[66:67], v[76:77]
    v_cvt_pk_bf16_f32 v105, v66, v67
    v_pk_add_f32 v[68:69], v[68:69], v[78:79]
    v_cvt_pk_bf16_f32 v106, v68, v69
    v_pk_add_f32 v[70:71], v[70:71], v[80:81]
    v_cvt_pk_bf16_f32 v107, v70, v71
    v_lshlrev_b32 v64, 16, v252
    v_and_b32 v65, 0xffff0000, v252
    v_pk_mul_f32 v[64:65], v[64:65], v[28:29]
    v_cvt_pk_bf16_f32 v72, v64, v65
    v_lshlrev_b32 v64, 16, v72
    v_and_b32 v65, 0xffff0000, v72
    v_lshlrev_b32 v66, 16, v253
    v_and_b32 v67, 0xffff0000, v253
    v_pk_mul_f32 v[66:67], v[66:67], v[30:31]
    v_cvt_pk_bf16_f32 v72, v66, v67
    v_lshlrev_b32 v66, 16, v72
    v_and_b32 v67, 0xffff0000, v72
    v_lshlrev_b32 v68, 16, v254
    v_and_b32 v69, 0xffff0000, v254
    v_pk_mul_f32 v[68:69], v[68:69], v[28:29]
    v_cvt_pk_bf16_f32 v72, v68, v69
    v_lshlrev_b32 v68, 16, v72
    v_and_b32 v69, 0xffff0000, v72
    v_lshlrev_b32 v70, 16, v255
    v_and_b32 v71, 0xffff0000, v255
    v_pk_mul_f32 v[70:71], v[70:71], v[30:31]
    v_cvt_pk_bf16_f32 v72, v70, v71
    v_lshlrev_b32 v70, 16, v72
    v_and_b32 v71, 0xffff0000, v72
    v_lshlrev_b32 v74, 16, v60
    v_and_b32 v78, 0xffff0000, v60
    v_lshlrev_b32 v75, 16, v61
    v_and_b32 v79, 0xffff0000, v61
    v_lshlrev_b32 v76, 16, v62
    v_and_b32 v80, 0xffff0000, v62
    v_lshlrev_b32 v77, 16, v63
    v_and_b32 v81, 0xffff0000, v63
    v_pk_add_f32 v[64:65], v[64:65], v[74:75]
    v_cvt_pk_bf16_f32 v108, v64, v65
    v_pk_add_f32 v[66:67], v[66:67], v[76:77]
    v_cvt_pk_bf16_f32 v109, v66, v67
    v_pk_add_f32 v[68:69], v[68:69], v[78:79]
    v_cvt_pk_bf16_f32 v110, v68, v69
    v_pk_add_f32 v[70:71], v[70:71], v[80:81]
    v_cvt_pk_bf16_f32 v111, v70, v71
    v_lshrrev_b32 v20, 3, v0
    v_lshrrev_b32 v21, 4, v20
    v_and_b32 v22, 15, v20
    v_mul_u32_u24 v23, 20480, v20
    v_sub_u32 v23, v4, v23
    s_mov_b32 s40, 1929216
    v_mul_lo_u32 v24, v21, s40
    v_add_u32 v24, v24, v23
    v_add_u32 v25, 1, v22
    v_mul_u32_u24 v25, 20480, v25
    v_add_u32 v25, v25, v24
    v_cmp_eq_u32 s[42:43], 15, v22
    v_cmp_eq_u32 s[44:45], 0, v22
    v_add_u32 v26, 3858432, v24
    v_add_u32 v27, 348160, v24
    v_cndmask_b32 v26, v27, v26, s[42:43]
    v_cmp_ne_u32 vcc, 0, v20
    s_and_b64 s[46:47], s[44:45], vcc
    s_or_b64 s[46:47], s[46:47], s[42:43]
    v_cmp_ne_u32 vcc, 31, v20
    s_and_b64 s[52:53], s[42:43], vcc
    s_or_b64 s[52:53], s[52:53], s[44:45]
    s_or_b64 s[44:45], s[44:45], s[42:43]
    s_add_u32 s39, s38, 14381056
    buffer_store_dwordx4 v[96:99], v25, s[28:31], s39 offen sc1
    s_mov_b64 exec, s[46:47]
    s_cbranch_execz k1_kernel_halo1
    s_sub_u32 s41, s39, 1929216
    buffer_store_dwordx4 v[96:99], v26, s[28:31], s41 offen sc1
k1_kernel_halo1:
    s_mov_b64 exec, -1
    s_add_u32 s39, s39, 3858432
    buffer_store_dwordx4 v[100:103], v25, s[28:31], s39 offen sc1
    s_mov_b64 exec, s[44:45]
    s_cbranch_execz k1_kernel_halo2
    s_sub_u32 s41, s39, 1929216
    buffer_store_dwordx4 v[100:103], v26, s[28:31], s41 offen sc1
k1_kernel_halo2:
    s_mov_b64 exec, -1
    s_add_u32 s39, s39, 3858432
    buffer_store_dwordx4 v[104:107], v25, s[28:31], s39 offen sc1
    s_mov_b64 exec, s[44:45]
    s_cbranch_execz k1_kernel_halo3
    s_sub_u32 s41, s39, 1929216
    buffer_store_dwordx4 v[104:107], v26, s[28:31], s41 offen sc1
k1_kernel_halo3:
    s_mov_b64 exec, -1
    s_add_u32 s39, s39, 3858432
    buffer_store_dwordx4 v[108:111], v25, s[28:31], s39 offen sc1
    s_mov_b64 exec, s[52:53]
    s_cbranch_execz k1_kernel_halo4
    s_sub_u32 s41, s39, 1929216
    buffer_store_dwordx4 v[108:111], v26, s[28:31], s41 offen sc1
k1_kernel_halo4:
    s_mov_b64 exec, -1
    s_add_u32 s39, s39, 3858432
    s_waitcnt vmcnt(0)
    s_endpgm
k1_pack:
    s_load_dwordx2 s[10:11], s[0:1], 120
    s_load_dwordx8 s[12:19], s[0:1], 56
    v_lshrrev_b32 v2, 6, v0
    v_and_b32 v1, 63, v0
    v_readfirstlane_b32 s20, v2
    s_waitcnt lgkmcnt(0)
    s_mov_b32 s28, s10
    s_mov_b32 s29, s11
    s_mov_b32 s30, 268435456
    s_mov_b32 s31, 0x00020000
    s_sub_u32 s21, s2, 220
    v_lshrrev_b32 v3, 3, v0
    v_and_b32 v4, 7, v0
    v_mul_u32_u24 v5, 144, v3
    v_lshl_add_u32 v5, v4, 4, v5
    v_and_b32 v6, 15, v1
    v_lshrrev_b32 v7, 4, v1
    v_lshrrev_b32 v8, 2, v6
    v_lshl_add_u32 v8, v7, 3, v8
    v_mul_u32_u24 v8, 144, v8
    v_and_b32 v9, 3, v6
    v_lshl_add_u32 v8, v9, 3, v8
    s_lshl_b32 s22, s20, 5
    v_add_u32 v8, s22, v8
    v_lshlrev_b32 v9, 4, v1
    s_cmp_lt_u32 s21, 20
    s_cbranch_scc1 k1_kernel_pk5
    s_cmp_lt_u32 s21, 40
    s_cbranch_scc1 k1_kernel_pk6
    s_cmp_lt_u32 s21, 94
    s_cbranch_scc1 k1_kernel_pk7
    s_branch k1_kernel_pk8
k1_kernel_pk5:
    s_mov_b32 s24, s12
    s_mov_b32 s25, s13
    s_mov_b32 s26, 819200
    s_mov_b32 s27, 0x00020000
    s_sub_u32 s32, s21, 0
    s_mul_i32 s33, s32, 52429
    s_lshr_b32 s33, s33, 19
    s_mul_i32 s34, s33, 10
    s_sub_u32 s34, s32, s34
    v_mul_u32_u24 v10, 1280, v3
    v_lshl_add_u32 v10, v4, 4, v10
    s_mul_i32 s35, s33, 409600
    s_lshl_b32 s36, s34, 7
    s_add_u32 s35, s35, s36
    buffer_load_dwordx4 v[32:35], v10, s[24:27], s35 offen
    s_add_u32 s35, s35, 40960
    buffer_load_dwordx4 v[36:39], v10, s[24:27], s35 offen
    s_add_u32 s35, s35, 40960
    buffer_load_dwordx4 v[40:43], v10, s[24:27], s35 offen
    s_add_u32 s35, s35, 40960
    buffer_load_dwordx4 v[44:47], v10, s[24:27], s35 offen
    s_add_u32 s35, s35, 40960
    buffer_load_dwordx4 v[48:51], v10, s[24:27], s35 offen
    s_add_u32 s35, s35, 40960
    buffer_load_dwordx4 v[52:55], v10, s[24:27], s35 offen
    s_add_u32 s35, s35, 40960
    buffer_load_dwordx4 v[56:59], v10, s[24:27], s35 offen
    s_add_u32 s35, s35, 40960
    buffer_load_dwordx4 v[60:63], v10, s[24:27], s35 offen
    s_add_u32 s35, s35, 40960
    buffer_load_dwordx4 v[64:67], v10, s[24:27], s35 offen
    s_add_u32 s35, s35, 40960
    buffer_load_dwordx4 v[68:71], v10, s[24:27], s35 offen
    s_lshl_b32 s36, s34, 2
    s_add_u32 s36, s36, s20
    s_mul_i32 s38, s36, 52429
    s_lshr_b32 s38, s38, 18
    s_mul_i32 s39, s38, 5
    s_sub_u32 s39, s36, s39
    s_mul_i32 s37, s38, 100
    s_mul_i32 s40, s33, 50
    s_add_u32 s37, s37, s40
    s_add_u32 s37, s37, s39
    s_lshl_b32 s37, s37, 10
    s_add_u32 s37, s37, 8089600
    s_waitcnt vmcnt(9)
    ds_write_b128 v5, v[32:35] offset:0
    s_waitcnt vmcnt(8)
    ds_write_b128 v5, v[36:39] offset:4608
    s_waitcnt vmcnt(7)
    ds_write_b128 v5, v[40:43] offset:9216
    s_waitcnt vmcnt(6)
    ds_write_b128 v5, v[44:47] offset:13824
    s_waitcnt vmcnt(5)
    ds_write_b128 v5, v[48:51] offset:18432
    s_waitcnt vmcnt(4)
    ds_write_b128 v5, v[52:55] offset:23040
    s_waitcnt vmcnt(3)
    ds_write_b128 v5, v[56:59] offset:27648
    s_waitcnt vmcnt(2)
    ds_write_b128 v5, v[60:63] offset:32256
    s_waitcnt vmcnt(1)
    ds_write_b128 v5, v[64:67] offset:36864
    s_waitcnt vmcnt(0)
    ds_write_b128 v5, v[68:71] offset:41472
    s_waitcnt lgkmcnt(0)
    s_barrier
    ds_read_b64_tr_b16 v[32:33], v8 offset:0
    ds_read_b64_tr_b16 v[34:35], v8 offset:576
    ds_read_b64_tr_b16 v[36:37], v8 offset:4608
    ds_read_b64_tr_b16 v[38:39], v8 offset:5184
    ds_read_b64_tr_b16 v[40:41], v8 offset:9216
    ds_read_b64_tr_b16 v[42:43], v8 offset:9792
    ds_read_b64_tr_b16 v[44:45], v8 offset:13824
    ds_read_b64_tr_b16 v[46:47], v8 offset:14400
    ds_read_b64_tr_b16 v[48:49], v8 offset:18432
    ds_read_b64_tr_b16 v[50:51], v8 offset:19008
    ds_read_b64_tr_b16 v[52:53], v8 offset:23040
    ds_read_b64_tr_b16 v[54:55], v8 offset:23616
    ds_read_b64_tr_b16 v[56:57], v8 offset:27648
    ds_read_b64_tr_b16 v[58:59], v8 offset:28224
    ds_read_b64_tr_b16 v[60:61], v8 offset:32256
    ds_read_b64_tr_b16 v[62:63], v8 offset:32832
    ds_read_b64_tr_b16 v[64:65], v8 offset:36864
    ds_read_b64_tr_b16 v[66:67], v8 offset:37440
    ds_read_b64_tr_b16 v[68:69], v8 offset:41472
    ds_read_b64_tr_b16 v[70:71], v8 offset:42048
    v_mov_b32 v12, 0
    v_mov_b32 v13, 0x3f803f80
    s_waitcnt lgkmcnt(15)
    s_add_u32 s38, s37, 0
    buffer_store_dwordx4 v[32:35], v9, s[28:31], s38 offen sc1
    v_dot2_f32_bf16 v12, v32, v13, v12
    v_dot2_f32_bf16 v12, v33, v13, v12
    v_dot2_f32_bf16 v12, v34, v13, v12
    v_dot2_f32_bf16 v12, v35, v13, v12
    s_waitcnt lgkmcnt(15)
    s_add_u32 s38, s37, 5120
    buffer_store_dwordx4 v[36:39], v9, s[28:31], s38 offen sc1
    v_dot2_f32_bf16 v12, v36, v13, v12
    v_dot2_f32_bf16 v12, v37, v13, v12
    v_dot2_f32_bf16 v12, v38, v13, v12
    v_dot2_f32_bf16 v12, v39, v13, v12
    s_waitcnt lgkmcnt(14)
    s_add_u32 s38, s37, 10240
    buffer_store_dwordx4 v[40:43], v9, s[28:31], s38 offen sc1
    v_dot2_f32_bf16 v12, v40, v13, v12
    v_dot2_f32_bf16 v12, v41, v13, v12
    v_dot2_f32_bf16 v12, v42, v13, v12
    v_dot2_f32_bf16 v12, v43, v13, v12
    s_waitcnt lgkmcnt(12)
    s_add_u32 s38, s37, 15360
    buffer_store_dwordx4 v[44:47], v9, s[28:31], s38 offen sc1
    v_dot2_f32_bf16 v12, v44, v13, v12
    v_dot2_f32_bf16 v12, v45, v13, v12
    v_dot2_f32_bf16 v12, v46, v13, v12
    v_dot2_f32_bf16 v12, v47, v13, v12
    s_waitcnt lgkmcnt(10)
    s_add_u32 s38, s37, 20480
    buffer_store_dwordx4 v[48:51], v9, s[28:31], s38 offen sc1
    v_dot2_f32_bf16 v12, v48, v13, v12
    v_dot2_f32_bf16 v12, v49, v13, v12
    v_dot2_f32_bf16 v12, v50, v13, v12
    v_dot2_f32_bf16 v12, v51, v13, v12
    s_waitcnt lgkmcnt(8)
    s_add_u32 s38, s37, 25600
    buffer_store_dwordx4 v[52:55], v9, s[28:31], s38 offen sc1
    v_dot2_f32_bf16 v12, v52, v13, v12
    v_dot2_f32_bf16 v12, v53, v13, v12
    v_dot2_f32_bf16 v12, v54, v13, v12
    v_dot2_f32_bf16 v12, v55, v13, v12
    s_waitcnt lgkmcnt(6)
    s_add_u32 s38, s37, 30720
    buffer_store_dwordx4 v[56:59], v9, s[28:31], s38 offen sc1
    v_dot2_f32_bf16 v12, v56, v13, v12
    v_dot2_f32_bf16 v12, v57, v13, v12
    v_dot2_f32_bf16 v12, v58, v13, v12
    v_dot2_f32_bf16 v12, v59, v13, v12
    s_waitcnt lgkmcnt(4)
    s_add_u32 s38, s37, 35840
    buffer_store_dwordx4 v[60:63], v9, s[28:31], s38 offen sc1
    v_dot2_f32_bf16 v12, v60, v13, v12
    v_dot2_f32_bf16 v12, v61, v13, v12
    v_dot2_f32_bf16 v12, v62, v13, v12
    v_dot2_f32_bf16 v12, v63, v13, v12
    s_waitcnt lgkmcnt(2)
    s_add_u32 s38, s37, 40960
    buffer_store_dwordx4 v[64:67], v9, s[28:31], s38 offen sc1
    v_dot2_f32_bf16 v12, v64, v13, v12
    v_dot2_f32_bf16 v12, v65, v13, v12
    v_dot2_f32_bf16 v12, v66, v13, v12
    v_dot2_f32_bf16 v12, v67, v13, v12
    s_waitcnt lgkmcnt(0)
    s_add_u32 s38, s37, 46080
    buffer_store_dwordx4 v[68:71], v9, s[28:31], s38 offen sc1
    v_dot2_f32_bf16 v12, v68, v13, v12
    v_dot2_f32_bf16 v12, v69, v13, v12
    v_dot2_f32_bf16 v12, v70, v13, v12
    v_dot2_f32_bf16 v12, v71, v13, v12
    s_nop 2
    v_mov_b32 v13, v12
    s_nop 1
    v_permlane32_swap_b32 v13, v12
    v_add_f32 v12, v12, v13
    v_mov_b32 v13, v12
    s_nop 1
    v_permlane16_swap_b32 v13, v12
    v_add_f32 v12, v12, v13
    s_mul_i32 s38, s33, 7168
    s_lshl_b32 s39, s36, 6
    s_add_u32 s38, s38, s39
    s_add_u32 s38, s38, 8073216
    v_lshlrev_b32 v14, 2, v1
    v_cmp_gt_u32 vcc, 16, v1
    s_and_saveexec_b64 s[40:41], vcc
    buffer_store_dword v12, v14, s[28:31], s38 offen sc1
    s_mov_b64 exec, -1
    s_endpgm
k1_kernel_pk6:
    s_mov_b32 s24, s14
    s_mov_b32 s25, s15
    s_mov_b32 s26, 819200
    s_mov_b32 s27, 0x00020000
    s_sub_u32 s32, s21, 20
    s_mul_i32 s33, s32, 52429
    s_lshr_b32 s33, s33, 19
    s_mul_i32 s34, s33, 10
    s_sub_u32 s34, s32, s34
    v_mul_u32_u24 v10, 1280, v3
    v_lshl_add_u32 v10, v4, 4, v10
    s_mul_i32 s35, s33, 409600
    s_lshl_b32 s36, s34, 7
    s_add_u32 s35, s35, s36
    buffer_load_dwordx4 v[32:35], v10, s[24:27], s35 offen
    s_add_u32 s35, s35, 40960
    buffer_load_dwordx4 v[36:39], v10, s[24:27], s35 offen
    s_add_u32 s35, s35, 40960
    buffer_load_dwordx4 v[40:43], v10, s[24:27], s35 offen
    s_add_u32 s35, s35, 40960
    buffer_load_dwordx4 v[44:47], v10, s[24:27], s35 offen
    s_add_u32 s35, s35, 40960
    buffer_load_dwordx4 v[48:51], v10, s[24:27], s35 offen
    s_add_u32 s35, s35, 40960
    buffer_load_dwordx4 v[52:55], v10, s[24:27], s35 offen
    s_add_u32 s35, s35, 40960
    buffer_load_dwordx4 v[56:59], v10, s[24:27], s35 offen
    s_add_u32 s35, s35, 40960
    buffer_load_dwordx4 v[60:63], v10, s[24:27], s35 offen
    s_add_u32 s35, s35, 40960
    buffer_load_dwordx4 v[64:67], v10, s[24:27], s35 offen
    s_add_u32 s35, s35, 40960
    buffer_load_dwordx4 v[68:71], v10, s[24:27], s35 offen
    s_lshl_b32 s36, s34, 2
    s_add_u32 s36, s36, s20
    s_mul_i32 s38, s36, 52429
    s_lshr_b32 s38, s38, 18
    s_mul_i32 s39, s38, 5
    s_sub_u32 s39, s36, s39
    s_mul_i32 s37, s38, 100
    s_mul_i32 s40, s33, 50
    s_add_u32 s37, s37, s40
    s_add_u32 s37, s37, s39
    s_lshl_b32 s37, s37, 10
    s_add_u32 s37, s37, 8908800
    s_waitcnt vmcnt(9)
    ds_write_b128 v5, v[32:35] offset:0
    s_waitcnt vmcnt(8)
    ds_write_b128 v5, v[36:39] offset:4608
    s_waitcnt vmcnt(7)
    ds_write_b128 v5, v[40:43] offset:9216
    s_waitcnt vmcnt(6)
    ds_write_b128 v5, v[44:47] offset:13824
    s_waitcnt vmcnt(5)
    ds_write_b128 v5, v[48:51] offset:18432
    s_waitcnt vmcnt(4)
    ds_write_b128 v5, v[52:55] offset:23040
    s_waitcnt vmcnt(3)
    ds_write_b128 v5, v[56:59] offset:27648
    s_waitcnt vmcnt(2)
    ds_write_b128 v5, v[60:63] offset:32256
    s_waitcnt vmcnt(1)
    ds_write_b128 v5, v[64:67] offset:36864
    s_waitcnt vmcnt(0)
    ds_write_b128 v5, v[68:71] offset:41472
    s_waitcnt lgkmcnt(0)
    s_barrier
    ds_read_b64_tr_b16 v[32:33], v8 offset:0
    ds_read_b64_tr_b16 v[34:35], v8 offset:576
    ds_read_b64_tr_b16 v[36:37], v8 offset:4608
    ds_read_b64_tr_b16 v[38:39], v8 offset:5184
    ds_read_b64_tr_b16 v[40:41], v8 offset:9216
    ds_read_b64_tr_b16 v[42:43], v8 offset:9792
    ds_read_b64_tr_b16 v[44:45], v8 offset:13824
    ds_read_b64_tr_b16 v[46:47], v8 offset:14400
    ds_read_b64_tr_b16 v[48:49], v8 offset:18432
    ds_read_b64_tr_b16 v[50:51], v8 offset:19008
    ds_read_b64_tr_b16 v[52:53], v8 offset:23040
    ds_read_b64_tr_b16 v[54:55], v8 offset:23616
    ds_read_b64_tr_b16 v[56:57], v8 offset:27648
    ds_read_b64_tr_b16 v[58:59], v8 offset:28224
    ds_read_b64_tr_b16 v[60:61], v8 offset:32256
    ds_read_b64_tr_b16 v[62:63], v8 offset:32832
    ds_read_b64_tr_b16 v[64:65], v8 offset:36864
    ds_read_b64_tr_b16 v[66:67], v8 offset:37440
    ds_read_b64_tr_b16 v[68:69], v8 offset:41472
    ds_read_b64_tr_b16 v[70:71], v8 offset:42048
    s_waitcnt lgkmcnt(15)
    s_add_u32 s38, s37, 0
    buffer_store_dwordx4 v[32:35], v9, s[28:31], s38 offen sc1
    s_waitcnt lgkmcnt(15)
    s_add_u32 s38, s37, 5120
    buffer_store_dwordx4 v[36:39], v9, s[28:31], s38 offen sc1
    s_waitcnt lgkmcnt(14)
    s_add_u32 s38, s37, 10240
    buffer_store_dwordx4 v[40:43], v9, s[28:31], s38 offen sc1
    s_waitcnt lgkmcnt(12)
    s_add_u32 s38, s37, 15360
    buffer_store_dwordx4 v[44:47], v9, s[28:31], s38 offen sc1
    s_waitcnt lgkmcnt(10)
    s_add_u32 s38, s37, 20480
    buffer_store_dwordx4 v[48:51], v9, s[28:31], s38 offen sc1
    s_waitcnt lgkmcnt(8)
    s_add_u32 s38, s37, 25600
    buffer_store_dwordx4 v[52:55], v9, s[28:31], s38 offen sc1
    s_waitcnt lgkmcnt(6)
    s_add_u32 s38, s37, 30720
    buffer_store_dwordx4 v[56:59], v9, s[28:31], s38 offen sc1
    s_waitcnt lgkmcnt(4)
    s_add_u32 s38, s37, 35840
    buffer_store_dwordx4 v[60:63], v9, s[28:31], s38 offen sc1
    s_waitcnt lgkmcnt(2)
    s_add_u32 s38, s37, 40960
    buffer_store_dwordx4 v[64:67], v9, s[28:31], s38 offen sc1
    s_waitcnt lgkmcnt(0)
    s_add_u32 s38, s37, 46080
    buffer_store_dwordx4 v[68:71], v9, s[28:31], s38 offen sc1
    s_endpgm
k1_kernel_pk7:
    s_mov_b32 s24, s16
    s_mov_b32 s25, s17
    s_mov_b32 s26, 2211840
    s_mov_b32 s27, 0x00020000
    s_sub_u32 s32, s21, 40
    s_mul_i32 s33, s32, 2428
    s_lshr_b32 s33, s33, 16
    s_mul_i32 s34, s33, 27
    s_sub_u32 s34, s32, s34
    v_mul_u32_u24 v10, 3456, v3
    v_lshl_add_u32 v10, v4, 4, v10
    s_mul_i32 s35, s33, 1105920
    s_lshl_b32 s36, s34, 7
    s_add_u32 s35, s35, s36
    buffer_load_dwordx4 v[32:35], v10, s[24:27], s35 offen
    s_add_u32 s35, s35, 110592
    buffer_load_dwordx4 v[36:39], v10, s[24:27], s35 offen
    s_add_u32 s35, s35, 110592
    buffer_load_dwordx4 v[40:43], v10, s[24:27], s35 offen
    s_add_u32 s35, s35, 110592
    buffer_load_dwordx4 v[44:47], v10, s[24:27], s35 offen
    s_add_u32 s35, s35, 110592
    buffer_load_dwordx4 v[48:51], v10, s[24:27], s35 offen
    s_add_u32 s35, s35, 110592
    buffer_load_dwordx4 v[52:55], v10, s[24:27], s35 offen
    s_add_u32 s35, s35, 110592
    buffer_load_dwordx4 v[56:59], v10, s[24:27], s35 offen
    s_add_u32 s35, s35, 110592
    buffer_load_dwordx4 v[60:63], v10, s[24:27], s35 offen
    s_add_u32 s35, s35, 110592
    buffer_load_dwordx4 v[64:67], v10, s[24:27], s35 offen
    s_add_u32 s35, s35, 110592
    buffer_load_dwordx4 v[68:71], v10, s[24:27], s35 offen
    s_lshl_b32 s36, s34, 2
    s_add_u32 s36, s36, s20
    s_mul_i32 s38, s36, 9363
    s_lshr_b32 s38, s38, 16
    s_mul_i32 s39, s38, 7
    s_sub_u32 s39, s36, s39
    s_mul_i32 s37, s38, 140
    s_mul_i32 s40, s33, 70
    s_add_u32 s37, s37, s40
    s_add_u32 s37, s37, s39
    s_lshl_b32 s37, s37, 10
    s_add_u32 s37, s37, 9728000
    s_waitcnt vmcnt(9)
    ds_write_b128 v5, v[32:35] offset:0
    s_waitcnt vmcnt(8)
    ds_write_b128 v5, v[36:39] offset:4608
    s_waitcnt vmcnt(7)
    ds_write_b128 v5, v[40:43] offset:9216
    s_waitcnt vmcnt(6)
    ds_write_b128 v5, v[44:47] offset:13824
    s_waitcnt vmcnt(5)
    ds_write_b128 v5, v[48:51] offset:18432
    s_waitcnt vmcnt(4)
    ds_write_b128 v5, v[52:55] offset:23040
    s_waitcnt vmcnt(3)
    ds_write_b128 v5, v[56:59] offset:27648
    s_waitcnt vmcnt(2)
    ds_write_b128 v5, v[60:63] offset:32256
    s_waitcnt vmcnt(1)
    ds_write_b128 v5, v[64:67] offset:36864
    s_waitcnt vmcnt(0)
    ds_write_b128 v5, v[68:71] offset:41472
    s_waitcnt lgkmcnt(0)
    s_barrier
    ds_read_b64_tr_b16 v[32:33], v8 offset:0
    ds_read_b64_tr_b16 v[34:35], v8 offset:576
    ds_read_b64_tr_b16 v[36:37], v8 offset:4608
    ds_read_b64_tr_b16 v[38:39], v8 offset:5184
    ds_read_b64_tr_b16 v[40:41], v8 offset:9216
    ds_read_b64_tr_b16 v[42:43], v8 offset:9792
    ds_read_b64_tr_b16 v[44:45], v8 offset:13824
    ds_read_b64_tr_b16 v[46:47], v8 offset:14400
    ds_read_b64_tr_b16 v[48:49], v8 offset:18432
    ds_read_b64_tr_b16 v[50:51], v8 offset:19008
    ds_read_b64_tr_b16 v[52:53], v8 offset:23040
    ds_read_b64_tr_b16 v[54:55], v8 offset:23616
    ds_read_b64_tr_b16 v[56:57], v8 offset:27648
    ds_read_b64_tr_b16 v[58:59], v8 offset:28224
    ds_read_b64_tr_b16 v[60:61], v8 offset:32256
    ds_read_b64_tr_b16 v[62:63], v8 offset:32832
    ds_read_b64_tr_b16 v[64:65], v8 offset:36864
    ds_read_b64_tr_b16 v[66:67], v8 offset:37440
    ds_read_b64_tr_b16 v[68:69], v8 offset:41472
    ds_read_b64_tr_b16 v[70:71], v8 offset:42048
    v_mov_b32 v12, 0
    v_mov_b32 v13, 0x3f803f80
    s_waitcnt lgkmcnt(15)
    s_add_u32 s38, s37, 0
    buffer_store_dwordx4 v[32:35], v9, s[28:31], s38 offen sc1
    v_dot2_f32_bf16 v12, v32, v13, v12
    v_dot2_f32_bf16 v12, v33, v13, v12
    v_dot2_f32_bf16 v12, v34, v13, v12
    v_dot2_f32_bf16 v12, v35, v13, v12
    s_waitcnt lgkmcnt(15)
    s_add_u32 s38, s37, 7168
    buffer_store_dwordx4 v[36:39], v9, s[28:31], s38 offen sc1
    v_dot2_f32_bf16 v12, v36, v13, v12
    v_dot2_f32_bf16 v12, v37, v13, v12
    v_dot2_f32_bf16 v12, v38, v13, v12
    v_dot2_f32_bf16 v12, v39, v13, v12
    s_waitcnt lgkmcnt(14)
    s_add_u32 s38, s37, 14336
    buffer_store_dwordx4 v[40:43], v9, s[28:31], s38 offen sc1
    v_dot2_f32_bf16 v12, v40, v13, v12
    v_dot2_f32_bf16 v12, v41, v13, v12
    v_dot2_f32_bf16 v12, v42, v13, v12
    v_dot2_f32_bf16 v12, v43, v13, v12
    s_waitcnt lgkmcnt(12)
    s_add_u32 s38, s37, 21504
    buffer_store_dwordx4 v[44:47], v9, s[28:31], s38 offen sc1
    v_dot2_f32_bf16 v12, v44, v13, v12
    v_dot2_f32_bf16 v12, v45, v13, v12
    v_dot2_f32_bf16 v12, v46, v13, v12
    v_dot2_f32_bf16 v12, v47, v13, v12
    s_waitcnt lgkmcnt(10)
    s_add_u32 s38, s37, 28672
    buffer_store_dwordx4 v[48:51], v9, s[28:31], s38 offen sc1
    v_dot2_f32_bf16 v12, v48, v13, v12
    v_dot2_f32_bf16 v12, v49, v13, v12
    v_dot2_f32_bf16 v12, v50, v13, v12
    v_dot2_f32_bf16 v12, v51, v13, v12
    s_waitcnt lgkmcnt(8)
    s_add_u32 s38, s37, 35840
    buffer_store_dwordx4 v[52:55], v9, s[28:31], s38 offen sc1
    v_dot2_f32_bf16 v12, v52, v13, v12
    v_dot2_f32_bf16 v12, v53, v13, v12
    v_dot2_f32_bf16 v12, v54, v13, v12
    v_dot2_f32_bf16 v12, v55, v13, v12
    s_waitcnt lgkmcnt(6)
    s_add_u32 s38, s37, 43008
    buffer_store_dwordx4 v[56:59], v9, s[28:31], s38 offen sc1
    v_dot2_f32_bf16 v12, v56, v13, v12
    v_dot2_f32_bf16 v12, v57, v13, v12
    v_dot2_f32_bf16 v12, v58, v13, v12
    v_dot2_f32_bf16 v12, v59, v13, v12
    s_waitcnt lgkmcnt(4)
    s_add_u32 s38, s37, 50176
    buffer_store_dwordx4 v[60:63], v9, s[28:31], s38 offen sc1
    v_dot2_f32_bf16 v12, v60, v13, v12
    v_dot2_f32_bf16 v12, v61, v13, v12
    v_dot2_f32_bf16 v12, v62, v13, v12
    v_dot2_f32_bf16 v12, v63, v13, v12
    s_waitcnt lgkmcnt(2)
    s_add_u32 s38, s37, 57344
    buffer_store_dwordx4 v[64:67], v9, s[28:31], s38 offen sc1
    v_dot2_f32_bf16 v12, v64, v13, v12
    v_dot2_f32_bf16 v12, v65, v13, v12
    v_dot2_f32_bf16 v12, v66, v13, v12
    v_dot2_f32_bf16 v12, v67, v13, v12
    s_waitcnt lgkmcnt(0)
    s_add_u32 s38, s37, 64512
    buffer_store_dwordx4 v[68:71], v9, s[28:31], s38 offen sc1
    v_dot2_f32_bf16 v12, v68, v13, v12
    v_dot2_f32_bf16 v12, v69, v13, v12
    v_dot2_f32_bf16 v12, v70, v13, v12
    v_dot2_f32_bf16 v12, v71, v13, v12
    s_nop 2
    v_mov_b32 v13, v12
    s_nop 1
    v_permlane32_swap_b32 v13, v12
    v_add_f32 v12, v12, v13
    v_mov_b32 v13, v12
    s_nop 1
    v_permlane16_swap_b32 v13, v12
    v_add_f32 v12, v12, v13
    s_mul_i32 s38, s33, 7168
    s_lshl_b32 s39, s36, 6
    s_add_u32 s38, s38, s39
    s_add_u32 s38, s38, 8056832
    v_lshlrev_b32 v14, 2, v1
    v_cmp_gt_u32 vcc, 16, v1
    s_and_saveexec_b64 s[40:41], vcc
    buffer_store_dword v12, v14, s[28:31], s38 offen sc1
    s_mov_b64 exec, -1
    s_endpgm
k1_kernel_pk8:
    s_mov_b32 s24, s18
    s_mov_b32 s25, s19
    s_mov_b32 s26, 2211840
    s_mov_b32 s27, 0x00020000
    s_sub_u32 s32, s21, 94
    s_mul_i32 s33, s32, 52429
    s_lshr_b32 s33, s33, 19
    s_mul_i32 s34, s33, 10
    s_sub_u32 s34, s32, s34
    v_mul_u32_u24 v10, 1280, v3
    v_lshl_add_u32 v10, v4, 4, v10
    s_mul_i32 s35, s33, 368640
    s_lshl_b32 s36, s34, 7
    s_add_u32 s35, s35, s36
    buffer_load_dwordx4 v[32:35], v10, s[24:27], s35 offen
    s_add_u32 s35, s35, 40960
    buffer_load_dwordx4 v[36:39], v10, s[24:27], s35 offen
    s_add_u32 s35, s35, 40960
    buffer_load_dwordx4 v[40:43], v10, s[24:27], s35 offen
    s_add_u32 s35, s35, 40960
    buffer_load_dwordx4 v[44:47], v10, s[24:27], s35 offen
    s_add_u32 s35, s35, 40960
    buffer_load_dwordx4 v[48:51], v10, s[24:27], s35 offen
    s_add_u32 s35, s35, 40960
    buffer_load_dwordx4 v[52:55], v10, s[24:27], s35 offen
    s_add_u32 s35, s35, 40960
    buffer_load_dwordx4 v[56:59], v10, s[24:27], s35 offen
    s_add_u32 s35, s35, 40960
    buffer_load_dwordx4 v[60:63], v10, s[24:27], s35 offen
    s_add_u32 s35, s35, 40960
    buffer_load_dwordx4 v[64:67], v10, s[24:27], s35 offen
    s_lshl_b32 s36, s34, 2
    s_add_u32 s36, s36, s20
    s_mul_i32 s38, s36, 52429
    s_lshr_b32 s38, s38, 18
    s_mul_i32 s39, s38, 5
    s_sub_u32 s39, s36, s39
    s_mul_i32 s37, s38, 280
    s_mul_i32 s40, s33, 45
    s_add_u32 s37, s37, s40
    s_add_u32 s37, s37, s39
    s_lshl_b32 s37, s37, 10
    s_add_u32 s37, s37, 12021760
    s_waitcnt vmcnt(8)
    ds_write_b128 v5, v[32:35] offset:0
    s_waitcnt vmcnt(7)
    ds_write_b128 v5, v[36:39] offset:4608
    s_waitcnt vmcnt(6)
    ds_write_b128 v5, v[40:43] offset:9216
    s_waitcnt vmcnt(5)
    ds_write_b128 v5, v[44:47] offset:13824
    s_waitcnt vmcnt(4)
    ds_write_b128 v5, v[48:51] offset:18432
    s_waitcnt vmcnt(3)
    ds_write_b128 v5, v[52:55] offset:23040
    s_waitcnt vmcnt(2)
    ds_write_b128 v5, v[56:59] offset:27648
    s_waitcnt vmcnt(1)
    ds_write_b128 v5, v[60:63] offset:32256
    s_waitcnt vmcnt(0)
    ds_write_b128 v5, v[64:67] offset:36864
    s_waitcnt lgkmcnt(0)
    s_barrier
    ds_read_b64_tr_b16 v[32:33], v8 offset:0
    ds_read_b64_tr_b16 v[34:35], v8 offset:576
    ds_read_b64_tr_b16 v[36:37], v8 offset:4608
    ds_read_b64_tr_b16 v[38:39], v8 offset:5184
    ds_read_b64_tr_b16 v[40:41], v8 offset:9216
    ds_read_b64_tr_b16 v[42:43], v8 offset:9792
    ds_read_b64_tr_b16 v[44:45], v8 offset:13824
    ds_read_b64_tr_b16 v[46:47], v8 offset:14400
    ds_read_b64_tr_b16 v[48:49], v8 offset:18432
    ds_read_b64_tr_b16 v[50:51], v8 offset:19008
    ds_read_b64_tr_b16 v[52:53], v8 offset:23040
    ds_read_b64_tr_b16 v[54:55], v8 offset:23616
    ds_read_b64_tr_b16 v[56:57], v8 offset:27648
    ds_read_b64_tr_b16 v[58:59], v8 offset:28224
    ds_read_b64_tr_b16 v[60:61], v8 offset:32256
    ds_read_b64_tr_b16 v[62:63], v8 offset:32832
    ds_read_b64_tr_b16 v[64:65], v8 offset:36864
    ds_read_b64_tr_b16 v[66:67], v8 offset:37440
    s_waitcnt lgkmcnt(15)
    s_add_u32 s38, s37, 0
    buffer_store_dwordx4 v[32:35], v9, s[28:31], s38 offen sc1
    s_waitcnt lgkmcnt(14)
    s_add_u32 s38, s37, 5120
    buffer_store_dwordx4 v[36:39], v9, s[28:31], s38 offen sc1
    s_waitcnt lgkmcnt(12)
    s_add_u32 s38, s37, 10240
    buffer_store_dwordx4 v[40:43], v9, s[28:31], s38 offen sc1
    s_waitcnt lgkmcnt(10)
    s_add_u32 s38, s37, 15360
    buffer_store_dwordx4 v[44:47], v9, s[28:31], s38 offen sc1
    s_waitcnt lgkmcnt(8)
    s_add_u32 s38, s37, 20480
    buffer_store_dwordx4 v[48:51], v9, s[28:31], s38 offen sc1
    s_waitcnt lgkmcnt(6)
    s_add_u32 s38, s37, 25600
    buffer_store_dwordx4 v[52:55], v9, s[28:31], s38 offen sc1
    s_waitcnt lgkmcnt(4)
    s_add_u32 s38, s37, 30720
    buffer_store_dwordx4 v[56:59], v9, s[28:31], s38 offen sc1
    s_waitcnt lgkmcnt(2)
    s_add_u32 s38, s37, 35840
    buffer_store_dwordx4 v[60:63], v9, s[28:31], s38 offen sc1
    s_waitcnt lgkmcnt(0)
    s_add_u32 s38, s37, 40960
    buffer_store_dwordx4 v[64:67], v9, s[28:31], s38 offen sc1
    s_endpgm
k1_modf:
    s_load_dwordx4 s[12:15], s[0:1], 88
    s_sub_u32 s32, s2, 160
    v_and_b32 v3, 7, v0
    v_lshrrev_b32 v4, 3, v0
    v_lshlrev_b32 v5, 1, v4
    v_mul_u32_u24 v6, 7680, v4
    s_lshl_b32 s36, s32, 7
    v_lshl_add_u32 v7, v3, 4, s36
    v_add_u32 v6, v6, v7
    s_waitcnt lgkmcnt(0)
    s_mov_b32 s16, s12
    s_mov_b32 s17, s13
    s_mov_b32 s18, 1280
    s_mov_b32 s19, 0x00020000
    s_mov_b32 s20, s14
    s_mov_b32 s21, s15
    s_mov_b32 s22, 4915200
    s_mov_b32 s23, 0x00020000
    buffer_load_ushort v10, v5, s[16:19], 0 offen offset:0
    buffer_load_ushort v11, v5, s[16:19], 0 offen offset:64
    buffer_load_ushort v12, v5, s[16:19], 0 offen offset:128
    buffer_load_ushort v13, v5, s[16:19], 0 offen offset:192
    buffer_load_ushort v14, v5, s[16:19], 0 offen offset:256
    buffer_load_ushort v15, v5, s[16:19], 0 offen offset:320
    buffer_load_ushort v16, v5, s[16:19], 0 offen offset:384
    buffer_load_ushort v17, v5, s[16:19], 0 offen offset:448
    buffer_load_ushort v18, v5, s[16:19], 0 offen offset:512
    buffer_load_ushort v19, v5, s[16:19], 0 offen offset:576
    buffer_load_ushort v20, v5, s[16:19], 0 offen offset:640
    buffer_load_ushort v21, v5, s[16:19], 0 offen offset:704
    buffer_load_ushort v22, v5, s[16:19], 0 offen offset:768
    buffer_load_ushort v23, v5, s[16:19], 0 offen offset:832
    buffer_load_ushort v24, v5, s[16:19], 0 offen offset:896
    buffer_load_ushort v25, v5, s[16:19], 0 offen offset:960
    buffer_load_ushort v26, v5, s[16:19], 0 offen offset:1024
    buffer_load_ushort v27, v5, s[16:19], 0 offen offset:1088
    buffer_load_ushort v28, v5, s[16:19], 0 offen offset:1152
    buffer_load_ushort v29, v5, s[16:19], 0 offen offset:1216
    s_mov_b32 s37, 0
    buffer_load_dwordx4 v[32:35], v6, s[20:23], s37 offen
    s_mov_b32 s37, 245760
    buffer_load_dwordx4 v[36:39], v6, s[20:23], s37 offen
    s_mov_b32 s37, 491520
    buffer_load_dwordx4 v[40:43], v6, s[20:23], s37 offen
    s_mov_b32 s37, 737280
    buffer_load_dwordx4 v[44:47], v6, s[20:23], s37 offen
    s_mov_b32 s37, 983040
    buffer_load_dwordx4 v[48:51], v6, s[20:23], s37 offen
    s_mov_b32 s37, 1228800
    buffer_load_dwordx4 v[52:55], v6, s[20:23], s37 offen
    s_mov_b32 s37, 1474560
    buffer_load_dwordx4 v[56:59], v6, s[20:23], s37 offen
    s_mov_b32 s37, 1720320
    buffer_load_dwordx4 v[60:63], v6, s[20:23], s37 offen
    s_mov_b32 s37, 1966080
    buffer_load_dwordx4 v[64:67], v6, s[20:23], s37 offen
    s_mov_b32 s37, 2211840
    buffer_load_dwordx4 v[68:71], v6, s[20:23], s37 offen
    s_mov_b32 s37, 2457600
    buffer_load_dwordx4 v[72:75], v6, s[20:23], s37 offen
    s_mov_b32 s37, 2703360
    buffer_load_dwordx4 v[76:79], v6, s[20:23], s37 offen
    s_mov_b32 s37, 2949120
    buffer_load_dwordx4 v[80:83], v6, s[20:23], s37 offen
    s_mov_b32 s37, 3194880
    buffer_load_dwordx4 v[84:87], v6, s[20:23], s37 offen
    s_mov_b32 s37, 3440640
    buffer_load_dwordx4 v[88:91], v6, s[20:23], s37 offen
    s_mov_b32 s37, 3686400
    buffer_load_dwordx4 v[92:95], v6, s[20:23], s37 offen
    s_mov_b32 s37, 3932160
    buffer_load_dwordx4 v[96:99], v6, s[20:23], s37 offen
    s_mov_b32 s37, 4177920
    buffer_load_dwordx4 v[100:103], v6, s[20:23], s37 offen
    s_mov_b32 s37, 4423680
    buffer_load_dwordx4 v[104:107], v6, s[20:23], s37 offen
    s_mov_b32 s37, 4669440
    buffer_load_dwordx4 v[108:111], v6, s[20:23], s37 offen
    s_waitcnt vmcnt(20)
    v_lshlrev_b32 v10, 16, v10
    v_mul_f32 v120, 0xbfb8aa3b, v10
    v_exp_f32 v120, v120
    v_lshlrev_b32 v11, 16, v11
    v_mul_f32 v121, 0xbfb8aa3b, v11
    v_exp_f32 v121, v121
    v_lshlrev_b32 v12, 16, v12
    v_mul_f32 v122, 0xbfb8aa3b, v12
    v_exp_f32 v122, v122
    v_lshlrev_b32 v13, 16, v13
    v_mul_f32 v123, 0xbfb8aa3b, v13
    v_exp_f32 v123, v123
    v_lshlrev_b32 v14, 16, v14
    v_mul_f32 v124, 0xbfb8aa3b, v14
    v_exp_f32 v124, v124
    v_lshlrev_b32 v15, 16, v15
    v_mul_f32 v125, 0xbfb8aa3b, v15
    v_exp_f32 v125, v125
    v_lshlrev_b32 v16, 16, v16
    v_mul_f32 v126, 0xbfb8aa3b, v16
    v_exp_f32 v126, v126
    v_lshlrev_b32 v17, 16, v17
    v_mul_f32 v127, 0xbfb8aa3b, v17
    v_exp_f32 v127, v127
    v_lshlrev_b32 v18, 16, v18
    v_mul_f32 v128, 0xbfb8aa3b, v18
    v_exp_f32 v128, v128
    v_lshlrev_b32 v19, 16, v19
    v_mul_f32 v129, 0xbfb8aa3b, v19
    v_exp_f32 v129, v129
    v_lshlrev_b32 v20, 16, v20
    v_mul_f32 v130, 0xbfb8aa3b, v20
    v_exp_f32 v130, v130
    v_lshlrev_b32 v21, 16, v21
    v_mul_f32 v131, 0xbfb8aa3b, v21
    v_exp_f32 v131, v131
    v_lshlrev_b32 v22, 16, v22
    v_mul_f32 v132, 0xbfb8aa3b, v22
    v_exp_f32 v132, v132
    v_lshlrev_b32 v23, 16, v23
    v_mul_f32 v133, 0xbfb8aa3b, v23
    v_exp_f32 v133, v133
    v_lshlrev_b32 v24, 16, v24
    v_mul_f32 v134, 0xbfb8aa3b, v24
    v_exp_f32 v134, v134
    v_lshlrev_b32 v25, 16, v25
    v_mul_f32 v135, 0xbfb8aa3b, v25
    v_exp_f32 v135, v135
    v_lshlrev_b32 v26, 16, v26
    v_mul_f32 v136, 0xbfb8aa3b, v26
    v_exp_f32 v136, v136
    v_lshlrev_b32 v27, 16, v27
    v_mul_f32 v137, 0xbfb8aa3b, v27
    v_exp_f32 v137, v137
    v_lshlrev_b32 v28, 16, v28
    v_mul_f32 v138, 0xbfb8aa3b, v28
    v_exp_f32 v138, v138
    v_lshlrev_b32 v29, 16, v29
    v_mul_f32 v139, 0xbfb8aa3b, v29
    v_exp_f32 v139, v139
    v_add_f32 v120, 1.0, v120
    v_rcp_f32 v120, v120
    v_add_f32 v121, 1.0, v121
    v_rcp_f32 v121, v121
    v_add_f32 v122, 1.0, v122
    v_rcp_f32 v122, v122
    v_add_f32 v123, 1.0, v123
    v_rcp_f32 v123, v123
    v_add_f32 v124, 1.0, v124
    v_rcp_f32 v124, v124
    v_add_f32 v125, 1.0, v125
    v_rcp_f32 v125, v125
    v_add_f32 v126, 1.0, v126
    v_rcp_f32 v126, v126
    v_add_f32 v127, 1.0, v127
    v_rcp_f32 v127, v127
    v_add_f32 v128, 1.0, v128
    v_rcp_f32 v128, v128
    v_add_f32 v129, 1.0, v129
    v_rcp_f32 v129, v129
    v_add_f32 v130, 1.0, v130
    v_rcp_f32 v130, v130
    v_add_f32 v131, 1.0, v131
    v_rcp_f32 v131, v131
    v_add_f32 v132, 1.0, v132
    v_rcp_f32 v132, v132
    v_add_f32 v133, 1.0, v133
    v_rcp_f32 v133, v133
    v_add_f32 v134, 1.0, v134
    v_rcp_f32 v134, v134
    v_add_f32 v135, 1.0, v135
    v_rcp_f32 v135, v135
    v_add_f32 v136, 1.0, v136
    v_rcp_f32 v136, v136
    v_add_f32 v137, 1.0, v137
    v_rcp_f32 v137, v137
    v_add_f32 v138, 1.0, v138
    v_rcp_f32 v138, v138
    v_add_f32 v139, 1.0, v139
    v_rcp_f32 v139, v139
    s_nop 0
    v_mul_f32 v10, v10, v120
    v_mul_f32 v11, v11, v121
    v_mul_f32 v12, v12, v122
    v_mul_f32 v13, v13, v123
    v_mul_f32 v14, v14, v124
    v_mul_f32 v15, v15, v125
    v_mul_f32 v16, v16, v126
    v_mul_f32 v17, v17, v127
    v_mul_f32 v18, v18, v128
    v_mul_f32 v19, v19, v129
    v_mul_f32 v20, v20, v130
    v_mul_f32 v21, v21, v131
    v_mul_f32 v22, v22, v132
    v_mul_f32 v23, v23, v133
    v_mul_f32 v24, v24, v134
    v_mul_f32 v25, v25, v135
    v_mul_f32 v26, v26, v136
    v_mul_f32 v27, v27, v137
    v_mul_f32 v28, v28, v138
    v_mul_f32 v29, v29, v139
    v_cvt_pk_bf16_f32 v120, v10, v11
    v_lshlrev_b32 v10, 16, v120
    v_and_b32 v11, 0xffff0000, v120
    v_cvt_pk_bf16_f32 v120, v12, v13
    v_lshlrev_b32 v12, 16, v120
    v_and_b32 v13, 0xffff0000, v120
    v_cvt_pk_bf16_f32 v120, v14, v15
    v_lshlrev_b32 v14, 16, v120
    v_and_b32 v15, 0xffff0000, v120
    v_cvt_pk_bf16_f32 v120, v16, v17
    v_lshlrev_b32 v16, 16, v120
    v_and_b32 v17, 0xffff0000, v120
    v_cvt_pk_bf16_f32 v120, v18, v19
    v_lshlrev_b32 v18, 16, v120
    v_and_b32 v19, 0xffff0000, v120
    v_cvt_pk_bf16_f32 v120, v20, v21
    v_lshlrev_b32 v20, 16, v120
    v_and_b32 v21, 0xffff0000, v120
    v_cvt_pk_bf16_f32 v120, v22, v23
    v_lshlrev_b32 v22, 16, v120
    v_and_b32 v23, 0xffff0000, v120
    v_cvt_pk_bf16_f32 v120, v24, v25
    v_lshlrev_b32 v24, 16, v120
    v_and_b32 v25, 0xffff0000, v120
    v_cvt_pk_bf16_f32 v120, v26, v27
    v_lshlrev_b32 v26, 16, v120
    v_and_b32 v27, 0xffff0000, v120
    v_cvt_pk_bf16_f32 v120, v28, v29
    v_lshlrev_b32 v28, 16, v120
    v_and_b32 v29, 0xffff0000, v120
    v_mov_b32 v112, 0
    v_mov_b32 v113, 0
    v_mov_b32 v114, 0
    v_mov_b32 v115, 0
    v_mov_b32 v116, 0
    v_mov_b32 v117, 0
    v_mov_b32 v118, 0
    v_mov_b32 v119, 0
    s_waitcnt vmcnt(19)
    v_lshlrev_b32 v120, 16, v32
    v_and_b32 v121, 0xffff0000, v32
    v_fmac_f32 v112, v10, v120
    v_fmac_f32 v113, v10, v121
    v_lshlrev_b32 v120, 16, v33
    v_and_b32 v121, 0xffff0000, v33
    v_fmac_f32 v114, v10, v120
    v_fmac_f32 v115, v10, v121
    v_lshlrev_b32 v120, 16, v34
    v_and_b32 v121, 0xffff0000, v34
    v_fmac_f32 v116, v10, v120
    v_fmac_f32 v117, v10, v121
    v_lshlrev_b32 v120, 16, v35
    v_and_b32 v121, 0xffff0000, v35
    v_fmac_f32 v118, v10, v120
    v_fmac_f32 v119, v10, v121
    s_waitcnt vmcnt(18)
    v_lshlrev_b32 v120, 16, v36
    v_and_b32 v121, 0xffff0000, v36
    v_fmac_f32 v112, v11, v120
    v_fmac_f32 v113, v11, v121
    v_lshlrev_b32 v120, 16, v37
    v_and_b32 v121, 0xffff0000, v37
    v_fmac_f32 v114, v11, v120
    v_fmac_f32 v115, v11, v121
    v_lshlrev_b32 v120, 16, v38
    v_and_b32 v121, 0xffff0000, v38
    v_fmac_f32 v116, v11, v120
    v_fmac_f32 v117, v11, v121
    v_lshlrev_b32 v120, 16, v39
    v_and_b32 v121, 0xffff0000, v39
    v_fmac_f32 v118, v11, v120
    v_fmac_f32 v119, v11, v121
    s_waitcnt vmcnt(17)
    v_lshlrev_b32 v120, 16, v40
    v_and_b32 v121, 0xffff0000, v40
    v_fmac_f32 v112, v12, v120
    v_fmac_f32 v113, v12, v121
    v_lshlrev_b32 v120, 16, v41
    v_and_b32 v121, 0xffff0000, v41
    v_fmac_f32 v114, v12, v120
    v_fmac_f32 v115, v12, v121
    v_lshlrev_b32 v120, 16, v42
    v_and_b32 v121, 0xffff0000, v42
    v_fmac_f32 v116, v12, v120
    v_fmac_f32 v117, v12, v121
    v_lshlrev_b32 v120, 16, v43
    v_and_b32 v121, 0xffff0000, v43
    v_fmac_f32 v118, v12, v120
    v_fmac_f32 v119, v12, v121
    s_waitcnt vmcnt(16)
    v_lshlrev_b32 v120, 16, v44
    v_and_b32 v121, 0xffff0000, v44
    v_fmac_f32 v112, v13, v120
    v_fmac_f32 v113, v13, v121
    v_lshlrev_b32 v120, 16, v45
    v_and_b32 v121, 0xffff0000, v45
    v_fmac_f32 v114, v13, v120
    v_fmac_f32 v115, v13, v121
    v_lshlrev_b32 v120, 16, v46
    v_and_b32 v121, 0xffff0000, v46
    v_fmac_f32 v116, v13, v120
    v_fmac_f32 v117, v13, v121
    v_lshlrev_b32 v120, 16, v47
    v_and_b32 v121, 0xffff0000, v47
    v_fmac_f32 v118, v13, v120
    v_fmac_f32 v119, v13, v121
    s_waitcnt vmcnt(15)
    v_lshlrev_b32 v120, 16, v48
    v_and_b32 v121, 0xffff0000, v48
    v_fmac_f32 v112, v14, v120
    v_fmac_f32 v113, v14, v121
    v_lshlrev_b32 v120, 16, v49
    v_and_b32 v121, 0xffff0000, v49
    v_fmac_f32 v114, v14, v120
    v_fmac_f32 v115, v14, v121
    v_lshlrev_b32 v120, 16, v50
    v_and_b32 v121, 0xffff0000, v50
    v_fmac_f32 v116, v14, v120
    v_fmac_f32 v117, v14, v121
    v_lshlrev_b32 v120, 16, v51
    v_and_b32 v121, 0xffff0000, v51
    v_fmac_f32 v118, v14, v120
    v_fmac_f32 v119, v14, v121
    s_waitcnt vmcnt(14)
    v_lshlrev_b32 v120, 16, v52
    v_and_b32 v121, 0xffff0000, v52
    v_fmac_f32 v112, v15, v120
    v_fmac_f32 v113, v15, v121
    v_lshlrev_b32 v120, 16, v53
    v_and_b32 v121, 0xffff0000, v53
    v_fmac_f32 v114, v15, v120
    v_fmac_f32 v115, v15, v121
    v_lshlrev_b32 v120, 16, v54
    v_and_b32 v121, 0xffff0000, v54
    v_fmac_f32 v116, v15, v120
    v_fmac_f32 v117, v15, v121
    v_lshlrev_b32 v120, 16, v55
    v_and_b32 v121, 0xffff0000, v55
    v_fmac_f32 v118, v15, v120
    v_fmac_f32 v119, v15, v121
    s_waitcnt vmcnt(13)
    v_lshlrev_b32 v120, 16, v56
    v_and_b32 v121, 0xffff0000, v56
    v_fmac_f32 v112, v16, v120
    v_fmac_f32 v113, v16, v121
    v_lshlrev_b32 v120, 16, v57
    v_and_b32 v121, 0xffff0000, v57
    v_fmac_f32 v114, v16, v120
    v_fmac_f32 v115, v16, v121
    v_lshlrev_b32 v120, 16, v58
    v_and_b32 v121, 0xffff0000, v58
    v_fmac_f32 v116, v16, v120
    v_fmac_f32 v117, v16, v121
    v_lshlrev_b32 v120, 16, v59
    v_and_b32 v121, 0xffff0000, v59
    v_fmac_f32 v118, v16, v120
    v_fmac_f32 v119, v16, v121
    s_waitcnt vmcnt(12)
    v_lshlrev_b32 v120, 16, v60
    v_and_b32 v121, 0xffff0000, v60
    v_fmac_f32 v112, v17, v120
    v_fmac_f32 v113, v17, v121
    v_lshlrev_b32 v120, 16, v61
    v_and_b32 v121, 0xffff0000, v61
    v_fmac_f32 v114, v17, v120
    v_fmac_f32 v115, v17, v121
    v_lshlrev_b32 v120, 16, v62
    v_and_b32 v121, 0xffff0000, v62
    v_fmac_f32 v116, v17, v120
    v_fmac_f32 v117, v17, v121
    v_lshlrev_b32 v120, 16, v63
    v_and_b32 v121, 0xffff0000, v63
    v_fmac_f32 v118, v17, v120
    v_fmac_f32 v119, v17, v121
    s_waitcnt vmcnt(11)
    v_lshlrev_b32 v120, 16, v64
    v_and_b32 v121, 0xffff0000, v64
    v_fmac_f32 v112, v18, v120
    v_fmac_f32 v113, v18, v121
    v_lshlrev_b32 v120, 16, v65
    v_and_b32 v121, 0xffff0000, v65
    v_fmac_f32 v114, v18, v120
    v_fmac_f32 v115, v18, v121
    v_lshlrev_b32 v120, 16, v66
    v_and_b32 v121, 0xffff0000, v66
    v_fmac_f32 v116, v18, v120
    v_fmac_f32 v117, v18, v121
    v_lshlrev_b32 v120, 16, v67
    v_and_b32 v121, 0xffff0000, v67
    v_fmac_f32 v118, v18, v120
    v_fmac_f32 v119, v18, v121
    s_waitcnt vmcnt(10)
    v_lshlrev_b32 v120, 16, v68
    v_and_b32 v121, 0xffff0000, v68
    v_fmac_f32 v112, v19, v120
    v_fmac_f32 v113, v19, v121
    v_lshlrev_b32 v120, 16, v69
    v_and_b32 v121, 0xffff0000, v69
    v_fmac_f32 v114, v19, v120
    v_fmac_f32 v115, v19, v121
    v_lshlrev_b32 v120, 16, v70
    v_and_b32 v121, 0xffff0000, v70
    v_fmac_f32 v116, v19, v120
    v_fmac_f32 v117, v19, v121
    v_lshlrev_b32 v120, 16, v71
    v_and_b32 v121, 0xffff0000, v71
    v_fmac_f32 v118, v19, v120
    v_fmac_f32 v119, v19, v121
    s_waitcnt vmcnt(9)
    v_lshlrev_b32 v120, 16, v72
    v_and_b32 v121, 0xffff0000, v72
    v_fmac_f32 v112, v20, v120
    v_fmac_f32 v113, v20, v121
    v_lshlrev_b32 v120, 16, v73
    v_and_b32 v121, 0xffff0000, v73
    v_fmac_f32 v114, v20, v120
    v_fmac_f32 v115, v20, v121
    v_lshlrev_b32 v120, 16, v74
    v_and_b32 v121, 0xffff0000, v74
    v_fmac_f32 v116, v20, v120
    v_fmac_f32 v117, v20, v121
    v_lshlrev_b32 v120, 16, v75
    v_and_b32 v121, 0xffff0000, v75
    v_fmac_f32 v118, v20, v120
    v_fmac_f32 v119, v20, v121
    s_waitcnt vmcnt(8)
    v_lshlrev_b32 v120, 16, v76
    v_and_b32 v121, 0xffff0000, v76
    v_fmac_f32 v112, v21, v120
    v_fmac_f32 v113, v21, v121
    v_lshlrev_b32 v120, 16, v77
    v_and_b32 v121, 0xffff0000, v77
    v_fmac_f32 v114, v21, v120
    v_fmac_f32 v115, v21, v121
    v_lshlrev_b32 v120, 16, v78
    v_and_b32 v121, 0xffff0000, v78
    v_fmac_f32 v116, v21, v120
    v_fmac_f32 v117, v21, v121
    v_lshlrev_b32 v120, 16, v79
    v_and_b32 v121, 0xffff0000, v79
    v_fmac_f32 v118, v21, v120
    v_fmac_f32 v119, v21, v121
    s_waitcnt vmcnt(7)
    v_lshlrev_b32 v120, 16, v80
    v_and_b32 v121, 0xffff0000, v80
    v_fmac_f32 v112, v22, v120
    v_fmac_f32 v113, v22, v121
    v_lshlrev_b32 v120, 16, v81
    v_and_b32 v121, 0xffff0000, v81
    v_fmac_f32 v114, v22, v120
    v_fmac_f32 v115, v22, v121
    v_lshlrev_b32 v120, 16, v82
    v_and_b32 v121, 0xffff0000, v82
    v_fmac_f32 v116, v22, v120
    v_fmac_f32 v117, v22, v121
    v_lshlrev_b32 v120, 16, v83
    v_and_b32 v121, 0xffff0000, v83
    v_fmac_f32 v118, v22, v120
    v_fmac_f32 v119, v22, v121
    s_waitcnt vmcnt(6)
    v_lshlrev_b32 v120, 16, v84
    v_and_b32 v121, 0xffff0000, v84
    v_fmac_f32 v112, v23, v120
    v_fmac_f32 v113, v23, v121
    v_lshlrev_b32 v120, 16, v85
    v_and_b32 v121, 0xffff0000, v85
    v_fmac_f32 v114, v23, v120
    v_fmac_f32 v115, v23, v121
    v_lshlrev_b32 v120, 16, v86
    v_and_b32 v121, 0xffff0000, v86
    v_fmac_f32 v116, v23, v120
    v_fmac_f32 v117, v23, v121
    v_lshlrev_b32 v120, 16, v87
    v_and_b32 v121, 0xffff0000, v87
    v_fmac_f32 v118, v23, v120
    v_fmac_f32 v119, v23, v121
    s_waitcnt vmcnt(5)
    v_lshlrev_b32 v120, 16, v88
    v_and_b32 v121, 0xffff0000, v88
    v_fmac_f32 v112, v24, v120
    v_fmac_f32 v113, v24, v121
    v_lshlrev_b32 v120, 16, v89
    v_and_b32 v121, 0xffff0000, v89
    v_fmac_f32 v114, v24, v120
    v_fmac_f32 v115, v24, v121
    v_lshlrev_b32 v120, 16, v90
    v_and_b32 v121, 0xffff0000, v90
    v_fmac_f32 v116, v24, v120
    v_fmac_f32 v117, v24, v121
    v_lshlrev_b32 v120, 16, v91
    v_and_b32 v121, 0xffff0000, v91
    v_fmac_f32 v118, v24, v120
    v_fmac_f32 v119, v24, v121
    s_waitcnt vmcnt(4)
    v_lshlrev_b32 v120, 16, v92
    v_and_b32 v121, 0xffff0000, v92
    v_fmac_f32 v112, v25, v120
    v_fmac_f32 v113, v25, v121
    v_lshlrev_b32 v120, 16, v93
    v_and_b32 v121, 0xffff0000, v93
    v_fmac_f32 v114, v25, v120
    v_fmac_f32 v115, v25, v121
    v_lshlrev_b32 v120, 16, v94
    v_and_b32 v121, 0xffff0000, v94
    v_fmac_f32 v116, v25, v120
    v_fmac_f32 v117, v25, v121
    v_lshlrev_b32 v120, 16, v95
    v_and_b32 v121, 0xffff0000, v95
    v_fmac_f32 v118, v25, v120
    v_fmac_f32 v119, v25, v121
    s_waitcnt vmcnt(3)
    v_lshlrev_b32 v120, 16, v96
    v_and_b32 v121, 0xffff0000, v96
    v_fmac_f32 v112, v26, v120
    v_fmac_f32 v113, v26, v121
    v_lshlrev_b32 v120, 16, v97
    v_and_b32 v121, 0xffff0000, v97
    v_fmac_f32 v114, v26, v120
    v_fmac_f32 v115, v26, v121
    v_lshlrev_b32 v120, 16, v98
    v_and_b32 v121, 0xffff0000, v98
    v_fmac_f32 v116, v26, v120
    v_fmac_f32 v117, v26, v121
    v_lshlrev_b32 v120, 16, v99
    v_and_b32 v121, 0xffff0000, v99
    v_fmac_f32 v118, v26, v120
    v_fmac_f32 v119, v26, v121
    s_waitcnt vmcnt(2)
    v_lshlrev_b32 v120, 16, v100
    v_and_b32 v121, 0xffff0000, v100
    v_fmac_f32 v112, v27, v120
    v_fmac_f32 v113, v27, v121
    v_lshlrev_b32 v120, 16, v101
    v_and_b32 v121, 0xffff0000, v101
    v_fmac_f32 v114, v27, v120
    v_fmac_f32 v115, v27, v121
    v_lshlrev_b32 v120, 16, v102
    v_and_b32 v121, 0xffff0000, v102
    v_fmac_f32 v116, v27, v120
    v_fmac_f32 v117, v27, v121
    v_lshlrev_b32 v120, 16, v103
    v_and_b32 v121, 0xffff0000, v103
    v_fmac_f32 v118, v27, v120
    v_fmac_f32 v119, v27, v121
    s_waitcnt vmcnt(1)
    v_lshlrev_b32 v120, 16, v104
    v_and_b32 v121, 0xffff0000, v104
    v_fmac_f32 v112, v28, v120
    v_fmac_f32 v113, v28, v121
    v_lshlrev_b32 v120, 16, v105
    v_and_b32 v121, 0xffff0000, v105
    v_fmac_f32 v114, v28, v120
    v_fmac_f32 v115, v28, v121
    v_lshlrev_b32 v120, 16, v106
    v_and_b32 v121, 0xffff0000, v106
    v_fmac_f32 v116, v28, v120
    v_fmac_f32 v117, v28, v121
    v_lshlrev_b32 v120, 16, v107
    v_and_b32 v121, 0xffff0000, v107
    v_fmac_f32 v118, v28, v120
    v_fmac_f32 v119, v28, v121
    s_waitcnt vmcnt(0)
    v_lshlrev_b32 v120, 16, v108
    v_and_b32 v121, 0xffff0000, v108
    v_fmac_f32 v112, v29, v120
    v_fmac_f32 v113, v29, v121
    v_lshlrev_b32 v120, 16, v109
    v_and_b32 v121, 0xffff0000, v109
    v_fmac_f32 v114, v29, v120
    v_fmac_f32 v115, v29, v121
    v_lshlrev_b32 v120, 16, v110
    v_and_b32 v121, 0xffff0000, v110
    v_fmac_f32 v116, v29, v120
    v_fmac_f32 v117, v29, v121
    v_lshlrev_b32 v120, 16, v111
    v_and_b32 v121, 0xffff0000, v111
    v_fmac_f32 v118, v29, v120
    v_fmac_f32 v119, v29, v121
    v_lshlrev_b32 v7, 5, v0
    ds_write_b128 v7, v[112:115]
    ds_write_b128 v7, v[116:119] offset:16
    s_waitcnt lgkmcnt(0)
    s_barrier
    v_cmp_gt_u32 vcc, 64, v0
    s_and_saveexec_b64 s[42:43], vcc
    s_cbranch_execz k1_end
    v_lshlrev_b32 v7, 2, v0
    ds_read_b32 v32, v7 offset:0
    ds_read_b32 v33, v7 offset:256
    ds_read_b32 v34, v7 offset:512
    ds_read_b32 v35, v7 offset:768
    ds_read_b32 v36, v7 offset:1024
    ds_read_b32 v37, v7 offset:1280
    ds_read_b32 v38, v7 offset:1536
    ds_read_b32 v39, v7 offset:1792
    ds_read_b32 v40, v7 offset:2048
    ds_read_b32 v41, v7 offset:2304
    ds_read_b32 v42, v7 offset:2560
    ds_read_b32 v43, v7 offset:2816
    ds_read_b32 v44, v7 offset:3072
    ds_read_b32 v45, v7 offset:3328
    ds_read_b32 v46, v7 offset:3584
    ds_read_b32 v47, v7 offset:3840
    ds_read_b32 v48, v7 offset:4096
    ds_read_b32 v49, v7 offset:4352
    ds_read_b32 v50, v7 offset:4608
    ds_read_b32 v51, v7 offset:4864
    ds_read_b32 v52, v7 offset:5120
    ds_read_b32 v53, v7 offset:5376
    ds_read_b32 v54, v7 offset:5632
    ds_read_b32 v55, v7 offset:5888
    ds_read_b32 v56, v7 offset:6144
    ds_read_b32 v57, v7 offset:6400
    ds_read_b32 v58, v7 offset:6656
    ds_read_b32 v59, v7 offset:6912
    ds_read_b32 v60, v7 offset:7168
    ds_read_b32 v61, v7 offset:7424
    ds_read_b32 v62, v7 offset:7680
    ds_read_b32 v63, v7 offset:7936
    s_waitcnt lgkmcnt(0)
    v_add_f32 v32, v32, v48
    v_add_f32 v33, v33, v49
    v_add_f32 v34, v34, v50
    v_add_f32 v35, v35, v51
    v_add_f32 v36, v36, v52
    v_add_f32 v37, v37, v53
    v_add_f32 v38, v38, v54
    v_add_f32 v39, v39, v55
    v_add_f32 v40, v40, v56
    v_add_f32 v41, v41, v57
    v_add_f32 v42, v42, v58
    v_add_f32 v43, v43, v59
    v_add_f32 v44, v44, v60
    v_add_f32 v45, v45, v61
    v_add_f32 v46, v46, v62
    v_add_f32 v47, v47, v63
    v_add_f32 v32, v32, v40
    v_add_f32 v33, v33, v41
    v_add_f32 v34, v34, v42
    v_add_f32 v35, v35, v43
    v_add_f32 v36, v36, v44
    v_add_f32 v37, v37, v45
    v_add_f32 v38, v38, v46
    v_add_f32 v39, v39, v47
    v_add_f32 v32, v32, v36
    v_add_f32 v33, v33, v37
    v_add_f32 v34, v34, v38
    v_add_f32 v35, v35, v39
    v_add_f32 v32, v32, v34
    v_add_f32 v33, v33, v35
    v_add_f32 v32, v32, v33
    s_movk_i32 s22, 640
    v_cvt_pk_bf16_f32 v32, v32, v32
    v_lshlrev_b32 v32, 16, v32
    v_add_f32 v33, 1.0, v32
    v_cvt_pk_bf16_f32 v33, v33, v33
    v_lshlrev_b32 v33, 16, v33
    s_lshl_b32 s33, s32, 6
    v_add_u32 v34, s33, v0
    v_subrev_u32 v35, 640, v34
    v_cmp_gt_u32 vcc, 640, v35
    v_subrev_u32 v35, 2560, v34
    v_cmp_gt_u32 s[40:41], s22, v35
    s_or_b64 vcc, vcc, s[40:41]
    v_cndmask_b32 v32, v32, v33, vcc
    s_lshl_b32 s21, s32, 8
    s_add_u32 s21, s21, 8036352
    buffer_store_dword v32, v7, s[28:31], s21 offen sc1
k1_end:
    s_endpgm
k1_pf:
    s_load_dwordx2 s[4:5], s[0:1], 0
    s_load_dwordx2 s[10:11], s[0:1], 120
    v_lshrrev_b32 v2, 6, v0
    v_and_b32 v1, 63, v0
    v_readfirstlane_b32 s20, v2
    v_lshlrev_b32 v3, 7, v1
    v_lshlrev_b32 v1, 4, v1
    s_sub_u32 s24, s2, 376
    s_lshr_b32 s24, s24, 3
    s_lshl_b32 s24, s24, 2
    s_add_u32 s24, s24, s20
    s_and_b32 s22, s2, 7
    s_mul_i32 s21, s24, 10240
    s_mul_i32 s23, s22, 327680
    s_add_u32 s21, s21, s23
    s_waitcnt lgkmcnt(0)
    s_mov_b32 s16, s4
    s_mov_b32 s17, s5
    s_mov_b32 s18, 2621440
    s_mov_b32 s19, 0x00020000
    s_mov_b32 s28, s10
    s_mov_b32 s29, s11
    s_mov_b32 s30, 268435456
    s_mov_b32 s31, 0x00020000
    buffer_load_dwordx4 v[8:11], v1, s[16:19], s21 offen offset:0
    buffer_load_dwordx4 v[12:15], v1, s[16:19], s21 offen offset:1024
    buffer_load_dwordx4 v[16:19], v1, s[16:19], s21 offen offset:2048
    buffer_load_dwordx4 v[20:23], v1, s[16:19], s21 offen offset:3072
    s_add_u32 s21, s21, 4096
    buffer_load_dwordx4 v[24:27], v1, s[16:19], s21 offen offset:0
    buffer_load_dwordx4 v[28:31], v1, s[16:19], s21 offen offset:1024
    buffer_load_dwordx4 v[32:35], v1, s[16:19], s21 offen offset:2048
    buffer_load_dwordx4 v[36:39], v1, s[16:19], s21 offen offset:3072
    s_add_u32 s21, s21, 4096
    buffer_load_dwordx4 v[40:43], v1, s[16:19], s21 offen offset:0
    buffer_load_dwordx4 v[44:47], v1, s[16:19], s21 offen offset:1024
    s_mul_i32 s22, s22, 1929216
    s_add_u32 s22, s22, 14381056
    s_mul_i32 s23, s24, 10240
    s_add_u32 s23, s23, s22
    s_add_u32 s23, s23, 696320
    buffer_load_dword v48, v3, s[28:31], s23 offen
    s_add_u32 s23, s23, 8192
    s_mov_b64 exec, 0xffff
    buffer_load_dword v49, v3, s[28:31], s23 offen
    s_mov_b64 exec, -1
    s_mul_i32 s23, s24, 640
    s_add_u32 s23, s23, s22
    s_add_u32 s23, s23, 1908736
    s_mov_b64 exec, 0x1f
    buffer_load_dword v52, v3, s[28:31], s23 offen
    s_mov_b64 exec, -1
    s_waitcnt vmcnt(0)
    s_endpgm
.globl k2_kernel
.p2align 8
.type k2_kernel,@function
k2_kernel:
    s_cmp_ge_u32 s2, 256
    s_cbranch_scc1 k2_end
    s_load_dwordx2 s[4:5], s[0:1], 0
    s_load_dwordx2 s[6:7], s[0:1], 104
    s_load_dwordx2 s[8:9], s[0:1], 120
    s_getreg_b32 s42, hwreg(HW_REG_XCC_ID, 0, 4)
    v_lshrrev_b32 v2, 6, v0
    v_and_b32 v1, 63, v0
    v_readfirstlane_b32 s30, v2
    s_and_b32 s28, s2, 7
    s_lshr_b32 s29, s2, 3
    s_lshr_b32 s32, s29, 3
    s_and_b32 s33, s29, 7
    s_lshr_b32 s34, s29, 4
    s_and_b32 s35, s29, 15
    s_mul_i32 s36, s28, 1929216
    s_add_u32 s36, s36, 14381056
    s_lshl_b32 s37, s28, 13
    s_add_u32 s37, s37, 14315520
    s_add_u32 s42, s42, 1
    s_mov_b32 s31, 0
    v_lshlrev_b32 v2, 4, v1
    v_lshrrev_b32 v3, 4, v1
    v_and_b32 v4, 15, v1
    v_lshrrev_b32 v8, 1, v3
    v_lshl_add_u32 v8, v8, 4, v4
    v_and_b32 v9, 1, v3
    v_lshl_add_u32 v8, v8, 1, v9
    v_lshlrev_b32 v8, 3, v8
    v_lshlrev_b32 v5, 7, v1
    v_and_b32 v9, 1, v3
    v_lshlrev_b32 v9, 1, v9
    v_lshrrev_b32 v10, 1, v3
    v_or_b32 v9, v9, v10
    v_lshlrev_b32 v9, 8, v9
    v_lshl_add_u32 v254, v4, 4, v9
    s_waitcnt lgkmcnt(0)
    s_mov_b32 s12, s8
    s_mov_b32 s13, s9
    s_mov_b32 s14, 268435456
    s_mov_b32 s15, 0x00020000
    s_mov_b32 s16, s4
    s_mov_b32 s17, s5
    s_mov_b32 s18, 2621440
    s_mov_b32 s19, 0x00020000
    s_mov_b32 s24, s6
    s_mov_b32 s25, s7
    s_mov_b32 s26, 2621440
    s_mov_b32 s27, 0x00020000
    s_cmp_lg_u32 s30, 0
    s_cbranch_scc1 k2_kernel_L1
    s_lshl_b32 s41, s29, 2
    s_add_u32 s41, s41, s37
    v_mov_b32 v9, s42
    v_mov_b32 v10, 7424
    s_mov_b64 exec, 1
    buffer_store_dword v9, v10, s[12:15], s41 offen sc1
    s_mov_b64 exec, -1
k2_kernel_L1:
    s_mul_i32 s44, s33, 102400
    s_mul_i32 s45, s35, 143360
    s_add_u32 s45, s45, 9728000
    s_mul_i32 s40, s33, 286720
    s_mul_i32 s41, s30, 71680
    s_add_u32 s40, s40, s41
    s_add_u32 s40, s40, 12021760
    s_lshl_b32 s46, s32, 2
    s_add_u32 s46, s46, s30
    s_mul_i32 s47, s46, 20480
    s_mul_i32 s41, s33, 2560
    s_add_u32 s47, s47, s41
    s_add_u32 s54, s47, s36
    s_lshl_b32 s55, s46, 7
    s_add_u32 s55, s55, s37
    s_mul_i32 s38, s30, 25600
    s_add_u32 s39, s38, s44
    s_add_u32 s39, s39, 8089600
    s_add_u32 s38, s38, 0
    s_cmp_ge_u32 s29, 18
    s_cbranch_scc1 k2_kernel_nob02
    s_lshl_b32 s46, s28, 8
    s_lshl_b32 s47, s29, 4
    s_add_u32 s46, s46, s47
    s_sub_u32 s46, s46, 16
    s_lshl_b32 s47, s30, 2
    s_add_u32 s47, s47, s46
    v_add_u32 v11, s47, v3
    s_movk_i32 s48, 1280
    v_mul_lo_u32 v6, v11, s48
    v_lshl_add_u32 v6, v4, 4, v6
    buffer_load_dwordx4 v[16:19], v6, s[16:19], 0 offen offset:0
    buffer_load_dwordx4 v[20:23], v6, s[16:19], 0 offen offset:256
    buffer_load_dwordx4 v[24:27], v6, s[16:19], 0 offen offset:512
    buffer_load_dwordx4 v[28:31], v6, s[16:19], 0 offen offset:768
    buffer_load_dwordx4 v[32:35], v6, s[16:19], 0 offen offset:1024
    s_mul_i32 s47, s29, 20480
    s_mul_i32 s48, s30, 5120
    s_add_u32 s47, s47, s48
    s_add_u32 s47, s47, s36
    s_cmp_lt_u32 s46, 2048
    s_cselect_b32 s47, s47, 0x80000000
    v_add_u32 v12, s47, v2
    s_add_u32 s48, s48, 135168
    s_mov_b32 m0, s48
    s_nop 0
    buffer_load_dwordx4 v12, s[12:15], 0 offen offset:0 lds
    buffer_load_dwordx4 v12, s[12:15], 0 offen offset:1024 lds
    buffer_load_dwordx4 v12, s[12:15], 0 offen offset:2048 lds
    buffer_load_dwordx4 v12, s[12:15], 0 offen offset:3072 lds
    s_add_u32 s48, s48, 4096
    s_mov_b32 m0, s48
    s_movk_i32 s47, 4096
    buffer_load_dwordx4 v12, s[12:15], s47 offen lds
    s_lshl_b32 s47, s30, 12
    s_add_u32 s48, s47, 118784
    s_mov_b32 m0, s48
    s_add_u32 s47, s47, 8036352
    buffer_load_dwordx4 v2, s[12:15], s47 offen offset:0 lds
    buffer_load_dwordx4 v2, s[12:15], s47 offen offset:1024 lds
    buffer_load_dwordx4 v2, s[12:15], s47 offen offset:2048 lds
    buffer_load_dwordx4 v2, s[12:15], s47 offen offset:3072 lds
    v_lshl_add_u32 v15, s30, 2, v3
    v_lshrrev_b32 v7, 1, v15
    v_and_b32 v9, 7, v4
    v_xor_b32 v7, v7, v9
    v_and_b32 v9, 1, v15
    v_lshl_add_u32 v7, v7, 1, v9
    v_lshlrev_b32 v7, 3, v7
    v_lshl_add_u32 v7, v4, 8, v7
    v_add_u32 v7, 135168, v7
    v_lshlrev_b32 v10, 5, v4
    v_add_u32 v10, 118784, v10
    v_lshrrev_b32 v12, 2, v4
    v_and_b32 v13, 3, v4
    v_lshl_add_u32 v13, v13, 4, v15
    v_lshlrev_b32 v13, 4, v13
    v_lshl_add_u32 v6, v12, 10, v13
    s_movk_i32 s48, 2048
    v_cmp_gt_u32 s[50:51], s48, v11
    v_mov_b32 v120, 0
    v_mov_b32 v121, 0
    v_mov_b32 v124, 0
    v_mov_b32 v125, 0
    v_mov_b32 v126, 0x3f803f80
    s_waitcnt vmcnt(9)
    v_dot2_f32_bf16 v120, v16, v126, v120
    v_dot2_f32_bf16 v121, v16, v16, v121
    v_lshlrev_b32 v56, 16, v16
    v_and_b32 v57, 0xffff0000, v16
    v_dot2_f32_bf16 v120, v17, v126, v120
    v_dot2_f32_bf16 v121, v17, v17, v121
    v_lshlrev_b32 v58, 16, v17
    v_and_b32 v59, 0xffff0000, v17
    v_dot2_f32_bf16 v120, v18, v126, v120
    v_dot2_f32_bf16 v121, v18, v18, v121
    v_lshlrev_b32 v60, 16, v18
    v_and_b32 v61, 0xffff0000, v18
    s_cmp_eq_u32 s30, 1
    s_cbranch_scc1 k2_kernel_sm4
    s_cmp_ge_u32 s30, 2
    s_cbranch_scc1 k2_kernel_sm5
    s_mul_i32 s41, s33, 320
    s_add_u32 s41, s41, 8073216
    s_mov_b32 m0, 155648
    s_mov_b64 exec, 0xfffff
    buffer_load_dwordx4 v2, s[12:15], s41 offen lds
    s_add_u32 s41, s41, 7168
    s_mov_b32 m0, 156160
    s_nop 0
    buffer_load_dwordx4 v2, s[12:15], s41 offen lds
    s_branch k2_kernel_sm6
k2_kernel_sm4:
    s_mul_i32 s41, s35, 448
    s_add_u32 s41, s41, 8056832
    s_mov_b32 m0, 156672
    s_mov_b64 exec, 0xfffffff
    buffer_load_dwordx4 v2, s[12:15], s41 offen lds
    s_add_u32 s41, s41, 7168
    s_mov_b32 m0, 157184
    s_nop 0
    buffer_load_dwordx4 v2, s[12:15], s41 offen lds
    s_branch k2_kernel_sm6
k2_kernel_sm5:
    s_mul_i32 s41, s33, 320
    s_add_u32 s41, s41, 8049152
    s_mov_b32 m0, 157696
    s_mov_b64 exec, 0xfffff
    buffer_load_dwordx4 v2, s[12:15], s41 offen lds
k2_kernel_sm6:
    s_mov_b64 exec, -1
    v_dot2_f32_bf16 v120, v19, v126, v120
    v_dot2_f32_bf16 v121, v19, v19, v121
    v_lshlrev_b32 v62, 16, v19
    v_and_b32 v63, 0xffff0000, v19
    v_dot2_f32_bf16 v120, v20, v126, v120
    v_dot2_f32_bf16 v121, v20, v20, v121
    v_lshlrev_b32 v64, 16, v20
    v_and_b32 v65, 0xffff0000, v20
    s_mov_b32 m0, s38
    s_nop 0
    buffer_load_dwordx4 v2, s[12:15], s39 offen offset:0 lds
    v_dot2_f32_bf16 v120, v21, v126, v120
    v_dot2_f32_bf16 v121, v21, v21, v121
    v_lshlrev_b32 v66, 16, v21
    v_and_b32 v67, 0xffff0000, v21
    v_dot2_f32_bf16 v120, v22, v126, v120
    v_dot2_f32_bf16 v121, v22, v22, v121
    v_lshlrev_b32 v68, 16, v22
    v_and_b32 v69, 0xffff0000, v22
    s_mov_b32 m0, s38
    s_nop 0
    buffer_load_dwordx4 v2, s[12:15], s39 offen offset:1024 lds
    v_dot2_f32_bf16 v120, v23, v126, v120
    v_dot2_f32_bf16 v121, v23, v23, v121
    v_lshlrev_b32 v70, 16, v23
    v_and_b32 v71, 0xffff0000, v23
    v_dot2_f32_bf16 v120, v24, v126, v120
    v_dot2_f32_bf16 v121, v24, v24, v121
    v_lshlrev_b32 v72, 16, v24
    v_and_b32 v73, 0xffff0000, v24
    s_mov_b32 m0, s38
    s_nop 0
    buffer_load_dwordx4 v2, s[12:15], s39 offen offset:2048 lds
    v_dot2_f32_bf16 v120, v25, v126, v120
    v_dot2_f32_bf16 v121, v25, v25, v121
    v_lshlrev_b32 v74, 16, v25
    v_and_b32 v75, 0xffff0000, v25
    v_dot2_f32_bf16 v120, v26, v126, v120
    v_dot2_f32_bf16 v121, v26, v26, v121
    v_lshlrev_b32 v76, 16, v26
    v_and_b32 v77, 0xffff0000, v26
    s_mov_b32 m0, s38
    s_nop 0
    buffer_load_dwordx4 v2, s[12:15], s39 offen offset:3072 lds
    s_add_u32 s38, s38, 4096
    s_add_u32 s39, s39, 4096
    v_dot2_f32_bf16 v120, v27, v126, v120
    v_dot2_f32_bf16 v121, v27, v27, v121
    v_lshlrev_b32 v78, 16, v27
    v_and_b32 v79, 0xffff0000, v27
    v_dot2_f32_bf16 v120, v28, v126, v120
    v_dot2_f32_bf16 v121, v28, v28, v121
    v_lshlrev_b32 v80, 16, v28
    v_and_b32 v81, 0xffff0000, v28
    s_mov_b32 m0, s38
    s_nop 0
    buffer_load_dwordx4 v2, s[12:15], s39 offen offset:0 lds
    v_dot2_f32_bf16 v120, v29, v126, v120
    v_dot2_f32_bf16 v121, v29, v29, v121
    v_lshlrev_b32 v82, 16, v29
    v_and_b32 v83, 0xffff0000, v29
    v_dot2_f32_bf16 v120, v30, v126, v120
    v_dot2_f32_bf16 v121, v30, v30, v121
    v_lshlrev_b32 v84, 16, v30
    v_and_b32 v85, 0xffff0000, v30
    s_mov_b32 m0, s38
    s_nop 0
    buffer_load_dwordx4 v2, s[12:15], s39 offen offset:1024 lds
    v_dot2_f32_bf16 v120, v31, v126, v120
    v_dot2_f32_bf16 v121, v31, v31, v121
    v_lshlrev_b32 v86, 16, v31
    v_and_b32 v87, 0xffff0000, v31
    v_dot2_f32_bf16 v120, v32, v126, v120
    v_dot2_f32_bf16 v121, v32, v32, v121
    v_lshlrev_b32 v88, 16, v32
    v_and_b32 v89, 0xffff0000, v32
    s_mov_b32 m0, s38
    s_nop 0
    buffer_load_dwordx4 v2, s[12:15], s39 offen offset:2048 lds
    v_dot2_f32_bf16 v120, v33, v126, v120
    v_dot2_f32_bf16 v121, v33, v33, v121
    v_lshlrev_b32 v90, 16, v33
    v_and_b32 v91, 0xffff0000, v33
    v_dot2_f32_bf16 v120, v34, v126, v120
    v_dot2_f32_bf16 v121, v34, v34, v121
    v_lshlrev_b32 v92, 16, v34
    v_and_b32 v93, 0xffff0000, v34
    s_mov_b32 m0, s38
    s_nop 0
    buffer_load_dwordx4 v2, s[12:15], s39 offen offset:3072 lds
    s_add_u32 s38, s38, 4096
    s_add_u32 s39, s39, 4096
    v_dot2_f32_bf16 v120, v35, v126, v120
    v_dot2_f32_bf16 v121, v35, v35, v121
    v_lshlrev_b32 v94, 16, v35
    v_and_b32 v95, 0xffff0000, v35
    s_nop 1
    s_nop 0
    v_add_f32_dpp v120, v120, v120 quad_perm:[1,0,3,2] row_mask:0xf bank_mask:0xf
    v_add_f32_dpp v121, v121, v121 quad_perm:[1,0,3,2] row_mask:0xf bank_mask:0xf
    s_nop 0
    v_add_f32_dpp v120, v120, v120 quad_perm:[2,3,0,1] row_mask:0xf bank_mask:0xf
    v_add_f32_dpp v121, v121, v121 quad_perm:[2,3,0,1] row_mask:0xf bank_mask:0xf
    s_nop 0
    v_add_f32_dpp v120, v120, v120 row_half_mirror row_mask:0xf bank_mask:0xf
    v_add_f32_dpp v121, v121, v121 row_half_mirror row_mask:0xf bank_mask:0xf
    s_nop 0
    v_add_f32_dpp v120, v120, v120 row_mirror row_mask:0xf bank_mask:0xf
    v_add_f32_dpp v121, v121, v121 row_mirror row_mask:0xf bank_mask:0xf
    v_mul_f32 v120, 0x3acccccd, v120
    v_mul_f32 v121, 0x3acccccd, v121
    v_fma_f32 v121, -v120, v120, v121
    v_max_f32 v121, 0, v121
    v_cvt_pk_bf16_f32 v122, v120, v121
    v_lshlrev_b32 v120, 16, v122
    v_and_b32 v121, 0xffff0000, v122
    v_add_f32 v121, 0x3727c5ac, v121
    v_cvt_pk_bf16_f32 v122, v121, v121
    v_lshlrev_b32 v121, 16, v122
    v_sqrt_f32 v121, v121
    s_nop 0
    v_cvt_pk_bf16_f32 v122, v121, v121
    v_lshlrev_b32 v121, 16, v122
    v_rcp_f32 v121, v121
    s_nop 0
    v_mul_f32 v120, v120, v121
    v_sub_f32 v120, 0, v120
    s_waitcnt vmcnt(9)
    s_barrier
    ds_read_b64 v[36:37], v7 offset:0
    ds_read_b64 v[38:39], v7 offset:128
    ds_read_b64 v[40:41], v7 offset:4096
    ds_read_b64 v[42:43], v7 offset:4224
    ds_read_b64 v[44:45], v7 offset:8192
    ds_read_b64 v[46:47], v7 offset:8320
    ds_read_b64 v[48:49], v7 offset:12288
    ds_read_b64 v[50:51], v7 offset:12416
    ds_read_b64 v[52:53], v7 offset:16384
    ds_read_b64 v[54:55], v7 offset:16512
    ds_read_b128 v[96:99], v10 offset:2560
    ds_read_b128 v[100:103], v10 offset:2576
    ds_read_b128 v[104:107], v10 offset:0
    ds_read_b128 v[108:111], v10 offset:16
    ds_read_b128 v[112:115], v10 offset:5120
    ds_read_b128 v[116:119], v10 offset:5136
    ds_read_b128 v[160:163], v10 offset:3072
    ds_read_b128 v[164:167], v10 offset:3088
    ds_read_b128 v[168:171], v10 offset:512
    ds_read_b128 v[172:175], v10 offset:528
    ds_read_b128 v[176:179], v10 offset:5632
    ds_read_b128 v[180:183], v10 offset:5648
    s_waitcnt lgkmcnt(6)
    v_lshlrev_b32 v152, 16, v36
    v_and_b32 v153, 0xffff0000, v36
    v_lshlrev_b32 v154, 16, v37
    v_and_b32 v155, 0xffff0000, v37
    v_lshlrev_b32 v156, 16, v38
    v_and_b32 v157, 0xffff0000, v38
    v_lshlrev_b32 v158, 16, v39
    v_and_b32 v159, 0xffff0000, v39
    v_pk_fma_f32 v[144:145], v[56:57], v[120:121], v[120:121] op_sel:[0,1,0] op_sel_hi:[1,1,0]
    v_pk_fma_f32 v[146:147], v[58:59], v[120:121], v[120:121] op_sel:[0,1,0] op_sel_hi:[1,1,0]
    v_pk_fma_f32 v[148:149], v[60:61], v[120:121], v[120:121] op_sel:[0,1,0] op_sel_hi:[1,1,0]
    v_pk_fma_f32 v[150:151], v[62:63], v[120:121], v[120:121] op_sel:[0,1,0] op_sel_hi:[1,1,0]
    v_pk_fma_f32 v[144:145], v[144:145], v[96:97], v[104:105]
    v_pk_fma_f32 v[146:147], v[146:147], v[98:99], v[106:107]
    v_pk_fma_f32 v[148:149], v[148:149], v[100:101], v[108:109]
    v_pk_fma_f32 v[150:151], v[150:151], v[102:103], v[110:111]
    v_pk_mul_f32 v[144:145], v[144:145], v[152:153]
    v_pk_mul_f32 v[146:147], v[146:147], v[154:155]
    v_pk_mul_f32 v[148:149], v[148:149], v[156:157]
    v_pk_mul_f32 v[150:151], v[150:151], v[158:159]
    v_pk_fma_f32 v[56:57], v[112:113], v[144:145], v[56:57]
    v_pk_fma_f32 v[58:59], v[114:115], v[146:147], v[58:59]
    v_pk_fma_f32 v[60:61], v[116:117], v[148:149], v[60:61]
    v_pk_fma_f32 v[62:63], v[118:119], v[150:151], v[62:63]
    v_cvt_pk_bf16_f32 v16, v56, v57
    v_cvt_pk_bf16_f32 v17, v58, v59
    v_cvt_pk_bf16_f32 v18, v60, v61
    v_cvt_pk_bf16_f32 v19, v62, v63
    v_lshlrev_b32 v56, 16, v16
    v_and_b32 v57, 0xffff0000, v16
    v_dot2_f32_bf16 v124, v16, v126, v124
    v_dot2_f32_bf16 v125, v16, v16, v125
    v_lshlrev_b32 v58, 16, v17
    v_and_b32 v59, 0xffff0000, v17
    v_dot2_f32_bf16 v124, v17, v126, v124
    v_dot2_f32_bf16 v125, v17, v17, v125
    v_lshlrev_b32 v60, 16, v18
    v_and_b32 v61, 0xffff0000, v18
    v_dot2_f32_bf16 v124, v18, v126, v124
    v_dot2_f32_bf16 v125, v18, v18, v125
    v_lshlrev_b32 v62, 16, v19
    v_and_b32 v63, 0xffff0000, v19
    v_dot2_f32_bf16 v124, v19, v126, v124
    v_dot2_f32_bf16 v125, v19, v19, v125
    ds_read_b128 v[96:99], v10 offset:3584
    ds_read_b128 v[100:103], v10 offset:3600
    ds_read_b128 v[104:107], v10 offset:1024
    ds_read_b128 v[108:111], v10 offset:1040
    ds_read_b128 v[112:115], v10 offset:6144
    ds_read_b128 v[116:119], v10 offset:6160
    s_waitcnt lgkmcnt(6)
    v_lshlrev_b32 v152, 16, v40
    v_and_b32 v153, 0xffff0000, v40
    v_lshlrev_b32 v154, 16, v41
    v_and_b32 v155, 0xffff0000, v41
    v_lshlrev_b32 v156, 16, v42
    v_and_b32 v157, 0xffff0000, v42
    v_lshlrev_b32 v158, 16, v43
    v_and_b32 v159, 0xffff0000, v43
    v_pk_fma_f32 v[144:145], v[64:65], v[120:121], v[120:121] op_sel:[0,1,0] op_sel_hi:[1,1,0]
    v_pk_fma_f32 v[146:147], v[66:67], v[120:121], v[120:121] op_sel:[0,1,0] op_sel_hi:[1,1,0]
    v_pk_fma_f32 v[148:149], v[68:69], v[120:121], v[120:121] op_sel:[0,1,0] op_sel_hi:[1,1,0]
    v_pk_fma_f32 v[150:151], v[70:71], v[120:121], v[120:121] op_sel:[0,1,0] op_sel_hi:[1,1,0]
    v_pk_fma_f32 v[144:145], v[144:145], v[160:161], v[168:169]
    v_pk_fma_f32 v[146:147], v[146:147], v[162:163], v[170:171]
    v_pk_fma_f32 v[148:149], v[148:149], v[164:165], v[172:173]
    v_pk_fma_f32 v[150:151], v[150:151], v[166:167], v[174:175]
    v_pk_mul_f32 v[144:145], v[144:145], v[152:153]
    v_pk_mul_f32 v[146:147], v[146:147], v[154:155]
    v_pk_mul_f32 v[148:149], v[148:149], v[156:157]
    v_pk_mul_f32 v[150:151], v[150:151], v[158:159]
    v_pk_fma_f32 v[64:65], v[176:177], v[144:145], v[64:65]
    v_pk_fma_f32 v[66:67], v[178:179], v[146:147], v[66:67]
    v_pk_fma_f32 v[68:69], v[180:181], v[148:149], v[68:69]
    v_pk_fma_f32 v[70:71], v[182:183], v[150:151], v[70:71]
    v_cvt_pk_bf16_f32 v20, v64, v65
    v_cvt_pk_bf16_f32 v21, v66, v67
    v_cvt_pk_bf16_f32 v22, v68, v69
    v_cvt_pk_bf16_f32 v23, v70, v71
    v_lshlrev_b32 v64, 16, v20
    v_and_b32 v65, 0xffff0000, v20
    v_dot2_f32_bf16 v124, v20, v126, v124
    v_dot2_f32_bf16 v125, v20, v20, v125
    v_lshlrev_b32 v66, 16, v21
    v_and_b32 v67, 0xffff0000, v21
    v_dot2_f32_bf16 v124, v21, v126, v124
    v_dot2_f32_bf16 v125, v21, v21, v125
    v_lshlrev_b32 v68, 16, v22
    v_and_b32 v69, 0xffff0000, v22
    v_dot2_f32_bf16 v124, v22, v126, v124
    v_dot2_f32_bf16 v125, v22, v22, v125
    v_lshlrev_b32 v70, 16, v23
    v_and_b32 v71, 0xffff0000, v23
    v_dot2_f32_bf16 v124, v23, v126, v124
    v_dot2_f32_bf16 v125, v23, v23, v125
    ds_read_b128 v[160:163], v10 offset:4096
    ds_read_b128 v[164:167], v10 offset:4112
    ds_read_b128 v[168:171], v10 offset:1536
    ds_read_b128 v[172:175], v10 offset:1552
    ds_read_b128 v[176:179], v10 offset:6656
    ds_read_b128 v[180:183], v10 offset:6672
    s_waitcnt lgkmcnt(6)
    v_lshlrev_b32 v152, 16, v44
    v_and_b32 v153, 0xffff0000, v44
    v_lshlrev_b32 v154, 16, v45
    v_and_b32 v155, 0xffff0000, v45
    v_lshlrev_b32 v156, 16, v46
    v_and_b32 v157, 0xffff0000, v46
    v_lshlrev_b32 v158, 16, v47
    v_and_b32 v159, 0xffff0000, v47
    v_pk_fma_f32 v[144:145], v[72:73], v[120:121], v[120:121] op_sel:[0,1,0] op_sel_hi:[1,1,0]
    v_pk_fma_f32 v[146:147], v[74:75], v[120:121], v[120:121] op_sel:[0,1,0] op_sel_hi:[1,1,0]
    v_pk_fma_f32 v[148:149], v[76:77], v[120:121], v[120:121] op_sel:[0,1,0] op_sel_hi:[1,1,0]
    v_pk_fma_f32 v[150:151], v[78:79], v[120:121], v[120:121] op_sel:[0,1,0] op_sel_hi:[1,1,0]
    v_pk_fma_f32 v[144:145], v[144:145], v[96:97], v[104:105]
    v_pk_fma_f32 v[146:147], v[146:147], v[98:99], v[106:107]
    v_pk_fma_f32 v[148:149], v[148:149], v[100:101], v[108:109]
    v_pk_fma_f32 v[150:151], v[150:151], v[102:103], v[110:111]
    v_pk_mul_f32 v[144:145], v[144:145], v[152:153]
    v_pk_mul_f32 v[146:147], v[146:147], v[154:155]
    v_pk_mul_f32 v[148:149], v[148:149], v[156:157]
    v_pk_mul_f32 v[150:151], v[150:151], v[158:159]
    v_pk_fma_f32 v[72:73], v[112:113], v[144:145], v[72:73]
    v_pk_fma_f32 v[74:75], v[114:115], v[146:147], v[74:75]
    v_pk_fma_f32 v[76:77], v[116:117], v[148:149], v[76:77]
    v_pk_fma_f32 v[78:79], v[118:119], v[150:151], v[78:79]
    v_cvt_pk_bf16_f32 v24, v72, v73
    v_cvt_pk_bf16_f32 v25, v74, v75
    v_cvt_pk_bf16_f32 v26, v76, v77
    v_cvt_pk_bf16_f32 v27, v78, v79
    v_lshlrev_b32 v72, 16, v24
    v_and_b32 v73, 0xffff0000, v24
    v_dot2_f32_bf16 v124, v24, v126, v124
    v_dot2_f32_bf16 v125, v24, v24, v125
    v_lshlrev_b32 v74, 16, v25
    v_and_b32 v75, 0xffff0000, v25
    v_dot2_f32_bf16 v124, v25, v126, v124
    v_dot2_f32_bf16 v125, v25, v25, v125
    v_lshlrev_b32 v76, 16, v26
    v_and_b32 v77, 0xffff0000, v26
    v_dot2_f32_bf16 v124, v26, v126, v124
    v_dot2_f32_bf16 v125, v26, v26, v125
    v_lshlrev_b32 v78, 16, v27
    v_and_b32 v79, 0xffff0000, v27
    v_dot2_f32_bf16 v124, v27, v126, v124
    v_dot2_f32_bf16 v125, v27, v27, v125
    ds_read_b128 v[96:99], v10 offset:4608
    ds_read_b128 v[100:103], v10 offset:4624
    ds_read_b128 v[104:107], v10 offset:2048
    ds_read_b128 v[108:111], v10 offset:2064
    ds_read_b128 v[112:115], v10 offset:7168
    ds_read_b128 v[116:119], v10 offset:7184
    s_waitcnt lgkmcnt(6)
    v_lshlrev_b32 v152, 16, v48
    v_and_b32 v153, 0xffff0000, v48
    v_lshlrev_b32 v154, 16, v49
    v_and_b32 v155, 0xffff0000, v49
    v_lshlrev_b32 v156, 16, v50
    v_and_b32 v157, 0xffff0000, v50
    v_lshlrev_b32 v158, 16, v51
    v_and_b32 v159, 0xffff0000, v51
    v_pk_fma_f32 v[144:145], v[80:81], v[120:121], v[120:121] op_sel:[0,1,0] op_sel_hi:[1,1,0]
    v_pk_fma_f32 v[146:147], v[82:83], v[120:121], v[120:121] op_sel:[0,1,0] op_sel_hi:[1,1,0]
    v_pk_fma_f32 v[148:149], v[84:85], v[120:121], v[120:121] op_sel:[0,1,0] op_sel_hi:[1,1,0]
    v_pk_fma_f32 v[150:151], v[86:87], v[120:121], v[120:121] op_sel:[0,1,0] op_sel_hi:[1,1,0]
    v_pk_fma_f32 v[144:145], v[144:145], v[160:161], v[168:169]
    v_pk_fma_f32 v[146:147], v[146:147], v[162:163], v[170:171]
    v_pk_fma_f32 v[148:149], v[148:149], v[164:165], v[172:173]
    v_pk_fma_f32 v[150:151], v[150:151], v[166:167], v[174:175]
    v_pk_mul_f32 v[144:145], v[144:145], v[152:153]
    v_pk_mul_f32 v[146:147], v[146:147], v[154:155]
    v_pk_mul_f32 v[148:149], v[148:149], v[156:157]
    v_pk_mul_f32 v[150:151], v[150:151], v[158:159]
    v_pk_fma_f32 v[80:81], v[176:177], v[144:145], v[80:81]
    v_pk_fma_f32 v[82:83], v[178:179], v[146:147], v[82:83]
    v_pk_fma_f32 v[84:85], v[180:181], v[148:149], v[84:85]
    v_pk_fma_f32 v[86:87], v[182:183], v[150:151], v[86:87]
    v_cvt_pk_bf16_f32 v28, v80, v81
    v_cvt_pk_bf16_f32 v29, v82, v83
    v_cvt_pk_bf16_f32 v30, v84, v85
    v_cvt_pk_bf16_f32 v31, v86, v87
    v_lshlrev_b32 v80, 16, v28
    v_and_b32 v81, 0xffff0000, v28
    v_dot2_f32_bf16 v124, v28, v126, v124
    v_dot2_f32_bf16 v125, v28, v28, v125
    v_lshlrev_b32 v82, 16, v29
    v_and_b32 v83, 0xffff0000, v29
    v_dot2_f32_bf16 v124, v29, v126, v124
    v_dot2_f32_bf16 v125, v29, v29, v125
    v_lshlrev_b32 v84, 16, v30
    v_and_b32 v85, 0xffff0000, v30
    v_dot2_f32_bf16 v124, v30, v126, v124
    v_dot2_f32_bf16 v125, v30, v30, v125
    v_lshlrev_b32 v86, 16, v31
    v_and_b32 v87, 0xffff0000, v31
    v_dot2_f32_bf16 v124, v31, v126, v124
    v_dot2_f32_bf16 v125, v31, v31, v125
    s_waitcnt lgkmcnt(0)
    v_lshlrev_b32 v152, 16, v52
    v_and_b32 v153, 0xffff0000, v52
    v_lshlrev_b32 v154, 16, v53
    v_and_b32 v155, 0xffff0000, v53
    v_lshlrev_b32 v156, 16, v54
    v_and_b32 v157, 0xffff0000, v54
    v_lshlrev_b32 v158, 16, v55
    v_and_b32 v159, 0xffff0000, v55
    v_pk_fma_f32 v[144:145], v[88:89], v[120:121], v[120:121] op_sel:[0,1,0] op_sel_hi:[1,1,0]
    v_pk_fma_f32 v[146:147], v[90:91], v[120:121], v[120:121] op_sel:[0,1,0] op_sel_hi:[1,1,0]
    v_pk_fma_f32 v[148:149], v[92:93], v[120:121], v[120:121] op_sel:[0,1,0] op_sel_hi:[1,1,0]
    v_pk_fma_f32 v[150:151], v[94:95], v[120:121], v[120:121] op_sel:[0,1,0] op_sel_hi:[1,1,0]
    v_pk_fma_f32 v[144:145], v[144:145], v[96:97], v[104:105]
    v_pk_fma_f32 v[146:147], v[146:147], v[98:99], v[106:107]
    v_pk_fma_f32 v[148:149], v[148:149], v[100:101], v[108:109]
    v_pk_fma_f32 v[150:151], v[150:151], v[102:103], v[110:111]
    v_pk_mul_f32 v[144:145], v[144:145], v[152:153]
    v_pk_mul_f32 v[146:147], v[146:147], v[154:155]
    v_pk_mul_f32 v[148:149], v[148:149], v[156:157]
    v_pk_mul_f32 v[150:151], v[150:151], v[158:159]
    v_pk_fma_f32 v[88:89], v[112:113], v[144:145], v[88:89]
    v_pk_fma_f32 v[90:91], v[114:115], v[146:147], v[90:91]
    v_pk_fma_f32 v[92:93], v[116:117], v[148:149], v[92:93]
    v_pk_fma_f32 v[94:95], v[118:119], v[150:151], v[94:95]
    v_cvt_pk_bf16_f32 v32, v88, v89
    v_cvt_pk_bf16_f32 v33, v90, v91
    v_cvt_pk_bf16_f32 v34, v92, v93
    v_cvt_pk_bf16_f32 v35, v94, v95
    v_lshlrev_b32 v88, 16, v32
    v_and_b32 v89, 0xffff0000, v32
    v_dot2_f32_bf16 v124, v32, v126, v124
    v_dot2_f32_bf16 v125, v32, v32, v125
    v_lshlrev_b32 v90, 16, v33
    v_and_b32 v91, 0xffff0000, v33
    v_dot2_f32_bf16 v124, v33, v126, v124
    v_dot2_f32_bf16 v125, v33, v33, v125
    v_lshlrev_b32 v92, 16, v34
    v_and_b32 v93, 0xffff0000, v34
    v_dot2_f32_bf16 v124, v34, v126, v124
    v_dot2_f32_bf16 v125, v34, v34, v125
    v_lshlrev_b32 v94, 16, v35
    v_and_b32 v95, 0xffff0000, v35
    v_dot2_f32_bf16 v124, v35, v126, v124
    v_dot2_f32_bf16 v125, v35, v35, v125
    v_and_b32 v191, 31, v1
    v_lshlrev_b32 v191, 2, v191
    s_add_u32 s41, s37, 7424
    buffer_load_dword v190, v191, s[12:15], s41 offen sc1
    ds_read_b128 v[96:99], v10 offset:10240
    ds_read_b128 v[100:103], v10 offset:10256
    ds_read_b128 v[104:107], v10 offset:7680
    ds_read_b128 v[108:111], v10 offset:7696
    s_nop 1
    s_nop 0
    v_add_f32_dpp v124, v124, v124 quad_perm:[1,0,3,2] row_mask:0xf bank_mask:0xf
    v_add_f32_dpp v125, v125, v125 quad_perm:[1,0,3,2] row_mask:0xf bank_mask:0xf
    s_nop 0
    v_add_f32_dpp v124, v124, v124 quad_perm:[2,3,0,1] row_mask:0xf bank_mask:0xf
    v_add_f32_dpp v125, v125, v125 quad_perm:[2,3,0,1] row_mask:0xf bank_mask:0xf
    s_nop 0
    v_add_f32_dpp v124, v124, v124 row_half_mirror row_mask:0xf bank_mask:0xf
    v_add_f32_dpp v125, v125, v125 row_half_mirror row_mask:0xf bank_mask:0xf
    s_nop 0
    v_add_f32_dpp v124, v124, v124 row_mirror row_mask:0xf bank_mask:0xf
    v_add_f32_dpp v125, v125, v125 row_mirror row_mask:0xf bank_mask:0xf
    v_mul_f32 v124, 0x3acccccd, v124
    v_mul_f32 v125, 0x3acccccd, v125
    v_fma_f32 v125, -v124, v124, v125
    v_max_f32 v125, 0, v125
    v_cvt_pk_bf16_f32 v122, v124, v125
    v_lshlrev_b32 v124, 16, v122
    v_and_b32 v125, 0xffff0000, v122
    v_add_f32 v125, 0x3727c5ac, v125
    v_cvt_pk_bf16_f32 v122, v125, v125
    v_lshlrev_b32 v125, 16, v122
    v_sqrt_f32 v125, v125
    s_nop 0
    v_cvt_pk_bf16_f32 v122, v125, v125
    v_lshlrev_b32 v125, 16, v122
    v_rcp_f32 v125, v125
    s_nop 0
    v_mul_f32 v124, v124, v125
    v_sub_f32 v124, 0, v124
    v_mov_b32 v120, 0
    v_mov_b32 v121, 0
    ds_read_b128 v[160:163], v10 offset:10752
    ds_read_b128 v[164:167], v10 offset:10768
    ds_read_b128 v[168:171], v10 offset:8192
    ds_read_b128 v[172:175], v10 offset:8208
    s_waitcnt lgkmcnt(4)
    v_pk_fma_f32 v[56:57], v[56:57], v[124:125], v[124:125] op_sel:[0,1,0] op_sel_hi:[1,1,0]
    v_pk_fma_f32 v[58:59], v[58:59], v[124:125], v[124:125] op_sel:[0,1,0] op_sel_hi:[1,1,0]
    v_pk_fma_f32 v[60:61], v[60:61], v[124:125], v[124:125] op_sel:[0,1,0] op_sel_hi:[1,1,0]
    v_pk_fma_f32 v[62:63], v[62:63], v[124:125], v[124:125] op_sel:[0,1,0] op_sel_hi:[1,1,0]
    v_pk_fma_f32 v[56:57], v[56:57], v[96:97], v[104:105]
    v_pk_fma_f32 v[58:59], v[58:59], v[98:99], v[106:107]
    v_pk_fma_f32 v[60:61], v[60:61], v[100:101], v[108:109]
    v_pk_fma_f32 v[62:63], v[62:63], v[102:103], v[110:111]
    v_cvt_pk_bf16_f32 v36, v56, v57
    v_cvt_pk_bf16_f32 v37, v58, v59
    v_cvt_pk_bf16_f32 v38, v60, v61
    v_cvt_pk_bf16_f32 v39, v62, v63
    v_dot2_f32_bf16 v120, v36, v126, v120
    v_dot2_f32_bf16 v121, v36, v36, v121
    v_dot2_f32_bf16 v120, v37, v126, v120
    v_dot2_f32_bf16 v121, v37, v37, v121
    v_dot2_f32_bf16 v120, v38, v126, v120
    v_dot2_f32_bf16 v121, v38, v38, v121
    v_dot2_f32_bf16 v120, v39, v126, v120
    v_dot2_f32_bf16 v121, v39, v39, v121
    ds_read_b128 v[96:99], v10 offset:11264
    ds_read_b128 v[100:103], v10 offset:11280
    ds_read_b128 v[104:107], v10 offset:8704
    ds_read_b128 v[108:111], v10 offset:8720
    s_waitcnt lgkmcnt(4)
    v_pk_fma_f32 v[64:65], v[64:65], v[124:125], v[124:125] op_sel:[0,1,0] op_sel_hi:[1,1,0]
    v_pk_fma_f32 v[66:67], v[66:67], v[124:125], v[124:125] op_sel:[0,1,0] op_sel_hi:[1,1,0]
    v_pk_fma_f32 v[68:69], v[68:69], v[124:125], v[124:125] op_sel:[0,1,0] op_sel_hi:[1,1,0]
    v_pk_fma_f32 v[70:71], v[70:71], v[124:125], v[124:125] op_sel:[0,1,0] op_sel_hi:[1,1,0]
    v_pk_fma_f32 v[64:65], v[64:65], v[160:161], v[168:169]
    v_pk_fma_f32 v[66:67], v[66:67], v[162:163], v[170:171]
    v_pk_fma_f32 v[68:69], v[68:69], v[164:165], v[172:173]
    v_pk_fma_f32 v[70:71], v[70:71], v[166:167], v[174:175]
    v_cvt_pk_bf16_f32 v40, v64, v65
    v_cvt_pk_bf16_f32 v41, v66, v67
    v_cvt_pk_bf16_f32 v42, v68, v69
    v_cvt_pk_bf16_f32 v43, v70, v71
    v_dot2_f32_bf16 v120, v40, v126, v120
    v_dot2_f32_bf16 v121, v40, v40, v121
    v_dot2_f32_bf16 v120, v41, v126, v120
    v_dot2_f32_bf16 v121, v41, v41, v121
    v_dot2_f32_bf16 v120, v42, v126, v120
    v_dot2_f32_bf16 v121, v42, v42, v121
    v_dot2_f32_bf16 v120, v43, v126, v120
    v_dot2_f32_bf16 v121, v43, v43, v121
    ds_read_b128 v[160:163], v10 offset:11776
    ds_read_b128 v[164:167], v10 offset:11792
    ds_read_b128 v[168:171], v10 offset:9216
    ds_read_b128 v[172:175], v10 offset:9232
    s_waitcnt lgkmcnt(4)
    v_pk_fma_f32 v[72:73], v[72:73], v[124:125], v[124:125] op_sel:[0,1,0] op_sel_hi:[1,1,0]
    v_pk_fma_f32 v[74:75], v[74:75], v[124:125], v[124:125] op_sel:[0,1,0] op_sel_hi:[1,1,0]
    v_pk_fma_f32 v[76:77], v[76:77], v[124:125], v[124:125] op_sel:[0,1,0] op_sel_hi:[1,1,0]
    v_pk_fma_f32 v[78:79], v[78:79], v[124:125], v[124:125] op_sel:[0,1,0] op_sel_hi:[1,1,0]
    v_pk_fma_f32 v[72:73], v[72:73], v[96:97], v[104:105]
    v_pk_fma_f32 v[74:75], v[74:75], v[98:99], v[106:107]
    v_pk_fma_f32 v[76:77], v[76:77], v[100:101], v[108:109]
    v_pk_fma_f32 v[78:79], v[78:79], v[102:103], v[110:111]
    v_cvt_pk_bf16_f32 v44, v72, v73
    v_cvt_pk_bf16_f32 v45, v74, v75
    v_cvt_pk_bf16_f32 v46, v76, v77
    v_cvt_pk_bf16_f32 v47, v78, v79
    v_dot2_f32_bf16 v120, v44, v126, v120
    v_dot2_f32_bf16 v121, v44, v44, v121
    v_dot2_f32_bf16 v120, v45, v126, v120
    v_dot2_f32_bf16 v121, v45, v45, v121
    v_dot2_f32_bf16 v120, v46, v126, v120
    v_dot2_f32_bf16 v121, v46, v46, v121
    v_dot2_f32_bf16 v120, v47, v126, v120
    v_dot2_f32_bf16 v121, v47, v47, v121
    ds_read_b128 v[96:99], v10 offset:12288
    ds_read_b128 v[100:103], v10 offset:12304
    ds_read_b128 v[104:107], v10 offset:9728
    ds_read_b128 v[108:111], v10 offset:9744
    s_waitcnt lgkmcnt(4)
    v_pk_fma_f32 v[80:81], v[80:81], v[124:125], v[124:125] op_sel:[0,1,0] op_sel_hi:[1,1,0]
    v_pk_fma_f32 v[82:83], v[82:83], v[124:125], v[124:125] op_sel:[0,1,0] op_sel_hi:[1,1,0]
    v_pk_fma_f32 v[84:85], v[84:85], v[124:125], v[124:125] op_sel:[0,1,0] op_sel_hi:[1,1,0]
    v_pk_fma_f32 v[86:87], v[86:87], v[124:125], v[124:125] op_sel:[0,1,0] op_sel_hi:[1,1,0]
    v_pk_fma_f32 v[80:81], v[80:81], v[160:161], v[168:169]
    v_pk_fma_f32 v[82:83], v[82:83], v[162:163], v[170:171]
    v_pk_fma_f32 v[84:85], v[84:85], v[164:165], v[172:173]
    v_pk_fma_f32 v[86:87], v[86:87], v[166:167], v[174:175]
    v_cvt_pk_bf16_f32 v48, v80, v81
    v_cvt_pk_bf16_f32 v49, v82, v83
    v_cvt_pk_bf16_f32 v50, v84, v85
    v_cvt_pk_bf16_f32 v51, v86, v87
    v_dot2_f32_bf16 v120, v48, v126, v120
    v_dot2_f32_bf16 v121, v48, v48, v121
    v_dot2_f32_bf16 v120, v49, v126, v120
    v_dot2_f32_bf16 v121, v49, v49, v121
    v_dot2_f32_bf16 v120, v50, v126, v120
    v_dot2_f32_bf16 v121, v50, v50, v121
    v_dot2_f32_bf16 v120, v51, v126, v120
    v_dot2_f32_bf16 v121, v51, v51, v121
    s_waitcnt lgkmcnt(0)
    v_pk_fma_f32 v[88:89], v[88:89], v[124:125], v[124:125] op_sel:[0,1,0] op_sel_hi:[1,1,0]
    v_pk_fma_f32 v[90:91], v[90:91], v[124:125], v[124:125] op_sel:[0,1,0] op_sel_hi:[1,1,0]
    v_pk_fma_f32 v[92:93], v[92:93], v[124:125], v[124:125] op_sel:[0,1,0] op_sel_hi:[1,1,0]
    v_pk_fma_f32 v[94:95], v[94:95], v[124:125], v[124:125] op_sel:[0,1,0] op_sel_hi:[1,1,0]
    v_pk_fma_f32 v[88:89], v[88:89], v[96:97], v[104:105]
    v_pk_fma_f32 v[90:91], v[90:91], v[98:99], v[106:107]
    v_pk_fma_f32 v[92:93], v[92:93], v[100:101], v[108:109]
    v_pk_fma_f32 v[94:95], v[94:95], v[102:103], v[110:111]
    v_cvt_pk_bf16_f32 v52, v88, v89
    v_cvt_pk_bf16_f32 v53, v90, v91
    v_cvt_pk_bf16_f32 v54, v92, v93
    v_cvt_pk_bf16_f32 v55, v94, v95
    v_dot2_f32_bf16 v120, v52, v126, v120
    v_dot2_f32_bf16 v121, v52, v52, v121
    v_dot2_f32_bf16 v120, v53, v126, v120
    v_dot2_f32_bf16 v121, v53, v53, v121
    v_dot2_f32_bf16 v120, v54, v126, v120
    v_dot2_f32_bf16 v121, v54, v54, v121
    v_dot2_f32_bf16 v120, v55, v126, v120
    v_dot2_f32_bf16 v121, v55, v55, v121
    s_nop 1
    s_nop 0
    v_add_f32_dpp v120, v120, v120 quad_perm:[1,0,3,2] row_mask:0xf bank_mask:0xf
    v_add_f32_dpp v121, v121, v121 quad_perm:[1,0,3,2] row_mask:0xf bank_mask:0xf
    s_nop 0
    v_add_f32_dpp v120, v120, v120 quad_perm:[2,3,0,1] row_mask:0xf bank_mask:0xf
    v_add_f32_dpp v121, v121, v121 quad_perm:[2,3,0,1] row_mask:0xf bank_mask:0xf
    s_nop 0
    v_add_f32_dpp v120, v120, v120 row_half_mirror row_mask:0xf bank_mask:0xf
    v_add_f32_dpp v121, v121, v121 row_half_mirror row_mask:0xf bank_mask:0xf
    s_nop 0
    v_add_f32_dpp v120, v120, v120 row_mirror row_mask:0xf bank_mask:0xf
    v_add_f32_dpp v121, v121, v121 row_mirror row_mask:0xf bank_mask:0xf
    v_mul_f32 v120, 0x3acccccd, v120
    v_mul_f32 v121, 0x3acccccd, v121
    v_fma_f32 v121, -v120, v120, v121
    v_max_f32 v121, 0, v121
    v_cvt_pk_bf16_f32 v122, v120, v121
    v_lshlrev_b32 v120, 16, v122
    v_and_b32 v121, 0xffff0000, v122
    v_add_f32 v121, 0x3727c5ac, v121
    v_cvt_pk_bf16_f32 v122, v121, v121
    v_lshlrev_b32 v121, 16, v122
    v_sqrt_f32 v121, v121
    s_nop 0
    v_cvt_pk_bf16_f32 v122, v121, v121
    v_lshlrev_b32 v121, 16, v122
    v_rcp_f32 v121, v121
    s_nop 0
    v_mul_f32 v120, v120, v121
    v_sub_f32 v120, 0, v120
    v_cndmask_b32 v120, 0, v120, s[50:51]
    v_cndmask_b32 v121, 0, v121, s[50:51]
    s_mul_i32 s46, s29, 20480
    s_add_u32 s46, s46, s36
    s_add_u32 s47, s46, 348160
    s_lshl_b32 s48, s29, 7
    s_add_u32 s48, s48, s36
    s_add_u32 s48, s48, 1925120
    v_lshlrev_b32 v12, 3, v15
    s_lshl_b32 s49, s29, 7
    s_add_u32 s49, s49, s37
    s_lshl_b32 s41, s30, 2
    s_add_u32 s49, s49, s41
    s_waitcnt vmcnt(0)
    s_mov_b32 s43, 200000
k2_kernel_xp7:
    v_cmp_ne_u32 vcc, 0, v190
    s_sub_u32 s43, s43, 1
    s_cmp_eq_u64 vcc, -1
    s_cbranch_scc1 k2_kernel_xd8
    s_cmp_eq_u32 s43, 0
    s_cbranch_scc1 k2_kernel_xd8
    s_add_u32 s41, s37, 7424
    buffer_load_dword v190, v191, s[12:15], s41 offen sc1
    s_waitcnt vmcnt(0)
    s_branch k2_kernel_xp7
k2_kernel_xd8:
    v_cmp_eq_u32 vcc, s42, v190
    s_nop 1
    s_cmp_eq_u64 vcc, -1
    s_cselect_b32 s31, 1, 0
    s_barrier
    v_and_b32 v9, 7, v4
    v_xor_b32 v9, v15, v9
    v_and_b32 v10, 3, v4
    v_lshl_add_u32 v9, v10, 4, v9
    v_lshrrev_b32 v10, 2, v4
    v_lshl_add_u32 v9, v10, 6, v9
    v_lshlrev_b32 v9, 4, v9
    v_add_u32 v9, 114688, v9
    ds_write_b128 v9, v[36:39] offset:0
    ds_write_b128 v9, v[16:19] offset:20480
    ds_write_b128 v9, v[40:43] offset:4096
    ds_write_b128 v9, v[20:23] offset:24576
    ds_write_b128 v9, v[44:47] offset:8192
    ds_write_b128 v9, v[24:27] offset:28672
    ds_write_b128 v9, v[48:51] offset:12288
    ds_write_b128 v9, v[28:31] offset:32768
    ds_write_b128 v9, v[52:55] offset:16384
    ds_write_b128 v9, v[32:35] offset:36864
    v_xor_b32 v9, v4, v3
    v_xor_b32 v10, 4, v9
    v_lshl_add_u32 v9, v3, 4, v9
    v_lshl_add_u32 v10, v3, 4, v10
    s_mul_i32 s41, s30, 5120
    s_add_u32 s41, s41, 114688
    v_lshl_add_u32 v9, v9, 4, s41
    v_lshl_add_u32 v10, v10, 4, s41
    s_cmp_eq_u32 s30, 1
    s_cselect_b32 s41, 1, 0
    s_cmp_eq_u32 s30, 3
    s_cselect_b32 s41, 1, s41
    s_cmp_eq_u32 s41, 1
    v_mov_b32 v11, v9
    s_cbranch_scc0 k2_noswap
    v_mov_b32 v9, v10
    v_mov_b32 v10, v11
k2_noswap:
    s_mul_i32 s41, s30, 5120
    s_add_u32 s46, s46, s41
    s_add_u32 s47, s47, s41
    s_waitcnt lgkmcnt(0)
    s_barrier
    ds_read_b128 v[36:39], v9 offset:0
    ds_read_b128 v[40:43], v10 offset:1024
    ds_read_b128 v[44:47], v9 offset:2048
    ds_read_b128 v[48:51], v10 offset:3072
    ds_read_b128 v[52:55], v9 offset:4096
    ds_read_b128 v[220:223], v9 offset:20480
    ds_read_b128 v[224:227], v10 offset:21504
    ds_read_b128 v[228:231], v9 offset:22528
    ds_read_b128 v[232:235], v10 offset:23552
    ds_read_b128 v[236:239], v9 offset:24576
    s_add_u32 s52, s46, 4096
    s_sub_u32 s41, s29, 1
    s_cmp_lt_u32 s41, 16
    s_cselect_b32 s20, s47, 0x90000000
    s_cmp_eq_u32 s31, 0
    s_cbranch_scc1 k2_kernel_slow9
    s_waitcnt lgkmcnt(9)
    buffer_store_dwordx4 v[36:39], v2, s[12:15], s46 offen offset:0
    s_waitcnt lgkmcnt(8)
    buffer_store_dwordx4 v[40:43], v2, s[12:15], s46 offen offset:1024
    s_waitcnt lgkmcnt(7)
    buffer_store_dwordx4 v[44:47], v2, s[12:15], s46 offen offset:2048
    s_waitcnt lgkmcnt(6)
    buffer_store_dwordx4 v[48:51], v2, s[12:15], s46 offen offset:3072
    s_waitcnt lgkmcnt(5)
    buffer_store_dwordx4 v[52:55], v2, s[12:15], s52 offen offset:0
    v_cmp_eq_u32 vcc, 0, v4
    s_and_saveexec_b64 s[50:51], vcc
    buffer_store_dwordx2 v[120:121], v12, s[12:15], s48 offen
    s_mov_b64 exec, -1
    s_waitcnt vmcnt(0)
    v_mov_b32 v9, 1
    v_mov_b32 v10, 0
    s_mov_b64 exec, 1
    buffer_store_dword v9, v10, s[12:15], s49 offen
    s_mov_b64 exec, -1
    s_branch k2_kernel_sent10
k2_kernel_slow9:
    s_waitcnt lgkmcnt(9)
    buffer_store_dwordx4 v[36:39], v2, s[12:15], s46 offen offset:0 sc1
    s_waitcnt lgkmcnt(8)
    buffer_store_dwordx4 v[40:43], v2, s[12:15], s46 offen offset:1024 sc1
    s_waitcnt lgkmcnt(7)
    buffer_store_dwordx4 v[44:47], v2, s[12:15], s46 offen offset:2048 sc1
    s_waitcnt lgkmcnt(6)
    buffer_store_dwordx4 v[48:51], v2, s[12:15], s46 offen offset:3072 sc1
    s_waitcnt lgkmcnt(5)
    buffer_store_dwordx4 v[52:55], v2, s[12:15], s52 offen offset:0 sc1
    v_cmp_eq_u32 vcc, 0, v4
    s_and_saveexec_b64 s[50:51], vcc
    buffer_store_dwordx2 v[120:121], v12, s[12:15], s48 offen sc1
    s_mov_b64 exec, -1
    s_waitcnt vmcnt(0)
    v_mov_b32 v9, 1
    v_mov_b32 v10, 0
    s_mov_b64 exec, 1
    buffer_store_dword v9, v10, s[12:15], s49 offen sc1
    s_mov_b64 exec, -1
k2_kernel_sent10:
    s_mov_b32 s21, s49
    s_mov_b32 m0, s38
    s_nop 0
    buffer_load_dwordx4 v2, s[12:15], s39 offen offset:0 lds
    s_mov_b32 m0, s38
    s_nop 0
    buffer_load_dwordx4 v2, s[12:15], s39 offen offset:1024 lds
    s_mov_b32 m0, s38
    s_nop 0
    buffer_load_dwordx4 v2, s[12:15], s39 offen offset:2048 lds
    s_mov_b32 m0, s38
    s_nop 0
    buffer_load_dwordx4 v2, s[12:15], s39 offen offset:3072 lds
    s_add_u32 s38, s38, 4096
    s_add_u32 s39, s39, 4096
    s_mov_b32 m0, s38
    s_nop 0
    buffer_load_dwordx4 v2, s[12:15], s39 offen offset:0 lds
    s_mov_b32 m0, s38
    s_nop 0
    buffer_load_dwordx4 v2, s[12:15], s39 offen offset:1024 lds
    s_mov_b32 m0, s38
    s_nop 0
    buffer_load_dwordx4 v2, s[12:15], s39 offen offset:2048 lds
    s_mov_b32 m0, s38
    s_nop 0
    buffer_load_dwordx4 v2, s[12:15], s39 offen offset:3072 lds
    s_add_u32 s38, s38, 4096
    s_add_u32 s39, s39, 4096
    s_mov_b32 m0, s38
    s_nop 0
    buffer_load_dwordx4 v2, s[12:15], s39 offen offset:0 lds
    s_mov_b32 m0, s38
    s_nop 0
    buffer_load_dwordx4 v2, s[12:15], s39 offen offset:1024 lds
    s_mov_b32 m0, s38
    s_nop 0
    buffer_load_dwordx4 v2, s[12:15], s39 offen offset:2048 lds
    s_mov_b32 m0, s38
    s_nop 0
    buffer_load_dwordx4 v2, s[12:15], s39 offen offset:3072 lds
    s_add_u32 s38, s38, 4096
    s_add_u32 s39, s39, 4096
    s_mov_b32 m0, s38
    s_nop 0
    buffer_load_dwordx4 v2, s[12:15], s39 offen offset:0 lds
    s_mov_b32 m0, s38
    s_nop 0
    buffer_load_dwordx4 v2, s[12:15], s39 offen offset:1024 lds
    s_mov_b32 m0, s38
    s_nop 0
    buffer_load_dwordx4 v2, s[12:15], s39 offen offset:2048 lds
    s_mov_b32 m0, s38
    s_nop 0
    buffer_load_dwordx4 v2, s[12:15], s39 offen offset:3072 lds
    s_add_u32 s38, s38, 4096
    s_add_u32 s39, s39, 4096
    s_mov_b32 m0, s38
    s_nop 0
    buffer_load_dwordx4 v2, s[12:15], s39 offen offset:0 lds
    s_branch k2_kernel_join03
k2_kernel_nob02:
    s_mov_b32 s21, 0
    s_mov_b32 s20, 0x90000000
    s_mul_i32 s38, s30, 25600
    s_add_u32 s39, s38, s44
    s_add_u32 s39, s39, 8089600
    s_cmp_eq_u32 s30, 1
    s_cbranch_scc1 k2_kernel_sm11
    s_cmp_ge_u32 s30, 2
    s_cbranch_scc1 k2_kernel_sm12
    s_mul_i32 s41, s33, 320
    s_add_u32 s41, s41, 8073216
    s_mov_b32 m0, 155648
    s_mov_b64 exec, 0xfffff
    buffer_load_dwordx4 v2, s[12:15], s41 offen lds
    s_add_u32 s41, s41, 7168
    s_mov_b32 m0, 156160
    s_nop 0
    buffer_load_dwordx4 v2, s[12:15], s41 offen lds
    s_branch k2_kernel_sm13
k2_kernel_sm11:
    s_mul_i32 s41, s35, 448
    s_add_u32 s41, s41, 8056832
    s_mov_b32 m0, 156672
    s_mov_b64 exec, 0xfffffff
    buffer_load_dwordx4 v2, s[12:15], s41 offen lds
    s_add_u32 s41, s41, 7168
    s_mov_b32 m0, 157184
    s_nop 0
    buffer_load_dwordx4 v2, s[12:15], s41 offen lds
    s_branch k2_kernel_sm13
k2_kernel_sm12:
    s_mul_i32 s41, s33, 320
    s_add_u32 s41, s41, 8049152
    s_mov_b32 m0, 157696
    s_mov_b64 exec, 0xfffff
    buffer_load_dwordx4 v2, s[12:15], s41 offen lds
k2_kernel_sm13:
    s_mov_b64 exec, -1
    s_mov_b32 m0, s38
    s_nop 0
    buffer_load_dwordx4 v2, s[12:15], s39 offen offset:0 lds
    s_mov_b32 m0, s38
    s_nop 0
    buffer_load_dwordx4 v2, s[12:15], s39 offen offset:1024 lds
    s_mov_b32 m0, s38
    s_nop 0
    buffer_load_dwordx4 v2, s[12:15], s39 offen offset:2048 lds
    s_mov_b32 m0, s38
    s_nop 0
    buffer_load_dwordx4 v2, s[12:15], s39 offen offset:3072 lds
    s_add_u32 s38, s38, 4096
    s_add_u32 s39, s39, 4096
    s_mov_b32 m0, s38
    s_nop 0
    buffer_load_dwordx4 v2, s[12:15], s39 offen offset:0 lds
    s_mov_b32 m0, s38
    s_nop 0
    buffer_load_dwordx4 v2, s[12:15], s39 offen offset:1024 lds
    s_mov_b32 m0, s38
    s_nop 0
    buffer_load_dwordx4 v2, s[12:15], s39 offen offset:2048 lds
    s_mov_b32 m0, s38
    s_nop 0
    buffer_load_dwordx4 v2, s[12:15], s39 offen offset:3072 lds
    s_add_u32 s38, s38, 4096
    s_add_u32 s39, s39, 4096
    s_mov_b32 m0, s38
    s_nop 0
    buffer_load_dwordx4 v2, s[12:15], s39 offen offset:0 lds
    s_mov_b32 m0, s38
    s_nop 0
    buffer_load_dwordx4 v2, s[12:15], s39 offen offset:1024 lds
    s_mov_b32 m0, s38
    s_nop 0
    buffer_load_dwordx4 v2, s[12:15], s39 offen offset:2048 lds
    s_mov_b32 m0, s38
    s_nop 0
    buffer_load_dwordx4 v2, s[12:15], s39 offen offset:3072 lds
    s_add_u32 s38, s38, 4096
    s_add_u32 s39, s39, 4096
    s_mov_b32 m0, s38
    s_nop 0
    buffer_load_dwordx4 v2, s[12:15], s39 offen offset:0 lds
    s_mov_b32 m0, s38
    s_nop 0
    buffer_load_dwordx4 v2, s[12:15], s39 offen offset:1024 lds
    s_mov_b32 m0, s38
    s_nop 0
    buffer_load_dwordx4 v2, s[12:15], s39 offen offset:2048 lds
    s_mov_b32 m0, s38
    s_nop 0
    buffer_load_dwordx4 v2, s[12:15], s39 offen offset:3072 lds
    s_add_u32 s38, s38, 4096
    s_add_u32 s39, s39, 4096
    s_mov_b32 m0, s38
    s_nop 0
    buffer_load_dwordx4 v2, s[12:15], s39 offen offset:0 lds
    s_mov_b32 m0, s38
    s_nop 0
    buffer_load_dwordx4 v2, s[12:15], s39 offen offset:1024 lds
    s_mov_b32 m0, s38
    s_nop 0
    buffer_load_dwordx4 v2, s[12:15], s39 offen offset:2048 lds
    s_mov_b32 m0, s38
    s_nop 0
    buffer_load_dwordx4 v2, s[12:15], s39 offen offset:3072 lds
    s_add_u32 s38, s38, 4096
    s_add_u32 s39, s39, 4096
    s_mov_b32 m0, s38
    s_nop 0
    buffer_load_dwordx4 v2, s[12:15], s39 offen offset:0 lds
    s_mov_b32 m0, s38
    s_nop 0
    buffer_load_dwordx4 v2, s[12:15], s39 offen offset:1024 lds
    s_mov_b32 m0, s38
    s_nop 0
    buffer_load_dwordx4 v2, s[12:15], s39 offen offset:2048 lds
    s_mov_b32 m0, s38
    s_nop 0
    buffer_load_dwordx4 v2, s[12:15], s39 offen offset:3072 lds
    s_add_u32 s38, s38, 4096
    s_add_u32 s39, s39, 4096
    s_mov_b32 m0, s38
    s_nop 0
    buffer_load_dwordx4 v2, s[12:15], s39 offen offset:0 lds
    v_and_b32 v191, 31, v1
    v_lshlrev_b32 v191, 2, v191
    s_add_u32 s41, s37, 7424
    buffer_load_dword v190, v191, s[12:15], s41 offen sc1
    s_sub_u32 s47, s29, 18
    s_lshl_b32 s47, s47, 2
    s_add_u32 s47, s47, s30
    s_mul_i32 s47, s47, 40960
    s_add_u32 s47, s47, 9728000
    s_waitcnt vmcnt(0)
    s_mov_b32 s43, 200000
k2_kernel_xp14:
    v_cmp_ne_u32 vcc, 0, v190
    s_sub_u32 s43, s43, 1
    s_cmp_eq_u64 vcc, -1
    s_cbranch_scc1 k2_kernel_xd15
    s_cmp_eq_u32 s43, 0
    s_cbranch_scc1 k2_kernel_xd15
    s_add_u32 s41, s37, 7424
    buffer_load_dword v190, v191, s[12:15], s41 offen sc1
    s_waitcnt vmcnt(0)
    s_branch k2_kernel_xp14
k2_kernel_xd15:
    v_cmp_eq_u32 vcc, s42, v190
    s_nop 1
    s_cmp_eq_u64 vcc, -1
    s_cselect_b32 s31, 1, 0
k2_kernel_join03:
    s_lshl_b32 s46, s32, 2
    s_add_u32 s46, s46, s30
    s_lshr_b32 s47, s33, 1
    s_and_b32 s48, s47, 1
    s_lshr_b32 s47, s47, 1
    s_add_u32 s47, s47, 1
    s_sub_u32 s49, 0, s47
    s_cmp_eq_u32 s48, 1
    s_cselect_b32 s47, s47, s49
    s_lshl_b32 s49, s46, 4
    s_add_u32 s49, s49, 16
    s_add_u32 s49, s49, s47
    v_add_u32 v9, s49, v4
    v_lshrrev_b32 v10, 4, v9
    v_mul_u32_u24 v6, 20480, v10
    v_and_b32 v10, 15, v9
    v_lshl_add_u32 v10, v3, 4, v10
    v_lshl_add_u32 v6, v10, 4, v6
    v_lshlrev_b32 v13, 3, v9
    s_add_u32 s49, s46, s48
    s_lshl_b32 s49, s49, 7
    s_add_u32 s49, s49, s37
    v_bfe_u32 v7, v1, 2, 1
    v_lshlrev_b32 v7, 7, v7
    v_and_b32 v9, 3, v1
    v_lshl_add_u32 v7, v9, 2, v7
    s_mov_b32 s43, 200000
k2_kernel_poll16:
    buffer_load_dword v9, v7, s[12:15], s49 offen sc1
    s_waitcnt vmcnt(0)
    v_cmp_ne_u32 vcc, 0, v9
    s_sub_u32 s43, s43, 1
    s_cmp_eq_u64 vcc, -1
    s_cbranch_scc1 k2_kernel_go17
    s_cmp_lg_u32 s43, 0
    s_cbranch_scc1 k2_kernel_poll16
k2_kernel_go17:
    s_add_u32 s41, s36, 0
    buffer_load_dwordx4 v[16:19], v6, s[12:15], s41 offen offset:0 sc1
    s_add_u32 s41, s36, 0
    buffer_load_dwordx4 v[20:23], v6, s[12:15], s41 offen offset:1024 sc1
    s_add_u32 s41, s36, 0
    buffer_load_dwordx4 v[24:27], v6, s[12:15], s41 offen offset:2048 sc1
    s_add_u32 s41, s36, 0
    buffer_load_dwordx4 v[28:31], v6, s[12:15], s41 offen offset:3072 sc1
    s_add_u32 s41, s36, 1925120
    buffer_load_dwordx2 v[176:177], v13, s[12:15], s41 offen sc1
    v_mov_b32 v14, v2
    v_add_u32 v15, 0x10000, v2
    v_add_u32 v11, 0x20000, v2
    s_barrier
    s_mul_i32 s38, s30, 13312
    s_add_u32 s39, s38, s44
    s_add_u32 s39, s39, 8908800
    s_add_u32 s38, s38, 102400
    ds_read_b128 v[96:99], v14 offset:0
    ds_read_b128 v[100:103], v14 offset:1024
    ds_read_b128 v[104:107], v14 offset:2048
    ds_read_b128 v[108:111], v14 offset:3072
    ds_read_b128 v[112:115], v14 offset:4096
    ds_read_b128 v[116:119], v14 offset:5120
    ds_read_b128 v[120:123], v14 offset:6144
    ds_read_b128 v[124:127], v14 offset:7168
    ds_read_b128 v[128:131], v14 offset:8192
    ds_read_b128 v[132:135], v14 offset:9216
    s_waitcnt vmcnt(4)
    s_waitcnt lgkmcnt(5)
    v_mfma_f32_16x16x32_bf16 v[156:159], v[96:99], v[16:19], 0
    s_add_u32 s41, s36, 4096
    buffer_load_dwordx4 v[32:35], v6, s[12:15], s41 offen offset:0 sc1
    v_mfma_f32_16x16x32_bf16 v[160:163], v[100:103], v[16:19], 0
    ds_read_b128 v[136:139], v14 offset:10240
    v_mfma_f32_16x16x32_bf16 v[164:167], v[104:107], v[16:19], 0
    ds_read_b128 v[140:143], v14 offset:11264
    v_mfma_f32_16x16x32_bf16 v[168:171], v[108:111], v[16:19], 0
    ds_read_b128 v[144:147], v14 offset:12288
    s_add_u32 s41, s36, 4096
    buffer_load_dwordx4 v[36:39], v6, s[12:15], s41 offen offset:1024 sc1
    v_mfma_f32_16x16x32_bf16 v[172:175], v[112:115], v[16:19], 0
    ds_read_b128 v[148:151], v14 offset:13312
    ds_read_b128 v[152:155], v14 offset:14336
    s_waitcnt vmcnt(5)
    s_waitcnt lgkmcnt(5)
    v_mfma_f32_16x16x32_bf16 v[156:159], v[116:119], v[20:23], v[156:159]
    s_add_u32 s41, s36, 4096
    buffer_load_dwordx4 v[40:43], v6, s[12:15], s41 offen offset:2048 sc1
    v_mfma_f32_16x16x32_bf16 v[160:163], v[120:123], v[20:23], v[160:163]
    ds_read_b128 v[96:99], v14 offset:15360
    v_mfma_f32_16x16x32_bf16 v[164:167], v[124:127], v[20:23], v[164:167]
    ds_read_b128 v[100:103], v14 offset:16384
    v_mfma_f32_16x16x32_bf16 v[168:171], v[128:131], v[20:23], v[168:171]
    ds_read_b128 v[104:107], v14 offset:17408
    s_add_u32 s41, s36, 4096
    buffer_load_dwordx4 v[44:47], v6, s[12:15], s41 offen offset:3072 sc1
    v_mfma_f32_16x16x32_bf16 v[172:175], v[132:135], v[20:23], v[172:175]
    ds_read_b128 v[108:111], v14 offset:18432
    ds_read_b128 v[112:115], v14 offset:19456
    s_waitcnt vmcnt(6)
    s_waitcnt lgkmcnt(5)
    v_mfma_f32_16x16x32_bf16 v[156:159], v[136:139], v[24:27], v[156:159]
    s_add_u32 s41, s36, 8192
    buffer_load_dwordx4 v[48:51], v6, s[12:15], s41 offen offset:0 sc1
    v_mfma_f32_16x16x32_bf16 v[160:163], v[140:143], v[24:27], v[160:163]
    ds_read_b128 v[116:119], v14 offset:20480
    v_mfma_f32_16x16x32_bf16 v[164:167], v[144:147], v[24:27], v[164:167]
    ds_read_b128 v[120:123], v14 offset:21504
    v_mfma_f32_16x16x32_bf16 v[168:171], v[148:151], v[24:27], v[168:171]
    ds_read_b128 v[124:127], v14 offset:22528
    s_add_u32 s41, s36, 8192
    buffer_load_dwordx4 v[52:55], v6, s[12:15], s41 offen offset:1024 sc1
    v_mfma_f32_16x16x32_bf16 v[172:175], v[152:155], v[24:27], v[172:175]
    ds_read_b128 v[128:131], v14 offset:23552
    ds_read_b128 v[132:135], v14 offset:24576
    s_waitcnt vmcnt(7)
    s_waitcnt lgkmcnt(5)
    v_mfma_f32_16x16x32_bf16 v[156:159], v[96:99], v[28:31], v[156:159]
    s_add_u32 s41, s36, 8192
    buffer_load_dwordx4 v[56:59], v6, s[12:15], s41 offen offset:2048 sc1
    v_mfma_f32_16x16x32_bf16 v[160:163], v[100:103], v[28:31], v[160:163]
    ds_read_b128 v[136:139], v14 offset:25600
    v_mfma_f32_16x16x32_bf16 v[164:167], v[104:107], v[28:31], v[164:167]
    ds_read_b128 v[140:143], v14 offset:26624
    v_mfma_f32_16x16x32_bf16 v[168:171], v[108:111], v[28:31], v[168:171]
    ds_read_b128 v[144:147], v14 offset:27648
    s_add_u32 s41, s36, 8192
    buffer_load_dwordx4 v[60:63], v6, s[12:15], s41 offen offset:3072 sc1
    v_mfma_f32_16x16x32_bf16 v[172:175], v[112:115], v[28:31], v[172:175]
    ds_read_b128 v[148:151], v14 offset:28672
    ds_read_b128 v[152:155], v14 offset:29696
    s_waitcnt vmcnt(7)
    s_waitcnt lgkmcnt(5)
    v_mfma_f32_16x16x32_bf16 v[156:159], v[116:119], v[32:35], v[156:159]
    s_add_u32 s41, s36, 12288
    buffer_load_dwordx4 v[64:67], v6, s[12:15], s41 offen offset:0 sc1
    v_mfma_f32_16x16x32_bf16 v[160:163], v[120:123], v[32:35], v[160:163]
    ds_read_b128 v[96:99], v14 offset:30720
    v_mfma_f32_16x16x32_bf16 v[164:167], v[124:127], v[32:35], v[164:167]
    ds_read_b128 v[100:103], v14 offset:31744
    v_mfma_f32_16x16x32_bf16 v[168:171], v[128:131], v[32:35], v[168:171]
    ds_read_b128 v[104:107], v14 offset:32768
    s_add_u32 s41, s36, 12288
    buffer_load_dwordx4 v[68:71], v6, s[12:15], s41 offen offset:1024 sc1
    v_mfma_f32_16x16x32_bf16 v[172:175], v[132:135], v[32:35], v[172:175]
    ds_read_b128 v[108:111], v14 offset:33792
    ds_read_b128 v[112:115], v14 offset:34816
    s_waitcnt vmcnt(8)
    s_waitcnt lgkmcnt(5)
    v_mfma_f32_16x16x32_bf16 v[156:159], v[136:139], v[36:39], v[156:159]
    s_add_u32 s41, s36, 12288
    buffer_load_dwordx4 v[72:75], v6, s[12:15], s41 offen offset:2048 sc1
    v_mfma_f32_16x16x32_bf16 v[160:163], v[140:143], v[36:39], v[160:163]
    ds_read_b128 v[116:119], v14 offset:35840
    v_mfma_f32_16x16x32_bf16 v[164:167], v[144:147], v[36:39], v[164:167]
    ds_read_b128 v[120:123], v14 offset:36864
    v_mfma_f32_16x16x32_bf16 v[168:171], v[148:151], v[36:39], v[168:171]
    ds_read_b128 v[124:127], v14 offset:37888
    s_add_u32 s41, s36, 12288
    buffer_load_dwordx4 v[76:79], v6, s[12:15], s41 offen offset:3072 sc1
    v_mfma_f32_16x16x32_bf16 v[172:175], v[152:155], v[36:39], v[172:175]
    ds_read_b128 v[128:131], v14 offset:38912
    ds_read_b128 v[132:135], v14 offset:39936
    s_waitcnt vmcnt(9)
    s_waitcnt lgkmcnt(5)
    v_mfma_f32_16x16x32_bf16 v[156:159], v[96:99], v[40:43], v[156:159]
    s_add_u32 s41, s36, 16384
    buffer_load_dwordx4 v[80:83], v6, s[12:15], s41 offen offset:0 sc1
    v_mfma_f32_16x16x32_bf16 v[160:163], v[100:103], v[40:43], v[160:163]
    ds_read_b128 v[136:139], v14 offset:40960
    v_mfma_f32_16x16x32_bf16 v[164:167], v[104:107], v[40:43], v[164:167]
    ds_read_b128 v[140:143], v14 offset:41984
    v_mfma_f32_16x16x32_bf16 v[168:171], v[108:111], v[40:43], v[168:171]
    ds_read_b128 v[144:147], v14 offset:43008
    s_add_u32 s41, s36, 16384
    buffer_load_dwordx4 v[84:87], v6, s[12:15], s41 offen offset:1024 sc1
    v_mfma_f32_16x16x32_bf16 v[172:175], v[112:115], v[40:43], v[172:175]
    ds_read_b128 v[148:151], v14 offset:44032
    ds_read_b128 v[152:155], v14 offset:45056
    s_waitcnt vmcnt(10)
    s_waitcnt lgkmcnt(5)
    v_mfma_f32_16x16x32_bf16 v[156:159], v[116:119], v[44:47], v[156:159]
    s_add_u32 s41, s36, 16384
    buffer_load_dwordx4 v[88:91], v6, s[12:15], s41 offen offset:2048 sc1
    v_mfma_f32_16x16x32_bf16 v[160:163], v[120:123], v[44:47], v[160:163]
    ds_read_b128 v[96:99], v14 offset:46080
    v_mfma_f32_16x16x32_bf16 v[164:167], v[124:127], v[44:47], v[164:167]
    ds_read_b128 v[100:103], v14 offset:47104
    v_mfma_f32_16x16x32_bf16 v[168:171], v[128:131], v[44:47], v[168:171]
    ds_read_b128 v[104:107], v14 offset:48128
    s_add_u32 s41, s36, 16384
    buffer_load_dwordx4 v[92:95], v6, s[12:15], s41 offen offset:3072 sc1
    v_mfma_f32_16x16x32_bf16 v[172:175], v[132:135], v[44:47], v[172:175]
    ds_read_b128 v[108:111], v14 offset:49152
    ds_read_b128 v[112:115], v14 offset:50176
    s_waitcnt vmcnt(11)
    s_waitcnt lgkmcnt(5)
    v_mfma_f32_16x16x32_bf16 v[156:159], v[136:139], v[48:51], v[156:159]
    v_mfma_f32_16x16x32_bf16 v[160:163], v[140:143], v[48:51], v[160:163]
    ds_read_b128 v[116:119], v14 offset:51200
    s_mov_b32 m0, s38
    s_nop 0
    buffer_load_dwordx4 v2, s[12:15], s39 offen offset:0 lds
    v_mfma_f32_16x16x32_bf16 v[164:167], v[144:147], v[48:51], v[164:167]
    ds_read_b128 v[120:123], v14 offset:52224
    v_mfma_f32_16x16x32_bf16 v[168:171], v[148:151], v[48:51], v[168:171]
    ds_read_b128 v[124:127], v14 offset:53248
    v_mfma_f32_16x16x32_bf16 v[172:175], v[152:155], v[48:51], v[172:175]
    ds_read_b128 v[128:131], v14 offset:54272
    ds_read_b128 v[132:135], v14 offset:55296
    s_add_u32 s41, s20, 0
    buffer_store_dwordx4 v[220:223], v2, s[12:15], s41 offen sc1
    s_waitcnt vmcnt(12)
    s_waitcnt lgkmcnt(5)
    s_barrier
    v_mfma_f32_16x16x32_bf16 v[156:159], v[96:99], v[52:55], v[156:159]
    v_mfma_f32_16x16x32_bf16 v[160:163], v[100:103], v[52:55], v[160:163]
    ds_read_b128 v[136:139], v14 offset:56320
    s_mov_b32 m0, s38
    s_nop 0
    buffer_load_dwordx4 v2, s[12:15], s39 offen offset:1024 lds
    v_mfma_f32_16x16x32_bf16 v[164:167], v[104:107], v[52:55], v[164:167]
    ds_read_b128 v[140:143], v14 offset:57344
    v_mfma_f32_16x16x32_bf16 v[168:171], v[108:111], v[52:55], v[168:171]
    ds_read_b128 v[144:147], v14 offset:58368
    v_mfma_f32_16x16x32_bf16 v[172:175], v[112:115], v[52:55], v[172:175]
    ds_read_b128 v[148:151], v14 offset:59392
    ds_read_b128 v[152:155], v14 offset:60416
    s_add_u32 s41, s20, 1024
    buffer_store_dwordx4 v[224:227], v2, s[12:15], s41 offen sc1
    s_waitcnt vmcnt(13)
    s_waitcnt lgkmcnt(5)
    v_mfma_f32_16x16x32_bf16 v[156:159], v[116:119], v[56:59], v[156:159]
    v_mfma_f32_16x16x32_bf16 v[160:163], v[120:123], v[56:59], v[160:163]
    ds_read_b128 v[96:99], v14 offset:61440
    s_mov_b32 m0, s38
    s_nop 0
    buffer_load_dwordx4 v2, s[12:15], s39 offen offset:2048 lds
    v_mfma_f32_16x16x32_bf16 v[164:167], v[124:127], v[56:59], v[164:167]
    ds_read_b128 v[100:103], v14 offset:62464
    v_mfma_f32_16x16x32_bf16 v[168:171], v[128:131], v[56:59], v[168:171]
    ds_read_b128 v[104:107], v14 offset:63488
    v_mfma_f32_16x16x32_bf16 v[172:175], v[132:135], v[56:59], v[172:175]
    ds_read_b128 v[108:111], v14 offset:64512
    ds_read_b128 v[112:115], v15 offset:0
    s_add_u32 s41, s20, 2048
    buffer_store_dwordx4 v[228:231], v2, s[12:15], s41 offen sc1
    s_waitcnt vmcnt(14)
    s_waitcnt lgkmcnt(5)
    v_mfma_f32_16x16x32_bf16 v[156:159], v[136:139], v[60:63], v[156:159]
    v_mfma_f32_16x16x32_bf16 v[160:163], v[140:143], v[60:63], v[160:163]
    ds_read_b128 v[116:119], v15 offset:1024
    s_mov_b32 m0, s38
    s_nop 0
    buffer_load_dwordx4 v2, s[12:15], s39 offen offset:3072 lds
    s_add_u32 s38, s38, 4096
    s_add_u32 s39, s39, 4096
    v_mfma_f32_16x16x32_bf16 v[164:167], v[144:147], v[60:63], v[164:167]
    ds_read_b128 v[120:123], v15 offset:2048
    v_mfma_f32_16x16x32_bf16 v[168:171], v[148:151], v[60:63], v[168:171]
    ds_read_b128 v[124:127], v15 offset:3072
    v_mfma_f32_16x16x32_bf16 v[172:175], v[152:155], v[60:63], v[172:175]
    ds_read_b128 v[128:131], v15 offset:4096
    ds_read_b128 v[132:135], v15 offset:5120
    s_add_u32 s41, s20, 3072
    buffer_store_dwordx4 v[232:235], v2, s[12:15], s41 offen sc1
    s_waitcnt vmcnt(15)
    s_waitcnt lgkmcnt(5)
    v_mfma_f32_16x16x32_bf16 v[156:159], v[96:99], v[64:67], v[156:159]
    v_mfma_f32_16x16x32_bf16 v[160:163], v[100:103], v[64:67], v[160:163]
    ds_read_b128 v[136:139], v15 offset:6144
    s_mov_b32 m0, s38
    s_nop 0
    buffer_load_dwordx4 v2, s[12:15], s39 offen offset:0 lds
    v_mfma_f32_16x16x32_bf16 v[164:167], v[104:107], v[64:67], v[164:167]
    ds_read_b128 v[140:143], v15 offset:7168
    v_mfma_f32_16x16x32_bf16 v[168:171], v[108:111], v[64:67], v[168:171]
    ds_read_b128 v[144:147], v15 offset:8192
    v_mfma_f32_16x16x32_bf16 v[172:175], v[112:115], v[64:67], v[172:175]
    ds_read_b128 v[148:151], v15 offset:9216
    ds_read_b128 v[152:155], v15 offset:10240
    s_add_u32 s41, s20, 4096
    buffer_store_dwordx4 v[236:239], v2, s[12:15], s41 offen sc1
    s_waitcnt vmcnt(16)
    s_waitcnt lgkmcnt(5)
    v_mfma_f32_16x16x32_bf16 v[156:159], v[116:119], v[68:71], v[156:159]
    v_mfma_f32_16x16x32_bf16 v[160:163], v[120:123], v[68:71], v[160:163]
    ds_read_b128 v[96:99], v15 offset:11264
    s_mov_b32 m0, s38
    s_nop 0
    buffer_load_dwordx4 v2, s[12:15], s39 offen offset:1024 lds
    v_mfma_f32_16x16x32_bf16 v[164:167], v[124:127], v[68:71], v[164:167]
    ds_read_b128 v[100:103], v15 offset:12288
    v_mfma_f32_16x16x32_bf16 v[168:171], v[128:131], v[68:71], v[168:171]
    ds_read_b128 v[104:107], v15 offset:13312
    v_mfma_f32_16x16x32_bf16 v[172:175], v[132:135], v[68:71], v[172:175]
    ds_read_b128 v[108:111], v15 offset:14336
    ds_read_b128 v[112:115], v15 offset:15360
    s_mov_b32 m0, s38
    s_nop 0
    buffer_load_dwordx4 v2, s[12:15], s39 offen offset:2048 lds
    s_waitcnt vmcnt(17)
    s_waitcnt lgkmcnt(5)
    v_mfma_f32_16x16x32_bf16 v[156:159], v[136:139], v[72:75], v[156:159]
    v_mfma_f32_16x16x32_bf16 v[160:163], v[140:143], v[72:75], v[160:163]
    ds_read_b128 v[116:119], v15 offset:16384
    s_mov_b32 m0, s38
    s_nop 0
    buffer_load_dwordx4 v2, s[12:15], s39 offen offset:3072 lds
    s_add_u32 s38, s38, 4096
    s_add_u32 s39, s39, 4096
    v_mfma_f32_16x16x32_bf16 v[164:167], v[144:147], v[72:75], v[164:167]
    ds_read_b128 v[120:123], v15 offset:17408
    v_mfma_f32_16x16x32_bf16 v[168:171], v[148:151], v[72:75], v[168:171]
    ds_read_b128 v[124:127], v15 offset:18432
    v_mfma_f32_16x16x32_bf16 v[172:175], v[152:155], v[72:75], v[172:175]
    ds_read_b128 v[128:131], v15 offset:19456
    ds_read_b128 v[132:135], v15 offset:20480
    s_mov_b32 m0, s38
    s_nop 0
    buffer_load_dwordx4 v2, s[12:15], s39 offen offset:0 lds
    s_waitcnt vmcnt(18)
    s_waitcnt lgkmcnt(5)
    v_mfma_f32_16x16x32_bf16 v[156:159], v[96:99], v[76:79], v[156:159]
    v_mfma_f32_16x16x32_bf16 v[160:163], v[100:103], v[76:79], v[160:163]
    ds_read_b128 v[136:139], v15 offset:21504
    s_mov_b32 m0, s38
    s_nop 0
    buffer_load_dwordx4 v2, s[12:15], s39 offen offset:1024 lds
    v_mfma_f32_16x16x32_bf16 v[164:167], v[104:107], v[76:79], v[164:167]
    ds_read_b128 v[140:143], v15 offset:22528
    v_mfma_f32_16x16x32_bf16 v[168:171], v[108:111], v[76:79], v[168:171]
    ds_read_b128 v[144:147], v15 offset:23552
    v_mfma_f32_16x16x32_bf16 v[172:175], v[112:115], v[76:79], v[172:175]
    ds_read_b128 v[148:151], v15 offset:24576
    ds_read_b128 v[152:155], v15 offset:25600
    s_mov_b32 m0, s38
    s_nop 0
    buffer_load_dwordx4 v2, s[12:15], s39 offen offset:2048 lds
    s_waitcnt vmcnt(19)
    s_waitcnt lgkmcnt(5)
    v_mfma_f32_16x16x32_bf16 v[156:159], v[116:119], v[80:83], v[156:159]
    v_mfma_f32_16x16x32_bf16 v[160:163], v[120:123], v[80:83], v[160:163]
    ds_read_b128 v[96:99], v15 offset:26624
    s_mov_b32 m0, s38
    s_nop 0
    buffer_load_dwordx4 v2, s[12:15], s39 offen offset:3072 lds
    s_add_u32 s38, s38, 4096
    s_add_u32 s39, s39, 4096
    v_mfma_f32_16x16x32_bf16 v[164:167], v[124:127], v[80:83], v[164:167]
    ds_read_b128 v[100:103], v15 offset:27648
    v_mfma_f32_16x16x32_bf16 v[168:171], v[128:131], v[80:83], v[168:171]
    ds_read_b128 v[104:107], v15 offset:28672
    v_mfma_f32_16x16x32_bf16 v[172:175], v[132:135], v[80:83], v[172:175]
    ds_read_b128 v[108:111], v15 offset:29696
    ds_read_b128 v[112:115], v15 offset:30720
    s_mov_b32 m0, s38
    s_nop 0
    buffer_load_dwordx4 v2, s[12:15], s39 offen offset:0 lds
    s_waitcnt vmcnt(20)
    s_waitcnt lgkmcnt(5)
    v_mfma_f32_16x16x32_bf16 v[156:159], v[136:139], v[84:87], v[156:159]
    v_mfma_f32_16x16x32_bf16 v[160:163], v[140:143], v[84:87], v[160:163]
    ds_read_b128 v[116:119], v15 offset:31744
    s_mul_i32 s38, s30, 12288
    s_add_u32 s39, s38, s44
    s_add_u32 s39, s39, 8962048
    s_add_u32 s38, s38, 0
    s_mov_b32 m0, s38
    s_nop 0
    buffer_load_dwordx4 v2, s[12:15], s39 offen offset:0 lds
    v_mfma_f32_16x16x32_bf16 v[164:167], v[144:147], v[84:87], v[164:167]
    ds_read_b128 v[120:123], v15 offset:32768
    v_mfma_f32_16x16x32_bf16 v[168:171], v[148:151], v[84:87], v[168:171]
    ds_read_b128 v[124:127], v15 offset:33792
    v_mfma_f32_16x16x32_bf16 v[172:175], v[152:155], v[84:87], v[172:175]
    ds_read_b128 v[128:131], v15 offset:34816
    ds_read_b128 v[132:135], v15 offset:35840
    s_mov_b32 m0, s38
    s_nop 0
    buffer_load_dwordx4 v2, s[12:15], s39 offen offset:1024 lds
    s_waitcnt vmcnt(21)
    s_waitcnt lgkmcnt(5)
    v_mfma_f32_16x16x32_bf16 v[156:159], v[96:99], v[88:91], v[156:159]
    v_mfma_f32_16x16x32_bf16 v[160:163], v[100:103], v[88:91], v[160:163]
    s_mov_b32 m0, s38
    s_nop 0
    buffer_load_dwordx4 v2, s[12:15], s39 offen offset:2048 lds
    v_mfma_f32_16x16x32_bf16 v[164:167], v[104:107], v[88:91], v[164:167]
    v_mfma_f32_16x16x32_bf16 v[168:171], v[108:111], v[88:91], v[168:171]
    v_mfma_f32_16x16x32_bf16 v[172:175], v[112:115], v[88:91], v[172:175]
    s_mov_b32 m0, s38
    s_nop 0
    buffer_load_dwordx4 v2, s[12:15], s39 offen offset:3072 lds
    s_add_u32 s38, s38, 4096
    s_add_u32 s39, s39, 4096
    s_waitcnt vmcnt(22)
    s_waitcnt lgkmcnt(0)
    v_mfma_f32_16x16x32_bf16 v[156:159], v[116:119], v[92:95], v[156:159]
    v_mfma_f32_16x16x32_bf16 v[160:163], v[120:123], v[92:95], v[160:163]
    s_mov_b32 m0, s38
    s_nop 0
    buffer_load_dwordx4 v2, s[12:15], s39 offen offset:0 lds
    v_mfma_f32_16x16x32_bf16 v[164:167], v[124:127], v[92:95], v[164:167]
    v_mfma_f32_16x16x32_bf16 v[168:171], v[128:131], v[92:95], v[168:171]
    v_mfma_f32_16x16x32_bf16 v[172:175], v[132:135], v[92:95], v[172:175]
    s_mov_b32 m0, s38
    s_nop 0
    buffer_load_dwordx4 v2, s[12:15], s39 offen offset:1024 lds
    s_barrier
    s_mov_b32 m0, s38
    s_nop 0
    buffer_load_dwordx4 v2, s[12:15], s39 offen offset:2048 lds
    s_mov_b32 m0, s38
    s_nop 0
    buffer_load_dwordx4 v2, s[12:15], s39 offen offset:3072 lds
    s_add_u32 s38, s38, 4096
    s_add_u32 s39, s39, 4096
    s_mov_b32 m0, s38
    s_nop 0
    buffer_load_dwordx4 v2, s[12:15], s39 offen offset:0 lds
    s_mov_b32 m0, s38
    s_nop 0
    buffer_load_dwordx4 v2, s[12:15], s39 offen offset:1024 lds
    s_mov_b32 m0, s38
    s_nop 0
    buffer_load_dwordx4 v2, s[12:15], s39 offen offset:2048 lds
    s_mov_b32 m0, s38
    s_nop 0
    buffer_load_dwordx4 v2, s[12:15], s39 offen offset:3072 lds
    s_mul_i32 s38, s30, 13312
    s_add_u32 s39, s38, s45
    s_add_u32 s39, s39, 0
    s_add_u32 s38, s38, 49152
    s_mov_b32 m0, s38
    s_nop 0
    buffer_load_dwordx4 v2, s[12:15], s39 offen offset:0 lds
    s_mov_b32 m0, s38
    s_nop 0
    buffer_load_dwordx4 v2, s[12:15], s39 offen offset:1024 lds
    s_mov_b32 m0, s38
    s_nop 0
    buffer_load_dwordx4 v2, s[12:15], s39 offen offset:2048 lds
    s_mov_b32 m0, s38
    s_nop 0
    buffer_load_dwordx4 v2, s[12:15], s39 offen offset:3072 lds
    s_add_u32 s38, s38, 4096
    s_add_u32 s39, s39, 4096
    s_mov_b32 m0, s38
    s_nop 0
    buffer_load_dwordx4 v2, s[12:15], s39 offen offset:0 lds
    s_mov_b32 m0, s38
    s_nop 0
    buffer_load_dwordx4 v2, s[12:15], s39 offen offset:1024 lds
    s_mov_b32 m0, s38
    s_nop 0
    buffer_load_dwordx4 v2, s[12:15], s39 offen offset:2048 lds
    s_mov_b32 m0, s38
    s_nop 0
    buffer_load_dwordx4 v2, s[12:15], s39 offen offset:3072 lds
    s_add_u32 s38, s38, 4096
    s_add_u32 s39, s39, 4096
    s_mov_b32 m0, s38
    s_nop 0
    buffer_load_dwordx4 v2, s[12:15], s39 offen offset:0 lds
    s_mov_b32 m0, s38
    s_nop 0
    buffer_load_dwordx4 v2, s[12:15], s39 offen offset:1024 lds
    s_mov_b32 m0, s38
    s_nop 0
    buffer_load_dwordx4 v2, s[12:15], s39 offen offset:2048 lds
    s_mov_b32 m0, s38
    s_nop 0
    buffer_load_dwordx4 v2, s[12:15], s39 offen offset:3072 lds
    s_add_u32 s38, s38, 4096
    s_add_u32 s39, s39, 4096
    s_mov_b32 m0, s38
    s_nop 0
    buffer_load_dwordx4 v2, s[12:15], s39 offen offset:0 lds
    v_lshlrev_b32 v9, 4, v3
    v_add_u32 v9, 155648, v9
    v_mov_b32 v12, 0xbdd2d3e8
    v_mov_b32 v13, 0xc0135761
    ds_read_b128 v[180:183], v9 offset:0
    ds_read_b128 v[200:203], v9 offset:512
    ds_read_b128 v[184:187], v9 offset:64
    ds_read_b128 v[204:207], v9 offset:576
    ds_read_b128 v[188:191], v9 offset:128
    ds_read_b128 v[208:211], v9 offset:640
    ds_read_b128 v[192:195], v9 offset:192
    ds_read_b128 v[212:215], v9 offset:704
    ds_read_b128 v[196:199], v9 offset:256
    ds_read_b128 v[216:219], v9 offset:768
    s_waitcnt lgkmcnt(0)
    v_pk_add_f32 v[180:181], v[180:181], v[200:201]
    v_pk_add_f32 v[182:183], v[182:183], v[202:203]
    v_pk_add_f32 v[184:185], v[184:185], v[204:205]
    v_pk_add_f32 v[186:187], v[186:187], v[206:207]
    v_pk_add_f32 v[188:189], v[188:189], v[208:209]
    v_pk_add_f32 v[190:191], v[190:191], v[210:211]
    v_pk_add_f32 v[192:193], v[192:193], v[212:213]
    v_pk_add_f32 v[194:195], v[194:195], v[214:215]
    v_pk_add_f32 v[196:197], v[196:197], v[216:217]
    v_pk_add_f32 v[198:199], v[198:199], v[218:219]
    v_pk_mul_f32 v[200:201], v[180:181], v[176:177] op_sel_hi:[1,0]
    v_pk_mul_f32 v[202:203], v[182:183], v[176:177] op_sel_hi:[1,0]
    v_pk_mul_f32 v[204:205], v[184:185], v[176:177] op_sel_hi:[1,0]
    v_pk_mul_f32 v[206:207], v[186:187], v[176:177] op_sel_hi:[1,0]
    v_pk_mul_f32 v[208:209], v[188:189], v[176:177] op_sel_hi:[1,0]
    v_pk_mul_f32 v[210:211], v[190:191], v[176:177] op_sel_hi:[1,0]
    v_pk_mul_f32 v[212:213], v[192:193], v[176:177] op_sel_hi:[1,0]
    v_pk_mul_f32 v[214:215], v[194:195], v[176:177] op_sel_hi:[1,0]
    v_pk_mul_f32 v[216:217], v[196:197], v[176:177] op_sel_hi:[1,0]
    v_pk_mul_f32 v[218:219], v[198:199], v[176:177] op_sel_hi:[1,0]
    v_pk_fma_f32 v[156:157], v[156:157], v[176:177], v[200:201] op_sel:[0,1,0] op_sel_hi:[1,1,1]
    v_pk_fma_f32 v[158:159], v[158:159], v[176:177], v[202:203] op_sel:[0,1,0] op_sel_hi:[1,1,1]
    v_pk_fma_f32 v[160:161], v[160:161], v[176:177], v[204:205] op_sel:[0,1,0] op_sel_hi:[1,1,1]
    v_pk_fma_f32 v[162:163], v[162:163], v[176:177], v[206:207] op_sel:[0,1,0] op_sel_hi:[1,1,1]
    v_pk_fma_f32 v[164:165], v[164:165], v[176:177], v[208:209] op_sel:[0,1,0] op_sel_hi:[1,1,1]
    v_pk_fma_f32 v[166:167], v[166:167], v[176:177], v[210:211] op_sel:[0,1,0] op_sel_hi:[1,1,1]
    v_pk_fma_f32 v[168:169], v[168:169], v[176:177], v[212:213] op_sel:[0,1,0] op_sel_hi:[1,1,1]
    v_pk_fma_f32 v[170:171], v[170:171], v[176:177], v[214:215] op_sel:[0,1,0] op_sel_hi:[1,1,1]
    v_pk_fma_f32 v[172:173], v[172:173], v[176:177], v[216:217] op_sel:[0,1,0] op_sel_hi:[1,1,1]
    v_pk_fma_f32 v[174:175], v[174:175], v[176:177], v[218:219] op_sel:[0,1,0] op_sel_hi:[1,1,1]
    v_pk_mul_f32 v[200:201], v[156:157], v[156:157]
    v_pk_mul_f32 v[202:203], v[158:159], v[158:159]
    v_pk_mul_f32 v[204:205], v[160:161], v[160:161]
    v_pk_mul_f32 v[206:207], v[162:163], v[162:163]
    v_pk_mul_f32 v[208:209], v[164:165], v[164:165]
    v_pk_mul_f32 v[210:211], v[166:167], v[166:167]
    v_pk_mul_f32 v[212:213], v[168:169], v[168:169]
    v_pk_mul_f32 v[214:215], v[170:171], v[170:171]
    v_pk_mul_f32 v[216:217], v[172:173], v[172:173]
    v_pk_mul_f32 v[218:219], v[174:175], v[174:175]
    v_pk_fma_f32 v[200:201], v[200:201], v[12:13], v[12:13] op_sel:[0,0,1] op_sel_hi:[1,0,1]
    v_pk_fma_f32 v[202:203], v[202:203], v[12:13], v[12:13] op_sel:[0,0,1] op_sel_hi:[1,0,1]
    v_pk_fma_f32 v[204:205], v[204:205], v[12:13], v[12:13] op_sel:[0,0,1] op_sel_hi:[1,0,1]
    v_pk_fma_f32 v[206:207], v[206:207], v[12:13], v[12:13] op_sel:[0,0,1] op_sel_hi:[1,0,1]
    v_pk_fma_f32 v[208:209], v[208:209], v[12:13], v[12:13] op_sel:[0,0,1] op_sel_hi:[1,0,1]
    v_pk_fma_f32 v[210:211], v[210:211], v[12:13], v[12:13] op_sel:[0,0,1] op_sel_hi:[1,0,1]
    v_pk_fma_f32 v[212:213], v[212:213], v[12:13], v[12:13] op_sel:[0,0,1] op_sel_hi:[1,0,1]
    v_pk_fma_f32 v[214:215], v[214:215], v[12:13], v[12:13] op_sel:[0,0,1] op_sel_hi:[1,0,1]
    v_pk_fma_f32 v[216:217], v[216:217], v[12:13], v[12:13] op_sel:[0,0,1] op_sel_hi:[1,0,1]
    v_pk_fma_f32 v[218:219], v[218:219], v[12:13], v[12:13] op_sel:[0,0,1] op_sel_hi:[1,0,1]
    v_pk_mul_f32 v[200:201], v[200:201], v[156:157]
    v_pk_mul_f32 v[202:203], v[202:203], v[158:159]
    v_pk_mul_f32 v[204:205], v[204:205], v[160:161]
    v_pk_mul_f32 v[206:207], v[206:207], v[162:163]
    v_pk_mul_f32 v[208:209], v[208:209], v[164:165]
    v_pk_mul_f32 v[210:211], v[210:211], v[166:167]
    v_pk_mul_f32 v[212:213], v[212:213], v[168:169]
    v_pk_mul_f32 v[214:215], v[214:215], v[170:171]
    v_pk_mul_f32 v[216:217], v[216:217], v[172:173]
    v_pk_mul_f32 v[218:219], v[218:219], v[174:175]
    v_exp_f32 v200, v200
    v_exp_f32 v201, v201
    v_exp_f32 v202, v202
    v_exp_f32 v203, v203
    v_exp_f32 v204, v204
    v_exp_f32 v205, v205
    v_exp_f32 v206, v206
    v_exp_f32 v207, v207
    v_exp_f32 v208, v208
    v_exp_f32 v209, v209
    v_exp_f32 v210, v210
    v_exp_f32 v211, v211
    v_exp_f32 v212, v212
    v_exp_f32 v213, v213
    v_exp_f32 v214, v214
    v_exp_f32 v215, v215
    v_exp_f32 v216, v216
    v_exp_f32 v217, v217
    v_exp_f32 v218, v218
    v_exp_f32 v219, v219
    v_pk_add_f32 v[200:201], v[200:201], 1.0 op_sel_hi:[1,0]
    v_pk_add_f32 v[202:203], v[202:203], 1.0 op_sel_hi:[1,0]
    v_pk_add_f32 v[204:205], v[204:205], 1.0 op_sel_hi:[1,0]
    v_pk_add_f32 v[206:207], v[206:207], 1.0 op_sel_hi:[1,0]
    v_pk_add_f32 v[208:209], v[208:209], 1.0 op_sel_hi:[1,0]
    v_pk_add_f32 v[210:211], v[210:211], 1.0 op_sel_hi:[1,0]
    v_pk_add_f32 v[212:213], v[212:213], 1.0 op_sel_hi:[1,0]
    v_pk_add_f32 v[214:215], v[214:215], 1.0 op_sel_hi:[1,0]
    v_pk_add_f32 v[216:217], v[216:217], 1.0 op_sel_hi:[1,0]
    v_pk_add_f32 v[218:219], v[218:219], 1.0 op_sel_hi:[1,0]
    v_rcp_f32 v200, v200
    v_rcp_f32 v201, v201
    v_rcp_f32 v202, v202
    v_rcp_f32 v203, v203
    v_rcp_f32 v204, v204
    v_rcp_f32 v205, v205
    v_rcp_f32 v206, v206
    v_rcp_f32 v207, v207
    v_rcp_f32 v208, v208
    v_rcp_f32 v209, v209
    v_rcp_f32 v210, v210
    v_rcp_f32 v211, v211
    v_rcp_f32 v212, v212
    v_rcp_f32 v213, v213
    v_rcp_f32 v214, v214
    v_rcp_f32 v215, v215
    v_rcp_f32 v216, v216
    v_rcp_f32 v217, v217
    v_rcp_f32 v218, v218
    v_rcp_f32 v219, v219
    s_nop 0
    v_pk_mul_f32 v[156:157], v[156:157], v[200:201]
    v_pk_mul_f32 v[158:159], v[158:159], v[202:203]
    v_pk_mul_f32 v[160:161], v[160:161], v[204:205]
    v_pk_mul_f32 v[162:163], v[162:163], v[206:207]
    v_pk_mul_f32 v[164:165], v[164:165], v[208:209]
    v_pk_mul_f32 v[166:167], v[166:167], v[210:211]
    v_pk_mul_f32 v[168:169], v[168:169], v[212:213]
    v_pk_mul_f32 v[170:171], v[170:171], v[214:215]
    v_pk_mul_f32 v[172:173], v[172:173], v[216:217]
    v_pk_mul_f32 v[174:175], v[174:175], v[218:219]
    v_cvt_pk_bf16_f32 v156, v156, v157
    v_cvt_pk_bf16_f32 v157, v158, v159
    v_cvt_pk_bf16_f32 v158, v160, v161
    v_cvt_pk_bf16_f32 v159, v162, v163
    v_cvt_pk_bf16_f32 v164, v164, v165
    v_cvt_pk_bf16_f32 v165, v166, v167
    v_cvt_pk_bf16_f32 v166, v168, v169
    v_cvt_pk_bf16_f32 v167, v170, v171
    v_cvt_pk_bf16_f32 v172, v172, v173
    v_cvt_pk_bf16_f32 v173, v174, v175
    s_nop 1
    v_permlane16_swap_b32 v156, v158
    v_permlane16_swap_b32 v157, v159
    v_permlane16_swap_b32 v164, v166
    v_permlane16_swap_b32 v165, v167
    s_add_u32 s46, s54, 696320
    s_lshl_b32 s41, s33, 2
    s_add_u32 s49, s55, s41
    s_cmp_eq_u32 s31, 0
    s_cbranch_scc1 k2_kernel_slow18
    buffer_store_dwordx4 v[156:159], v254, s[12:15], s46 offen offset:0
    buffer_store_dwordx4 v[164:167], v254, s[12:15], s46 offen offset:1024
    buffer_store_dwordx2 v[172:173], v8, s[12:15], s46 offen offset:2048
    s_waitcnt vmcnt(0)
    v_mov_b32 v9, 1
    v_mov_b32 v10, 2304
    s_mov_b64 exec, 1
    buffer_store_dword v9, v10, s[12:15], s49 offen
    s_mov_b64 exec, -1
    s_branch k2_kernel_sent19
k2_kernel_slow18:
    buffer_store_dwordx4 v[156:159], v254, s[12:15], s46 offen offset:0 sc1
    buffer_store_dwordx4 v[164:167], v254, s[12:15], s46 offen offset:1024 sc1
    buffer_store_dwordx2 v[172:173], v8, s[12:15], s46 offen offset:2048 sc1
    s_waitcnt vmcnt(0)
    v_mov_b32 v9, 1
    v_mov_b32 v10, 2304
    s_mov_b64 exec, 1
    buffer_store_dword v9, v10, s[12:15], s49 offen sc1
    s_mov_b64 exec, -1
k2_kernel_sent19:
    s_cmp_eq_u32 s21, 0
    s_cbranch_scc1 k2_kernel_xas22
    v_mov_b32 v9, 3
    v_mov_b32 v10, 0
    s_mov_b64 exec, 1
    s_cmp_eq_u32 s31, 0
    s_cbranch_scc1 k2_kernel_xas20
    buffer_store_dword v9, v10, s[12:15], s21 offen
    s_branch k2_kernel_xas21
k2_kernel_xas20:
    buffer_store_dword v9, v10, s[12:15], s21 offen sc1
k2_kernel_xas21:
    s_mov_b64 exec, -1
k2_kernel_xas22:
    s_sub_u32 s41, s55, s37
    s_lshr_b32 s41, s41, 7
    v_bfe_u32 v7, v1, 3, 2
    v_min_u32 v7, 2, v7
    v_add_u32 v7, s41, v7
    v_subrev_u32 v7, 1, v7
    v_max_i32 v7, 0, v7
    v_min_i32 v7, 15, v7
    v_lshlrev_b32 v7, 7, v7
    v_and_b32 v9, 7, v1
    v_lshl_add_u32 v7, v9, 2, v7
    s_add_u32 s49, s37, 2304
    s_mov_b32 s43, 200000
k2_kernel_poll23:
    buffer_load_dword v9, v7, s[12:15], s49 offen sc1
    s_waitcnt vmcnt(0)
    v_cmp_ne_u32 vcc, 0, v9
    s_sub_u32 s43, s43, 1
    s_cmp_eq_u64 vcc, -1
    s_cbranch_scc1 k2_kernel_go24
    s_cmp_lg_u32 s43, 0
    s_cbranch_scc1 k2_kernel_poll23
k2_kernel_go24:
    s_mul_i32 s41, s33, 2560
    s_sub_u32 s47, s54, s41
    s_add_u32 s47, s47, 696320
    s_mov_b32 s52, s47
    s_add_u32 s41, s52, 0
    buffer_load_dwordx4 v[16:19], v2, s[12:15], s41 offen offset:0 sc1
    s_add_u32 s41, s52, 0
    buffer_load_dwordx4 v[20:23], v2, s[12:15], s41 offen offset:1024 sc1
    s_add_u32 s41, s52, 0
    buffer_load_dwordx4 v[24:27], v2, s[12:15], s41 offen offset:2048 sc1
    s_add_u32 s41, s52, 0
    buffer_load_dwordx4 v[28:31], v2, s[12:15], s41 offen offset:3072 sc1
    s_add_u32 s41, s54, 20480
    s_mov_b32 s48, s41
    s_sub_u32 s41, s55, s37
    s_lshl_b32 s41, s41, 3
    s_add_u32 s46, s41, s36
    s_add_u32 s46, s46, 1908736
    s_barrier
    ds_read_b128 v[96:99], v15 offset:36864
    ds_read_b128 v[100:103], v15 offset:37888
    ds_read_b128 v[104:107], v15 offset:38912
    ds_read_b128 v[108:111], v15 offset:39936
    ds_read_b128 v[112:115], v15 offset:40960
    ds_read_b128 v[116:119], v15 offset:41984
    ds_read_b128 v[120:123], v15 offset:43008
    ds_read_b128 v[124:127], v15 offset:44032
    ds_read_b128 v[128:131], v15 offset:45056
    ds_read_b128 v[132:135], v15 offset:46080
    s_waitcnt vmcnt(3)
    s_waitcnt lgkmcnt(5)
    v_mfma_f32_16x16x32_bf16 v[156:159], v[96:99], v[16:19], 0
    s_add_u32 s41, s52, 4096
    buffer_load_dwordx4 v[32:35], v2, s[12:15], s41 offen offset:0 sc1
    v_mfma_f32_16x16x32_bf16 v[160:163], v[100:103], v[16:19], 0
    ds_read_b128 v[136:139], v15 offset:47104
    v_mfma_f32_16x16x32_bf16 v[164:167], v[104:107], v[16:19], 0
    ds_read_b128 v[140:143], v15 offset:48128
    v_mfma_f32_16x16x32_bf16 v[168:171], v[108:111], v[16:19], 0
    ds_read_b128 v[144:147], v15 offset:49152
    s_add_u32 s41, s52, 4096
    buffer_load_dwordx4 v[36:39], v2, s[12:15], s41 offen offset:1024 sc1
    v_mfma_f32_16x16x32_bf16 v[172:175], v[112:115], v[16:19], 0
    ds_read_b128 v[148:151], v15 offset:50176
    ds_read_b128 v[152:155], v15 offset:51200
    s_waitcnt vmcnt(4)
    s_waitcnt lgkmcnt(5)
    v_mfma_f32_16x16x32_bf16 v[156:159], v[116:119], v[20:23], v[156:159]
    s_add_u32 s41, s52, 4096
    buffer_load_dwordx4 v[40:43], v2, s[12:15], s41 offen offset:2048 sc1
    v_mfma_f32_16x16x32_bf16 v[160:163], v[120:123], v[20:23], v[160:163]
    ds_read_b128 v[96:99], v15 offset:52224
    v_mfma_f32_16x16x32_bf16 v[164:167], v[124:127], v[20:23], v[164:167]
    ds_read_b128 v[100:103], v15 offset:53248
    v_mfma_f32_16x16x32_bf16 v[168:171], v[128:131], v[20:23], v[168:171]
    ds_read_b128 v[104:107], v15 offset:54272
    s_add_u32 s41, s52, 4096
    buffer_load_dwordx4 v[44:47], v2, s[12:15], s41 offen offset:3072 sc1
    v_mfma_f32_16x16x32_bf16 v[172:175], v[132:135], v[20:23], v[172:175]
    ds_read_b128 v[108:111], v15 offset:55296
    ds_read_b128 v[112:115], v15 offset:56320
    s_waitcnt vmcnt(5)
    s_waitcnt lgkmcnt(5)
    v_mfma_f32_16x16x32_bf16 v[156:159], v[136:139], v[24:27], v[156:159]
    s_add_u32 s41, s52, 8192
    buffer_load_dwordx4 v[48:51], v2, s[12:15], s41 offen offset:0 sc1
    v_mfma_f32_16x16x32_bf16 v[160:163], v[140:143], v[24:27], v[160:163]
    ds_read_b128 v[116:119], v15 offset:57344
    v_mfma_f32_16x16x32_bf16 v[164:167], v[144:147], v[24:27], v[164:167]
    ds_read_b128 v[120:123], v15 offset:58368
    v_mfma_f32_16x16x32_bf16 v[168:171], v[148:151], v[24:27], v[168:171]
    ds_read_b128 v[124:127], v15 offset:59392
    s_add_u32 s41, s52, 8192
    buffer_load_dwordx4 v[52:55], v2, s[12:15], s41 offen offset:1024 sc1
    v_mfma_f32_16x16x32_bf16 v[172:175], v[152:155], v[24:27], v[172:175]
    ds_read_b128 v[128:131], v15 offset:60416
    ds_read_b128 v[132:135], v15 offset:61440
    s_waitcnt vmcnt(6)
    s_waitcnt lgkmcnt(5)
    v_mfma_f32_16x16x32_bf16 v[156:159], v[96:99], v[28:31], v[156:159]
    s_add_u32 s41, s52, 8192
    buffer_load_dwordx4 v[56:59], v2, s[12:15], s41 offen offset:2048 sc1
    v_mfma_f32_16x16x32_bf16 v[160:163], v[100:103], v[28:31], v[160:163]
    ds_read_b128 v[136:139], v15 offset:62464
    v_mfma_f32_16x16x32_bf16 v[164:167], v[104:107], v[28:31], v[164:167]
    ds_read_b128 v[140:143], v15 offset:63488
    v_mfma_f32_16x16x32_bf16 v[168:171], v[108:111], v[28:31], v[168:171]
    ds_read_b128 v[144:147], v15 offset:64512
    s_add_u32 s41, s52, 8192
    buffer_load_dwordx4 v[60:63], v2, s[12:15], s41 offen offset:3072 sc1
    v_mfma_f32_16x16x32_bf16 v[172:175], v[112:115], v[28:31], v[172:175]
    ds_read_b128 v[148:151], v11 offset:0
    ds_read_b128 v[152:155], v11 offset:1024
    s_waitcnt vmcnt(7)
    s_waitcnt lgkmcnt(5)
    v_mfma_f32_16x16x32_bf16 v[156:159], v[116:119], v[32:35], v[156:159]
    s_add_u32 s41, s52, 12288
    buffer_load_dwordx4 v[64:67], v2, s[12:15], s41 offen offset:0 sc1
    v_mfma_f32_16x16x32_bf16 v[160:163], v[120:123], v[32:35], v[160:163]
    ds_read_b128 v[96:99], v11 offset:2048
    v_mfma_f32_16x16x32_bf16 v[164:167], v[124:127], v[32:35], v[164:167]
    ds_read_b128 v[100:103], v11 offset:3072
    v_mfma_f32_16x16x32_bf16 v[168:171], v[128:131], v[32:35], v[168:171]
    ds_read_b128 v[104:107], v11 offset:4096
    s_add_u32 s41, s52, 12288
    buffer_load_dwordx4 v[68:71], v2, s[12:15], s41 offen offset:1024 sc1
    v_mfma_f32_16x16x32_bf16 v[172:175], v[132:135], v[32:35], v[172:175]
    ds_read_b128 v[108:111], v11 offset:5120
    ds_read_b128 v[112:115], v11 offset:6144
    s_waitcnt vmcnt(8)
    s_waitcnt lgkmcnt(5)
    v_mfma_f32_16x16x32_bf16 v[156:159], v[136:139], v[36:39], v[156:159]
    s_add_u32 s41, s52, 12288
    buffer_load_dwordx4 v[72:75], v2, s[12:15], s41 offen offset:2048 sc1
    v_mfma_f32_16x16x32_bf16 v[160:163], v[140:143], v[36:39], v[160:163]
    ds_read_b128 v[116:119], v11 offset:7168
    v_mfma_f32_16x16x32_bf16 v[164:167], v[144:147], v[36:39], v[164:167]
    ds_read_b128 v[120:123], v11 offset:8192
    v_mfma_f32_16x16x32_bf16 v[168:171], v[148:151], v[36:39], v[168:171]
    ds_read_b128 v[124:127], v11 offset:9216
    s_add_u32 s41, s52, 12288
    buffer_load_dwordx4 v[76:79], v2, s[12:15], s41 offen offset:3072 sc1
    v_mfma_f32_16x16x32_bf16 v[172:175], v[152:155], v[36:39], v[172:175]
    ds_read_b128 v[128:131], v11 offset:10240
    ds_read_b128 v[132:135], v11 offset:11264
    s_waitcnt vmcnt(9)
    s_waitcnt lgkmcnt(5)
    v_mfma_f32_16x16x32_bf16 v[156:159], v[96:99], v[40:43], v[156:159]
    s_add_u32 s41, s52, 16384
    buffer_load_dwordx4 v[80:83], v2, s[12:15], s41 offen offset:0 sc1
    v_mfma_f32_16x16x32_bf16 v[160:163], v[100:103], v[40:43], v[160:163]
    ds_read_b128 v[136:139], v11 offset:12288
    v_mfma_f32_16x16x32_bf16 v[164:167], v[104:107], v[40:43], v[164:167]
    ds_read_b128 v[140:143], v11 offset:13312
    v_mfma_f32_16x16x32_bf16 v[168:171], v[108:111], v[40:43], v[168:171]
    ds_read_b128 v[144:147], v11 offset:14336
    s_add_u32 s41, s52, 16384
    buffer_load_dwordx4 v[84:87], v2, s[12:15], s41 offen offset:1024 sc1
    v_mfma_f32_16x16x32_bf16 v[172:175], v[112:115], v[40:43], v[172:175]
    ds_read_b128 v[148:151], v11 offset:15360
    ds_read_b128 v[152:155], v11 offset:16384
    s_waitcnt vmcnt(10)
    s_waitcnt lgkmcnt(5)
    v_mfma_f32_16x16x32_bf16 v[156:159], v[116:119], v[44:47], v[156:159]
    s_add_u32 s41, s52, 16384
    buffer_load_dwordx4 v[88:91], v2, s[12:15], s41 offen offset:2048 sc1
    v_mfma_f32_16x16x32_bf16 v[160:163], v[120:123], v[44:47], v[160:163]
    ds_read_b128 v[96:99], v11 offset:17408
    v_mfma_f32_16x16x32_bf16 v[164:167], v[124:127], v[44:47], v[164:167]
    ds_read_b128 v[100:103], v11 offset:18432
    v_mfma_f32_16x16x32_bf16 v[168:171], v[128:131], v[44:47], v[168:171]
    ds_read_b128 v[104:107], v11 offset:19456
    s_add_u32 s41, s52, 16384
    buffer_load_dwordx4 v[92:95], v2, s[12:15], s41 offen offset:3072 sc1
    v_mfma_f32_16x16x32_bf16 v[172:175], v[132:135], v[44:47], v[172:175]
    ds_read_b128 v[108:111], v11 offset:20480
    ds_read_b128 v[112:115], v11 offset:21504
    s_waitcnt vmcnt(11)
    s_waitcnt lgkmcnt(5)
    v_mfma_f32_16x16x32_bf16 v[156:159], v[136:139], v[48:51], v[156:159]
    v_mfma_f32_16x16x32_bf16 v[160:163], v[140:143], v[48:51], v[160:163]
    ds_read_b128 v[116:119], v11 offset:22528
    buffer_load_dwordx4 v[176:179], v254, s[12:15], s48 offen sc1
    buffer_load_dwordx4 v[180:183], v254, s[12:15], s48 offen offset:1024 sc1
    buffer_load_dwordx2 v[184:185], v8, s[12:15], s48 offen offset:2048 sc1
    v_mfma_f32_16x16x32_bf16 v[164:167], v[144:147], v[48:51], v[164:167]
    ds_read_b128 v[120:123], v11 offset:23552
    v_mfma_f32_16x16x32_bf16 v[168:171], v[148:151], v[48:51], v[168:171]
    ds_read_b128 v[124:127], v14 offset:0
    v_mfma_f32_16x16x32_bf16 v[172:175], v[152:155], v[48:51], v[172:175]
    ds_read_b128 v[128:131], v14 offset:1024
    ds_read_b128 v[132:135], v14 offset:2048
    s_waitcnt vmcnt(13)
    s_waitcnt lgkmcnt(5)
    s_barrier
    v_mfma_f32_16x16x32_bf16 v[156:159], v[96:99], v[52:55], v[156:159]
    v_mfma_f32_16x16x32_bf16 v[160:163], v[100:103], v[52:55], v[160:163]
    ds_read_b128 v[136:139], v14 offset:3072
    v_mfma_f32_16x16x32_bf16 v[164:167], v[104:107], v[52:55], v[164:167]
    ds_read_b128 v[140:143], v14 offset:4096
    v_mfma_f32_16x16x32_bf16 v[168:171], v[108:111], v[52:55], v[168:171]
    ds_read_b128 v[144:147], v14 offset:5120
    v_mfma_f32_16x16x32_bf16 v[172:175], v[112:115], v[52:55], v[172:175]
    ds_read_b128 v[148:151], v14 offset:6144
    ds_read_b128 v[152:155], v14 offset:7168
    s_waitcnt vmcnt(12)
    s_waitcnt lgkmcnt(5)
    v_mfma_f32_16x16x32_bf16 v[156:159], v[116:119], v[56:59], v[156:159]
    v_mfma_f32_16x16x32_bf16 v[160:163], v[120:123], v[56:59], v[160:163]
    ds_read_b128 v[96:99], v14 offset:8192
    s_mul_i32 s38, s30, 12288
    s_add_u32 s39, s38, s45
    s_add_u32 s39, s39, 53248
    s_add_u32 s38, s38, 102400
    s_mov_b32 m0, s38
    s_nop 0
    buffer_load_dwordx4 v2, s[12:15], s39 offen offset:0 lds
    v_mfma_f32_16x16x32_bf16 v[164:167], v[124:127], v[56:59], v[164:167]
    ds_read_b128 v[100:103], v14 offset:9216
    v_mfma_f32_16x16x32_bf16 v[168:171], v[128:131], v[56:59], v[168:171]
    ds_read_b128 v[104:107], v14 offset:10240
    v_mfma_f32_16x16x32_bf16 v[172:175], v[132:135], v[56:59], v[172:175]
    ds_read_b128 v[108:111], v14 offset:11264
    ds_read_b128 v[112:115], v14 offset:12288
    s_mov_b32 m0, s38
    s_nop 0
    buffer_load_dwordx4 v2, s[12:15], s39 offen offset:1024 lds
    s_waitcnt vmcnt(13)
    s_waitcnt lgkmcnt(5)
    v_mfma_f32_16x16x32_bf16 v[156:159], v[136:139], v[60:63], v[156:159]
    v_mfma_f32_16x16x32_bf16 v[160:163], v[140:143], v[60:63], v[160:163]
    ds_read_b128 v[116:119], v14 offset:13312
    s_mov_b32 m0, s38
    s_nop 0
    buffer_load_dwordx4 v2, s[12:15], s39 offen offset:2048 lds
    v_mfma_f32_16x16x32_bf16 v[164:167], v[144:147], v[60:63], v[164:167]
    ds_read_b128 v[120:123], v14 offset:14336
    v_mfma_f32_16x16x32_bf16 v[168:171], v[148:151], v[60:63], v[168:171]
    ds_read_b128 v[124:127], v14 offset:15360
    v_mfma_f32_16x16x32_bf16 v[172:175], v[152:155], v[60:63], v[172:175]
    ds_read_b128 v[128:131], v14 offset:16384
    ds_read_b128 v[132:135], v14 offset:17408
    s_mov_b32 m0, s38
    s_nop 0
    buffer_load_dwordx4 v2, s[12:15], s39 offen offset:3072 lds
    s_add_u32 s38, s38, 4096
    s_add_u32 s39, s39, 4096
    s_waitcnt vmcnt(14)
    s_waitcnt lgkmcnt(5)
    v_mfma_f32_16x16x32_bf16 v[156:159], v[96:99], v[64:67], v[156:159]
    v_mfma_f32_16x16x32_bf16 v[160:163], v[100:103], v[64:67], v[160:163]
    ds_read_b128 v[136:139], v14 offset:18432
    s_mov_b32 m0, s38
    s_nop 0
    buffer_load_dwordx4 v2, s[12:15], s39 offen offset:0 lds
    v_mfma_f32_16x16x32_bf16 v[164:167], v[104:107], v[64:67], v[164:167]
    ds_read_b128 v[140:143], v14 offset:19456
    v_mfma_f32_16x16x32_bf16 v[168:171], v[108:111], v[64:67], v[168:171]
    ds_read_b128 v[144:147], v14 offset:20480
    v_mfma_f32_16x16x32_bf16 v[172:175], v[112:115], v[64:67], v[172:175]
    ds_read_b128 v[148:151], v14 offset:21504
    ds_read_b128 v[152:155], v14 offset:22528
    s_mov_b32 m0, s38
    s_nop 0
    buffer_load_dwordx4 v2, s[12:15], s39 offen offset:1024 lds
    s_waitcnt vmcnt(15)
    s_waitcnt lgkmcnt(5)
    v_mfma_f32_16x16x32_bf16 v[156:159], v[116:119], v[68:71], v[156:159]
    v_mfma_f32_16x16x32_bf16 v[160:163], v[120:123], v[68:71], v[160:163]
    ds_read_b128 v[96:99], v14 offset:23552
    s_mov_b32 m0, s38
    s_nop 0
    buffer_load_dwordx4 v2, s[12:15], s39 offen offset:2048 lds
    v_mfma_f32_16x16x32_bf16 v[164:167], v[124:127], v[68:71], v[164:167]
    ds_read_b128 v[100:103], v14 offset:24576
    v_mfma_f32_16x16x32_bf16 v[168:171], v[128:131], v[68:71], v[168:171]
    ds_read_b128 v[104:107], v14 offset:25600
    v_mfma_f32_16x16x32_bf16 v[172:175], v[132:135], v[68:71], v[172:175]
    ds_read_b128 v[108:111], v14 offset:26624
    ds_read_b128 v[112:115], v14 offset:27648
    s_mov_b32 m0, s38
    s_nop 0
    buffer_load_dwordx4 v2, s[12:15], s39 offen offset:3072 lds
    s_add_u32 s38, s38, 4096
    s_add_u32 s39, s39, 4096
    s_waitcnt vmcnt(16)
    s_waitcnt lgkmcnt(5)
    v_mfma_f32_16x16x32_bf16 v[156:159], v[136:139], v[72:75], v[156:159]
    v_mfma_f32_16x16x32_bf16 v[160:163], v[140:143], v[72:75], v[160:163]
    ds_read_b128 v[116:119], v14 offset:28672
    s_mov_b32 m0, s38
    s_nop 0
    buffer_load_dwordx4 v2, s[12:15], s39 offen offset:0 lds
    v_mfma_f32_16x16x32_bf16 v[164:167], v[144:147], v[72:75], v[164:167]
    ds_read_b128 v[120:123], v14 offset:29696
    v_mfma_f32_16x16x32_bf16 v[168:171], v[148:151], v[72:75], v[168:171]
    ds_read_b128 v[124:127], v14 offset:30720
    v_mfma_f32_16x16x32_bf16 v[172:175], v[152:155], v[72:75], v[172:175]
    ds_read_b128 v[128:131], v14 offset:31744
    ds_read_b128 v[132:135], v14 offset:32768
    s_mov_b32 m0, s38
    s_nop 0
    buffer_load_dwordx4 v2, s[12:15], s39 offen offset:1024 lds
    s_waitcnt vmcnt(17)
    s_waitcnt lgkmcnt(5)
    v_mfma_f32_16x16x32_bf16 v[156:159], v[96:99], v[76:79], v[156:159]
    v_mfma_f32_16x16x32_bf16 v[160:163], v[100:103], v[76:79], v[160:163]
    ds_read_b128 v[136:139], v14 offset:33792
    s_mov_b32 m0, s38
    s_nop 0
    buffer_load_dwordx4 v2, s[12:15], s39 offen offset:2048 lds
    v_mfma_f32_16x16x32_bf16 v[164:167], v[104:107], v[76:79], v[164:167]
    ds_read_b128 v[140:143], v14 offset:34816
    v_mfma_f32_16x16x32_bf16 v[168:171], v[108:111], v[76:79], v[168:171]
    ds_read_b128 v[144:147], v14 offset:35840
    v_mfma_f32_16x16x32_bf16 v[172:175], v[112:115], v[76:79], v[172:175]
    ds_read_b128 v[148:151], v14 offset:36864
    ds_read_b128 v[152:155], v14 offset:37888
    s_mov_b32 m0, s38
    s_nop 0
    buffer_load_dwordx4 v2, s[12:15], s39 offen offset:3072 lds
    s_waitcnt vmcnt(18)
    s_waitcnt lgkmcnt(5)
    v_mfma_f32_16x16x32_bf16 v[156:159], v[116:119], v[80:83], v[156:159]
    v_mfma_f32_16x16x32_bf16 v[160:163], v[120:123], v[80:83], v[160:163]
    ds_read_b128 v[96:99], v14 offset:38912
    v_mfma_f32_16x16x32_bf16 v[164:167], v[124:127], v[80:83], v[164:167]
    ds_read_b128 v[100:103], v14 offset:39936
    v_mfma_f32_16x16x32_bf16 v[168:171], v[128:131], v[80:83], v[168:171]
    ds_read_b128 v[104:107], v14 offset:40960
    v_mfma_f32_16x16x32_bf16 v[172:175], v[132:135], v[80:83], v[172:175]
    ds_read_b128 v[108:111], v14 offset:41984
    ds_read_b128 v[112:115], v14 offset:43008
    s_waitcnt vmcnt(17)
    s_waitcnt lgkmcnt(5)
    v_mfma_f32_16x16x32_bf16 v[156:159], v[136:139], v[84:87], v[156:159]
    v_mfma_f32_16x16x32_bf16 v[160:163], v[140:143], v[84:87], v[160:163]
    ds_read_b128 v[116:119], v14 offset:44032
    v_mfma_f32_16x16x32_bf16 v[164:167], v[144:147], v[84:87], v[164:167]
    ds_read_b128 v[120:123], v14 offset:45056
    v_mfma_f32_16x16x32_bf16 v[168:171], v[148:151], v[84:87], v[168:171]
    ds_read_b128 v[124:127], v14 offset:46080
    v_mfma_f32_16x16x32_bf16 v[172:175], v[152:155], v[84:87], v[172:175]
    ds_read_b128 v[128:131], v14 offset:47104
    ds_read_b128 v[132:135], v14 offset:48128
    s_waitcnt vmcnt(16)
    s_waitcnt lgkmcnt(5)
    v_mfma_f32_16x16x32_bf16 v[156:159], v[96:99], v[88:91], v[156:159]
    v_mfma_f32_16x16x32_bf16 v[160:163], v[100:103], v[88:91], v[160:163]
    v_mfma_f32_16x16x32_bf16 v[164:167], v[104:107], v[88:91], v[164:167]
    v_mfma_f32_16x16x32_bf16 v[168:171], v[108:111], v[88:91], v[168:171]
    v_mfma_f32_16x16x32_bf16 v[172:175], v[112:115], v[88:91], v[172:175]
    s_waitcnt vmcnt(15)
    s_waitcnt lgkmcnt(0)
    v_mfma_f32_16x16x32_bf16 v[156:159], v[116:119], v[92:95], v[156:159]
    v_mfma_f32_16x16x32_bf16 v[160:163], v[120:123], v[92:95], v[160:163]
    v_mfma_f32_16x16x32_bf16 v[164:167], v[124:127], v[92:95], v[164:167]
    v_mfma_f32_16x16x32_bf16 v[168:171], v[128:131], v[92:95], v[168:171]
    v_mfma_f32_16x16x32_bf16 v[172:175], v[132:135], v[92:95], v[172:175]
    s_barrier
    s_mul_i32 s38, s30, 1024
    s_add_u32 s39, s38, s45
    s_add_u32 s39, s39, 102400
    s_add_u32 s38, s38, 151552
    s_mov_b32 m0, s38
    s_nop 0
    buffer_load_dwordx4 v2, s[12:15], s39 offen offset:0 lds
    s_mul_i32 s38, s30, 9216
    s_add_u32 s39, s38, s45
    s_add_u32 s39, s39, 106496
    s_add_u32 s38, s38, 0
    s_mov_b32 m0, s38
    s_nop 0
    buffer_load_dwordx4 v2, s[12:15], s39 offen offset:0 lds
    s_mov_b32 m0, s38
    s_nop 0
    buffer_load_dwordx4 v2, s[12:15], s39 offen offset:1024 lds
    s_mov_b32 m0, s38
    s_nop 0
    buffer_load_dwordx4 v2, s[12:15], s39 offen offset:2048 lds
    s_mov_b32 m0, s38
    s_nop 0
    buffer_load_dwordx4 v2, s[12:15], s39 offen offset:3072 lds
    s_add_u32 s38, s38, 4096
    s_add_u32 s39, s39, 4096
    s_mov_b32 m0, s38
    s_nop 0
    buffer_load_dwordx4 v2, s[12:15], s39 offen offset:0 lds
    s_mov_b32 m0, s38
    s_nop 0
    buffer_load_dwordx4 v2, s[12:15], s39 offen offset:1024 lds
    s_mov_b32 m0, s38
    s_nop 0
    buffer_load_dwordx4 v2, s[12:15], s39 offen offset:2048 lds
    s_mov_b32 m0, s38
    s_nop 0
    buffer_load_dwordx4 v2, s[12:15], s39 offen offset:3072 lds
    s_add_u32 s38, s38, 4096
    s_add_u32 s39, s39, 4096
    s_mov_b32 m0, s38
    s_nop 0
    buffer_load_dwordx4 v2, s[12:15], s39 offen offset:0 lds
    v_mov_b32 v196, 0x3f803f80
    v_mov_b32 v198, 0
    v_mov_b32 v199, 0
    s_waitcnt vmcnt(22)
    s_nop 1
    v_permlane16_swap_b32 v176, v178
    v_permlane16_swap_b32 v177, v179
    v_permlane16_swap_b32 v180, v182
    v_permlane16_swap_b32 v181, v183
    s_nop 1
    v_lshlrev_b32 v200, 16, v176
    v_and_b32 v201, 0xffff0000, v176
    v_lshlrev_b32 v202, 16, v177
    v_and_b32 v203, 0xffff0000, v177
    v_lshlrev_b32 v204, 16, v178
    v_and_b32 v205, 0xffff0000, v178
    v_lshlrev_b32 v206, 16, v179
    v_and_b32 v207, 0xffff0000, v179
    v_lshlrev_b32 v208, 16, v180
    v_and_b32 v209, 0xffff0000, v180
    v_lshlrev_b32 v210, 16, v181
    v_and_b32 v211, 0xffff0000, v181
    v_lshlrev_b32 v212, 16, v182
    v_and_b32 v213, 0xffff0000, v182
    v_lshlrev_b32 v214, 16, v183
    v_and_b32 v215, 0xffff0000, v183
    v_lshlrev_b32 v216, 16, v184
    v_and_b32 v217, 0xffff0000, v184
    v_lshlrev_b32 v218, 16, v185
    v_and_b32 v219, 0xffff0000, v185
    v_pk_add_f32 v[156:157], v[156:157], v[200:201]
    v_pk_add_f32 v[158:159], v[158:159], v[202:203]
    v_pk_add_f32 v[160:161], v[160:161], v[204:205]
    v_pk_add_f32 v[162:163], v[162:163], v[206:207]
    v_pk_add_f32 v[164:165], v[164:165], v[208:209]
    v_pk_add_f32 v[166:167], v[166:167], v[210:211]
    v_pk_add_f32 v[168:169], v[168:169], v[212:213]
    v_pk_add_f32 v[170:171], v[170:171], v[214:215]
    v_pk_add_f32 v[172:173], v[172:173], v[216:217]
    v_pk_add_f32 v[174:175], v[174:175], v[218:219]
    v_cvt_pk_bf16_f32 v156, v156, v157
    v_cvt_pk_bf16_f32 v157, v158, v159
    v_cvt_pk_bf16_f32 v158, v160, v161
    v_cvt_pk_bf16_f32 v159, v162, v163
    v_cvt_pk_bf16_f32 v164, v164, v165
    v_cvt_pk_bf16_f32 v165, v166, v167
    v_cvt_pk_bf16_f32 v166, v168, v169
    v_cvt_pk_bf16_f32 v167, v170, v171
    v_cvt_pk_bf16_f32 v172, v172, v173
    v_cvt_pk_bf16_f32 v173, v174, v175
    v_dot2_f32_bf16 v198, v156, v196, v198
    v_dot2_f32_bf16 v199, v156, v156, v199
    v_dot2_f32_bf16 v198, v157, v196, v198
    v_dot2_f32_bf16 v199, v157, v157, v199
    v_dot2_f32_bf16 v198, v158, v196, v198
    v_dot2_f32_bf16 v199, v158, v158, v199
    v_dot2_f32_bf16 v198, v159, v196, v198
    v_dot2_f32_bf16 v199, v159, v159, v199
    v_dot2_f32_bf16 v198, v164, v196, v198
    v_dot2_f32_bf16 v199, v164, v164, v199
    v_dot2_f32_bf16 v198, v165, v196, v198
    v_dot2_f32_bf16 v199, v165, v165, v199
    v_dot2_f32_bf16 v198, v166, v196, v198
    v_dot2_f32_bf16 v199, v166, v166, v199
    v_dot2_f32_bf16 v198, v167, v196, v198
    v_dot2_f32_bf16 v199, v167, v167, v199
    v_dot2_f32_bf16 v198, v172, v196, v198
    v_dot2_f32_bf16 v199, v172, v172, v199
    v_dot2_f32_bf16 v198, v173, v196, v198
    v_dot2_f32_bf16 v199, v173, v173, v199
    s_nop 1
    s_nop 1
    v_permlane16_swap_b32 v156, v158
    v_permlane16_swap_b32 v157, v159
    v_permlane16_swap_b32 v164, v166
    v_permlane16_swap_b32 v165, v167
    s_nop 2
    v_mov_b32 v188, v198
    v_mov_b32 v189, v199
    s_nop 1
    v_permlane32_swap_b32 v188, v198
    v_permlane32_swap_b32 v189, v199
    s_nop 0
    v_add_f32 v198, v198, v188
    v_add_f32 v199, v199, v189
    v_mov_b32 v188, v198
    v_mov_b32 v189, v199
    s_nop 1
    v_permlane16_swap_b32 v188, v198
    v_permlane16_swap_b32 v189, v199
    s_nop 0
    v_add_f32 v198, v198, v188
    v_add_f32 v199, v199, v189
    s_add_u32 s47, s54, 20480
    v_lshlrev_b32 v9, 6, v4
    s_lshl_b32 s41, s33, 3
    s_add_u32 s46, s46, s41
    s_lshl_b32 s41, s33, 2
    s_add_u32 s49, s55, s41
    v_mov_b32 v11, v9
    s_cmp_eq_u32 s31, 0
    s_cbranch_scc1 k2_kernel_slow25
    buffer_store_dwordx4 v[156:159], v254, s[12:15], s47 offen offset:0
    buffer_store_dwordx4 v[164:167], v254, s[12:15], s47 offen offset:1024
    buffer_store_dwordx2 v[172:173], v8, s[12:15], s47 offen offset:2048
    s_mov_b64 exec, 0xffff
    buffer_store_dwordx2 v[198:199], v11, s[12:15], s46 offen
    s_mov_b64 exec, -1
    s_waitcnt vmcnt(0)
    v_mov_b32 v9, 1
    v_mov_b32 v10, 4352
    s_mov_b64 exec, 1
    buffer_store_dword v9, v10, s[12:15], s49 offen
    s_mov_b64 exec, -1
    s_branch k2_kernel_sent26
k2_kernel_slow25:
    buffer_store_dwordx4 v[156:159], v254, s[12:15], s47 offen offset:0 sc1
    buffer_store_dwordx4 v[164:167], v254, s[12:15], s47 offen offset:1024 sc1
    buffer_store_dwordx2 v[172:173], v8, s[12:15], s47 offen offset:2048 sc1
    s_mov_b64 exec, 0xffff
    buffer_store_dwordx2 v[198:199], v11, s[12:15], s46 offen sc1
    s_mov_b64 exec, -1
    s_waitcnt vmcnt(0)
    v_mov_b32 v9, 1
    v_mov_b32 v10, 4352
    s_mov_b64 exec, 1
    buffer_store_dword v9, v10, s[12:15], s49 offen sc1
    s_mov_b64 exec, -1
k2_kernel_sent26:
    s_lshl_b32 s46, s34, 3
    s_lshl_b32 s47, s30, 1
    s_add_u32 s46, s46, s47
    s_lshl_b32 s49, s46, 7
    s_add_u32 s49, s49, 4352
    v_bfe_u32 v7, v1, 3, 1
    v_lshlrev_b32 v7, 7, v7
    v_and_b32 v9, 7, v1
    v_lshl_add_u32 v7, v9, 2, v7
    v_add_u32 v7, s49, v7
    s_sub_u32 s49, s55, s37
    s_add_u32 s49, s49, 128
    v_and_b32 v9, 3, v1
    v_lshlrev_b32 v9, 2, v9
    v_add_u32 v9, s49, v9
    v_and_b32 v10, 16, v1
    v_cmp_ne_u32 vcc, 0, v10
    v_mov_b32 v11, 1
    v_mov_b32 v10, 3
    v_cndmask_b32 v7, v7, v9, vcc
    v_cndmask_b32 v10, v11, v10, vcc
    s_mov_b32 s43, 200000
k2_kernel_poll27:
    buffer_load_dword v9, v7, s[12:15], s37 offen sc1
    s_waitcnt vmcnt(0)
    v_cmp_le_u32 vcc, v10, v9
    s_sub_u32 s43, s43, 1
    s_cmp_eq_u64 vcc, -1
    s_cbranch_scc1 k2_kernel_go28
    s_cmp_lg_u32 s43, 0
    s_cbranch_scc1 k2_kernel_poll27
k2_kernel_go28:
    s_mul_i32 s47, s46, 20480
    s_add_u32 s47, s47, s36
    s_add_u32 s47, s47, 20480
    s_add_u32 s48, s47, 20480
    s_add_u32 s41, s47, 0
    buffer_load_dwordx4 v[72:75], v2, s[12:15], s41 offen offset:0 sc1
    s_add_u32 s41, s48, 0
    buffer_load_dwordx4 v[76:79], v2, s[12:15], s41 offen offset:0 sc1
    s_add_u32 s41, s47, 0
    buffer_load_dwordx4 v[80:83], v2, s[12:15], s41 offen offset:1024 sc1
    s_add_u32 s41, s48, 0
    buffer_load_dwordx4 v[84:87], v2, s[12:15], s41 offen offset:1024 sc1
    s_add_u32 s41, s47, 0
    buffer_load_dwordx4 v[88:91], v2, s[12:15], s41 offen offset:2048 sc1
    s_add_u32 s41, s48, 0
    buffer_load_dwordx4 v[92:95], v2, s[12:15], s41 offen offset:2048 sc1
    v_lshlrev_b32 v9, 6, v4
    v_lshl_add_u32 v9, v3, 4, v9
    s_lshl_b32 s41, s46, 10
    s_add_u32 s41, s41, s36
    s_add_u32 s41, s41, 1908736
    buffer_load_dwordx4 v[216:219], v9, s[12:15], s41 offen offset:0 sc1
    buffer_load_dwordx4 v[220:223], v9, s[12:15], s41 offen offset:1024 sc1
    s_mul_i32 s52, s46, 55296
    s_mul_i32 s41, s35, 3584
    s_add_u32 s52, s52, s41
    s_add_u32 s52, s52, s36
    s_add_u32 s52, s52, 1024000
    s_add_u32 s53, s52, 55296
    s_barrier
    v_add_u32 v11, 0x20000, v2
    ds_read_b128 v[160:163], v14 offset:49152
    ds_read_b128 v[164:167], v14 offset:50176
    ds_read_b128 v[168:171], v14 offset:51200
    ds_read_b128 v[172:175], v14 offset:52224
    ds_read_b128 v[176:179], v14 offset:53248
    ds_read_b128 v[180:183], v14 offset:54272
    ds_read_b128 v[184:187], v14 offset:55296
    s_waitcnt vmcnt(6)
    s_waitcnt lgkmcnt(6)
    v_mfma_f32_16x16x32_bf16 v[16:19], v[160:163], v[72:75], 0
    v_mfma_f32_16x16x32_bf16 v[44:47], v[160:163], v[76:79], 0
    ds_read_b128 v[188:191], v14 offset:56320
    s_waitcnt lgkmcnt(6)
    v_mfma_f32_16x16x32_bf16 v[20:23], v[164:167], v[72:75], 0
    v_mfma_f32_16x16x32_bf16 v[48:51], v[164:167], v[76:79], 0
    ds_read_b128 v[192:195], v14 offset:57344
    s_add_u32 s41, s47, 0
    buffer_load_dwordx4 v[96:99], v2, s[12:15], s41 offen offset:3072 sc1
    s_add_u32 s41, s48, 0
    buffer_load_dwordx4 v[100:103], v2, s[12:15], s41 offen offset:3072 sc1
    s_waitcnt lgkmcnt(6)
    v_mfma_f32_16x16x32_bf16 v[24:27], v[168:171], v[72:75], 0
    v_mfma_f32_16x16x32_bf16 v[52:55], v[168:171], v[76:79], 0
    ds_read_b128 v[196:199], v14 offset:58368
    s_waitcnt lgkmcnt(6)
    v_mfma_f32_16x16x32_bf16 v[28:31], v[172:175], v[72:75], 0
    v_mfma_f32_16x16x32_bf16 v[56:59], v[172:175], v[76:79], 0
    ds_read_b128 v[200:203], v14 offset:59392
    s_waitcnt lgkmcnt(6)
    v_mfma_f32_16x16x32_bf16 v[32:35], v[176:179], v[72:75], 0
    v_mfma_f32_16x16x32_bf16 v[60:63], v[176:179], v[76:79], 0
    ds_read_b128 v[204:207], v14 offset:60416
    s_add_u32 s41, s47, 4096
    buffer_load_dwordx4 v[104:107], v2, s[12:15], s41 offen offset:0 sc1
    s_add_u32 s41, s48, 4096
    buffer_load_dwordx4 v[108:111], v2, s[12:15], s41 offen offset:0 sc1
    s_waitcnt lgkmcnt(6)
    v_mfma_f32_16x16x32_bf16 v[36:39], v[180:183], v[72:75], 0
    v_mfma_f32_16x16x32_bf16 v[64:67], v[180:183], v[76:79], 0
    ds_read_b128 v[208:211], v14 offset:61440
    s_waitcnt lgkmcnt(6)
    v_mfma_f32_16x16x32_bf16 v[40:43], v[184:187], v[72:75], 0
    v_mfma_f32_16x16x32_bf16 v[68:71], v[184:187], v[76:79], 0
    ds_read_b128 v[212:215], v14 offset:62464
    s_waitcnt vmcnt(8)
    s_waitcnt lgkmcnt(6)
    v_mfma_f32_16x16x32_bf16 v[16:19], v[188:191], v[80:83], v[16:19]
    v_mfma_f32_16x16x32_bf16 v[44:47], v[188:191], v[84:87], v[44:47]
    ds_read_b128 v[160:163], v14 offset:63488
    s_waitcnt lgkmcnt(6)
    v_mfma_f32_16x16x32_bf16 v[20:23], v[192:195], v[80:83], v[20:23]
    v_mfma_f32_16x16x32_bf16 v[48:51], v[192:195], v[84:87], v[48:51]
    ds_read_b128 v[164:167], v14 offset:64512
    s_add_u32 s41, s47, 4096
    buffer_load_dwordx4 v[112:115], v2, s[12:15], s41 offen offset:1024 sc1
    s_add_u32 s41, s48, 4096
    buffer_load_dwordx4 v[116:119], v2, s[12:15], s41 offen offset:1024 sc1
    s_waitcnt lgkmcnt(6)
    v_mfma_f32_16x16x32_bf16 v[24:27], v[196:199], v[80:83], v[24:27]
    v_mfma_f32_16x16x32_bf16 v[52:55], v[196:199], v[84:87], v[52:55]
    ds_read_b128 v[168:171], v15 offset:0
    buffer_load_dwordx4 a[0:3], v2, s[12:15], s40 offen offset:0
    s_waitcnt lgkmcnt(6)
    v_mfma_f32_16x16x32_bf16 v[28:31], v[200:203], v[80:83], v[28:31]
    v_mfma_f32_16x16x32_bf16 v[56:59], v[200:203], v[84:87], v[56:59]
    ds_read_b128 v[172:175], v15 offset:1024
    buffer_load_dwordx4 a[4:7], v2, s[12:15], s40 offen offset:1024
    s_waitcnt lgkmcnt(6)
    v_mfma_f32_16x16x32_bf16 v[32:35], v[204:207], v[80:83], v[32:35]
    v_mfma_f32_16x16x32_bf16 v[60:63], v[204:207], v[84:87], v[60:63]
    ds_read_b128 v[176:179], v15 offset:2048
    s_add_u32 s41, s47, 4096
    buffer_load_dwordx4 v[120:123], v2, s[12:15], s41 offen offset:2048 sc1
    s_add_u32 s41, s48, 4096
    buffer_load_dwordx4 v[124:127], v2, s[12:15], s41 offen offset:2048 sc1
    s_waitcnt lgkmcnt(6)
    v_mfma_f32_16x16x32_bf16 v[36:39], v[208:211], v[80:83], v[36:39]
    v_mfma_f32_16x16x32_bf16 v[64:67], v[208:211], v[84:87], v[64:67]
    ds_read_b128 v[180:183], v15 offset:3072
    buffer_load_dwordx4 a[8:11], v2, s[12:15], s40 offen offset:2048
    s_waitcnt lgkmcnt(6)
    v_mfma_f32_16x16x32_bf16 v[40:43], v[212:215], v[80:83], v[40:43]
    v_mfma_f32_16x16x32_bf16 v[68:71], v[212:215], v[84:87], v[68:71]
    ds_read_b128 v[184:187], v15 offset:4096
    s_waitcnt vmcnt(13)
    s_waitcnt lgkmcnt(6)
    v_mfma_f32_16x16x32_bf16 v[16:19], v[160:163], v[88:91], v[16:19]
    v_mfma_f32_16x16x32_bf16 v[44:47], v[160:163], v[92:95], v[44:47]
    ds_read_b128 v[188:191], v15 offset:5120
    s_waitcnt lgkmcnt(6)
    v_mfma_f32_16x16x32_bf16 v[20:23], v[164:167], v[88:91], v[20:23]
    v_mfma_f32_16x16x32_bf16 v[48:51], v[164:167], v[92:95], v[48:51]
    ds_read_b128 v[192:195], v15 offset:6144
    s_add_u32 s41, s47, 4096
    buffer_load_dwordx4 v[128:131], v2, s[12:15], s41 offen offset:3072 sc1
    s_add_u32 s41, s48, 4096
    buffer_load_dwordx4 v[132:135], v2, s[12:15], s41 offen offset:3072 sc1
    s_waitcnt lgkmcnt(6)
    v_mfma_f32_16x16x32_bf16 v[24:27], v[168:171], v[88:91], v[24:27]
    v_mfma_f32_16x16x32_bf16 v[52:55], v[168:171], v[92:95], v[52:55]
    ds_read_b128 v[196:199], v15 offset:7168
    buffer_load_dwordx4 a[12:15], v2, s[12:15], s40 offen offset:3072
    s_add_u32 s40, s40, 4096
    s_waitcnt lgkmcnt(6)
    v_mfma_f32_16x16x32_bf16 v[28:31], v[172:175], v[88:91], v[28:31]
    v_mfma_f32_16x16x32_bf16 v[56:59], v[172:175], v[92:95], v[56:59]
    ds_read_b128 v[200:203], v15 offset:8192
    buffer_load_dwordx4 a[16:19], v2, s[12:15], s40 offen offset:0
    s_waitcnt lgkmcnt(6)
    v_mfma_f32_16x16x32_bf16 v[32:35], v[176:179], v[88:91], v[32:35]
    v_mfma_f32_16x16x32_bf16 v[60:63], v[176:179], v[92:95], v[60:63]
    ds_read_b128 v[204:207], v15 offset:9216
    s_add_u32 s41, s47, 8192
    buffer_load_dwordx4 v[136:139], v2, s[12:15], s41 offen offset:0 sc1
    s_add_u32 s41, s48, 8192
    buffer_load_dwordx4 v[140:143], v2, s[12:15], s41 offen offset:0 sc1
    s_waitcnt lgkmcnt(6)
    v_mfma_f32_16x16x32_bf16 v[36:39], v[180:183], v[88:91], v[36:39]
    v_mfma_f32_16x16x32_bf16 v[64:67], v[180:183], v[92:95], v[64:67]
    ds_read_b128 v[208:211], v15 offset:10240
    buffer_load_dwordx4 a[20:23], v2, s[12:15], s40 offen offset:1024
    s_waitcnt lgkmcnt(6)
    v_mfma_f32_16x16x32_bf16 v[40:43], v[184:187], v[88:91], v[40:43]
    v_mfma_f32_16x16x32_bf16 v[68:71], v[184:187], v[92:95], v[68:71]
    ds_read_b128 v[212:215], v15 offset:11264
    s_waitcnt vmcnt(16)
    s_waitcnt lgkmcnt(6)
    v_mfma_f32_16x16x32_bf16 v[16:19], v[188:191], v[96:99], v[16:19]
    v_mfma_f32_16x16x32_bf16 v[44:47], v[188:191], v[100:103], v[44:47]
    ds_read_b128 v[160:163], v15 offset:12288
    s_waitcnt lgkmcnt(6)
    v_mfma_f32_16x16x32_bf16 v[20:23], v[192:195], v[96:99], v[20:23]
    v_mfma_f32_16x16x32_bf16 v[48:51], v[192:195], v[100:103], v[48:51]
    ds_read_b128 v[164:167], v15 offset:13312
    s_add_u32 s41, s47, 8192
    buffer_load_dwordx4 v[144:147], v2, s[12:15], s41 offen offset:1024 sc1
    s_add_u32 s41, s48, 8192
    buffer_load_dwordx4 v[148:151], v2, s[12:15], s41 offen offset:1024 sc1
    s_waitcnt lgkmcnt(6)
    v_mfma_f32_16x16x32_bf16 v[24:27], v[196:199], v[96:99], v[24:27]
    v_mfma_f32_16x16x32_bf16 v[52:55], v[196:199], v[100:103], v[52:55]
    ds_read_b128 v[168:171], v15 offset:14336
    buffer_load_dwordx4 a[24:27], v2, s[12:15], s40 offen offset:2048
    s_waitcnt lgkmcnt(6)
    v_mfma_f32_16x16x32_bf16 v[28:31], v[200:203], v[96:99], v[28:31]
    v_mfma_f32_16x16x32_bf16 v[56:59], v[200:203], v[100:103], v[56:59]
    ds_read_b128 v[172:175], v15 offset:15360
    buffer_load_dwordx4 a[28:31], v2, s[12:15], s40 offen offset:3072
    s_add_u32 s40, s40, 4096
    s_waitcnt lgkmcnt(6)
    v_mfma_f32_16x16x32_bf16 v[32:35], v[204:207], v[96:99], v[32:35]
    v_mfma_f32_16x16x32_bf16 v[60:63], v[204:207], v[100:103], v[60:63]
    ds_read_b128 v[176:179], v15 offset:16384
    s_waitcnt lgkmcnt(6)
    v_mfma_f32_16x16x32_bf16 v[36:39], v[208:211], v[96:99], v[36:39]
    v_mfma_f32_16x16x32_bf16 v[64:67], v[208:211], v[100:103], v[64:67]
    ds_read_b128 v[180:183], v15 offset:17408
    buffer_load_dwordx4 a[32:35], v2, s[12:15], s40 offen offset:0
    s_waitcnt lgkmcnt(6)
    v_mfma_f32_16x16x32_bf16 v[40:43], v[212:215], v[96:99], v[40:43]
    v_mfma_f32_16x16x32_bf16 v[68:71], v[212:215], v[100:103], v[68:71]
    ds_read_b128 v[184:187], v15 offset:18432
    s_waitcnt vmcnt(19)
    s_waitcnt lgkmcnt(6)
    v_mfma_f32_16x16x32_bf16 v[16:19], v[160:163], v[104:107], v[16:19]
    v_mfma_f32_16x16x32_bf16 v[44:47], v[160:163], v[108:111], v[44:47]
    ds_read_b128 v[188:191], v15 offset:19456
    s_waitcnt lgkmcnt(6)
    v_mfma_f32_16x16x32_bf16 v[20:23], v[164:167], v[104:107], v[20:23]
    v_mfma_f32_16x16x32_bf16 v[48:51], v[164:167], v[108:111], v[48:51]
    ds_read_b128 v[192:195], v15 offset:20480
    s_add_u32 s41, s47, 8192
    buffer_load_dwordx4 v[152:155], v2, s[12:15], s41 offen offset:2048 sc1
    s_add_u32 s41, s48, 8192
    buffer_load_dwordx4 v[156:159], v2, s[12:15], s41 offen offset:2048 sc1
    s_waitcnt lgkmcnt(6)
    v_mfma_f32_16x16x32_bf16 v[24:27], v[168:171], v[104:107], v[24:27]
    v_mfma_f32_16x16x32_bf16 v[52:55], v[168:171], v[108:111], v[52:55]
    ds_read_b128 v[196:199], v15 offset:21504
    buffer_load_dwordx4 a[36:39], v2, s[12:15], s40 offen offset:1024
    s_waitcnt lgkmcnt(6)
    v_mfma_f32_16x16x32_bf16 v[28:31], v[172:175], v[104:107], v[28:31]
    v_mfma_f32_16x16x32_bf16 v[56:59], v[172:175], v[108:111], v[56:59]
    ds_read_b128 v[200:203], v15 offset:22528
    buffer_load_dwordx4 a[40:43], v2, s[12:15], s40 offen offset:2048
    s_waitcnt lgkmcnt(6)
    v_mfma_f32_16x16x32_bf16 v[32:35], v[176:179], v[104:107], v[32:35]
    v_mfma_f32_16x16x32_bf16 v[60:63], v[176:179], v[108:111], v[60:63]
    ds_read_b128 v[204:207], v15 offset:23552
    s_waitcnt lgkmcnt(6)
    v_mfma_f32_16x16x32_bf16 v[36:39], v[180:183], v[104:107], v[36:39]
    v_mfma_f32_16x16x32_bf16 v[64:67], v[180:183], v[108:111], v[64:67]
    ds_read_b128 v[208:211], v15 offset:24576
    buffer_load_dwordx4 a[44:47], v2, s[12:15], s40 offen offset:3072
    s_add_u32 s40, s40, 4096
    s_waitcnt lgkmcnt(6)
    v_mfma_f32_16x16x32_bf16 v[40:43], v[184:187], v[104:107], v[40:43]
    v_mfma_f32_16x16x32_bf16 v[68:71], v[184:187], v[108:111], v[68:71]
    ds_read_b128 v[212:215], v15 offset:25600
    s_waitcnt vmcnt(22)
    s_waitcnt lgkmcnt(6)
    v_mfma_f32_16x16x32_bf16 v[16:19], v[188:191], v[112:115], v[16:19]
    v_mfma_f32_16x16x32_bf16 v[44:47], v[188:191], v[116:119], v[44:47]
    ds_read_b128 v[160:163], v15 offset:26624
    s_waitcnt lgkmcnt(6)
    v_mfma_f32_16x16x32_bf16 v[20:23], v[192:195], v[112:115], v[20:23]
    v_mfma_f32_16x16x32_bf16 v[48:51], v[192:195], v[116:119], v[48:51]
    ds_read_b128 v[164:167], v15 offset:27648
    s_add_u32 s41, s47, 8192
    buffer_load_dwordx4 v[72:75], v2, s[12:15], s41 offen offset:3072 sc1
    s_add_u32 s41, s48, 8192
    buffer_load_dwordx4 v[76:79], v2, s[12:15], s41 offen offset:3072 sc1
    s_waitcnt lgkmcnt(6)
    v_mfma_f32_16x16x32_bf16 v[24:27], v[196:199], v[112:115], v[24:27]
    v_mfma_f32_16x16x32_bf16 v[52:55], v[196:199], v[116:119], v[52:55]
    ds_read_b128 v[168:171], v15 offset:28672
    buffer_load_dwordx4 a[48:51], v2, s[12:15], s40 offen offset:0
    s_waitcnt lgkmcnt(6)
    v_mfma_f32_16x16x32_bf16 v[28:31], v[200:203], v[112:115], v[28:31]
    v_mfma_f32_16x16x32_bf16 v[56:59], v[200:203], v[116:119], v[56:59]
    ds_read_b128 v[172:175], v15 offset:29696
    buffer_load_dwordx4 a[52:55], v2, s[12:15], s40 offen offset:1024
    s_waitcnt lgkmcnt(6)
    v_mfma_f32_16x16x32_bf16 v[32:35], v[204:207], v[112:115], v[32:35]
    v_mfma_f32_16x16x32_bf16 v[60:63], v[204:207], v[116:119], v[60:63]
    ds_read_b128 v[176:179], v15 offset:30720
    s_waitcnt lgkmcnt(6)
    v_mfma_f32_16x16x32_bf16 v[36:39], v[208:211], v[112:115], v[36:39]
    v_mfma_f32_16x16x32_bf16 v[64:67], v[208:211], v[116:119], v[64:67]
    ds_read_b128 v[180:183], v15 offset:31744
    buffer_load_dwordx4 a[56:59], v2, s[12:15], s40 offen offset:2048
    s_waitcnt lgkmcnt(6)
    v_mfma_f32_16x16x32_bf16 v[40:43], v[212:215], v[112:115], v[40:43]
    v_mfma_f32_16x16x32_bf16 v[68:71], v[212:215], v[116:119], v[68:71]
    ds_read_b128 v[184:187], v15 offset:32768
    s_waitcnt vmcnt(23)
    s_waitcnt lgkmcnt(6)
    v_mfma_f32_16x16x32_bf16 v[16:19], v[160:163], v[120:123], v[16:19]
    v_mfma_f32_16x16x32_bf16 v[44:47], v[160:163], v[124:127], v[44:47]
    ds_read_b128 v[188:191], v15 offset:33792
    s_waitcnt lgkmcnt(6)
    v_mfma_f32_16x16x32_bf16 v[20:23], v[164:167], v[120:123], v[20:23]
    v_mfma_f32_16x16x32_bf16 v[48:51], v[164:167], v[124:127], v[48:51]
    ds_read_b128 v[192:195], v15 offset:34816
    s_add_u32 s41, s47, 12288
    buffer_load_dwordx4 v[80:83], v2, s[12:15], s41 offen offset:0 sc1
    s_add_u32 s41, s48, 12288
    buffer_load_dwordx4 v[84:87], v2, s[12:15], s41 offen offset:0 sc1
    s_waitcnt lgkmcnt(6)
    v_mfma_f32_16x16x32_bf16 v[24:27], v[168:171], v[120:123], v[24:27]
    v_mfma_f32_16x16x32_bf16 v[52:55], v[168:171], v[124:127], v[52:55]
    ds_read_b128 v[196:199], v15 offset:35840
    buffer_load_dwordx4 a[60:63], v2, s[12:15], s40 offen offset:3072
    s_add_u32 s40, s40, 4096
    s_waitcnt lgkmcnt(6)
    v_mfma_f32_16x16x32_bf16 v[28:31], v[172:175], v[120:123], v[28:31]
    v_mfma_f32_16x16x32_bf16 v[56:59], v[172:175], v[124:127], v[56:59]
    ds_read_b128 v[200:203], v15 offset:36864
    buffer_load_dwordx4 a[64:67], v2, s[12:15], s40 offen offset:0
    s_waitcnt lgkmcnt(6)
    v_mfma_f32_16x16x32_bf16 v[32:35], v[176:179], v[120:123], v[32:35]
    v_mfma_f32_16x16x32_bf16 v[60:63], v[176:179], v[124:127], v[60:63]
    ds_read_b128 v[204:207], v15 offset:37888
    s_waitcnt lgkmcnt(6)
    v_mfma_f32_16x16x32_bf16 v[36:39], v[180:183], v[120:123], v[36:39]
    v_mfma_f32_16x16x32_bf16 v[64:67], v[180:183], v[124:127], v[64:67]
    ds_read_b128 v[208:211], v15 offset:38912
    buffer_load_dwordx4 a[68:71], v2, s[12:15], s40 offen offset:1024
    s_waitcnt lgkmcnt(6)
    v_mfma_f32_16x16x32_bf16 v[40:43], v[184:187], v[120:123], v[40:43]
    v_mfma_f32_16x16x32_bf16 v[68:71], v[184:187], v[124:127], v[68:71]
    ds_read_b128 v[212:215], v15 offset:39936
    s_waitcnt vmcnt(25)
    s_waitcnt lgkmcnt(6)
    v_mfma_f32_16x16x32_bf16 v[16:19], v[188:191], v[128:131], v[16:19]
    v_mfma_f32_16x16x32_bf16 v[44:47], v[188:191], v[132:135], v[44:47]
    ds_read_b128 v[160:163], v15 offset:40960
    s_waitcnt lgkmcnt(6)
    v_mfma_f32_16x16x32_bf16 v[20:23], v[192:195], v[128:131], v[20:23]
    v_mfma_f32_16x16x32_bf16 v[48:51], v[192:195], v[132:135], v[48:51]
    ds_read_b128 v[164:167], v15 offset:41984
    s_add_u32 s41, s47, 12288
    buffer_load_dwordx4 v[88:91], v2, s[12:15], s41 offen offset:1024 sc1
    s_add_u32 s41, s48, 12288
    buffer_load_dwordx4 v[92:95], v2, s[12:15], s41 offen offset:1024 sc1
    s_waitcnt lgkmcnt(6)
    v_mfma_f32_16x16x32_bf16 v[24:27], v[196:199], v[128:131], v[24:27]
    v_mfma_f32_16x16x32_bf16 v[52:55], v[196:199], v[132:135], v[52:55]
    ds_read_b128 v[168:171], v15 offset:43008
    buffer_load_dwordx4 a[72:75], v2, s[12:15], s40 offen offset:2048
    s_waitcnt lgkmcnt(6)
    v_mfma_f32_16x16x32_bf16 v[28:31], v[200:203], v[128:131], v[28:31]
    v_mfma_f32_16x16x32_bf16 v[56:59], v[200:203], v[132:135], v[56:59]
    ds_read_b128 v[172:175], v15 offset:44032
    buffer_load_dwordx4 a[76:79], v2, s[12:15], s40 offen offset:3072
    s_add_u32 s40, s40, 4096
    s_waitcnt lgkmcnt(6)
    v_mfma_f32_16x16x32_bf16 v[32:35], v[204:207], v[128:131], v[32:35]
    v_mfma_f32_16x16x32_bf16 v[60:63], v[204:207], v[132:135], v[60:63]
    ds_read_b128 v[176:179], v15 offset:45056
    s_waitcnt lgkmcnt(6)
    v_mfma_f32_16x16x32_bf16 v[36:39], v[208:211], v[128:131], v[36:39]
    v_mfma_f32_16x16x32_bf16 v[64:67], v[208:211], v[132:135], v[64:67]
    ds_read_b128 v[180:183], v15 offset:46080
    buffer_load_dwordx4 a[80:83], v2, s[12:15], s40 offen offset:0
    s_waitcnt lgkmcnt(6)
    v_mfma_f32_16x16x32_bf16 v[40:43], v[212:215], v[128:131], v[40:43]
    v_mfma_f32_16x16x32_bf16 v[68:71], v[212:215], v[132:135], v[68:71]
    ds_read_b128 v[184:187], v15 offset:47104
    s_waitcnt vmcnt(26)
    s_waitcnt lgkmcnt(6)
    v_mfma_f32_16x16x32_bf16 v[16:19], v[160:163], v[136:139], v[16:19]
    v_mfma_f32_16x16x32_bf16 v[44:47], v[160:163], v[140:143], v[44:47]
    ds_read_b128 v[188:191], v15 offset:48128
    s_waitcnt lgkmcnt(6)
    v_mfma_f32_16x16x32_bf16 v[20:23], v[164:167], v[136:139], v[20:23]
    v_mfma_f32_16x16x32_bf16 v[48:51], v[164:167], v[140:143], v[48:51]
    ds_read_b128 v[192:195], v15 offset:49152
    s_add_u32 s41, s47, 12288
    buffer_load_dwordx4 v[96:99], v2, s[12:15], s41 offen offset:2048 sc1
    s_add_u32 s41, s48, 12288
    buffer_load_dwordx4 v[100:103], v2, s[12:15], s41 offen offset:2048 sc1
    s_waitcnt lgkmcnt(6)
    v_mfma_f32_16x16x32_bf16 v[24:27], v[168:171], v[136:139], v[24:27]
    v_mfma_f32_16x16x32_bf16 v[52:55], v[168:171], v[140:143], v[52:55]
    ds_read_b128 v[196:199], v15 offset:50176
    buffer_load_dwordx4 a[84:87], v2, s[12:15], s40 offen offset:1024
    s_waitcnt lgkmcnt(6)
    v_mfma_f32_16x16x32_bf16 v[28:31], v[172:175], v[136:139], v[28:31]
    v_mfma_f32_16x16x32_bf16 v[56:59], v[172:175], v[140:143], v[56:59]
    ds_read_b128 v[200:203], v15 offset:51200
    buffer_load_dwordx4 a[88:91], v2, s[12:15], s40 offen offset:2048
    s_waitcnt lgkmcnt(6)
    v_mfma_f32_16x16x32_bf16 v[32:35], v[176:179], v[136:139], v[32:35]
    v_mfma_f32_16x16x32_bf16 v[60:63], v[176:179], v[140:143], v[60:63]
    ds_read_b128 v[204:207], v15 offset:52224
    s_waitcnt lgkmcnt(6)
    v_mfma_f32_16x16x32_bf16 v[36:39], v[180:183], v[136:139], v[36:39]
    v_mfma_f32_16x16x32_bf16 v[64:67], v[180:183], v[140:143], v[64:67]
    ds_read_b128 v[208:211], v15 offset:53248
    buffer_load_dwordx4 a[92:95], v2, s[12:15], s40 offen offset:3072
    s_add_u32 s40, s40, 4096
    s_waitcnt lgkmcnt(6)
    v_mfma_f32_16x16x32_bf16 v[40:43], v[184:187], v[136:139], v[40:43]
    v_mfma_f32_16x16x32_bf16 v[68:71], v[184:187], v[140:143], v[68:71]
    ds_read_b128 v[212:215], v15 offset:54272
    s_waitcnt vmcnt(28)
    s_waitcnt lgkmcnt(6)
    v_mfma_f32_16x16x32_bf16 v[16:19], v[188:191], v[144:147], v[16:19]
    v_mfma_f32_16x16x32_bf16 v[44:47], v[188:191], v[148:151], v[44:47]
    ds_read_b128 v[160:163], v15 offset:55296
    s_waitcnt lgkmcnt(6)
    v_mfma_f32_16x16x32_bf16 v[20:23], v[192:195], v[144:147], v[20:23]
    v_mfma_f32_16x16x32_bf16 v[48:51], v[192:195], v[148:151], v[48:51]
    ds_read_b128 v[164:167], v15 offset:56320
    s_add_u32 s41, s47, 12288
    buffer_load_dwordx4 v[104:107], v2, s[12:15], s41 offen offset:3072 sc1
    s_add_u32 s41, s48, 12288
    buffer_load_dwordx4 v[108:111], v2, s[12:15], s41 offen offset:3072 sc1
    s_waitcnt lgkmcnt(6)
    v_mfma_f32_16x16x32_bf16 v[24:27], v[196:199], v[144:147], v[24:27]
    v_mfma_f32_16x16x32_bf16 v[52:55], v[196:199], v[148:151], v[52:55]
    ds_read_b128 v[168:171], v15 offset:57344
    buffer_load_dwordx4 a[96:99], v2, s[12:15], s40 offen offset:0
    s_waitcnt lgkmcnt(6)
    v_mfma_f32_16x16x32_bf16 v[28:31], v[200:203], v[144:147], v[28:31]
    v_mfma_f32_16x16x32_bf16 v[56:59], v[200:203], v[148:151], v[56:59]
    ds_read_b128 v[172:175], v15 offset:58368
    buffer_load_dwordx4 a[100:103], v2, s[12:15], s40 offen offset:1024
    s_waitcnt lgkmcnt(6)
    v_mfma_f32_16x16x32_bf16 v[32:35], v[204:207], v[144:147], v[32:35]
    v_mfma_f32_16x16x32_bf16 v[60:63], v[204:207], v[148:151], v[60:63]
    ds_read_b128 v[176:179], v15 offset:59392
    s_waitcnt lgkmcnt(6)
    v_mfma_f32_16x16x32_bf16 v[36:39], v[208:211], v[144:147], v[36:39]
    v_mfma_f32_16x16x32_bf16 v[64:67], v[208:211], v[148:151], v[64:67]
    ds_read_b128 v[180:183], v15 offset:60416
    buffer_load_dwordx4 a[104:107], v2, s[12:15], s40 offen offset:2048
    s_waitcnt lgkmcnt(6)
    v_mfma_f32_16x16x32_bf16 v[40:43], v[212:215], v[144:147], v[40:43]
    v_mfma_f32_16x16x32_bf16 v[68:71], v[212:215], v[148:151], v[68:71]
    ds_read_b128 v[184:187], v15 offset:61440
    s_waitcnt vmcnt(28)
    s_waitcnt lgkmcnt(6)
    v_mfma_f32_16x16x32_bf16 v[16:19], v[160:163], v[152:155], v[16:19]
    v_mfma_f32_16x16x32_bf16 v[44:47], v[160:163], v[156:159], v[44:47]
    ds_read_b128 v[188:191], v15 offset:62464
    s_waitcnt lgkmcnt(6)
    v_mfma_f32_16x16x32_bf16 v[20:23], v[164:167], v[152:155], v[20:23]
    v_mfma_f32_16x16x32_bf16 v[48:51], v[164:167], v[156:159], v[48:51]
    ds_read_b128 v[192:195], v15 offset:63488
    s_add_u32 s41, s47, 16384
    buffer_load_dwordx4 v[112:115], v2, s[12:15], s41 offen offset:0 sc1
    s_add_u32 s41, s48, 16384
    buffer_load_dwordx4 v[116:119], v2, s[12:15], s41 offen offset:0 sc1
    s_waitcnt lgkmcnt(6)
    v_mfma_f32_16x16x32_bf16 v[24:27], v[168:171], v[152:155], v[24:27]
    v_mfma_f32_16x16x32_bf16 v[52:55], v[168:171], v[156:159], v[52:55]
    ds_read_b128 v[196:199], v15 offset:64512
    buffer_load_dwordx4 a[108:111], v2, s[12:15], s40 offen offset:3072
    s_add_u32 s40, s40, 4096
    s_waitcnt lgkmcnt(6)
    v_mfma_f32_16x16x32_bf16 v[28:31], v[172:175], v[152:155], v[28:31]
    v_mfma_f32_16x16x32_bf16 v[56:59], v[172:175], v[156:159], v[56:59]
    ds_read_b128 v[200:203], v11 offset:0
    buffer_load_dwordx4 a[112:115], v2, s[12:15], s40 offen offset:0
    s_waitcnt lgkmcnt(6)
    v_mfma_f32_16x16x32_bf16 v[32:35], v[176:179], v[152:155], v[32:35]
    v_mfma_f32_16x16x32_bf16 v[60:63], v[176:179], v[156:159], v[60:63]
    ds_read_b128 v[204:207], v11 offset:1024
    s_waitcnt lgkmcnt(6)
    v_mfma_f32_16x16x32_bf16 v[36:39], v[180:183], v[152:155], v[36:39]
    v_mfma_f32_16x16x32_bf16 v[64:67], v[180:183], v[156:159], v[64:67]
    ds_read_b128 v[208:211], v11 offset:2048
    buffer_load_dwordx4 a[116:119], v2, s[12:15], s40 offen offset:1024
    s_waitcnt lgkmcnt(6)
    v_mfma_f32_16x16x32_bf16 v[40:43], v[184:187], v[152:155], v[40:43]
    v_mfma_f32_16x16x32_bf16 v[68:71], v[184:187], v[156:159], v[68:71]
    ds_read_b128 v[212:215], v11 offset:3072
    s_waitcnt vmcnt(28)
    s_waitcnt lgkmcnt(6)
    v_mfma_f32_16x16x32_bf16 v[16:19], v[188:191], v[72:75], v[16:19]
    v_mfma_f32_16x16x32_bf16 v[44:47], v[188:191], v[76:79], v[44:47]
    ds_read_b128 v[160:163], v11 offset:4096
    s_waitcnt lgkmcnt(6)
    v_mfma_f32_16x16x32_bf16 v[20:23], v[192:195], v[72:75], v[20:23]
    v_mfma_f32_16x16x32_bf16 v[48:51], v[192:195], v[76:79], v[48:51]
    ds_read_b128 v[164:167], v11 offset:5120
    s_add_u32 s41, s47, 16384
    buffer_load_dwordx4 v[120:123], v2, s[12:15], s41 offen offset:1024 sc1
    s_add_u32 s41, s48, 16384
    buffer_load_dwordx4 v[124:127], v2, s[12:15], s41 offen offset:1024 sc1
    s_waitcnt lgkmcnt(6)
    v_mfma_f32_16x16x32_bf16 v[24:27], v[196:199], v[72:75], v[24:27]
    v_mfma_f32_16x16x32_bf16 v[52:55], v[196:199], v[76:79], v[52:55]
    ds_read_b128 v[168:171], v11 offset:6144
    buffer_load_dwordx4 a[120:123], v2, s[12:15], s40 offen offset:2048
    s_waitcnt lgkmcnt(6)
    v_mfma_f32_16x16x32_bf16 v[28:31], v[200:203], v[72:75], v[28:31]
    v_mfma_f32_16x16x32_bf16 v[56:59], v[200:203], v[76:79], v[56:59]
    ds_read_b128 v[172:175], v11 offset:7168
    buffer_load_dwordx4 a[124:127], v2, s[12:15], s40 offen offset:3072
    s_add_u32 s40, s40, 4096
    s_waitcnt lgkmcnt(6)
    v_mfma_f32_16x16x32_bf16 v[32:35], v[204:207], v[72:75], v[32:35]
    v_mfma_f32_16x16x32_bf16 v[60:63], v[204:207], v[76:79], v[60:63]
    ds_read_b128 v[176:179], v11 offset:8192
    s_waitcnt lgkmcnt(6)
    v_mfma_f32_16x16x32_bf16 v[36:39], v[208:211], v[72:75], v[36:39]
    v_mfma_f32_16x16x32_bf16 v[64:67], v[208:211], v[76:79], v[64:67]
    ds_read_b128 v[180:183], v11 offset:9216
    buffer_load_dwordx4 a[128:131], v2, s[12:15], s40 offen offset:0
    s_waitcnt lgkmcnt(6)
    v_mfma_f32_16x16x32_bf16 v[40:43], v[212:215], v[72:75], v[40:43]
    v_mfma_f32_16x16x32_bf16 v[68:71], v[212:215], v[76:79], v[68:71]
    ds_read_b128 v[184:187], v11 offset:10240
    s_waitcnt vmcnt(28)
    s_waitcnt lgkmcnt(6)
    v_mfma_f32_16x16x32_bf16 v[16:19], v[160:163], v[80:83], v[16:19]
    v_mfma_f32_16x16x32_bf16 v[44:47], v[160:163], v[84:87], v[44:47]
    ds_read_b128 v[188:191], v11 offset:11264
    s_waitcnt lgkmcnt(6)
    v_mfma_f32_16x16x32_bf16 v[20:23], v[164:167], v[80:83], v[20:23]
    v_mfma_f32_16x16x32_bf16 v[48:51], v[164:167], v[84:87], v[48:51]
    ds_read_b128 v[192:195], v11 offset:12288
    s_add_u32 s41, s47, 16384
    buffer_load_dwordx4 v[128:131], v2, s[12:15], s41 offen offset:2048 sc1
    s_add_u32 s41, s48, 16384
    buffer_load_dwordx4 v[132:135], v2, s[12:15], s41 offen offset:2048 sc1
    s_waitcnt lgkmcnt(6)
    v_mfma_f32_16x16x32_bf16 v[24:27], v[168:171], v[80:83], v[24:27]
    v_mfma_f32_16x16x32_bf16 v[52:55], v[168:171], v[84:87], v[52:55]
    ds_read_b128 v[196:199], v11 offset:13312
    buffer_load_dwordx4 a[132:135], v2, s[12:15], s40 offen offset:1024
    s_waitcnt lgkmcnt(6)
    v_mfma_f32_16x16x32_bf16 v[28:31], v[172:175], v[80:83], v[28:31]
    v_mfma_f32_16x16x32_bf16 v[56:59], v[172:175], v[84:87], v[56:59]
    ds_read_b128 v[200:203], v11 offset:14336
    buffer_load_dwordx4 a[136:139], v2, s[12:15], s40 offen offset:2048
    s_waitcnt lgkmcnt(6)
    v_mfma_f32_16x16x32_bf16 v[32:35], v[176:179], v[80:83], v[32:35]
    v_mfma_f32_16x16x32_bf16 v[60:63], v[176:179], v[84:87], v[60:63]
    ds_read_b128 v[204:207], v11 offset:15360
    s_waitcnt lgkmcnt(6)
    v_mfma_f32_16x16x32_bf16 v[36:39], v[180:183], v[80:83], v[36:39]
    v_mfma_f32_16x16x32_bf16 v[64:67], v[180:183], v[84:87], v[64:67]
    ds_read_b128 v[208:211], v11 offset:16384
    buffer_load_dwordx4 a[140:143], v2, s[12:15], s40 offen offset:3072
    s_add_u32 s40, s40, 4096
    s_waitcnt lgkmcnt(6)
    v_mfma_f32_16x16x32_bf16 v[40:43], v[184:187], v[80:83], v[40:43]
    v_mfma_f32_16x16x32_bf16 v[68:71], v[184:187], v[84:87], v[68:71]
    ds_read_b128 v[212:215], v11 offset:17408
    buffer_load_dwordx4 a[144:147], v2, s[12:15], s40 offen offset:0
    s_waitcnt vmcnt(29)
    s_waitcnt lgkmcnt(6)
    v_mfma_f32_16x16x32_bf16 v[16:19], v[188:191], v[88:91], v[16:19]
    v_mfma_f32_16x16x32_bf16 v[44:47], v[188:191], v[92:95], v[44:47]
    ds_read_b128 v[160:163], v11 offset:18432
    s_waitcnt lgkmcnt(6)
    v_mfma_f32_16x16x32_bf16 v[20:23], v[192:195], v[88:91], v[20:23]
    v_mfma_f32_16x16x32_bf16 v[48:51], v[192:195], v[92:95], v[48:51]
    ds_read_b128 v[164:167], v11 offset:19456
    s_add_u32 s41, s47, 16384
    buffer_load_dwordx4 v[136:139], v2, s[12:15], s41 offen offset:3072 sc1
    s_add_u32 s41, s48, 16384
    buffer_load_dwordx4 v[140:143], v2, s[12:15], s41 offen offset:3072 sc1
    s_waitcnt lgkmcnt(6)
    v_mfma_f32_16x16x32_bf16 v[24:27], v[196:199], v[88:91], v[24:27]
    v_mfma_f32_16x16x32_bf16 v[52:55], v[196:199], v[92:95], v[52:55]
    ds_read_b128 v[168:171], v11 offset:20480
    buffer_load_dwordx4 a[148:151], v2, s[12:15], s40 offen offset:1024
    s_waitcnt lgkmcnt(6)
    v_mfma_f32_16x16x32_bf16 v[28:31], v[200:203], v[88:91], v[28:31]
    v_mfma_f32_16x16x32_bf16 v[56:59], v[200:203], v[92:95], v[56:59]
    ds_read_b128 v[172:175], v11 offset:21504
    buffer_load_dwordx4 a[152:155], v2, s[12:15], s40 offen offset:2048
    s_waitcnt lgkmcnt(6)
    v_mfma_f32_16x16x32_bf16 v[32:35], v[204:207], v[88:91], v[32:35]
    v_mfma_f32_16x16x32_bf16 v[60:63], v[204:207], v[92:95], v[60:63]
    ds_read_b128 v[176:179], v11 offset:22528
    s_waitcnt lgkmcnt(6)
    v_mfma_f32_16x16x32_bf16 v[36:39], v[208:211], v[88:91], v[36:39]
    v_mfma_f32_16x16x32_bf16 v[64:67], v[208:211], v[92:95], v[64:67]
    ds_read_b128 v[180:183], v11 offset:23552
    buffer_load_dwordx4 a[156:159], v2, s[12:15], s40 offen offset:3072
    s_add_u32 s40, s40, 4096
    s_waitcnt lgkmcnt(6)
    v_mfma_f32_16x16x32_bf16 v[40:43], v[212:215], v[88:91], v[40:43]
    v_mfma_f32_16x16x32_bf16 v[68:71], v[212:215], v[92:95], v[68:71]
    ds_read_b128 v[184:187], v14 offset:0
    buffer_load_dwordx4 a[160:163], v2, s[12:15], s40 offen offset:0
    s_add_u32 s48, s54, 368640
    buffer_load_dwordx4 v[228:231], v254, s[12:15], s48 offen sc1
    buffer_load_dwordx4 v[232:235], v254, s[12:15], s48 offen offset:1024 sc1
    buffer_load_dwordx2 v[236:237], v8, s[12:15], s48 offen offset:2048 sc1
    s_waitcnt vmcnt(33)
    s_waitcnt lgkmcnt(6)
    v_mfma_f32_16x16x32_bf16 v[16:19], v[160:163], v[96:99], v[16:19]
    v_mfma_f32_16x16x32_bf16 v[44:47], v[160:163], v[100:103], v[44:47]
    ds_read_b128 v[188:191], v14 offset:1024
    s_waitcnt lgkmcnt(6)
    v_mfma_f32_16x16x32_bf16 v[20:23], v[164:167], v[96:99], v[20:23]
    v_mfma_f32_16x16x32_bf16 v[48:51], v[164:167], v[100:103], v[48:51]
    ds_read_b128 v[192:195], v14 offset:2048
    s_waitcnt lgkmcnt(6)
    v_mfma_f32_16x16x32_bf16 v[24:27], v[168:171], v[96:99], v[24:27]
    v_mfma_f32_16x16x32_bf16 v[52:55], v[168:171], v[100:103], v[52:55]
    ds_read_b128 v[196:199], v14 offset:3072
    buffer_load_dwordx4 a[164:167], v2, s[12:15], s40 offen offset:1024
    s_waitcnt lgkmcnt(6)
    v_mfma_f32_16x16x32_bf16 v[28:31], v[172:175], v[96:99], v[28:31]
    v_mfma_f32_16x16x32_bf16 v[56:59], v[172:175], v[100:103], v[56:59]
    ds_read_b128 v[200:203], v14 offset:4096
    buffer_load_dwordx4 a[168:171], v2, s[12:15], s40 offen offset:2048
    s_waitcnt lgkmcnt(6)
    v_mfma_f32_16x16x32_bf16 v[32:35], v[176:179], v[96:99], v[32:35]
    v_mfma_f32_16x16x32_bf16 v[60:63], v[176:179], v[100:103], v[60:63]
    ds_read_b128 v[204:207], v14 offset:5120
    s_waitcnt lgkmcnt(6)
    v_mfma_f32_16x16x32_bf16 v[36:39], v[180:183], v[96:99], v[36:39]
    v_mfma_f32_16x16x32_bf16 v[64:67], v[180:183], v[100:103], v[64:67]
    ds_read_b128 v[208:211], v14 offset:6144
    buffer_load_dwordx4 a[172:175], v2, s[12:15], s40 offen offset:3072
    s_add_u32 s40, s40, 4096
    s_waitcnt lgkmcnt(6)
    v_mfma_f32_16x16x32_bf16 v[40:43], v[184:187], v[96:99], v[40:43]
    v_mfma_f32_16x16x32_bf16 v[68:71], v[184:187], v[100:103], v[68:71]
    ds_read_b128 v[212:215], v14 offset:7168
    buffer_load_dwordx4 a[176:179], v2, s[12:15], s40 offen offset:0
    s_add_u32 s48, s54, 20480
    buffer_load_dwordx4 v[238:241], v254, s[12:15], s48 offen sc1
    buffer_load_dwordx4 v[242:245], v254, s[12:15], s48 offen offset:1024 sc1
    buffer_load_dwordx2 v[246:247], v8, s[12:15], s48 offen offset:2048 sc1
    s_waitcnt vmcnt(35)
    s_waitcnt lgkmcnt(6)
    v_mfma_f32_16x16x32_bf16 v[16:19], v[188:191], v[104:107], v[16:19]
    v_mfma_f32_16x16x32_bf16 v[44:47], v[188:191], v[108:111], v[44:47]
    ds_read_b128 v[160:163], v14 offset:8192
    s_waitcnt lgkmcnt(6)
    v_mfma_f32_16x16x32_bf16 v[20:23], v[192:195], v[104:107], v[20:23]
    v_mfma_f32_16x16x32_bf16 v[48:51], v[192:195], v[108:111], v[48:51]
    ds_read_b128 v[164:167], v14 offset:9216
    s_waitcnt lgkmcnt(6)
    v_mfma_f32_16x16x32_bf16 v[24:27], v[196:199], v[104:107], v[24:27]
    v_mfma_f32_16x16x32_bf16 v[52:55], v[196:199], v[108:111], v[52:55]
    ds_read_b128 v[168:171], v14 offset:10240
    buffer_load_dwordx4 a[180:183], v2, s[12:15], s40 offen offset:1024
    s_waitcnt lgkmcnt(6)
    v_mfma_f32_16x16x32_bf16 v[28:31], v[200:203], v[104:107], v[28:31]
    v_mfma_f32_16x16x32_bf16 v[56:59], v[200:203], v[108:111], v[56:59]
    ds_read_b128 v[172:175], v14 offset:11264
    buffer_load_dwordx4 a[184:187], v2, s[12:15], s40 offen offset:2048
    s_waitcnt lgkmcnt(6)
    v_mfma_f32_16x16x32_bf16 v[32:35], v[204:207], v[104:107], v[32:35]
    v_mfma_f32_16x16x32_bf16 v[60:63], v[204:207], v[108:111], v[60:63]
    ds_read_b128 v[176:179], v14 offset:12288
    s_waitcnt lgkmcnt(6)
    v_mfma_f32_16x16x32_bf16 v[36:39], v[208:211], v[104:107], v[36:39]
    v_mfma_f32_16x16x32_bf16 v[64:67], v[208:211], v[108:111], v[64:67]
    ds_read_b128 v[180:183], v14 offset:13312
    buffer_load_dwordx4 a[188:191], v2, s[12:15], s40 offen offset:3072
    s_add_u32 s40, s40, 4096
    s_waitcnt lgkmcnt(6)
    v_mfma_f32_16x16x32_bf16 v[40:43], v[212:215], v[104:107], v[40:43]
    v_mfma_f32_16x16x32_bf16 v[68:71], v[212:215], v[108:111], v[68:71]
    ds_read_b128 v[184:187], v14 offset:14336
    buffer_load_dwordx4 a[192:195], v2, s[12:15], s40 offen offset:0
    s_waitcnt vmcnt(34)
    s_waitcnt lgkmcnt(6)
    v_mfma_f32_16x16x32_bf16 v[16:19], v[160:163], v[112:115], v[16:19]
    v_mfma_f32_16x16x32_bf16 v[44:47], v[160:163], v[116:119], v[44:47]
    ds_read_b128 v[188:191], v14 offset:15360
    s_waitcnt lgkmcnt(6)
    v_mfma_f32_16x16x32_bf16 v[20:23], v[164:167], v[112:115], v[20:23]
    v_mfma_f32_16x16x32_bf16 v[48:51], v[164:167], v[116:119], v[48:51]
    ds_read_b128 v[192:195], v14 offset:16384
    s_waitcnt lgkmcnt(6)
    v_mfma_f32_16x16x32_bf16 v[24:27], v[168:171], v[112:115], v[24:27]
    v_mfma_f32_16x16x32_bf16 v[52:55], v[168:171], v[116:119], v[52:55]
    ds_read_b128 v[196:199], v14 offset:17408
    buffer_load_dwordx4 a[196:199], v2, s[12:15], s40 offen offset:1024
    s_waitcnt lgkmcnt(6)
    v_mfma_f32_16x16x32_bf16 v[28:31], v[172:175], v[112:115], v[28:31]
    v_mfma_f32_16x16x32_bf16 v[56:59], v[172:175], v[116:119], v[56:59]
    ds_read_b128 v[200:203], v14 offset:18432
    buffer_load_dwordx4 a[200:203], v2, s[12:15], s40 offen offset:2048
    s_waitcnt lgkmcnt(6)
    v_mfma_f32_16x16x32_bf16 v[32:35], v[176:179], v[112:115], v[32:35]
    v_mfma_f32_16x16x32_bf16 v[60:63], v[176:179], v[116:119], v[60:63]
    ds_read_b128 v[204:207], v14 offset:19456
    s_waitcnt lgkmcnt(6)
    v_mfma_f32_16x16x32_bf16 v[36:39], v[180:183], v[112:115], v[36:39]
    v_mfma_f32_16x16x32_bf16 v[64:67], v[180:183], v[116:119], v[64:67]
    ds_read_b128 v[208:211], v14 offset:20480
    buffer_load_dwordx4 a[204:207], v2, s[12:15], s40 offen offset:3072
    s_add_u32 s40, s40, 4096
    s_waitcnt lgkmcnt(6)
    v_mfma_f32_16x16x32_bf16 v[40:43], v[184:187], v[112:115], v[40:43]
    v_mfma_f32_16x16x32_bf16 v[68:71], v[184:187], v[116:119], v[68:71]
    ds_read_b128 v[212:215], v14 offset:21504
    buffer_load_dwordx4 a[208:211], v2, s[12:15], s40 offen offset:0
    s_waitcnt vmcnt(33)
    s_waitcnt lgkmcnt(6)
    v_mfma_f32_16x16x32_bf16 v[16:19], v[188:191], v[120:123], v[16:19]
    v_mfma_f32_16x16x32_bf16 v[44:47], v[188:191], v[124:127], v[44:47]
    ds_read_b128 v[160:163], v14 offset:22528
    s_waitcnt lgkmcnt(6)
    v_mfma_f32_16x16x32_bf16 v[20:23], v[192:195], v[120:123], v[20:23]
    v_mfma_f32_16x16x32_bf16 v[48:51], v[192:195], v[124:127], v[48:51]
    ds_read_b128 v[164:167], v14 offset:23552
    s_waitcnt lgkmcnt(6)
    v_mfma_f32_16x16x32_bf16 v[24:27], v[196:199], v[120:123], v[24:27]
    v_mfma_f32_16x16x32_bf16 v[52:55], v[196:199], v[124:127], v[52:55]
    ds_read_b128 v[168:171], v14 offset:24576
    buffer_load_dwordx4 a[212:215], v2, s[12:15], s40 offen offset:1024
    s_waitcnt lgkmcnt(6)
    v_mfma_f32_16x16x32_bf16 v[28:31], v[200:203], v[120:123], v[28:31]
    v_mfma_f32_16x16x32_bf16 v[56:59], v[200:203], v[124:127], v[56:59]
    ds_read_b128 v[172:175], v14 offset:25600
    buffer_load_dwordx4 a[216:219], v2, s[12:15], s40 offen offset:2048
    s_waitcnt lgkmcnt(6)
    v_mfma_f32_16x16x32_bf16 v[32:35], v[204:207], v[120:123], v[32:35]
    v_mfma_f32_16x16x32_bf16 v[60:63], v[204:207], v[124:127], v[60:63]
    ds_read_b128 v[176:179], v14 offset:26624
    s_waitcnt lgkmcnt(6)
    v_mfma_f32_16x16x32_bf16 v[36:39], v[208:211], v[120:123], v[36:39]
    v_mfma_f32_16x16x32_bf16 v[64:67], v[208:211], v[124:127], v[64:67]
    ds_read_b128 v[180:183], v14 offset:27648
    buffer_load_dwordx4 a[220:223], v2, s[12:15], s40 offen offset:3072
    s_add_u32 s40, s40, 4096
    s_waitcnt lgkmcnt(6)
    v_mfma_f32_16x16x32_bf16 v[40:43], v[212:215], v[120:123], v[40:43]
    v_mfma_f32_16x16x32_bf16 v[68:71], v[212:215], v[124:127], v[68:71]
    ds_read_b128 v[184:187], v14 offset:28672
    buffer_load_dwordx4 a[224:227], v2, s[12:15], s40 offen offset:0
    s_waitcnt vmcnt(32)
    s_waitcnt lgkmcnt(6)
    v_mfma_f32_16x16x32_bf16 v[16:19], v[160:163], v[128:131], v[16:19]
    v_mfma_f32_16x16x32_bf16 v[44:47], v[160:163], v[132:135], v[44:47]
    ds_read_b128 v[188:191], v14 offset:29696
    s_waitcnt lgkmcnt(6)
    v_mfma_f32_16x16x32_bf16 v[20:23], v[164:167], v[128:131], v[20:23]
    v_mfma_f32_16x16x32_bf16 v[48:51], v[164:167], v[132:135], v[48:51]
    ds_read_b128 v[192:195], v14 offset:30720
    s_waitcnt lgkmcnt(6)
    v_mfma_f32_16x16x32_bf16 v[24:27], v[168:171], v[128:131], v[24:27]
    v_mfma_f32_16x16x32_bf16 v[52:55], v[168:171], v[132:135], v[52:55]
    ds_read_b128 v[196:199], v14 offset:31744
    buffer_load_dwordx4 a[228:231], v2, s[12:15], s40 offen offset:1024
    s_waitcnt lgkmcnt(6)
    v_mfma_f32_16x16x32_bf16 v[28:31], v[172:175], v[128:131], v[28:31]
    v_mfma_f32_16x16x32_bf16 v[56:59], v[172:175], v[132:135], v[56:59]
    ds_read_b128 v[200:203], v14 offset:32768
    buffer_load_dwordx4 a[232:235], v2, s[12:15], s40 offen offset:2048
    s_waitcnt lgkmcnt(6)
    v_mfma_f32_16x16x32_bf16 v[32:35], v[176:179], v[128:131], v[32:35]
    v_mfma_f32_16x16x32_bf16 v[60:63], v[176:179], v[132:135], v[60:63]
    ds_read_b128 v[204:207], v14 offset:33792
    s_waitcnt lgkmcnt(6)
    v_mfma_f32_16x16x32_bf16 v[36:39], v[180:183], v[128:131], v[36:39]
    v_mfma_f32_16x16x32_bf16 v[64:67], v[180:183], v[132:135], v[64:67]
    ds_read_b128 v[208:211], v14 offset:34816
    buffer_load_dwordx4 a[236:239], v2, s[12:15], s40 offen offset:3072
    s_add_u32 s40, s40, 4096
    s_waitcnt lgkmcnt(6)
    v_mfma_f32_16x16x32_bf16 v[40:43], v[184:187], v[128:131], v[40:43]
    v_mfma_f32_16x16x32_bf16 v[68:71], v[184:187], v[132:135], v[68:71]
    ds_read_b128 v[212:215], v14 offset:35840
    buffer_load_dwordx4 a[240:243], v2, s[12:15], s40 offen offset:0
    s_waitcnt vmcnt(30)
    s_waitcnt lgkmcnt(6)
    v_mfma_f32_16x16x32_bf16 v[16:19], v[188:191], v[136:139], v[16:19]
    v_mfma_f32_16x16x32_bf16 v[44:47], v[188:191], v[140:143], v[44:47]
    s_waitcnt lgkmcnt(5)
    v_mfma_f32_16x16x32_bf16 v[20:23], v[192:195], v[136:139], v[20:23]
    v_mfma_f32_16x16x32_bf16 v[48:51], v[192:195], v[140:143], v[48:51]
    s_waitcnt lgkmcnt(4)
    v_mfma_f32_16x16x32_bf16 v[24:27], v[196:199], v[136:139], v[24:27]
    v_mfma_f32_16x16x32_bf16 v[52:55], v[196:199], v[140:143], v[52:55]
    buffer_load_dwordx4 a[244:247], v2, s[12:15], s40 offen offset:1024
    s_waitcnt lgkmcnt(3)
    v_mfma_f32_16x16x32_bf16 v[28:31], v[200:203], v[136:139], v[28:31]
    v_mfma_f32_16x16x32_bf16 v[56:59], v[200:203], v[140:143], v[56:59]
    buffer_load_dwordx4 a[248:251], v2, s[12:15], s40 offen offset:2048
    s_waitcnt lgkmcnt(2)
    v_mfma_f32_16x16x32_bf16 v[32:35], v[204:207], v[136:139], v[32:35]
    v_mfma_f32_16x16x32_bf16 v[60:63], v[204:207], v[140:143], v[60:63]
    s_waitcnt lgkmcnt(1)
    v_mfma_f32_16x16x32_bf16 v[36:39], v[208:211], v[136:139], v[36:39]
    v_mfma_f32_16x16x32_bf16 v[64:67], v[208:211], v[140:143], v[64:67]
    buffer_load_dwordx4 a[252:255], v2, s[12:15], s40 offen offset:3072
    s_add_u32 s40, s40, 4096
    s_waitcnt lgkmcnt(0)
    v_mfma_f32_16x16x32_bf16 v[40:43], v[212:215], v[136:139], v[40:43]
    v_mfma_f32_16x16x32_bf16 v[68:71], v[212:215], v[140:143], v[68:71]
    v_add_f32 v224, v216, v218
    v_add_f32 v225, v217, v219
    v_mov_b32 v216, v224
    v_mov_b32 v217, v225
    s_nop 1
    v_permlane32_swap_b32 v216, v224
    v_permlane32_swap_b32 v217, v225
    s_nop 0
    v_add_f32 v224, v224, v216
    v_add_f32 v225, v225, v217
    v_mov_b32 v216, v224
    v_mov_b32 v217, v225
    s_nop 1
    v_permlane16_swap_b32 v216, v224
    v_permlane16_swap_b32 v217, v225
    s_nop 0
    v_add_f32 v224, v224, v216
    v_add_f32 v225, v225, v217
    v_mul_f32 v224, 0x3acccccd, v224
    v_mul_f32 v225, 0x3acccccd, v225
    v_fma_f32 v225, -v224, v224, v225
    v_max_f32 v225, 0, v225
    v_cvt_pk_bf16_f32 v216, v224, v225
    v_lshlrev_b32 v224, 16, v216
    v_and_b32 v225, 0xffff0000, v216
    v_add_f32 v225, 0x3727c5ac, v225
    v_cvt_pk_bf16_f32 v216, v225, v225
    v_lshlrev_b32 v225, 16, v216
    v_sqrt_f32 v225, v225
    s_nop 0
    v_cvt_pk_bf16_f32 v216, v225, v225
    v_lshlrev_b32 v225, 16, v216
    v_rcp_f32 v225, v225
    s_nop 0
    v_mul_f32 v224, v224, v225
    v_sub_f32 v224, 0, v224
    v_add_f32 v226, v220, v222
    v_add_f32 v227, v221, v223
    v_mov_b32 v216, v226
    v_mov_b32 v217, v227
    s_nop 1
    v_permlane32_swap_b32 v216, v226
    v_permlane32_swap_b32 v217, v227
    s_nop 0
    v_add_f32 v226, v226, v216
    v_add_f32 v227, v227, v217
    v_mov_b32 v216, v226
    v_mov_b32 v217, v227
    s_nop 1
    v_permlane16_swap_b32 v216, v226
    v_permlane16_swap_b32 v217, v227
    s_nop 0
    v_add_f32 v226, v226, v216
    v_add_f32 v227, v227, v217
    v_mul_f32 v226, 0x3acccccd, v226
    v_mul_f32 v227, 0x3acccccd, v227
    v_fma_f32 v227, -v226, v226, v227
    v_max_f32 v227, 0, v227
    v_cvt_pk_bf16_f32 v216, v226, v227
    v_lshlrev_b32 v226, 16, v216
    v_and_b32 v227, 0xffff0000, v216
    v_add_f32 v227, 0x3727c5ac, v227
    v_cvt_pk_bf16_f32 v216, v227, v227
    v_lshlrev_b32 v227, 16, v216
    v_sqrt_f32 v227, v227
    s_nop 0
    v_cvt_pk_bf16_f32 v216, v227, v227
    v_lshlrev_b32 v227, 16, v216
    v_rcp_f32 v227, v227
    s_nop 0
    v_mul_f32 v226, v226, v227
    v_sub_f32 v226, 0, v226
    v_lshlrev_b32 v9, 4, v3
    v_add_u32 v9, 156672, v9
    v_mov_b32 v12, 0xbdd2d3e8
    v_mov_b32 v13, 0xc0135761
    ds_read_b128 v[72:75], v9 offset:0
    ds_read_b128 v[100:103], v9 offset:512
    ds_read_b128 v[76:79], v9 offset:64
    ds_read_b128 v[104:107], v9 offset:576
    ds_read_b128 v[80:83], v9 offset:128
    ds_read_b128 v[108:111], v9 offset:640
    ds_read_b128 v[84:87], v9 offset:192
    ds_read_b128 v[112:115], v9 offset:704
    ds_read_b128 v[88:91], v9 offset:256
    ds_read_b128 v[116:119], v9 offset:768
    ds_read_b128 v[92:95], v9 offset:320
    ds_read_b128 v[120:123], v9 offset:832
    ds_read_b128 v[96:99], v9 offset:384
    ds_read_b128 v[124:127], v9 offset:896
    s_waitcnt lgkmcnt(0)
    v_pk_add_f32 v[72:73], v[72:73], v[100:101]
    v_pk_add_f32 v[74:75], v[74:75], v[102:103]
    v_pk_add_f32 v[76:77], v[76:77], v[104:105]
    v_pk_add_f32 v[78:79], v[78:79], v[106:107]
    v_pk_add_f32 v[80:81], v[80:81], v[108:109]
    v_pk_add_f32 v[82:83], v[82:83], v[110:111]
    v_pk_add_f32 v[84:85], v[84:85], v[112:113]
    v_pk_add_f32 v[86:87], v[86:87], v[114:115]
    v_pk_add_f32 v[88:89], v[88:89], v[116:117]
    v_pk_add_f32 v[90:91], v[90:91], v[118:119]
    v_pk_add_f32 v[92:93], v[92:93], v[120:121]
    v_pk_add_f32 v[94:95], v[94:95], v[122:123]
    v_pk_add_f32 v[96:97], v[96:97], v[124:125]
    v_pk_add_f32 v[98:99], v[98:99], v[126:127]
    s_lshl_b32 s49, s34, 2
    s_add_u32 s49, s49, s30
    s_lshl_b32 s49, s49, 7
    s_add_u32 s49, s49, s37
    s_lshl_b32 s41, s35, 2
    s_add_u32 s49, s49, s41
    v_pk_mul_f32 v[160:161], v[72:73], v[224:225] op_sel_hi:[1,0]
    v_pk_mul_f32 v[162:163], v[74:75], v[224:225] op_sel_hi:[1,0]
    v_pk_mul_f32 v[164:165], v[72:73], v[226:227] op_sel_hi:[1,0]
    v_pk_mul_f32 v[166:167], v[74:75], v[226:227] op_sel_hi:[1,0]
    v_pk_mul_f32 v[168:169], v[76:77], v[224:225] op_sel_hi:[1,0]
    v_pk_mul_f32 v[170:171], v[78:79], v[224:225] op_sel_hi:[1,0]
    v_pk_mul_f32 v[172:173], v[76:77], v[226:227] op_sel_hi:[1,0]
    v_pk_mul_f32 v[174:175], v[78:79], v[226:227] op_sel_hi:[1,0]
    v_pk_fma_f32 v[16:17], v[16:17], v[224:225], v[160:161] op_sel:[0,1,0] op_sel_hi:[1,1,1]
    v_pk_fma_f32 v[18:19], v[18:19], v[224:225], v[162:163] op_sel:[0,1,0] op_sel_hi:[1,1,1]
    v_pk_fma_f32 v[44:45], v[44:45], v[226:227], v[164:165] op_sel:[0,1,0] op_sel_hi:[1,1,1]
    v_pk_fma_f32 v[46:47], v[46:47], v[226:227], v[166:167] op_sel:[0,1,0] op_sel_hi:[1,1,1]
    v_pk_fma_f32 v[20:21], v[20:21], v[224:225], v[168:169] op_sel:[0,1,0] op_sel_hi:[1,1,1]
    v_pk_fma_f32 v[22:23], v[22:23], v[224:225], v[170:171] op_sel:[0,1,0] op_sel_hi:[1,1,1]
    v_pk_fma_f32 v[48:49], v[48:49], v[226:227], v[172:173] op_sel:[0,1,0] op_sel_hi:[1,1,1]
    v_pk_fma_f32 v[50:51], v[50:51], v[226:227], v[174:175] op_sel:[0,1,0] op_sel_hi:[1,1,1]
    v_pk_mul_f32 v[160:161], v[16:17], v[16:17]
    v_pk_mul_f32 v[162:163], v[18:19], v[18:19]
    v_pk_mul_f32 v[164:165], v[44:45], v[44:45]
    v_pk_mul_f32 v[166:167], v[46:47], v[46:47]
    v_pk_mul_f32 v[168:169], v[20:21], v[20:21]
    v_pk_mul_f32 v[170:171], v[22:23], v[22:23]
    v_pk_mul_f32 v[172:173], v[48:49], v[48:49]
    v_pk_mul_f32 v[174:175], v[50:51], v[50:51]
    v_pk_fma_f32 v[160:161], v[160:161], v[12:13], v[12:13] op_sel:[0,0,1] op_sel_hi:[1,0,1]
    v_pk_fma_f32 v[162:163], v[162:163], v[12:13], v[12:13] op_sel:[0,0,1] op_sel_hi:[1,0,1]
    v_pk_fma_f32 v[164:165], v[164:165], v[12:13], v[12:13] op_sel:[0,0,1] op_sel_hi:[1,0,1]
    v_pk_fma_f32 v[166:167], v[166:167], v[12:13], v[12:13] op_sel:[0,0,1] op_sel_hi:[1,0,1]
    v_pk_fma_f32 v[168:169], v[168:169], v[12:13], v[12:13] op_sel:[0,0,1] op_sel_hi:[1,0,1]
    v_pk_fma_f32 v[170:171], v[170:171], v[12:13], v[12:13] op_sel:[0,0,1] op_sel_hi:[1,0,1]
    v_pk_fma_f32 v[172:173], v[172:173], v[12:13], v[12:13] op_sel:[0,0,1] op_sel_hi:[1,0,1]
    v_pk_fma_f32 v[174:175], v[174:175], v[12:13], v[12:13] op_sel:[0,0,1] op_sel_hi:[1,0,1]
    v_pk_mul_f32 v[160:161], v[160:161], v[16:17]
    v_pk_mul_f32 v[162:163], v[162:163], v[18:19]
    v_pk_mul_f32 v[164:165], v[164:165], v[44:45]
    v_pk_mul_f32 v[166:167], v[166:167], v[46:47]
    v_pk_mul_f32 v[168:169], v[168:169], v[20:21]
    v_pk_mul_f32 v[170:171], v[170:171], v[22:23]
    v_pk_mul_f32 v[172:173], v[172:173], v[48:49]
    v_pk_mul_f32 v[174:175], v[174:175], v[50:51]
    v_exp_f32 v160, v160
    v_exp_f32 v161, v161
    v_exp_f32 v162, v162
    v_exp_f32 v163, v163
    v_exp_f32 v164, v164
    v_exp_f32 v165, v165
    v_exp_f32 v166, v166
    v_exp_f32 v167, v167
    v_exp_f32 v168, v168
    v_exp_f32 v169, v169
    v_exp_f32 v170, v170
    v_exp_f32 v171, v171
    v_exp_f32 v172, v172
    v_exp_f32 v173, v173
    v_exp_f32 v174, v174
    v_exp_f32 v175, v175
    v_pk_add_f32 v[160:161], v[160:161], 1.0 op_sel_hi:[1,0]
    v_pk_add_f32 v[162:163], v[162:163], 1.0 op_sel_hi:[1,0]
    v_pk_add_f32 v[164:165], v[164:165], 1.0 op_sel_hi:[1,0]
    v_pk_add_f32 v[166:167], v[166:167], 1.0 op_sel_hi:[1,0]
    v_pk_add_f32 v[168:169], v[168:169], 1.0 op_sel_hi:[1,0]
    v_pk_add_f32 v[170:171], v[170:171], 1.0 op_sel_hi:[1,0]
    v_pk_add_f32 v[172:173], v[172:173], 1.0 op_sel_hi:[1,0]
    v_pk_add_f32 v[174:175], v[174:175], 1.0 op_sel_hi:[1,0]
    v_rcp_f32 v160, v160
    v_rcp_f32 v161, v161
    v_rcp_f32 v162, v162
    v_rcp_f32 v163, v163
    v_rcp_f32 v164, v164
    v_rcp_f32 v165, v165
    v_rcp_f32 v166, v166
    v_rcp_f32 v167, v167
    v_rcp_f32 v168, v168
    v_rcp_f32 v169, v169
    v_rcp_f32 v170, v170
    v_rcp_f32 v171, v171
    v_rcp_f32 v172, v172
    v_rcp_f32 v173, v173
    v_rcp_f32 v174, v174
    v_rcp_f32 v175, v175
    s_nop 0
    v_pk_mul_f32 v[16:17], v[16:17], v[160:161]
    v_pk_mul_f32 v[18:19], v[18:19], v[162:163]
    v_pk_mul_f32 v[44:45], v[44:45], v[164:165]
    v_pk_mul_f32 v[46:47], v[46:47], v[166:167]
    v_pk_mul_f32 v[20:21], v[20:21], v[168:169]
    v_pk_mul_f32 v[22:23], v[22:23], v[170:171]
    v_pk_mul_f32 v[48:49], v[48:49], v[172:173]
    v_pk_mul_f32 v[50:51], v[50:51], v[174:175]
    v_cvt_pk_bf16_f32 v16, v16, v17
    v_cvt_pk_bf16_f32 v17, v18, v19
    v_cvt_pk_bf16_f32 v18, v20, v21
    v_cvt_pk_bf16_f32 v19, v22, v23
    v_cvt_pk_bf16_f32 v44, v44, v45
    v_cvt_pk_bf16_f32 v45, v46, v47
    v_cvt_pk_bf16_f32 v46, v48, v49
    v_cvt_pk_bf16_f32 v47, v50, v51
    s_nop 1
    v_permlane16_swap_b32 v16, v18
    v_permlane16_swap_b32 v17, v19
    v_permlane16_swap_b32 v44, v46
    v_permlane16_swap_b32 v45, v47
    buffer_store_dwordx4 v[16:19], v254, s[12:15], s52 offen offset:0 sc1
    buffer_store_dwordx4 v[44:47], v254, s[12:15], s53 offen offset:0 sc1
k2_kernel_gs29:
    v_pk_mul_f32 v[160:161], v[80:81], v[224:225] op_sel_hi:[1,0]
    v_pk_mul_f32 v[162:163], v[82:83], v[224:225] op_sel_hi:[1,0]
    v_pk_mul_f32 v[164:165], v[80:81], v[226:227] op_sel_hi:[1,0]
    v_pk_mul_f32 v[166:167], v[82:83], v[226:227] op_sel_hi:[1,0]
    v_pk_mul_f32 v[168:169], v[84:85], v[224:225] op_sel_hi:[1,0]
    v_pk_mul_f32 v[170:171], v[86:87], v[224:225] op_sel_hi:[1,0]
    v_pk_mul_f32 v[172:173], v[84:85], v[226:227] op_sel_hi:[1,0]
    v_pk_mul_f32 v[174:175], v[86:87], v[226:227] op_sel_hi:[1,0]
    v_pk_fma_f32 v[24:25], v[24:25], v[224:225], v[160:161] op_sel:[0,1,0] op_sel_hi:[1,1,1]
    v_pk_fma_f32 v[26:27], v[26:27], v[224:225], v[162:163] op_sel:[0,1,0] op_sel_hi:[1,1,1]
    v_pk_fma_f32 v[52:53], v[52:53], v[226:227], v[164:165] op_sel:[0,1,0] op_sel_hi:[1,1,1]
    v_pk_fma_f32 v[54:55], v[54:55], v[226:227], v[166:167] op_sel:[0,1,0] op_sel_hi:[1,1,1]
    v_pk_fma_f32 v[28:29], v[28:29], v[224:225], v[168:169] op_sel:[0,1,0] op_sel_hi:[1,1,1]
    v_pk_fma_f32 v[30:31], v[30:31], v[224:225], v[170:171] op_sel:[0,1,0] op_sel_hi:[1,1,1]
    v_pk_fma_f32 v[56:57], v[56:57], v[226:227], v[172:173] op_sel:[0,1,0] op_sel_hi:[1,1,1]
    v_pk_fma_f32 v[58:59], v[58:59], v[226:227], v[174:175] op_sel:[0,1,0] op_sel_hi:[1,1,1]
    v_pk_mul_f32 v[160:161], v[24:25], v[24:25]
    v_pk_mul_f32 v[162:163], v[26:27], v[26:27]
    v_pk_mul_f32 v[164:165], v[52:53], v[52:53]
    v_pk_mul_f32 v[166:167], v[54:55], v[54:55]
    v_pk_mul_f32 v[168:169], v[28:29], v[28:29]
    v_pk_mul_f32 v[170:171], v[30:31], v[30:31]
    v_pk_mul_f32 v[172:173], v[56:57], v[56:57]
    v_pk_mul_f32 v[174:175], v[58:59], v[58:59]
    v_pk_fma_f32 v[160:161], v[160:161], v[12:13], v[12:13] op_sel:[0,0,1] op_sel_hi:[1,0,1]
    v_pk_fma_f32 v[162:163], v[162:163], v[12:13], v[12:13] op_sel:[0,0,1] op_sel_hi:[1,0,1]
    v_pk_fma_f32 v[164:165], v[164:165], v[12:13], v[12:13] op_sel:[0,0,1] op_sel_hi:[1,0,1]
    v_pk_fma_f32 v[166:167], v[166:167], v[12:13], v[12:13] op_sel:[0,0,1] op_sel_hi:[1,0,1]
    v_pk_fma_f32 v[168:169], v[168:169], v[12:13], v[12:13] op_sel:[0,0,1] op_sel_hi:[1,0,1]
    v_pk_fma_f32 v[170:171], v[170:171], v[12:13], v[12:13] op_sel:[0,0,1] op_sel_hi:[1,0,1]
    v_pk_fma_f32 v[172:173], v[172:173], v[12:13], v[12:13] op_sel:[0,0,1] op_sel_hi:[1,0,1]
    v_pk_fma_f32 v[174:175], v[174:175], v[12:13], v[12:13] op_sel:[0,0,1] op_sel_hi:[1,0,1]
    v_pk_mul_f32 v[160:161], v[160:161], v[24:25]
    v_pk_mul_f32 v[162:163], v[162:163], v[26:27]
    v_pk_mul_f32 v[164:165], v[164:165], v[52:53]
    v_pk_mul_f32 v[166:167], v[166:167], v[54:55]
    v_pk_mul_f32 v[168:169], v[168:169], v[28:29]
    v_pk_mul_f32 v[170:171], v[170:171], v[30:31]
    v_pk_mul_f32 v[172:173], v[172:173], v[56:57]
    v_pk_mul_f32 v[174:175], v[174:175], v[58:59]
    v_exp_f32 v160, v160
    v_exp_f32 v161, v161
    v_exp_f32 v162, v162
    v_exp_f32 v163, v163
    v_exp_f32 v164, v164
    v_exp_f32 v165, v165
    v_exp_f32 v166, v166
    v_exp_f32 v167, v167
    v_exp_f32 v168, v168
    v_exp_f32 v169, v169
    v_exp_f32 v170, v170
    v_exp_f32 v171, v171
    v_exp_f32 v172, v172
    v_exp_f32 v173, v173
    v_exp_f32 v174, v174
    v_exp_f32 v175, v175
    v_pk_add_f32 v[160:161], v[160:161], 1.0 op_sel_hi:[1,0]
    v_pk_add_f32 v[162:163], v[162:163], 1.0 op_sel_hi:[1,0]
    v_pk_add_f32 v[164:165], v[164:165], 1.0 op_sel_hi:[1,0]
    v_pk_add_f32 v[166:167], v[166:167], 1.0 op_sel_hi:[1,0]
    v_pk_add_f32 v[168:169], v[168:169], 1.0 op_sel_hi:[1,0]
    v_pk_add_f32 v[170:171], v[170:171], 1.0 op_sel_hi:[1,0]
    v_pk_add_f32 v[172:173], v[172:173], 1.0 op_sel_hi:[1,0]
    v_pk_add_f32 v[174:175], v[174:175], 1.0 op_sel_hi:[1,0]
    v_rcp_f32 v160, v160
    v_rcp_f32 v161, v161
    v_rcp_f32 v162, v162
    v_rcp_f32 v163, v163
    v_rcp_f32 v164, v164
    v_rcp_f32 v165, v165
    v_rcp_f32 v166, v166
    v_rcp_f32 v167, v167
    v_rcp_f32 v168, v168
    v_rcp_f32 v169, v169
    v_rcp_f32 v170, v170
    v_rcp_f32 v171, v171
    v_rcp_f32 v172, v172
    v_rcp_f32 v173, v173
    v_rcp_f32 v174, v174
    v_rcp_f32 v175, v175
    s_nop 0
    v_pk_mul_f32 v[24:25], v[24:25], v[160:161]
    v_pk_mul_f32 v[26:27], v[26:27], v[162:163]
    v_pk_mul_f32 v[52:53], v[52:53], v[164:165]
    v_pk_mul_f32 v[54:55], v[54:55], v[166:167]
    v_pk_mul_f32 v[28:29], v[28:29], v[168:169]
    v_pk_mul_f32 v[30:31], v[30:31], v[170:171]
    v_pk_mul_f32 v[56:57], v[56:57], v[172:173]
    v_pk_mul_f32 v[58:59], v[58:59], v[174:175]
    v_cvt_pk_bf16_f32 v24, v24, v25
    v_cvt_pk_bf16_f32 v25, v26, v27
    v_cvt_pk_bf16_f32 v26, v28, v29
    v_cvt_pk_bf16_f32 v27, v30, v31
    v_cvt_pk_bf16_f32 v52, v52, v53
    v_cvt_pk_bf16_f32 v53, v54, v55
    v_cvt_pk_bf16_f32 v54, v56, v57
    v_cvt_pk_bf16_f32 v55, v58, v59
    s_nop 1
    v_permlane16_swap_b32 v24, v26
    v_permlane16_swap_b32 v25, v27
    v_permlane16_swap_b32 v52, v54
    v_permlane16_swap_b32 v53, v55
    s_cmp_eq_u32 s35, 15
    s_cselect_b32 s46, 0xffff, -1
    s_mov_b32 exec_lo, s46
    s_mov_b32 exec_hi, s46
    buffer_store_dwordx4 v[24:27], v254, s[12:15], s52 offen offset:1024 sc1
    buffer_store_dwordx4 v[52:55], v254, s[12:15], s53 offen offset:1024 sc1
    s_mov_b64 exec, -1
k2_kernel_gs30:
    v_pk_mul_f32 v[160:161], v[88:89], v[224:225] op_sel_hi:[1,0]
    v_pk_mul_f32 v[162:163], v[90:91], v[224:225] op_sel_hi:[1,0]
    v_pk_mul_f32 v[164:165], v[88:89], v[226:227] op_sel_hi:[1,0]
    v_pk_mul_f32 v[166:167], v[90:91], v[226:227] op_sel_hi:[1,0]
    v_pk_mul_f32 v[168:169], v[92:93], v[224:225] op_sel_hi:[1,0]
    v_pk_mul_f32 v[170:171], v[94:95], v[224:225] op_sel_hi:[1,0]
    v_pk_mul_f32 v[172:173], v[92:93], v[226:227] op_sel_hi:[1,0]
    v_pk_mul_f32 v[174:175], v[94:95], v[226:227] op_sel_hi:[1,0]
    v_pk_fma_f32 v[32:33], v[32:33], v[224:225], v[160:161] op_sel:[0,1,0] op_sel_hi:[1,1,1]
    v_pk_fma_f32 v[34:35], v[34:35], v[224:225], v[162:163] op_sel:[0,1,0] op_sel_hi:[1,1,1]
    v_pk_fma_f32 v[60:61], v[60:61], v[226:227], v[164:165] op_sel:[0,1,0] op_sel_hi:[1,1,1]
    v_pk_fma_f32 v[62:63], v[62:63], v[226:227], v[166:167] op_sel:[0,1,0] op_sel_hi:[1,1,1]
    v_pk_fma_f32 v[36:37], v[36:37], v[224:225], v[168:169] op_sel:[0,1,0] op_sel_hi:[1,1,1]
    v_pk_fma_f32 v[38:39], v[38:39], v[224:225], v[170:171] op_sel:[0,1,0] op_sel_hi:[1,1,1]
    v_pk_fma_f32 v[64:65], v[64:65], v[226:227], v[172:173] op_sel:[0,1,0] op_sel_hi:[1,1,1]
    v_pk_fma_f32 v[66:67], v[66:67], v[226:227], v[174:175] op_sel:[0,1,0] op_sel_hi:[1,1,1]
    v_pk_mul_f32 v[160:161], v[32:33], v[32:33]
    v_pk_mul_f32 v[162:163], v[34:35], v[34:35]
    v_pk_mul_f32 v[164:165], v[60:61], v[60:61]
    v_pk_mul_f32 v[166:167], v[62:63], v[62:63]
    v_pk_mul_f32 v[168:169], v[36:37], v[36:37]
    v_pk_mul_f32 v[170:171], v[38:39], v[38:39]
    v_pk_mul_f32 v[172:173], v[64:65], v[64:65]
    v_pk_mul_f32 v[174:175], v[66:67], v[66:67]
    v_pk_fma_f32 v[160:161], v[160:161], v[12:13], v[12:13] op_sel:[0,0,1] op_sel_hi:[1,0,1]
    v_pk_fma_f32 v[162:163], v[162:163], v[12:13], v[12:13] op_sel:[0,0,1] op_sel_hi:[1,0,1]
    v_pk_fma_f32 v[164:165], v[164:165], v[12:13], v[12:13] op_sel:[0,0,1] op_sel_hi:[1,0,1]
    v_pk_fma_f32 v[166:167], v[166:167], v[12:13], v[12:13] op_sel:[0,0,1] op_sel_hi:[1,0,1]
    v_pk_fma_f32 v[168:169], v[168:169], v[12:13], v[12:13] op_sel:[0,0,1] op_sel_hi:[1,0,1]
    v_pk_fma_f32 v[170:171], v[170:171], v[12:13], v[12:13] op_sel:[0,0,1] op_sel_hi:[1,0,1]
    v_pk_fma_f32 v[172:173], v[172:173], v[12:13], v[12:13] op_sel:[0,0,1] op_sel_hi:[1,0,1]
    v_pk_fma_f32 v[174:175], v[174:175], v[12:13], v[12:13] op_sel:[0,0,1] op_sel_hi:[1,0,1]
    v_pk_mul_f32 v[160:161], v[160:161], v[32:33]
    v_pk_mul_f32 v[162:163], v[162:163], v[34:35]
    v_pk_mul_f32 v[164:165], v[164:165], v[60:61]
    v_pk_mul_f32 v[166:167], v[166:167], v[62:63]
    v_pk_mul_f32 v[168:169], v[168:169], v[36:37]
    v_pk_mul_f32 v[170:171], v[170:171], v[38:39]
    v_pk_mul_f32 v[172:173], v[172:173], v[64:65]
    v_pk_mul_f32 v[174:175], v[174:175], v[66:67]
    v_exp_f32 v160, v160
    v_exp_f32 v161, v161
    v_exp_f32 v162, v162
    v_exp_f32 v163, v163
    v_exp_f32 v164, v164
    v_exp_f32 v165, v165
    v_exp_f32 v166, v166
    v_exp_f32 v167, v167
    v_exp_f32 v168, v168
    v_exp_f32 v169, v169
    v_exp_f32 v170, v170
    v_exp_f32 v171, v171
    v_exp_f32 v172, v172
    v_exp_f32 v173, v173
    v_exp_f32 v174, v174
    v_exp_f32 v175, v175
    v_pk_add_f32 v[160:161], v[160:161], 1.0 op_sel_hi:[1,0]
    v_pk_add_f32 v[162:163], v[162:163], 1.0 op_sel_hi:[1,0]
    v_pk_add_f32 v[164:165], v[164:165], 1.0 op_sel_hi:[1,0]
    v_pk_add_f32 v[166:167], v[166:167], 1.0 op_sel_hi:[1,0]
    v_pk_add_f32 v[168:169], v[168:169], 1.0 op_sel_hi:[1,0]
    v_pk_add_f32 v[170:171], v[170:171], 1.0 op_sel_hi:[1,0]
    v_pk_add_f32 v[172:173], v[172:173], 1.0 op_sel_hi:[1,0]
    v_pk_add_f32 v[174:175], v[174:175], 1.0 op_sel_hi:[1,0]
    v_rcp_f32 v160, v160
    v_rcp_f32 v161, v161
    v_rcp_f32 v162, v162
    v_rcp_f32 v163, v163
    v_rcp_f32 v164, v164
    v_rcp_f32 v165, v165
    v_rcp_f32 v166, v166
    v_rcp_f32 v167, v167
    v_rcp_f32 v168, v168
    v_rcp_f32 v169, v169
    v_rcp_f32 v170, v170
    v_rcp_f32 v171, v171
    v_rcp_f32 v172, v172
    v_rcp_f32 v173, v173
    v_rcp_f32 v174, v174
    v_rcp_f32 v175, v175
    s_nop 0
    v_pk_mul_f32 v[32:33], v[32:33], v[160:161]
    v_pk_mul_f32 v[34:35], v[34:35], v[162:163]
    v_pk_mul_f32 v[60:61], v[60:61], v[164:165]
    v_pk_mul_f32 v[62:63], v[62:63], v[166:167]
    v_pk_mul_f32 v[36:37], v[36:37], v[168:169]
    v_pk_mul_f32 v[38:39], v[38:39], v[170:171]
    v_pk_mul_f32 v[64:65], v[64:65], v[172:173]
    v_pk_mul_f32 v[66:67], v[66:67], v[174:175]
    v_cvt_pk_bf16_f32 v32, v32, v33
    v_cvt_pk_bf16_f32 v33, v34, v35
    v_cvt_pk_bf16_f32 v34, v36, v37
    v_cvt_pk_bf16_f32 v35, v38, v39
    v_cvt_pk_bf16_f32 v60, v60, v61
    v_cvt_pk_bf16_f32 v61, v62, v63
    v_cvt_pk_bf16_f32 v62, v64, v65
    v_cvt_pk_bf16_f32 v63, v66, v67
    s_nop 1
    v_permlane16_swap_b32 v32, v34
    v_permlane16_swap_b32 v33, v35
    v_permlane16_swap_b32 v60, v62
    v_permlane16_swap_b32 v61, v63
    s_cmp_eq_u32 s35, 15
    s_cbranch_scc1 k2_kernel_gs31
    buffer_store_dwordx4 v[32:35], v254, s[12:15], s52 offen offset:2048 sc1
    buffer_store_dwordx4 v[60:63], v254, s[12:15], s53 offen offset:2048 sc1
k2_kernel_gs31:
    v_pk_mul_f32 v[160:161], v[96:97], v[224:225] op_sel_hi:[1,0]
    v_pk_mul_f32 v[162:163], v[98:99], v[224:225] op_sel_hi:[1,0]
    v_pk_mul_f32 v[164:165], v[96:97], v[226:227] op_sel_hi:[1,0]
    v_pk_mul_f32 v[166:167], v[98:99], v[226:227] op_sel_hi:[1,0]
    v_pk_fma_f32 v[40:41], v[40:41], v[224:225], v[160:161] op_sel:[0,1,0] op_sel_hi:[1,1,1]
    v_pk_fma_f32 v[42:43], v[42:43], v[224:225], v[162:163] op_sel:[0,1,0] op_sel_hi:[1,1,1]
    v_pk_fma_f32 v[68:69], v[68:69], v[226:227], v[164:165] op_sel:[0,1,0] op_sel_hi:[1,1,1]
    v_pk_fma_f32 v[70:71], v[70:71], v[226:227], v[166:167] op_sel:[0,1,0] op_sel_hi:[1,1,1]
    v_pk_mul_f32 v[160:161], v[40:41], v[40:41]
    v_pk_mul_f32 v[162:163], v[42:43], v[42:43]
    v_pk_mul_f32 v[164:165], v[68:69], v[68:69]
    v_pk_mul_f32 v[166:167], v[70:71], v[70:71]
    v_pk_fma_f32 v[160:161], v[160:161], v[12:13], v[12:13] op_sel:[0,0,1] op_sel_hi:[1,0,1]
    v_pk_fma_f32 v[162:163], v[162:163], v[12:13], v[12:13] op_sel:[0,0,1] op_sel_hi:[1,0,1]
    v_pk_fma_f32 v[164:165], v[164:165], v[12:13], v[12:13] op_sel:[0,0,1] op_sel_hi:[1,0,1]
    v_pk_fma_f32 v[166:167], v[166:167], v[12:13], v[12:13] op_sel:[0,0,1] op_sel_hi:[1,0,1]
    v_pk_mul_f32 v[160:161], v[160:161], v[40:41]
    v_pk_mul_f32 v[162:163], v[162:163], v[42:43]
    v_pk_mul_f32 v[164:165], v[164:165], v[68:69]
    v_pk_mul_f32 v[166:167], v[166:167], v[70:71]
    v_exp_f32 v160, v160
    v_exp_f32 v161, v161
    v_exp_f32 v162, v162
    v_exp_f32 v163, v163
    v_exp_f32 v164, v164
    v_exp_f32 v165, v165
    v_exp_f32 v166, v166
    v_exp_f32 v167, v167
    v_pk_add_f32 v[160:161], v[160:161], 1.0 op_sel_hi:[1,0]
    v_pk_add_f32 v[162:163], v[162:163], 1.0 op_sel_hi:[1,0]
    v_pk_add_f32 v[164:165], v[164:165], 1.0 op_sel_hi:[1,0]
    v_pk_add_f32 v[166:167], v[166:167], 1.0 op_sel_hi:[1,0]
    v_rcp_f32 v160, v160
    v_rcp_f32 v161, v161
    v_rcp_f32 v162, v162
    v_rcp_f32 v163, v163
    v_rcp_f32 v164, v164
    v_rcp_f32 v165, v165
    v_rcp_f32 v166, v166
    v_rcp_f32 v167, v167
    s_nop 0
    v_pk_mul_f32 v[40:41], v[40:41], v[160:161]
    v_pk_mul_f32 v[42:43], v[42:43], v[162:163]
    v_pk_mul_f32 v[68:69], v[68:69], v[164:165]
    v_pk_mul_f32 v[70:71], v[70:71], v[166:167]
    v_cvt_pk_bf16_f32 v40, v40, v41
    v_cvt_pk_bf16_f32 v41, v42, v43
    v_cvt_pk_bf16_f32 v68, v68, v69
    v_cvt_pk_bf16_f32 v69, v70, v71
    s_cmp_eq_u32 s35, 15
    s_cbranch_scc1 k2_kernel_gs32
    buffer_store_dwordx2 v[40:41], v8, s[12:15], s52 offen offset:3072 sc1
    buffer_store_dwordx2 v[68:69], v8, s[12:15], s53 offen offset:3072 sc1
k2_kernel_gs32:
    s_waitcnt vmcnt(0)
    v_mov_b32 v9, 1
    v_mov_b32 v10, 6400
    s_mov_b64 exec, 1
    s_cmp_eq_u32 s31, 0
    s_cbranch_scc1 k2_kernel_slow33
    buffer_store_dword v9, v10, s[12:15], s49 offen
    s_branch k2_kernel_sent34
k2_kernel_slow33:
    buffer_store_dword v9, v10, s[12:15], s49 offen sc1
k2_kernel_sent34:
    s_mov_b64 exec, -1
    buffer_load_dwordx4 v[192:195], v2, s[12:15], s40 offen offset:0
    buffer_load_dwordx4 v[196:199], v2, s[12:15], s40 offen offset:1024
    buffer_load_dwordx4 v[200:203], v2, s[12:15], s40 offen offset:2048
    buffer_load_dwordx4 v[204:207], v2, s[12:15], s40 offen offset:3072
    s_add_u32 s40, s40, 4096
    buffer_load_dwordx4 v[208:211], v2, s[12:15], s40 offen offset:0
    buffer_load_dwordx4 v[212:215], v2, s[12:15], s40 offen offset:1024
    s_and_b32 s41, s32, 1
    s_lshl_b32 s41, s41, 1
    s_lshl_b32 s49, s34, 2
    s_add_u32 s49, s49, s41
    s_lshl_b32 s49, s49, 7
    s_add_u32 s49, s49, s37
    s_lshl_b32 s41, s30, 4
    s_add_u32 s49, s49, s41
    s_add_u32 s49, s49, 6400
    v_bfe_u32 v7, v1, 2, 1
    v_lshlrev_b32 v7, 7, v7
    v_and_b32 v9, 3, v1
    v_lshl_add_u32 v7, v9, 2, v7
    s_add_u32 s41, s30, 0
    s_and_b32 s41, s41, 3
    s_lshl_b32 s46, s32, 2
    s_add_u32 s41, s41, s46
    s_mul_i32 s41, s41, 55296
    s_mul_i32 s46, s30, 14336
    s_add_u32 s41, s41, s46
    s_add_u32 s41, s41, s36
    s_add_u32 s50, s41, 1024000
    s_add_u32 s41, s30, 1
    s_and_b32 s41, s41, 3
    s_lshl_b32 s46, s32, 2
    s_add_u32 s41, s41, s46
    s_mul_i32 s41, s41, 55296
    s_mul_i32 s46, s30, 14336
    s_add_u32 s41, s41, s46
    s_add_u32 s41, s41, s36
    s_add_u32 s51, s41, 1024000
    s_add_u32 s41, s30, 2
    s_and_b32 s41, s41, 3
    s_lshl_b32 s46, s32, 2
    s_add_u32 s41, s41, s46
    s_mul_i32 s41, s41, 55296
    s_mul_i32 s46, s30, 14336
    s_add_u32 s41, s41, s46
    s_add_u32 s41, s41, s36
    s_add_u32 s52, s41, 1024000
    s_add_u32 s41, s30, 3
    s_and_b32 s41, s41, 3
    s_lshl_b32 s46, s32, 2
    s_add_u32 s41, s41, s46
    s_mul_i32 s41, s41, 55296
    s_mul_i32 s46, s30, 14336
    s_add_u32 s41, s41, s46
    s_add_u32 s41, s41, s36
    s_add_u32 s53, s41, 1024000
    s_mov_b32 s43, 200000
k2_kernel_poll35:
    buffer_load_dword v9, v7, s[12:15], s49 offen sc1
    s_waitcnt vmcnt(0)
    v_cmp_ne_u32 vcc, 0, v9
    s_sub_u32 s43, s43, 1
    s_cmp_eq_u64 vcc, -1
    s_cbranch_scc1 k2_kernel_go36
    s_cmp_lg_u32 s43, 0
    s_cbranch_scc1 k2_kernel_poll35
k2_kernel_go36:
    s_add_u32 s41, s50, 0
    buffer_load_dwordx4 v[96:99], v2, s[12:15], s41 offen offset:0 sc1
    s_add_u32 s41, s51, 0
    buffer_load_dwordx4 v[100:103], v2, s[12:15], s41 offen offset:0 sc1
    s_add_u32 s41, s52, 0
    buffer_load_dwordx4 v[104:107], v2, s[12:15], s41 offen offset:0 sc1
    s_add_u32 s41, s53, 0
    buffer_load_dwordx4 v[108:111], v2, s[12:15], s41 offen offset:0 sc1
    s_add_u32 s41, s50, 0
    buffer_load_dwordx4 v[112:115], v2, s[12:15], s41 offen offset:1024 sc1
    s_add_u32 s41, s51, 0
    buffer_load_dwordx4 v[116:119], v2, s[12:15], s41 offen offset:1024 sc1
    s_add_u32 s41, s52, 0
    buffer_load_dwordx4 v[120:123], v2, s[12:15], s41 offen offset:1024 sc1
    s_add_u32 s41, s53, 0
    buffer_load_dwordx4 v[124:127], v2, s[12:15], s41 offen offset:1024 sc1
    s_waitcnt vmcnt(4)
    v_mfma_f32_16x16x32_bf16 v[16:19], a[0:3], v[96:99], 0
    v_mfma_f32_16x16x32_bf16 v[36:39], a[0:3], v[100:103], 0
    v_mfma_f32_16x16x32_bf16 v[56:59], a[0:3], v[104:107], 0
    v_mfma_f32_16x16x32_bf16 v[76:79], a[0:3], v[108:111], 0
    s_add_u32 s41, s50, 0
    buffer_load_dwordx4 v[128:131], v2, s[12:15], s41 offen offset:2048 sc1
    v_mfma_f32_16x16x32_bf16 v[20:23], a[4:7], v[96:99], 0
    v_mfma_f32_16x16x32_bf16 v[40:43], a[4:7], v[100:103], 0
    v_mfma_f32_16x16x32_bf16 v[60:63], a[4:7], v[104:107], 0
    v_mfma_f32_16x16x32_bf16 v[80:83], a[4:7], v[108:111], 0
    s_add_u32 s41, s51, 0
    buffer_load_dwordx4 v[132:135], v2, s[12:15], s41 offen offset:2048 sc1
    s_add_u32 s41, s52, 0
    buffer_load_dwordx4 v[136:139], v2, s[12:15], s41 offen offset:2048 sc1
    v_mfma_f32_16x16x32_bf16 v[24:27], a[8:11], v[96:99], 0
    v_mfma_f32_16x16x32_bf16 v[44:47], a[8:11], v[100:103], 0
    v_mfma_f32_16x16x32_bf16 v[64:67], a[8:11], v[104:107], 0
    v_mfma_f32_16x16x32_bf16 v[84:87], a[8:11], v[108:111], 0
    s_add_u32 s41, s53, 0
    buffer_load_dwordx4 v[140:143], v2, s[12:15], s41 offen offset:2048 sc1
    v_mfma_f32_16x16x32_bf16 v[28:31], a[12:15], v[96:99], 0
    v_mfma_f32_16x16x32_bf16 v[48:51], a[12:15], v[100:103], 0
    v_mfma_f32_16x16x32_bf16 v[68:71], a[12:15], v[104:107], 0
    v_mfma_f32_16x16x32_bf16 v[88:91], a[12:15], v[108:111], 0
    s_add_u32 s41, s50, 0
    buffer_load_dwordx4 v[144:147], v2, s[12:15], s41 offen offset:3072 sc1
    s_add_u32 s41, s51, 0
    buffer_load_dwordx4 v[148:151], v2, s[12:15], s41 offen offset:3072 sc1
    v_mfma_f32_16x16x32_bf16 v[32:35], a[16:19], v[96:99], 0
    v_mfma_f32_16x16x32_bf16 v[52:55], a[16:19], v[100:103], 0
    v_mfma_f32_16x16x32_bf16 v[72:75], a[16:19], v[104:107], 0
    v_mfma_f32_16x16x32_bf16 v[92:95], a[16:19], v[108:111], 0
    s_add_u32 s41, s52, 0
    buffer_load_dwordx4 v[152:155], v2, s[12:15], s41 offen offset:3072 sc1
    s_waitcnt vmcnt(7)
    v_mfma_f32_16x16x32_bf16 v[16:19], a[20:23], v[112:115], v[16:19]
    v_mfma_f32_16x16x32_bf16 v[36:39], a[20:23], v[116:119], v[36:39]
    v_mfma_f32_16x16x32_bf16 v[56:59], a[20:23], v[120:123], v[56:59]
    v_mfma_f32_16x16x32_bf16 v[76:79], a[20:23], v[124:127], v[76:79]
    s_add_u32 s41, s53, 0
    buffer_load_dwordx4 v[156:159], v2, s[12:15], s41 offen offset:3072 sc1
    v_mfma_f32_16x16x32_bf16 v[20:23], a[24:27], v[112:115], v[20:23]
    v_mfma_f32_16x16x32_bf16 v[40:43], a[24:27], v[116:119], v[40:43]
    v_mfma_f32_16x16x32_bf16 v[60:63], a[24:27], v[120:123], v[60:63]
    v_mfma_f32_16x16x32_bf16 v[80:83], a[24:27], v[124:127], v[80:83]
    s_add_u32 s41, s50, 4096
    buffer_load_dwordx4 v[160:163], v2, s[12:15], s41 offen offset:0 sc1
    s_add_u32 s41, s51, 4096
    buffer_load_dwordx4 v[164:167], v2, s[12:15], s41 offen offset:0 sc1
    v_mfma_f32_16x16x32_bf16 v[24:27], a[28:31], v[112:115], v[24:27]
    v_mfma_f32_16x16x32_bf16 v[44:47], a[28:31], v[116:119], v[44:47]
    v_mfma_f32_16x16x32_bf16 v[64:67], a[28:31], v[120:123], v[64:67]
    v_mfma_f32_16x16x32_bf16 v[84:87], a[28:31], v[124:127], v[84:87]
    s_add_u32 s41, s52, 4096
    buffer_load_dwordx4 v[168:171], v2, s[12:15], s41 offen offset:0 sc1
    v_mfma_f32_16x16x32_bf16 v[28:31], a[32:35], v[112:115], v[28:31]
    v_mfma_f32_16x16x32_bf16 v[48:51], a[32:35], v[116:119], v[48:51]
    v_mfma_f32_16x16x32_bf16 v[68:71], a[32:35], v[120:123], v[68:71]
    v_mfma_f32_16x16x32_bf16 v[88:91], a[32:35], v[124:127], v[88:91]
    s_add_u32 s41, s53, 4096
    buffer_load_dwordx4 v[172:175], v2, s[12:15], s41 offen offset:0 sc1
    s_add_u32 s41, s50, 4096
    buffer_load_dwordx4 v[176:179], v2, s[12:15], s41 offen offset:1024 sc1
    v_mfma_f32_16x16x32_bf16 v[32:35], a[36:39], v[112:115], v[32:35]
    v_mfma_f32_16x16x32_bf16 v[52:55], a[36:39], v[116:119], v[52:55]
    v_mfma_f32_16x16x32_bf16 v[72:75], a[36:39], v[120:123], v[72:75]
    v_mfma_f32_16x16x32_bf16 v[92:95], a[36:39], v[124:127], v[92:95]
    s_add_u32 s41, s51, 4096
    buffer_load_dwordx4 v[180:183], v2, s[12:15], s41 offen offset:1024 sc1
    s_waitcnt vmcnt(10)
    v_mfma_f32_16x16x32_bf16 v[16:19], a[40:43], v[128:131], v[16:19]
    v_mfma_f32_16x16x32_bf16 v[36:39], a[40:43], v[132:135], v[36:39]
    v_mfma_f32_16x16x32_bf16 v[56:59], a[40:43], v[136:139], v[56:59]
    v_mfma_f32_16x16x32_bf16 v[76:79], a[40:43], v[140:143], v[76:79]
    s_add_u32 s41, s52, 4096
    buffer_load_dwordx4 v[184:187], v2, s[12:15], s41 offen offset:1024 sc1
    v_mfma_f32_16x16x32_bf16 v[20:23], a[44:47], v[128:131], v[20:23]
    v_mfma_f32_16x16x32_bf16 v[40:43], a[44:47], v[132:135], v[40:43]
    v_mfma_f32_16x16x32_bf16 v[60:63], a[44:47], v[136:139], v[60:63]
    v_mfma_f32_16x16x32_bf16 v[80:83], a[44:47], v[140:143], v[80:83]
    s_add_u32 s41, s53, 4096
    buffer_load_dwordx4 v[188:191], v2, s[12:15], s41 offen offset:1024 sc1
    s_add_u32 s41, s50, 4096
    buffer_load_dwordx4 v[96:99], v2, s[12:15], s41 offen offset:2048 sc1
    v_mfma_f32_16x16x32_bf16 v[24:27], a[48:51], v[128:131], v[24:27]
    v_mfma_f32_16x16x32_bf16 v[44:47], a[48:51], v[132:135], v[44:47]
    v_mfma_f32_16x16x32_bf16 v[64:67], a[48:51], v[136:139], v[64:67]
    v_mfma_f32_16x16x32_bf16 v[84:87], a[48:51], v[140:143], v[84:87]
    s_add_u32 s41, s51, 4096
    buffer_load_dwordx4 v[100:103], v2, s[12:15], s41 offen offset:2048 sc1
    v_mfma_f32_16x16x32_bf16 v[28:31], a[52:55], v[128:131], v[28:31]
    v_mfma_f32_16x16x32_bf16 v[48:51], a[52:55], v[132:135], v[48:51]
    v_mfma_f32_16x16x32_bf16 v[68:71], a[52:55], v[136:139], v[68:71]
    v_mfma_f32_16x16x32_bf16 v[88:91], a[52:55], v[140:143], v[88:91]
    s_add_u32 s41, s52, 4096
    buffer_load_dwordx4 v[104:107], v2, s[12:15], s41 offen offset:2048 sc1
    v_mfma_f32_16x16x32_bf16 v[32:35], a[56:59], v[128:131], v[32:35]
    v_mfma_f32_16x16x32_bf16 v[52:55], a[56:59], v[132:135], v[52:55]
    v_mfma_f32_16x16x32_bf16 v[72:75], a[56:59], v[136:139], v[72:75]
    v_mfma_f32_16x16x32_bf16 v[92:95], a[56:59], v[140:143], v[92:95]
    s_add_u32 s41, s53, 4096
    buffer_load_dwordx4 v[108:111], v2, s[12:15], s41 offen offset:2048 sc1
    s_waitcnt vmcnt(12)
    v_mfma_f32_16x16x32_bf16 v[16:19], a[60:63], v[144:147], v[16:19]
    v_mfma_f32_16x16x32_bf16 v[36:39], a[60:63], v[148:151], v[36:39]
    v_mfma_f32_16x16x32_bf16 v[56:59], a[60:63], v[152:155], v[56:59]
    v_mfma_f32_16x16x32_bf16 v[76:79], a[60:63], v[156:159], v[76:79]
    s_add_u32 s41, s50, 4096
    buffer_load_dwordx4 v[112:115], v2, s[12:15], s41 offen offset:3072 sc1
    v_mfma_f32_16x16x32_bf16 v[20:23], a[64:67], v[144:147], v[20:23]
    v_mfma_f32_16x16x32_bf16 v[40:43], a[64:67], v[148:151], v[40:43]
    v_mfma_f32_16x16x32_bf16 v[60:63], a[64:67], v[152:155], v[60:63]
    v_mfma_f32_16x16x32_bf16 v[80:83], a[64:67], v[156:159], v[80:83]
    s_add_u32 s41, s51, 4096
    buffer_load_dwordx4 v[116:119], v2, s[12:15], s41 offen offset:3072 sc1
    v_mfma_f32_16x16x32_bf16 v[24:27], a[68:71], v[144:147], v[24:27]
    v_mfma_f32_16x16x32_bf16 v[44:47], a[68:71], v[148:151], v[44:47]
    v_mfma_f32_16x16x32_bf16 v[64:67], a[68:71], v[152:155], v[64:67]
    v_mfma_f32_16x16x32_bf16 v[84:87], a[68:71], v[156:159], v[84:87]
    s_add_u32 s41, s52, 4096
    buffer_load_dwordx4 v[120:123], v2, s[12:15], s41 offen offset:3072 sc1
    v_mfma_f32_16x16x32_bf16 v[28:31], a[72:75], v[144:147], v[28:31]
    v_mfma_f32_16x16x32_bf16 v[48:51], a[72:75], v[148:151], v[48:51]
    v_mfma_f32_16x16x32_bf16 v[68:71], a[72:75], v[152:155], v[68:71]
    v_mfma_f32_16x16x32_bf16 v[88:91], a[72:75], v[156:159], v[88:91]
    s_add_u32 s41, s53, 4096
    buffer_load_dwordx4 v[124:127], v2, s[12:15], s41 offen offset:3072 sc1
    v_mfma_f32_16x16x32_bf16 v[32:35], a[76:79], v[144:147], v[32:35]
    v_mfma_f32_16x16x32_bf16 v[52:55], a[76:79], v[148:151], v[52:55]
    v_mfma_f32_16x16x32_bf16 v[72:75], a[76:79], v[152:155], v[72:75]
    v_mfma_f32_16x16x32_bf16 v[92:95], a[76:79], v[156:159], v[92:95]
    s_add_u32 s41, s50, 8192
    buffer_load_dwordx4 v[128:131], v2, s[12:15], s41 offen offset:0 sc1
    s_waitcnt vmcnt(13)
    v_mfma_f32_16x16x32_bf16 v[16:19], a[80:83], v[160:163], v[16:19]
    v_mfma_f32_16x16x32_bf16 v[36:39], a[80:83], v[164:167], v[36:39]
    v_mfma_f32_16x16x32_bf16 v[56:59], a[80:83], v[168:171], v[56:59]
    v_mfma_f32_16x16x32_bf16 v[76:79], a[80:83], v[172:175], v[76:79]
    s_add_u32 s41, s51, 8192
    buffer_load_dwordx4 v[132:135], v2, s[12:15], s41 offen offset:0 sc1
    v_mfma_f32_16x16x32_bf16 v[20:23], a[84:87], v[160:163], v[20:23]
    v_mfma_f32_16x16x32_bf16 v[40:43], a[84:87], v[164:167], v[40:43]
    v_mfma_f32_16x16x32_bf16 v[60:63], a[84:87], v[168:171], v[60:63]
    v_mfma_f32_16x16x32_bf16 v[80:83], a[84:87], v[172:175], v[80:83]
    s_add_u32 s41, s52, 8192
    buffer_load_dwordx4 v[136:139], v2, s[12:15], s41 offen offset:0 sc1
    v_mfma_f32_16x16x32_bf16 v[24:27], a[88:91], v[160:163], v[24:27]
    v_mfma_f32_16x16x32_bf16 v[44:47], a[88:91], v[164:167], v[44:47]
    v_mfma_f32_16x16x32_bf16 v[64:67], a[88:91], v[168:171], v[64:67]
    v_mfma_f32_16x16x32_bf16 v[84:87], a[88:91], v[172:175], v[84:87]
    s_add_u32 s41, s53, 8192
    buffer_load_dwordx4 v[140:143], v2, s[12:15], s41 offen offset:0 sc1
    v_mfma_f32_16x16x32_bf16 v[28:31], a[92:95], v[160:163], v[28:31]
    v_mfma_f32_16x16x32_bf16 v[48:51], a[92:95], v[164:167], v[48:51]
    v_mfma_f32_16x16x32_bf16 v[68:71], a[92:95], v[168:171], v[68:71]
    v_mfma_f32_16x16x32_bf16 v[88:91], a[92:95], v[172:175], v[88:91]
    s_add_u32 s41, s50, 8192
    buffer_load_dwordx4 v[144:147], v2, s[12:15], s41 offen offset:1024 sc1
    v_mfma_f32_16x16x32_bf16 v[32:35], a[96:99], v[160:163], v[32:35]
    v_mfma_f32_16x16x32_bf16 v[52:55], a[96:99], v[164:167], v[52:55]
    v_mfma_f32_16x16x32_bf16 v[72:75], a[96:99], v[168:171], v[72:75]
    v_mfma_f32_16x16x32_bf16 v[92:95], a[96:99], v[172:175], v[92:95]
    s_add_u32 s41, s51, 8192
    buffer_load_dwordx4 v[148:151], v2, s[12:15], s41 offen offset:1024 sc1
    s_waitcnt vmcnt(14)
    v_mfma_f32_16x16x32_bf16 v[16:19], a[100:103], v[176:179], v[16:19]
    v_mfma_f32_16x16x32_bf16 v[36:39], a[100:103], v[180:183], v[36:39]
    v_mfma_f32_16x16x32_bf16 v[56:59], a[100:103], v[184:187], v[56:59]
    v_mfma_f32_16x16x32_bf16 v[76:79], a[100:103], v[188:191], v[76:79]
    s_add_u32 s41, s52, 8192
    buffer_load_dwordx4 v[152:155], v2, s[12:15], s41 offen offset:1024 sc1
    v_mfma_f32_16x16x32_bf16 v[20:23], a[104:107], v[176:179], v[20:23]
    v_mfma_f32_16x16x32_bf16 v[40:43], a[104:107], v[180:183], v[40:43]
    v_mfma_f32_16x16x32_bf16 v[60:63], a[104:107], v[184:187], v[60:63]
    v_mfma_f32_16x16x32_bf16 v[80:83], a[104:107], v[188:191], v[80:83]
    s_add_u32 s41, s53, 8192
    buffer_load_dwordx4 v[156:159], v2, s[12:15], s41 offen offset:1024 sc1
    v_mfma_f32_16x16x32_bf16 v[24:27], a[108:111], v[176:179], v[24:27]
    v_mfma_f32_16x16x32_bf16 v[44:47], a[108:111], v[180:183], v[44:47]
    v_mfma_f32_16x16x32_bf16 v[64:67], a[108:111], v[184:187], v[64:67]
    v_mfma_f32_16x16x32_bf16 v[84:87], a[108:111], v[188:191], v[84:87]
    s_add_u32 s41, s50, 8192
    buffer_load_dwordx4 v[160:163], v2, s[12:15], s41 offen offset:2048 sc1
    v_mfma_f32_16x16x32_bf16 v[28:31], a[112:115], v[176:179], v[28:31]
    v_mfma_f32_16x16x32_bf16 v[48:51], a[112:115], v[180:183], v[48:51]
    v_mfma_f32_16x16x32_bf16 v[68:71], a[112:115], v[184:187], v[68:71]
    v_mfma_f32_16x16x32_bf16 v[88:91], a[112:115], v[188:191], v[88:91]
    s_add_u32 s41, s51, 8192
    buffer_load_dwordx4 v[164:167], v2, s[12:15], s41 offen offset:2048 sc1
    v_mfma_f32_16x16x32_bf16 v[32:35], a[116:119], v[176:179], v[32:35]
    v_mfma_f32_16x16x32_bf16 v[52:55], a[116:119], v[180:183], v[52:55]
    v_mfma_f32_16x16x32_bf16 v[72:75], a[116:119], v[184:187], v[72:75]
    v_mfma_f32_16x16x32_bf16 v[92:95], a[116:119], v[188:191], v[92:95]
    s_add_u32 s41, s52, 8192
    buffer_load_dwordx4 v[168:171], v2, s[12:15], s41 offen offset:2048 sc1
    s_waitcnt vmcnt(15)
    v_mfma_f32_16x16x32_bf16 v[16:19], a[120:123], v[96:99], v[16:19]
    v_mfma_f32_16x16x32_bf16 v[36:39], a[120:123], v[100:103], v[36:39]
    v_mfma_f32_16x16x32_bf16 v[56:59], a[120:123], v[104:107], v[56:59]
    v_mfma_f32_16x16x32_bf16 v[76:79], a[120:123], v[108:111], v[76:79]
    s_add_u32 s41, s53, 8192
    buffer_load_dwordx4 v[172:175], v2, s[12:15], s41 offen offset:2048 sc1
    v_mfma_f32_16x16x32_bf16 v[20:23], a[124:127], v[96:99], v[20:23]
    v_mfma_f32_16x16x32_bf16 v[40:43], a[124:127], v[100:103], v[40:43]
    v_mfma_f32_16x16x32_bf16 v[60:63], a[124:127], v[104:107], v[60:63]
    v_mfma_f32_16x16x32_bf16 v[80:83], a[124:127], v[108:111], v[80:83]
    s_add_u32 s41, s50, 8192
    buffer_load_dwordx4 v[176:179], v2, s[12:15], s41 offen offset:3072 sc1
    v_mfma_f32_16x16x32_bf16 v[24:27], a[128:131], v[96:99], v[24:27]
    v_mfma_f32_16x16x32_bf16 v[44:47], a[128:131], v[100:103], v[44:47]
    v_mfma_f32_16x16x32_bf16 v[64:67], a[128:131], v[104:107], v[64:67]
    v_mfma_f32_16x16x32_bf16 v[84:87], a[128:131], v[108:111], v[84:87]
    s_add_u32 s41, s51, 8192
    buffer_load_dwordx4 v[180:183], v2, s[12:15], s41 offen offset:3072 sc1
    v_mfma_f32_16x16x32_bf16 v[28:31], a[132:135], v[96:99], v[28:31]
    v_mfma_f32_16x16x32_bf16 v[48:51], a[132:135], v[100:103], v[48:51]
    v_mfma_f32_16x16x32_bf16 v[68:71], a[132:135], v[104:107], v[68:71]
    v_mfma_f32_16x16x32_bf16 v[88:91], a[132:135], v[108:111], v[88:91]
    s_add_u32 s41, s52, 8192
    buffer_load_dwordx4 v[184:187], v2, s[12:15], s41 offen offset:3072 sc1
    v_mfma_f32_16x16x32_bf16 v[32:35], a[136:139], v[96:99], v[32:35]
    v_mfma_f32_16x16x32_bf16 v[52:55], a[136:139], v[100:103], v[52:55]
    v_mfma_f32_16x16x32_bf16 v[72:75], a[136:139], v[104:107], v[72:75]
    v_mfma_f32_16x16x32_bf16 v[92:95], a[136:139], v[108:111], v[92:95]
    s_add_u32 s41, s53, 8192
    buffer_load_dwordx4 v[188:191], v2, s[12:15], s41 offen offset:3072 sc1
    s_waitcnt vmcnt(16)
    v_mfma_f32_16x16x32_bf16 v[16:19], a[140:143], v[112:115], v[16:19]
    v_mfma_f32_16x16x32_bf16 v[36:39], a[140:143], v[116:119], v[36:39]
    v_mfma_f32_16x16x32_bf16 v[56:59], a[140:143], v[120:123], v[56:59]
    v_mfma_f32_16x16x32_bf16 v[76:79], a[140:143], v[124:127], v[76:79]
    v_mfma_f32_16x16x32_bf16 v[20:23], a[144:147], v[112:115], v[20:23]
    v_mfma_f32_16x16x32_bf16 v[40:43], a[144:147], v[116:119], v[40:43]
    v_mfma_f32_16x16x32_bf16 v[60:63], a[144:147], v[120:123], v[60:63]
    v_mfma_f32_16x16x32_bf16 v[80:83], a[144:147], v[124:127], v[80:83]
    s_add_u32 s41, s50, 12288
    buffer_load_dwordx4 v[96:99], v2, s[12:15], s41 offen offset:0 sc1
    v_mfma_f32_16x16x32_bf16 v[24:27], a[148:151], v[112:115], v[24:27]
    v_mfma_f32_16x16x32_bf16 v[44:47], a[148:151], v[116:119], v[44:47]
    v_mfma_f32_16x16x32_bf16 v[64:67], a[148:151], v[120:123], v[64:67]
    v_mfma_f32_16x16x32_bf16 v[84:87], a[148:151], v[124:127], v[84:87]
    s_add_u32 s41, s51, 12288
    buffer_load_dwordx4 v[100:103], v2, s[12:15], s41 offen offset:0 sc1
    v_mfma_f32_16x16x32_bf16 v[28:31], a[152:155], v[112:115], v[28:31]
    v_mfma_f32_16x16x32_bf16 v[48:51], a[152:155], v[116:119], v[48:51]
    v_mfma_f32_16x16x32_bf16 v[68:71], a[152:155], v[120:123], v[68:71]
    v_mfma_f32_16x16x32_bf16 v[88:91], a[152:155], v[124:127], v[88:91]
    s_add_u32 s41, s52, 12288
    buffer_load_dwordx4 v[104:107], v2, s[12:15], s41 offen offset:0 sc1
    v_mfma_f32_16x16x32_bf16 v[32:35], a[156:159], v[112:115], v[32:35]
    v_mfma_f32_16x16x32_bf16 v[52:55], a[156:159], v[116:119], v[52:55]
    v_mfma_f32_16x16x32_bf16 v[72:75], a[156:159], v[120:123], v[72:75]
    v_mfma_f32_16x16x32_bf16 v[92:95], a[156:159], v[124:127], v[92:95]
    s_add_u32 s41, s53, 12288
    buffer_load_dwordx4 v[108:111], v2, s[12:15], s41 offen offset:0 sc1
    s_waitcnt vmcnt(16)
    v_mfma_f32_16x16x32_bf16 v[16:19], a[160:163], v[128:131], v[16:19]
    v_mfma_f32_16x16x32_bf16 v[36:39], a[160:163], v[132:135], v[36:39]
    v_mfma_f32_16x16x32_bf16 v[56:59], a[160:163], v[136:139], v[56:59]
    v_mfma_f32_16x16x32_bf16 v[76:79], a[160:163], v[140:143], v[76:79]
    v_mfma_f32_16x16x32_bf16 v[20:23], a[164:167], v[128:131], v[20:23]
    v_mfma_f32_16x16x32_bf16 v[40:43], a[164:167], v[132:135], v[40:43]
    v_mfma_f32_16x16x32_bf16 v[60:63], a[164:167], v[136:139], v[60:63]
    v_mfma_f32_16x16x32_bf16 v[80:83], a[164:167], v[140:143], v[80:83]
    s_add_u32 s41, s50, 12288
    buffer_load_dwordx4 v[112:115], v2, s[12:15], s41 offen offset:1024 sc1
    v_mfma_f32_16x16x32_bf16 v[24:27], a[168:171], v[128:131], v[24:27]
    v_mfma_f32_16x16x32_bf16 v[44:47], a[168:171], v[132:135], v[44:47]
    v_mfma_f32_16x16x32_bf16 v[64:67], a[168:171], v[136:139], v[64:67]
    v_mfma_f32_16x16x32_bf16 v[84:87], a[168:171], v[140:143], v[84:87]
    s_add_u32 s41, s51, 12288
    buffer_load_dwordx4 v[116:119], v2, s[12:15], s41 offen offset:1024 sc1
    v_mfma_f32_16x16x32_bf16 v[28:31], a[172:175], v[128:131], v[28:31]
    v_mfma_f32_16x16x32_bf16 v[48:51], a[172:175], v[132:135], v[48:51]
    v_mfma_f32_16x16x32_bf16 v[68:71], a[172:175], v[136:139], v[68:71]
    v_mfma_f32_16x16x32_bf16 v[88:91], a[172:175], v[140:143], v[88:91]
    s_add_u32 s41, s52, 12288
    buffer_load_dwordx4 v[120:123], v2, s[12:15], s41 offen offset:1024 sc1
    v_mfma_f32_16x16x32_bf16 v[32:35], a[176:179], v[128:131], v[32:35]
    v_mfma_f32_16x16x32_bf16 v[52:55], a[176:179], v[132:135], v[52:55]
    v_mfma_f32_16x16x32_bf16 v[72:75], a[176:179], v[136:139], v[72:75]
    v_mfma_f32_16x16x32_bf16 v[92:95], a[176:179], v[140:143], v[92:95]
    s_add_u32 s41, s53, 12288
    buffer_load_dwordx4 v[124:127], v2, s[12:15], s41 offen offset:1024 sc1
    s_waitcnt vmcnt(16)
    v_mfma_f32_16x16x32_bf16 v[16:19], a[180:183], v[144:147], v[16:19]
    v_mfma_f32_16x16x32_bf16 v[36:39], a[180:183], v[148:151], v[36:39]
    v_mfma_f32_16x16x32_bf16 v[56:59], a[180:183], v[152:155], v[56:59]
    v_mfma_f32_16x16x32_bf16 v[76:79], a[180:183], v[156:159], v[76:79]
    v_mfma_f32_16x16x32_bf16 v[20:23], a[184:187], v[144:147], v[20:23]
    v_mfma_f32_16x16x32_bf16 v[40:43], a[184:187], v[148:151], v[40:43]
    v_mfma_f32_16x16x32_bf16 v[60:63], a[184:187], v[152:155], v[60:63]
    v_mfma_f32_16x16x32_bf16 v[80:83], a[184:187], v[156:159], v[80:83]
    v_mfma_f32_16x16x32_bf16 v[24:27], a[188:191], v[144:147], v[24:27]
    v_mfma_f32_16x16x32_bf16 v[44:47], a[188:191], v[148:151], v[44:47]
    v_mfma_f32_16x16x32_bf16 v[64:67], a[188:191], v[152:155], v[64:67]
    v_mfma_f32_16x16x32_bf16 v[84:87], a[188:191], v[156:159], v[84:87]
    v_mfma_f32_16x16x32_bf16 v[28:31], a[192:195], v[144:147], v[28:31]
    v_mfma_f32_16x16x32_bf16 v[48:51], a[192:195], v[148:151], v[48:51]
    v_mfma_f32_16x16x32_bf16 v[68:71], a[192:195], v[152:155], v[68:71]
    v_mfma_f32_16x16x32_bf16 v[88:91], a[192:195], v[156:159], v[88:91]
    v_mfma_f32_16x16x32_bf16 v[32:35], a[196:199], v[144:147], v[32:35]
    v_mfma_f32_16x16x32_bf16 v[52:55], a[196:199], v[148:151], v[52:55]
    v_mfma_f32_16x16x32_bf16 v[72:75], a[196:199], v[152:155], v[72:75]
    v_mfma_f32_16x16x32_bf16 v[92:95], a[196:199], v[156:159], v[92:95]
    s_waitcnt vmcnt(12)
    v_mfma_f32_16x16x32_bf16 v[16:19], a[200:203], v[160:163], v[16:19]
    v_mfma_f32_16x16x32_bf16 v[36:39], a[200:203], v[164:167], v[36:39]
    v_mfma_f32_16x16x32_bf16 v[56:59], a[200:203], v[168:171], v[56:59]
    v_mfma_f32_16x16x32_bf16 v[76:79], a[200:203], v[172:175], v[76:79]
    v_mfma_f32_16x16x32_bf16 v[20:23], a[204:207], v[160:163], v[20:23]
    v_mfma_f32_16x16x32_bf16 v[40:43], a[204:207], v[164:167], v[40:43]
    v_mfma_f32_16x16x32_bf16 v[60:63], a[204:207], v[168:171], v[60:63]
    v_mfma_f32_16x16x32_bf16 v[80:83], a[204:207], v[172:175], v[80:83]
    v_mfma_f32_16x16x32_bf16 v[24:27], a[208:211], v[160:163], v[24:27]
    v_mfma_f32_16x16x32_bf16 v[44:47], a[208:211], v[164:167], v[44:47]
    v_mfma_f32_16x16x32_bf16 v[64:67], a[208:211], v[168:171], v[64:67]
    v_mfma_f32_16x16x32_bf16 v[84:87], a[208:211], v[172:175], v[84:87]
    v_mfma_f32_16x16x32_bf16 v[28:31], a[212:215], v[160:163], v[28:31]
    v_mfma_f32_16x16x32_bf16 v[48:51], a[212:215], v[164:167], v[48:51]
    v_mfma_f32_16x16x32_bf16 v[68:71], a[212:215], v[168:171], v[68:71]
    v_mfma_f32_16x16x32_bf16 v[88:91], a[212:215], v[172:175], v[88:91]
    v_mfma_f32_16x16x32_bf16 v[32:35], a[216:219], v[160:163], v[32:35]
    v_mfma_f32_16x16x32_bf16 v[52:55], a[216:219], v[164:167], v[52:55]
    v_mfma_f32_16x16x32_bf16 v[72:75], a[216:219], v[168:171], v[72:75]
    v_mfma_f32_16x16x32_bf16 v[92:95], a[216:219], v[172:175], v[92:95]
    s_waitcnt vmcnt(8)
    v_mfma_f32_16x16x32_bf16 v[16:19], a[220:223], v[176:179], v[16:19]
    v_mfma_f32_16x16x32_bf16 v[36:39], a[220:223], v[180:183], v[36:39]
    v_mfma_f32_16x16x32_bf16 v[56:59], a[220:223], v[184:187], v[56:59]
    v_mfma_f32_16x16x32_bf16 v[76:79], a[220:223], v[188:191], v[76:79]
    v_mfma_f32_16x16x32_bf16 v[20:23], a[224:227], v[176:179], v[20:23]
    v_mfma_f32_16x16x32_bf16 v[40:43], a[224:227], v[180:183], v[40:43]
    v_mfma_f32_16x16x32_bf16 v[60:63], a[224:227], v[184:187], v[60:63]
    v_mfma_f32_16x16x32_bf16 v[80:83], a[224:227], v[188:191], v[80:83]
    v_mfma_f32_16x16x32_bf16 v[24:27], a[228:231], v[176:179], v[24:27]
    v_mfma_f32_16x16x32_bf16 v[44:47], a[228:231], v[180:183], v[44:47]
    v_mfma_f32_16x16x32_bf16 v[64:67], a[228:231], v[184:187], v[64:67]
    v_mfma_f32_16x16x32_bf16 v[84:87], a[228:231], v[188:191], v[84:87]
    v_mfma_f32_16x16x32_bf16 v[28:31], a[232:235], v[176:179], v[28:31]
    v_mfma_f32_16x16x32_bf16 v[48:51], a[232:235], v[180:183], v[48:51]
    v_mfma_f32_16x16x32_bf16 v[68:71], a[232:235], v[184:187], v[68:71]
    v_mfma_f32_16x16x32_bf16 v[88:91], a[232:235], v[188:191], v[88:91]
    v_mfma_f32_16x16x32_bf16 v[32:35], a[236:239], v[176:179], v[32:35]
    v_mfma_f32_16x16x32_bf16 v[52:55], a[236:239], v[180:183], v[52:55]
    v_mfma_f32_16x16x32_bf16 v[72:75], a[236:239], v[184:187], v[72:75]
    v_mfma_f32_16x16x32_bf16 v[92:95], a[236:239], v[188:191], v[92:95]
    s_cmp_eq_u32 s30, 3
    s_cbranch_scc1 k2_kernel_k4skip37
    s_waitcnt vmcnt(4)
    v_mfma_f32_16x16x32_bf16 v[16:19], a[240:243], v[96:99], v[16:19]
    v_mfma_f32_16x16x32_bf16 v[36:39], a[240:243], v[100:103], v[36:39]
    v_mfma_f32_16x16x32_bf16 v[56:59], a[240:243], v[104:107], v[56:59]
    v_mfma_f32_16x16x32_bf16 v[76:79], a[240:243], v[108:111], v[76:79]
    v_mfma_f32_16x16x32_bf16 v[20:23], a[244:247], v[96:99], v[20:23]
    v_mfma_f32_16x16x32_bf16 v[40:43], a[244:247], v[100:103], v[40:43]
    v_mfma_f32_16x16x32_bf16 v[60:63], a[244:247], v[104:107], v[60:63]
    v_mfma_f32_16x16x32_bf16 v[80:83], a[244:247], v[108:111], v[80:83]
    v_mfma_f32_16x16x32_bf16 v[24:27], a[248:251], v[96:99], v[24:27]
    v_mfma_f32_16x16x32_bf16 v[44:47], a[248:251], v[100:103], v[44:47]
    v_mfma_f32_16x16x32_bf16 v[64:67], a[248:251], v[104:107], v[64:67]
    v_mfma_f32_16x16x32_bf16 v[84:87], a[248:251], v[108:111], v[84:87]
    v_mfma_f32_16x16x32_bf16 v[28:31], a[252:255], v[96:99], v[28:31]
    v_mfma_f32_16x16x32_bf16 v[48:51], a[252:255], v[100:103], v[48:51]
    v_mfma_f32_16x16x32_bf16 v[68:71], a[252:255], v[104:107], v[68:71]
    v_mfma_f32_16x16x32_bf16 v[88:91], a[252:255], v[108:111], v[88:91]
    v_mfma_f32_16x16x32_bf16 v[32:35], v[192:195], v[96:99], v[32:35]
    v_mfma_f32_16x16x32_bf16 v[52:55], v[192:195], v[100:103], v[52:55]
    v_mfma_f32_16x16x32_bf16 v[72:75], v[192:195], v[104:107], v[72:75]
    v_mfma_f32_16x16x32_bf16 v[92:95], v[192:195], v[108:111], v[92:95]
    s_waitcnt vmcnt(0)
    v_mfma_f32_16x16x32_bf16 v[16:19], v[196:199], v[112:115], v[16:19]
    v_mfma_f32_16x16x32_bf16 v[36:39], v[196:199], v[116:119], v[36:39]
    v_mfma_f32_16x16x32_bf16 v[56:59], v[196:199], v[120:123], v[56:59]
    v_mfma_f32_16x16x32_bf16 v[76:79], v[196:199], v[124:127], v[76:79]
    v_mfma_f32_16x16x32_bf16 v[20:23], v[200:203], v[112:115], v[20:23]
    v_mfma_f32_16x16x32_bf16 v[40:43], v[200:203], v[116:119], v[40:43]
    v_mfma_f32_16x16x32_bf16 v[60:63], v[200:203], v[120:123], v[60:63]
    v_mfma_f32_16x16x32_bf16 v[80:83], v[200:203], v[124:127], v[80:83]
    v_mfma_f32_16x16x32_bf16 v[24:27], v[204:207], v[112:115], v[24:27]
    v_mfma_f32_16x16x32_bf16 v[44:47], v[204:207], v[116:119], v[44:47]
    v_mfma_f32_16x16x32_bf16 v[64:67], v[204:207], v[120:123], v[64:67]
    v_mfma_f32_16x16x32_bf16 v[84:87], v[204:207], v[124:127], v[84:87]
    v_mfma_f32_16x16x32_bf16 v[28:31], v[208:211], v[112:115], v[28:31]
    v_mfma_f32_16x16x32_bf16 v[48:51], v[208:211], v[116:119], v[48:51]
    v_mfma_f32_16x16x32_bf16 v[68:71], v[208:211], v[120:123], v[68:71]
    v_mfma_f32_16x16x32_bf16 v[88:91], v[208:211], v[124:127], v[88:91]
    v_mfma_f32_16x16x32_bf16 v[32:35], v[212:215], v[112:115], v[32:35]
    v_mfma_f32_16x16x32_bf16 v[52:55], v[212:215], v[116:119], v[52:55]
    v_mfma_f32_16x16x32_bf16 v[72:75], v[212:215], v[120:123], v[72:75]
    v_mfma_f32_16x16x32_bf16 v[92:95], v[212:215], v[124:127], v[92:95]
k2_kernel_k4skip37:
    s_waitcnt vmcnt(0)
    s_barrier
    s_add_u32 s41, s30, 1
    s_and_b32 s41, s41, 3
    s_mul_i32 s41, s41, 15360
    s_add_u32 s41, s41, 0
    v_add_u32 v9, s41, v2
    ds_write_b128 v9, v[36:39] offset:0
    ds_write_b128 v9, v[40:43] offset:1024
    ds_write_b128 v9, v[44:47] offset:2048
    ds_write_b128 v9, v[48:51] offset:3072
    ds_write_b128 v9, v[52:55] offset:4096
    s_add_u32 s41, s30, 2
    s_and_b32 s41, s41, 3
    s_mul_i32 s41, s41, 15360
    s_add_u32 s41, s41, 5120
    v_add_u32 v9, s41, v2
    ds_write_b128 v9, v[56:59] offset:0
    ds_write_b128 v9, v[60:63] offset:1024
    ds_write_b128 v9, v[64:67] offset:2048
    ds_write_b128 v9, v[68:71] offset:3072
    ds_write_b128 v9, v[72:75] offset:4096
    s_add_u32 s41, s30, 3
    s_and_b32 s41, s41, 3
    s_mul_i32 s41, s41, 15360
    s_add_u32 s41, s41, 10240
    v_add_u32 v9, s41, v2
    ds_write_b128 v9, v[76:79] offset:0
    ds_write_b128 v9, v[80:83] offset:1024
    ds_write_b128 v9, v[84:87] offset:2048
    ds_write_b128 v9, v[88:91] offset:3072
    ds_write_b128 v9, v[92:95] offset:4096
    v_lshlrev_b32 v10, 4, v3
    v_add_u32 v10, 157696, v10
    ds_read_b128 v[96:99], v10 offset:0
    ds_read_b128 v[100:103], v10 offset:64
    ds_read_b128 v[104:107], v10 offset:128
    ds_read_b128 v[108:111], v10 offset:192
    ds_read_b128 v[112:115], v10 offset:256
    s_mul_i32 s41, s30, 15360
    v_add_u32 v9, s41, v2
    s_waitcnt lgkmcnt(0)
    s_barrier
    ds_read_b128 v[116:119], v9 offset:0
    ds_read_b128 v[120:123], v9 offset:1024
    ds_read_b128 v[124:127], v9 offset:2048
    ds_read_b128 v[128:131], v9 offset:3072
    ds_read_b128 v[132:135], v9 offset:4096
    ds_read_b128 v[136:139], v9 offset:5120
    ds_read_b128 v[140:143], v9 offset:6144
    ds_read_b128 v[144:147], v9 offset:7168
    ds_read_b128 v[148:151], v9 offset:8192
    ds_read_b128 v[152:155], v9 offset:9216
    ds_read_b128 v[156:159], v9 offset:10240
    ds_read_b128 v[160:163], v9 offset:11264
    ds_read_b128 v[164:167], v9 offset:12288
    ds_read_b128 v[168:171], v9 offset:13312
    ds_read_b128 v[172:175], v9 offset:14336
    s_lshl_b32 s46, s32, 2
    s_add_u32 s46, s46, s30
    s_lshl_b32 s46, s46, 4
    s_lshl_b32 s47, s28, 8
    s_add_u32 s46, s46, s47
    v_add_u32 v10, s46, v4
    v_mul_u32_u24 v10, 1280, v10
    v_lshl_add_u32 v10, v3, 3, v10
    s_mul_i32 s47, s33, 160
    s_nop 1
    v_permlane16_swap_b32 v228, v230
    v_permlane16_swap_b32 v229, v231
    v_permlane16_swap_b32 v232, v234
    v_permlane16_swap_b32 v233, v235
    v_permlane16_swap_b32 v238, v240
    v_permlane16_swap_b32 v239, v241
    v_permlane16_swap_b32 v242, v244
    v_permlane16_swap_b32 v243, v245
    s_waitcnt lgkmcnt(0)
    v_pk_add_f32 v[16:17], v[16:17], v[116:117]
    v_pk_add_f32 v[18:19], v[18:19], v[118:119]
    v_pk_add_f32 v[20:21], v[20:21], v[120:121]
    v_pk_add_f32 v[22:23], v[22:23], v[122:123]
    v_pk_add_f32 v[24:25], v[24:25], v[124:125]
    v_pk_add_f32 v[26:27], v[26:27], v[126:127]
    v_pk_add_f32 v[28:29], v[28:29], v[128:129]
    v_pk_add_f32 v[30:31], v[30:31], v[130:131]
    v_pk_add_f32 v[32:33], v[32:33], v[132:133]
    v_pk_add_f32 v[34:35], v[34:35], v[134:135]
    v_pk_add_f32 v[16:17], v[16:17], v[136:137]
    v_pk_add_f32 v[18:19], v[18:19], v[138:139]
    v_pk_add_f32 v[20:21], v[20:21], v[140:141]
    v_pk_add_f32 v[22:23], v[22:23], v[142:143]
    v_pk_add_f32 v[24:25], v[24:25], v[144:145]
    v_pk_add_f32 v[26:27], v[26:27], v[146:147]
    v_pk_add_f32 v[28:29], v[28:29], v[148:149]
    v_pk_add_f32 v[30:31], v[30:31], v[150:151]
    v_pk_add_f32 v[32:33], v[32:33], v[152:153]
    v_pk_add_f32 v[34:35], v[34:35], v[154:155]
    v_pk_add_f32 v[16:17], v[16:17], v[156:157]
    v_pk_add_f32 v[18:19], v[18:19], v[158:159]
    v_pk_add_f32 v[20:21], v[20:21], v[160:161]
    v_pk_add_f32 v[22:23], v[22:23], v[162:163]
    v_pk_add_f32 v[24:25], v[24:25], v[164:165]
    v_pk_add_f32 v[26:27], v[26:27], v[166:167]
    v_pk_add_f32 v[28:29], v[28:29], v[168:169]
    v_pk_add_f32 v[30:31], v[30:31], v[170:171]
    v_pk_add_f32 v[32:33], v[32:33], v[172:173]
    v_pk_add_f32 v[34:35], v[34:35], v[174:175]
    v_lshlrev_b32 v116, 16, v238
    v_and_b32 v117, 0xffff0000, v238
    v_lshlrev_b32 v118, 16, v239
    v_and_b32 v119, 0xffff0000, v239
    v_lshlrev_b32 v136, 16, v228
    v_and_b32 v137, 0xffff0000, v228
    v_lshlrev_b32 v138, 16, v229
    v_and_b32 v139, 0xffff0000, v229
    v_lshlrev_b32 v120, 16, v240
    v_and_b32 v121, 0xffff0000, v240
    v_lshlrev_b32 v122, 16, v241
    v_and_b32 v123, 0xffff0000, v241
    v_lshlrev_b32 v140, 16, v230
    v_and_b32 v141, 0xffff0000, v230
    v_lshlrev_b32 v142, 16, v231
    v_and_b32 v143, 0xffff0000, v231
    v_lshlrev_b32 v124, 16, v242
    v_and_b32 v125, 0xffff0000, v242
    v_lshlrev_b32 v126, 16, v243
    v_and_b32 v127, 0xffff0000, v243
    v_lshlrev_b32 v144, 16, v232
    v_and_b32 v145, 0xffff0000, v232
    v_lshlrev_b32 v146, 16, v233
    v_and_b32 v147, 0xffff0000, v233
    v_lshlrev_b32 v128, 16, v244
    v_and_b32 v129, 0xffff0000, v244
    v_lshlrev_b32 v130, 16, v245
    v_and_b32 v131, 0xffff0000, v245
    v_lshlrev_b32 v148, 16, v234
    v_and_b32 v149, 0xffff0000, v234
    v_lshlrev_b32 v150, 16, v235
    v_and_b32 v151, 0xffff0000, v235
    v_lshlrev_b32 v132, 16, v246
    v_and_b32 v133, 0xffff0000, v246
    v_lshlrev_b32 v134, 16, v247
    v_and_b32 v135, 0xffff0000, v247
    v_lshlrev_b32 v152, 16, v236
    v_and_b32 v153, 0xffff0000, v236
    v_lshlrev_b32 v154, 16, v237
    v_and_b32 v155, 0xffff0000, v237
    v_pk_add_f32 v[16:17], v[16:17], v[116:117]
    v_pk_add_f32 v[18:19], v[18:19], v[118:119]
    v_pk_add_f32 v[20:21], v[20:21], v[120:121]
    v_pk_add_f32 v[22:23], v[22:23], v[122:123]
    v_pk_add_f32 v[24:25], v[24:25], v[124:125]
    v_pk_add_f32 v[26:27], v[26:27], v[126:127]
    v_pk_add_f32 v[28:29], v[28:29], v[128:129]
    v_pk_add_f32 v[30:31], v[30:31], v[130:131]
    v_pk_add_f32 v[32:33], v[32:33], v[132:133]
    v_pk_add_f32 v[34:35], v[34:35], v[134:135]
    v_pk_fma_f32 v[16:17], v[16:17], v[96:97], v[136:137]
    v_pk_fma_f32 v[18:19], v[18:19], v[98:99], v[138:139]
    v_pk_fma_f32 v[20:21], v[20:21], v[100:101], v[140:141]
    v_pk_fma_f32 v[22:23], v[22:23], v[102:103], v[142:143]
    v_pk_fma_f32 v[24:25], v[24:25], v[104:105], v[144:145]
    v_pk_fma_f32 v[26:27], v[26:27], v[106:107], v[146:147]
    v_pk_fma_f32 v[28:29], v[28:29], v[108:109], v[148:149]
    v_pk_fma_f32 v[30:31], v[30:31], v[110:111], v[150:151]
    v_pk_fma_f32 v[32:33], v[32:33], v[112:113], v[152:153]
    v_pk_fma_f32 v[34:35], v[34:35], v[114:115], v[154:155]
    v_cvt_pk_bf16_f32 v16, v16, v17
    v_cvt_pk_bf16_f32 v17, v18, v19
    v_cvt_pk_bf16_f32 v18, v20, v21
    v_cvt_pk_bf16_f32 v19, v22, v23
    v_cvt_pk_bf16_f32 v24, v24, v25
    v_cvt_pk_bf16_f32 v25, v26, v27
    v_cvt_pk_bf16_f32 v26, v28, v29
    v_cvt_pk_bf16_f32 v27, v30, v31
    v_cvt_pk_bf16_f32 v32, v32, v33
    v_cvt_pk_bf16_f32 v33, v34, v35
    s_nop 1
    v_permlane16_swap_b32 v16, v18
    v_permlane16_swap_b32 v17, v19
    v_permlane16_swap_b32 v24, v26
    v_permlane16_swap_b32 v25, v27
    v_and_b32 v9, 1, v3
    v_lshlrev_b32 v9, 5, v9
    v_lshrrev_b32 v11, 1, v3
    v_lshl_add_u32 v9, v11, 4, v9
    v_lshlrev_b32 v11, 3, v3
    v_sub_u32 v11, v10, v11
    v_add_u32 v11, v11, v9
    buffer_store_dwordx4 v[16:19], v11, s[24:27], s47 offen offset:0 sc1
    buffer_store_dwordx4 v[24:27], v11, s[24:27], s47 offen offset:64 sc1
    buffer_store_dwordx2 v[32:33], v10, s[24:27], s47 offen offset:128 sc1
    s_waitcnt vmcnt(0) lgkmcnt(0)
    s_endpgm
k2_end:
    s_endpgm
CODE_END:
    s_endpgm
.section .rodata,"a"
.p2align 6
.amdhsa_kernel k0_kernel
  .amdhsa_next_free_vgpr 112
  .amdhsa_next_free_sgpr 64
  .amdhsa_accum_offset 112
  .amdhsa_group_segment_fixed_size 0
  .amdhsa_kernarg_size 128
  .amdhsa_user_sgpr_count 2
  .amdhsa_user_sgpr_kernarg_segment_ptr 1
  .amdhsa_system_sgpr_workgroup_id_x 1
  .amdhsa_float_denorm_mode_32 3
.end_amdhsa_kernel
.p2align 6
.amdhsa_kernel k1_kernel
  .amdhsa_next_free_vgpr 256
  .amdhsa_next_free_sgpr 64
  .amdhsa_accum_offset 256
  .amdhsa_group_segment_fixed_size 0
  .amdhsa_kernarg_size 128
  .amdhsa_user_sgpr_count 2
  .amdhsa_user_sgpr_kernarg_segment_ptr 1
  .amdhsa_system_sgpr_workgroup_id_x 1
  .amdhsa_float_denorm_mode_32 3
.end_amdhsa_kernel
.p2align 6
.amdhsa_kernel k2_kernel
  .amdhsa_next_free_vgpr 512
  .amdhsa_next_free_sgpr 102
  .amdhsa_accum_offset 256
  .amdhsa_group_segment_fixed_size 0
  .amdhsa_kernarg_size 128
  .amdhsa_user_sgpr_count 2
  .amdhsa_user_sgpr_kernarg_segment_ptr 1
  .amdhsa_system_sgpr_workgroup_id_x 1
  .amdhsa_float_denorm_mode_32 3
.end_amdhsa_kernel
```

```asm
; @launch kernel=k1_kernel grid=(352,1,1) block=(256,1,1) lds=48128
; @launch kernel=k2_kernel grid=(256,1,1) block=(256,1,1) lds=163840
.amdgcn_target "amdgcn-amd-amdhsa--gfx950"
.text
.globl k1_kernel
.p2align 8
.type k1_kernel,@function
k1_kernel:
    s_cmp_ge_u32 s2, 352
    s_cbranch_scc1 k1_end
    s_load_dwordx4 s[4:7], s[0:1], 32
    s_load_dwordx2 s[10:11], s[0:1], 120
    s_load_dwordx4 s[12:15], s[0:1], 8
    s_load_dwordx2 s[8:9], s[0:1], 24
    v_lshrrev_b32 v2, 6, v0
    v_and_b32 v1, 63, v0
    v_readfirstlane_b32 s20, v2
    s_sub_u32 s54, s2, 160
    s_cmp_ge_u32 s2, 256
    s_cbranch_scc1 k1_side
    s_and_b32 s55, s2, 7
    s_lshr_b32 s56, s2, 3
    s_lshl_b32 s57, s55, 9
    s_add_u32 s57, s57, 9056256
    v_mov_b32 v250, 0
    s_waitcnt lgkmcnt(0)
    s_mov_b32 s28, s10
    s_mov_b32 s29, s11
    s_mov_b32 s30, 268435456
    s_mov_b32 s31, 0x00020000
    buffer_load_dword v251, v250, s[28:31], s57 offen sc1
    s_mov_b32 s16, s12
    s_mov_b32 s17, s13
    s_mov_b32 s18, 2621440
    s_mov_b32 s19, 0x00020000
    s_mov_b32 s40, s14
    s_mov_b32 s41, s15
    s_mov_b32 s42, 2621440
    s_mov_b32 s43, 0x00020000
    s_mov_b32 s44, s8
    s_mov_b32 s45, s9
    s_mov_b32 s46, 5120
    s_mov_b32 s47, 0x00020000
    v_mul_u32_u24 v4, 3277, v0
    v_lshrrev_b32 v4, 16, v4
    v_mul_u32_u24 v5, 20, v4
    v_sub_u32 v5, v0, v5
    s_lshl_b32 s21, s56, 6
    v_lshl_add_u32 v6, v4, 3, s21
    v_mul_u32_u24 v6, 1280, v6
    s_mul_i32 s22, s55, 160
    v_lshl_add_u32 v7, v5, 3, s22
    v_add_u32 v6, v6, v7
    v_subrev_u32 v8, 3840, v6
    v_add_u32 v9, 5120, v6
    s_movk_i32 s23, 160
    v_cmp_gt_u32 vcc, s23, v0
    s_and_saveexec_b64 s[60:61], vcc
    s_cbranch_execz k1_kvld
    buffer_load_dwordx2 v[10:11], v8, s[16:19], 0 offen offset:0
    buffer_load_dwordx2 v[12:13], v8, s[16:19], 0 offen offset:1280
    buffer_load_dwordx2 v[14:15], v8, s[16:19], 0 offen offset:2560
    buffer_load_dwordx2 v[16:17], v6, s[16:19], 0 offen offset:0
    buffer_load_dwordx2 v[18:19], v6, s[16:19], 0 offen offset:1280
    buffer_load_dwordx2 v[20:21], v6, s[16:19], 0 offen offset:2560
    buffer_load_dwordx2 v[22:23], v6, s[16:19], 0 offen offset:3840
    buffer_load_dwordx2 v[24:25], v9, s[16:19], 0 offen offset:0
    buffer_load_dwordx2 v[26:27], v9, s[16:19], 0 offen offset:1280
    buffer_load_dwordx2 v[28:29], v9, s[16:19], 0 offen offset:2560
    buffer_load_dwordx2 v[30:31], v9, s[16:19], 0 offen offset:3840
    v_lshlrev_b32 v150, 2, v7
    buffer_load_dwordx4 v[48:51], v150, s[44:47], 0 offen
    buffer_load_dwordx4 v[52:55], v150, s[44:47], 0 offen offset:16
    buffer_load_dwordx2 v[32:33], v6, s[40:43], 0 offen offset:0
    buffer_load_dwordx2 v[34:35], v6, s[40:43], 0 offen offset:1280
    buffer_load_dwordx2 v[36:37], v6, s[40:43], 0 offen offset:2560
    buffer_load_dwordx2 v[38:39], v6, s[40:43], 0 offen offset:3840
    buffer_load_dwordx2 v[40:41], v9, s[40:43], 0 offen offset:0
    buffer_load_dwordx2 v[42:43], v9, s[40:43], 0 offen offset:1280
    buffer_load_dwordx2 v[44:45], v9, s[40:43], 0 offen offset:2560
    buffer_load_dwordx2 v[46:47], v9, s[40:43], 0 offen offset:3840
k1_kvld:
    s_mov_b64 exec, -1
    s_mov_b32 s24, s4
    s_mov_b32 s25, s5
    s_mov_b32 s26, 2621440
    s_mov_b32 s27, 0x00020000
    s_cmp_lt_u32 s56, 12
    s_cbranch_scc1 k1_kernel_nc1
    s_mul_i32 s58, s55, 20
    s_add_u32 s58, s58, s56
    s_sub_u32 s58, s58, 12
    s_lshl_b32 s21, s58, 2
    s_add_u32 s21, s21, s20
    s_mul_i32 s34, s20, 9472
    v_lshlrev_b32 v3, 4, v1
    s_lshl_b32 s35, s21, 12
    s_add_u32 s36, s34, 256
    s_mov_b32 m0, s36
    s_nop 0
    buffer_load_dwordx4 v3, s[24:27], s35 offen offset:0 lds
    buffer_load_dwordx4 v3, s[24:27], s35 offen offset:1024 lds
    buffer_load_dwordx4 v3, s[24:27], s35 offen offset:2048 lds
    buffer_load_dwordx4 v3, s[24:27], s35 offen offset:3072 lds
k1_kernel_nc1:
    s_mov_b64 exec, s[60:61]
    s_movk_i32 s23, 160
    v_cmp_gt_u32 vcc, s23, v0
    s_and_b64 exec, exec, vcc
    s_cbranch_execz k1_kvskip
    v_sub_u32 v150, 7, v4
    v_and_b32 v151, 7, v5
    v_xor_b32 v150, v150, v151
    v_lshlrev_b32 v150, 4, v150
    v_lshl_add_u32 v150, v5, 9, v150
    v_add_u32 v150, 37888, v150
    s_cmp_lt_u32 s56, 12
    s_cbranch_scc1 k1_w8
    s_waitcnt vmcnt(12)
    s_branch k1_w9
k1_w8:
    s_waitcnt vmcnt(8)
k1_w9:
    v_lshlrev_b32 v56, 16, v48
    v_and_b32 v60, 0xffff0000, v48
    v_lshlrev_b32 v64, 16, v49
    v_and_b32 v68, 0xffff0000, v49
    v_lshlrev_b32 v57, 16, v50
    v_and_b32 v61, 0xffff0000, v50
    v_lshlrev_b32 v65, 16, v51
    v_and_b32 v69, 0xffff0000, v51
    v_lshlrev_b32 v58, 16, v52
    v_and_b32 v62, 0xffff0000, v52
    v_lshlrev_b32 v66, 16, v53
    v_and_b32 v70, 0xffff0000, v53
    v_lshlrev_b32 v59, 16, v54
    v_and_b32 v63, 0xffff0000, v54
    v_lshlrev_b32 v67, 16, v55
    v_and_b32 v71, 0xffff0000, v55
    v_lshlrev_b32 v72, 16, v10
    v_and_b32 v73, 0xffff0000, v10
    v_lshlrev_b32 v74, 16, v11
    v_and_b32 v75, 0xffff0000, v11
    v_lshlrev_b32 v76, 16, v12
    v_and_b32 v77, 0xffff0000, v12
    v_lshlrev_b32 v78, 16, v13
    v_and_b32 v79, 0xffff0000, v13
    v_lshlrev_b32 v80, 16, v14
    v_and_b32 v81, 0xffff0000, v14
    v_lshlrev_b32 v82, 16, v15
    v_and_b32 v83, 0xffff0000, v15
    v_lshlrev_b32 v84, 16, v16
    v_and_b32 v85, 0xffff0000, v16
    v_lshlrev_b32 v86, 16, v17
    v_and_b32 v87, 0xffff0000, v17
    v_lshlrev_b32 v88, 16, v18
    v_and_b32 v89, 0xffff0000, v18
    v_lshlrev_b32 v90, 16, v19
    v_and_b32 v91, 0xffff0000, v19
    v_lshlrev_b32 v92, 16, v20
    v_and_b32 v93, 0xffff0000, v20
    v_lshlrev_b32 v94, 16, v21
    v_and_b32 v95, 0xffff0000, v21
    v_lshlrev_b32 v96, 16, v22
    v_and_b32 v97, 0xffff0000, v22
    v_lshlrev_b32 v98, 16, v23
    v_and_b32 v99, 0xffff0000, v23
    v_lshlrev_b32 v100, 16, v24
    v_and_b32 v101, 0xffff0000, v24
    v_lshlrev_b32 v102, 16, v25
    v_and_b32 v103, 0xffff0000, v25
    v_lshlrev_b32 v104, 16, v26
    v_and_b32 v105, 0xffff0000, v26
    v_lshlrev_b32 v106, 16, v27
    v_and_b32 v107, 0xffff0000, v27
    v_lshlrev_b32 v108, 16, v28
    v_and_b32 v109, 0xffff0000, v28
    v_lshlrev_b32 v110, 16, v29
    v_and_b32 v111, 0xffff0000, v29
    v_lshlrev_b32 v112, 16, v30
    v_and_b32 v113, 0xffff0000, v30
    v_lshlrev_b32 v114, 16, v31
    v_and_b32 v115, 0xffff0000, v31
    v_pk_mul_f32 v[116:117], v[72:73], v[68:69]
    v_pk_mul_f32 v[120:121], v[76:77], v[68:69]
    v_pk_mul_f32 v[124:125], v[80:81], v[68:69]
    v_pk_mul_f32 v[128:129], v[84:85], v[68:69]
    v_pk_mul_f32 v[132:133], v[88:89], v[68:69]
    v_pk_mul_f32 v[136:137], v[92:93], v[68:69]
    v_pk_mul_f32 v[140:141], v[96:97], v[68:69]
    v_pk_mul_f32 v[144:145], v[100:101], v[68:69]
    v_pk_fma_f32 v[116:117], v[76:77], v[64:65], v[116:117]
    v_pk_fma_f32 v[120:121], v[80:81], v[64:65], v[120:121]
    v_pk_fma_f32 v[124:125], v[84:85], v[64:65], v[124:125]
    v_pk_fma_f32 v[128:129], v[88:89], v[64:65], v[128:129]
    v_pk_fma_f32 v[132:133], v[92:93], v[64:65], v[132:133]
    v_pk_fma_f32 v[136:137], v[96:97], v[64:65], v[136:137]
    v_pk_fma_f32 v[140:141], v[100:101], v[64:65], v[140:141]
    v_pk_fma_f32 v[144:145], v[104:105], v[64:65], v[144:145]
    v_pk_fma_f32 v[116:117], v[80:81], v[60:61], v[116:117]
    v_pk_fma_f32 v[120:121], v[84:85], v[60:61], v[120:121]
    v_pk_fma_f32 v[124:125], v[88:89], v[60:61], v[124:125]
    v_pk_fma_f32 v[128:129], v[92:93], v[60:61], v[128:129]
    v_pk_fma_f32 v[132:133], v[96:97], v[60:61], v[132:133]
    v_pk_fma_f32 v[136:137], v[100:101], v[60:61], v[136:137]
    v_pk_fma_f32 v[140:141], v[104:105], v[60:61], v[140:141]
    v_pk_fma_f32 v[144:145], v[108:109], v[60:61], v[144:145]
    v_pk_fma_f32 v[116:117], v[84:85], v[56:57], v[116:117]
    v_pk_fma_f32 v[120:121], v[88:89], v[56:57], v[120:121]
    v_pk_fma_f32 v[124:125], v[92:93], v[56:57], v[124:125]
    v_pk_fma_f32 v[128:129], v[96:97], v[56:57], v[128:129]
    v_pk_fma_f32 v[132:133], v[100:101], v[56:57], v[132:133]
    v_pk_fma_f32 v[136:137], v[104:105], v[56:57], v[136:137]
    v_pk_fma_f32 v[140:141], v[108:109], v[56:57], v[140:141]
    v_pk_fma_f32 v[144:145], v[112:113], v[56:57], v[144:145]
    v_pk_mul_f32 v[118:119], v[74:75], v[70:71]
    v_pk_mul_f32 v[122:123], v[78:79], v[70:71]
    v_pk_mul_f32 v[126:127], v[82:83], v[70:71]
    v_pk_mul_f32 v[130:131], v[86:87], v[70:71]
    v_pk_mul_f32 v[134:135], v[90:91], v[70:71]
    v_pk_mul_f32 v[138:139], v[94:95], v[70:71]
    v_pk_mul_f32 v[142:143], v[98:99], v[70:71]
    v_pk_mul_f32 v[146:147], v[102:103], v[70:71]
    v_pk_fma_f32 v[118:119], v[78:79], v[66:67], v[118:119]
    v_pk_fma_f32 v[122:123], v[82:83], v[66:67], v[122:123]
    v_pk_fma_f32 v[126:127], v[86:87], v[66:67], v[126:127]
    v_pk_fma_f32 v[130:131], v[90:91], v[66:67], v[130:131]
    v_pk_fma_f32 v[134:135], v[94:95], v[66:67], v[134:135]
    v_pk_fma_f32 v[138:139], v[98:99], v[66:67], v[138:139]
    v_pk_fma_f32 v[142:143], v[102:103], v[66:67], v[142:143]
    v_pk_fma_f32 v[146:147], v[106:107], v[66:67], v[146:147]
    v_pk_fma_f32 v[118:119], v[82:83], v[62:63], v[118:119]
    v_pk_fma_f32 v[122:123], v[86:87], v[62:63], v[122:123]
    v_pk_fma_f32 v[126:127], v[90:91], v[62:63], v[126:127]
    v_pk_fma_f32 v[130:131], v[94:95], v[62:63], v[130:131]
    v_pk_fma_f32 v[134:135], v[98:99], v[62:63], v[134:135]
    v_pk_fma_f32 v[138:139], v[102:103], v[62:63], v[138:139]
    v_pk_fma_f32 v[142:143], v[106:107], v[62:63], v[142:143]
    v_pk_fma_f32 v[146:147], v[110:111], v[62:63], v[146:147]
    v_pk_fma_f32 v[118:119], v[86:87], v[58:59], v[118:119]
    v_pk_fma_f32 v[122:123], v[90:91], v[58:59], v[122:123]
    v_pk_fma_f32 v[126:127], v[94:95], v[58:59], v[126:127]
    v_pk_fma_f32 v[130:131], v[98:99], v[58:59], v[130:131]
    v_pk_fma_f32 v[134:135], v[102:103], v[58:59], v[134:135]
    v_pk_fma_f32 v[138:139], v[106:107], v[58:59], v[138:139]
    v_pk_fma_f32 v[142:143], v[110:111], v[58:59], v[142:143]
    v_pk_fma_f32 v[146:147], v[114:115], v[58:59], v[146:147]
    v_cvt_pk_bf16_f32 v154, v116, v117
    v_lshlrev_b32 v116, 16, v154
    v_and_b32 v117, 0xffff0000, v154
    v_cvt_pk_bf16_f32 v155, v118, v119
    v_lshlrev_b32 v118, 16, v155
    v_and_b32 v119, 0xffff0000, v155
    v_cvt_pk_bf16_f32 v156, v120, v121
    v_lshlrev_b32 v120, 16, v156
    v_and_b32 v121, 0xffff0000, v156
    v_cvt_pk_bf16_f32 v157, v122, v123
    v_lshlrev_b32 v122, 16, v157
    v_and_b32 v123, 0xffff0000, v157
    v_cvt_pk_bf16_f32 v158, v124, v125
    v_lshlrev_b32 v124, 16, v158
    v_and_b32 v125, 0xffff0000, v158
    v_cvt_pk_bf16_f32 v159, v126, v127
    v_lshlrev_b32 v126, 16, v159
    v_and_b32 v127, 0xffff0000, v159
    v_cvt_pk_bf16_f32 v160, v128, v129
    v_lshlrev_b32 v128, 16, v160
    v_and_b32 v129, 0xffff0000, v160
    v_cvt_pk_bf16_f32 v161, v130, v131
    v_lshlrev_b32 v130, 16, v161
    v_and_b32 v131, 0xffff0000, v161
    v_cvt_pk_bf16_f32 v154, v132, v133
    v_lshlrev_b32 v132, 16, v154
    v_and_b32 v133, 0xffff0000, v154
    v_cvt_pk_bf16_f32 v155, v134, v135
    v_lshlrev_b32 v134, 16, v155
    v_and_b32 v135, 0xffff0000, v155
    v_cvt_pk_bf16_f32 v156, v136, v137
    v_lshlrev_b32 v136, 16, v156
    v_and_b32 v137, 0xffff0000, v156
    v_cvt_pk_bf16_f32 v157, v138, v139
    v_lshlrev_b32 v138, 16, v157
    v_and_b32 v139, 0xffff0000, v157
    v_cvt_pk_bf16_f32 v158, v140, v141
    v_lshlrev_b32 v140, 16, v158
    v_and_b32 v141, 0xffff0000, v158
    v_cvt_pk_bf16_f32 v159, v142, v143
    v_lshlrev_b32 v142, 16, v159
    v_and_b32 v143, 0xffff0000, v159
    v_cvt_pk_bf16_f32 v160, v144, v145
    v_lshlrev_b32 v144, 16, v160
    v_and_b32 v145, 0xffff0000, v160
    v_cvt_pk_bf16_f32 v161, v146, v147
    v_lshlrev_b32 v146, 16, v161
    v_and_b32 v147, 0xffff0000, v161
    s_cmp_lt_u32 s56, 12
    s_cbranch_scc1 k1_w0
    s_waitcnt vmcnt(4)
    s_branch k1_w1
k1_w0:
    s_waitcnt vmcnt(0)
k1_w1:
    v_lshlrev_b32 v72, 16, v32
    v_and_b32 v73, 0xffff0000, v32
    v_lshlrev_b32 v74, 16, v33
    v_and_b32 v75, 0xffff0000, v33
    v_lshlrev_b32 v76, 16, v34
    v_and_b32 v77, 0xffff0000, v34
    v_lshlrev_b32 v78, 16, v35
    v_and_b32 v79, 0xffff0000, v35
    v_lshlrev_b32 v80, 16, v36
    v_and_b32 v81, 0xffff0000, v36
    v_lshlrev_b32 v82, 16, v37
    v_and_b32 v83, 0xffff0000, v37
    v_lshlrev_b32 v84, 16, v38
    v_and_b32 v85, 0xffff0000, v38
    v_lshlrev_b32 v86, 16, v39
    v_and_b32 v87, 0xffff0000, v39
    v_lshlrev_b32 v88, 16, v40
    v_and_b32 v89, 0xffff0000, v40
    v_lshlrev_b32 v90, 16, v41
    v_and_b32 v91, 0xffff0000, v41
    v_lshlrev_b32 v92, 16, v42
    v_and_b32 v93, 0xffff0000, v42
    v_lshlrev_b32 v94, 16, v43
    v_and_b32 v95, 0xffff0000, v43
    v_lshlrev_b32 v96, 16, v44
    v_and_b32 v97, 0xffff0000, v44
    v_lshlrev_b32 v98, 16, v45
    v_and_b32 v99, 0xffff0000, v45
    v_lshlrev_b32 v100, 16, v46
    v_and_b32 v101, 0xffff0000, v46
    v_lshlrev_b32 v102, 16, v47
    v_and_b32 v103, 0xffff0000, v47
    v_pk_mul_f32 v[116:117], v[116:117], v[72:73]
    v_pk_mul_f32 v[118:119], v[118:119], v[74:75]
    v_pk_mul_f32 v[120:121], v[120:121], v[76:77]
    v_pk_mul_f32 v[122:123], v[122:123], v[78:79]
    v_pk_mul_f32 v[124:125], v[124:125], v[80:81]
    v_pk_mul_f32 v[126:127], v[126:127], v[82:83]
    v_pk_mul_f32 v[128:129], v[128:129], v[84:85]
    v_pk_mul_f32 v[130:131], v[130:131], v[86:87]
    v_pk_mul_f32 v[132:133], v[132:133], v[88:89]
    v_pk_mul_f32 v[134:135], v[134:135], v[90:91]
    v_pk_mul_f32 v[136:137], v[136:137], v[92:93]
    v_pk_mul_f32 v[138:139], v[138:139], v[94:95]
    v_pk_mul_f32 v[140:141], v[140:141], v[96:97]
    v_pk_mul_f32 v[142:143], v[142:143], v[98:99]
    v_pk_mul_f32 v[144:145], v[144:145], v[100:101]
    v_pk_mul_f32 v[146:147], v[146:147], v[102:103]
    v_cvt_pk_bf16_f32 v10, v144, v140
    v_cvt_pk_bf16_f32 v11, v136, v132
    v_cvt_pk_bf16_f32 v12, v128, v124
    v_cvt_pk_bf16_f32 v13, v120, v116
    v_cvt_pk_bf16_f32 v14, v145, v141
    v_cvt_pk_bf16_f32 v15, v137, v133
    v_cvt_pk_bf16_f32 v16, v129, v125
    v_cvt_pk_bf16_f32 v17, v121, v117
    v_cvt_pk_bf16_f32 v18, v146, v142
    v_cvt_pk_bf16_f32 v19, v138, v134
    v_cvt_pk_bf16_f32 v20, v130, v126
    v_cvt_pk_bf16_f32 v21, v122, v118
    v_cvt_pk_bf16_f32 v22, v147, v143
    v_cvt_pk_bf16_f32 v23, v139, v135
    v_cvt_pk_bf16_f32 v24, v131, v127
    v_cvt_pk_bf16_f32 v25, v123, v119
    ds_write_b128 v150, v[10:13] offset:0
    ds_write_b128 v150, v[14:17] offset:128
    ds_write_b128 v150, v[18:21] offset:256
    ds_write_b128 v150, v[22:25] offset:384
k1_kvskip:
    s_mov_b64 exec, -1
    v_lshrrev_b32 v151, 3, v0
    v_and_b32 v152, 7, v0
    v_lshrrev_b32 v153, 2, v151
    v_and_b32 v153, 7, v153
    v_xor_b32 v153, v153, v152
    v_lshlrev_b32 v153, 4, v153
    v_lshl_add_u32 v153, v151, 7, v153
    v_add_u32 v153, 37888, v153
    v_mul_u32_u24 v151, 4224, v151
    v_lshl_add_u32 v154, v152, 4, v151
    s_mul_i32 s36, s55, 337920
    s_add_u32 s36, s36, 0
    s_lshl_b32 s37, s56, 7
    s_sub_u32 s38, 3968, s37
    s_add_u32 s38, s38, s36
    s_waitcnt lgkmcnt(0)
    s_barrier
    ds_read_b128 v[32:35], v153 offset:0
    ds_read_b128 v[36:39], v153 offset:4096
    ds_read_b128 v[40:43], v153 offset:8192
    s_waitcnt lgkmcnt(2)
    buffer_store_dwordx4 v[32:35], v154, s[28:31], s38 offen sc1
    s_add_u32 s38, s38, 135168
    s_waitcnt lgkmcnt(1)
    buffer_store_dwordx4 v[36:39], v154, s[28:31], s38 offen sc1
    s_add_u32 s38, s38, 135168
    s_movk_i32 s23, 128
    v_cmp_gt_u32 vcc, s23, v0
    s_and_saveexec_b64 s[60:61], vcc
    s_cbranch_execz k1_st2skip
    s_waitcnt lgkmcnt(0)
    buffer_store_dwordx4 v[40:43], v154, s[28:31], s38 offen sc1
    s_add_u32 s38, s38, 135168
k1_st2skip:
    s_mov_b64 exec, -1
    s_cmp_lg_u32 s56, 0
    s_cbranch_scc1 k1_kernel_L2
    v_mov_b32 v44, 0
    v_mov_b32 v45, 0
    v_mov_b32 v46, 0
    v_mov_b32 v47, 0
    s_add_u32 s36, s36, 4096
    buffer_store_dwordx4 v[44:47], v154, s[28:31], s36 offen sc1
    s_add_u32 s36, s36, 135168
    buffer_store_dwordx4 v[44:47], v154, s[28:31], s36 offen sc1
    s_add_u32 s36, s36, 135168
    s_movk_i32 s23, 128
    v_cmp_gt_u32 vcc, s23, v0
    s_and_b64 exec, exec, vcc
    s_cbranch_execz k1_kernel_L2
    buffer_store_dwordx4 v[44:47], v154, s[28:31], s36 offen sc1
    s_add_u32 s36, s36, 135168
k1_kernel_L2:
    s_mov_b64 exec, -1
    s_waitcnt vmcnt(0)
    v_add_u32 v251, 1, v251
    s_barrier
    s_cmp_lg_u32 s20, 0
    s_cbranch_scc1 k1_kernel_kf3
    s_lshl_b32 s23, s56, 2
    s_add_u32 s23, s23, s57
    s_mov_b64 exec, 1
    buffer_store_dword v251, v250, s[28:31], s23 offen offset:256
    buffer_store_dword v251, v250, s[28:31], s23 offen offset:128 sc1
    s_mov_b64 exec, -1
k1_kernel_kf3:
    s_lshl_b32 s54, s56, 3
    s_add_u32 s54, s54, s55
    s_cmp_lt_u32 s56, 12
    s_cbranch_scc1 k1_side2
    s_cmp_lg_u32 s20, 0
    s_cbranch_scc1 k1_kernel_kw4
    v_and_b32 v5, 31, v1
    v_lshlrev_b32 v5, 2, v5
    s_mov_b32 s23, 200000
    s_mov_b64 s[60:61], 0
k1_kernel_kp5:
    buffer_load_dword v6, v5, s[28:31], s57 offen offset:256 sc1
    s_waitcnt vmcnt(0)
    v_cmp_eq_u32 vcc, v251, v6
    s_sub_u32 s23, s23, 1
    s_or_b64 s[60:61], s[60:61], vcc
    s_cmp_eq_u64 s[60:61], -1
    s_cbranch_scc1 k1_kernel_kd6
    s_and_b32 s21, s23, 3
    s_cmp_lg_u32 s21, 0
    s_cbranch_scc1 k1_kernel_kq8
    buffer_load_dword v6, v5, s[28:31], s57 offen offset:128 sc1
    s_waitcnt vmcnt(0)
    v_cmp_eq_u32 vcc, v251, v6
    s_nop 1
    s_or_b64 s[60:61], s[60:61], vcc
    s_cmp_eq_u64 s[60:61], -1
    s_cbranch_scc1 k1_kernel_kd6
k1_kernel_kq8:
    s_sleep 2
    s_cmp_lg_u32 s23, 0
    s_cbranch_scc1 k1_kernel_kp5
k1_kernel_kd6:
    s_cmp_lg_u32 s56, 12
    s_cbranch_scc1 k1_kernel_kw4
    s_mov_b64 exec, 1
    buffer_store_dword v251, v250, s[28:31], s57 offen sc1
    s_mov_b64 exec, -1
k1_kernel_kw4:
    s_barrier
    s_mov_b32 s2, s58
    s_setprio 3
    s_lshl_b32 s21, s2, 3
    s_add_u32 s22, s6, s21
    s_addc_u32 s23, s7, 0
    s_load_dwordx2 s[32:33], s[22:23], 0
    s_lshl_b32 s21, s2, 2
    s_add_u32 s21, s21, s20
    s_mul_i32 s34, s20, 9472
    v_lshlrev_b32 v3, 4, v1
    s_mul_i32 s37, s21, 4224
    s_add_u32 s37, s37, 0
    v_lshrrev_b32 v4, 3, v0
    v_mul_u32_u24 v4, 20480, v4
    s_lshr_b32 s38, s2, 1
    s_and_b32 s38, s38, 7
    v_and_b32 v5, 7, v0
    v_xor_b32 v5, s38, v5
    v_lshl_add_u32 v4, v5, 4, v4
    s_lshl_b32 s38, s2, 7
    v_add_u32 v20, 0, v1
    v_mul_u32_u24 v21, 3856, v20
    v_lshrrev_b32 v21, 16, v21
    v_mul_u32_u24 v22, 17, v21
    v_sub_u32 v22, v20, v22
    v_lshlrev_b32 v22, 4, v22
    v_lshlrev_b32 v21, 8, v21
    v_sub_u32 v22, v22, v21
    v_add_u32 v23, 3840, v22
    v_add_u32 v20, 64, v1
    v_mul_u32_u24 v21, 3856, v20
    v_lshrrev_b32 v21, 16, v21
    v_mul_u32_u24 v22, 17, v21
    v_sub_u32 v22, v20, v22
    v_lshlrev_b32 v22, 4, v22
    v_lshlrev_b32 v21, 8, v21
    v_sub_u32 v22, v22, v21
    v_add_u32 v24, 3840, v22
    v_add_u32 v20, 128, v1
    v_mul_u32_u24 v21, 3856, v20
    v_lshrrev_b32 v21, 16, v21
    v_mul_u32_u24 v22, 17, v21
    v_sub_u32 v22, v20, v22
    v_lshlrev_b32 v22, 4, v22
    v_lshlrev_b32 v21, 8, v21
    v_sub_u32 v22, v22, v21
    v_add_u32 v25, 3840, v22
    v_add_u32 v20, 192, v1
    v_mul_u32_u24 v21, 3856, v20
    v_lshrrev_b32 v21, 16, v21
    v_mul_u32_u24 v22, 17, v21
    v_sub_u32 v22, v20, v22
    v_lshlrev_b32 v22, 4, v22
    v_lshlrev_b32 v21, 8, v21
    v_sub_u32 v22, v22, v21
    v_add_u32 v26, 3840, v22
    v_add_u32 v20, 256, v1
    v_mul_u32_u24 v21, 3856, v20
    v_lshrrev_b32 v21, 16, v21
    v_mul_u32_u24 v22, 17, v21
    v_sub_u32 v22, v20, v22
    v_lshlrev_b32 v22, 4, v22
    v_lshlrev_b32 v21, 8, v21
    v_sub_u32 v22, v22, v21
    v_add_u32 v27, 3840, v22
    s_add_u32 s36, s34, 4352
    s_mov_b32 m0, s36
    s_nop 0
    buffer_load_dwordx4 v23, s[28:31], s37 offen sc1 lds
    s_add_u32 s36, s34, 5376
    s_mov_b32 m0, s36
    s_nop 0
    buffer_load_dwordx4 v24, s[28:31], s37 offen sc1 lds
    s_add_u32 s36, s34, 6400
    s_mov_b32 m0, s36
    s_nop 0
    buffer_load_dwordx4 v25, s[28:31], s37 offen sc1 lds
    s_add_u32 s36, s34, 7424
    s_mov_b32 m0, s36
    s_nop 0
    buffer_load_dwordx4 v26, s[28:31], s37 offen sc1 lds
    s_add_u32 s36, s34, 8448
    s_mov_b32 m0, s36
    s_mov_b64 exec, 0xffff
    buffer_load_dwordx4 v27, s[28:31], s37 offen sc1 lds
    s_mov_b64 exec, -1
    v_lshl_add_u32 v5, v1, 2, s34
    v_mov_b32 v6, 0
    ds_write_b32 v5, v6
    v_and_b32 v7, 15, v1
    v_bfe_u32 v8, v1, 4, 1
    v_lshrrev_b32 v9, 5, v1
    v_mul_u32_u24 v10, 272, v7
    v_lshl_add_u32 v10, v9, 4, v10
    v_add_u32 v10, s34, v10
    v_add_u32 v10, 4356, v10
    v_lshlrev_b32 v11, 2, v8
    v_sub_u32 v10, v10, v11
    v_and_b32 v12, 7, v1
    v_mul_u32_u24 v13, 272, v12
    v_lshl_add_u32 v13, v9, 4, v13
    v_add_u32 v13, s34, v13
    v_add_u32 v13, 4356, v13
    v_sub_u32 v13, v13, v11
    v_bfe_u32 v11, v1, 3, 1
    v_lshlrev_b32 v11, 4, v11
    v_sub_u32 v11, 16, v11
    v_and_b32 v14, 31, v1
    v_lshlrev_b32 v14, 3, v14
    v_lshl_add_u32 v14, v9, 4, v14
    v_add_u32 v14, s34, v14
    v_add_u32 v14, 8, v14
    v_cmp_ne_u32 vcc, 0, v12
    v_mov_b32 v16, 0
    s_nop 1
    v_cndmask_b32 v15, v16, -1, vcc
    s_waitcnt vmcnt(0) lgkmcnt(0)
    ds_read_b64 v[176:177], v14 offset:1792
    ds_read_b64 v[178:179], v14 offset:1800
    ds_read_b64 v[180:181], v14 offset:1824
    ds_read_b64 v[182:183], v14 offset:1832
    ds_read_b64 v[184:185], v14 offset:1856
    ds_read_b64 v[186:187], v14 offset:1864
    ds_read_b64 v[188:189], v14 offset:1888
    ds_read_b64 v[190:191], v14 offset:1896
    ds_read_b64 v[192:193], v14 offset:1920
    ds_read_b64 v[194:195], v14 offset:1928
    ds_read_b64 v[196:197], v14 offset:1952
    ds_read_b64 v[198:199], v14 offset:1960
    ds_read_b64 v[200:201], v14 offset:1984
    ds_read_b64 v[202:203], v14 offset:1992
    ds_read_b64 v[204:205], v14 offset:2016
    ds_read_b64 v[206:207], v14 offset:2024
    ds_read2_b32 v[64:65], v10 offset0:0 offset1:1
    ds_read2_b32 v[66:67], v10 offset0:2 offset1:3
    ds_read2_b32 v[68:69], v10 offset0:8 offset1:9
    ds_read2_b32 v[70:71], v10 offset0:10 offset1:11
    ds_read2_b32 v[72:73], v10 offset0:16 offset1:17
    ds_read2_b32 v[74:75], v10 offset0:18 offset1:19
    ds_read2_b32 v[76:77], v10 offset0:24 offset1:25
    ds_read2_b32 v[78:79], v10 offset0:26 offset1:27
    ds_read2_b32 v[80:81], v10 offset0:32 offset1:33
    ds_read2_b32 v[82:83], v10 offset0:34 offset1:35
    ds_read2_b32 v[84:85], v10 offset0:40 offset1:41
    ds_read2_b32 v[86:87], v10 offset0:42 offset1:43
    ds_read2_b32 v[88:89], v10 offset0:48 offset1:49
    ds_read2_b32 v[90:91], v10 offset0:50 offset1:51
    ds_read2_b32 v[92:93], v10 offset0:56 offset1:57
    ds_read2_b32 v[94:95], v10 offset0:58 offset1:59
    s_waitcnt lgkmcnt(0)
    v_mfma_f32_32x32x16_bf16 v[144:159], v[176:179], v[64:67], 0
    ds_read_b32 v16, v10 offset:16
    ds_read_b32 v17, v10 offset:48
    ds_read_b32 v18, v10 offset:80
    ds_read_b32 v19, v10 offset:112
    ds_read_b32 v20, v10 offset:144
    ds_read_b32 v21, v10 offset:176
    ds_read_b32 v22, v10 offset:208
    ds_read_b32 v23, v10 offset:240
    ds_read2_b32 v[96:97], v13 offset0:0 offset1:1
    ds_read2_b32 v[98:99], v13 offset0:2 offset1:3
    ds_read_b32 v24, v13 offset:16
    ds_read2_b32 v[100:101], v13 offset0:8 offset1:9
    ds_read2_b32 v[102:103], v13 offset0:10 offset1:11
    ds_read_b32 v25, v13 offset:48
    ds_read2_b32 v[104:105], v13 offset0:16 offset1:17
    ds_read2_b32 v[106:107], v13 offset0:18 offset1:19
    v_mfma_f32_32x32x16_bf16 v[144:159], v[180:183], v[68:71], v[144:159]
    ds_read_b32 v26, v13 offset:80
    ds_read2_b32 v[108:109], v13 offset0:24 offset1:25
    ds_read2_b32 v[110:111], v13 offset0:26 offset1:27
    ds_read_b32 v27, v13 offset:112
    ds_read2_b32 v[112:113], v13 offset0:32 offset1:33
    ds_read2_b32 v[114:115], v13 offset0:34 offset1:35
    ds_read_b32 v28, v13 offset:144
    ds_read2_b32 v[116:117], v13 offset0:40 offset1:41
    ds_read2_b32 v[118:119], v13 offset0:42 offset1:43
    ds_read_b32 v29, v13 offset:176
    ds_read2_b32 v[120:121], v13 offset0:48 offset1:49
    ds_read2_b32 v[122:123], v13 offset0:50 offset1:51
    ds_read_b32 v30, v13 offset:208
    ds_read2_b32 v[124:125], v13 offset0:56 offset1:57
    ds_read2_b32 v[126:127], v13 offset0:58 offset1:59
    ds_read_b32 v31, v13 offset:240
    v_mfma_f32_32x32x16_bf16 v[144:159], v[184:187], v[72:75], v[144:159]
    s_waitcnt lgkmcnt(15)
    s_waitcnt lgkmcnt(0)
    v_alignbit_b32 v32, v65, v64, 16
    v_alignbit_b32 v33, v66, v65, 16
    v_alignbit_b32 v34, v67, v66, 16
    v_alignbit_b32 v35, v16, v67, 16
    v_mfma_f32_32x32x16_bf16 v[144:159], v[188:191], v[76:79], v[144:159]
    v_alignbit_b32 v36, v69, v68, 16
    v_alignbit_b32 v37, v70, v69, 16
    v_alignbit_b32 v38, v71, v70, 16
    v_alignbit_b32 v39, v17, v71, 16
    v_alignbit_b32 v40, v73, v72, 16
    v_alignbit_b32 v41, v74, v73, 16
    v_mfma_f32_32x32x16_bf16 v[144:159], v[192:195], v[80:83], v[144:159]
    v_alignbit_b32 v42, v75, v74, 16
    v_alignbit_b32 v43, v18, v75, 16
    v_alignbit_b32 v44, v77, v76, 16
    v_alignbit_b32 v45, v78, v77, 16
    v_alignbit_b32 v46, v79, v78, 16
    v_alignbit_b32 v47, v19, v79, 16
    v_mfma_f32_32x32x16_bf16 v[144:159], v[196:199], v[84:87], v[144:159]
    v_alignbit_b32 v48, v81, v80, 16
    v_alignbit_b32 v49, v82, v81, 16
    v_alignbit_b32 v50, v83, v82, 16
    v_alignbit_b32 v51, v20, v83, 16
    v_alignbit_b32 v52, v85, v84, 16
    v_alignbit_b32 v53, v86, v85, 16
    v_mfma_f32_32x32x16_bf16 v[144:159], v[200:203], v[88:91], v[144:159]
    v_alignbit_b32 v54, v87, v86, 16
    v_alignbit_b32 v55, v21, v87, 16
    v_alignbit_b32 v56, v89, v88, 16
    v_alignbit_b32 v57, v90, v89, 16
    v_alignbit_b32 v58, v91, v90, 16
    v_alignbit_b32 v59, v22, v91, 16
    v_mfma_f32_32x32x16_bf16 v[144:159], v[204:207], v[92:95], v[144:159]
    v_alignbit_b32 v60, v93, v92, 16
    v_alignbit_b32 v61, v94, v93, 16
    v_alignbit_b32 v62, v95, v94, 16
    v_alignbit_b32 v63, v23, v95, 16
    s_nop 0
    v_mfma_f32_32x32x16_bf16 v[128:143], v[176:179], v[32:35], 0
    ds_read_b64 v[208:209], v14 offset:3840
    ds_read_b64 v[210:211], v14 offset:3848
    s_nop 2
    v_mfma_f32_32x32x16_bf16 v[128:143], v[180:183], v[36:39], v[128:143]
    ds_read_b64 v[212:213], v14 offset:3872
    ds_read_b64 v[214:215], v14 offset:3880
    s_nop 2
    v_mfma_f32_32x32x16_bf16 v[128:143], v[184:187], v[40:43], v[128:143]
    ds_read_b64 v[216:217], v14 offset:3904
    ds_read_b64 v[218:219], v14 offset:3912
    v_alignbit_b32 v96, v97, v96, v11
    v_alignbit_b32 v97, v98, v97, v11
    v_alignbit_b32 v98, v99, v98, v11
    v_alignbit_b32 v99, v24, v99, v11
    v_alignbit_b32 v100, v101, v100, v11
    v_alignbit_b32 v101, v102, v101, v11
    v_alignbit_b32 v102, v103, v102, v11
    v_alignbit_b32 v103, v25, v103, v11
    v_alignbit_b32 v104, v105, v104, v11
    v_mfma_f32_32x32x16_bf16 v[128:143], v[188:191], v[44:47], v[128:143]
    ds_read_b64 v[220:221], v14 offset:3936
    ds_read_b64 v[222:223], v14 offset:3944
    v_alignbit_b32 v105, v106, v105, v11
    v_alignbit_b32 v106, v107, v106, v11
    v_alignbit_b32 v107, v26, v107, v11
    v_alignbit_b32 v108, v109, v108, v11
    v_alignbit_b32 v109, v110, v109, v11
    v_alignbit_b32 v110, v111, v110, v11
    v_alignbit_b32 v111, v27, v111, v11
    v_mov_b32_dpp v144, v144 row_shr:1 row_mask:0xf bank_mask:0xf bound_ctrl:0
    v_mfma_f32_32x32x16_bf16 v[128:143], v[192:195], v[48:51], v[128:143]
    ds_read_b64 v[224:225], v14 offset:3968
    ds_read_b64 v[226:227], v14 offset:3976
    v_mov_b32_dpp v145, v145 row_shr:1 row_mask:0xf bank_mask:0xf bound_ctrl:0
    v_mov_b32_dpp v146, v146 row_shr:1 row_mask:0xf bank_mask:0xf bound_ctrl:0
    v_mov_b32_dpp v147, v147 row_shr:1 row_mask:0xf bank_mask:0xf bound_ctrl:0
    v_mov_b32_dpp v148, v148 row_shr:1 row_mask:0xf bank_mask:0xf bound_ctrl:0
    v_mov_b32_dpp v149, v149 row_shr:1 row_mask:0xf bank_mask:0xf bound_ctrl:0
    v_mov_b32_dpp v150, v150 row_shr:1 row_mask:0xf bank_mask:0xf bound_ctrl:0
    v_mov_b32_dpp v151, v151 row_shr:1 row_mask:0xf bank_mask:0xf bound_ctrl:0
    v_mov_b32_dpp v152, v152 row_shr:1 row_mask:0xf bank_mask:0xf bound_ctrl:0
    v_mfma_f32_32x32x16_bf16 v[128:143], v[196:199], v[52:55], v[128:143]
    ds_read_b64 v[228:229], v14 offset:4000
    ds_read_b64 v[230:231], v14 offset:4008
    v_mov_b32_dpp v153, v153 row_shr:1 row_mask:0xf bank_mask:0xf bound_ctrl:0
    v_mov_b32_dpp v154, v154 row_shr:1 row_mask:0xf bank_mask:0xf bound_ctrl:0
    v_mov_b32_dpp v155, v155 row_shr:1 row_mask:0xf bank_mask:0xf bound_ctrl:0
    v_mov_b32_dpp v156, v156 row_shr:1 row_mask:0xf bank_mask:0xf bound_ctrl:0
    v_mov_b32_dpp v157, v157 row_shr:1 row_mask:0xf bank_mask:0xf bound_ctrl:0
    v_mov_b32_dpp v158, v158 row_shr:1 row_mask:0xf bank_mask:0xf bound_ctrl:0
    v_mov_b32_dpp v159, v159 row_shr:1 row_mask:0xf bank_mask:0xf bound_ctrl:0
    v_alignbit_b32 v112, v113, v112, v11
    v_mfma_f32_32x32x16_bf16 v[128:143], v[200:203], v[56:59], v[128:143]
    ds_read_b64 v[232:233], v14 offset:4032
    ds_read_b64 v[234:235], v14 offset:4040
    v_alignbit_b32 v113, v114, v113, v11
    v_alignbit_b32 v114, v115, v114, v11
    v_alignbit_b32 v115, v28, v115, v11
    v_alignbit_b32 v116, v117, v116, v11
    v_alignbit_b32 v117, v118, v117, v11
    v_alignbit_b32 v118, v119, v118, v11
    v_alignbit_b32 v119, v29, v119, v11
    v_alignbit_b32 v120, v121, v120, v11
    v_mfma_f32_32x32x16_bf16 v[128:143], v[204:207], v[60:63], v[128:143]
    ds_read_b64 v[236:237], v14 offset:4064
    ds_read_b64 v[238:239], v14 offset:4072
    v_alignbit_b32 v121, v122, v121, v11
    v_alignbit_b32 v122, v123, v122, v11
    v_alignbit_b32 v123, v30, v123, v11
    v_alignbit_b32 v124, v125, v124, v11
    v_alignbit_b32 v125, v126, v125, v11
    v_alignbit_b32 v126, v127, v126, v11
    v_alignbit_b32 v127, v31, v127, v11
    s_nop 0
    s_waitcnt lgkmcnt(0)
    v_mfma_f32_32x32x16_bf16 v[160:175], v[208:211], v[96:99], 0
    ds_read_b64 v[176:177], v14 offset:1536
    ds_read_b64 v[178:179], v14 offset:1544
    ds_read_b64 v[180:181], v14 offset:1568
    ds_read_b64 v[182:183], v14 offset:1576
    s_nop 0
    v_mfma_f32_32x32x16_bf16 v[160:175], v[212:215], v[100:103], v[160:175]
    ds_read_b64 v[184:185], v14 offset:1600
    ds_read_b64 v[186:187], v14 offset:1608
    ds_read_b64 v[188:189], v14 offset:1632
    s_nop 1
    v_mfma_f32_32x32x16_bf16 v[160:175], v[216:219], v[104:107], v[160:175]
    ds_read_b64 v[190:191], v14 offset:1640
    ds_read_b64 v[192:193], v14 offset:1664
    ds_read_b64 v[194:195], v14 offset:1672
    v_mov_b32_dpp v128, v128 row_shr:1 row_mask:0xf bank_mask:0xf bound_ctrl:0
    v_mov_b32_dpp v129, v129 row_shr:1 row_mask:0xf bank_mask:0xf bound_ctrl:0
    v_mov_b32_dpp v130, v130 row_shr:1 row_mask:0xf bank_mask:0xf bound_ctrl:0
    v_mfma_f32_32x32x16_bf16 v[160:175], v[220:223], v[108:111], v[160:175]
    ds_read_b64 v[196:197], v14 offset:1696
    ds_read_b64 v[198:199], v14 offset:1704
    ds_read_b64 v[200:201], v14 offset:1728
    v_mov_b32_dpp v131, v131 row_shr:1 row_mask:0xf bank_mask:0xf bound_ctrl:0
    v_mov_b32_dpp v132, v132 row_shr:1 row_mask:0xf bank_mask:0xf bound_ctrl:0
    v_mov_b32_dpp v133, v133 row_shr:1 row_mask:0xf bank_mask:0xf bound_ctrl:0
    v_mfma_f32_32x32x16_bf16 v[160:175], v[224:227], v[112:115], v[160:175]
    ds_read_b64 v[202:203], v14 offset:1736
    ds_read_b64 v[204:205], v14 offset:1760
    ds_read_b64 v[206:207], v14 offset:1768
    v_mov_b32_dpp v134, v134 row_shr:1 row_mask:0xf bank_mask:0xf bound_ctrl:0
    v_mov_b32_dpp v135, v135 row_shr:1 row_mask:0xf bank_mask:0xf bound_ctrl:0
    v_mov_b32_dpp v136, v136 row_shr:1 row_mask:0xf bank_mask:0xf bound_ctrl:0
    v_mfma_f32_32x32x16_bf16 v[160:175], v[228:231], v[116:119], v[160:175]
    v_mov_b32_dpp v137, v137 row_shr:1 row_mask:0xf bank_mask:0xf bound_ctrl:0
    v_mov_b32_dpp v138, v138 row_shr:1 row_mask:0xf bank_mask:0xf bound_ctrl:0
    v_mov_b32_dpp v139, v139 row_shr:1 row_mask:0xf bank_mask:0xf bound_ctrl:0
    v_mfma_f32_32x32x16_bf16 v[160:175], v[232:235], v[120:123], v[160:175]
    v_mov_b32_dpp v140, v140 row_shr:1 row_mask:0xf bank_mask:0xf bound_ctrl:0
    v_mov_b32_dpp v141, v141 row_shr:1 row_mask:0xf bank_mask:0xf bound_ctrl:0
    v_mfma_f32_32x32x16_bf16 v[160:175], v[236:239], v[124:127], v[160:175]
    v_mov_b32_dpp v142, v142 row_shr:1 row_mask:0xf bank_mask:0xf bound_ctrl:0
    v_mov_b32_dpp v143, v143 row_shr:1 row_mask:0xf bank_mask:0xf bound_ctrl:0
    s_waitcnt lgkmcnt(0)
    v_mfma_f32_32x32x16_bf16 v[144:159], v[176:179], v[64:67], v[144:159]
    ds_read_b64 v[208:209], v14 offset:3584
    ds_read_b64 v[210:211], v14 offset:3592
    s_nop 2
    v_mfma_f32_32x32x16_bf16 v[144:159], v[180:183], v[68:71], v[144:159]
    ds_read_b64 v[212:213], v14 offset:3616
    ds_read_b64 v[214:215], v14 offset:3624
    s_nop 2
    v_mfma_f32_32x32x16_bf16 v[144:159], v[184:187], v[72:75], v[144:159]
    ds_read_b64 v[216:217], v14 offset:3648
    ds_read_b64 v[218:219], v14 offset:3656
    v_and_b32_dpp v160, v160, v15 row_shr:1 row_mask:0xf bank_mask:0xf bound_ctrl:0
    v_and_b32_dpp v161, v161, v15 row_shr:1 row_mask:0xf bank_mask:0xf bound_ctrl:0
    v_and_b32_dpp v162, v162, v15 row_shr:1 row_mask:0xf bank_mask:0xf bound_ctrl:0
    v_mfma_f32_32x32x16_bf16 v[144:159], v[188:191], v[76:79], v[144:159]
    ds_read_b64 v[220:221], v14 offset:3680
    ds_read_b64 v[222:223], v14 offset:3688
    v_and_b32_dpp v163, v163, v15 row_shr:1 row_mask:0xf bank_mask:0xf bound_ctrl:0
    v_and_b32_dpp v164, v164, v15 row_shr:1 row_mask:0xf bank_mask:0xf bound_ctrl:0
    v_and_b32_dpp v165, v165, v15 row_shr:1 row_mask:0xf bank_mask:0xf bound_ctrl:0
    v_mfma_f32_32x32x16_bf16 v[144:159], v[192:195], v[80:83], v[144:159]
    ds_read_b64 v[224:225], v14 offset:3712
    ds_read_b64 v[226:227], v14 offset:3720
    v_and_b32_dpp v166, v166, v15 row_shr:1 row_mask:0xf bank_mask:0xf bound_ctrl:0
    v_and_b32_dpp v167, v167, v15 row_shr:1 row_mask:0xf bank_mask:0xf bound_ctrl:0
    v_and_b32_dpp v168, v168, v15 row_shr:1 row_mask:0xf bank_mask:0xf bound_ctrl:0
    v_mfma_f32_32x32x16_bf16 v[144:159], v[196:199], v[84:87], v[144:159]
    ds_read_b64 v[228:229], v14 offset:3744
    ds_read_b64 v[230:231], v14 offset:3752
    v_and_b32_dpp v169, v169, v15 row_shr:1 row_mask:0xf bank_mask:0xf bound_ctrl:0
    v_and_b32_dpp v170, v170, v15 row_shr:1 row_mask:0xf bank_mask:0xf bound_ctrl:0
    v_and_b32_dpp v171, v171, v15 row_shr:1 row_mask:0xf bank_mask:0xf bound_ctrl:0
    v_mfma_f32_32x32x16_bf16 v[144:159], v[200:203], v[88:91], v[144:159]
    ds_read_b64 v[232:233], v14 offset:3776
    ds_read_b64 v[234:235], v14 offset:3784
    v_and_b32_dpp v172, v172, v15 row_shr:1 row_mask:0xf bank_mask:0xf bound_ctrl:0
    v_and_b32_dpp v173, v173, v15 row_shr:1 row_mask:0xf bank_mask:0xf bound_ctrl:0
    v_mfma_f32_32x32x16_bf16 v[144:159], v[204:207], v[92:95], v[144:159]
    ds_read_b64 v[236:237], v14 offset:3808
    ds_read_b64 v[238:239], v14 offset:3816
    v_and_b32_dpp v174, v174, v15 row_shr:1 row_mask:0xf bank_mask:0xf bound_ctrl:0
    v_and_b32_dpp v175, v175, v15 row_shr:1 row_mask:0xf bank_mask:0xf bound_ctrl:0
    v_mfma_f32_32x32x16_bf16 v[128:143], v[176:179], v[32:35], v[128:143]
    s_nop 4
    v_mfma_f32_32x32x16_bf16 v[128:143], v[180:183], v[36:39], v[128:143]
    s_nop 4
    v_mfma_f32_32x32x16_bf16 v[128:143], v[184:187], v[40:43], v[128:143]
    v_mov_b32_dpp v144, v144 row_shr:1 row_mask:0xf bank_mask:0xf bound_ctrl:0
    v_mov_b32_dpp v145, v145 row_shr:1 row_mask:0xf bank_mask:0xf bound_ctrl:0
    v_mov_b32_dpp v146, v146 row_shr:1 row_mask:0xf bank_mask:0xf bound_ctrl:0
    v_mfma_f32_32x32x16_bf16 v[128:143], v[188:191], v[44:47], v[128:143]
    v_mov_b32_dpp v147, v147 row_shr:1 row_mask:0xf bank_mask:0xf bound_ctrl:0
    v_mov_b32_dpp v148, v148 row_shr:1 row_mask:0xf bank_mask:0xf bound_ctrl:0
    v_mov_b32_dpp v149, v149 row_shr:1 row_mask:0xf bank_mask:0xf bound_ctrl:0
    v_mfma_f32_32x32x16_bf16 v[128:143], v[192:195], v[48:51], v[128:143]
    v_mov_b32_dpp v150, v150 row_shr:1 row_mask:0xf bank_mask:0xf bound_ctrl:0
    v_mov_b32_dpp v151, v151 row_shr:1 row_mask:0xf bank_mask:0xf bound_ctrl:0
    v_mov_b32_dpp v152, v152 row_shr:1 row_mask:0xf bank_mask:0xf bound_ctrl:0
    v_mfma_f32_32x32x16_bf16 v[128:143], v[196:199], v[52:55], v[128:143]
    v_mov_b32_dpp v153, v153 row_shr:1 row_mask:0xf bank_mask:0xf bound_ctrl:0
    v_mov_b32_dpp v154, v154 row_shr:1 row_mask:0xf bank_mask:0xf bound_ctrl:0
    v_mov_b32_dpp v155, v155 row_shr:1 row_mask:0xf bank_mask:0xf bound_ctrl:0
    v_mfma_f32_32x32x16_bf16 v[128:143], v[200:203], v[56:59], v[128:143]
    v_mov_b32_dpp v156, v156 row_shr:1 row_mask:0xf bank_mask:0xf bound_ctrl:0
    v_mov_b32_dpp v157, v157 row_shr:1 row_mask:0xf bank_mask:0xf bound_ctrl:0
    v_mfma_f32_32x32x16_bf16 v[128:143], v[204:207], v[60:63], v[128:143]
    v_mov_b32_dpp v158, v158 row_shr:1 row_mask:0xf bank_mask:0xf bound_ctrl:0
    v_mov_b32_dpp v159, v159 row_shr:1 row_mask:0xf bank_mask:0xf bound_ctrl:0
    s_waitcnt lgkmcnt(0)
    v_mfma_f32_32x32x16_bf16 v[160:175], v[208:211], v[96:99], v[160:175]
    ds_read_b64 v[176:177], v14 offset:1280
    ds_read_b64 v[178:179], v14 offset:1288
    ds_read_b64 v[180:181], v14 offset:1312
    ds_read_b64 v[182:183], v14 offset:1320
    s_nop 0
    v_mfma_f32_32x32x16_bf16 v[160:175], v[212:215], v[100:103], v[160:175]
    ds_read_b64 v[184:185], v14 offset:1344
    ds_read_b64 v[186:187], v14 offset:1352
    ds_read_b64 v[188:189], v14 offset:1376
    s_nop 1
    v_mfma_f32_32x32x16_bf16 v[160:175], v[216:219], v[104:107], v[160:175]
    ds_read_b64 v[190:191], v14 offset:1384
    ds_read_b64 v[192:193], v14 offset:1408
    ds_read_b64 v[194:195], v14 offset:1416
    v_mov_b32_dpp v128, v128 row_shr:1 row_mask:0xf bank_mask:0xf bound_ctrl:0
    v_mov_b32_dpp v129, v129 row_shr:1 row_mask:0xf bank_mask:0xf bound_ctrl:0
    v_mov_b32_dpp v130, v130 row_shr:1 row_mask:0xf bank_mask:0xf bound_ctrl:0
    v_mfma_f32_32x32x16_bf16 v[160:175], v[220:223], v[108:111], v[160:175]
    ds_read_b64 v[196:197], v14 offset:1440
    ds_read_b64 v[198:199], v14 offset:1448
    ds_read_b64 v[200:201], v14 offset:1472
    v_mov_b32_dpp v131, v131 row_shr:1 row_mask:0xf bank_mask:0xf bound_ctrl:0
    v_mov_b32_dpp v132, v132 row_shr:1 row_mask:0xf bank_mask:0xf bound_ctrl:0
    v_mov_b32_dpp v133, v133 row_shr:1 row_mask:0xf bank_mask:0xf bound_ctrl:0
    v_mfma_f32_32x32x16_bf16 v[160:175], v[224:227], v[112:115], v[160:175]
    ds_read_b64 v[202:203], v14 offset:1480
    ds_read_b64 v[204:205], v14 offset:1504
    ds_read_b64 v[206:207], v14 offset:1512
    v_mov_b32_dpp v134, v134 row_shr:1 row_mask:0xf bank_mask:0xf bound_ctrl:0
    v_mov_b32_dpp v135, v135 row_shr:1 row_mask:0xf bank_mask:0xf bound_ctrl:0
    v_mov_b32_dpp v136, v136 row_shr:1 row_mask:0xf bank_mask:0xf bound_ctrl:0
    v_mfma_f32_32x32x16_bf16 v[160:175], v[228:231], v[116:119], v[160:175]
    v_mov_b32_dpp v137, v137 row_shr:1 row_mask:0xf bank_mask:0xf bound_ctrl:0
    v_mov_b32_dpp v138, v138 row_shr:1 row_mask:0xf bank_mask:0xf bound_ctrl:0
    v_mov_b32_dpp v139, v139 row_shr:1 row_mask:0xf bank_mask:0xf bound_ctrl:0
    v_mfma_f32_32x32x16_bf16 v[160:175], v[232:235], v[120:123], v[160:175]
    v_mov_b32_dpp v140, v140 row_shr:1 row_mask:0xf bank_mask:0xf bound_ctrl:0
    v_mov_b32_dpp v141, v141 row_shr:1 row_mask:0xf bank_mask:0xf bound_ctrl:0
    v_mfma_f32_32x32x16_bf16 v[160:175], v[236:239], v[124:127], v[160:175]
    v_mov_b32_dpp v142, v142 row_shr:1 row_mask:0xf bank_mask:0xf bound_ctrl:0
    v_mov_b32_dpp v143, v143 row_shr:1 row_mask:0xf bank_mask:0xf bound_ctrl:0
    s_waitcnt lgkmcnt(0)
    v_mfma_f32_32x32x16_bf16 v[144:159], v[176:179], v[64:67], v[144:159]
    ds_read_b64 v[208:209], v14 offset:3328
    ds_read_b64 v[210:211], v14 offset:3336
    s_nop 2
    v_mfma_f32_32x32x16_bf16 v[144:159], v[180:183], v[68:71], v[144:159]
    ds_read_b64 v[212:213], v14 offset:3360
    ds_read_b64 v[214:215], v14 offset:3368
    s_nop 2
    v_mfma_f32_32x32x16_bf16 v[144:159], v[184:187], v[72:75], v[144:159]
    ds_read_b64 v[216:217], v14 offset:3392
    ds_read_b64 v[218:219], v14 offset:3400
    v_and_b32_dpp v160, v160, v15 row_shr:1 row_mask:0xf bank_mask:0xf bound_ctrl:0
    v_and_b32_dpp v161, v161, v15 row_shr:1 row_mask:0xf bank_mask:0xf bound_ctrl:0
    v_and_b32_dpp v162, v162, v15 row_shr:1 row_mask:0xf bank_mask:0xf bound_ctrl:0
    v_mfma_f32_32x32x16_bf16 v[144:159], v[188:191], v[76:79], v[144:159]
    ds_read_b64 v[220:221], v14 offset:3424
    ds_read_b64 v[222:223], v14 offset:3432
    v_and_b32_dpp v163, v163, v15 row_shr:1 row_mask:0xf bank_mask:0xf bound_ctrl:0
    v_and_b32_dpp v164, v164, v15 row_shr:1 row_mask:0xf bank_mask:0xf bound_ctrl:0
    v_and_b32_dpp v165, v165, v15 row_shr:1 row_mask:0xf bank_mask:0xf bound_ctrl:0
    v_mfma_f32_32x32x16_bf16 v[144:159], v[192:195], v[80:83], v[144:159]
    ds_read_b64 v[224:225], v14 offset:3456
    ds_read_b64 v[226:227], v14 offset:3464
    v_and_b32_dpp v166, v166, v15 row_shr:1 row_mask:0xf bank_mask:0xf bound_ctrl:0
    v_and_b32_dpp v167, v167, v15 row_shr:1 row_mask:0xf bank_mask:0xf bound_ctrl:0
    v_and_b32_dpp v168, v168, v15 row_shr:1 row_mask:0xf bank_mask:0xf bound_ctrl:0
    v_mfma_f32_32x32x16_bf16 v[144:159], v[196:199], v[84:87], v[144:159]
    ds_read_b64 v[228:229], v14 offset:3488
    ds_read_b64 v[230:231], v14 offset:3496
    v_and_b32_dpp v169, v169, v15 row_shr:1 row_mask:0xf bank_mask:0xf bound_ctrl:0
    v_and_b32_dpp v170, v170, v15 row_shr:1 row_mask:0xf bank_mask:0xf bound_ctrl:0
    v_and_b32_dpp v171, v171, v15 row_shr:1 row_mask:0xf bank_mask:0xf bound_ctrl:0
    v_mfma_f32_32x32x16_bf16 v[144:159], v[200:203], v[88:91], v[144:159]
    ds_read_b64 v[232:233], v14 offset:3520
    ds_read_b64 v[234:235], v14 offset:3528
    v_and_b32_dpp v172, v172, v15 row_shr:1 row_mask:0xf bank_mask:0xf bound_ctrl:0
    v_and_b32_dpp v173, v173, v15 row_shr:1 row_mask:0xf bank_mask:0xf bound_ctrl:0
    v_mfma_f32_32x32x16_bf16 v[144:159], v[204:207], v[92:95], v[144:159]
    ds_read_b64 v[236:237], v14 offset:3552
    ds_read_b64 v[238:239], v14 offset:3560
    v_and_b32_dpp v174, v174, v15 row_shr:1 row_mask:0xf bank_mask:0xf bound_ctrl:0
    v_and_b32_dpp v175, v175, v15 row_shr:1 row_mask:0xf bank_mask:0xf bound_ctrl:0
    v_mfma_f32_32x32x16_bf16 v[128:143], v[176:179], v[32:35], v[128:143]
    s_nop 4
    v_mfma_f32_32x32x16_bf16 v[128:143], v[180:183], v[36:39], v[128:143]
    s_nop 4
    v_mfma_f32_32x32x16_bf16 v[128:143], v[184:187], v[40:43], v[128:143]
    v_mov_b32_dpp v144, v144 row_shr:1 row_mask:0xf bank_mask:0xf bound_ctrl:0
    v_mov_b32_dpp v145, v145 row_shr:1 row_mask:0xf bank_mask:0xf bound_ctrl:0
    v_mov_b32_dpp v146, v146 row_shr:1 row_mask:0xf bank_mask:0xf bound_ctrl:0
    v_mfma_f32_32x32x16_bf16 v[128:143], v[188:191], v[44:47], v[128:143]
    v_mov_b32_dpp v147, v147 row_shr:1 row_mask:0xf bank_mask:0xf bound_ctrl:0
    v_mov_b32_dpp v148, v148 row_shr:1 row_mask:0xf bank_mask:0xf bound_ctrl:0
    v_mov_b32_dpp v149, v149 row_shr:1 row_mask:0xf bank_mask:0xf bound_ctrl:0
    v_mfma_f32_32x32x16_bf16 v[128:143], v[192:195], v[48:51], v[128:143]
    v_mov_b32_dpp v150, v150 row_shr:1 row_mask:0xf bank_mask:0xf bound_ctrl:0
    v_mov_b32_dpp v151, v151 row_shr:1 row_mask:0xf bank_mask:0xf bound_ctrl:0
    v_mov_b32_dpp v152, v152 row_shr:1 row_mask:0xf bank_mask:0xf bound_ctrl:0
    v_mfma_f32_32x32x16_bf16 v[128:143], v[196:199], v[52:55], v[128:143]
    v_mov_b32_dpp v153, v153 row_shr:1 row_mask:0xf bank_mask:0xf bound_ctrl:0
    v_mov_b32_dpp v154, v154 row_shr:1 row_mask:0xf bank_mask:0xf bound_ctrl:0
    v_mov_b32_dpp v155, v155 row_shr:1 row_mask:0xf bank_mask:0xf bound_ctrl:0
    v_mfma_f32_32x32x16_bf16 v[128:143], v[200:203], v[56:59], v[128:143]
    v_mov_b32_dpp v156, v156 row_shr:1 row_mask:0xf bank_mask:0xf bound_ctrl:0
    v_mov_b32_dpp v157, v157 row_shr:1 row_mask:0xf bank_mask:0xf bound_ctrl:0
    v_mfma_f32_32x32x16_bf16 v[128:143], v[204:207], v[60:63], v[128:143]
    v_mov_b32_dpp v158, v158 row_shr:1 row_mask:0xf bank_mask:0xf bound_ctrl:0
    v_mov_b32_dpp v159, v159 row_shr:1 row_mask:0xf bank_mask:0xf bound_ctrl:0
    s_waitcnt lgkmcnt(0)
    v_mfma_f32_32x32x16_bf16 v[160:175], v[208:211], v[96:99], v[160:175]
    ds_read_b64 v[176:177], v14 offset:1024
    ds_read_b64 v[178:179], v14 offset:1032
    ds_read_b64 v[180:181], v14 offset:1056
    ds_read_b64 v[182:183], v14 offset:1064
    s_nop 0
    v_mfma_f32_32x32x16_bf16 v[160:175], v[212:215], v[100:103], v[160:175]
    ds_read_b64 v[184:185], v14 offset:1088
    ds_read_b64 v[186:187], v14 offset:1096
    ds_read_b64 v[188:189], v14 offset:1120
    s_nop 1
    v_mfma_f32_32x32x16_bf16 v[160:175], v[216:219], v[104:107], v[160:175]
    ds_read_b64 v[190:191], v14 offset:1128
    ds_read_b64 v[192:193], v14 offset:1152
    ds_read_b64 v[194:195], v14 offset:1160
    v_mov_b32_dpp v128, v128 row_shr:1 row_mask:0xf bank_mask:0xf bound_ctrl:0
    v_mov_b32_dpp v129, v129 row_shr:1 row_mask:0xf bank_mask:0xf bound_ctrl:0
    v_mov_b32_dpp v130, v130 row_shr:1 row_mask:0xf bank_mask:0xf bound_ctrl:0
    v_mfma_f32_32x32x16_bf16 v[160:175], v[220:223], v[108:111], v[160:175]
    ds_read_b64 v[196:197], v14 offset:1184
    ds_read_b64 v[198:199], v14 offset:1192
    ds_read_b64 v[200:201], v14 offset:1216
    v_mov_b32_dpp v131, v131 row_shr:1 row_mask:0xf bank_mask:0xf bound_ctrl:0
    v_mov_b32_dpp v132, v132 row_shr:1 row_mask:0xf bank_mask:0xf bound_ctrl:0
    v_mov_b32_dpp v133, v133 row_shr:1 row_mask:0xf bank_mask:0xf bound_ctrl:0
    v_mfma_f32_32x32x16_bf16 v[160:175], v[224:227], v[112:115], v[160:175]
    ds_read_b64 v[202:203], v14 offset:1224
    ds_read_b64 v[204:205], v14 offset:1248
    ds_read_b64 v[206:207], v14 offset:1256
    v_mov_b32_dpp v134, v134 row_shr:1 row_mask:0xf bank_mask:0xf bound_ctrl:0
    v_mov_b32_dpp v135, v135 row_shr:1 row_mask:0xf bank_mask:0xf bound_ctrl:0
    v_mov_b32_dpp v136, v136 row_shr:1 row_mask:0xf bank_mask:0xf bound_ctrl:0
    v_mfma_f32_32x32x16_bf16 v[160:175], v[228:231], v[116:119], v[160:175]
    v_mov_b32_dpp v137, v137 row_shr:1 row_mask:0xf bank_mask:0xf bound_ctrl:0
    v_mov_b32_dpp v138, v138 row_shr:1 row_mask:0xf bank_mask:0xf bound_ctrl:0
    v_mov_b32_dpp v139, v139 row_shr:1 row_mask:0xf bank_mask:0xf bound_ctrl:0
    v_mfma_f32_32x32x16_bf16 v[160:175], v[232:235], v[120:123], v[160:175]
    v_mov_b32_dpp v140, v140 row_shr:1 row_mask:0xf bank_mask:0xf bound_ctrl:0
    v_mov_b32_dpp v141, v141 row_shr:1 row_mask:0xf bank_mask:0xf bound_ctrl:0
    v_mfma_f32_32x32x16_bf16 v[160:175], v[236:239], v[124:127], v[160:175]
    v_mov_b32_dpp v142, v142 row_shr:1 row_mask:0xf bank_mask:0xf bound_ctrl:0
    v_mov_b32_dpp v143, v143 row_shr:1 row_mask:0xf bank_mask:0xf bound_ctrl:0
    s_waitcnt lgkmcnt(0)
    v_mfma_f32_32x32x16_bf16 v[144:159], v[176:179], v[64:67], v[144:159]
    ds_read_b64 v[208:209], v14 offset:3072
    ds_read_b64 v[210:211], v14 offset:3080
    s_nop 2
    v_mfma_f32_32x32x16_bf16 v[144:159], v[180:183], v[68:71], v[144:159]
    ds_read_b64 v[212:213], v14 offset:3104
    ds_read_b64 v[214:215], v14 offset:3112
    s_nop 2
    v_mfma_f32_32x32x16_bf16 v[144:159], v[184:187], v[72:75], v[144:159]
    ds_read_b64 v[216:217], v14 offset:3136
    ds_read_b64 v[218:219], v14 offset:3144
    v_and_b32_dpp v160, v160, v15 row_shr:1 row_mask:0xf bank_mask:0xf bound_ctrl:0
    v_and_b32_dpp v161, v161, v15 row_shr:1 row_mask:0xf bank_mask:0xf bound_ctrl:0
    v_and_b32_dpp v162, v162, v15 row_shr:1 row_mask:0xf bank_mask:0xf bound_ctrl:0
    v_mfma_f32_32x32x16_bf16 v[144:159], v[188:191], v[76:79], v[144:159]
    ds_read_b64 v[220:221], v14 offset:3168
    ds_read_b64 v[222:223], v14 offset:3176
    v_and_b32_dpp v163, v163, v15 row_shr:1 row_mask:0xf bank_mask:0xf bound_ctrl:0
    v_and_b32_dpp v164, v164, v15 row_shr:1 row_mask:0xf bank_mask:0xf bound_ctrl:0
    v_and_b32_dpp v165, v165, v15 row_shr:1 row_mask:0xf bank_mask:0xf bound_ctrl:0
    v_mfma_f32_32x32x16_bf16 v[144:159], v[192:195], v[80:83], v[144:159]
    ds_read_b64 v[224:225], v14 offset:3200
    ds_read_b64 v[226:227], v14 offset:3208
    v_and_b32_dpp v166, v166, v15 row_shr:1 row_mask:0xf bank_mask:0xf bound_ctrl:0
    v_and_b32_dpp v167, v167, v15 row_shr:1 row_mask:0xf bank_mask:0xf bound_ctrl:0
    v_and_b32_dpp v168, v168, v15 row_shr:1 row_mask:0xf bank_mask:0xf bound_ctrl:0
    v_mfma_f32_32x32x16_bf16 v[144:159], v[196:199], v[84:87], v[144:159]
    ds_read_b64 v[228:229], v14 offset:3232
    ds_read_b64 v[230:231], v14 offset:3240
    v_and_b32_dpp v169, v169, v15 row_shr:1 row_mask:0xf bank_mask:0xf bound_ctrl:0
    v_and_b32_dpp v170, v170, v15 row_shr:1 row_mask:0xf bank_mask:0xf bound_ctrl:0
    v_and_b32_dpp v171, v171, v15 row_shr:1 row_mask:0xf bank_mask:0xf bound_ctrl:0
    v_mfma_f32_32x32x16_bf16 v[144:159], v[200:203], v[88:91], v[144:159]
    ds_read_b64 v[232:233], v14 offset:3264
    ds_read_b64 v[234:235], v14 offset:3272
    v_and_b32_dpp v172, v172, v15 row_shr:1 row_mask:0xf bank_mask:0xf bound_ctrl:0
    v_and_b32_dpp v173, v173, v15 row_shr:1 row_mask:0xf bank_mask:0xf bound_ctrl:0
    v_mfma_f32_32x32x16_bf16 v[144:159], v[204:207], v[92:95], v[144:159]
    ds_read_b64 v[236:237], v14 offset:3296
    ds_read_b64 v[238:239], v14 offset:3304
    v_and_b32_dpp v174, v174, v15 row_shr:1 row_mask:0xf bank_mask:0xf bound_ctrl:0
    v_and_b32_dpp v175, v175, v15 row_shr:1 row_mask:0xf bank_mask:0xf bound_ctrl:0
    v_mfma_f32_32x32x16_bf16 v[128:143], v[176:179], v[32:35], v[128:143]
    s_nop 4
    v_mfma_f32_32x32x16_bf16 v[128:143], v[180:183], v[36:39], v[128:143]
    s_nop 4
    v_mfma_f32_32x32x16_bf16 v[128:143], v[184:187], v[40:43], v[128:143]
    v_mov_b32_dpp v144, v144 row_shr:1 row_mask:0xf bank_mask:0xf bound_ctrl:0
    v_mov_b32_dpp v145, v145 row_shr:1 row_mask:0xf bank_mask:0xf bound_ctrl:0
    v_mov_b32_dpp v146, v146 row_shr:1 row_mask:0xf bank_mask:0xf bound_ctrl:0
    v_mfma_f32_32x32x16_bf16 v[128:143], v[188:191], v[44:47], v[128:143]
    v_mov_b32_dpp v147, v147 row_shr:1 row_mask:0xf bank_mask:0xf bound_ctrl:0
    v_mov_b32_dpp v148, v148 row_shr:1 row_mask:0xf bank_mask:0xf bound_ctrl:0
    v_mov_b32_dpp v149, v149 row_shr:1 row_mask:0xf bank_mask:0xf bound_ctrl:0
    v_mfma_f32_32x32x16_bf16 v[128:143], v[192:195], v[48:51], v[128:143]
    v_mov_b32_dpp v150, v150 row_shr:1 row_mask:0xf bank_mask:0xf bound_ctrl:0
    v_mov_b32_dpp v151, v151 row_shr:1 row_mask:0xf bank_mask:0xf bound_ctrl:0
    v_mov_b32_dpp v152, v152 row_shr:1 row_mask:0xf bank_mask:0xf bound_ctrl:0
    v_mfma_f32_32x32x16_bf16 v[128:143], v[196:199], v[52:55], v[128:143]
    v_mov_b32_dpp v153, v153 row_shr:1 row_mask:0xf bank_mask:0xf bound_ctrl:0
    v_mov_b32_dpp v154, v154 row_shr:1 row_mask:0xf bank_mask:0xf bound_ctrl:0
    v_mov_b32_dpp v155, v155 row_shr:1 row_mask:0xf bank_mask:0xf bound_ctrl:0
    v_mfma_f32_32x32x16_bf16 v[128:143], v[200:203], v[56:59], v[128:143]
    v_mov_b32_dpp v156, v156 row_shr:1 row_mask:0xf bank_mask:0xf bound_ctrl:0
    v_mov_b32_dpp v157, v157 row_shr:1 row_mask:0xf bank_mask:0xf bound_ctrl:0
    v_mfma_f32_32x32x16_bf16 v[128:143], v[204:207], v[60:63], v[128:143]
    v_mov_b32_dpp v158, v158 row_shr:1 row_mask:0xf bank_mask:0xf bound_ctrl:0
    v_mov_b32_dpp v159, v159 row_shr:1 row_mask:0xf bank_mask:0xf bound_ctrl:0
    s_waitcnt lgkmcnt(0)
    v_mfma_f32_32x32x16_bf16 v[160:175], v[208:211], v[96:99], v[160:175]
    ds_read_b64 v[176:177], v14 offset:768
    ds_read_b64 v[178:179], v14 offset:776
    ds_read_b64 v[180:181], v14 offset:800
    ds_read_b64 v[182:183], v14 offset:808
    s_nop 0
    v_mfma_f32_32x32x16_bf16 v[160:175], v[212:215], v[100:103], v[160:175]
    ds_read_b64 v[184:185], v14 offset:832
    ds_read_b64 v[186:187], v14 offset:840
    ds_read_b64 v[188:189], v14 offset:864
    s_nop 1
    v_mfma_f32_32x32x16_bf16 v[160:175], v[216:219], v[104:107], v[160:175]
    ds_read_b64 v[190:191], v14 offset:872
    ds_read_b64 v[192:193], v14 offset:896
    ds_read_b64 v[194:195], v14 offset:904
    v_mov_b32_dpp v128, v128 row_shr:1 row_mask:0xf bank_mask:0xf bound_ctrl:0
    v_mov_b32_dpp v129, v129 row_shr:1 row_mask:0xf bank_mask:0xf bound_ctrl:0
    v_mov_b32_dpp v130, v130 row_shr:1 row_mask:0xf bank_mask:0xf bound_ctrl:0
    v_mfma_f32_32x32x16_bf16 v[160:175], v[220:223], v[108:111], v[160:175]
    ds_read_b64 v[196:197], v14 offset:928
    ds_read_b64 v[198:199], v14 offset:936
    ds_read_b64 v[200:201], v14 offset:960
    v_mov_b32_dpp v131, v131 row_shr:1 row_mask:0xf bank_mask:0xf bound_ctrl:0
    v_mov_b32_dpp v132, v132 row_shr:1 row_mask:0xf bank_mask:0xf bound_ctrl:0
    v_mov_b32_dpp v133, v133 row_shr:1 row_mask:0xf bank_mask:0xf bound_ctrl:0
    v_mfma_f32_32x32x16_bf16 v[160:175], v[224:227], v[112:115], v[160:175]
    ds_read_b64 v[202:203], v14 offset:968
    ds_read_b64 v[204:205], v14 offset:992
    ds_read_b64 v[206:207], v14 offset:1000
    v_mov_b32_dpp v134, v134 row_shr:1 row_mask:0xf bank_mask:0xf bound_ctrl:0
    v_mov_b32_dpp v135, v135 row_shr:1 row_mask:0xf bank_mask:0xf bound_ctrl:0
    v_mov_b32_dpp v136, v136 row_shr:1 row_mask:0xf bank_mask:0xf bound_ctrl:0
    v_mfma_f32_32x32x16_bf16 v[160:175], v[228:231], v[116:119], v[160:175]
    v_mov_b32_dpp v137, v137 row_shr:1 row_mask:0xf bank_mask:0xf bound_ctrl:0
    v_mov_b32_dpp v138, v138 row_shr:1 row_mask:0xf bank_mask:0xf bound_ctrl:0
    v_mov_b32_dpp v139, v139 row_shr:1 row_mask:0xf bank_mask:0xf bound_ctrl:0
    v_mfma_f32_32x32x16_bf16 v[160:175], v[232:235], v[120:123], v[160:175]
    v_mov_b32_dpp v140, v140 row_shr:1 row_mask:0xf bank_mask:0xf bound_ctrl:0
    v_mov_b32_dpp v141, v141 row_shr:1 row_mask:0xf bank_mask:0xf bound_ctrl:0
    v_mfma_f32_32x32x16_bf16 v[160:175], v[236:239], v[124:127], v[160:175]
    v_mov_b32_dpp v142, v142 row_shr:1 row_mask:0xf bank_mask:0xf bound_ctrl:0
    v_mov_b32_dpp v143, v143 row_shr:1 row_mask:0xf bank_mask:0xf bound_ctrl:0
    s_waitcnt lgkmcnt(0)
    v_mfma_f32_32x32x16_bf16 v[144:159], v[176:179], v[64:67], v[144:159]
    ds_read_b64 v[208:209], v14 offset:2816
    ds_read_b64 v[210:211], v14 offset:2824
    s_nop 2
    v_mfma_f32_32x32x16_bf16 v[144:159], v[180:183], v[68:71], v[144:159]
    ds_read_b64 v[212:213], v14 offset:2848
    ds_read_b64 v[214:215], v14 offset:2856
    s_nop 2
    v_mfma_f32_32x32x16_bf16 v[144:159], v[184:187], v[72:75], v[144:159]
    ds_read_b64 v[216:217], v14 offset:2880
    ds_read_b64 v[218:219], v14 offset:2888
    v_and_b32_dpp v160, v160, v15 row_shr:1 row_mask:0xf bank_mask:0xf bound_ctrl:0
    v_and_b32_dpp v161, v161, v15 row_shr:1 row_mask:0xf bank_mask:0xf bound_ctrl:0
    v_and_b32_dpp v162, v162, v15 row_shr:1 row_mask:0xf bank_mask:0xf bound_ctrl:0
    v_mfma_f32_32x32x16_bf16 v[144:159], v[188:191], v[76:79], v[144:159]
    ds_read_b64 v[220:221], v14 offset:2912
    ds_read_b64 v[222:223], v14 offset:2920
    v_and_b32_dpp v163, v163, v15 row_shr:1 row_mask:0xf bank_mask:0xf bound_ctrl:0
    v_and_b32_dpp v164, v164, v15 row_shr:1 row_mask:0xf bank_mask:0xf bound_ctrl:0
    v_and_b32_dpp v165, v165, v15 row_shr:1 row_mask:0xf bank_mask:0xf bound_ctrl:0
    v_mfma_f32_32x32x16_bf16 v[144:159], v[192:195], v[80:83], v[144:159]
    ds_read_b64 v[224:225], v14 offset:2944
    ds_read_b64 v[226:227], v14 offset:2952
    v_and_b32_dpp v166, v166, v15 row_shr:1 row_mask:0xf bank_mask:0xf bound_ctrl:0
    v_and_b32_dpp v167, v167, v15 row_shr:1 row_mask:0xf bank_mask:0xf bound_ctrl:0
    v_and_b32_dpp v168, v168, v15 row_shr:1 row_mask:0xf bank_mask:0xf bound_ctrl:0
    v_mfma_f32_32x32x16_bf16 v[144:159], v[196:199], v[84:87], v[144:159]
    ds_read_b64 v[228:229], v14 offset:2976
    ds_read_b64 v[230:231], v14 offset:2984
    v_and_b32_dpp v169, v169, v15 row_shr:1 row_mask:0xf bank_mask:0xf bound_ctrl:0
    v_and_b32_dpp v170, v170, v15 row_shr:1 row_mask:0xf bank_mask:0xf bound_ctrl:0
    v_and_b32_dpp v171, v171, v15 row_shr:1 row_mask:0xf bank_mask:0xf bound_ctrl:0
    v_mfma_f32_32x32x16_bf16 v[144:159], v[200:203], v[88:91], v[144:159]
    ds_read_b64 v[232:233], v14 offset:3008
    ds_read_b64 v[234:235], v14 offset:3016
    v_and_b32_dpp v172, v172, v15 row_shr:1 row_mask:0xf bank_mask:0xf bound_ctrl:0
    v_and_b32_dpp v173, v173, v15 row_shr:1 row_mask:0xf bank_mask:0xf bound_ctrl:0
    v_mfma_f32_32x32x16_bf16 v[144:159], v[204:207], v[92:95], v[144:159]
    ds_read_b64 v[236:237], v14 offset:3040
    ds_read_b64 v[238:239], v14 offset:3048
    v_and_b32_dpp v174, v174, v15 row_shr:1 row_mask:0xf bank_mask:0xf bound_ctrl:0
    v_and_b32_dpp v175, v175, v15 row_shr:1 row_mask:0xf bank_mask:0xf bound_ctrl:0
    v_mfma_f32_32x32x16_bf16 v[128:143], v[176:179], v[32:35], v[128:143]
    s_nop 4
    v_mfma_f32_32x32x16_bf16 v[128:143], v[180:183], v[36:39], v[128:143]
    s_nop 4
    v_mfma_f32_32x32x16_bf16 v[128:143], v[184:187], v[40:43], v[128:143]
    v_mov_b32_dpp v144, v144 row_shr:1 row_mask:0xf bank_mask:0xf bound_ctrl:0
    v_mov_b32_dpp v145, v145 row_shr:1 row_mask:0xf bank_mask:0xf bound_ctrl:0
    v_mov_b32_dpp v146, v146 row_shr:1 row_mask:0xf bank_mask:0xf bound_ctrl:0
    v_mfma_f32_32x32x16_bf16 v[128:143], v[188:191], v[44:47], v[128:143]
    v_mov_b32_dpp v147, v147 row_shr:1 row_mask:0xf bank_mask:0xf bound_ctrl:0
    v_mov_b32_dpp v148, v148 row_shr:1 row_mask:0xf bank_mask:0xf bound_ctrl:0
    v_mov_b32_dpp v149, v149 row_shr:1 row_mask:0xf bank_mask:0xf bound_ctrl:0
    v_mfma_f32_32x32x16_bf16 v[128:143], v[192:195], v[48:51], v[128:143]
    v_mov_b32_dpp v150, v150 row_shr:1 row_mask:0xf bank_mask:0xf bound_ctrl:0
    v_mov_b32_dpp v151, v151 row_shr:1 row_mask:0xf bank_mask:0xf bound_ctrl:0
    v_mov_b32_dpp v152, v152 row_shr:1 row_mask:0xf bank_mask:0xf bound_ctrl:0
    v_mfma_f32_32x32x16_bf16 v[128:143], v[196:199], v[52:55], v[128:143]
    v_mov_b32_dpp v153, v153 row_shr:1 row_mask:0xf bank_mask:0xf bound_ctrl:0
    v_mov_b32_dpp v154, v154 row_shr:1 row_mask:0xf bank_mask:0xf bound_ctrl:0
    v_mov_b32_dpp v155, v155 row_shr:1 row_mask:0xf bank_mask:0xf bound_ctrl:0
    v_mfma_f32_32x32x16_bf16 v[128:143], v[200:203], v[56:59], v[128:143]
    v_mov_b32_dpp v156, v156 row_shr:1 row_mask:0xf bank_mask:0xf bound_ctrl:0
    v_mov_b32_dpp v157, v157 row_shr:1 row_mask:0xf bank_mask:0xf bound_ctrl:0
    v_mfma_f32_32x32x16_bf16 v[128:143], v[204:207], v[60:63], v[128:143]
    v_mov_b32_dpp v158, v158 row_shr:1 row_mask:0xf bank_mask:0xf bound_ctrl:0
    v_mov_b32_dpp v159, v159 row_shr:1 row_mask:0xf bank_mask:0xf bound_ctrl:0
    s_waitcnt lgkmcnt(0)
    v_mfma_f32_32x32x16_bf16 v[160:175], v[208:211], v[96:99], v[160:175]
    ds_read_b64 v[176:177], v14 offset:512
    ds_read_b64 v[178:179], v14 offset:520
    ds_read_b64 v[180:181], v14 offset:544
    ds_read_b64 v[182:183], v14 offset:552
    s_nop 0
    v_mfma_f32_32x32x16_bf16 v[160:175], v[212:215], v[100:103], v[160:175]
    ds_read_b64 v[184:185], v14 offset:576
    ds_read_b64 v[186:187], v14 offset:584
    ds_read_b64 v[188:189], v14 offset:608
    s_nop 1
    v_mfma_f32_32x32x16_bf16 v[160:175], v[216:219], v[104:107], v[160:175]
    ds_read_b64 v[190:191], v14 offset:616
    ds_read_b64 v[192:193], v14 offset:640
    ds_read_b64 v[194:195], v14 offset:648
    v_mov_b32_dpp v128, v128 row_shr:1 row_mask:0xf bank_mask:0xf bound_ctrl:0
    v_mov_b32_dpp v129, v129 row_shr:1 row_mask:0xf bank_mask:0xf bound_ctrl:0
    v_mov_b32_dpp v130, v130 row_shr:1 row_mask:0xf bank_mask:0xf bound_ctrl:0
    v_mfma_f32_32x32x16_bf16 v[160:175], v[220:223], v[108:111], v[160:175]
    ds_read_b64 v[196:197], v14 offset:672
    ds_read_b64 v[198:199], v14 offset:680
    ds_read_b64 v[200:201], v14 offset:704
    v_mov_b32_dpp v131, v131 row_shr:1 row_mask:0xf bank_mask:0xf bound_ctrl:0
    v_mov_b32_dpp v132, v132 row_shr:1 row_mask:0xf bank_mask:0xf bound_ctrl:0
    v_mov_b32_dpp v133, v133 row_shr:1 row_mask:0xf bank_mask:0xf bound_ctrl:0
    v_mfma_f32_32x32x16_bf16 v[160:175], v[224:227], v[112:115], v[160:175]
    ds_read_b64 v[202:203], v14 offset:712
    ds_read_b64 v[204:205], v14 offset:736
    ds_read_b64 v[206:207], v14 offset:744
    v_mov_b32_dpp v134, v134 row_shr:1 row_mask:0xf bank_mask:0xf bound_ctrl:0
    v_mov_b32_dpp v135, v135 row_shr:1 row_mask:0xf bank_mask:0xf bound_ctrl:0
    v_mov_b32_dpp v136, v136 row_shr:1 row_mask:0xf bank_mask:0xf bound_ctrl:0
    v_mfma_f32_32x32x16_bf16 v[160:175], v[228:231], v[116:119], v[160:175]
    v_mov_b32_dpp v137, v137 row_shr:1 row_mask:0xf bank_mask:0xf bound_ctrl:0
    v_mov_b32_dpp v138, v138 row_shr:1 row_mask:0xf bank_mask:0xf bound_ctrl:0
    v_mov_b32_dpp v139, v139 row_shr:1 row_mask:0xf bank_mask:0xf bound_ctrl:0
    v_mfma_f32_32x32x16_bf16 v[160:175], v[232:235], v[120:123], v[160:175]
    v_mov_b32_dpp v140, v140 row_shr:1 row_mask:0xf bank_mask:0xf bound_ctrl:0
    v_mov_b32_dpp v141, v141 row_shr:1 row_mask:0xf bank_mask:0xf bound_ctrl:0
    v_mfma_f32_32x32x16_bf16 v[160:175], v[236:239], v[124:127], v[160:175]
    v_mov_b32_dpp v142, v142 row_shr:1 row_mask:0xf bank_mask:0xf bound_ctrl:0
    v_mov_b32_dpp v143, v143 row_shr:1 row_mask:0xf bank_mask:0xf bound_ctrl:0
    s_waitcnt lgkmcnt(0)
    v_mfma_f32_32x32x16_bf16 v[144:159], v[176:179], v[64:67], v[144:159]
    ds_read_b64 v[208:209], v14 offset:2560
    ds_read_b64 v[210:211], v14 offset:2568
    s_nop 2
    v_mfma_f32_32x32x16_bf16 v[144:159], v[180:183], v[68:71], v[144:159]
    ds_read_b64 v[212:213], v14 offset:2592
    ds_read_b64 v[214:215], v14 offset:2600
    s_nop 2
    v_mfma_f32_32x32x16_bf16 v[144:159], v[184:187], v[72:75], v[144:159]
    ds_read_b64 v[216:217], v14 offset:2624
    ds_read_b64 v[218:219], v14 offset:2632
    v_and_b32_dpp v160, v160, v15 row_shr:1 row_mask:0xf bank_mask:0xf bound_ctrl:0
    v_and_b32_dpp v161, v161, v15 row_shr:1 row_mask:0xf bank_mask:0xf bound_ctrl:0
    v_and_b32_dpp v162, v162, v15 row_shr:1 row_mask:0xf bank_mask:0xf bound_ctrl:0
    v_mfma_f32_32x32x16_bf16 v[144:159], v[188:191], v[76:79], v[144:159]
    ds_read_b64 v[220:221], v14 offset:2656
    ds_read_b64 v[222:223], v14 offset:2664
    v_and_b32_dpp v163, v163, v15 row_shr:1 row_mask:0xf bank_mask:0xf bound_ctrl:0
    v_and_b32_dpp v164, v164, v15 row_shr:1 row_mask:0xf bank_mask:0xf bound_ctrl:0
    v_and_b32_dpp v165, v165, v15 row_shr:1 row_mask:0xf bank_mask:0xf bound_ctrl:0
    v_mfma_f32_32x32x16_bf16 v[144:159], v[192:195], v[80:83], v[144:159]
    ds_read_b64 v[224:225], v14 offset:2688
    ds_read_b64 v[226:227], v14 offset:2696
    v_and_b32_dpp v166, v166, v15 row_shr:1 row_mask:0xf bank_mask:0xf bound_ctrl:0
    v_and_b32_dpp v167, v167, v15 row_shr:1 row_mask:0xf bank_mask:0xf bound_ctrl:0
    v_and_b32_dpp v168, v168, v15 row_shr:1 row_mask:0xf bank_mask:0xf bound_ctrl:0
    v_mfma_f32_32x32x16_bf16 v[144:159], v[196:199], v[84:87], v[144:159]
    ds_read_b64 v[228:229], v14 offset:2720
    ds_read_b64 v[230:231], v14 offset:2728
    v_and_b32_dpp v169, v169, v15 row_shr:1 row_mask:0xf bank_mask:0xf bound_ctrl:0
    v_and_b32_dpp v170, v170, v15 row_shr:1 row_mask:0xf bank_mask:0xf bound_ctrl:0
    v_and_b32_dpp v171, v171, v15 row_shr:1 row_mask:0xf bank_mask:0xf bound_ctrl:0
    v_mfma_f32_32x32x16_bf16 v[144:159], v[200:203], v[88:91], v[144:159]
    ds_read_b64 v[232:233], v14 offset:2752
    ds_read_b64 v[234:235], v14 offset:2760
    v_and_b32_dpp v172, v172, v15 row_shr:1 row_mask:0xf bank_mask:0xf bound_ctrl:0
    v_and_b32_dpp v173, v173, v15 row_shr:1 row_mask:0xf bank_mask:0xf bound_ctrl:0
    v_mfma_f32_32x32x16_bf16 v[144:159], v[204:207], v[92:95], v[144:159]
    ds_read_b64 v[236:237], v14 offset:2784
    ds_read_b64 v[238:239], v14 offset:2792
    v_and_b32_dpp v174, v174, v15 row_shr:1 row_mask:0xf bank_mask:0xf bound_ctrl:0
    v_and_b32_dpp v175, v175, v15 row_shr:1 row_mask:0xf bank_mask:0xf bound_ctrl:0
    v_mfma_f32_32x32x16_bf16 v[128:143], v[176:179], v[32:35], v[128:143]
    s_nop 4
    v_mfma_f32_32x32x16_bf16 v[128:143], v[180:183], v[36:39], v[128:143]
    s_nop 4
    v_mfma_f32_32x32x16_bf16 v[128:143], v[184:187], v[40:43], v[128:143]
    v_mov_b32_dpp v144, v144 row_shr:1 row_mask:0xf bank_mask:0xf bound_ctrl:0
    v_mov_b32_dpp v145, v145 row_shr:1 row_mask:0xf bank_mask:0xf bound_ctrl:0
    v_mov_b32_dpp v146, v146 row_shr:1 row_mask:0xf bank_mask:0xf bound_ctrl:0
    v_mfma_f32_32x32x16_bf16 v[128:143], v[188:191], v[44:47], v[128:143]
    v_mov_b32_dpp v147, v147 row_shr:1 row_mask:0xf bank_mask:0xf bound_ctrl:0
    v_mov_b32_dpp v148, v148 row_shr:1 row_mask:0xf bank_mask:0xf bound_ctrl:0
    v_mov_b32_dpp v149, v149 row_shr:1 row_mask:0xf bank_mask:0xf bound_ctrl:0
    v_mfma_f32_32x32x16_bf16 v[128:143], v[192:195], v[48:51], v[128:143]
    v_mov_b32_dpp v150, v150 row_shr:1 row_mask:0xf bank_mask:0xf bound_ctrl:0
    v_mov_b32_dpp v151, v151 row_shr:1 row_mask:0xf bank_mask:0xf bound_ctrl:0
    v_mov_b32_dpp v152, v152 row_shr:1 row_mask:0xf bank_mask:0xf bound_ctrl:0
    v_mfma_f32_32x32x16_bf16 v[128:143], v[196:199], v[52:55], v[128:143]
    v_mov_b32_dpp v153, v153 row_shr:1 row_mask:0xf bank_mask:0xf bound_ctrl:0
    v_mov_b32_dpp v154, v154 row_shr:1 row_mask:0xf bank_mask:0xf bound_ctrl:0
    v_mov_b32_dpp v155, v155 row_shr:1 row_mask:0xf bank_mask:0xf bound_ctrl:0
    v_mfma_f32_32x32x16_bf16 v[128:143], v[200:203], v[56:59], v[128:143]
    v_mov_b32_dpp v156, v156 row_shr:1 row_mask:0xf bank_mask:0xf bound_ctrl:0
    v_mov_b32_dpp v157, v157 row_shr:1 row_mask:0xf bank_mask:0xf bound_ctrl:0
    v_mfma_f32_32x32x16_bf16 v[128:143], v[204:207], v[60:63], v[128:143]
    v_mov_b32_dpp v158, v158 row_shr:1 row_mask:0xf bank_mask:0xf bound_ctrl:0
    v_mov_b32_dpp v159, v159 row_shr:1 row_mask:0xf bank_mask:0xf bound_ctrl:0
    s_waitcnt lgkmcnt(0)
    v_mfma_f32_32x32x16_bf16 v[160:175], v[208:211], v[96:99], v[160:175]
    ds_read_b64 v[176:177], v14 offset:256
    ds_read_b64 v[178:179], v14 offset:264
    ds_read_b64 v[180:181], v14 offset:288
    ds_read_b64 v[182:183], v14 offset:296
    s_nop 0
    v_mfma_f32_32x32x16_bf16 v[160:175], v[212:215], v[100:103], v[160:175]
    ds_read_b64 v[184:185], v14 offset:320
    ds_read_b64 v[186:187], v14 offset:328
    ds_read_b64 v[188:189], v14 offset:352
    s_nop 1
    v_mfma_f32_32x32x16_bf16 v[160:175], v[216:219], v[104:107], v[160:175]
    ds_read_b64 v[190:191], v14 offset:360
    ds_read_b64 v[192:193], v14 offset:384
    ds_read_b64 v[194:195], v14 offset:392
    v_mov_b32_dpp v128, v128 row_shr:1 row_mask:0xf bank_mask:0xf bound_ctrl:0
    v_mov_b32_dpp v129, v129 row_shr:1 row_mask:0xf bank_mask:0xf bound_ctrl:0
    v_mov_b32_dpp v130, v130 row_shr:1 row_mask:0xf bank_mask:0xf bound_ctrl:0
    v_mfma_f32_32x32x16_bf16 v[160:175], v[220:223], v[108:111], v[160:175]
    ds_read_b64 v[196:197], v14 offset:416
    ds_read_b64 v[198:199], v14 offset:424
    ds_read_b64 v[200:201], v14 offset:448
    v_mov_b32_dpp v131, v131 row_shr:1 row_mask:0xf bank_mask:0xf bound_ctrl:0
    v_mov_b32_dpp v132, v132 row_shr:1 row_mask:0xf bank_mask:0xf bound_ctrl:0
    v_mov_b32_dpp v133, v133 row_shr:1 row_mask:0xf bank_mask:0xf bound_ctrl:0
    v_mfma_f32_32x32x16_bf16 v[160:175], v[224:227], v[112:115], v[160:175]
    ds_read_b64 v[202:203], v14 offset:456
    ds_read_b64 v[204:205], v14 offset:480
    ds_read_b64 v[206:207], v14 offset:488
    v_mov_b32_dpp v134, v134 row_shr:1 row_mask:0xf bank_mask:0xf bound_ctrl:0
    v_mov_b32_dpp v135, v135 row_shr:1 row_mask:0xf bank_mask:0xf bound_ctrl:0
    v_mov_b32_dpp v136, v136 row_shr:1 row_mask:0xf bank_mask:0xf bound_ctrl:0
    v_mfma_f32_32x32x16_bf16 v[160:175], v[228:231], v[116:119], v[160:175]
    v_mov_b32_dpp v137, v137 row_shr:1 row_mask:0xf bank_mask:0xf bound_ctrl:0
    v_mov_b32_dpp v138, v138 row_shr:1 row_mask:0xf bank_mask:0xf bound_ctrl:0
    v_mov_b32_dpp v139, v139 row_shr:1 row_mask:0xf bank_mask:0xf bound_ctrl:0
    v_mfma_f32_32x32x16_bf16 v[160:175], v[232:235], v[120:123], v[160:175]
    v_mov_b32_dpp v140, v140 row_shr:1 row_mask:0xf bank_mask:0xf bound_ctrl:0
    v_mov_b32_dpp v141, v141 row_shr:1 row_mask:0xf bank_mask:0xf bound_ctrl:0
    v_mfma_f32_32x32x16_bf16 v[160:175], v[236:239], v[124:127], v[160:175]
    v_mov_b32_dpp v142, v142 row_shr:1 row_mask:0xf bank_mask:0xf bound_ctrl:0
    v_mov_b32_dpp v143, v143 row_shr:1 row_mask:0xf bank_mask:0xf bound_ctrl:0
    s_waitcnt lgkmcnt(0)
    v_mfma_f32_32x32x16_bf16 v[144:159], v[176:179], v[64:67], v[144:159]
    ds_read_b64 v[208:209], v14 offset:2304
    ds_read_b64 v[210:211], v14 offset:2312
    s_nop 2
    v_mfma_f32_32x32x16_bf16 v[144:159], v[180:183], v[68:71], v[144:159]
    ds_read_b64 v[212:213], v14 offset:2336
    ds_read_b64 v[214:215], v14 offset:2344
    s_nop 2
    v_mfma_f32_32x32x16_bf16 v[144:159], v[184:187], v[72:75], v[144:159]
    ds_read_b64 v[216:217], v14 offset:2368
    ds_read_b64 v[218:219], v14 offset:2376
    v_and_b32_dpp v160, v160, v15 row_shr:1 row_mask:0xf bank_mask:0xf bound_ctrl:0
    v_and_b32_dpp v161, v161, v15 row_shr:1 row_mask:0xf bank_mask:0xf bound_ctrl:0
    v_and_b32_dpp v162, v162, v15 row_shr:1 row_mask:0xf bank_mask:0xf bound_ctrl:0
    v_mfma_f32_32x32x16_bf16 v[144:159], v[188:191], v[76:79], v[144:159]
    ds_read_b64 v[220:221], v14 offset:2400
    ds_read_b64 v[222:223], v14 offset:2408
    v_and_b32_dpp v163, v163, v15 row_shr:1 row_mask:0xf bank_mask:0xf bound_ctrl:0
    v_and_b32_dpp v164, v164, v15 row_shr:1 row_mask:0xf bank_mask:0xf bound_ctrl:0
    v_and_b32_dpp v165, v165, v15 row_shr:1 row_mask:0xf bank_mask:0xf bound_ctrl:0
    v_mfma_f32_32x32x16_bf16 v[144:159], v[192:195], v[80:83], v[144:159]
    ds_read_b64 v[224:225], v14 offset:2432
    ds_read_b64 v[226:227], v14 offset:2440
    v_and_b32_dpp v166, v166, v15 row_shr:1 row_mask:0xf bank_mask:0xf bound_ctrl:0
    v_and_b32_dpp v167, v167, v15 row_shr:1 row_mask:0xf bank_mask:0xf bound_ctrl:0
    v_and_b32_dpp v168, v168, v15 row_shr:1 row_mask:0xf bank_mask:0xf bound_ctrl:0
    v_mfma_f32_32x32x16_bf16 v[144:159], v[196:199], v[84:87], v[144:159]
    ds_read_b64 v[228:229], v14 offset:2464
    ds_read_b64 v[230:231], v14 offset:2472
    v_and_b32_dpp v169, v169, v15 row_shr:1 row_mask:0xf bank_mask:0xf bound_ctrl:0
    v_and_b32_dpp v170, v170, v15 row_shr:1 row_mask:0xf bank_mask:0xf bound_ctrl:0
    v_and_b32_dpp v171, v171, v15 row_shr:1 row_mask:0xf bank_mask:0xf bound_ctrl:0
    v_mfma_f32_32x32x16_bf16 v[144:159], v[200:203], v[88:91], v[144:159]
    ds_read_b64 v[232:233], v14 offset:2496
    ds_read_b64 v[234:235], v14 offset:2504
    v_and_b32_dpp v172, v172, v15 row_shr:1 row_mask:0xf bank_mask:0xf bound_ctrl:0
    v_and_b32_dpp v173, v173, v15 row_shr:1 row_mask:0xf bank_mask:0xf bound_ctrl:0
    v_mfma_f32_32x32x16_bf16 v[144:159], v[204:207], v[92:95], v[144:159]
    ds_read_b64 v[236:237], v14 offset:2528
    ds_read_b64 v[238:239], v14 offset:2536
    v_and_b32_dpp v174, v174, v15 row_shr:1 row_mask:0xf bank_mask:0xf bound_ctrl:0
    v_and_b32_dpp v175, v175, v15 row_shr:1 row_mask:0xf bank_mask:0xf bound_ctrl:0
    v_mfma_f32_32x32x16_bf16 v[128:143], v[176:179], v[32:35], v[128:143]
    s_nop 4
    v_mfma_f32_32x32x16_bf16 v[128:143], v[180:183], v[36:39], v[128:143]
    s_nop 4
    v_mfma_f32_32x32x16_bf16 v[128:143], v[184:187], v[40:43], v[128:143]
    v_mov_b32_dpp v144, v144 row_shr:1 row_mask:0xf bank_mask:0xf bound_ctrl:0
    v_mov_b32_dpp v145, v145 row_shr:1 row_mask:0xf bank_mask:0xf bound_ctrl:0
    v_mov_b32_dpp v146, v146 row_shr:1 row_mask:0xf bank_mask:0xf bound_ctrl:0
    v_mfma_f32_32x32x16_bf16 v[128:143], v[188:191], v[44:47], v[128:143]
    v_mov_b32_dpp v147, v147 row_shr:1 row_mask:0xf bank_mask:0xf bound_ctrl:0
    v_mov_b32_dpp v148, v148 row_shr:1 row_mask:0xf bank_mask:0xf bound_ctrl:0
    v_mov_b32_dpp v149, v149 row_shr:1 row_mask:0xf bank_mask:0xf bound_ctrl:0
    v_mfma_f32_32x32x16_bf16 v[128:143], v[192:195], v[48:51], v[128:143]
    v_mov_b32_dpp v150, v150 row_shr:1 row_mask:0xf bank_mask:0xf bound_ctrl:0
    v_mov_b32_dpp v151, v151 row_shr:1 row_mask:0xf bank_mask:0xf bound_ctrl:0
    v_mov_b32_dpp v152, v152 row_shr:1 row_mask:0xf bank_mask:0xf bound_ctrl:0
    v_mfma_f32_32x32x16_bf16 v[128:143], v[196:199], v[52:55], v[128:143]
    v_mov_b32_dpp v153, v153 row_shr:1 row_mask:0xf bank_mask:0xf bound_ctrl:0
    v_mov_b32_dpp v154, v154 row_shr:1 row_mask:0xf bank_mask:0xf bound_ctrl:0
    v_mov_b32_dpp v155, v155 row_shr:1 row_mask:0xf bank_mask:0xf bound_ctrl:0
    v_mfma_f32_32x32x16_bf16 v[128:143], v[200:203], v[56:59], v[128:143]
    v_mov_b32_dpp v156, v156 row_shr:1 row_mask:0xf bank_mask:0xf bound_ctrl:0
    v_mov_b32_dpp v157, v157 row_shr:1 row_mask:0xf bank_mask:0xf bound_ctrl:0
    v_mfma_f32_32x32x16_bf16 v[128:143], v[204:207], v[60:63], v[128:143]
    v_mov_b32_dpp v158, v158 row_shr:1 row_mask:0xf bank_mask:0xf bound_ctrl:0
    v_mov_b32_dpp v159, v159 row_shr:1 row_mask:0xf bank_mask:0xf bound_ctrl:0
    s_waitcnt lgkmcnt(0)
    v_mfma_f32_32x32x16_bf16 v[160:175], v[208:211], v[96:99], v[160:175]
    ds_read_b64 v[176:177], v14 offset:0
    ds_read_b64 v[178:179], v14 offset:8
    ds_read_b64 v[180:181], v14 offset:32
    ds_read_b64 v[182:183], v14 offset:40
    s_nop 0
    v_mfma_f32_32x32x16_bf16 v[160:175], v[212:215], v[100:103], v[160:175]
    ds_read_b64 v[184:185], v14 offset:64
    ds_read_b64 v[186:187], v14 offset:72
    ds_read_b64 v[188:189], v14 offset:96
    s_nop 1
    v_mfma_f32_32x32x16_bf16 v[160:175], v[216:219], v[104:107], v[160:175]
    ds_read_b64 v[190:191], v14 offset:104
    ds_read_b64 v[192:193], v14 offset:128
    ds_read_b64 v[194:195], v14 offset:136
    v_mov_b32_dpp v128, v128 row_shr:1 row_mask:0xf bank_mask:0xf bound_ctrl:0
    v_mov_b32_dpp v129, v129 row_shr:1 row_mask:0xf bank_mask:0xf bound_ctrl:0
    v_mov_b32_dpp v130, v130 row_shr:1 row_mask:0xf bank_mask:0xf bound_ctrl:0
    v_mfma_f32_32x32x16_bf16 v[160:175], v[220:223], v[108:111], v[160:175]
    ds_read_b64 v[196:197], v14 offset:160
    ds_read_b64 v[198:199], v14 offset:168
    ds_read_b64 v[200:201], v14 offset:192
    v_mov_b32_dpp v131, v131 row_shr:1 row_mask:0xf bank_mask:0xf bound_ctrl:0
    v_mov_b32_dpp v132, v132 row_shr:1 row_mask:0xf bank_mask:0xf bound_ctrl:0
    v_mov_b32_dpp v133, v133 row_shr:1 row_mask:0xf bank_mask:0xf bound_ctrl:0
    v_mfma_f32_32x32x16_bf16 v[160:175], v[224:227], v[112:115], v[160:175]
    ds_read_b64 v[202:203], v14 offset:200
    ds_read_b64 v[204:205], v14 offset:224
    ds_read_b64 v[206:207], v14 offset:232
    v_mov_b32_dpp v134, v134 row_shr:1 row_mask:0xf bank_mask:0xf bound_ctrl:0
    v_mov_b32_dpp v135, v135 row_shr:1 row_mask:0xf bank_mask:0xf bound_ctrl:0
    v_mov_b32_dpp v136, v136 row_shr:1 row_mask:0xf bank_mask:0xf bound_ctrl:0
    v_mfma_f32_32x32x16_bf16 v[160:175], v[228:231], v[116:119], v[160:175]
    v_mov_b32_dpp v137, v137 row_shr:1 row_mask:0xf bank_mask:0xf bound_ctrl:0
    v_mov_b32_dpp v138, v138 row_shr:1 row_mask:0xf bank_mask:0xf bound_ctrl:0
    v_mov_b32_dpp v139, v139 row_shr:1 row_mask:0xf bank_mask:0xf bound_ctrl:0
    v_mfma_f32_32x32x16_bf16 v[160:175], v[232:235], v[120:123], v[160:175]
    v_mov_b32_dpp v140, v140 row_shr:1 row_mask:0xf bank_mask:0xf bound_ctrl:0
    v_mov_b32_dpp v141, v141 row_shr:1 row_mask:0xf bank_mask:0xf bound_ctrl:0
    v_mfma_f32_32x32x16_bf16 v[160:175], v[236:239], v[124:127], v[160:175]
    v_mov_b32_dpp v142, v142 row_shr:1 row_mask:0xf bank_mask:0xf bound_ctrl:0
    v_mov_b32_dpp v143, v143 row_shr:1 row_mask:0xf bank_mask:0xf bound_ctrl:0
    s_waitcnt lgkmcnt(0)
    v_mfma_f32_32x32x16_bf16 v[144:159], v[176:179], v[64:67], v[144:159]
    ds_read_b64 v[208:209], v14 offset:2048
    ds_read_b64 v[210:211], v14 offset:2056
    s_nop 2
    v_mfma_f32_32x32x16_bf16 v[144:159], v[180:183], v[68:71], v[144:159]
    ds_read_b64 v[212:213], v14 offset:2080
    ds_read_b64 v[214:215], v14 offset:2088
    s_nop 2
    v_mfma_f32_32x32x16_bf16 v[144:159], v[184:187], v[72:75], v[144:159]
    ds_read_b64 v[216:217], v14 offset:2112
    ds_read_b64 v[218:219], v14 offset:2120
    v_and_b32_dpp v160, v160, v15 row_shr:1 row_mask:0xf bank_mask:0xf bound_ctrl:0
    v_and_b32_dpp v161, v161, v15 row_shr:1 row_mask:0xf bank_mask:0xf bound_ctrl:0
    v_and_b32_dpp v162, v162, v15 row_shr:1 row_mask:0xf bank_mask:0xf bound_ctrl:0
    v_mfma_f32_32x32x16_bf16 v[144:159], v[188:191], v[76:79], v[144:159]
    ds_read_b64 v[220:221], v14 offset:2144
    ds_read_b64 v[222:223], v14 offset:2152
    v_and_b32_dpp v163, v163, v15 row_shr:1 row_mask:0xf bank_mask:0xf bound_ctrl:0
    v_and_b32_dpp v164, v164, v15 row_shr:1 row_mask:0xf bank_mask:0xf bound_ctrl:0
    v_and_b32_dpp v165, v165, v15 row_shr:1 row_mask:0xf bank_mask:0xf bound_ctrl:0
    v_mfma_f32_32x32x16_bf16 v[144:159], v[192:195], v[80:83], v[144:159]
    ds_read_b64 v[224:225], v14 offset:2176
    ds_read_b64 v[226:227], v14 offset:2184
    v_and_b32_dpp v166, v166, v15 row_shr:1 row_mask:0xf bank_mask:0xf bound_ctrl:0
    v_and_b32_dpp v167, v167, v15 row_shr:1 row_mask:0xf bank_mask:0xf bound_ctrl:0
    v_and_b32_dpp v168, v168, v15 row_shr:1 row_mask:0xf bank_mask:0xf bound_ctrl:0
    v_mfma_f32_32x32x16_bf16 v[144:159], v[196:199], v[84:87], v[144:159]
    ds_read_b64 v[228:229], v14 offset:2208
    ds_read_b64 v[230:231], v14 offset:2216
    v_and_b32_dpp v169, v169, v15 row_shr:1 row_mask:0xf bank_mask:0xf bound_ctrl:0
    v_and_b32_dpp v170, v170, v15 row_shr:1 row_mask:0xf bank_mask:0xf bound_ctrl:0
    v_and_b32_dpp v171, v171, v15 row_shr:1 row_mask:0xf bank_mask:0xf bound_ctrl:0
    v_mfma_f32_32x32x16_bf16 v[144:159], v[200:203], v[88:91], v[144:159]
    ds_read_b64 v[232:233], v14 offset:2240
    ds_read_b64 v[234:235], v14 offset:2248
    v_and_b32_dpp v172, v172, v15 row_shr:1 row_mask:0xf bank_mask:0xf bound_ctrl:0
    v_and_b32_dpp v173, v173, v15 row_shr:1 row_mask:0xf bank_mask:0xf bound_ctrl:0
    v_mfma_f32_32x32x16_bf16 v[144:159], v[204:207], v[92:95], v[144:159]
    ds_read_b64 v[236:237], v14 offset:2272
    ds_read_b64 v[238:239], v14 offset:2280
    v_and_b32_dpp v174, v174, v15 row_shr:1 row_mask:0xf bank_mask:0xf bound_ctrl:0
    v_and_b32_dpp v175, v175, v15 row_shr:1 row_mask:0xf bank_mask:0xf bound_ctrl:0
    v_mfma_f32_32x32x16_bf16 v[128:143], v[176:179], v[32:35], v[128:143]
    v_mfma_f32_32x32x16_bf16 v[128:143], v[180:183], v[36:39], v[128:143]
    v_mfma_f32_32x32x16_bf16 v[128:143], v[184:187], v[40:43], v[128:143]
    v_mfma_f32_32x32x16_bf16 v[128:143], v[188:191], v[44:47], v[128:143]
    v_mfma_f32_32x32x16_bf16 v[128:143], v[192:195], v[48:51], v[128:143]
    v_mfma_f32_32x32x16_bf16 v[128:143], v[196:199], v[52:55], v[128:143]
    v_mfma_f32_32x32x16_bf16 v[128:143], v[200:203], v[56:59], v[128:143]
    v_mfma_f32_32x32x16_bf16 v[128:143], v[204:207], v[60:63], v[128:143]
    s_waitcnt lgkmcnt(0)
    v_mfma_f32_32x32x16_bf16 v[160:175], v[208:211], v[96:99], v[160:175]
    v_mfma_f32_32x32x16_bf16 v[160:175], v[212:215], v[100:103], v[160:175]
    v_mfma_f32_32x32x16_bf16 v[160:175], v[216:219], v[104:107], v[160:175]
    v_mfma_f32_32x32x16_bf16 v[160:175], v[220:223], v[108:111], v[160:175]
    v_mfma_f32_32x32x16_bf16 v[160:175], v[224:227], v[112:115], v[160:175]
    v_mfma_f32_32x32x16_bf16 v[160:175], v[228:231], v[116:119], v[160:175]
    v_mfma_f32_32x32x16_bf16 v[160:175], v[232:235], v[120:123], v[160:175]
    v_mfma_f32_32x32x16_bf16 v[160:175], v[236:239], v[124:127], v[160:175]
    s_mov_b32 s48, 0x05040100
    s_mov_b32 s49, 0x07060302
    s_nop 11
    v_add_f32_dpp v128, v160, v128 row_shr:8 row_mask:0xf bank_mask:0xf bound_ctrl:0
    v_add_f32_dpp v129, v161, v129 row_shr:8 row_mask:0xf bank_mask:0xf bound_ctrl:0
    v_add_f32_dpp v130, v162, v130 row_shr:8 row_mask:0xf bank_mask:0xf bound_ctrl:0
    v_add_f32_dpp v131, v163, v131 row_shr:8 row_mask:0xf bank_mask:0xf bound_ctrl:0
    v_add_f32_dpp v132, v164, v132 row_shr:8 row_mask:0xf bank_mask:0xf bound_ctrl:0
    v_add_f32_dpp v133, v165, v133 row_shr:8 row_mask:0xf bank_mask:0xf bound_ctrl:0
    v_add_f32_dpp v134, v166, v134 row_shr:8 row_mask:0xf bank_mask:0xf bound_ctrl:0
    v_add_f32_dpp v135, v167, v135 row_shr:8 row_mask:0xf bank_mask:0xf bound_ctrl:0
    v_add_f32_dpp v136, v168, v136 row_shr:8 row_mask:0xf bank_mask:0xf bound_ctrl:0
    v_add_f32_dpp v137, v169, v137 row_shr:8 row_mask:0xf bank_mask:0xf bound_ctrl:0
    v_add_f32_dpp v138, v170, v138 row_shr:8 row_mask:0xf bank_mask:0xf bound_ctrl:0
    v_add_f32_dpp v139, v171, v139 row_shr:8 row_mask:0xf bank_mask:0xf bound_ctrl:0
    v_add_f32_dpp v140, v172, v140 row_shr:8 row_mask:0xf bank_mask:0xf bound_ctrl:0
    v_add_f32_dpp v141, v173, v141 row_shr:8 row_mask:0xf bank_mask:0xf bound_ctrl:0
    v_add_f32_dpp v142, v174, v142 row_shr:8 row_mask:0xf bank_mask:0xf bound_ctrl:0
    v_add_f32_dpp v143, v175, v143 row_shr:8 row_mask:0xf bank_mask:0xf bound_ctrl:0
    s_mov_b32 s42, 0xff00ff00
    s_mov_b32 s43, 0xff00ff00
    s_mov_b64 exec, s[42:43]
    v_add_f32 v144, v160, v144
    v_add_f32 v145, v161, v145
    v_add_f32 v146, v162, v146
    v_add_f32 v147, v163, v147
    v_add_f32 v148, v164, v148
    v_add_f32 v149, v165, v149
    v_add_f32 v150, v166, v150
    v_add_f32 v151, v167, v151
    v_add_f32 v152, v168, v152
    v_add_f32 v153, v169, v153
    v_add_f32 v154, v170, v154
    v_add_f32 v155, v171, v155
    v_add_f32 v156, v172, v156
    v_add_f32 v157, v173, v157
    v_add_f32 v158, v174, v158
    v_add_f32 v159, v175, v159
    s_mov_b64 exec, -1
    v_mul_u32_u24 v16, 272, v7
    v_add_u32 v16, s34, v16
    v_add_u32 v16, 4388, v16
    v_lshlrev_b32 v17, 2, v8
    v_sub_u32 v16, v16, v17
    v_lshlrev_b32 v17, 5, v9
    v_sub_u32 v16, v16, v17
    ds_read_b32 v48, v16 offset:216
    ds_read_b32 v49, v16 offset:208
    ds_read_b32 v50, v16 offset:200
    ds_read_b32 v51, v16 offset:192
    ds_read_b32 v52, v16 offset:152
    ds_read_b32 v53, v16 offset:144
    ds_read_b32 v54, v16 offset:136
    ds_read_b32 v55, v16 offset:128
    ds_read_b32 v56, v16 offset:88
    ds_read_b32 v57, v16 offset:80
    ds_read_b32 v58, v16 offset:72
    ds_read_b32 v59, v16 offset:64
    ds_read_b32 v60, v16 offset:24
    ds_read_b32 v61, v16 offset:16
    ds_read_b32 v62, v16 offset:8
    ds_read_b32 v63, v16 offset:0
    s_lshr_b32 s44, s20, 1
    s_and_b32 s45, s20, 1
    s_cmp_eq_u32 s44, 1
    s_cselect_b32 s44, s33, s32
    s_lshl_b32 s46, s44, 16
    s_and_b32 s47, s44, 0xffff0000
    s_cmp_eq_u32 s45, 1
    s_cselect_b32 s44, s47, s46
    v_mul_u32_u24 v18, 264, v7
    v_lshl_add_u32 v18, v9, 5, v18
    v_lshl_add_u32 v18, v8, 2, v18
    v_add_u32 v18, s34, v18
    s_waitcnt lgkmcnt(0)
    v_and_b32 v64, 0xffff0000, v48
    v_lshlrev_b32 v48, 16, v48
    v_and_b32 v65, 0xffff0000, v49
    v_lshlrev_b32 v49, 16, v49
    v_and_b32 v66, 0xffff0000, v50
    v_lshlrev_b32 v50, 16, v50
    v_and_b32 v67, 0xffff0000, v51
    v_lshlrev_b32 v51, 16, v51
    v_and_b32 v68, 0xffff0000, v52
    v_lshlrev_b32 v52, 16, v52
    v_and_b32 v69, 0xffff0000, v53
    v_lshlrev_b32 v53, 16, v53
    v_and_b32 v70, 0xffff0000, v54
    v_lshlrev_b32 v54, 16, v54
    v_and_b32 v71, 0xffff0000, v55
    v_lshlrev_b32 v55, 16, v55
    v_and_b32 v72, 0xffff0000, v56
    v_lshlrev_b32 v56, 16, v56
    v_and_b32 v73, 0xffff0000, v57
    v_lshlrev_b32 v57, 16, v57
    v_and_b32 v74, 0xffff0000, v58
    v_lshlrev_b32 v58, 16, v58
    v_and_b32 v75, 0xffff0000, v59
    v_lshlrev_b32 v59, 16, v59
    v_and_b32 v76, 0xffff0000, v60
    v_lshlrev_b32 v60, 16, v60
    v_and_b32 v77, 0xffff0000, v61
    v_lshlrev_b32 v61, 16, v61
    v_and_b32 v78, 0xffff0000, v62
    v_lshlrev_b32 v62, 16, v62
    v_and_b32 v79, 0xffff0000, v63
    v_lshlrev_b32 v63, 16, v63
    v_fma_f32 v128, v64, s44, v128
    v_fma_f32 v144, v48, s44, v144
    v_fma_f32 v129, v65, s44, v129
    v_fma_f32 v145, v49, s44, v145
    v_fma_f32 v130, v66, s44, v130
    v_fma_f32 v146, v50, s44, v146
    v_fma_f32 v131, v67, s44, v131
    v_fma_f32 v147, v51, s44, v147
    v_fma_f32 v132, v68, s44, v132
    v_fma_f32 v148, v52, s44, v148
    v_fma_f32 v133, v69, s44, v133
    v_fma_f32 v149, v53, s44, v149
    v_fma_f32 v134, v70, s44, v134
    v_fma_f32 v150, v54, s44, v150
    v_fma_f32 v135, v71, s44, v135
    v_fma_f32 v151, v55, s44, v151
    v_fma_f32 v136, v72, s44, v136
    v_fma_f32 v152, v56, s44, v152
    v_fma_f32 v137, v73, s44, v137
    v_fma_f32 v153, v57, s44, v153
    v_fma_f32 v138, v74, s44, v138
    v_fma_f32 v154, v58, s44, v154
    v_fma_f32 v139, v75, s44, v139
    v_fma_f32 v155, v59, s44, v155
    v_fma_f32 v140, v76, s44, v140
    v_fma_f32 v156, v60, s44, v156
    v_fma_f32 v141, v77, s44, v141
    v_fma_f32 v157, v61, s44, v157
    v_fma_f32 v142, v78, s44, v142
    v_fma_f32 v158, v62, s44, v158
    v_fma_f32 v143, v79, s44, v143
    v_fma_f32 v159, v63, s44, v159
    v_cvt_pk_bf16_f32 v32, v128, v144
    v_cvt_pk_bf16_f32 v33, v129, v145
    v_cvt_pk_bf16_f32 v34, v130, v146
    v_cvt_pk_bf16_f32 v35, v131, v147
    v_cvt_pk_bf16_f32 v36, v132, v148
    v_cvt_pk_bf16_f32 v37, v133, v149
    v_cvt_pk_bf16_f32 v38, v134, v150
    v_cvt_pk_bf16_f32 v39, v135, v151
    v_cvt_pk_bf16_f32 v40, v136, v152
    v_cvt_pk_bf16_f32 v41, v137, v153
    v_cvt_pk_bf16_f32 v42, v138, v154
    v_cvt_pk_bf16_f32 v43, v139, v155
    v_cvt_pk_bf16_f32 v44, v140, v156
    v_cvt_pk_bf16_f32 v45, v141, v157
    v_cvt_pk_bf16_f32 v46, v142, v158
    v_cvt_pk_bf16_f32 v47, v143, v159
    ds_write_b32 v18, v32 offset:0
    ds_write_b32 v18, v33 offset:8
    ds_write_b32 v18, v34 offset:16
    ds_write_b32 v18, v35 offset:24
    ds_write_b32 v18, v36 offset:64
    ds_write_b32 v18, v37 offset:72
    ds_write_b32 v18, v38 offset:80
    ds_write_b32 v18, v39 offset:88
    ds_write_b32 v18, v40 offset:128
    ds_write_b32 v18, v41 offset:136
    ds_write_b32 v18, v42 offset:144
    ds_write_b32 v18, v43 offset:152
    ds_write_b32 v18, v44 offset:192
    ds_write_b32 v18, v45 offset:200
    ds_write_b32 v18, v46 offset:208
    ds_write_b32 v18, v47 offset:216
    v_mul_u32_u24 v17, 264, v2
    v_lshl_add_u32 v17, v1, 2, v17
    s_waitcnt lgkmcnt(0)
    s_barrier
    ds_read_b32 v48, v17 offset:0
    ds_read_b32 v49, v17 offset:9472
    ds_read_b32 v50, v17 offset:18944
    ds_read_b32 v51, v17 offset:28416
    ds_read_b32 v52, v17 offset:1056
    ds_read_b32 v53, v17 offset:10528
    ds_read_b32 v54, v17 offset:20000
    ds_read_b32 v55, v17 offset:29472
    ds_read_b32 v56, v17 offset:2112
    ds_read_b32 v57, v17 offset:11584
    ds_read_b32 v58, v17 offset:21056
    ds_read_b32 v59, v17 offset:30528
    ds_read_b32 v60, v17 offset:3168
    ds_read_b32 v61, v17 offset:12640
    ds_read_b32 v62, v17 offset:22112
    ds_read_b32 v63, v17 offset:31584
    s_waitcnt lgkmcnt(0)
    v_perm_b32 v96, v49, v48, s48
    v_perm_b32 v98, v49, v48, s49
    v_perm_b32 v97, v51, v50, s48
    v_perm_b32 v99, v51, v50, s49
    v_perm_b32 v100, v53, v52, s48
    v_perm_b32 v102, v53, v52, s49
    v_perm_b32 v101, v55, v54, s48
    v_perm_b32 v103, v55, v54, s49
    v_perm_b32 v104, v57, v56, s48
    v_perm_b32 v106, v57, v56, s49
    v_perm_b32 v105, v59, v58, s48
    v_perm_b32 v107, v59, v58, s49
    v_perm_b32 v108, v61, v60, s48
    v_perm_b32 v110, v61, v60, s49
    v_perm_b32 v109, v63, v62, s48
    v_perm_b32 v111, v63, v62, s49
    v_lshrrev_b32 v20, 3, v0
    v_lshrrev_b32 v21, 4, v20
    v_and_b32 v22, 15, v20
    v_mul_u32_u24 v23, 20480, v20
    v_sub_u32 v23, v4, v23
    s_mov_b32 s40, 1601536
    v_mul_lo_u32 v24, v21, s40
    v_add_u32 v24, v24, v23
    v_add_u32 v25, 1, v22
    v_mul_u32_u24 v25, 20480, v25
    v_add_u32 v25, v25, v24
    v_cmp_eq_u32 s[42:43], 15, v22
    v_cmp_eq_u32 s[44:45], 0, v22
    v_add_u32 v26, 3203072, v24
    v_add_u32 v27, 348160, v24
    v_cndmask_b32 v26, v27, v26, s[42:43]
    v_cmp_ne_u32 vcc, 0, v20
    s_and_b64 s[46:47], s[44:45], vcc
    s_or_b64 s[46:47], s[46:47], s[42:43]
    v_cmp_ne_u32 vcc, 31, v20
    s_and_b64 s[52:53], s[42:43], vcc
    s_or_b64 s[52:53], s[52:53], s[44:45]
    s_or_b64 s[44:45], s[44:45], s[42:43]
    s_add_u32 s39, s38, 9060352
    buffer_store_dwordx4 v[96:99], v25, s[28:31], s39 offen sc1
    s_mov_b64 exec, s[46:47]
    s_cbranch_execz k1_kernel_halo9
    s_sub_u32 s41, s39, 1601536
    buffer_store_dwordx4 v[96:99], v26, s[28:31], s41 offen sc1
k1_kernel_halo9:
    s_mov_b64 exec, -1
    s_add_u32 s39, s39, 3203072
    buffer_store_dwordx4 v[100:103], v25, s[28:31], s39 offen sc1
    s_mov_b64 exec, s[44:45]
    s_cbranch_execz k1_kernel_halo10
    s_sub_u32 s41, s39, 1601536
    buffer_store_dwordx4 v[100:103], v26, s[28:31], s41 offen sc1
k1_kernel_halo10:
    s_mov_b64 exec, -1
    s_add_u32 s39, s39, 3203072
    buffer_store_dwordx4 v[104:107], v25, s[28:31], s39 offen sc1
    s_mov_b64 exec, s[44:45]
    s_cbranch_execz k1_kernel_halo11
    s_sub_u32 s41, s39, 1601536
    buffer_store_dwordx4 v[104:107], v26, s[28:31], s41 offen sc1
k1_kernel_halo11:
    s_mov_b64 exec, -1
    s_add_u32 s39, s39, 3203072
    buffer_store_dwordx4 v[108:111], v25, s[28:31], s39 offen sc1
    s_mov_b64 exec, s[52:53]
    s_cbranch_execz k1_kernel_halo12
    s_sub_u32 s41, s39, 1601536
    buffer_store_dwordx4 v[108:111], v26, s[28:31], s41 offen sc1
k1_kernel_halo12:
    s_mov_b64 exec, -1
    s_add_u32 s39, s39, 3203072
    s_waitcnt vmcnt(0)
    s_endpgm
k1_side:
    s_cmp_ge_u32 s54, 188
    s_cbranch_scc1 k1_end
    s_cmp_lt_u32 s54, 128
    s_cbranch_scc1 k1_kernel_sw14_x
    s_cmp_lg_u32 s20, 0
    s_cbranch_scc1 k1_kernel_sw14
    s_and_b32 s55, s2, 7
    s_lshl_b32 s57, s55, 9
    s_add_u32 s57, s57, 9056256
    v_mov_b32 v250, 0
    v_and_b32 v5, 31, v1
    v_lshlrev_b32 v5, 2, v5
    s_waitcnt lgkmcnt(0)
    s_mov_b32 s28, s10
    s_mov_b32 s29, s11
    s_mov_b32 s30, 268435456
    s_mov_b32 s31, 0x00020000
    buffer_load_dword v251, v250, s[28:31], s57 offen sc1
    s_mov_b32 s23, 12
    s_waitcnt vmcnt(0)
    v_add_u32 v251, 1, v251
k1_kernel_sw13:
    buffer_load_dword v6, v5, s[28:31], s57 offen offset:256 sc1
    s_waitcnt vmcnt(0)
    v_cmp_eq_u32 vcc, v251, v6
    s_sub_u32 s23, s23, 1
    s_cmp_eq_u64 vcc, -1
    s_cbranch_scc1 k1_kernel_sw14
    s_sleep 64
    s_cmp_lg_u32 s23, 0
    s_cbranch_scc1 k1_kernel_sw13
k1_kernel_sw14:
    s_barrier
k1_kernel_sw14_x:
    s_cmp_lt_u32 s54, 128
    s_cbranch_scc1 k1_pf
    s_branch k1_mod0
k1_side2:
    s_load_dwordx2 s[10:11], s[0:1], 120
    s_load_dwordx8 s[12:19], s[0:1], 56
    v_lshrrev_b32 v2, 6, v0
    v_and_b32 v1, 63, v0
    v_readfirstlane_b32 s20, v2
    s_waitcnt lgkmcnt(0)
    s_mov_b32 s28, s10
    s_mov_b32 s29, s11
    s_mov_b32 s30, 268435456
    s_mov_b32 s31, 0x00020000
    s_sub_u32 s21, s54, 0
    v_lshrrev_b32 v3, 3, v0
    v_and_b32 v4, 7, v0
    v_mul_u32_u24 v5, 144, v3
    v_lshl_add_u32 v5, v4, 4, v5
    v_and_b32 v6, 15, v1
    v_lshrrev_b32 v7, 4, v1
    v_lshrrev_b32 v8, 2, v6
    v_lshl_add_u32 v8, v7, 3, v8
    v_mul_u32_u24 v8, 144, v8
    v_and_b32 v9, 3, v6
    v_lshl_add_u32 v8, v9, 3, v8
    s_lshl_b32 s22, s20, 5
    v_add_u32 v8, s22, v8
    v_lshlrev_b32 v9, 4, v1
    s_cmp_lt_u32 s21, 10
    s_cbranch_scc1 k1_kernel_pk15
    s_cmp_lt_u32 s21, 20
    s_cbranch_scc1 k1_kernel_pk16
    s_cmp_lt_u32 s21, 48
    s_cbranch_scc1 k1_kernel_pk17
    s_cmp_lt_u32 s21, 78
    s_cbranch_scc1 k1_kernel_pk18
    s_branch k1_kernel_pke19
k1_kernel_pk15:
    s_mov_b32 s24, s12
    s_mov_b32 s25, s13
    s_mov_b32 s26, 819200
    s_mov_b32 s27, 0x00020000
    s_sub_u32 s32, s21, 0
    s_mul_i32 s33, s32, 52429
    s_lshr_b32 s33, s33, 18
    s_mul_i32 s34, s33, 5
    s_sub_u32 s34, s32, s34
    s_lshl_b32 s34, s34, 1
    v_mul_u32_u24 v10, 1280, v3
    v_lshl_add_u32 v10, v4, 4, v10
    s_mul_i32 s35, s33, 409600
    s_lshl_b32 s36, s34, 7
    s_add_u32 s35, s35, s36
    buffer_load_dwordx4 v[32:35], v10, s[24:27], s35 offen offset:0
    s_add_u32 s35, s35, 40960
    buffer_load_dwordx4 v[36:39], v10, s[24:27], s35 offen offset:0
    s_add_u32 s35, s35, 40960
    buffer_load_dwordx4 v[40:43], v10, s[24:27], s35 offen offset:0
    s_add_u32 s35, s35, 40960
    buffer_load_dwordx4 v[44:47], v10, s[24:27], s35 offen offset:0
    s_add_u32 s35, s35, 40960
    buffer_load_dwordx4 v[48:51], v10, s[24:27], s35 offen offset:0
    s_add_u32 s35, s35, 40960
    buffer_load_dwordx4 v[52:55], v10, s[24:27], s35 offen offset:0
    s_add_u32 s35, s35, 40960
    buffer_load_dwordx4 v[56:59], v10, s[24:27], s35 offen offset:0
    s_add_u32 s35, s35, 40960
    buffer_load_dwordx4 v[60:63], v10, s[24:27], s35 offen offset:0
    s_add_u32 s35, s35, 40960
    buffer_load_dwordx4 v[64:67], v10, s[24:27], s35 offen offset:0
    s_add_u32 s35, s35, 40960
    buffer_load_dwordx4 v[68:71], v10, s[24:27], s35 offen offset:0
    s_sub_u32 s35, s35, 368640
    buffer_load_dwordx4 v[72:75], v10, s[24:27], s35 offen offset:128
    s_add_u32 s35, s35, 40960
    buffer_load_dwordx4 v[76:79], v10, s[24:27], s35 offen offset:128
    s_add_u32 s35, s35, 40960
    buffer_load_dwordx4 v[80:83], v10, s[24:27], s35 offen offset:128
    s_add_u32 s35, s35, 40960
    buffer_load_dwordx4 v[84:87], v10, s[24:27], s35 offen offset:128
    s_add_u32 s35, s35, 40960
    buffer_load_dwordx4 v[88:91], v10, s[24:27], s35 offen offset:128
    s_add_u32 s35, s35, 40960
    buffer_load_dwordx4 v[92:95], v10, s[24:27], s35 offen offset:128
    s_add_u32 s35, s35, 40960
    buffer_load_dwordx4 v[96:99], v10, s[24:27], s35 offen offset:128
    s_add_u32 s35, s35, 40960
    buffer_load_dwordx4 v[100:103], v10, s[24:27], s35 offen offset:128
    s_add_u32 s35, s35, 40960
    buffer_load_dwordx4 v[104:107], v10, s[24:27], s35 offen offset:128
    s_add_u32 s35, s35, 40960
    buffer_load_dwordx4 v[108:111], v10, s[24:27], s35 offen offset:128
    s_lshl_b32 s36, s34, 2
    s_add_u32 s36, s36, s20
    s_mul_i32 s38, s36, 52429
    s_lshr_b32 s38, s38, 18
    s_mul_i32 s39, s38, 5
    s_sub_u32 s39, s36, s39
    s_mul_i32 s37, s38, 100
    s_mul_i32 s40, s33, 50
    s_add_u32 s37, s37, s40
    s_add_u32 s37, s37, s39
    s_lshl_b32 s37, s37, 10
    s_add_u32 s37, s37, 2764800
    s_waitcnt vmcnt(19)
    ds_write_b128 v5, v[32:35] offset:0
    s_waitcnt vmcnt(18)
    ds_write_b128 v5, v[36:39] offset:4608
    s_waitcnt vmcnt(17)
    ds_write_b128 v5, v[40:43] offset:9216
    s_waitcnt vmcnt(16)
    ds_write_b128 v5, v[44:47] offset:13824
    s_waitcnt vmcnt(15)
    ds_write_b128 v5, v[48:51] offset:18432
    s_waitcnt vmcnt(14)
    ds_write_b128 v5, v[52:55] offset:23040
    s_waitcnt vmcnt(13)
    ds_write_b128 v5, v[56:59] offset:27648
    s_waitcnt vmcnt(12)
    ds_write_b128 v5, v[60:63] offset:32256
    s_waitcnt vmcnt(11)
    ds_write_b128 v5, v[64:67] offset:36864
    s_waitcnt vmcnt(10)
    ds_write_b128 v5, v[68:71] offset:41472
    s_waitcnt lgkmcnt(0)
    s_barrier
    ds_read_b64_tr_b16 v[32:33], v8 offset:0
    ds_read_b64_tr_b16 v[34:35], v8 offset:576
    ds_read_b64_tr_b16 v[36:37], v8 offset:4608
    ds_read_b64_tr_b16 v[38:39], v8 offset:5184
    ds_read_b64_tr_b16 v[40:41], v8 offset:9216
    ds_read_b64_tr_b16 v[42:43], v8 offset:9792
    ds_read_b64_tr_b16 v[44:45], v8 offset:13824
    ds_read_b64_tr_b16 v[46:47], v8 offset:14400
    ds_read_b64_tr_b16 v[48:49], v8 offset:18432
    ds_read_b64_tr_b16 v[50:51], v8 offset:19008
    ds_read_b64_tr_b16 v[52:53], v8 offset:23040
    ds_read_b64_tr_b16 v[54:55], v8 offset:23616
    ds_read_b64_tr_b16 v[56:57], v8 offset:27648
    ds_read_b64_tr_b16 v[58:59], v8 offset:28224
    ds_read_b64_tr_b16 v[60:61], v8 offset:32256
    ds_read_b64_tr_b16 v[62:63], v8 offset:32832
    ds_read_b64_tr_b16 v[64:65], v8 offset:36864
    ds_read_b64_tr_b16 v[66:67], v8 offset:37440
    ds_read_b64_tr_b16 v[68:69], v8 offset:41472
    ds_read_b64_tr_b16 v[70:71], v8 offset:42048
    v_mov_b32 v12, 0
    v_mov_b32 v13, 0x3f803f80
    s_waitcnt lgkmcnt(15)
    s_add_u32 s38, s37, 0
    buffer_store_dwordx4 v[32:35], v9, s[28:31], s38 offen sc1
    v_dot2_f32_bf16 v12, v32, v13, v12
    v_dot2_f32_bf16 v12, v33, v13, v12
    v_dot2_f32_bf16 v12, v34, v13, v12
    v_dot2_f32_bf16 v12, v35, v13, v12
    s_waitcnt lgkmcnt(15)
    s_add_u32 s38, s37, 5120
    buffer_store_dwordx4 v[36:39], v9, s[28:31], s38 offen sc1
    v_dot2_f32_bf16 v12, v36, v13, v12
    v_dot2_f32_bf16 v12, v37, v13, v12
    v_dot2_f32_bf16 v12, v38, v13, v12
    v_dot2_f32_bf16 v12, v39, v13, v12
    s_waitcnt lgkmcnt(14)
    s_add_u32 s38, s37, 10240
    buffer_store_dwordx4 v[40:43], v9, s[28:31], s38 offen sc1
    v_dot2_f32_bf16 v12, v40, v13, v12
    v_dot2_f32_bf16 v12, v41, v13, v12
    v_dot2_f32_bf16 v12, v42, v13, v12
    v_dot2_f32_bf16 v12, v43, v13, v12
    s_waitcnt lgkmcnt(12)
    s_add_u32 s38, s37, 15360
    buffer_store_dwordx4 v[44:47], v9, s[28:31], s38 offen sc1
    v_dot2_f32_bf16 v12, v44, v13, v12
    v_dot2_f32_bf16 v12, v45, v13, v12
    v_dot2_f32_bf16 v12, v46, v13, v12
    v_dot2_f32_bf16 v12, v47, v13, v12
    s_waitcnt lgkmcnt(10)
    s_add_u32 s38, s37, 20480
    buffer_store_dwordx4 v[48:51], v9, s[28:31], s38 offen sc1
    v_dot2_f32_bf16 v12, v48, v13, v12
    v_dot2_f32_bf16 v12, v49, v13, v12
    v_dot2_f32_bf16 v12, v50, v13, v12
    v_dot2_f32_bf16 v12, v51, v13, v12
    s_waitcnt lgkmcnt(8)
    s_add_u32 s38, s37, 25600
    buffer_store_dwordx4 v[52:55], v9, s[28:31], s38 offen sc1
    v_dot2_f32_bf16 v12, v52, v13, v12
    v_dot2_f32_bf16 v12, v53, v13, v12
    v_dot2_f32_bf16 v12, v54, v13, v12
    v_dot2_f32_bf16 v12, v55, v13, v12
    s_waitcnt lgkmcnt(6)
    s_add_u32 s38, s37, 30720
    buffer_store_dwordx4 v[56:59], v9, s[28:31], s38 offen sc1
    v_dot2_f32_bf16 v12, v56, v13, v12
    v_dot2_f32_bf16 v12, v57, v13, v12
    v_dot2_f32_bf16 v12, v58, v13, v12
    v_dot2_f32_bf16 v12, v59, v13, v12
    s_waitcnt lgkmcnt(4)
    s_add_u32 s38, s37, 35840
    buffer_store_dwordx4 v[60:63], v9, s[28:31], s38 offen sc1
    v_dot2_f32_bf16 v12, v60, v13, v12
    v_dot2_f32_bf16 v12, v61, v13, v12
    v_dot2_f32_bf16 v12, v62, v13, v12
    v_dot2_f32_bf16 v12, v63, v13, v12
    s_waitcnt lgkmcnt(2)
    s_add_u32 s38, s37, 40960
    buffer_store_dwordx4 v[64:67], v9, s[28:31], s38 offen sc1
    v_dot2_f32_bf16 v12, v64, v13, v12
    v_dot2_f32_bf16 v12, v65, v13, v12
    v_dot2_f32_bf16 v12, v66, v13, v12
    v_dot2_f32_bf16 v12, v67, v13, v12
    s_waitcnt lgkmcnt(0)
    s_add_u32 s38, s37, 46080
    buffer_store_dwordx4 v[68:71], v9, s[28:31], s38 offen sc1
    v_dot2_f32_bf16 v12, v68, v13, v12
    v_dot2_f32_bf16 v12, v69, v13, v12
    v_dot2_f32_bf16 v12, v70, v13, v12
    v_dot2_f32_bf16 v12, v71, v13, v12
    s_nop 2
    v_mov_b32 v13, v12
    s_nop 1
    v_permlane32_swap_b32 v13, v12
    v_add_f32 v12, v12, v13
    v_mov_b32 v13, v12
    s_nop 1
    v_permlane16_swap_b32 v13, v12
    v_add_f32 v12, v12, v13
    s_mul_i32 s38, s33, 7168
    s_lshl_b32 s39, s36, 6
    s_add_u32 s38, s38, s39
    s_add_u32 s38, s38, 2748416
    v_lshlrev_b32 v14, 2, v1
    v_cmp_gt_u32 vcc, 16, v1
    s_and_saveexec_b64 s[40:41], vcc
    buffer_store_dword v12, v14, s[28:31], s38 offen sc1
    s_mov_b64 exec, -1
    s_add_u32 s34, s34, 1
    s_barrier
    s_lshl_b32 s36, s34, 2
    s_add_u32 s36, s36, s20
    s_mul_i32 s38, s36, 52429
    s_lshr_b32 s38, s38, 18
    s_mul_i32 s39, s38, 5
    s_sub_u32 s39, s36, s39
    s_mul_i32 s37, s38, 100
    s_mul_i32 s40, s33, 50
    s_add_u32 s37, s37, s40
    s_add_u32 s37, s37, s39
    s_lshl_b32 s37, s37, 10
    s_add_u32 s37, s37, 2764800
    s_waitcnt vmcnt(20)
    ds_write_b128 v5, v[72:75] offset:0
    s_waitcnt vmcnt(19)
    ds_write_b128 v5, v[76:79] offset:4608
    s_waitcnt vmcnt(18)
    ds_write_b128 v5, v[80:83] offset:9216
    s_waitcnt vmcnt(17)
    ds_write_b128 v5, v[84:87] offset:13824
    s_waitcnt vmcnt(16)
    ds_write_b128 v5, v[88:91] offset:18432
    s_waitcnt vmcnt(15)
    ds_write_b128 v5, v[92:95] offset:23040
    s_waitcnt vmcnt(14)
    ds_write_b128 v5, v[96:99] offset:27648
    s_waitcnt vmcnt(13)
    ds_write_b128 v5, v[100:103] offset:32256
    s_waitcnt vmcnt(12)
    ds_write_b128 v5, v[104:107] offset:36864
    s_waitcnt vmcnt(11)
    ds_write_b128 v5, v[108:111] offset:41472
    s_waitcnt lgkmcnt(0)
    s_barrier
    ds_read_b64_tr_b16 v[72:73], v8 offset:0
    ds_read_b64_tr_b16 v[74:75], v8 offset:576
    ds_read_b64_tr_b16 v[76:77], v8 offset:4608
    ds_read_b64_tr_b16 v[78:79], v8 offset:5184
    ds_read_b64_tr_b16 v[80:81], v8 offset:9216
    ds_read_b64_tr_b16 v[82:83], v8 offset:9792
    ds_read_b64_tr_b16 v[84:85], v8 offset:13824
    ds_read_b64_tr_b16 v[86:87], v8 offset:14400
    ds_read_b64_tr_b16 v[88:89], v8 offset:18432
    ds_read_b64_tr_b16 v[90:91], v8 offset:19008
    ds_read_b64_tr_b16 v[92:93], v8 offset:23040
    ds_read_b64_tr_b16 v[94:95], v8 offset:23616
    ds_read_b64_tr_b16 v[96:97], v8 offset:27648
    ds_read_b64_tr_b16 v[98:99], v8 offset:28224
    ds_read_b64_tr_b16 v[100:101], v8 offset:32256
    ds_read_b64_tr_b16 v[102:103], v8 offset:32832
    ds_read_b64_tr_b16 v[104:105], v8 offset:36864
    ds_read_b64_tr_b16 v[106:107], v8 offset:37440
    ds_read_b64_tr_b16 v[108:109], v8 offset:41472
    ds_read_b64_tr_b16 v[110:111], v8 offset:42048
    v_mov_b32 v12, 0
    v_mov_b32 v13, 0x3f803f80
    s_waitcnt lgkmcnt(15)
    s_add_u32 s38, s37, 0
    buffer_store_dwordx4 v[72:75], v9, s[28:31], s38 offen sc1
    v_dot2_f32_bf16 v12, v72, v13, v12
    v_dot2_f32_bf16 v12, v73, v13, v12
    v_dot2_f32_bf16 v12, v74, v13, v12
    v_dot2_f32_bf16 v12, v75, v13, v12
    s_waitcnt lgkmcnt(15)
    s_add_u32 s38, s37, 5120
    buffer_store_dwordx4 v[76:79], v9, s[28:31], s38 offen sc1
    v_dot2_f32_bf16 v12, v76, v13, v12
    v_dot2_f32_bf16 v12, v77, v13, v12
    v_dot2_f32_bf16 v12, v78, v13, v12
    v_dot2_f32_bf16 v12, v79, v13, v12
    s_waitcnt lgkmcnt(14)
    s_add_u32 s38, s37, 10240
    buffer_store_dwordx4 v[80:83], v9, s[28:31], s38 offen sc1
    v_dot2_f32_bf16 v12, v80, v13, v12
    v_dot2_f32_bf16 v12, v81, v13, v12
    v_dot2_f32_bf16 v12, v82, v13, v12
    v_dot2_f32_bf16 v12, v83, v13, v12
    s_waitcnt lgkmcnt(12)
    s_add_u32 s38, s37, 15360
    buffer_store_dwordx4 v[84:87], v9, s[28:31], s38 offen sc1
    v_dot2_f32_bf16 v12, v84, v13, v12
    v_dot2_f32_bf16 v12, v85, v13, v12
    v_dot2_f32_bf16 v12, v86, v13, v12
    v_dot2_f32_bf16 v12, v87, v13, v12
    s_waitcnt lgkmcnt(10)
    s_add_u32 s38, s37, 20480
    buffer_store_dwordx4 v[88:91], v9, s[28:31], s38 offen sc1
    v_dot2_f32_bf16 v12, v88, v13, v12
    v_dot2_f32_bf16 v12, v89, v13, v12
    v_dot2_f32_bf16 v12, v90, v13, v12
    v_dot2_f32_bf16 v12, v91, v13, v12
    s_waitcnt lgkmcnt(8)
    s_add_u32 s38, s37, 25600
    buffer_store_dwordx4 v[92:95], v9, s[28:31], s38 offen sc1
    v_dot2_f32_bf16 v12, v92, v13, v12
    v_dot2_f32_bf16 v12, v93, v13, v12
    v_dot2_f32_bf16 v12, v94, v13, v12
    v_dot2_f32_bf16 v12, v95, v13, v12
    s_waitcnt lgkmcnt(6)
    s_add_u32 s38, s37, 30720
    buffer_store_dwordx4 v[96:99], v9, s[28:31], s38 offen sc1
    v_dot2_f32_bf16 v12, v96, v13, v12
    v_dot2_f32_bf16 v12, v97, v13, v12
    v_dot2_f32_bf16 v12, v98, v13, v12
    v_dot2_f32_bf16 v12, v99, v13, v12
    s_waitcnt lgkmcnt(4)
    s_add_u32 s38, s37, 35840
    buffer_store_dwordx4 v[100:103], v9, s[28:31], s38 offen sc1
    v_dot2_f32_bf16 v12, v100, v13, v12
    v_dot2_f32_bf16 v12, v101, v13, v12
    v_dot2_f32_bf16 v12, v102, v13, v12
    v_dot2_f32_bf16 v12, v103, v13, v12
    s_waitcnt lgkmcnt(2)
    s_add_u32 s38, s37, 40960
    buffer_store_dwordx4 v[104:107], v9, s[28:31], s38 offen sc1
    v_dot2_f32_bf16 v12, v104, v13, v12
    v_dot2_f32_bf16 v12, v105, v13, v12
    v_dot2_f32_bf16 v12, v106, v13, v12
    v_dot2_f32_bf16 v12, v107, v13, v12
    s_waitcnt lgkmcnt(0)
    s_add_u32 s38, s37, 46080
    buffer_store_dwordx4 v[108:111], v9, s[28:31], s38 offen sc1
    v_dot2_f32_bf16 v12, v108, v13, v12
    v_dot2_f32_bf16 v12, v109, v13, v12
    v_dot2_f32_bf16 v12, v110, v13, v12
    v_dot2_f32_bf16 v12, v111, v13, v12
    s_nop 2
    v_mov_b32 v13, v12
    s_nop 1
    v_permlane32_swap_b32 v13, v12
    v_add_f32 v12, v12, v13
    v_mov_b32 v13, v12
    s_nop 1
    v_permlane16_swap_b32 v13, v12
    v_add_f32 v12, v12, v13
    s_mul_i32 s38, s33, 7168
    s_lshl_b32 s39, s36, 6
    s_add_u32 s38, s38, s39
    s_add_u32 s38, s38, 2748416
    v_lshlrev_b32 v14, 2, v1
    v_cmp_gt_u32 vcc, 16, v1
    s_and_saveexec_b64 s[40:41], vcc
    buffer_store_dword v12, v14, s[28:31], s38 offen sc1
    s_mov_b64 exec, -1
    s_endpgm
k1_kernel_pk16:
    s_mov_b32 s24, s14
    s_mov_b32 s25, s15
    s_mov_b32 s26, 819200
    s_mov_b32 s27, 0x00020000
    s_sub_u32 s32, s21, 10
    s_mul_i32 s33, s32, 52429
    s_lshr_b32 s33, s33, 18
    s_mul_i32 s34, s33, 5
    s_sub_u32 s34, s32, s34
    s_lshl_b32 s34, s34, 1
    v_mul_u32_u24 v10, 1280, v3
    v_lshl_add_u32 v10, v4, 4, v10
    s_mul_i32 s35, s33, 409600
    s_lshl_b32 s36, s34, 7
    s_add_u32 s35, s35, s36
    buffer_load_dwordx4 v[32:35], v10, s[24:27], s35 offen offset:0
    s_add_u32 s35, s35, 40960
    buffer_load_dwordx4 v[36:39], v10, s[24:27], s35 offen offset:0
    s_add_u32 s35, s35, 40960
    buffer_load_dwordx4 v[40:43], v10, s[24:27], s35 offen offset:0
    s_add_u32 s35, s35, 40960
    buffer_load_dwordx4 v[44:47], v10, s[24:27], s35 offen offset:0
    s_add_u32 s35, s35, 40960
    buffer_load_dwordx4 v[48:51], v10, s[24:27], s35 offen offset:0
    s_add_u32 s35, s35, 40960
    buffer_load_dwordx4 v[52:55], v10, s[24:27], s35 offen offset:0
    s_add_u32 s35, s35, 40960
    buffer_load_dwordx4 v[56:59], v10, s[24:27], s35 offen offset:0
    s_add_u32 s35, s35, 40960
    buffer_load_dwordx4 v[60:63], v10, s[24:27], s35 offen offset:0
    s_add_u32 s35, s35, 40960
    buffer_load_dwordx4 v[64:67], v10, s[24:27], s35 offen offset:0
    s_add_u32 s35, s35, 40960
    buffer_load_dwordx4 v[68:71], v10, s[24:27], s35 offen offset:0
    s_sub_u32 s35, s35, 368640
    buffer_load_dwordx4 v[72:75], v10, s[24:27], s35 offen offset:128
    s_add_u32 s35, s35, 40960
    buffer_load_dwordx4 v[76:79], v10, s[24:27], s35 offen offset:128
    s_add_u32 s35, s35, 40960
    buffer_load_dwordx4 v[80:83], v10, s[24:27], s35 offen offset:128
    s_add_u32 s35, s35, 40960
    buffer_load_dwordx4 v[84:87], v10, s[24:27], s35 offen offset:128
    s_add_u32 s35, s35, 40960
    buffer_load_dwordx4 v[88:91], v10, s[24:27], s35 offen offset:128
    s_add_u32 s35, s35, 40960
    buffer_load_dwordx4 v[92:95], v10, s[24:27], s35 offen offset:128
    s_add_u32 s35, s35, 40960
    buffer_load_dwordx4 v[96:99], v10, s[24:27], s35 offen offset:128
    s_add_u32 s35, s35, 40960
    buffer_load_dwordx4 v[100:103], v10, s[24:27], s35 offen offset:128
    s_add_u32 s35, s35, 40960
    buffer_load_dwordx4 v[104:107], v10, s[24:27], s35 offen offset:128
    s_add_u32 s35, s35, 40960
    buffer_load_dwordx4 v[108:111], v10, s[24:27], s35 offen offset:128
    s_lshl_b32 s36, s34, 2
    s_add_u32 s36, s36, s20
    s_mul_i32 s38, s36, 52429
    s_lshr_b32 s38, s38, 18
    s_mul_i32 s39, s38, 5
    s_sub_u32 s39, s36, s39
    s_mul_i32 s37, s38, 100
    s_mul_i32 s40, s33, 50
    s_add_u32 s37, s37, s40
    s_add_u32 s37, s37, s39
    s_lshl_b32 s37, s37, 10
    s_add_u32 s37, s37, 3584000
    s_waitcnt vmcnt(19)
    ds_write_b128 v5, v[32:35] offset:0
    s_waitcnt vmcnt(18)
    ds_write_b128 v5, v[36:39] offset:4608
    s_waitcnt vmcnt(17)
    ds_write_b128 v5, v[40:43] offset:9216
    s_waitcnt vmcnt(16)
    ds_write_b128 v5, v[44:47] offset:13824
    s_waitcnt vmcnt(15)
    ds_write_b128 v5, v[48:51] offset:18432
    s_waitcnt vmcnt(14)
    ds_write_b128 v5, v[52:55] offset:23040
    s_waitcnt vmcnt(13)
    ds_write_b128 v5, v[56:59] offset:27648
    s_waitcnt vmcnt(12)
    ds_write_b128 v5, v[60:63] offset:32256
    s_waitcnt vmcnt(11)
    ds_write_b128 v5, v[64:67] offset:36864
    s_waitcnt vmcnt(10)
    ds_write_b128 v5, v[68:71] offset:41472
    s_waitcnt lgkmcnt(0)
    s_barrier
    ds_read_b64_tr_b16 v[32:33], v8 offset:0
    ds_read_b64_tr_b16 v[34:35], v8 offset:576
    ds_read_b64_tr_b16 v[36:37], v8 offset:4608
    ds_read_b64_tr_b16 v[38:39], v8 offset:5184
    ds_read_b64_tr_b16 v[40:41], v8 offset:9216
    ds_read_b64_tr_b16 v[42:43], v8 offset:9792
    ds_read_b64_tr_b16 v[44:45], v8 offset:13824
    ds_read_b64_tr_b16 v[46:47], v8 offset:14400
    ds_read_b64_tr_b16 v[48:49], v8 offset:18432
    ds_read_b64_tr_b16 v[50:51], v8 offset:19008
    ds_read_b64_tr_b16 v[52:53], v8 offset:23040
    ds_read_b64_tr_b16 v[54:55], v8 offset:23616
    ds_read_b64_tr_b16 v[56:57], v8 offset:27648
    ds_read_b64_tr_b16 v[58:59], v8 offset:28224
    ds_read_b64_tr_b16 v[60:61], v8 offset:32256
    ds_read_b64_tr_b16 v[62:63], v8 offset:32832
    ds_read_b64_tr_b16 v[64:65], v8 offset:36864
    ds_read_b64_tr_b16 v[66:67], v8 offset:37440
    ds_read_b64_tr_b16 v[68:69], v8 offset:41472
    ds_read_b64_tr_b16 v[70:71], v8 offset:42048
    s_waitcnt lgkmcnt(15)
    s_add_u32 s38, s37, 0
    buffer_store_dwordx4 v[32:35], v9, s[28:31], s38 offen sc1
    s_waitcnt lgkmcnt(15)
    s_add_u32 s38, s37, 5120
    buffer_store_dwordx4 v[36:39], v9, s[28:31], s38 offen sc1
    s_waitcnt lgkmcnt(14)
    s_add_u32 s38, s37, 10240
    buffer_store_dwordx4 v[40:43], v9, s[28:31], s38 offen sc1
    s_waitcnt lgkmcnt(12)
    s_add_u32 s38, s37, 15360
    buffer_store_dwordx4 v[44:47], v9, s[28:31], s38 offen sc1
    s_waitcnt lgkmcnt(10)
    s_add_u32 s38, s37, 20480
    buffer_store_dwordx4 v[48:51], v9, s[28:31], s38 offen sc1
    s_waitcnt lgkmcnt(8)
    s_add_u32 s38, s37, 25600
    buffer_store_dwordx4 v[52:55], v9, s[28:31], s38 offen sc1
    s_waitcnt lgkmcnt(6)
    s_add_u32 s38, s37, 30720
    buffer_store_dwordx4 v[56:59], v9, s[28:31], s38 offen sc1
    s_waitcnt lgkmcnt(4)
    s_add_u32 s38, s37, 35840
    buffer_store_dwordx4 v[60:63], v9, s[28:31], s38 offen sc1
    s_waitcnt lgkmcnt(2)
    s_add_u32 s38, s37, 40960
    buffer_store_dwordx4 v[64:67], v9, s[28:31], s38 offen sc1
    s_waitcnt lgkmcnt(0)
    s_add_u32 s38, s37, 46080
    buffer_store_dwordx4 v[68:71], v9, s[28:31], s38 offen sc1
    s_add_u32 s34, s34, 1
    s_barrier
    s_lshl_b32 s36, s34, 2
    s_add_u32 s36, s36, s20
    s_mul_i32 s38, s36, 52429
    s_lshr_b32 s38, s38, 18
    s_mul_i32 s39, s38, 5
    s_sub_u32 s39, s36, s39
    s_mul_i32 s37, s38, 100
    s_mul_i32 s40, s33, 50
    s_add_u32 s37, s37, s40
    s_add_u32 s37, s37, s39
    s_lshl_b32 s37, s37, 10
    s_add_u32 s37, s37, 3584000
    s_waitcnt vmcnt(19)
    ds_write_b128 v5, v[72:75] offset:0
    s_waitcnt vmcnt(18)
    ds_write_b128 v5, v[76:79] offset:4608
    s_waitcnt vmcnt(17)
    ds_write_b128 v5, v[80:83] offset:9216
    s_waitcnt vmcnt(16)
    ds_write_b128 v5, v[84:87] offset:13824
    s_waitcnt vmcnt(15)
    ds_write_b128 v5, v[88:91] offset:18432
    s_waitcnt vmcnt(14)
    ds_write_b128 v5, v[92:95] offset:23040
    s_waitcnt vmcnt(13)
    ds_write_b128 v5, v[96:99] offset:27648
    s_waitcnt vmcnt(12)
    ds_write_b128 v5, v[100:103] offset:32256
    s_waitcnt vmcnt(11)
    ds_write_b128 v5, v[104:107] offset:36864
    s_waitcnt vmcnt(10)
    ds_write_b128 v5, v[108:111] offset:41472
    s_waitcnt lgkmcnt(0)
    s_barrier
    ds_read_b64_tr_b16 v[72:73], v8 offset:0
    ds_read_b64_tr_b16 v[74:75], v8 offset:576
    ds_read_b64_tr_b16 v[76:77], v8 offset:4608
    ds_read_b64_tr_b16 v[78:79], v8 offset:5184
    ds_read_b64_tr_b16 v[80:81], v8 offset:9216
    ds_read_b64_tr_b16 v[82:83], v8 offset:9792
    ds_read_b64_tr_b16 v[84:85], v8 offset:13824
    ds_read_b64_tr_b16 v[86:87], v8 offset:14400
    ds_read_b64_tr_b16 v[88:89], v8 offset:18432
    ds_read_b64_tr_b16 v[90:91], v8 offset:19008
    ds_read_b64_tr_b16 v[92:93], v8 offset:23040
    ds_read_b64_tr_b16 v[94:95], v8 offset:23616
    ds_read_b64_tr_b16 v[96:97], v8 offset:27648
    ds_read_b64_tr_b16 v[98:99], v8 offset:28224
    ds_read_b64_tr_b16 v[100:101], v8 offset:32256
    ds_read_b64_tr_b16 v[102:103], v8 offset:32832
    ds_read_b64_tr_b16 v[104:105], v8 offset:36864
    ds_read_b64_tr_b16 v[106:107], v8 offset:37440
    ds_read_b64_tr_b16 v[108:109], v8 offset:41472
    ds_read_b64_tr_b16 v[110:111], v8 offset:42048
    s_waitcnt lgkmcnt(15)
    s_add_u32 s38, s37, 0
    buffer_store_dwordx4 v[72:75], v9, s[28:31], s38 offen sc1
    s_waitcnt lgkmcnt(15)
    s_add_u32 s38, s37, 5120
    buffer_store_dwordx4 v[76:79], v9, s[28:31], s38 offen sc1
    s_waitcnt lgkmcnt(14)
    s_add_u32 s38, s37, 10240
    buffer_store_dwordx4 v[80:83], v9, s[28:31], s38 offen sc1
    s_waitcnt lgkmcnt(12)
    s_add_u32 s38, s37, 15360
    buffer_store_dwordx4 v[84:87], v9, s[28:31], s38 offen sc1
    s_waitcnt lgkmcnt(10)
    s_add_u32 s38, s37, 20480
    buffer_store_dwordx4 v[88:91], v9, s[28:31], s38 offen sc1
    s_waitcnt lgkmcnt(8)
    s_add_u32 s38, s37, 25600
    buffer_store_dwordx4 v[92:95], v9, s[28:31], s38 offen sc1
    s_waitcnt lgkmcnt(6)
    s_add_u32 s38, s37, 30720
    buffer_store_dwordx4 v[96:99], v9, s[28:31], s38 offen sc1
    s_waitcnt lgkmcnt(4)
    s_add_u32 s38, s37, 35840
    buffer_store_dwordx4 v[100:103], v9, s[28:31], s38 offen sc1
    s_waitcnt lgkmcnt(2)
    s_add_u32 s38, s37, 40960
    buffer_store_dwordx4 v[104:107], v9, s[28:31], s38 offen sc1
    s_waitcnt lgkmcnt(0)
    s_add_u32 s38, s37, 46080
    buffer_store_dwordx4 v[108:111], v9, s[28:31], s38 offen sc1
    s_endpgm
k1_kernel_pk17:
    s_mov_b32 s24, s16
    s_mov_b32 s25, s17
    s_mov_b32 s26, 2211840
    s_mov_b32 s27, 0x00020000
    s_sub_u32 s32, s21, 20
    s_mul_i32 s33, s32, 4682
    s_lshr_b32 s33, s33, 16
    s_mul_i32 s34, s33, 14
    s_sub_u32 s34, s32, s34
    s_lshl_b32 s34, s34, 1
    v_mul_u32_u24 v10, 3456, v3
    v_lshl_add_u32 v10, v4, 4, v10
    s_mul_i32 s35, s33, 1105920
    s_lshl_b32 s36, s34, 7
    s_add_u32 s35, s35, s36
    buffer_load_dwordx4 v[32:35], v10, s[24:27], s35 offen offset:0
    s_add_u32 s35, s35, 110592
    buffer_load_dwordx4 v[36:39], v10, s[24:27], s35 offen offset:0
    s_add_u32 s35, s35, 110592
    buffer_load_dwordx4 v[40:43], v10, s[24:27], s35 offen offset:0
    s_add_u32 s35, s35, 110592
    buffer_load_dwordx4 v[44:47], v10, s[24:27], s35 offen offset:0
    s_add_u32 s35, s35, 110592
    buffer_load_dwordx4 v[48:51], v10, s[24:27], s35 offen offset:0
    s_add_u32 s35, s35, 110592
    buffer_load_dwordx4 v[52:55], v10, s[24:27], s35 offen offset:0
    s_add_u32 s35, s35, 110592
    buffer_load_dwordx4 v[56:59], v10, s[24:27], s35 offen offset:0
    s_add_u32 s35, s35, 110592
    buffer_load_dwordx4 v[60:63], v10, s[24:27], s35 offen offset:0
    s_add_u32 s35, s35, 110592
    buffer_load_dwordx4 v[64:67], v10, s[24:27], s35 offen offset:0
    s_add_u32 s35, s35, 110592
    buffer_load_dwordx4 v[68:71], v10, s[24:27], s35 offen offset:0
    s_sub_u32 s35, s35, 995328
    buffer_load_dwordx4 v[72:75], v10, s[24:27], s35 offen offset:128
    s_add_u32 s35, s35, 110592
    buffer_load_dwordx4 v[76:79], v10, s[24:27], s35 offen offset:128
    s_add_u32 s35, s35, 110592
    buffer_load_dwordx4 v[80:83], v10, s[24:27], s35 offen offset:128
    s_add_u32 s35, s35, 110592
    buffer_load_dwordx4 v[84:87], v10, s[24:27], s35 offen offset:128
    s_add_u32 s35, s35, 110592
    buffer_load_dwordx4 v[88:91], v10, s[24:27], s35 offen offset:128
    s_add_u32 s35, s35, 110592
    buffer_load_dwordx4 v[92:95], v10, s[24:27], s35 offen offset:128
    s_add_u32 s35, s35, 110592
    buffer_load_dwordx4 v[96:99], v10, s[24:27], s35 offen offset:128
    s_add_u32 s35, s35, 110592
    buffer_load_dwordx4 v[100:103], v10, s[24:27], s35 offen offset:128
    s_add_u32 s35, s35, 110592
    buffer_load_dwordx4 v[104:107], v10, s[24:27], s35 offen offset:128
    s_add_u32 s35, s35, 110592
    buffer_load_dwordx4 v[108:111], v10, s[24:27], s35 offen offset:128
    s_lshl_b32 s36, s34, 2
    s_add_u32 s36, s36, s20
    s_mul_i32 s38, s36, 9363
    s_lshr_b32 s38, s38, 16
    s_mul_i32 s39, s38, 7
    s_sub_u32 s39, s36, s39
    s_mul_i32 s37, s38, 140
    s_mul_i32 s40, s33, 70
    s_add_u32 s37, s37, s40
    s_add_u32 s37, s37, s39
    s_lshl_b32 s37, s37, 10
    s_add_u32 s37, s37, 4403200
    s_waitcnt vmcnt(19)
    ds_write_b128 v5, v[32:35] offset:0
    s_waitcnt vmcnt(18)
    ds_write_b128 v5, v[36:39] offset:4608
    s_waitcnt vmcnt(17)
    ds_write_b128 v5, v[40:43] offset:9216
    s_waitcnt vmcnt(16)
    ds_write_b128 v5, v[44:47] offset:13824
    s_waitcnt vmcnt(15)
    ds_write_b128 v5, v[48:51] offset:18432
    s_waitcnt vmcnt(14)
    ds_write_b128 v5, v[52:55] offset:23040
    s_waitcnt vmcnt(13)
    ds_write_b128 v5, v[56:59] offset:27648
    s_waitcnt vmcnt(12)
    ds_write_b128 v5, v[60:63] offset:32256
    s_waitcnt vmcnt(11)
    ds_write_b128 v5, v[64:67] offset:36864
    s_waitcnt vmcnt(10)
    ds_write_b128 v5, v[68:71] offset:41472
    s_waitcnt lgkmcnt(0)
    s_barrier
    ds_read_b64_tr_b16 v[32:33], v8 offset:0
    ds_read_b64_tr_b16 v[34:35], v8 offset:576
    ds_read_b64_tr_b16 v[36:37], v8 offset:4608
    ds_read_b64_tr_b16 v[38:39], v8 offset:5184
    ds_read_b64_tr_b16 v[40:41], v8 offset:9216
    ds_read_b64_tr_b16 v[42:43], v8 offset:9792
    ds_read_b64_tr_b16 v[44:45], v8 offset:13824
    ds_read_b64_tr_b16 v[46:47], v8 offset:14400
    ds_read_b64_tr_b16 v[48:49], v8 offset:18432
    ds_read_b64_tr_b16 v[50:51], v8 offset:19008
    ds_read_b64_tr_b16 v[52:53], v8 offset:23040
    ds_read_b64_tr_b16 v[54:55], v8 offset:23616
    ds_read_b64_tr_b16 v[56:57], v8 offset:27648
    ds_read_b64_tr_b16 v[58:59], v8 offset:28224
    ds_read_b64_tr_b16 v[60:61], v8 offset:32256
    ds_read_b64_tr_b16 v[62:63], v8 offset:32832
    ds_read_b64_tr_b16 v[64:65], v8 offset:36864
    ds_read_b64_tr_b16 v[66:67], v8 offset:37440
    ds_read_b64_tr_b16 v[68:69], v8 offset:41472
    ds_read_b64_tr_b16 v[70:71], v8 offset:42048
    v_mov_b32 v12, 0
    v_mov_b32 v13, 0x3f803f80
    s_waitcnt lgkmcnt(15)
    s_add_u32 s38, s37, 0
    buffer_store_dwordx4 v[32:35], v9, s[28:31], s38 offen sc1
    v_dot2_f32_bf16 v12, v32, v13, v12
    v_dot2_f32_bf16 v12, v33, v13, v12
    v_dot2_f32_bf16 v12, v34, v13, v12
    v_dot2_f32_bf16 v12, v35, v13, v12
    s_waitcnt lgkmcnt(15)
    s_add_u32 s38, s37, 7168
    buffer_store_dwordx4 v[36:39], v9, s[28:31], s38 offen sc1
    v_dot2_f32_bf16 v12, v36, v13, v12
    v_dot2_f32_bf16 v12, v37, v13, v12
    v_dot2_f32_bf16 v12, v38, v13, v12
    v_dot2_f32_bf16 v12, v39, v13, v12
    s_waitcnt lgkmcnt(14)
    s_add_u32 s38, s37, 14336
    buffer_store_dwordx4 v[40:43], v9, s[28:31], s38 offen sc1
    v_dot2_f32_bf16 v12, v40, v13, v12
    v_dot2_f32_bf16 v12, v41, v13, v12
    v_dot2_f32_bf16 v12, v42, v13, v12
    v_dot2_f32_bf16 v12, v43, v13, v12
    s_waitcnt lgkmcnt(12)
    s_add_u32 s38, s37, 21504
    buffer_store_dwordx4 v[44:47], v9, s[28:31], s38 offen sc1
    v_dot2_f32_bf16 v12, v44, v13, v12
    v_dot2_f32_bf16 v12, v45, v13, v12
    v_dot2_f32_bf16 v12, v46, v13, v12
    v_dot2_f32_bf16 v12, v47, v13, v12
    s_waitcnt lgkmcnt(10)
    s_add_u32 s38, s37, 28672
    buffer_store_dwordx4 v[48:51], v9, s[28:31], s38 offen sc1
    v_dot2_f32_bf16 v12, v48, v13, v12
    v_dot2_f32_bf16 v12, v49, v13, v12
    v_dot2_f32_bf16 v12, v50, v13, v12
    v_dot2_f32_bf16 v12, v51, v13, v12
    s_waitcnt lgkmcnt(8)
    s_add_u32 s38, s37, 35840
    buffer_store_dwordx4 v[52:55], v9, s[28:31], s38 offen sc1
    v_dot2_f32_bf16 v12, v52, v13, v12
    v_dot2_f32_bf16 v12, v53, v13, v12
    v_dot2_f32_bf16 v12, v54, v13, v12
    v_dot2_f32_bf16 v12, v55, v13, v12
    s_waitcnt lgkmcnt(6)
    s_add_u32 s38, s37, 43008
    buffer_store_dwordx4 v[56:59], v9, s[28:31], s38 offen sc1
    v_dot2_f32_bf16 v12, v56, v13, v12
    v_dot2_f32_bf16 v12, v57, v13, v12
    v_dot2_f32_bf16 v12, v58, v13, v12
    v_dot2_f32_bf16 v12, v59, v13, v12
    s_waitcnt lgkmcnt(4)
    s_add_u32 s38, s37, 50176
    buffer_store_dwordx4 v[60:63], v9, s[28:31], s38 offen sc1
    v_dot2_f32_bf16 v12, v60, v13, v12
    v_dot2_f32_bf16 v12, v61, v13, v12
    v_dot2_f32_bf16 v12, v62, v13, v12
    v_dot2_f32_bf16 v12, v63, v13, v12
    s_waitcnt lgkmcnt(2)
    s_add_u32 s38, s37, 57344
    buffer_store_dwordx4 v[64:67], v9, s[28:31], s38 offen sc1
    v_dot2_f32_bf16 v12, v64, v13, v12
    v_dot2_f32_bf16 v12, v65, v13, v12
    v_dot2_f32_bf16 v12, v66, v13, v12
    v_dot2_f32_bf16 v12, v67, v13, v12
    s_waitcnt lgkmcnt(0)
    s_add_u32 s38, s37, 64512
    buffer_store_dwordx4 v[68:71], v9, s[28:31], s38 offen sc1
    v_dot2_f32_bf16 v12, v68, v13, v12
    v_dot2_f32_bf16 v12, v69, v13, v12
    v_dot2_f32_bf16 v12, v70, v13, v12
    v_dot2_f32_bf16 v12, v71, v13, v12
    s_nop 2
    v_mov_b32 v13, v12
    s_nop 1
    v_permlane32_swap_b32 v13, v12
    v_add_f32 v12, v12, v13
    v_mov_b32 v13, v12
    s_nop 1
    v_permlane16_swap_b32 v13, v12
    v_add_f32 v12, v12, v13
    s_mul_i32 s38, s33, 7168
    s_lshl_b32 s39, s36, 6
    s_add_u32 s38, s38, s39
    s_add_u32 s38, s38, 2732032
    v_lshlrev_b32 v14, 2, v1
    v_cmp_gt_u32 vcc, 16, v1
    s_and_saveexec_b64 s[40:41], vcc
    buffer_store_dword v12, v14, s[28:31], s38 offen sc1
    s_mov_b64 exec, -1
    s_cmp_ge_u32 s34, 26
    s_cbranch_scc1 k1_kernel_pke19
    s_add_u32 s34, s34, 1
    s_barrier
    s_lshl_b32 s36, s34, 2
    s_add_u32 s36, s36, s20
    s_mul_i32 s38, s36, 9363
    s_lshr_b32 s38, s38, 16
    s_mul_i32 s39, s38, 7
    s_sub_u32 s39, s36, s39
    s_mul_i32 s37, s38, 140
    s_mul_i32 s40, s33, 70
    s_add_u32 s37, s37, s40
    s_add_u32 s37, s37, s39
    s_lshl_b32 s37, s37, 10
    s_add_u32 s37, s37, 4403200
    s_waitcnt vmcnt(20)
    ds_write_b128 v5, v[72:75] offset:0
    s_waitcnt vmcnt(19)
    ds_write_b128 v5, v[76:79] offset:4608
    s_waitcnt vmcnt(18)
    ds_write_b128 v5, v[80:83] offset:9216
    s_waitcnt vmcnt(17)
    ds_write_b128 v5, v[84:87] offset:13824
    s_waitcnt vmcnt(16)
    ds_write_b128 v5, v[88:91] offset:18432
    s_waitcnt vmcnt(15)
    ds_write_b128 v5, v[92:95] offset:23040
    s_waitcnt vmcnt(14)
    ds_write_b128 v5, v[96:99] offset:27648
    s_waitcnt vmcnt(13)
    ds_write_b128 v5, v[100:103] offset:32256
    s_waitcnt vmcnt(12)
    ds_write_b128 v5, v[104:107] offset:36864
    s_waitcnt vmcnt(11)
    ds_write_b128 v5, v[108:111] offset:41472
    s_waitcnt lgkmcnt(0)
    s_barrier
    ds_read_b64_tr_b16 v[72:73], v8 offset:0
    ds_read_b64_tr_b16 v[74:75], v8 offset:576
    ds_read_b64_tr_b16 v[76:77], v8 offset:4608
    ds_read_b64_tr_b16 v[78:79], v8 offset:5184
    ds_read_b64_tr_b16 v[80:81], v8 offset:9216
    ds_read_b64_tr_b16 v[82:83], v8 offset:9792
    ds_read_b64_tr_b16 v[84:85], v8 offset:13824
    ds_read_b64_tr_b16 v[86:87], v8 offset:14400
    ds_read_b64_tr_b16 v[88:89], v8 offset:18432
    ds_read_b64_tr_b16 v[90:91], v8 offset:19008
    ds_read_b64_tr_b16 v[92:93], v8 offset:23040
    ds_read_b64_tr_b16 v[94:95], v8 offset:23616
    ds_read_b64_tr_b16 v[96:97], v8 offset:27648
    ds_read_b64_tr_b16 v[98:99], v8 offset:28224
    ds_read_b64_tr_b16 v[100:101], v8 offset:32256
    ds_read_b64_tr_b16 v[102:103], v8 offset:32832
    ds_read_b64_tr_b16 v[104:105], v8 offset:36864
    ds_read_b64_tr_b16 v[106:107], v8 offset:37440
    ds_read_b64_tr_b16 v[108:109], v8 offset:41472
    ds_read_b64_tr_b16 v[110:111], v8 offset:42048
    v_mov_b32 v12, 0
    v_mov_b32 v13, 0x3f803f80
    s_waitcnt lgkmcnt(15)
    s_add_u32 s38, s37, 0
    buffer_store_dwordx4 v[72:75], v9, s[28:31], s38 offen sc1
    v_dot2_f32_bf16 v12, v72, v13, v12
    v_dot2_f32_bf16 v12, v73, v13, v12
    v_dot2_f32_bf16 v12, v74, v13, v12
    v_dot2_f32_bf16 v12, v75, v13, v12
    s_waitcnt lgkmcnt(15)
    s_add_u32 s38, s37, 7168
    buffer_store_dwordx4 v[76:79], v9, s[28:31], s38 offen sc1
    v_dot2_f32_bf16 v12, v76, v13, v12
    v_dot2_f32_bf16 v12, v77, v13, v12
    v_dot2_f32_bf16 v12, v78, v13, v12
    v_dot2_f32_bf16 v12, v79, v13, v12
    s_waitcnt lgkmcnt(14)
    s_add_u32 s38, s37, 14336
    buffer_store_dwordx4 v[80:83], v9, s[28:31], s38 offen sc1
    v_dot2_f32_bf16 v12, v80, v13, v12
    v_dot2_f32_bf16 v12, v81, v13, v12
    v_dot2_f32_bf16 v12, v82, v13, v12
    v_dot2_f32_bf16 v12, v83, v13, v12
    s_waitcnt lgkmcnt(12)
    s_add_u32 s38, s37, 21504
    buffer_store_dwordx4 v[84:87], v9, s[28:31], s38 offen sc1
    v_dot2_f32_bf16 v12, v84, v13, v12
    v_dot2_f32_bf16 v12, v85, v13, v12
    v_dot2_f32_bf16 v12, v86, v13, v12
    v_dot2_f32_bf16 v12, v87, v13, v12
    s_waitcnt lgkmcnt(10)
    s_add_u32 s38, s37, 28672
    buffer_store_dwordx4 v[88:91], v9, s[28:31], s38 offen sc1
    v_dot2_f32_bf16 v12, v88, v13, v12
    v_dot2_f32_bf16 v12, v89, v13, v12
    v_dot2_f32_bf16 v12, v90, v13, v12
    v_dot2_f32_bf16 v12, v91, v13, v12
    s_waitcnt lgkmcnt(8)
    s_add_u32 s38, s37, 35840
    buffer_store_dwordx4 v[92:95], v9, s[28:31], s38 offen sc1
    v_dot2_f32_bf16 v12, v92, v13, v12
    v_dot2_f32_bf16 v12, v93, v13, v12
    v_dot2_f32_bf16 v12, v94, v13, v12
    v_dot2_f32_bf16 v12, v95, v13, v12
    s_waitcnt lgkmcnt(6)
    s_add_u32 s38, s37, 43008
    buffer_store_dwordx4 v[96:99], v9, s[28:31], s38 offen sc1
    v_dot2_f32_bf16 v12, v96, v13, v12
    v_dot2_f32_bf16 v12, v97, v13, v12
    v_dot2_f32_bf16 v12, v98, v13, v12
    v_dot2_f32_bf16 v12, v99, v13, v12
    s_waitcnt lgkmcnt(4)
    s_add_u32 s38, s37, 50176
    buffer_store_dwordx4 v[100:103], v9, s[28:31], s38 offen sc1
    v_dot2_f32_bf16 v12, v100, v13, v12
    v_dot2_f32_bf16 v12, v101, v13, v12
    v_dot2_f32_bf16 v12, v102, v13, v12
    v_dot2_f32_bf16 v12, v103, v13, v12
    s_waitcnt lgkmcnt(2)
    s_add_u32 s38, s37, 57344
    buffer_store_dwordx4 v[104:107], v9, s[28:31], s38 offen sc1
    v_dot2_f32_bf16 v12, v104, v13, v12
    v_dot2_f32_bf16 v12, v105, v13, v12
    v_dot2_f32_bf16 v12, v106, v13, v12
    v_dot2_f32_bf16 v12, v107, v13, v12
    s_waitcnt lgkmcnt(0)
    s_add_u32 s38, s37, 64512
    buffer_store_dwordx4 v[108:111], v9, s[28:31], s38 offen sc1
    v_dot2_f32_bf16 v12, v108, v13, v12
    v_dot2_f32_bf16 v12, v109, v13, v12
    v_dot2_f32_bf16 v12, v110, v13, v12
    v_dot2_f32_bf16 v12, v111, v13, v12
    s_nop 2
    v_mov_b32 v13, v12
    s_nop 1
    v_permlane32_swap_b32 v13, v12
    v_add_f32 v12, v12, v13
    v_mov_b32 v13, v12
    s_nop 1
    v_permlane16_swap_b32 v13, v12
    v_add_f32 v12, v12, v13
    s_mul_i32 s38, s33, 7168
    s_lshl_b32 s39, s36, 6
    s_add_u32 s38, s38, s39
    s_add_u32 s38, s38, 2732032
    v_lshlrev_b32 v14, 2, v1
    v_cmp_gt_u32 vcc, 16, v1
    s_and_saveexec_b64 s[40:41], vcc
    buffer_store_dword v12, v14, s[28:31], s38 offen sc1
    s_mov_b64 exec, -1
    s_endpgm
k1_kernel_pk18:
    s_mov_b32 s24, s18
    s_mov_b32 s25, s19
    s_mov_b32 s26, 2211840
    s_mov_b32 s27, 0x00020000
    s_sub_u32 s32, s21, 48
    s_mul_i32 s33, s32, 52429
    s_lshr_b32 s33, s33, 18
    s_mul_i32 s34, s33, 5
    s_sub_u32 s34, s32, s34
    s_lshl_b32 s34, s34, 1
    v_mul_u32_u24 v10, 1280, v3
    v_lshl_add_u32 v10, v4, 4, v10
    s_mul_i32 s35, s33, 368640
    s_lshl_b32 s36, s34, 7
    s_add_u32 s35, s35, s36
    buffer_load_dwordx4 v[32:35], v10, s[24:27], s35 offen offset:0
    s_add_u32 s35, s35, 40960
    buffer_load_dwordx4 v[36:39], v10, s[24:27], s35 offen offset:0
    s_add_u32 s35, s35, 40960
    buffer_load_dwordx4 v[40:43], v10, s[24:27], s35 offen offset:0
    s_add_u32 s35, s35, 40960
    buffer_load_dwordx4 v[44:47], v10, s[24:27], s35 offen offset:0
    s_add_u32 s35, s35, 40960
    buffer_load_dwordx4 v[48:51], v10, s[24:27], s35 offen offset:0
    s_add_u32 s35, s35, 40960
    buffer_load_dwordx4 v[52:55], v10, s[24:27], s35 offen offset:0
    s_add_u32 s35, s35, 40960
    buffer_load_dwordx4 v[56:59], v10, s[24:27], s35 offen offset:0
    s_add_u32 s35, s35, 40960
    buffer_load_dwordx4 v[60:63], v10, s[24:27], s35 offen offset:0
    s_add_u32 s35, s35, 40960
    buffer_load_dwordx4 v[64:67], v10, s[24:27], s35 offen offset:0
    s_sub_u32 s35, s35, 327680
    buffer_load_dwordx4 v[72:75], v10, s[24:27], s35 offen offset:128
    s_add_u32 s35, s35, 40960
    buffer_load_dwordx4 v[76:79], v10, s[24:27], s35 offen offset:128
    s_add_u32 s35, s35, 40960
    buffer_load_dwordx4 v[80:83], v10, s[24:27], s35 offen offset:128
    s_add_u32 s35, s35, 40960
    buffer_load_dwordx4 v[84:87], v10, s[24:27], s35 offen offset:128
    s_add_u32 s35, s35, 40960
    buffer_load_dwordx4 v[88:91], v10, s[24:27], s35 offen offset:128
    s_add_u32 s35, s35, 40960
    buffer_load_dwordx4 v[92:95], v10, s[24:27], s35 offen offset:128
    s_add_u32 s35, s35, 40960
    buffer_load_dwordx4 v[96:99], v10, s[24:27], s35 offen offset:128
    s_add_u32 s35, s35, 40960
    buffer_load_dwordx4 v[100:103], v10, s[24:27], s35 offen offset:128
    s_add_u32 s35, s35, 40960
    buffer_load_dwordx4 v[104:107], v10, s[24:27], s35 offen offset:128
    s_lshl_b32 s36, s34, 2
    s_add_u32 s36, s36, s20
    s_mul_i32 s38, s36, 52429
    s_lshr_b32 s38, s38, 18
    s_mul_i32 s39, s38, 5
    s_sub_u32 s39, s36, s39
    s_mul_i32 s37, s38, 280
    s_mul_i32 s40, s33, 45
    s_add_u32 s37, s37, s40
    s_add_u32 s37, s37, s39
    s_lshl_b32 s37, s37, 10
    s_add_u32 s37, s37, 6696960
    s_waitcnt vmcnt(17)
    ds_write_b128 v5, v[32:35] offset:0
    s_waitcnt vmcnt(16)
    ds_write_b128 v5, v[36:39] offset:4608
    s_waitcnt vmcnt(15)
    ds_write_b128 v5, v[40:43] offset:9216
    s_waitcnt vmcnt(14)
    ds_write_b128 v5, v[44:47] offset:13824
    s_waitcnt vmcnt(13)
    ds_write_b128 v5, v[48:51] offset:18432
    s_waitcnt vmcnt(12)
    ds_write_b128 v5, v[52:55] offset:23040
    s_waitcnt vmcnt(11)
    ds_write_b128 v5, v[56:59] offset:27648
    s_waitcnt vmcnt(10)
    ds_write_b128 v5, v[60:63] offset:32256
    s_waitcnt vmcnt(9)
    ds_write_b128 v5, v[64:67] offset:36864
    s_waitcnt lgkmcnt(0)
    s_barrier
    ds_read_b64_tr_b16 v[32:33], v8 offset:0
    ds_read_b64_tr_b16 v[34:35], v8 offset:576
    ds_read_b64_tr_b16 v[36:37], v8 offset:4608
    ds_read_b64_tr_b16 v[38:39], v8 offset:5184
    ds_read_b64_tr_b16 v[40:41], v8 offset:9216
    ds_read_b64_tr_b16 v[42:43], v8 offset:9792
    ds_read_b64_tr_b16 v[44:45], v8 offset:13824
    ds_read_b64_tr_b16 v[46:47], v8 offset:14400
    ds_read_b64_tr_b16 v[48:49], v8 offset:18432
    ds_read_b64_tr_b16 v[50:51], v8 offset:19008
    ds_read_b64_tr_b16 v[52:53], v8 offset:23040
    ds_read_b64_tr_b16 v[54:55], v8 offset:23616
    ds_read_b64_tr_b16 v[56:57], v8 offset:27648
    ds_read_b64_tr_b16 v[58:59], v8 offset:28224
    ds_read_b64_tr_b16 v[60:61], v8 offset:32256
    ds_read_b64_tr_b16 v[62:63], v8 offset:32832
    ds_read_b64_tr_b16 v[64:65], v8 offset:36864
    ds_read_b64_tr_b16 v[66:67], v8 offset:37440
    s_waitcnt lgkmcnt(15)
    s_add_u32 s38, s37, 0
    buffer_store_dwordx4 v[32:35], v9, s[28:31], s38 offen sc1
    s_waitcnt lgkmcnt(14)
    s_add_u32 s38, s37, 5120
    buffer_store_dwordx4 v[36:39], v9, s[28:31], s38 offen sc1
    s_waitcnt lgkmcnt(12)
    s_add_u32 s38, s37, 10240
    buffer_store_dwordx4 v[40:43], v9, s[28:31], s38 offen sc1
    s_waitcnt lgkmcnt(10)
    s_add_u32 s38, s37, 15360
    buffer_store_dwordx4 v[44:47], v9, s[28:31], s38 offen sc1
    s_waitcnt lgkmcnt(8)
    s_add_u32 s38, s37, 20480
    buffer_store_dwordx4 v[48:51], v9, s[28:31], s38 offen sc1
    s_waitcnt lgkmcnt(6)
    s_add_u32 s38, s37, 25600
    buffer_store_dwordx4 v[52:55], v9, s[28:31], s38 offen sc1
    s_waitcnt lgkmcnt(4)
    s_add_u32 s38, s37, 30720
    buffer_store_dwordx4 v[56:59], v9, s[28:31], s38 offen sc1
    s_waitcnt lgkmcnt(2)
    s_add_u32 s38, s37, 35840
    buffer_store_dwordx4 v[60:63], v9, s[28:31], s38 offen sc1
    s_waitcnt lgkmcnt(0)
    s_add_u32 s38, s37, 40960
    buffer_store_dwordx4 v[64:67], v9, s[28:31], s38 offen sc1
    s_add_u32 s34, s34, 1
    s_barrier
    s_lshl_b32 s36, s34, 2
    s_add_u32 s36, s36, s20
    s_mul_i32 s38, s36, 52429
    s_lshr_b32 s38, s38, 18
    s_mul_i32 s39, s38, 5
    s_sub_u32 s39, s36, s39
    s_mul_i32 s37, s38, 280
    s_mul_i32 s40, s33, 45
    s_add_u32 s37, s37, s40
    s_add_u32 s37, s37, s39
    s_lshl_b32 s37, s37, 10
    s_add_u32 s37, s37, 6696960
    s_waitcnt vmcnt(17)
    ds_write_b128 v5, v[72:75] offset:0
    s_waitcnt vmcnt(16)
    ds_write_b128 v5, v[76:79] offset:4608
    s_waitcnt vmcnt(15)
    ds_write_b128 v5, v[80:83] offset:9216
    s_waitcnt vmcnt(14)
    ds_write_b128 v5, v[84:87] offset:13824
    s_waitcnt vmcnt(13)
    ds_write_b128 v5, v[88:91] offset:18432
    s_waitcnt vmcnt(12)
    ds_write_b128 v5, v[92:95] offset:23040
    s_waitcnt vmcnt(11)
    ds_write_b128 v5, v[96:99] offset:27648
    s_waitcnt vmcnt(10)
    ds_write_b128 v5, v[100:103] offset:32256
    s_waitcnt vmcnt(9)
    ds_write_b128 v5, v[104:107] offset:36864
    s_waitcnt lgkmcnt(0)
    s_barrier
    ds_read_b64_tr_b16 v[72:73], v8 offset:0
    ds_read_b64_tr_b16 v[74:75], v8 offset:576
    ds_read_b64_tr_b16 v[76:77], v8 offset:4608
    ds_read_b64_tr_b16 v[78:79], v8 offset:5184
    ds_read_b64_tr_b16 v[80:81], v8 offset:9216
    ds_read_b64_tr_b16 v[82:83], v8 offset:9792
    ds_read_b64_tr_b16 v[84:85], v8 offset:13824
    ds_read_b64_tr_b16 v[86:87], v8 offset:14400
    ds_read_b64_tr_b16 v[88:89], v8 offset:18432
    ds_read_b64_tr_b16 v[90:91], v8 offset:19008
    ds_read_b64_tr_b16 v[92:93], v8 offset:23040
    ds_read_b64_tr_b16 v[94:95], v8 offset:23616
    ds_read_b64_tr_b16 v[96:97], v8 offset:27648
    ds_read_b64_tr_b16 v[98:99], v8 offset:28224
    ds_read_b64_tr_b16 v[100:101], v8 offset:32256
    ds_read_b64_tr_b16 v[102:103], v8 offset:32832
    ds_read_b64_tr_b16 v[104:105], v8 offset:36864
    ds_read_b64_tr_b16 v[106:107], v8 offset:37440
    s_waitcnt lgkmcnt(15)
    s_add_u32 s38, s37, 0
    buffer_store_dwordx4 v[72:75], v9, s[28:31], s38 offen sc1
    s_waitcnt lgkmcnt(14)
    s_add_u32 s38, s37, 5120
    buffer_store_dwordx4 v[76:79], v9, s[28:31], s38 offen sc1
    s_waitcnt lgkmcnt(12)
    s_add_u32 s38, s37, 10240
    buffer_store_dwordx4 v[80:83], v9, s[28:31], s38 offen sc1
    s_waitcnt lgkmcnt(10)
    s_add_u32 s38, s37, 15360
    buffer_store_dwordx4 v[84:87], v9, s[28:31], s38 offen sc1
    s_waitcnt lgkmcnt(8)
    s_add_u32 s38, s37, 20480
    buffer_store_dwordx4 v[88:91], v9, s[28:31], s38 offen sc1
    s_waitcnt lgkmcnt(6)
    s_add_u32 s38, s37, 25600
    buffer_store_dwordx4 v[92:95], v9, s[28:31], s38 offen sc1
    s_waitcnt lgkmcnt(4)
    s_add_u32 s38, s37, 30720
    buffer_store_dwordx4 v[96:99], v9, s[28:31], s38 offen sc1
    s_waitcnt lgkmcnt(2)
    s_add_u32 s38, s37, 35840
    buffer_store_dwordx4 v[100:103], v9, s[28:31], s38 offen sc1
    s_waitcnt lgkmcnt(0)
    s_add_u32 s38, s37, 40960
    buffer_store_dwordx4 v[104:107], v9, s[28:31], s38 offen sc1
    s_endpgm
k1_kernel_pke19:
    s_endpgm
k1_mod0:
    s_sub_u32 s54, s54, 128
    s_waitcnt lgkmcnt(0)
    s_mov_b32 s28, s10
    s_mov_b32 s29, s11
    s_mov_b32 s30, 268435456
    s_mov_b32 s31, 0x00020000
k1_modf:
    s_load_dwordx4 s[12:15], s[0:1], 88
    s_mov_b32 s32, s54
    v_and_b32 v3, 7, v0
    v_lshrrev_b32 v4, 3, v0
    v_lshlrev_b32 v5, 1, v4
    v_mul_u32_u24 v6, 7680, v4
    s_lshl_b32 s36, s32, 7
    v_lshl_add_u32 v7, v3, 4, s36
    v_add_u32 v6, v6, v7
    s_waitcnt lgkmcnt(0)
    s_mov_b32 s16, s12
    s_mov_b32 s17, s13
    s_mov_b32 s18, 1280
    s_mov_b32 s19, 0x00020000
    s_mov_b32 s20, s14
    s_mov_b32 s21, s15
    s_mov_b32 s22, 4915200
    s_mov_b32 s23, 0x00020000
    buffer_load_ushort v10, v5, s[16:19], 0 offen offset:0
    buffer_load_ushort v11, v5, s[16:19], 0 offen offset:64
    buffer_load_ushort v12, v5, s[16:19], 0 offen offset:128
    buffer_load_ushort v13, v5, s[16:19], 0 offen offset:192
    buffer_load_ushort v14, v5, s[16:19], 0 offen offset:256
    buffer_load_ushort v15, v5, s[16:19], 0 offen offset:320
    buffer_load_ushort v16, v5, s[16:19], 0 offen offset:384
    buffer_load_ushort v17, v5, s[16:19], 0 offen offset:448
    buffer_load_ushort v18, v5, s[16:19], 0 offen offset:512
    buffer_load_ushort v19, v5, s[16:19], 0 offen offset:576
    buffer_load_ushort v20, v5, s[16:19], 0 offen offset:640
    buffer_load_ushort v21, v5, s[16:19], 0 offen offset:704
    buffer_load_ushort v22, v5, s[16:19], 0 offen offset:768
    buffer_load_ushort v23, v5, s[16:19], 0 offen offset:832
    buffer_load_ushort v24, v5, s[16:19], 0 offen offset:896
    buffer_load_ushort v25, v5, s[16:19], 0 offen offset:960
    buffer_load_ushort v26, v5, s[16:19], 0 offen offset:1024
    buffer_load_ushort v27, v5, s[16:19], 0 offen offset:1088
    buffer_load_ushort v28, v5, s[16:19], 0 offen offset:1152
    buffer_load_ushort v29, v5, s[16:19], 0 offen offset:1216
    s_mov_b32 s37, 0
    buffer_load_dwordx4 v[32:35], v6, s[20:23], s37 offen
    s_mov_b32 s37, 245760
    buffer_load_dwordx4 v[36:39], v6, s[20:23], s37 offen
    s_mov_b32 s37, 491520
    buffer_load_dwordx4 v[40:43], v6, s[20:23], s37 offen
    s_mov_b32 s37, 737280
    buffer_load_dwordx4 v[44:47], v6, s[20:23], s37 offen
    s_mov_b32 s37, 983040
    buffer_load_dwordx4 v[48:51], v6, s[20:23], s37 offen
    s_mov_b32 s37, 1228800
    buffer_load_dwordx4 v[52:55], v6, s[20:23], s37 offen
    s_mov_b32 s37, 1474560
    buffer_load_dwordx4 v[56:59], v6, s[20:23], s37 offen
    s_mov_b32 s37, 1720320
    buffer_load_dwordx4 v[60:63], v6, s[20:23], s37 offen
    s_mov_b32 s37, 1966080
    buffer_load_dwordx4 v[64:67], v6, s[20:23], s37 offen
    s_mov_b32 s37, 2211840
    buffer_load_dwordx4 v[68:71], v6, s[20:23], s37 offen
    s_mov_b32 s37, 2457600
    buffer_load_dwordx4 v[72:75], v6, s[20:23], s37 offen
    s_mov_b32 s37, 2703360
    buffer_load_dwordx4 v[76:79], v6, s[20:23], s37 offen
    s_mov_b32 s37, 2949120
    buffer_load_dwordx4 v[80:83], v6, s[20:23], s37 offen
    s_mov_b32 s37, 3194880
    buffer_load_dwordx4 v[84:87], v6, s[20:23], s37 offen
    s_mov_b32 s37, 3440640
    buffer_load_dwordx4 v[88:91], v6, s[20:23], s37 offen
    s_mov_b32 s37, 3686400
    buffer_load_dwordx4 v[92:95], v6, s[20:23], s37 offen
    s_mov_b32 s37, 3932160
    buffer_load_dwordx4 v[96:99], v6, s[20:23], s37 offen
    s_mov_b32 s37, 4177920
    buffer_load_dwordx4 v[100:103], v6, s[20:23], s37 offen
    s_mov_b32 s37, 4423680
    buffer_load_dwordx4 v[104:107], v6, s[20:23], s37 offen
    s_mov_b32 s37, 4669440
    buffer_load_dwordx4 v[108:111], v6, s[20:23], s37 offen
    s_waitcnt vmcnt(20)
    v_lshlrev_b32 v10, 16, v10
    v_mul_f32 v120, 0xbfb8aa3b, v10
    v_exp_f32 v120, v120
    v_lshlrev_b32 v11, 16, v11
    v_mul_f32 v121, 0xbfb8aa3b, v11
    v_exp_f32 v121, v121
    v_lshlrev_b32 v12, 16, v12
    v_mul_f32 v122, 0xbfb8aa3b, v12
    v_exp_f32 v122, v122
    v_lshlrev_b32 v13, 16, v13
    v_mul_f32 v123, 0xbfb8aa3b, v13
    v_exp_f32 v123, v123
    v_lshlrev_b32 v14, 16, v14
    v_mul_f32 v124, 0xbfb8aa3b, v14
    v_exp_f32 v124, v124
    v_lshlrev_b32 v15, 16, v15
    v_mul_f32 v125, 0xbfb8aa3b, v15
    v_exp_f32 v125, v125
    v_lshlrev_b32 v16, 16, v16
    v_mul_f32 v126, 0xbfb8aa3b, v16
    v_exp_f32 v126, v126
    v_lshlrev_b32 v17, 16, v17
    v_mul_f32 v127, 0xbfb8aa3b, v17
    v_exp_f32 v127, v127
    v_lshlrev_b32 v18, 16, v18
    v_mul_f32 v128, 0xbfb8aa3b, v18
    v_exp_f32 v128, v128
    v_lshlrev_b32 v19, 16, v19
    v_mul_f32 v129, 0xbfb8aa3b, v19
    v_exp_f32 v129, v129
    v_lshlrev_b32 v20, 16, v20
    v_mul_f32 v130, 0xbfb8aa3b, v20
    v_exp_f32 v130, v130
    v_lshlrev_b32 v21, 16, v21
    v_mul_f32 v131, 0xbfb8aa3b, v21
    v_exp_f32 v131, v131
    v_lshlrev_b32 v22, 16, v22
    v_mul_f32 v132, 0xbfb8aa3b, v22
    v_exp_f32 v132, v132
    v_lshlrev_b32 v23, 16, v23
    v_mul_f32 v133, 0xbfb8aa3b, v23
    v_exp_f32 v133, v133
    v_lshlrev_b32 v24, 16, v24
    v_mul_f32 v134, 0xbfb8aa3b, v24
    v_exp_f32 v134, v134
    v_lshlrev_b32 v25, 16, v25
    v_mul_f32 v135, 0xbfb8aa3b, v25
    v_exp_f32 v135, v135
    v_lshlrev_b32 v26, 16, v26
    v_mul_f32 v136, 0xbfb8aa3b, v26
    v_exp_f32 v136, v136
    v_lshlrev_b32 v27, 16, v27
    v_mul_f32 v137, 0xbfb8aa3b, v27
    v_exp_f32 v137, v137
    v_lshlrev_b32 v28, 16, v28
    v_mul_f32 v138, 0xbfb8aa3b, v28
    v_exp_f32 v138, v138
    v_lshlrev_b32 v29, 16, v29
    v_mul_f32 v139, 0xbfb8aa3b, v29
    v_exp_f32 v139, v139
    v_add_f32 v120, 1.0, v120
    v_rcp_f32 v120, v120
    v_add_f32 v121, 1.0, v121
    v_rcp_f32 v121, v121
    v_add_f32 v122, 1.0, v122
    v_rcp_f32 v122, v122
    v_add_f32 v123, 1.0, v123
    v_rcp_f32 v123, v123
    v_add_f32 v124, 1.0, v124
    v_rcp_f32 v124, v124
    v_add_f32 v125, 1.0, v125
    v_rcp_f32 v125, v125
    v_add_f32 v126, 1.0, v126
    v_rcp_f32 v126, v126
    v_add_f32 v127, 1.0, v127
    v_rcp_f32 v127, v127
    v_add_f32 v128, 1.0, v128
    v_rcp_f32 v128, v128
    v_add_f32 v129, 1.0, v129
    v_rcp_f32 v129, v129
    v_add_f32 v130, 1.0, v130
    v_rcp_f32 v130, v130
    v_add_f32 v131, 1.0, v131
    v_rcp_f32 v131, v131
    v_add_f32 v132, 1.0, v132
    v_rcp_f32 v132, v132
    v_add_f32 v133, 1.0, v133
    v_rcp_f32 v133, v133
    v_add_f32 v134, 1.0, v134
    v_rcp_f32 v134, v134
    v_add_f32 v135, 1.0, v135
    v_rcp_f32 v135, v135
    v_add_f32 v136, 1.0, v136
    v_rcp_f32 v136, v136
    v_add_f32 v137, 1.0, v137
    v_rcp_f32 v137, v137
    v_add_f32 v138, 1.0, v138
    v_rcp_f32 v138, v138
    v_add_f32 v139, 1.0, v139
    v_rcp_f32 v139, v139
    s_nop 0
    v_mul_f32 v10, v10, v120
    v_mul_f32 v11, v11, v121
    v_mul_f32 v12, v12, v122
    v_mul_f32 v13, v13, v123
    v_mul_f32 v14, v14, v124
    v_mul_f32 v15, v15, v125
    v_mul_f32 v16, v16, v126
    v_mul_f32 v17, v17, v127
    v_mul_f32 v18, v18, v128
    v_mul_f32 v19, v19, v129
    v_mul_f32 v20, v20, v130
    v_mul_f32 v21, v21, v131
    v_mul_f32 v22, v22, v132
    v_mul_f32 v23, v23, v133
    v_mul_f32 v24, v24, v134
    v_mul_f32 v25, v25, v135
    v_mul_f32 v26, v26, v136
    v_mul_f32 v27, v27, v137
    v_mul_f32 v28, v28, v138
    v_mul_f32 v29, v29, v139
    v_cvt_pk_bf16_f32 v120, v10, v11
    v_lshlrev_b32 v10, 16, v120
    v_and_b32 v11, 0xffff0000, v120
    v_cvt_pk_bf16_f32 v120, v12, v13
    v_lshlrev_b32 v12, 16, v120
    v_and_b32 v13, 0xffff0000, v120
    v_cvt_pk_bf16_f32 v120, v14, v15
    v_lshlrev_b32 v14, 16, v120
    v_and_b32 v15, 0xffff0000, v120
    v_cvt_pk_bf16_f32 v120, v16, v17
    v_lshlrev_b32 v16, 16, v120
    v_and_b32 v17, 0xffff0000, v120
    v_cvt_pk_bf16_f32 v120, v18, v19
    v_lshlrev_b32 v18, 16, v120
    v_and_b32 v19, 0xffff0000, v120
    v_cvt_pk_bf16_f32 v120, v20, v21
    v_lshlrev_b32 v20, 16, v120
    v_and_b32 v21, 0xffff0000, v120
    v_cvt_pk_bf16_f32 v120, v22, v23
    v_lshlrev_b32 v22, 16, v120
    v_and_b32 v23, 0xffff0000, v120
    v_cvt_pk_bf16_f32 v120, v24, v25
    v_lshlrev_b32 v24, 16, v120
    v_and_b32 v25, 0xffff0000, v120
    v_cvt_pk_bf16_f32 v120, v26, v27
    v_lshlrev_b32 v26, 16, v120
    v_and_b32 v27, 0xffff0000, v120
    v_cvt_pk_bf16_f32 v120, v28, v29
    v_lshlrev_b32 v28, 16, v120
    v_and_b32 v29, 0xffff0000, v120
    v_mov_b32 v112, 0
    v_mov_b32 v113, 0
    v_mov_b32 v114, 0
    v_mov_b32 v115, 0
    v_mov_b32 v116, 0
    v_mov_b32 v117, 0
    v_mov_b32 v118, 0
    v_mov_b32 v119, 0
    s_waitcnt vmcnt(19)
    v_lshlrev_b32 v120, 16, v32
    v_and_b32 v121, 0xffff0000, v32
    v_fmac_f32 v112, v10, v120
    v_fmac_f32 v113, v10, v121
    v_lshlrev_b32 v120, 16, v33
    v_and_b32 v121, 0xffff0000, v33
    v_fmac_f32 v114, v10, v120
    v_fmac_f32 v115, v10, v121
    v_lshlrev_b32 v120, 16, v34
    v_and_b32 v121, 0xffff0000, v34
    v_fmac_f32 v116, v10, v120
    v_fmac_f32 v117, v10, v121
    v_lshlrev_b32 v120, 16, v35
    v_and_b32 v121, 0xffff0000, v35
    v_fmac_f32 v118, v10, v120
    v_fmac_f32 v119, v10, v121
    s_waitcnt vmcnt(18)
    v_lshlrev_b32 v120, 16, v36
    v_and_b32 v121, 0xffff0000, v36
    v_fmac_f32 v112, v11, v120
    v_fmac_f32 v113, v11, v121
    v_lshlrev_b32 v120, 16, v37
    v_and_b32 v121, 0xffff0000, v37
    v_fmac_f32 v114, v11, v120
    v_fmac_f32 v115, v11, v121
    v_lshlrev_b32 v120, 16, v38
    v_and_b32 v121, 0xffff0000, v38
    v_fmac_f32 v116, v11, v120
    v_fmac_f32 v117, v11, v121
    v_lshlrev_b32 v120, 16, v39
    v_and_b32 v121, 0xffff0000, v39
    v_fmac_f32 v118, v11, v120
    v_fmac_f32 v119, v11, v121
    s_waitcnt vmcnt(17)
    v_lshlrev_b32 v120, 16, v40
    v_and_b32 v121, 0xffff0000, v40
    v_fmac_f32 v112, v12, v120
    v_fmac_f32 v113, v12, v121
    v_lshlrev_b32 v120, 16, v41
    v_and_b32 v121, 0xffff0000, v41
    v_fmac_f32 v114, v12, v120
    v_fmac_f32 v115, v12, v121
    v_lshlrev_b32 v120, 16, v42
    v_and_b32 v121, 0xffff0000, v42
    v_fmac_f32 v116, v12, v120
    v_fmac_f32 v117, v12, v121
    v_lshlrev_b32 v120, 16, v43
    v_and_b32 v121, 0xffff0000, v43
    v_fmac_f32 v118, v12, v120
    v_fmac_f32 v119, v12, v121
    s_waitcnt vmcnt(16)
    v_lshlrev_b32 v120, 16, v44
    v_and_b32 v121, 0xffff0000, v44
    v_fmac_f32 v112, v13, v120
    v_fmac_f32 v113, v13, v121
    v_lshlrev_b32 v120, 16, v45
    v_and_b32 v121, 0xffff0000, v45
    v_fmac_f32 v114, v13, v120
    v_fmac_f32 v115, v13, v121
    v_lshlrev_b32 v120, 16, v46
    v_and_b32 v121, 0xffff0000, v46
    v_fmac_f32 v116, v13, v120
    v_fmac_f32 v117, v13, v121
    v_lshlrev_b32 v120, 16, v47
    v_and_b32 v121, 0xffff0000, v47
    v_fmac_f32 v118, v13, v120
    v_fmac_f32 v119, v13, v121
    s_waitcnt vmcnt(15)
    v_lshlrev_b32 v120, 16, v48
    v_and_b32 v121, 0xffff0000, v48
    v_fmac_f32 v112, v14, v120
    v_fmac_f32 v113, v14, v121
    v_lshlrev_b32 v120, 16, v49
    v_and_b32 v121, 0xffff0000, v49
    v_fmac_f32 v114, v14, v120
    v_fmac_f32 v115, v14, v121
    v_lshlrev_b32 v120, 16, v50
    v_and_b32 v121, 0xffff0000, v50
    v_fmac_f32 v116, v14, v120
    v_fmac_f32 v117, v14, v121
    v_lshlrev_b32 v120, 16, v51
    v_and_b32 v121, 0xffff0000, v51
    v_fmac_f32 v118, v14, v120
    v_fmac_f32 v119, v14, v121
    s_waitcnt vmcnt(14)
    v_lshlrev_b32 v120, 16, v52
    v_and_b32 v121, 0xffff0000, v52
    v_fmac_f32 v112, v15, v120
    v_fmac_f32 v113, v15, v121
    v_lshlrev_b32 v120, 16, v53
    v_and_b32 v121, 0xffff0000, v53
    v_fmac_f32 v114, v15, v120
    v_fmac_f32 v115, v15, v121
    v_lshlrev_b32 v120, 16, v54
    v_and_b32 v121, 0xffff0000, v54
    v_fmac_f32 v116, v15, v120
    v_fmac_f32 v117, v15, v121
    v_lshlrev_b32 v120, 16, v55
    v_and_b32 v121, 0xffff0000, v55
    v_fmac_f32 v118, v15, v120
    v_fmac_f32 v119, v15, v121
    s_waitcnt vmcnt(13)
    v_lshlrev_b32 v120, 16, v56
    v_and_b32 v121, 0xffff0000, v56
    v_fmac_f32 v112, v16, v120
    v_fmac_f32 v113, v16, v121
    v_lshlrev_b32 v120, 16, v57
    v_and_b32 v121, 0xffff0000, v57
    v_fmac_f32 v114, v16, v120
    v_fmac_f32 v115, v16, v121
    v_lshlrev_b32 v120, 16, v58
    v_and_b32 v121, 0xffff0000, v58
    v_fmac_f32 v116, v16, v120
    v_fmac_f32 v117, v16, v121
    v_lshlrev_b32 v120, 16, v59
    v_and_b32 v121, 0xffff0000, v59
    v_fmac_f32 v118, v16, v120
    v_fmac_f32 v119, v16, v121
    s_waitcnt vmcnt(12)
    v_lshlrev_b32 v120, 16, v60
    v_and_b32 v121, 0xffff0000, v60
    v_fmac_f32 v112, v17, v120
    v_fmac_f32 v113, v17, v121
    v_lshlrev_b32 v120, 16, v61
    v_and_b32 v121, 0xffff0000, v61
    v_fmac_f32 v114, v17, v120
    v_fmac_f32 v115, v17, v121
    v_lshlrev_b32 v120, 16, v62
    v_and_b32 v121, 0xffff0000, v62
    v_fmac_f32 v116, v17, v120
    v_fmac_f32 v117, v17, v121
    v_lshlrev_b32 v120, 16, v63
    v_and_b32 v121, 0xffff0000, v63
    v_fmac_f32 v118, v17, v120
    v_fmac_f32 v119, v17, v121
    s_waitcnt vmcnt(11)
    v_lshlrev_b32 v120, 16, v64
    v_and_b32 v121, 0xffff0000, v64
    v_fmac_f32 v112, v18, v120
    v_fmac_f32 v113, v18, v121
    v_lshlrev_b32 v120, 16, v65
    v_and_b32 v121, 0xffff0000, v65
    v_fmac_f32 v114, v18, v120
    v_fmac_f32 v115, v18, v121
    v_lshlrev_b32 v120, 16, v66
    v_and_b32 v121, 0xffff0000, v66
    v_fmac_f32 v116, v18, v120
    v_fmac_f32 v117, v18, v121
    v_lshlrev_b32 v120, 16, v67
    v_and_b32 v121, 0xffff0000, v67
    v_fmac_f32 v118, v18, v120
    v_fmac_f32 v119, v18, v121
    s_waitcnt vmcnt(10)
    v_lshlrev_b32 v120, 16, v68
    v_and_b32 v121, 0xffff0000, v68
    v_fmac_f32 v112, v19, v120
    v_fmac_f32 v113, v19, v121
    v_lshlrev_b32 v120, 16, v69
    v_and_b32 v121, 0xffff0000, v69
    v_fmac_f32 v114, v19, v120
    v_fmac_f32 v115, v19, v121
    v_lshlrev_b32 v120, 16, v70
    v_and_b32 v121, 0xffff0000, v70
    v_fmac_f32 v116, v19, v120
    v_fmac_f32 v117, v19, v121
    v_lshlrev_b32 v120, 16, v71
    v_and_b32 v121, 0xffff0000, v71
    v_fmac_f32 v118, v19, v120
    v_fmac_f32 v119, v19, v121
    s_waitcnt vmcnt(9)
    v_lshlrev_b32 v120, 16, v72
    v_and_b32 v121, 0xffff0000, v72
    v_fmac_f32 v112, v20, v120
    v_fmac_f32 v113, v20, v121
    v_lshlrev_b32 v120, 16, v73
    v_and_b32 v121, 0xffff0000, v73
    v_fmac_f32 v114, v20, v120
    v_fmac_f32 v115, v20, v121
    v_lshlrev_b32 v120, 16, v74
    v_and_b32 v121, 0xffff0000, v74
    v_fmac_f32 v116, v20, v120
    v_fmac_f32 v117, v20, v121
    v_lshlrev_b32 v120, 16, v75
    v_and_b32 v121, 0xffff0000, v75
    v_fmac_f32 v118, v20, v120
    v_fmac_f32 v119, v20, v121
    s_waitcnt vmcnt(8)
    v_lshlrev_b32 v120, 16, v76
    v_and_b32 v121, 0xffff0000, v76
    v_fmac_f32 v112, v21, v120
    v_fmac_f32 v113, v21, v121
    v_lshlrev_b32 v120, 16, v77
    v_and_b32 v121, 0xffff0000, v77
    v_fmac_f32 v114, v21, v120
    v_fmac_f32 v115, v21, v121
    v_lshlrev_b32 v120, 16, v78
    v_and_b32 v121, 0xffff0000, v78
    v_fmac_f32 v116, v21, v120
    v_fmac_f32 v117, v21, v121
    v_lshlrev_b32 v120, 16, v79
    v_and_b32 v121, 0xffff0000, v79
    v_fmac_f32 v118, v21, v120
    v_fmac_f32 v119, v21, v121
    s_waitcnt vmcnt(7)
    v_lshlrev_b32 v120, 16, v80
    v_and_b32 v121, 0xffff0000, v80
    v_fmac_f32 v112, v22, v120
    v_fmac_f32 v113, v22, v121
    v_lshlrev_b32 v120, 16, v81
    v_and_b32 v121, 0xffff0000, v81
    v_fmac_f32 v114, v22, v120
    v_fmac_f32 v115, v22, v121
    v_lshlrev_b32 v120, 16, v82
    v_and_b32 v121, 0xffff0000, v82
    v_fmac_f32 v116, v22, v120
    v_fmac_f32 v117, v22, v121
    v_lshlrev_b32 v120, 16, v83
    v_and_b32 v121, 0xffff0000, v83
    v_fmac_f32 v118, v22, v120
    v_fmac_f32 v119, v22, v121
    s_waitcnt vmcnt(6)
    v_lshlrev_b32 v120, 16, v84
    v_and_b32 v121, 0xffff0000, v84
    v_fmac_f32 v112, v23, v120
    v_fmac_f32 v113, v23, v121
    v_lshlrev_b32 v120, 16, v85
    v_and_b32 v121, 0xffff0000, v85
    v_fmac_f32 v114, v23, v120
    v_fmac_f32 v115, v23, v121
    v_lshlrev_b32 v120, 16, v86
    v_and_b32 v121, 0xffff0000, v86
    v_fmac_f32 v116, v23, v120
    v_fmac_f32 v117, v23, v121
    v_lshlrev_b32 v120, 16, v87
    v_and_b32 v121, 0xffff0000, v87
    v_fmac_f32 v118, v23, v120
    v_fmac_f32 v119, v23, v121
    s_waitcnt vmcnt(5)
    v_lshlrev_b32 v120, 16, v88
    v_and_b32 v121, 0xffff0000, v88
    v_fmac_f32 v112, v24, v120
    v_fmac_f32 v113, v24, v121
    v_lshlrev_b32 v120, 16, v89
    v_and_b32 v121, 0xffff0000, v89
    v_fmac_f32 v114, v24, v120
    v_fmac_f32 v115, v24, v121
    v_lshlrev_b32 v120, 16, v90
    v_and_b32 v121, 0xffff0000, v90
    v_fmac_f32 v116, v24, v120
    v_fmac_f32 v117, v24, v121
    v_lshlrev_b32 v120, 16, v91
    v_and_b32 v121, 0xffff0000, v91
    v_fmac_f32 v118, v24, v120
    v_fmac_f32 v119, v24, v121
    s_waitcnt vmcnt(4)
    v_lshlrev_b32 v120, 16, v92
    v_and_b32 v121, 0xffff0000, v92
    v_fmac_f32 v112, v25, v120
    v_fmac_f32 v113, v25, v121
    v_lshlrev_b32 v120, 16, v93
    v_and_b32 v121, 0xffff0000, v93
    v_fmac_f32 v114, v25, v120
    v_fmac_f32 v115, v25, v121
    v_lshlrev_b32 v120, 16, v94
    v_and_b32 v121, 0xffff0000, v94
    v_fmac_f32 v116, v25, v120
    v_fmac_f32 v117, v25, v121
    v_lshlrev_b32 v120, 16, v95
    v_and_b32 v121, 0xffff0000, v95
    v_fmac_f32 v118, v25, v120
    v_fmac_f32 v119, v25, v121
    s_waitcnt vmcnt(3)
    v_lshlrev_b32 v120, 16, v96
    v_and_b32 v121, 0xffff0000, v96
    v_fmac_f32 v112, v26, v120
    v_fmac_f32 v113, v26, v121
    v_lshlrev_b32 v120, 16, v97
    v_and_b32 v121, 0xffff0000, v97
    v_fmac_f32 v114, v26, v120
    v_fmac_f32 v115, v26, v121
    v_lshlrev_b32 v120, 16, v98
    v_and_b32 v121, 0xffff0000, v98
    v_fmac_f32 v116, v26, v120
    v_fmac_f32 v117, v26, v121
    v_lshlrev_b32 v120, 16, v99
    v_and_b32 v121, 0xffff0000, v99
    v_fmac_f32 v118, v26, v120
    v_fmac_f32 v119, v26, v121
    s_waitcnt vmcnt(2)
    v_lshlrev_b32 v120, 16, v100
    v_and_b32 v121, 0xffff0000, v100
    v_fmac_f32 v112, v27, v120
    v_fmac_f32 v113, v27, v121
    v_lshlrev_b32 v120, 16, v101
    v_and_b32 v121, 0xffff0000, v101
    v_fmac_f32 v114, v27, v120
    v_fmac_f32 v115, v27, v121
    v_lshlrev_b32 v120, 16, v102
    v_and_b32 v121, 0xffff0000, v102
    v_fmac_f32 v116, v27, v120
    v_fmac_f32 v117, v27, v121
    v_lshlrev_b32 v120, 16, v103
    v_and_b32 v121, 0xffff0000, v103
    v_fmac_f32 v118, v27, v120
    v_fmac_f32 v119, v27, v121
    s_waitcnt vmcnt(1)
    v_lshlrev_b32 v120, 16, v104
    v_and_b32 v121, 0xffff0000, v104
    v_fmac_f32 v112, v28, v120
    v_fmac_f32 v113, v28, v121
    v_lshlrev_b32 v120, 16, v105
    v_and_b32 v121, 0xffff0000, v105
    v_fmac_f32 v114, v28, v120
    v_fmac_f32 v115, v28, v121
    v_lshlrev_b32 v120, 16, v106
    v_and_b32 v121, 0xffff0000, v106
    v_fmac_f32 v116, v28, v120
    v_fmac_f32 v117, v28, v121
    v_lshlrev_b32 v120, 16, v107
    v_and_b32 v121, 0xffff0000, v107
    v_fmac_f32 v118, v28, v120
    v_fmac_f32 v119, v28, v121
    s_waitcnt vmcnt(0)
    v_lshlrev_b32 v120, 16, v108
    v_and_b32 v121, 0xffff0000, v108
    v_fmac_f32 v112, v29, v120
    v_fmac_f32 v113, v29, v121
    v_lshlrev_b32 v120, 16, v109
    v_and_b32 v121, 0xffff0000, v109
    v_fmac_f32 v114, v29, v120
    v_fmac_f32 v115, v29, v121
    v_lshlrev_b32 v120, 16, v110
    v_and_b32 v121, 0xffff0000, v110
    v_fmac_f32 v116, v29, v120
    v_fmac_f32 v117, v29, v121
    v_lshlrev_b32 v120, 16, v111
    v_and_b32 v121, 0xffff0000, v111
    v_fmac_f32 v118, v29, v120
    v_fmac_f32 v119, v29, v121
    v_lshlrev_b32 v7, 5, v0
    ds_write_b128 v7, v[112:115]
    ds_write_b128 v7, v[116:119] offset:16
    s_waitcnt lgkmcnt(0)
    s_barrier
    v_cmp_gt_u32 vcc, 64, v0
    s_and_saveexec_b64 s[42:43], vcc
    s_cbranch_execz k1_end
    v_lshlrev_b32 v7, 2, v0
    ds_read_b32 v32, v7 offset:0
    ds_read_b32 v33, v7 offset:256
    ds_read_b32 v34, v7 offset:512
    ds_read_b32 v35, v7 offset:768
    ds_read_b32 v36, v7 offset:1024
    ds_read_b32 v37, v7 offset:1280
    ds_read_b32 v38, v7 offset:1536
    ds_read_b32 v39, v7 offset:1792
    ds_read_b32 v40, v7 offset:2048
    ds_read_b32 v41, v7 offset:2304
    ds_read_b32 v42, v7 offset:2560
    ds_read_b32 v43, v7 offset:2816
    ds_read_b32 v44, v7 offset:3072
    ds_read_b32 v45, v7 offset:3328
    ds_read_b32 v46, v7 offset:3584
    ds_read_b32 v47, v7 offset:3840
    ds_read_b32 v48, v7 offset:4096
    ds_read_b32 v49, v7 offset:4352
    ds_read_b32 v50, v7 offset:4608
    ds_read_b32 v51, v7 offset:4864
    ds_read_b32 v52, v7 offset:5120
    ds_read_b32 v53, v7 offset:5376
    ds_read_b32 v54, v7 offset:5632
    ds_read_b32 v55, v7 offset:5888
    ds_read_b32 v56, v7 offset:6144
    ds_read_b32 v57, v7 offset:6400
    ds_read_b32 v58, v7 offset:6656
    ds_read_b32 v59, v7 offset:6912
    ds_read_b32 v60, v7 offset:7168
    ds_read_b32 v61, v7 offset:7424
    ds_read_b32 v62, v7 offset:7680
    ds_read_b32 v63, v7 offset:7936
    s_waitcnt lgkmcnt(0)
    v_add_f32 v32, v32, v48
    v_add_f32 v33, v33, v49
    v_add_f32 v34, v34, v50
    v_add_f32 v35, v35, v51
    v_add_f32 v36, v36, v52
    v_add_f32 v37, v37, v53
    v_add_f32 v38, v38, v54
    v_add_f32 v39, v39, v55
    v_add_f32 v40, v40, v56
    v_add_f32 v41, v41, v57
    v_add_f32 v42, v42, v58
    v_add_f32 v43, v43, v59
    v_add_f32 v44, v44, v60
    v_add_f32 v45, v45, v61
    v_add_f32 v46, v46, v62
    v_add_f32 v47, v47, v63
    v_add_f32 v32, v32, v40
    v_add_f32 v33, v33, v41
    v_add_f32 v34, v34, v42
    v_add_f32 v35, v35, v43
    v_add_f32 v36, v36, v44
    v_add_f32 v37, v37, v45
    v_add_f32 v38, v38, v46
    v_add_f32 v39, v39, v47
    v_add_f32 v32, v32, v36
    v_add_f32 v33, v33, v37
    v_add_f32 v34, v34, v38
    v_add_f32 v35, v35, v39
    v_add_f32 v32, v32, v34
    v_add_f32 v33, v33, v35
    v_add_f32 v32, v32, v33
    s_movk_i32 s22, 640
    v_cvt_pk_bf16_f32 v32, v32, v32
    v_lshlrev_b32 v32, 16, v32
    v_add_f32 v33, 1.0, v32
    v_cvt_pk_bf16_f32 v33, v33, v33
    v_lshlrev_b32 v33, 16, v33
    s_lshl_b32 s33, s32, 6
    v_add_u32 v34, s33, v0
    v_subrev_u32 v35, 640, v34
    v_cmp_gt_u32 vcc, 640, v35
    v_subrev_u32 v35, 2560, v34
    v_cmp_gt_u32 s[40:41], s22, v35
    s_or_b64 vcc, vcc, s[40:41]
    v_cndmask_b32 v32, v32, v33, vcc
    s_lshl_b32 s21, s32, 8
    s_add_u32 s21, s21, 2711552
    buffer_store_dword v32, v7, s[28:31], s21 offen sc1
k1_end:
    s_endpgm
k1_pf:
    s_waitcnt lgkmcnt(0)
    s_load_dwordx2 s[4:5], s[0:1], 0
    v_lshlrev_b32 v3, 7, v1
    v_lshlrev_b32 v1, 4, v1
    s_sub_u32 s24, s54, 96
    s_lshr_b32 s24, s24, 3
    s_lshl_b32 s24, s24, 2
    s_add_u32 s24, s24, s20
    s_and_b32 s22, s2, 7
    s_mul_i32 s21, s24, 20480
    s_mul_i32 s23, s22, 327680
    s_add_u32 s21, s21, s23
    s_waitcnt lgkmcnt(0)
    s_mov_b32 s16, s4
    s_mov_b32 s17, s5
    s_mov_b32 s18, 2621440
    s_mov_b32 s19, 0x00020000
    s_mov_b32 s28, s10
    s_mov_b32 s29, s11
    s_mov_b32 s30, 268435456
    s_mov_b32 s31, 0x00020000
    s_sub_u32 s36, s54, 96
    s_cmp_ge_u32 s36, 16
    s_cbranch_scc1 k1_kernel_zf21
    s_lshl_b32 s36, s36, 12
    s_add_u32 s36, s36, 8990720
    v_lshlrev_b32 v5, 4, v0
    v_mov_b32 v60, 0
    v_mov_b32 v61, 0
    v_mov_b32 v62, 0
    v_mov_b32 v63, 0
    buffer_store_dwordx4 v[60:63], v5, s[28:31], s36 offen sc1
k1_kernel_zf21:
    s_getpc_b64 s[40:41]
k1_pcref:
    s_sub_u32 s40, s40, k1_pcref-k1_kernel
    s_subb_u32 s41, s41, 0
    s_lshl_b32 s42, s24, 12
    s_add_u32 s43, s42, 0
    s_min_u32 s43, s43, (CODE_END-k1_kernel-1020)&0xfffffff0
    v_add_u32 v6, s43, v1
    global_load_dwordx4 v[64:67], v6, s[40:41]
    s_add_u32 s43, s42, 1024
    s_min_u32 s43, s43, (CODE_END-k1_kernel-1020)&0xfffffff0
    v_add_u32 v6, s43, v1
    global_load_dwordx4 v[68:71], v6, s[40:41]
    s_add_u32 s43, s42, 2048
    s_min_u32 s43, s43, (CODE_END-k1_kernel-1020)&0xfffffff0
    v_add_u32 v6, s43, v1
    global_load_dwordx4 v[72:75], v6, s[40:41]
    s_add_u32 s43, s42, 3072
    s_min_u32 s43, s43, (CODE_END-k1_kernel-1020)&0xfffffff0
    v_add_u32 v6, s43, v1
    global_load_dwordx4 v[76:79], v6, s[40:41]
    s_and_b32 s55, s2, 7
    s_lshl_b32 s57, s55, 9
    s_add_u32 s57, s57, 9056256
    v_mov_b32 v250, 0
    v_and_b32 v5, 31, v0
    v_lshlrev_b32 v5, 2, v5
    buffer_load_dword v251, v250, s[28:31], s57 offen sc1
    s_mov_b32 s44, 12
    s_waitcnt vmcnt(0)
    v_add_u32 v251, 1, v251
k1_kernel_pw22:
    buffer_load_dword v6, v5, s[28:31], s57 offen offset:256 sc1
    s_waitcnt vmcnt(0)
    v_cmp_eq_u32 vcc, v251, v6
    s_sub_u32 s44, s44, 1
    s_cmp_eq_u64 vcc, -1
    s_cbranch_scc1 k1_kernel_pw23
    s_sleep 64
    s_cmp_lg_u32 s44, 0
    s_cbranch_scc1 k1_kernel_pw22
k1_kernel_pw23:
    buffer_load_dwordx4 v[8:11], v1, s[16:19], s21 offen offset:0
    buffer_load_dwordx4 v[12:15], v1, s[16:19], s21 offen offset:1024
    buffer_load_dwordx4 v[16:19], v1, s[16:19], s21 offen offset:2048
    buffer_load_dwordx4 v[20:23], v1, s[16:19], s21 offen offset:3072
    s_add_u32 s21, s21, 4096
    buffer_load_dwordx4 v[24:27], v1, s[16:19], s21 offen offset:0
    buffer_load_dwordx4 v[28:31], v1, s[16:19], s21 offen offset:1024
    buffer_load_dwordx4 v[32:35], v1, s[16:19], s21 offen offset:2048
    buffer_load_dwordx4 v[36:39], v1, s[16:19], s21 offen offset:3072
    s_add_u32 s21, s21, 4096
    buffer_load_dwordx4 v[40:43], v1, s[16:19], s21 offen offset:0
    buffer_load_dwordx4 v[44:47], v1, s[16:19], s21 offen offset:1024
    buffer_load_dwordx4 v[8:11], v1, s[16:19], s21 offen offset:2048
    buffer_load_dwordx4 v[12:15], v1, s[16:19], s21 offen offset:3072
    s_add_u32 s21, s21, 4096
    buffer_load_dwordx4 v[16:19], v1, s[16:19], s21 offen offset:0
    buffer_load_dwordx4 v[20:23], v1, s[16:19], s21 offen offset:1024
    buffer_load_dwordx4 v[24:27], v1, s[16:19], s21 offen offset:2048
    buffer_load_dwordx4 v[28:31], v1, s[16:19], s21 offen offset:3072
    s_add_u32 s21, s21, 4096
    buffer_load_dwordx4 v[32:35], v1, s[16:19], s21 offen offset:0
    buffer_load_dwordx4 v[36:39], v1, s[16:19], s21 offen offset:1024
    buffer_load_dwordx4 v[40:43], v1, s[16:19], s21 offen offset:2048
    buffer_load_dwordx4 v[44:47], v1, s[16:19], s21 offen offset:3072
    s_add_u32 s21, s21, 4096
    s_mul_i32 s22, s22, 1601536
    s_add_u32 s22, s22, 9060352
    s_waitcnt vmcnt(0)
    s_endpgm
.globl k2_kernel
.p2align 8
.type k2_kernel,@function
k2_kernel:
    s_cmp_ge_u32 s2, 256
    s_cbranch_scc1 k2_end
    s_load_dwordx2 s[4:5], s[0:1], 0
    s_load_dwordx2 s[6:7], s[0:1], 104
    s_load_dwordx2 s[8:9], s[0:1], 120
    s_getreg_b32 s42, hwreg(HW_REG_XCC_ID, 0, 4)
    v_lshrrev_b32 v2, 6, v0
    v_and_b32 v1, 63, v0
    v_readfirstlane_b32 s30, v2
    s_and_b32 s28, s2, 7
    s_lshr_b32 s29, s2, 3
    s_lshr_b32 s32, s29, 3
    s_and_b32 s33, s29, 7
    s_lshr_b32 s34, s29, 4
    s_and_b32 s35, s29, 15
    s_mul_i32 s36, s28, 1601536
    s_add_u32 s36, s36, 9060352
    s_lshl_b32 s37, s28, 13
    s_add_u32 s37, s37, 8990720
    s_add_u32 s42, s42, 1
    s_mov_b32 s31, 0
    v_lshlrev_b32 v2, 4, v1
    v_lshrrev_b32 v3, 4, v1
    v_and_b32 v4, 15, v1
    v_lshrrev_b32 v8, 1, v3
    v_lshl_add_u32 v8, v8, 4, v4
    v_and_b32 v9, 1, v3
    v_lshl_add_u32 v8, v8, 1, v9
    v_lshlrev_b32 v8, 3, v8
    v_lshlrev_b32 v5, 7, v1
    v_and_b32 v9, 1, v3
    v_lshlrev_b32 v9, 1, v9
    v_lshrrev_b32 v10, 1, v3
    v_or_b32 v9, v9, v10
    v_lshlrev_b32 v9, 8, v9
    v_lshl_add_u32 v254, v4, 4, v9
    s_waitcnt lgkmcnt(0)
    s_mov_b32 s12, s8
    s_mov_b32 s13, s9
    s_mov_b32 s14, 268435456
    s_mov_b32 s15, 0x00020000
    s_mov_b32 s16, s4
    s_mov_b32 s17, s5
    s_mov_b32 s18, 2621440
    s_mov_b32 s19, 0x00020000
    s_mov_b32 s24, s6
    s_mov_b32 s25, s7
    s_mov_b32 s26, 2621440
    s_mov_b32 s27, 0x00020000
    s_cmp_lg_u32 s30, 0
    s_cbranch_scc1 k2_kernel_L1
    s_lshl_b32 s41, s29, 2
    s_add_u32 s41, s41, s37
    v_mov_b32 v9, s42
    v_mov_b32 v10, 7424
    s_mov_b64 exec, 1
    buffer_store_dword v9, v10, s[12:15], s41 offen sc1
    s_mov_b64 exec, -1
k2_kernel_L1:
    s_mul_i32 s44, s33, 102400
    s_mul_i32 s45, s35, 143360
    s_add_u32 s45, s45, 4403200
    s_mul_i32 s40, s33, 286720
    s_mul_i32 s41, s30, 71680
    s_add_u32 s40, s40, s41
    s_add_u32 s40, s40, 6696960
    s_lshl_b32 s46, s32, 2
    s_add_u32 s46, s46, s30
    s_mul_i32 s47, s46, 20480
    s_mul_i32 s41, s33, 2560
    s_add_u32 s47, s47, s41
    s_add_u32 s54, s47, s36
    s_lshl_b32 s55, s46, 7
    s_add_u32 s55, s55, s37
    s_mul_i32 s22, s28, 327680
    s_add_u32 s22, s22, s47
    s_add_u32 s22, s22, 0
    s_mul_i32 s38, s30, 25600
    s_add_u32 s39, s38, s44
    s_add_u32 s39, s39, 2764800
    s_add_u32 s38, s38, 0
    s_cmp_ge_u32 s29, 18
    s_cbranch_scc1 k2_kernel_nob02
    s_lshl_b32 s46, s28, 8
    s_lshl_b32 s47, s29, 4
    s_add_u32 s46, s46, s47
    s_sub_u32 s46, s46, 16
    s_lshl_b32 s47, s30, 2
    s_add_u32 s47, s47, s46
    v_add_u32 v11, s47, v3
    s_movk_i32 s48, 1280
    v_mul_lo_u32 v6, v11, s48
    v_lshl_add_u32 v6, v4, 4, v6
    buffer_load_dwordx4 v[16:19], v6, s[16:19], 0 offen offset:0
    buffer_load_dwordx4 v[20:23], v6, s[16:19], 0 offen offset:256
    buffer_load_dwordx4 v[24:27], v6, s[16:19], 0 offen offset:512
    buffer_load_dwordx4 v[28:31], v6, s[16:19], 0 offen offset:768
    buffer_load_dwordx4 v[32:35], v6, s[16:19], 0 offen offset:1024
    s_mul_i32 s47, s29, 20480
    s_mul_i32 s48, s30, 5120
    s_add_u32 s47, s47, s48
    s_add_u32 s47, s47, s36
    s_cmp_lt_u32 s46, 2048
    s_cselect_b32 s47, s47, 0x80000000
    v_add_u32 v12, s47, v2
    s_add_u32 s48, s48, 135168
    s_mov_b32 m0, s48
    s_nop 0
    buffer_load_dwordx4 v12, s[12:15], 0 offen offset:0 lds
    buffer_load_dwordx4 v12, s[12:15], 0 offen offset:1024 lds
    buffer_load_dwordx4 v12, s[12:15], 0 offen offset:2048 lds
    buffer_load_dwordx4 v12, s[12:15], 0 offen offset:3072 lds
    s_add_u32 s48, s48, 4096
    s_mov_b32 m0, s48
    s_movk_i32 s47, 4096
    buffer_load_dwordx4 v12, s[12:15], s47 offen lds
    s_lshl_b32 s47, s30, 12
    s_add_u32 s48, s47, 118784
    s_mov_b32 m0, s48
    s_add_u32 s47, s47, 2711552
    buffer_load_dwordx4 v2, s[12:15], s47 offen offset:0 lds
    buffer_load_dwordx4 v2, s[12:15], s47 offen offset:1024 lds
    buffer_load_dwordx4 v2, s[12:15], s47 offen offset:2048 lds
    buffer_load_dwordx4 v2, s[12:15], s47 offen offset:3072 lds
    v_lshl_add_u32 v15, s30, 2, v3
    v_lshrrev_b32 v7, 1, v15
    v_and_b32 v9, 7, v4
    v_xor_b32 v7, v7, v9
    v_and_b32 v9, 1, v15
    v_lshl_add_u32 v7, v7, 1, v9
    v_lshlrev_b32 v7, 3, v7
    v_lshl_add_u32 v7, v4, 8, v7
    v_add_u32 v7, 135168, v7
    v_lshlrev_b32 v10, 5, v4
    v_add_u32 v10, 118784, v10
    v_lshrrev_b32 v12, 2, v4
    v_and_b32 v13, 3, v4
    v_lshl_add_u32 v13, v13, 4, v15
    v_lshlrev_b32 v13, 4, v13
    v_lshl_add_u32 v6, v12, 10, v13
    s_movk_i32 s48, 2048
    v_cmp_gt_u32 s[50:51], s48, v11
    v_mov_b32 v120, 0
    v_mov_b32 v121, 0
    v_mov_b32 v124, 0
    v_mov_b32 v125, 0
    v_mov_b32 v126, 0x3f803f80
    s_waitcnt vmcnt(9)
    v_dot2_f32_bf16 v120, v16, v126, v120
    v_dot2_f32_bf16 v121, v16, v16, v121
    v_lshlrev_b32 v56, 16, v16
    v_and_b32 v57, 0xffff0000, v16
    v_dot2_f32_bf16 v120, v17, v126, v120
    v_dot2_f32_bf16 v121, v17, v17, v121
    v_lshlrev_b32 v58, 16, v17
    v_and_b32 v59, 0xffff0000, v17
    v_dot2_f32_bf16 v120, v18, v126, v120
    v_dot2_f32_bf16 v121, v18, v18, v121
    v_lshlrev_b32 v60, 16, v18
    v_and_b32 v61, 0xffff0000, v18
    s_cmp_eq_u32 s30, 1
    s_cbranch_scc1 k2_kernel_sm4
    s_cmp_ge_u32 s30, 2
    s_cbranch_scc1 k2_kernel_sm5
    s_mul_i32 s41, s33, 320
    s_add_u32 s41, s41, 2748416
    s_mov_b32 m0, 155648
    s_mov_b64 exec, 0xfffff
    buffer_load_dwordx4 v2, s[12:15], s41 offen lds
    s_add_u32 s41, s41, 7168
    s_mov_b32 m0, 156160
    s_nop 0
    buffer_load_dwordx4 v2, s[12:15], s41 offen lds
    s_branch k2_kernel_sm6
k2_kernel_sm4:
    s_mul_i32 s41, s35, 448
    s_add_u32 s41, s41, 2732032
    s_mov_b32 m0, 156672
    s_mov_b64 exec, 0xfffffff
    buffer_load_dwordx4 v2, s[12:15], s41 offen lds
    s_add_u32 s41, s41, 7168
    s_mov_b32 m0, 157184
    s_nop 0
    buffer_load_dwordx4 v2, s[12:15], s41 offen lds
    s_branch k2_kernel_sm6
k2_kernel_sm5:
    s_mul_i32 s41, s33, 320
    s_add_u32 s41, s41, 2724352
    s_mov_b32 m0, 157696
    s_mov_b64 exec, 0xfffff
    buffer_load_dwordx4 v2, s[12:15], s41 offen lds
k2_kernel_sm6:
    s_mov_b64 exec, -1
    v_dot2_f32_bf16 v120, v19, v126, v120
    v_dot2_f32_bf16 v121, v19, v19, v121
    v_lshlrev_b32 v62, 16, v19
    v_and_b32 v63, 0xffff0000, v19
    v_dot2_f32_bf16 v120, v20, v126, v120
    v_dot2_f32_bf16 v121, v20, v20, v121
    v_lshlrev_b32 v64, 16, v20
    v_and_b32 v65, 0xffff0000, v20
    s_mov_b32 m0, s38
    s_nop 0
    buffer_load_dwordx4 v2, s[12:15], s39 offen offset:0 lds
    v_dot2_f32_bf16 v120, v21, v126, v120
    v_dot2_f32_bf16 v121, v21, v21, v121
    v_lshlrev_b32 v66, 16, v21
    v_and_b32 v67, 0xffff0000, v21
    v_dot2_f32_bf16 v120, v22, v126, v120
    v_dot2_f32_bf16 v121, v22, v22, v121
    v_lshlrev_b32 v68, 16, v22
    v_and_b32 v69, 0xffff0000, v22
    s_mov_b32 m0, s38
    s_nop 0
    buffer_load_dwordx4 v2, s[12:15], s39 offen offset:1024 lds
    v_dot2_f32_bf16 v120, v23, v126, v120
    v_dot2_f32_bf16 v121, v23, v23, v121
    v_lshlrev_b32 v70, 16, v23
    v_and_b32 v71, 0xffff0000, v23
    v_dot2_f32_bf16 v120, v24, v126, v120
    v_dot2_f32_bf16 v121, v24, v24, v121
    v_lshlrev_b32 v72, 16, v24
    v_and_b32 v73, 0xffff0000, v24
    s_mov_b32 m0, s38
    s_nop 0
    buffer_load_dwordx4 v2, s[12:15], s39 offen offset:2048 lds
    v_dot2_f32_bf16 v120, v25, v126, v120
    v_dot2_f32_bf16 v121, v25, v25, v121
    v_lshlrev_b32 v74, 16, v25
    v_and_b32 v75, 0xffff0000, v25
    v_dot2_f32_bf16 v120, v26, v126, v120
    v_dot2_f32_bf16 v121, v26, v26, v121
    v_lshlrev_b32 v76, 16, v26
    v_and_b32 v77, 0xffff0000, v26
    s_mov_b32 m0, s38
    s_nop 0
    buffer_load_dwordx4 v2, s[12:15], s39 offen offset:3072 lds
    s_add_u32 s38, s38, 4096
    s_add_u32 s39, s39, 4096
    v_dot2_f32_bf16 v120, v27, v126, v120
    v_dot2_f32_bf16 v121, v27, v27, v121
    v_lshlrev_b32 v78, 16, v27
    v_and_b32 v79, 0xffff0000, v27
    v_dot2_f32_bf16 v120, v28, v126, v120
    v_dot2_f32_bf16 v121, v28, v28, v121
    v_lshlrev_b32 v80, 16, v28
    v_and_b32 v81, 0xffff0000, v28
    s_mov_b32 m0, s38
    s_nop 0
    buffer_load_dwordx4 v2, s[12:15], s39 offen offset:0 lds
    v_dot2_f32_bf16 v120, v29, v126, v120
    v_dot2_f32_bf16 v121, v29, v29, v121
    v_lshlrev_b32 v82, 16, v29
    v_and_b32 v83, 0xffff0000, v29
    v_dot2_f32_bf16 v120, v30, v126, v120
    v_dot2_f32_bf16 v121, v30, v30, v121
    v_lshlrev_b32 v84, 16, v30
    v_and_b32 v85, 0xffff0000, v30
    s_mov_b32 m0, s38
    s_nop 0
    buffer_load_dwordx4 v2, s[12:15], s39 offen offset:1024 lds
    v_dot2_f32_bf16 v120, v31, v126, v120
    v_dot2_f32_bf16 v121, v31, v31, v121
    v_lshlrev_b32 v86, 16, v31
    v_and_b32 v87, 0xffff0000, v31
    v_dot2_f32_bf16 v120, v32, v126, v120
    v_dot2_f32_bf16 v121, v32, v32, v121
    v_lshlrev_b32 v88, 16, v32
    v_and_b32 v89, 0xffff0000, v32
    s_mov_b32 m0, s38
    s_nop 0
    buffer_load_dwordx4 v2, s[12:15], s39 offen offset:2048 lds
    v_dot2_f32_bf16 v120, v33, v126, v120
    v_dot2_f32_bf16 v121, v33, v33, v121
    v_lshlrev_b32 v90, 16, v33
    v_and_b32 v91, 0xffff0000, v33
    v_dot2_f32_bf16 v120, v34, v126, v120
    v_dot2_f32_bf16 v121, v34, v34, v121
    v_lshlrev_b32 v92, 16, v34
    v_and_b32 v93, 0xffff0000, v34
    s_mov_b32 m0, s38
    s_nop 0
    buffer_load_dwordx4 v2, s[12:15], s39 offen offset:3072 lds
    s_add_u32 s38, s38, 4096
    s_add_u32 s39, s39, 4096
    v_dot2_f32_bf16 v120, v35, v126, v120
    v_dot2_f32_bf16 v121, v35, v35, v121
    v_lshlrev_b32 v94, 16, v35
    v_and_b32 v95, 0xffff0000, v35
    s_nop 1
    s_nop 0
    v_add_f32_dpp v120, v120, v120 quad_perm:[1,0,3,2] row_mask:0xf bank_mask:0xf
    v_add_f32_dpp v121, v121, v121 quad_perm:[1,0,3,2] row_mask:0xf bank_mask:0xf
    s_nop 0
    v_add_f32_dpp v120, v120, v120 quad_perm:[2,3,0,1] row_mask:0xf bank_mask:0xf
    v_add_f32_dpp v121, v121, v121 quad_perm:[2,3,0,1] row_mask:0xf bank_mask:0xf
    s_nop 0
    v_add_f32_dpp v120, v120, v120 row_half_mirror row_mask:0xf bank_mask:0xf
    v_add_f32_dpp v121, v121, v121 row_half_mirror row_mask:0xf bank_mask:0xf
    s_nop 0
    v_add_f32_dpp v120, v120, v120 row_mirror row_mask:0xf bank_mask:0xf
    v_add_f32_dpp v121, v121, v121 row_mirror row_mask:0xf bank_mask:0xf
    v_mul_f32 v120, 0x3acccccd, v120
    v_mul_f32 v121, 0x3acccccd, v121
    v_fma_f32 v121, -v120, v120, v121
    v_max_f32 v121, 0, v121
    v_cvt_pk_bf16_f32 v122, v120, v121
    v_lshlrev_b32 v120, 16, v122
    v_and_b32 v121, 0xffff0000, v122
    v_add_f32 v121, 0x3727c5ac, v121
    v_cvt_pk_bf16_f32 v122, v121, v121
    v_lshlrev_b32 v121, 16, v122
    v_sqrt_f32 v121, v121
    s_nop 0
    v_cvt_pk_bf16_f32 v122, v121, v121
    v_lshlrev_b32 v121, 16, v122
    v_rcp_f32 v121, v121
    s_nop 0
    v_mul_f32 v120, v120, v121
    v_sub_f32 v120, 0, v120
    s_waitcnt vmcnt(9)
    s_barrier
    ds_read_b64 v[36:37], v7 offset:0
    ds_read_b64 v[38:39], v7 offset:128
    ds_read_b64 v[40:41], v7 offset:4096
    ds_read_b64 v[42:43], v7 offset:4224
    ds_read_b64 v[44:45], v7 offset:8192
    ds_read_b64 v[46:47], v7 offset:8320
    ds_read_b64 v[48:49], v7 offset:12288
    ds_read_b64 v[50:51], v7 offset:12416
    ds_read_b64 v[52:53], v7 offset:16384
    ds_read_b64 v[54:55], v7 offset:16512
    ds_read_b128 v[96:99], v10 offset:2560
    ds_read_b128 v[100:103], v10 offset:2576
    ds_read_b128 v[104:107], v10 offset:0
    ds_read_b128 v[108:111], v10 offset:16
    ds_read_b128 v[112:115], v10 offset:5120
    ds_read_b128 v[116:119], v10 offset:5136
    ds_read_b128 v[160:163], v10 offset:3072
    ds_read_b128 v[164:167], v10 offset:3088
    ds_read_b128 v[168:171], v10 offset:512
    ds_read_b128 v[172:175], v10 offset:528
    ds_read_b128 v[176:179], v10 offset:5632
    ds_read_b128 v[180:183], v10 offset:5648
    s_waitcnt lgkmcnt(6)
    v_lshlrev_b32 v152, 16, v36
    v_and_b32 v153, 0xffff0000, v36
    v_lshlrev_b32 v154, 16, v37
    v_and_b32 v155, 0xffff0000, v37
    v_lshlrev_b32 v156, 16, v38
    v_and_b32 v157, 0xffff0000, v38
    v_lshlrev_b32 v158, 16, v39
    v_and_b32 v159, 0xffff0000, v39
    v_pk_fma_f32 v[144:145], v[56:57], v[120:121], v[120:121] op_sel:[0,1,0] op_sel_hi:[1,1,0]
    v_pk_fma_f32 v[146:147], v[58:59], v[120:121], v[120:121] op_sel:[0,1,0] op_sel_hi:[1,1,0]
    v_pk_fma_f32 v[148:149], v[60:61], v[120:121], v[120:121] op_sel:[0,1,0] op_sel_hi:[1,1,0]
    v_pk_fma_f32 v[150:151], v[62:63], v[120:121], v[120:121] op_sel:[0,1,0] op_sel_hi:[1,1,0]
    v_pk_fma_f32 v[144:145], v[144:145], v[96:97], v[104:105]
    v_pk_fma_f32 v[146:147], v[146:147], v[98:99], v[106:107]
    v_pk_fma_f32 v[148:149], v[148:149], v[100:101], v[108:109]
    v_pk_fma_f32 v[150:151], v[150:151], v[102:103], v[110:111]
    v_pk_mul_f32 v[144:145], v[144:145], v[152:153]
    v_pk_mul_f32 v[146:147], v[146:147], v[154:155]
    v_pk_mul_f32 v[148:149], v[148:149], v[156:157]
    v_pk_mul_f32 v[150:151], v[150:151], v[158:159]
    v_pk_fma_f32 v[56:57], v[112:113], v[144:145], v[56:57]
    v_pk_fma_f32 v[58:59], v[114:115], v[146:147], v[58:59]
    v_pk_fma_f32 v[60:61], v[116:117], v[148:149], v[60:61]
    v_pk_fma_f32 v[62:63], v[118:119], v[150:151], v[62:63]
    v_cvt_pk_bf16_f32 v16, v56, v57
    v_cvt_pk_bf16_f32 v17, v58, v59
    v_cvt_pk_bf16_f32 v18, v60, v61
    v_cvt_pk_bf16_f32 v19, v62, v63
    v_lshlrev_b32 v56, 16, v16
    v_and_b32 v57, 0xffff0000, v16
    v_dot2_f32_bf16 v124, v16, v126, v124
    v_dot2_f32_bf16 v125, v16, v16, v125
    v_lshlrev_b32 v58, 16, v17
    v_and_b32 v59, 0xffff0000, v17
    v_dot2_f32_bf16 v124, v17, v126, v124
    v_dot2_f32_bf16 v125, v17, v17, v125
    v_lshlrev_b32 v60, 16, v18
    v_and_b32 v61, 0xffff0000, v18
    v_dot2_f32_bf16 v124, v18, v126, v124
    v_dot2_f32_bf16 v125, v18, v18, v125
    v_lshlrev_b32 v62, 16, v19
    v_and_b32 v63, 0xffff0000, v19
    v_dot2_f32_bf16 v124, v19, v126, v124
    v_dot2_f32_bf16 v125, v19, v19, v125
    ds_read_b128 v[96:99], v10 offset:3584
    ds_read_b128 v[100:103], v10 offset:3600
    ds_read_b128 v[104:107], v10 offset:1024
    ds_read_b128 v[108:111], v10 offset:1040
    ds_read_b128 v[112:115], v10 offset:6144
    ds_read_b128 v[116:119], v10 offset:6160
    s_waitcnt lgkmcnt(6)
    v_lshlrev_b32 v152, 16, v40
    v_and_b32 v153, 0xffff0000, v40
    v_lshlrev_b32 v154, 16, v41
    v_and_b32 v155, 0xffff0000, v41
    v_lshlrev_b32 v156, 16, v42
    v_and_b32 v157, 0xffff0000, v42
    v_lshlrev_b32 v158, 16, v43
    v_and_b32 v159, 0xffff0000, v43
    v_pk_fma_f32 v[144:145], v[64:65], v[120:121], v[120:121] op_sel:[0,1,0] op_sel_hi:[1,1,0]
    v_pk_fma_f32 v[146:147], v[66:67], v[120:121], v[120:121] op_sel:[0,1,0] op_sel_hi:[1,1,0]
    v_pk_fma_f32 v[148:149], v[68:69], v[120:121], v[120:121] op_sel:[0,1,0] op_sel_hi:[1,1,0]
    v_pk_fma_f32 v[150:151], v[70:71], v[120:121], v[120:121] op_sel:[0,1,0] op_sel_hi:[1,1,0]
    v_pk_fma_f32 v[144:145], v[144:145], v[160:161], v[168:169]
    v_pk_fma_f32 v[146:147], v[146:147], v[162:163], v[170:171]
    v_pk_fma_f32 v[148:149], v[148:149], v[164:165], v[172:173]
    v_pk_fma_f32 v[150:151], v[150:151], v[166:167], v[174:175]
    v_pk_mul_f32 v[144:145], v[144:145], v[152:153]
    v_pk_mul_f32 v[146:147], v[146:147], v[154:155]
    v_pk_mul_f32 v[148:149], v[148:149], v[156:157]
    v_pk_mul_f32 v[150:151], v[150:151], v[158:159]
    v_pk_fma_f32 v[64:65], v[176:177], v[144:145], v[64:65]
    v_pk_fma_f32 v[66:67], v[178:179], v[146:147], v[66:67]
    v_pk_fma_f32 v[68:69], v[180:181], v[148:149], v[68:69]
    v_pk_fma_f32 v[70:71], v[182:183], v[150:151], v[70:71]
    v_cvt_pk_bf16_f32 v20, v64, v65
    v_cvt_pk_bf16_f32 v21, v66, v67
    v_cvt_pk_bf16_f32 v22, v68, v69
    v_cvt_pk_bf16_f32 v23, v70, v71
    v_lshlrev_b32 v64, 16, v20
    v_and_b32 v65, 0xffff0000, v20
    v_dot2_f32_bf16 v124, v20, v126, v124
    v_dot2_f32_bf16 v125, v20, v20, v125
    v_lshlrev_b32 v66, 16, v21
    v_and_b32 v67, 0xffff0000, v21
    v_dot2_f32_bf16 v124, v21, v126, v124
    v_dot2_f32_bf16 v125, v21, v21, v125
    v_lshlrev_b32 v68, 16, v22
    v_and_b32 v69, 0xffff0000, v22
    v_dot2_f32_bf16 v124, v22, v126, v124
    v_dot2_f32_bf16 v125, v22, v22, v125
    v_lshlrev_b32 v70, 16, v23
    v_and_b32 v71, 0xffff0000, v23
    v_dot2_f32_bf16 v124, v23, v126, v124
    v_dot2_f32_bf16 v125, v23, v23, v125
    ds_read_b128 v[160:163], v10 offset:4096
    ds_read_b128 v[164:167], v10 offset:4112
    ds_read_b128 v[168:171], v10 offset:1536
    ds_read_b128 v[172:175], v10 offset:1552
    ds_read_b128 v[176:179], v10 offset:6656
    ds_read_b128 v[180:183], v10 offset:6672
    s_waitcnt lgkmcnt(6)
    v_lshlrev_b32 v152, 16, v44
    v_and_b32 v153, 0xffff0000, v44
    v_lshlrev_b32 v154, 16, v45
    v_and_b32 v155, 0xffff0000, v45
    v_lshlrev_b32 v156, 16, v46
    v_and_b32 v157, 0xffff0000, v46
    v_lshlrev_b32 v158, 16, v47
    v_and_b32 v159, 0xffff0000, v47
    v_pk_fma_f32 v[144:145], v[72:73], v[120:121], v[120:121] op_sel:[0,1,0] op_sel_hi:[1,1,0]
    v_pk_fma_f32 v[146:147], v[74:75], v[120:121], v[120:121] op_sel:[0,1,0] op_sel_hi:[1,1,0]
    v_pk_fma_f32 v[148:149], v[76:77], v[120:121], v[120:121] op_sel:[0,1,0] op_sel_hi:[1,1,0]
    v_pk_fma_f32 v[150:151], v[78:79], v[120:121], v[120:121] op_sel:[0,1,0] op_sel_hi:[1,1,0]
    v_pk_fma_f32 v[144:145], v[144:145], v[96:97], v[104:105]
    v_pk_fma_f32 v[146:147], v[146:147], v[98:99], v[106:107]
    v_pk_fma_f32 v[148:149], v[148:149], v[100:101], v[108:109]
    v_pk_fma_f32 v[150:151], v[150:151], v[102:103], v[110:111]
    v_pk_mul_f32 v[144:145], v[144:145], v[152:153]
    v_pk_mul_f32 v[146:147], v[146:147], v[154:155]
    v_pk_mul_f32 v[148:149], v[148:149], v[156:157]
    v_pk_mul_f32 v[150:151], v[150:151], v[158:159]
    v_pk_fma_f32 v[72:73], v[112:113], v[144:145], v[72:73]
    v_pk_fma_f32 v[74:75], v[114:115], v[146:147], v[74:75]
    v_pk_fma_f32 v[76:77], v[116:117], v[148:149], v[76:77]
    v_pk_fma_f32 v[78:79], v[118:119], v[150:151], v[78:79]
    v_cvt_pk_bf16_f32 v24, v72, v73
    v_cvt_pk_bf16_f32 v25, v74, v75
    v_cvt_pk_bf16_f32 v26, v76, v77
    v_cvt_pk_bf16_f32 v27, v78, v79
    v_lshlrev_b32 v72, 16, v24
    v_and_b32 v73, 0xffff0000, v24
    v_dot2_f32_bf16 v124, v24, v126, v124
    v_dot2_f32_bf16 v125, v24, v24, v125
    v_lshlrev_b32 v74, 16, v25
    v_and_b32 v75, 0xffff0000, v25
    v_dot2_f32_bf16 v124, v25, v126, v124
    v_dot2_f32_bf16 v125, v25, v25, v125
    v_lshlrev_b32 v76, 16, v26
    v_and_b32 v77, 0xffff0000, v26
    v_dot2_f32_bf16 v124, v26, v126, v124
    v_dot2_f32_bf16 v125, v26, v26, v125
    v_lshlrev_b32 v78, 16, v27
    v_and_b32 v79, 0xffff0000, v27
    v_dot2_f32_bf16 v124, v27, v126, v124
    v_dot2_f32_bf16 v125, v27, v27, v125
    ds_read_b128 v[96:99], v10 offset:4608
    ds_read_b128 v[100:103], v10 offset:4624
    ds_read_b128 v[104:107], v10 offset:2048
    ds_read_b128 v[108:111], v10 offset:2064
    ds_read_b128 v[112:115], v10 offset:7168
    ds_read_b128 v[116:119], v10 offset:7184
    s_waitcnt lgkmcnt(6)
    v_lshlrev_b32 v152, 16, v48
    v_and_b32 v153, 0xffff0000, v48
    v_lshlrev_b32 v154, 16, v49
    v_and_b32 v155, 0xffff0000, v49
    v_lshlrev_b32 v156, 16, v50
    v_and_b32 v157, 0xffff0000, v50
    v_lshlrev_b32 v158, 16, v51
    v_and_b32 v159, 0xffff0000, v51
    v_pk_fma_f32 v[144:145], v[80:81], v[120:121], v[120:121] op_sel:[0,1,0] op_sel_hi:[1,1,0]
    v_pk_fma_f32 v[146:147], v[82:83], v[120:121], v[120:121] op_sel:[0,1,0] op_sel_hi:[1,1,0]
    v_pk_fma_f32 v[148:149], v[84:85], v[120:121], v[120:121] op_sel:[0,1,0] op_sel_hi:[1,1,0]
    v_pk_fma_f32 v[150:151], v[86:87], v[120:121], v[120:121] op_sel:[0,1,0] op_sel_hi:[1,1,0]
    v_pk_fma_f32 v[144:145], v[144:145], v[160:161], v[168:169]
    v_pk_fma_f32 v[146:147], v[146:147], v[162:163], v[170:171]
    v_pk_fma_f32 v[148:149], v[148:149], v[164:165], v[172:173]
    v_pk_fma_f32 v[150:151], v[150:151], v[166:167], v[174:175]
    v_pk_mul_f32 v[144:145], v[144:145], v[152:153]
    v_pk_mul_f32 v[146:147], v[146:147], v[154:155]
    v_pk_mul_f32 v[148:149], v[148:149], v[156:157]
    v_pk_mul_f32 v[150:151], v[150:151], v[158:159]
    v_pk_fma_f32 v[80:81], v[176:177], v[144:145], v[80:81]
    v_pk_fma_f32 v[82:83], v[178:179], v[146:147], v[82:83]
    v_pk_fma_f32 v[84:85], v[180:181], v[148:149], v[84:85]
    v_pk_fma_f32 v[86:87], v[182:183], v[150:151], v[86:87]
    v_cvt_pk_bf16_f32 v28, v80, v81
    v_cvt_pk_bf16_f32 v29, v82, v83
    v_cvt_pk_bf16_f32 v30, v84, v85
    v_cvt_pk_bf16_f32 v31, v86, v87
    v_lshlrev_b32 v80, 16, v28
    v_and_b32 v81, 0xffff0000, v28
    v_dot2_f32_bf16 v124, v28, v126, v124
    v_dot2_f32_bf16 v125, v28, v28, v125
    v_lshlrev_b32 v82, 16, v29
    v_and_b32 v83, 0xffff0000, v29
    v_dot2_f32_bf16 v124, v29, v126, v124
    v_dot2_f32_bf16 v125, v29, v29, v125
    v_lshlrev_b32 v84, 16, v30
    v_and_b32 v85, 0xffff0000, v30
    v_dot2_f32_bf16 v124, v30, v126, v124
    v_dot2_f32_bf16 v125, v30, v30, v125
    v_lshlrev_b32 v86, 16, v31
    v_and_b32 v87, 0xffff0000, v31
    v_dot2_f32_bf16 v124, v31, v126, v124
    v_dot2_f32_bf16 v125, v31, v31, v125
    s_waitcnt lgkmcnt(0)
    v_lshlrev_b32 v152, 16, v52
    v_and_b32 v153, 0xffff0000, v52
    v_lshlrev_b32 v154, 16, v53
    v_and_b32 v155, 0xffff0000, v53
    v_lshlrev_b32 v156, 16, v54
    v_and_b32 v157, 0xffff0000, v54
    v_lshlrev_b32 v158, 16, v55
    v_and_b32 v159, 0xffff0000, v55
    v_pk_fma_f32 v[144:145], v[88:89], v[120:121], v[120:121] op_sel:[0,1,0] op_sel_hi:[1,1,0]
    v_pk_fma_f32 v[146:147], v[90:91], v[120:121], v[120:121] op_sel:[0,1,0] op_sel_hi:[1,1,0]
    v_pk_fma_f32 v[148:149], v[92:93], v[120:121], v[120:121] op_sel:[0,1,0] op_sel_hi:[1,1,0]
    v_pk_fma_f32 v[150:151], v[94:95], v[120:121], v[120:121] op_sel:[0,1,0] op_sel_hi:[1,1,0]
    v_pk_fma_f32 v[144:145], v[144:145], v[96:97], v[104:105]
    v_pk_fma_f32 v[146:147], v[146:147], v[98:99], v[106:107]
    v_pk_fma_f32 v[148:149], v[148:149], v[100:101], v[108:109]
    v_pk_fma_f32 v[150:151], v[150:151], v[102:103], v[110:111]
    v_pk_mul_f32 v[144:145], v[144:145], v[152:153]
    v_pk_mul_f32 v[146:147], v[146:147], v[154:155]
    v_pk_mul_f32 v[148:149], v[148:149], v[156:157]
    v_pk_mul_f32 v[150:151], v[150:151], v[158:159]
    v_pk_fma_f32 v[88:89], v[112:113], v[144:145], v[88:89]
    v_pk_fma_f32 v[90:91], v[114:115], v[146:147], v[90:91]
    v_pk_fma_f32 v[92:93], v[116:117], v[148:149], v[92:93]
    v_pk_fma_f32 v[94:95], v[118:119], v[150:151], v[94:95]
    v_cvt_pk_bf16_f32 v32, v88, v89
    v_cvt_pk_bf16_f32 v33, v90, v91
    v_cvt_pk_bf16_f32 v34, v92, v93
    v_cvt_pk_bf16_f32 v35, v94, v95
    v_lshlrev_b32 v88, 16, v32
    v_and_b32 v89, 0xffff0000, v32
    v_dot2_f32_bf16 v124, v32, v126, v124
    v_dot2_f32_bf16 v125, v32, v32, v125
    v_lshlrev_b32 v90, 16, v33
    v_and_b32 v91, 0xffff0000, v33
    v_dot2_f32_bf16 v124, v33, v126, v124
    v_dot2_f32_bf16 v125, v33, v33, v125
    v_lshlrev_b32 v92, 16, v34
    v_and_b32 v93, 0xffff0000, v34
    v_dot2_f32_bf16 v124, v34, v126, v124
    v_dot2_f32_bf16 v125, v34, v34, v125
    v_lshlrev_b32 v94, 16, v35
    v_and_b32 v95, 0xffff0000, v35
    v_dot2_f32_bf16 v124, v35, v126, v124
    v_dot2_f32_bf16 v125, v35, v35, v125
    v_and_b32 v191, 31, v1
    v_lshlrev_b32 v191, 2, v191
    s_add_u32 s41, s37, 7424
    buffer_load_dword v190, v191, s[12:15], s41 offen sc1
    ds_read_b128 v[96:99], v10 offset:10240
    ds_read_b128 v[100:103], v10 offset:10256
    ds_read_b128 v[104:107], v10 offset:7680
    ds_read_b128 v[108:111], v10 offset:7696
    s_nop 1
    s_nop 0
    v_add_f32_dpp v124, v124, v124 quad_perm:[1,0,3,2] row_mask:0xf bank_mask:0xf
    v_add_f32_dpp v125, v125, v125 quad_perm:[1,0,3,2] row_mask:0xf bank_mask:0xf
    s_nop 0
    v_add_f32_dpp v124, v124, v124 quad_perm:[2,3,0,1] row_mask:0xf bank_mask:0xf
    v_add_f32_dpp v125, v125, v125 quad_perm:[2,3,0,1] row_mask:0xf bank_mask:0xf
    s_nop 0
    v_add_f32_dpp v124, v124, v124 row_half_mirror row_mask:0xf bank_mask:0xf
    v_add_f32_dpp v125, v125, v125 row_half_mirror row_mask:0xf bank_mask:0xf
    s_nop 0
    v_add_f32_dpp v124, v124, v124 row_mirror row_mask:0xf bank_mask:0xf
    v_add_f32_dpp v125, v125, v125 row_mirror row_mask:0xf bank_mask:0xf
    v_mul_f32 v124, 0x3acccccd, v124
    v_mul_f32 v125, 0x3acccccd, v125
    v_fma_f32 v125, -v124, v124, v125
    v_max_f32 v125, 0, v125
    v_cvt_pk_bf16_f32 v122, v124, v125
    v_lshlrev_b32 v124, 16, v122
    v_and_b32 v125, 0xffff0000, v122
    v_add_f32 v125, 0x3727c5ac, v125
    v_cvt_pk_bf16_f32 v122, v125, v125
    v_lshlrev_b32 v125, 16, v122
    v_sqrt_f32 v125, v125
    s_nop 0
    v_cvt_pk_bf16_f32 v122, v125, v125
    v_lshlrev_b32 v125, 16, v122
    v_rcp_f32 v125, v125
    s_nop 0
    v_mul_f32 v124, v124, v125
    v_sub_f32 v124, 0, v124
    v_mov_b32 v120, 0
    v_mov_b32 v121, 0
    ds_read_b128 v[160:163], v10 offset:10752
    ds_read_b128 v[164:167], v10 offset:10768
    ds_read_b128 v[168:171], v10 offset:8192
    ds_read_b128 v[172:175], v10 offset:8208
    s_waitcnt lgkmcnt(4)
    v_pk_fma_f32 v[56:57], v[56:57], v[124:125], v[124:125] op_sel:[0,1,0] op_sel_hi:[1,1,0]
    v_pk_fma_f32 v[58:59], v[58:59], v[124:125], v[124:125] op_sel:[0,1,0] op_sel_hi:[1,1,0]
    v_pk_fma_f32 v[60:61], v[60:61], v[124:125], v[124:125] op_sel:[0,1,0] op_sel_hi:[1,1,0]
    v_pk_fma_f32 v[62:63], v[62:63], v[124:125], v[124:125] op_sel:[0,1,0] op_sel_hi:[1,1,0]
    v_pk_fma_f32 v[56:57], v[56:57], v[96:97], v[104:105]
    v_pk_fma_f32 v[58:59], v[58:59], v[98:99], v[106:107]
    v_pk_fma_f32 v[60:61], v[60:61], v[100:101], v[108:109]
    v_pk_fma_f32 v[62:63], v[62:63], v[102:103], v[110:111]
    v_cvt_pk_bf16_f32 v36, v56, v57
    v_cvt_pk_bf16_f32 v37, v58, v59
    v_cvt_pk_bf16_f32 v38, v60, v61
    v_cvt_pk_bf16_f32 v39, v62, v63
    v_dot2_f32_bf16 v120, v36, v126, v120
    v_dot2_f32_bf16 v121, v36, v36, v121
    v_dot2_f32_bf16 v120, v37, v126, v120
    v_dot2_f32_bf16 v121, v37, v37, v121
    v_dot2_f32_bf16 v120, v38, v126, v120
    v_dot2_f32_bf16 v121, v38, v38, v121
    v_dot2_f32_bf16 v120, v39, v126, v120
    v_dot2_f32_bf16 v121, v39, v39, v121
    ds_read_b128 v[96:99], v10 offset:11264
    ds_read_b128 v[100:103], v10 offset:11280
    ds_read_b128 v[104:107], v10 offset:8704
    ds_read_b128 v[108:111], v10 offset:8720
    s_waitcnt lgkmcnt(4)
    v_pk_fma_f32 v[64:65], v[64:65], v[124:125], v[124:125] op_sel:[0,1,0] op_sel_hi:[1,1,0]
    v_pk_fma_f32 v[66:67], v[66:67], v[124:125], v[124:125] op_sel:[0,1,0] op_sel_hi:[1,1,0]
    v_pk_fma_f32 v[68:69], v[68:69], v[124:125], v[124:125] op_sel:[0,1,0] op_sel_hi:[1,1,0]
    v_pk_fma_f32 v[70:71], v[70:71], v[124:125], v[124:125] op_sel:[0,1,0] op_sel_hi:[1,1,0]
    v_pk_fma_f32 v[64:65], v[64:65], v[160:161], v[168:169]
    v_pk_fma_f32 v[66:67], v[66:67], v[162:163], v[170:171]
    v_pk_fma_f32 v[68:69], v[68:69], v[164:165], v[172:173]
    v_pk_fma_f32 v[70:71], v[70:71], v[166:167], v[174:175]
    v_cvt_pk_bf16_f32 v40, v64, v65
    v_cvt_pk_bf16_f32 v41, v66, v67
    v_cvt_pk_bf16_f32 v42, v68, v69
    v_cvt_pk_bf16_f32 v43, v70, v71
    v_dot2_f32_bf16 v120, v40, v126, v120
    v_dot2_f32_bf16 v121, v40, v40, v121
    v_dot2_f32_bf16 v120, v41, v126, v120
    v_dot2_f32_bf16 v121, v41, v41, v121
    v_dot2_f32_bf16 v120, v42, v126, v120
    v_dot2_f32_bf16 v121, v42, v42, v121
    v_dot2_f32_bf16 v120, v43, v126, v120
    v_dot2_f32_bf16 v121, v43, v43, v121
    ds_read_b128 v[160:163], v10 offset:11776
    ds_read_b128 v[164:167], v10 offset:11792
    ds_read_b128 v[168:171], v10 offset:9216
    ds_read_b128 v[172:175], v10 offset:9232
    s_waitcnt lgkmcnt(4)
    v_pk_fma_f32 v[72:73], v[72:73], v[124:125], v[124:125] op_sel:[0,1,0] op_sel_hi:[1,1,0]
    v_pk_fma_f32 v[74:75], v[74:75], v[124:125], v[124:125] op_sel:[0,1,0] op_sel_hi:[1,1,0]
    v_pk_fma_f32 v[76:77], v[76:77], v[124:125], v[124:125] op_sel:[0,1,0] op_sel_hi:[1,1,0]
    v_pk_fma_f32 v[78:79], v[78:79], v[124:125], v[124:125] op_sel:[0,1,0] op_sel_hi:[1,1,0]
    v_pk_fma_f32 v[72:73], v[72:73], v[96:97], v[104:105]
    v_pk_fma_f32 v[74:75], v[74:75], v[98:99], v[106:107]
    v_pk_fma_f32 v[76:77], v[76:77], v[100:101], v[108:109]
    v_pk_fma_f32 v[78:79], v[78:79], v[102:103], v[110:111]
    v_cvt_pk_bf16_f32 v44, v72, v73
    v_cvt_pk_bf16_f32 v45, v74, v75
    v_cvt_pk_bf16_f32 v46, v76, v77
    v_cvt_pk_bf16_f32 v47, v78, v79
    v_dot2_f32_bf16 v120, v44, v126, v120
    v_dot2_f32_bf16 v121, v44, v44, v121
    v_dot2_f32_bf16 v120, v45, v126, v120
    v_dot2_f32_bf16 v121, v45, v45, v121
    v_dot2_f32_bf16 v120, v46, v126, v120
    v_dot2_f32_bf16 v121, v46, v46, v121
    v_dot2_f32_bf16 v120, v47, v126, v120
    v_dot2_f32_bf16 v121, v47, v47, v121
    ds_read_b128 v[96:99], v10 offset:12288
    ds_read_b128 v[100:103], v10 offset:12304
    ds_read_b128 v[104:107], v10 offset:9728
    ds_read_b128 v[108:111], v10 offset:9744
    s_waitcnt lgkmcnt(4)
    v_pk_fma_f32 v[80:81], v[80:81], v[124:125], v[124:125] op_sel:[0,1,0] op_sel_hi:[1,1,0]
    v_pk_fma_f32 v[82:83], v[82:83], v[124:125], v[124:125] op_sel:[0,1,0] op_sel_hi:[1,1,0]
    v_pk_fma_f32 v[84:85], v[84:85], v[124:125], v[124:125] op_sel:[0,1,0] op_sel_hi:[1,1,0]
    v_pk_fma_f32 v[86:87], v[86:87], v[124:125], v[124:125] op_sel:[0,1,0] op_sel_hi:[1,1,0]
    v_pk_fma_f32 v[80:81], v[80:81], v[160:161], v[168:169]
    v_pk_fma_f32 v[82:83], v[82:83], v[162:163], v[170:171]
    v_pk_fma_f32 v[84:85], v[84:85], v[164:165], v[172:173]
    v_pk_fma_f32 v[86:87], v[86:87], v[166:167], v[174:175]
    v_cvt_pk_bf16_f32 v48, v80, v81
    v_cvt_pk_bf16_f32 v49, v82, v83
    v_cvt_pk_bf16_f32 v50, v84, v85
    v_cvt_pk_bf16_f32 v51, v86, v87
    v_dot2_f32_bf16 v120, v48, v126, v120
    v_dot2_f32_bf16 v121, v48, v48, v121
    v_dot2_f32_bf16 v120, v49, v126, v120
    v_dot2_f32_bf16 v121, v49, v49, v121
    v_dot2_f32_bf16 v120, v50, v126, v120
    v_dot2_f32_bf16 v121, v50, v50, v121
    v_dot2_f32_bf16 v120, v51, v126, v120
    v_dot2_f32_bf16 v121, v51, v51, v121
    s_waitcnt lgkmcnt(0)
    v_pk_fma_f32 v[88:89], v[88:89], v[124:125], v[124:125] op_sel:[0,1,0] op_sel_hi:[1,1,0]
    v_pk_fma_f32 v[90:91], v[90:91], v[124:125], v[124:125] op_sel:[0,1,0] op_sel_hi:[1,1,0]
    v_pk_fma_f32 v[92:93], v[92:93], v[124:125], v[124:125] op_sel:[0,1,0] op_sel_hi:[1,1,0]
    v_pk_fma_f32 v[94:95], v[94:95], v[124:125], v[124:125] op_sel:[0,1,0] op_sel_hi:[1,1,0]
    v_pk_fma_f32 v[88:89], v[88:89], v[96:97], v[104:105]
    v_pk_fma_f32 v[90:91], v[90:91], v[98:99], v[106:107]
    v_pk_fma_f32 v[92:93], v[92:93], v[100:101], v[108:109]
    v_pk_fma_f32 v[94:95], v[94:95], v[102:103], v[110:111]
    v_cvt_pk_bf16_f32 v52, v88, v89
    v_cvt_pk_bf16_f32 v53, v90, v91
    v_cvt_pk_bf16_f32 v54, v92, v93
    v_cvt_pk_bf16_f32 v55, v94, v95
    v_dot2_f32_bf16 v120, v52, v126, v120
    v_dot2_f32_bf16 v121, v52, v52, v121
    v_dot2_f32_bf16 v120, v53, v126, v120
    v_dot2_f32_bf16 v121, v53, v53, v121
    v_dot2_f32_bf16 v120, v54, v126, v120
    v_dot2_f32_bf16 v121, v54, v54, v121
    v_dot2_f32_bf16 v120, v55, v126, v120
    v_dot2_f32_bf16 v121, v55, v55, v121
    s_nop 1
    s_nop 0
    v_add_f32_dpp v120, v120, v120 quad_perm:[1,0,3,2] row_mask:0xf bank_mask:0xf
    v_add_f32_dpp v121, v121, v121 quad_perm:[1,0,3,2] row_mask:0xf bank_mask:0xf
    s_nop 0
    v_add_f32_dpp v120, v120, v120 quad_perm:[2,3,0,1] row_mask:0xf bank_mask:0xf
    v_add_f32_dpp v121, v121, v121 quad_perm:[2,3,0,1] row_mask:0xf bank_mask:0xf
    s_nop 0
    v_add_f32_dpp v120, v120, v120 row_half_mirror row_mask:0xf bank_mask:0xf
    v_add_f32_dpp v121, v121, v121 row_half_mirror row_mask:0xf bank_mask:0xf
    s_nop 0
    v_add_f32_dpp v120, v120, v120 row_mirror row_mask:0xf bank_mask:0xf
    v_add_f32_dpp v121, v121, v121 row_mirror row_mask:0xf bank_mask:0xf
    v_mul_f32 v120, 0x3acccccd, v120
    v_mul_f32 v121, 0x3acccccd, v121
    v_fma_f32 v121, -v120, v120, v121
    v_max_f32 v121, 0, v121
    v_cvt_pk_bf16_f32 v122, v120, v121
    v_lshlrev_b32 v120, 16, v122
    v_and_b32 v121, 0xffff0000, v122
    v_add_f32 v121, 0x3727c5ac, v121
    v_cvt_pk_bf16_f32 v122, v121, v121
    v_lshlrev_b32 v121, 16, v122
    v_sqrt_f32 v121, v121
    s_nop 0
    v_cvt_pk_bf16_f32 v122, v121, v121
    v_lshlrev_b32 v121, 16, v122
    v_rcp_f32 v121, v121
    s_nop 0
    v_mul_f32 v120, v120, v121
    v_sub_f32 v120, 0, v120
    v_cndmask_b32 v120, 0, v120, s[50:51]
    v_cndmask_b32 v121, 0, v121, s[50:51]
    s_mul_i32 s46, s29, 20480
    s_add_u32 s46, s46, s36
    s_add_u32 s47, s46, 348160
    s_lshl_b32 s48, s29, 7
    s_add_u32 s48, s48, s36
    s_add_u32 s48, s48, 1597440
    v_lshlrev_b32 v12, 3, v15
    s_lshl_b32 s49, s29, 7
    s_add_u32 s49, s49, s37
    s_lshl_b32 s41, s30, 2
    s_add_u32 s49, s49, s41
    s_waitcnt vmcnt(0)
    s_mov_b32 s43, 200000
k2_kernel_xp7:
    v_cmp_ne_u32 vcc, 0, v190
    s_sub_u32 s43, s43, 1
    s_cmp_eq_u64 vcc, -1
    s_cbranch_scc1 k2_kernel_xd8
    s_cmp_eq_u32 s43, 0
    s_cbranch_scc1 k2_kernel_xd8
    s_add_u32 s41, s37, 7424
    buffer_load_dword v190, v191, s[12:15], s41 offen sc1
    s_waitcnt vmcnt(0)
    s_branch k2_kernel_xp7
k2_kernel_xd8:
    v_cmp_eq_u32 vcc, s42, v190
    s_nop 1
    s_cmp_eq_u64 vcc, -1
    s_cselect_b32 s31, 1, 0
    s_barrier
    v_and_b32 v9, 7, v4
    v_xor_b32 v9, v15, v9
    v_and_b32 v10, 3, v4
    v_lshl_add_u32 v9, v10, 4, v9
    v_lshrrev_b32 v10, 2, v4
    v_lshl_add_u32 v9, v10, 6, v9
    v_lshlrev_b32 v9, 4, v9
    v_add_u32 v9, 114688, v9
    ds_write_b128 v9, v[36:39] offset:0
    ds_write_b128 v9, v[16:19] offset:20480
    ds_write_b128 v9, v[40:43] offset:4096
    ds_write_b128 v9, v[20:23] offset:24576
    ds_write_b128 v9, v[44:47] offset:8192
    ds_write_b128 v9, v[24:27] offset:28672
    ds_write_b128 v9, v[48:51] offset:12288
    ds_write_b128 v9, v[28:31] offset:32768
    ds_write_b128 v9, v[52:55] offset:16384
    ds_write_b128 v9, v[32:35] offset:36864
    v_xor_b32 v9, v4, v3
    v_xor_b32 v10, 4, v9
    v_lshl_add_u32 v9, v3, 4, v9
    v_lshl_add_u32 v10, v3, 4, v10
    s_mul_i32 s41, s30, 5120
    s_add_u32 s41, s41, 114688
    v_lshl_add_u32 v9, v9, 4, s41
    v_lshl_add_u32 v10, v10, 4, s41
    s_cmp_eq_u32 s30, 1
    s_cselect_b32 s41, 1, 0
    s_cmp_eq_u32 s30, 3
    s_cselect_b32 s41, 1, s41
    s_cmp_eq_u32 s41, 1
    v_mov_b32 v11, v9
    s_cbranch_scc0 k2_noswap
    v_mov_b32 v9, v10
    v_mov_b32 v10, v11
k2_noswap:
    s_mul_i32 s41, s30, 5120
    s_add_u32 s46, s46, s41
    s_add_u32 s47, s47, s41
    s_waitcnt lgkmcnt(0)
    s_barrier
    ds_read_b128 v[36:39], v9 offset:0
    ds_read_b128 v[40:43], v10 offset:1024
    ds_read_b128 v[44:47], v9 offset:2048
    ds_read_b128 v[48:51], v10 offset:3072
    ds_read_b128 v[52:55], v9 offset:4096
    ds_read_b128 v[220:223], v9 offset:20480
    ds_read_b128 v[224:227], v10 offset:21504
    ds_read_b128 v[228:231], v9 offset:22528
    ds_read_b128 v[232:235], v10 offset:23552
    ds_read_b128 v[236:239], v9 offset:24576
    s_add_u32 s52, s46, 4096
    s_sub_u32 s41, s29, 1
    s_cmp_lt_u32 s41, 16
    s_cselect_b32 s20, s47, 0x90000000
    s_cmp_eq_u32 s31, 0
    s_cbranch_scc1 k2_kernel_slow9
    s_waitcnt lgkmcnt(9)
    buffer_store_dwordx4 v[36:39], v2, s[12:15], s46 offen offset:0
    s_waitcnt lgkmcnt(8)
    buffer_store_dwordx4 v[40:43], v2, s[12:15], s46 offen offset:1024
    s_waitcnt lgkmcnt(7)
    buffer_store_dwordx4 v[44:47], v2, s[12:15], s46 offen offset:2048
    s_waitcnt lgkmcnt(6)
    buffer_store_dwordx4 v[48:51], v2, s[12:15], s46 offen offset:3072
    s_waitcnt lgkmcnt(5)
    buffer_store_dwordx4 v[52:55], v2, s[12:15], s52 offen offset:0
    v_cmp_eq_u32 vcc, 0, v4
    s_and_saveexec_b64 s[50:51], vcc
    buffer_store_dwordx2 v[120:121], v12, s[12:15], s48 offen
    s_mov_b64 exec, -1
    s_waitcnt vmcnt(0)
    v_mov_b32 v9, 1
    v_mov_b32 v10, 0
    s_mov_b64 exec, 1
    buffer_store_dword v9, v10, s[12:15], s49 offen
    s_mov_b64 exec, -1
    s_branch k2_kernel_sent10
k2_kernel_slow9:
    s_waitcnt lgkmcnt(9)
    buffer_store_dwordx4 v[36:39], v2, s[12:15], s46 offen offset:0 sc1
    s_waitcnt lgkmcnt(8)
    buffer_store_dwordx4 v[40:43], v2, s[12:15], s46 offen offset:1024 sc1
    s_waitcnt lgkmcnt(7)
    buffer_store_dwordx4 v[44:47], v2, s[12:15], s46 offen offset:2048 sc1
    s_waitcnt lgkmcnt(6)
    buffer_store_dwordx4 v[48:51], v2, s[12:15], s46 offen offset:3072 sc1
    s_waitcnt lgkmcnt(5)
    buffer_store_dwordx4 v[52:55], v2, s[12:15], s52 offen offset:0 sc1
    v_cmp_eq_u32 vcc, 0, v4
    s_and_saveexec_b64 s[50:51], vcc
    buffer_store_dwordx2 v[120:121], v12, s[12:15], s48 offen sc1
    s_mov_b64 exec, -1
    s_waitcnt vmcnt(0)
    v_mov_b32 v9, 1
    v_mov_b32 v10, 0
    s_mov_b64 exec, 1
    buffer_store_dword v9, v10, s[12:15], s49 offen sc1
    s_mov_b64 exec, -1
k2_kernel_sent10:
    s_mov_b32 s21, s49
    s_mov_b32 m0, s38
    s_nop 0
    buffer_load_dwordx4 v2, s[12:15], s39 offen offset:0 lds
    s_mov_b32 m0, s38
    s_nop 0
    buffer_load_dwordx4 v2, s[12:15], s39 offen offset:1024 lds
    s_mov_b32 m0, s38
    s_nop 0
    buffer_load_dwordx4 v2, s[12:15], s39 offen offset:2048 lds
    s_mov_b32 m0, s38
    s_nop 0
    buffer_load_dwordx4 v2, s[12:15], s39 offen offset:3072 lds
    s_add_u32 s38, s38, 4096
    s_add_u32 s39, s39, 4096
    s_mov_b32 m0, s38
    s_nop 0
    buffer_load_dwordx4 v2, s[12:15], s39 offen offset:0 lds
    s_mov_b32 m0, s38
    s_nop 0
    buffer_load_dwordx4 v2, s[12:15], s39 offen offset:1024 lds
    s_mov_b32 m0, s38
    s_nop 0
    buffer_load_dwordx4 v2, s[12:15], s39 offen offset:2048 lds
    s_mov_b32 m0, s38
    s_nop 0
    buffer_load_dwordx4 v2, s[12:15], s39 offen offset:3072 lds
    s_add_u32 s38, s38, 4096
    s_add_u32 s39, s39, 4096
    s_mov_b32 m0, s38
    s_nop 0
    buffer_load_dwordx4 v2, s[12:15], s39 offen offset:0 lds
    s_mov_b32 m0, s38
    s_nop 0
    buffer_load_dwordx4 v2, s[12:15], s39 offen offset:1024 lds
    s_mov_b32 m0, s38
    s_nop 0
    buffer_load_dwordx4 v2, s[12:15], s39 offen offset:2048 lds
    s_mov_b32 m0, s38
    s_nop 0
    buffer_load_dwordx4 v2, s[12:15], s39 offen offset:3072 lds
    s_add_u32 s38, s38, 4096
    s_add_u32 s39, s39, 4096
    s_mov_b32 m0, s38
    s_nop 0
    buffer_load_dwordx4 v2, s[12:15], s39 offen offset:0 lds
    s_mov_b32 m0, s38
    s_nop 0
    buffer_load_dwordx4 v2, s[12:15], s39 offen offset:1024 lds
    s_mov_b32 m0, s38
    s_nop 0
    buffer_load_dwordx4 v2, s[12:15], s39 offen offset:2048 lds
    s_mov_b32 m0, s38
    s_nop 0
    buffer_load_dwordx4 v2, s[12:15], s39 offen offset:3072 lds
    s_add_u32 s38, s38, 4096
    s_add_u32 s39, s39, 4096
    s_mov_b32 m0, s38
    s_nop 0
    buffer_load_dwordx4 v2, s[12:15], s39 offen offset:0 lds
    s_branch k2_kernel_join03
k2_kernel_nob02:
    s_mov_b32 s21, 0
    s_mov_b32 s20, 0x90000000
    s_mul_i32 s38, s30, 25600
    s_add_u32 s39, s38, s44
    s_add_u32 s39, s39, 2764800
    v_and_b32 v191, 31, v1
    v_lshlrev_b32 v191, 2, v191
    s_add_u32 s41, s37, 7424
    buffer_load_dword v190, v191, s[12:15], s41 offen sc1
    s_waitcnt vmcnt(0)
    s_mov_b32 s43, 200000
k2_kernel_xp11:
    v_cmp_ne_u32 vcc, 0, v190
    s_sub_u32 s43, s43, 1
    s_cmp_eq_u64 vcc, -1
    s_cbranch_scc1 k2_kernel_xd12
    s_cmp_eq_u32 s43, 0
    s_cbranch_scc1 k2_kernel_xd12
    s_add_u32 s41, s37, 7424
    buffer_load_dword v190, v191, s[12:15], s41 offen sc1
    s_waitcnt vmcnt(0)
    s_branch k2_kernel_xp11
k2_kernel_xd12:
    v_cmp_eq_u32 vcc, s42, v190
    s_nop 1
    s_cmp_eq_u64 vcc, -1
    s_cselect_b32 s31, 1, 0
    s_cmp_eq_u32 s30, 1
    s_cbranch_scc1 k2_kernel_sm13
    s_cmp_ge_u32 s30, 2
    s_cbranch_scc1 k2_kernel_sm14
    s_mul_i32 s41, s33, 320
    s_add_u32 s41, s41, 2748416
    s_mov_b32 m0, 155648
    s_mov_b64 exec, 0xfffff
    buffer_load_dwordx4 v2, s[12:15], s41 offen lds
    s_add_u32 s41, s41, 7168
    s_mov_b32 m0, 156160
    s_nop 0
    buffer_load_dwordx4 v2, s[12:15], s41 offen lds
    s_branch k2_kernel_sm15
k2_kernel_sm13:
    s_mul_i32 s41, s35, 448
    s_add_u32 s41, s41, 2732032
    s_mov_b32 m0, 156672
    s_mov_b64 exec, 0xfffffff
    buffer_load_dwordx4 v2, s[12:15], s41 offen lds
    s_add_u32 s41, s41, 7168
    s_mov_b32 m0, 157184
    s_nop 0
    buffer_load_dwordx4 v2, s[12:15], s41 offen lds
    s_branch k2_kernel_sm15
k2_kernel_sm14:
    s_mul_i32 s41, s33, 320
    s_add_u32 s41, s41, 2724352
    s_mov_b32 m0, 157696
    s_mov_b64 exec, 0xfffff
    buffer_load_dwordx4 v2, s[12:15], s41 offen lds
k2_kernel_sm15:
    s_mov_b64 exec, -1
    s_mov_b32 m0, s38
    s_nop 0
    buffer_load_dwordx4 v2, s[12:15], s39 offen offset:0 lds
    s_mov_b32 m0, s38
    s_nop 0
    buffer_load_dwordx4 v2, s[12:15], s39 offen offset:1024 lds
    s_mov_b32 m0, s38
    s_nop 0
    buffer_load_dwordx4 v2, s[12:15], s39 offen offset:2048 lds
    s_mov_b32 m0, s38
    s_nop 0
    buffer_load_dwordx4 v2, s[12:15], s39 offen offset:3072 lds
    s_add_u32 s38, s38, 4096
    s_add_u32 s39, s39, 4096
    s_mov_b32 m0, s38
    s_nop 0
    buffer_load_dwordx4 v2, s[12:15], s39 offen offset:0 lds
    s_mov_b32 m0, s38
    s_nop 0
    buffer_load_dwordx4 v2, s[12:15], s39 offen offset:1024 lds
    s_mov_b32 m0, s38
    s_nop 0
    buffer_load_dwordx4 v2, s[12:15], s39 offen offset:2048 lds
    s_mov_b32 m0, s38
    s_nop 0
    buffer_load_dwordx4 v2, s[12:15], s39 offen offset:3072 lds
    s_add_u32 s38, s38, 4096
    s_add_u32 s39, s39, 4096
    s_mov_b32 m0, s38
    s_nop 0
    buffer_load_dwordx4 v2, s[12:15], s39 offen offset:0 lds
    s_mov_b32 m0, s38
    s_nop 0
    buffer_load_dwordx4 v2, s[12:15], s39 offen offset:1024 lds
    s_mov_b32 m0, s38
    s_nop 0
    buffer_load_dwordx4 v2, s[12:15], s39 offen offset:2048 lds
    s_mov_b32 m0, s38
    s_nop 0
    buffer_load_dwordx4 v2, s[12:15], s39 offen offset:3072 lds
    s_add_u32 s38, s38, 4096
    s_add_u32 s39, s39, 4096
    s_mov_b32 m0, s38
    s_nop 0
    buffer_load_dwordx4 v2, s[12:15], s39 offen offset:0 lds
    s_mov_b32 m0, s38
    s_nop 0
    buffer_load_dwordx4 v2, s[12:15], s39 offen offset:1024 lds
    s_mov_b32 m0, s38
    s_nop 0
    buffer_load_dwordx4 v2, s[12:15], s39 offen offset:2048 lds
    s_mov_b32 m0, s38
    s_nop 0
    buffer_load_dwordx4 v2, s[12:15], s39 offen offset:3072 lds
    s_add_u32 s38, s38, 4096
    s_add_u32 s39, s39, 4096
    s_mov_b32 m0, s38
    s_nop 0
    buffer_load_dwordx4 v2, s[12:15], s39 offen offset:0 lds
    s_mov_b32 m0, s38
    s_nop 0
    buffer_load_dwordx4 v2, s[12:15], s39 offen offset:1024 lds
    s_mov_b32 m0, s38
    s_nop 0
    buffer_load_dwordx4 v2, s[12:15], s39 offen offset:2048 lds
    s_mov_b32 m0, s38
    s_nop 0
    buffer_load_dwordx4 v2, s[12:15], s39 offen offset:3072 lds
    s_add_u32 s38, s38, 4096
    s_add_u32 s39, s39, 4096
    s_mov_b32 m0, s38
    s_nop 0
    buffer_load_dwordx4 v2, s[12:15], s39 offen offset:0 lds
    s_mov_b32 m0, s38
    s_nop 0
    buffer_load_dwordx4 v2, s[12:15], s39 offen offset:1024 lds
    s_mov_b32 m0, s38
    s_nop 0
    buffer_load_dwordx4 v2, s[12:15], s39 offen offset:2048 lds
    s_mov_b32 m0, s38
    s_nop 0
    buffer_load_dwordx4 v2, s[12:15], s39 offen offset:3072 lds
    s_add_u32 s38, s38, 4096
    s_add_u32 s39, s39, 4096
    s_mov_b32 m0, s38
    s_nop 0
    buffer_load_dwordx4 v2, s[12:15], s39 offen offset:0 lds
    s_cmp_eq_u32 s31, 0
    s_cbranch_scc1 k2_kernel_nt16
    s_sub_u32 s47, s29, 18
    s_lshl_b32 s47, s47, 2
    s_add_u32 s47, s47, s30
    s_mul_i32 s48, s47, 6144
    s_min_u32 s48, s48, 321536
    s_mul_i32 s49, s28, 327680
    s_add_u32 s48, s48, s49
    s_add_u32 s48, s48, 0
    buffer_load_dwordx4 v[64:67], v2, s[12:15], s48 offen offset:0
    buffer_load_dwordx4 v[68:71], v2, s[12:15], s48 offen offset:1024
    buffer_load_dwordx4 v[72:75], v2, s[12:15], s48 offen offset:2048
    buffer_load_dwordx4 v[76:79], v2, s[12:15], s48 offen offset:3072
    s_add_u32 s48, s48, 4096
    buffer_load_dwordx4 v[80:83], v2, s[12:15], s48 offen offset:0
    buffer_load_dwordx4 v[84:87], v2, s[12:15], s48 offen offset:1024
    s_mul_i32 s48, s47, 384
    s_min_u32 s48, s48, 20096
    s_add_u32 s48, s48, s36
    s_add_u32 s48, s48, 1581056
    s_mov_b64 exec, 7
    buffer_load_dword v100, v5, s[12:15], s48 offen
    s_mov_b64 exec, -1
k2_kernel_nt16:
k2_kernel_join03:
    s_lshl_b32 s46, s32, 2
    s_add_u32 s46, s46, s30
    s_lshr_b32 s47, s33, 1
    s_and_b32 s48, s47, 1
    s_lshr_b32 s47, s47, 1
    s_add_u32 s47, s47, 1
    s_sub_u32 s49, 0, s47
    s_cmp_eq_u32 s48, 1
    s_cselect_b32 s47, s47, s49
    s_lshl_b32 s49, s46, 4
    s_add_u32 s49, s49, 16
    s_add_u32 s49, s49, s47
    v_add_u32 v9, s49, v4
    v_lshrrev_b32 v10, 4, v9
    v_mul_u32_u24 v6, 20480, v10
    v_and_b32 v10, 15, v9
    v_lshl_add_u32 v10, v3, 4, v10
    v_lshl_add_u32 v6, v10, 4, v6
    v_lshlrev_b32 v13, 3, v9
    s_add_u32 s49, s46, s48
    s_lshl_b32 s49, s49, 7
    s_add_u32 s49, s49, s37
    v_bfe_u32 v7, v1, 2, 1
    v_lshlrev_b32 v7, 7, v7
    v_and_b32 v9, 3, v1
    v_lshl_add_u32 v7, v9, 2, v7
    s_mov_b32 s43, 200000
k2_kernel_poll17:
    buffer_load_dword v9, v7, s[12:15], s49 offen sc1
    s_waitcnt vmcnt(0)
    v_cmp_ne_u32 vcc, 0, v9
    s_sub_u32 s43, s43, 1
    s_cmp_eq_u64 vcc, -1
    s_cbranch_scc1 k2_kernel_go18
    s_cmp_lg_u32 s43, 0
    s_cbranch_scc1 k2_kernel_poll17
k2_kernel_go18:
    s_add_u32 s41, s36, 0
    buffer_load_dwordx4 v[16:19], v6, s[12:15], s41 offen offset:0 sc1
    s_add_u32 s41, s36, 0
    buffer_load_dwordx4 v[20:23], v6, s[12:15], s41 offen offset:1024 sc1
    s_add_u32 s41, s36, 0
    buffer_load_dwordx4 v[24:27], v6, s[12:15], s41 offen offset:2048 sc1
    s_add_u32 s41, s36, 0
    buffer_load_dwordx4 v[28:31], v6, s[12:15], s41 offen offset:3072 sc1
    s_add_u32 s41, s36, 1597440
    buffer_load_dwordx2 v[176:177], v13, s[12:15], s41 offen sc1
    v_mov_b32 v14, v2
    v_add_u32 v15, 0x10000, v2
    v_add_u32 v11, 0x20000, v2
    s_barrier
    s_mul_i32 s38, s30, 13312
    s_add_u32 s39, s38, s44
    s_add_u32 s39, s39, 3584000
    s_add_u32 s38, s38, 102400
    ds_read_b128 v[96:99], v14 offset:0
    ds_read_b128 v[100:103], v14 offset:1024
    ds_read_b128 v[104:107], v14 offset:2048
    ds_read_b128 v[108:111], v14 offset:3072
    ds_read_b128 v[112:115], v14 offset:4096
    ds_read_b128 v[116:119], v14 offset:5120
    ds_read_b128 v[120:123], v14 offset:6144
    ds_read_b128 v[124:127], v14 offset:7168
    ds_read_b128 v[128:131], v14 offset:8192
    ds_read_b128 v[132:135], v14 offset:9216
    s_waitcnt vmcnt(4)
    s_waitcnt lgkmcnt(5)
    v_mfma_f32_16x16x32_bf16 v[156:159], v[96:99], v[16:19], 0
    s_add_u32 s41, s36, 4096
    buffer_load_dwordx4 v[32:35], v6, s[12:15], s41 offen offset:0 sc1
    v_mfma_f32_16x16x32_bf16 v[160:163], v[100:103], v[16:19], 0
    ds_read_b128 v[136:139], v14 offset:10240
    v_mfma_f32_16x16x32_bf16 v[164:167], v[104:107], v[16:19], 0
    ds_read_b128 v[140:143], v14 offset:11264
    v_mfma_f32_16x16x32_bf16 v[168:171], v[108:111], v[16:19], 0
    ds_read_b128 v[144:147], v14 offset:12288
    s_add_u32 s41, s36, 4096
    buffer_load_dwordx4 v[36:39], v6, s[12:15], s41 offen offset:1024 sc1
    v_mfma_f32_16x16x32_bf16 v[172:175], v[112:115], v[16:19], 0
    ds_read_b128 v[148:151], v14 offset:13312
    ds_read_b128 v[152:155], v14 offset:14336
    s_waitcnt vmcnt(5)
    s_waitcnt lgkmcnt(5)
    v_mfma_f32_16x16x32_bf16 v[156:159], v[116:119], v[20:23], v[156:159]
    s_add_u32 s41, s36, 4096
    buffer_load_dwordx4 v[40:43], v6, s[12:15], s41 offen offset:2048 sc1
    v_mfma_f32_16x16x32_bf16 v[160:163], v[120:123], v[20:23], v[160:163]
    ds_read_b128 v[96:99], v14 offset:15360
    v_mfma_f32_16x16x32_bf16 v[164:167], v[124:127], v[20:23], v[164:167]
    ds_read_b128 v[100:103], v14 offset:16384
    v_mfma_f32_16x16x32_bf16 v[168:171], v[128:131], v[20:23], v[168:171]
    ds_read_b128 v[104:107], v14 offset:17408
    s_add_u32 s41, s36, 4096
    buffer_load_dwordx4 v[44:47], v6, s[12:15], s41 offen offset:3072 sc1
    v_mfma_f32_16x16x32_bf16 v[172:175], v[132:135], v[20:23], v[172:175]
    ds_read_b128 v[108:111], v14 offset:18432
    ds_read_b128 v[112:115], v14 offset:19456
    s_waitcnt vmcnt(6)
    s_waitcnt lgkmcnt(5)
    v_mfma_f32_16x16x32_bf16 v[156:159], v[136:139], v[24:27], v[156:159]
    s_add_u32 s41, s36, 8192
    buffer_load_dwordx4 v[48:51], v6, s[12:15], s41 offen offset:0 sc1
    v_mfma_f32_16x16x32_bf16 v[160:163], v[140:143], v[24:27], v[160:163]
    ds_read_b128 v[116:119], v14 offset:20480
    v_mfma_f32_16x16x32_bf16 v[164:167], v[144:147], v[24:27], v[164:167]
    ds_read_b128 v[120:123], v14 offset:21504
    v_mfma_f32_16x16x32_bf16 v[168:171], v[148:151], v[24:27], v[168:171]
    ds_read_b128 v[124:127], v14 offset:22528
    s_add_u32 s41, s36, 8192
    buffer_load_dwordx4 v[52:55], v6, s[12:15], s41 offen offset:1024 sc1
    v_mfma_f32_16x16x32_bf16 v[172:175], v[152:155], v[24:27], v[172:175]
    ds_read_b128 v[128:131], v14 offset:23552
    ds_read_b128 v[132:135], v14 offset:24576
    s_waitcnt vmcnt(7)
    s_waitcnt lgkmcnt(5)
    v_mfma_f32_16x16x32_bf16 v[156:159], v[96:99], v[28:31], v[156:159]
    s_add_u32 s41, s36, 8192
    buffer_load_dwordx4 v[56:59], v6, s[12:15], s41 offen offset:2048 sc1
    v_mfma_f32_16x16x32_bf16 v[160:163], v[100:103], v[28:31], v[160:163]
    ds_read_b128 v[136:139], v14 offset:25600
    v_mfma_f32_16x16x32_bf16 v[164:167], v[104:107], v[28:31], v[164:167]
    ds_read_b128 v[140:143], v14 offset:26624
    v_mfma_f32_16x16x32_bf16 v[168:171], v[108:111], v[28:31], v[168:171]
    ds_read_b128 v[144:147], v14 offset:27648
    s_add_u32 s41, s36, 8192
    buffer_load_dwordx4 v[60:63], v6, s[12:15], s41 offen offset:3072 sc1
    v_mfma_f32_16x16x32_bf16 v[172:175], v[112:115], v[28:31], v[172:175]
    ds_read_b128 v[148:151], v14 offset:28672
    ds_read_b128 v[152:155], v14 offset:29696
    s_waitcnt vmcnt(7)
    s_waitcnt lgkmcnt(5)
    v_mfma_f32_16x16x32_bf16 v[156:159], v[116:119], v[32:35], v[156:159]
    s_add_u32 s41, s36, 12288
    buffer_load_dwordx4 v[64:67], v6, s[12:15], s41 offen offset:0 sc1
    v_mfma_f32_16x16x32_bf16 v[160:163], v[120:123], v[32:35], v[160:163]
    ds_read_b128 v[96:99], v14 offset:30720
    v_mfma_f32_16x16x32_bf16 v[164:167], v[124:127], v[32:35], v[164:167]
    ds_read_b128 v[100:103], v14 offset:31744
    v_mfma_f32_16x16x32_bf16 v[168:171], v[128:131], v[32:35], v[168:171]
    ds_read_b128 v[104:107], v14 offset:32768
    s_add_u32 s41, s36, 12288
    buffer_load_dwordx4 v[68:71], v6, s[12:15], s41 offen offset:1024 sc1
    v_mfma_f32_16x16x32_bf16 v[172:175], v[132:135], v[32:35], v[172:175]
    ds_read_b128 v[108:111], v14 offset:33792
    ds_read_b128 v[112:115], v14 offset:34816
    s_waitcnt vmcnt(8)
    s_waitcnt lgkmcnt(5)
    v_mfma_f32_16x16x32_bf16 v[156:159], v[136:139], v[36:39], v[156:159]
    s_add_u32 s41, s36, 12288
    buffer_load_dwordx4 v[72:75], v6, s[12:15], s41 offen offset:2048 sc1
    v_mfma_f32_16x16x32_bf16 v[160:163], v[140:143], v[36:39], v[160:163]
    ds_read_b128 v[116:119], v14 offset:35840
    v_mfma_f32_16x16x32_bf16 v[164:167], v[144:147], v[36:39], v[164:167]
    ds_read_b128 v[120:123], v14 offset:36864
    v_mfma_f32_16x16x32_bf16 v[168:171], v[148:151], v[36:39], v[168:171]
    ds_read_b128 v[124:127], v14 offset:37888
    s_add_u32 s41, s36, 12288
    buffer_load_dwordx4 v[76:79], v6, s[12:15], s41 offen offset:3072 sc1
    v_mfma_f32_16x16x32_bf16 v[172:175], v[152:155], v[36:39], v[172:175]
    ds_read_b128 v[128:131], v14 offset:38912
    ds_read_b128 v[132:135], v14 offset:39936
    s_waitcnt vmcnt(9)
    s_waitcnt lgkmcnt(5)
    v_mfma_f32_16x16x32_bf16 v[156:159], v[96:99], v[40:43], v[156:159]
    s_add_u32 s41, s36, 16384
    buffer_load_dwordx4 v[80:83], v6, s[12:15], s41 offen offset:0 sc1
    v_mfma_f32_16x16x32_bf16 v[160:163], v[100:103], v[40:43], v[160:163]
    ds_read_b128 v[136:139], v14 offset:40960
    v_mfma_f32_16x16x32_bf16 v[164:167], v[104:107], v[40:43], v[164:167]
    ds_read_b128 v[140:143], v14 offset:41984
    v_mfma_f32_16x16x32_bf16 v[168:171], v[108:111], v[40:43], v[168:171]
    ds_read_b128 v[144:147], v14 offset:43008
    s_add_u32 s41, s36, 16384
    buffer_load_dwordx4 v[84:87], v6, s[12:15], s41 offen offset:1024 sc1
    v_mfma_f32_16x16x32_bf16 v[172:175], v[112:115], v[40:43], v[172:175]
    ds_read_b128 v[148:151], v14 offset:44032
    ds_read_b128 v[152:155], v14 offset:45056
    s_waitcnt vmcnt(10)
    s_waitcnt lgkmcnt(5)
    v_mfma_f32_16x16x32_bf16 v[156:159], v[116:119], v[44:47], v[156:159]
    s_add_u32 s41, s36, 16384
    buffer_load_dwordx4 v[88:91], v6, s[12:15], s41 offen offset:2048 sc1
    v_mfma_f32_16x16x32_bf16 v[160:163], v[120:123], v[44:47], v[160:163]
    ds_read_b128 v[96:99], v14 offset:46080
    v_mfma_f32_16x16x32_bf16 v[164:167], v[124:127], v[44:47], v[164:167]
    ds_read_b128 v[100:103], v14 offset:47104
    v_mfma_f32_16x16x32_bf16 v[168:171], v[128:131], v[44:47], v[168:171]
    ds_read_b128 v[104:107], v14 offset:48128
    s_add_u32 s41, s36, 16384
    buffer_load_dwordx4 v[92:95], v6, s[12:15], s41 offen offset:3072 sc1
    v_mfma_f32_16x16x32_bf16 v[172:175], v[132:135], v[44:47], v[172:175]
    ds_read_b128 v[108:111], v14 offset:49152
    ds_read_b128 v[112:115], v14 offset:50176
    s_waitcnt vmcnt(11)
    s_waitcnt lgkmcnt(5)
    v_mfma_f32_16x16x32_bf16 v[156:159], v[136:139], v[48:51], v[156:159]
    v_mfma_f32_16x16x32_bf16 v[160:163], v[140:143], v[48:51], v[160:163]
    ds_read_b128 v[116:119], v14 offset:51200
    s_mov_b32 m0, s38
    s_nop 0
    buffer_load_dwordx4 v2, s[12:15], s39 offen offset:0 lds
    v_mfma_f32_16x16x32_bf16 v[164:167], v[144:147], v[48:51], v[164:167]
    ds_read_b128 v[120:123], v14 offset:52224
    v_mfma_f32_16x16x32_bf16 v[168:171], v[148:151], v[48:51], v[168:171]
    ds_read_b128 v[124:127], v14 offset:53248
    v_mfma_f32_16x16x32_bf16 v[172:175], v[152:155], v[48:51], v[172:175]
    ds_read_b128 v[128:131], v14 offset:54272
    ds_read_b128 v[132:135], v14 offset:55296
    s_add_u32 s41, s20, 0
    buffer_store_dwordx4 v[220:223], v2, s[12:15], s41 offen sc1
    s_waitcnt vmcnt(12)
    s_waitcnt lgkmcnt(5)
    s_barrier
    v_mfma_f32_16x16x32_bf16 v[156:159], v[96:99], v[52:55], v[156:159]
    v_mfma_f32_16x16x32_bf16 v[160:163], v[100:103], v[52:55], v[160:163]
    ds_read_b128 v[136:139], v14 offset:56320
    s_mov_b32 m0, s38
    s_nop 0
    buffer_load_dwordx4 v2, s[12:15], s39 offen offset:1024 lds
    v_mfma_f32_16x16x32_bf16 v[164:167], v[104:107], v[52:55], v[164:167]
    ds_read_b128 v[140:143], v14 offset:57344
    v_mfma_f32_16x16x32_bf16 v[168:171], v[108:111], v[52:55], v[168:171]
    ds_read_b128 v[144:147], v14 offset:58368
    v_mfma_f32_16x16x32_bf16 v[172:175], v[112:115], v[52:55], v[172:175]
    ds_read_b128 v[148:151], v14 offset:59392
    ds_read_b128 v[152:155], v14 offset:60416
    s_add_u32 s41, s20, 1024
    buffer_store_dwordx4 v[224:227], v2, s[12:15], s41 offen sc1
    s_waitcnt vmcnt(13)
    s_waitcnt lgkmcnt(5)
    v_mfma_f32_16x16x32_bf16 v[156:159], v[116:119], v[56:59], v[156:159]
    v_mfma_f32_16x16x32_bf16 v[160:163], v[120:123], v[56:59], v[160:163]
    ds_read_b128 v[96:99], v14 offset:61440
    s_mov_b32 m0, s38
    s_nop 0
    buffer_load_dwordx4 v2, s[12:15], s39 offen offset:2048 lds
    v_mfma_f32_16x16x32_bf16 v[164:167], v[124:127], v[56:59], v[164:167]
    ds_read_b128 v[100:103], v14 offset:62464
    v_mfma_f32_16x16x32_bf16 v[168:171], v[128:131], v[56:59], v[168:171]
    ds_read_b128 v[104:107], v14 offset:63488
    v_mfma_f32_16x16x32_bf16 v[172:175], v[132:135], v[56:59], v[172:175]
    ds_read_b128 v[108:111], v14 offset:64512
    ds_read_b128 v[112:115], v15 offset:0
    s_add_u32 s41, s20, 2048
    buffer_store_dwordx4 v[228:231], v2, s[12:15], s41 offen sc1
    s_waitcnt vmcnt(14)
    s_waitcnt lgkmcnt(5)
    v_mfma_f32_16x16x32_bf16 v[156:159], v[136:139], v[60:63], v[156:159]
    v_mfma_f32_16x16x32_bf16 v[160:163], v[140:143], v[60:63], v[160:163]
    ds_read_b128 v[116:119], v15 offset:1024
    s_mov_b32 m0, s38
    s_nop 0
    buffer_load_dwordx4 v2, s[12:15], s39 offen offset:3072 lds
    s_add_u32 s38, s38, 4096
    s_add_u32 s39, s39, 4096
    v_mfma_f32_16x16x32_bf16 v[164:167], v[144:147], v[60:63], v[164:167]
    ds_read_b128 v[120:123], v15 offset:2048
    v_mfma_f32_16x16x32_bf16 v[168:171], v[148:151], v[60:63], v[168:171]
    ds_read_b128 v[124:127], v15 offset:3072
    v_mfma_f32_16x16x32_bf16 v[172:175], v[152:155], v[60:63], v[172:175]
    ds_read_b128 v[128:131], v15 offset:4096
    ds_read_b128 v[132:135], v15 offset:5120
    s_add_u32 s41, s20, 3072
    buffer_store_dwordx4 v[232:235], v2, s[12:15], s41 offen sc1
    s_waitcnt vmcnt(15)
    s_waitcnt lgkmcnt(5)
    v_mfma_f32_16x16x32_bf16 v[156:159], v[96:99], v[64:67], v[156:159]
    v_mfma_f32_16x16x32_bf16 v[160:163], v[100:103], v[64:67], v[160:163]
    ds_read_b128 v[136:139], v15 offset:6144
    s_mov_b32 m0, s38
    s_nop 0
    buffer_load_dwordx4 v2, s[12:15], s39 offen offset:0 lds
    v_mfma_f32_16x16x32_bf16 v[164:167], v[104:107], v[64:67], v[164:167]
    ds_read_b128 v[140:143], v15 offset:7168
    v_mfma_f32_16x16x32_bf16 v[168:171], v[108:111], v[64:67], v[168:171]
    ds_read_b128 v[144:147], v15 offset:8192
    v_mfma_f32_16x16x32_bf16 v[172:175], v[112:115], v[64:67], v[172:175]
    ds_read_b128 v[148:151], v15 offset:9216
    ds_read_b128 v[152:155], v15 offset:10240
    s_add_u32 s41, s20, 4096
    buffer_store_dwordx4 v[236:239], v2, s[12:15], s41 offen sc1
    s_waitcnt vmcnt(16)
    s_waitcnt lgkmcnt(5)
    v_mfma_f32_16x16x32_bf16 v[156:159], v[116:119], v[68:71], v[156:159]
    v_mfma_f32_16x16x32_bf16 v[160:163], v[120:123], v[68:71], v[160:163]
    ds_read_b128 v[96:99], v15 offset:11264
    s_mov_b32 m0, s38
    s_nop 0
    buffer_load_dwordx4 v2, s[12:15], s39 offen offset:1024 lds
    v_mfma_f32_16x16x32_bf16 v[164:167], v[124:127], v[68:71], v[164:167]
    ds_read_b128 v[100:103], v15 offset:12288
    v_mfma_f32_16x16x32_bf16 v[168:171], v[128:131], v[68:71], v[168:171]
    ds_read_b128 v[104:107], v15 offset:13312
    v_mfma_f32_16x16x32_bf16 v[172:175], v[132:135], v[68:71], v[172:175]
    ds_read_b128 v[108:111], v15 offset:14336
    ds_read_b128 v[112:115], v15 offset:15360
    s_mov_b32 m0, s38
    s_nop 0
    buffer_load_dwordx4 v2, s[12:15], s39 offen offset:2048 lds
    s_waitcnt vmcnt(17)
    s_waitcnt lgkmcnt(5)
    v_mfma_f32_16x16x32_bf16 v[156:159], v[136:139], v[72:75], v[156:159]
    v_mfma_f32_16x16x32_bf16 v[160:163], v[140:143], v[72:75], v[160:163]
    ds_read_b128 v[116:119], v15 offset:16384
    s_mov_b32 m0, s38
    s_nop 0
    buffer_load_dwordx4 v2, s[12:15], s39 offen offset:3072 lds
    s_add_u32 s38, s38, 4096
    s_add_u32 s39, s39, 4096
    v_mfma_f32_16x16x32_bf16 v[164:167], v[144:147], v[72:75], v[164:167]
    ds_read_b128 v[120:123], v15 offset:17408
    v_mfma_f32_16x16x32_bf16 v[168:171], v[148:151], v[72:75], v[168:171]
    ds_read_b128 v[124:127], v15 offset:18432
    v_mfma_f32_16x16x32_bf16 v[172:175], v[152:155], v[72:75], v[172:175]
    ds_read_b128 v[128:131], v15 offset:19456
    ds_read_b128 v[132:135], v15 offset:20480
    s_mov_b32 m0, s38
    s_nop 0
    buffer_load_dwordx4 v2, s[12:15], s39 offen offset:0 lds
    s_waitcnt vmcnt(18)
    s_waitcnt lgkmcnt(5)
    v_mfma_f32_16x16x32_bf16 v[156:159], v[96:99], v[76:79], v[156:159]
    v_mfma_f32_16x16x32_bf16 v[160:163], v[100:103], v[76:79], v[160:163]
    ds_read_b128 v[136:139], v15 offset:21504
    s_mov_b32 m0, s38
    s_nop 0
    buffer_load_dwordx4 v2, s[12:15], s39 offen offset:1024 lds
    v_mfma_f32_16x16x32_bf16 v[164:167], v[104:107], v[76:79], v[164:167]
    ds_read_b128 v[140:143], v15 offset:22528
    v_mfma_f32_16x16x32_bf16 v[168:171], v[108:111], v[76:79], v[168:171]
    ds_read_b128 v[144:147], v15 offset:23552
    v_mfma_f32_16x16x32_bf16 v[172:175], v[112:115], v[76:79], v[172:175]
    ds_read_b128 v[148:151], v15 offset:24576
    ds_read_b128 v[152:155], v15 offset:25600
    s_mov_b32 m0, s38
    s_nop 0
    buffer_load_dwordx4 v2, s[12:15], s39 offen offset:2048 lds
    s_waitcnt vmcnt(19)
    s_waitcnt lgkmcnt(5)
    v_mfma_f32_16x16x32_bf16 v[156:159], v[116:119], v[80:83], v[156:159]
    v_mfma_f32_16x16x32_bf16 v[160:163], v[120:123], v[80:83], v[160:163]
    ds_read_b128 v[96:99], v15 offset:26624
    s_mov_b32 m0, s38
    s_nop 0
    buffer_load_dwordx4 v2, s[12:15], s39 offen offset:3072 lds
    s_add_u32 s38, s38, 4096
    s_add_u32 s39, s39, 4096
    v_mfma_f32_16x16x32_bf16 v[164:167], v[124:127], v[80:83], v[164:167]
    ds_read_b128 v[100:103], v15 offset:27648
    v_mfma_f32_16x16x32_bf16 v[168:171], v[128:131], v[80:83], v[168:171]
    ds_read_b128 v[104:107], v15 offset:28672
    v_mfma_f32_16x16x32_bf16 v[172:175], v[132:135], v[80:83], v[172:175]
    ds_read_b128 v[108:111], v15 offset:29696
    ds_read_b128 v[112:115], v15 offset:30720
    s_mov_b32 m0, s38
    s_nop 0
    buffer_load_dwordx4 v2, s[12:15], s39 offen offset:0 lds
    s_waitcnt vmcnt(20)
    s_waitcnt lgkmcnt(5)
    v_mfma_f32_16x16x32_bf16 v[156:159], v[136:139], v[84:87], v[156:159]
    v_mfma_f32_16x16x32_bf16 v[160:163], v[140:143], v[84:87], v[160:163]
    ds_read_b128 v[116:119], v15 offset:31744
    s_mul_i32 s38, s30, 12288
    s_add_u32 s39, s38, s44
    s_add_u32 s39, s39, 3637248
    s_add_u32 s38, s38, 0
    s_mov_b32 m0, s38
    s_nop 0
    buffer_load_dwordx4 v2, s[12:15], s39 offen offset:0 lds
    v_mfma_f32_16x16x32_bf16 v[164:167], v[144:147], v[84:87], v[164:167]
    ds_read_b128 v[120:123], v15 offset:32768
    v_mfma_f32_16x16x32_bf16 v[168:171], v[148:151], v[84:87], v[168:171]
    ds_read_b128 v[124:127], v15 offset:33792
    v_mfma_f32_16x16x32_bf16 v[172:175], v[152:155], v[84:87], v[172:175]
    ds_read_b128 v[128:131], v15 offset:34816
    ds_read_b128 v[132:135], v15 offset:35840
    s_mov_b32 m0, s38
    s_nop 0
    buffer_load_dwordx4 v2, s[12:15], s39 offen offset:1024 lds
    s_waitcnt vmcnt(21)
    s_waitcnt lgkmcnt(5)
    v_mfma_f32_16x16x32_bf16 v[156:159], v[96:99], v[88:91], v[156:159]
    v_mfma_f32_16x16x32_bf16 v[160:163], v[100:103], v[88:91], v[160:163]
    s_mov_b32 m0, s38
    s_nop 0
    buffer_load_dwordx4 v2, s[12:15], s39 offen offset:2048 lds
    v_mfma_f32_16x16x32_bf16 v[164:167], v[104:107], v[88:91], v[164:167]
    v_mfma_f32_16x16x32_bf16 v[168:171], v[108:111], v[88:91], v[168:171]
    v_mfma_f32_16x16x32_bf16 v[172:175], v[112:115], v[88:91], v[172:175]
    s_mov_b32 m0, s38
    s_nop 0
    buffer_load_dwordx4 v2, s[12:15], s39 offen offset:3072 lds
    s_add_u32 s38, s38, 4096
    s_add_u32 s39, s39, 4096
    s_waitcnt vmcnt(22)
    s_waitcnt lgkmcnt(0)
    v_mfma_f32_16x16x32_bf16 v[156:159], v[116:119], v[92:95], v[156:159]
    v_mfma_f32_16x16x32_bf16 v[160:163], v[120:123], v[92:95], v[160:163]
    s_mov_b32 m0, s38
    s_nop 0
    buffer_load_dwordx4 v2, s[12:15], s39 offen offset:0 lds
    v_mfma_f32_16x16x32_bf16 v[164:167], v[124:127], v[92:95], v[164:167]
    v_mfma_f32_16x16x32_bf16 v[168:171], v[128:131], v[92:95], v[168:171]
    v_mfma_f32_16x16x32_bf16 v[172:175], v[132:135], v[92:95], v[172:175]
    s_mov_b32 m0, s38
    s_nop 0
    buffer_load_dwordx4 v2, s[12:15], s39 offen offset:1024 lds
    s_barrier
    s_mov_b32 m0, s38
    s_nop 0
    buffer_load_dwordx4 v2, s[12:15], s39 offen offset:2048 lds
    s_mov_b32 m0, s38
    s_nop 0
    buffer_load_dwordx4 v2, s[12:15], s39 offen offset:3072 lds
    s_add_u32 s38, s38, 4096
    s_add_u32 s39, s39, 4096
    s_mov_b32 m0, s38
    s_nop 0
    buffer_load_dwordx4 v2, s[12:15], s39 offen offset:0 lds
    s_mov_b32 m0, s38
    s_nop 0
    buffer_load_dwordx4 v2, s[12:15], s39 offen offset:1024 lds
    s_mov_b32 m0, s38
    s_nop 0
    buffer_load_dwordx4 v2, s[12:15], s39 offen offset:2048 lds
    s_mov_b32 m0, s38
    s_nop 0
    buffer_load_dwordx4 v2, s[12:15], s39 offen offset:3072 lds
    s_mul_i32 s38, s30, 13312
    s_add_u32 s39, s38, s45
    s_add_u32 s39, s39, 0
    s_add_u32 s38, s38, 49152
    s_mov_b32 m0, s38
    s_nop 0
    buffer_load_dwordx4 v2, s[12:15], s39 offen offset:0 lds
    s_mov_b32 m0, s38
    s_nop 0
    buffer_load_dwordx4 v2, s[12:15], s39 offen offset:1024 lds
    s_mov_b32 m0, s38
    s_nop 0
    buffer_load_dwordx4 v2, s[12:15], s39 offen offset:2048 lds
    s_mov_b32 m0, s38
    s_nop 0
    buffer_load_dwordx4 v2, s[12:15], s39 offen offset:3072 lds
    s_add_u32 s38, s38, 4096
    s_add_u32 s39, s39, 4096
    s_mov_b32 m0, s38
    s_nop 0
    buffer_load_dwordx4 v2, s[12:15], s39 offen offset:0 lds
    s_mov_b32 m0, s38
    s_nop 0
    buffer_load_dwordx4 v2, s[12:15], s39 offen offset:1024 lds
    s_mov_b32 m0, s38
    s_nop 0
    buffer_load_dwordx4 v2, s[12:15], s39 offen offset:2048 lds
    s_mov_b32 m0, s38
    s_nop 0
    buffer_load_dwordx4 v2, s[12:15], s39 offen offset:3072 lds
    s_add_u32 s38, s38, 4096
    s_add_u32 s39, s39, 4096
    s_mov_b32 m0, s38
    s_nop 0
    buffer_load_dwordx4 v2, s[12:15], s39 offen offset:0 lds
    s_mov_b32 m0, s38
    s_nop 0
    buffer_load_dwordx4 v2, s[12:15], s39 offen offset:1024 lds
    s_mov_b32 m0, s38
    s_nop 0
    buffer_load_dwordx4 v2, s[12:15], s39 offen offset:2048 lds
    s_mov_b32 m0, s38
    s_nop 0
    buffer_load_dwordx4 v2, s[12:15], s39 offen offset:3072 lds
    s_add_u32 s38, s38, 4096
    s_add_u32 s39, s39, 4096
    s_mov_b32 m0, s38
    s_nop 0
    buffer_load_dwordx4 v2, s[12:15], s39 offen offset:0 lds
    v_lshlrev_b32 v9, 4, v3
    v_add_u32 v9, 155648, v9
    v_mov_b32 v12, 0xbdd2d3e8
    v_mov_b32 v13, 0xc0135761
    ds_read_b128 v[180:183], v9 offset:0
    ds_read_b128 v[200:203], v9 offset:512
    ds_read_b128 v[184:187], v9 offset:64
    ds_read_b128 v[204:207], v9 offset:576
    ds_read_b128 v[188:191], v9 offset:128
    ds_read_b128 v[208:211], v9 offset:640
    ds_read_b128 v[192:195], v9 offset:192
    ds_read_b128 v[212:215], v9 offset:704
    ds_read_b128 v[196:199], v9 offset:256
    ds_read_b128 v[216:219], v9 offset:768
    s_waitcnt lgkmcnt(0)
    v_pk_add_f32 v[180:181], v[180:181], v[200:201]
    v_pk_add_f32 v[182:183], v[182:183], v[202:203]
    v_pk_add_f32 v[184:185], v[184:185], v[204:205]
    v_pk_add_f32 v[186:187], v[186:187], v[206:207]
    v_pk_add_f32 v[188:189], v[188:189], v[208:209]
    v_pk_add_f32 v[190:191], v[190:191], v[210:211]
    v_pk_add_f32 v[192:193], v[192:193], v[212:213]
    v_pk_add_f32 v[194:195], v[194:195], v[214:215]
    v_pk_add_f32 v[196:197], v[196:197], v[216:217]
    v_pk_add_f32 v[198:199], v[198:199], v[218:219]
    v_pk_mul_f32 v[200:201], v[180:181], v[176:177] op_sel_hi:[1,0]
    v_pk_mul_f32 v[202:203], v[182:183], v[176:177] op_sel_hi:[1,0]
    v_pk_mul_f32 v[204:205], v[184:185], v[176:177] op_sel_hi:[1,0]
    v_pk_mul_f32 v[206:207], v[186:187], v[176:177] op_sel_hi:[1,0]
    v_pk_mul_f32 v[208:209], v[188:189], v[176:177] op_sel_hi:[1,0]
    v_pk_mul_f32 v[210:211], v[190:191], v[176:177] op_sel_hi:[1,0]
    v_pk_mul_f32 v[212:213], v[192:193], v[176:177] op_sel_hi:[1,0]
    v_pk_mul_f32 v[214:215], v[194:195], v[176:177] op_sel_hi:[1,0]
    v_pk_mul_f32 v[216:217], v[196:197], v[176:177] op_sel_hi:[1,0]
    v_pk_mul_f32 v[218:219], v[198:199], v[176:177] op_sel_hi:[1,0]
    v_pk_fma_f32 v[156:157], v[156:157], v[176:177], v[200:201] op_sel:[0,1,0] op_sel_hi:[1,1,1]
    v_pk_fma_f32 v[158:159], v[158:159], v[176:177], v[202:203] op_sel:[0,1,0] op_sel_hi:[1,1,1]
    v_pk_fma_f32 v[160:161], v[160:161], v[176:177], v[204:205] op_sel:[0,1,0] op_sel_hi:[1,1,1]
    v_pk_fma_f32 v[162:163], v[162:163], v[176:177], v[206:207] op_sel:[0,1,0] op_sel_hi:[1,1,1]
    v_pk_fma_f32 v[164:165], v[164:165], v[176:177], v[208:209] op_sel:[0,1,0] op_sel_hi:[1,1,1]
    v_pk_fma_f32 v[166:167], v[166:167], v[176:177], v[210:211] op_sel:[0,1,0] op_sel_hi:[1,1,1]
    v_pk_fma_f32 v[168:169], v[168:169], v[176:177], v[212:213] op_sel:[0,1,0] op_sel_hi:[1,1,1]
    v_pk_fma_f32 v[170:171], v[170:171], v[176:177], v[214:215] op_sel:[0,1,0] op_sel_hi:[1,1,1]
    v_pk_fma_f32 v[172:173], v[172:173], v[176:177], v[216:217] op_sel:[0,1,0] op_sel_hi:[1,1,1]
    v_pk_fma_f32 v[174:175], v[174:175], v[176:177], v[218:219] op_sel:[0,1,0] op_sel_hi:[1,1,1]
    v_pk_mul_f32 v[200:201], v[156:157], v[156:157]
    v_pk_mul_f32 v[202:203], v[158:159], v[158:159]
    v_pk_mul_f32 v[204:205], v[160:161], v[160:161]
    v_pk_mul_f32 v[206:207], v[162:163], v[162:163]
    v_pk_mul_f32 v[208:209], v[164:165], v[164:165]
    v_pk_mul_f32 v[210:211], v[166:167], v[166:167]
    v_pk_mul_f32 v[212:213], v[168:169], v[168:169]
    v_pk_mul_f32 v[214:215], v[170:171], v[170:171]
    v_pk_mul_f32 v[216:217], v[172:173], v[172:173]
    v_pk_mul_f32 v[218:219], v[174:175], v[174:175]
    v_pk_fma_f32 v[200:201], v[200:201], v[12:13], v[12:13] op_sel:[0,0,1] op_sel_hi:[1,0,1]
    v_pk_fma_f32 v[202:203], v[202:203], v[12:13], v[12:13] op_sel:[0,0,1] op_sel_hi:[1,0,1]
    v_pk_fma_f32 v[204:205], v[204:205], v[12:13], v[12:13] op_sel:[0,0,1] op_sel_hi:[1,0,1]
    v_pk_fma_f32 v[206:207], v[206:207], v[12:13], v[12:13] op_sel:[0,0,1] op_sel_hi:[1,0,1]
    v_pk_fma_f32 v[208:209], v[208:209], v[12:13], v[12:13] op_sel:[0,0,1] op_sel_hi:[1,0,1]
    v_pk_fma_f32 v[210:211], v[210:211], v[12:13], v[12:13] op_sel:[0,0,1] op_sel_hi:[1,0,1]
    v_pk_fma_f32 v[212:213], v[212:213], v[12:13], v[12:13] op_sel:[0,0,1] op_sel_hi:[1,0,1]
    v_pk_fma_f32 v[214:215], v[214:215], v[12:13], v[12:13] op_sel:[0,0,1] op_sel_hi:[1,0,1]
    v_pk_fma_f32 v[216:217], v[216:217], v[12:13], v[12:13] op_sel:[0,0,1] op_sel_hi:[1,0,1]
    v_pk_fma_f32 v[218:219], v[218:219], v[12:13], v[12:13] op_sel:[0,0,1] op_sel_hi:[1,0,1]
    v_pk_mul_f32 v[200:201], v[200:201], v[156:157]
    v_pk_mul_f32 v[202:203], v[202:203], v[158:159]
    v_pk_mul_f32 v[204:205], v[204:205], v[160:161]
    v_pk_mul_f32 v[206:207], v[206:207], v[162:163]
    v_pk_mul_f32 v[208:209], v[208:209], v[164:165]
    v_pk_mul_f32 v[210:211], v[210:211], v[166:167]
    v_pk_mul_f32 v[212:213], v[212:213], v[168:169]
    v_pk_mul_f32 v[214:215], v[214:215], v[170:171]
    v_pk_mul_f32 v[216:217], v[216:217], v[172:173]
    v_pk_mul_f32 v[218:219], v[218:219], v[174:175]
    v_exp_f32 v200, v200
    v_exp_f32 v201, v201
    v_exp_f32 v202, v202
    v_exp_f32 v203, v203
    v_exp_f32 v204, v204
    v_exp_f32 v205, v205
    v_exp_f32 v206, v206
    v_exp_f32 v207, v207
    v_exp_f32 v208, v208
    v_exp_f32 v209, v209
    v_exp_f32 v210, v210
    v_exp_f32 v211, v211
    v_exp_f32 v212, v212
    v_exp_f32 v213, v213
    v_exp_f32 v214, v214
    v_exp_f32 v215, v215
    v_exp_f32 v216, v216
    v_exp_f32 v217, v217
    v_exp_f32 v218, v218
    v_exp_f32 v219, v219
    v_pk_add_f32 v[200:201], v[200:201], 1.0 op_sel_hi:[1,0]
    v_pk_add_f32 v[202:203], v[202:203], 1.0 op_sel_hi:[1,0]
    v_pk_add_f32 v[204:205], v[204:205], 1.0 op_sel_hi:[1,0]
    v_pk_add_f32 v[206:207], v[206:207], 1.0 op_sel_hi:[1,0]
    v_pk_add_f32 v[208:209], v[208:209], 1.0 op_sel_hi:[1,0]
    v_pk_add_f32 v[210:211], v[210:211], 1.0 op_sel_hi:[1,0]
    v_pk_add_f32 v[212:213], v[212:213], 1.0 op_sel_hi:[1,0]
    v_pk_add_f32 v[214:215], v[214:215], 1.0 op_sel_hi:[1,0]
    v_pk_add_f32 v[216:217], v[216:217], 1.0 op_sel_hi:[1,0]
    v_pk_add_f32 v[218:219], v[218:219], 1.0 op_sel_hi:[1,0]
    v_rcp_f32 v200, v200
    v_rcp_f32 v201, v201
    v_rcp_f32 v202, v202
    v_rcp_f32 v203, v203
    v_rcp_f32 v204, v204
    v_rcp_f32 v205, v205
    v_rcp_f32 v206, v206
    v_rcp_f32 v207, v207
    v_rcp_f32 v208, v208
    v_rcp_f32 v209, v209
    v_rcp_f32 v210, v210
    v_rcp_f32 v211, v211
    v_rcp_f32 v212, v212
    v_rcp_f32 v213, v213
    v_rcp_f32 v214, v214
    v_rcp_f32 v215, v215
    v_rcp_f32 v216, v216
    v_rcp_f32 v217, v217
    v_rcp_f32 v218, v218
    v_rcp_f32 v219, v219
    s_nop 0
    v_pk_mul_f32 v[156:157], v[156:157], v[200:201]
    v_pk_mul_f32 v[158:159], v[158:159], v[202:203]
    v_pk_mul_f32 v[160:161], v[160:161], v[204:205]
    v_pk_mul_f32 v[162:163], v[162:163], v[206:207]
    v_pk_mul_f32 v[164:165], v[164:165], v[208:209]
    v_pk_mul_f32 v[166:167], v[166:167], v[210:211]
    v_pk_mul_f32 v[168:169], v[168:169], v[212:213]
    v_pk_mul_f32 v[170:171], v[170:171], v[214:215]
    v_pk_mul_f32 v[172:173], v[172:173], v[216:217]
    v_pk_mul_f32 v[174:175], v[174:175], v[218:219]
    v_cvt_pk_bf16_f32 v156, v156, v157
    v_cvt_pk_bf16_f32 v157, v158, v159
    v_cvt_pk_bf16_f32 v158, v160, v161
    v_cvt_pk_bf16_f32 v159, v162, v163
    v_cvt_pk_bf16_f32 v164, v164, v165
    v_cvt_pk_bf16_f32 v165, v166, v167
    v_cvt_pk_bf16_f32 v166, v168, v169
    v_cvt_pk_bf16_f32 v167, v170, v171
    v_cvt_pk_bf16_f32 v172, v172, v173
    v_cvt_pk_bf16_f32 v173, v174, v175
    s_nop 1
    v_permlane16_swap_b32 v156, v158
    v_permlane16_swap_b32 v157, v159
    v_permlane16_swap_b32 v164, v166
    v_permlane16_swap_b32 v165, v167
    s_mov_b32 s46, s22
    s_lshl_b32 s41, s33, 2
    s_add_u32 s49, s55, s41
    s_cmp_eq_u32 s31, 0
    s_cbranch_scc1 k2_kernel_slow19
    buffer_store_dwordx4 v[156:159], v254, s[12:15], s46 offen offset:0
    buffer_store_dwordx4 v[164:167], v254, s[12:15], s46 offen offset:1024
    buffer_store_dwordx2 v[172:173], v8, s[12:15], s46 offen offset:2048
    s_waitcnt vmcnt(0)
    v_mov_b32 v9, 1
    v_mov_b32 v10, 2304
    s_mov_b64 exec, 1
    buffer_store_dword v9, v10, s[12:15], s49 offen
    s_mov_b64 exec, -1
    s_branch k2_kernel_sent20
k2_kernel_slow19:
    buffer_store_dwordx4 v[156:159], v254, s[12:15], s46 offen offset:0 sc1
    buffer_store_dwordx4 v[164:167], v254, s[12:15], s46 offen offset:1024 sc1
    buffer_store_dwordx2 v[172:173], v8, s[12:15], s46 offen offset:2048 sc1
    s_waitcnt vmcnt(0)
    v_mov_b32 v9, 1
    v_mov_b32 v10, 2304
    s_mov_b64 exec, 1
    buffer_store_dword v9, v10, s[12:15], s49 offen sc1
    s_mov_b64 exec, -1
k2_kernel_sent20:
    s_cmp_eq_u32 s21, 0
    s_cbranch_scc1 k2_kernel_xas23
    v_mov_b32 v9, 3
    v_mov_b32 v10, 0
    s_mov_b64 exec, 1
    s_cmp_eq_u32 s31, 0
    s_cbranch_scc1 k2_kernel_xas21
    buffer_store_dword v9, v10, s[12:15], s21 offen
    s_branch k2_kernel_xas22
k2_kernel_xas21:
    buffer_store_dword v9, v10, s[12:15], s21 offen sc1
k2_kernel_xas22:
    s_mov_b64 exec, -1
k2_kernel_xas23:
    s_sub_u32 s41, s55, s37
    s_lshr_b32 s41, s41, 7
    v_bfe_u32 v7, v1, 3, 2
    v_min_u32 v7, 2, v7
    v_add_u32 v7, s41, v7
    v_subrev_u32 v7, 1, v7
    v_max_i32 v7, 0, v7
    v_min_i32 v7, 15, v7
    v_lshlrev_b32 v7, 7, v7
    v_and_b32 v9, 7, v1
    v_lshl_add_u32 v7, v9, 2, v7
    s_add_u32 s49, s37, 2304
    s_mov_b32 s43, 200000
k2_kernel_poll24:
    buffer_load_dword v9, v7, s[12:15], s49 offen sc1
    s_waitcnt vmcnt(0)
    v_cmp_ne_u32 vcc, 0, v9
    s_sub_u32 s43, s43, 1
    s_cmp_eq_u64 vcc, -1
    s_cbranch_scc1 k2_kernel_go25
    s_cmp_lg_u32 s43, 0
    s_cbranch_scc1 k2_kernel_poll24
k2_kernel_go25:
    s_mul_i32 s41, s33, 2560
    s_sub_u32 s47, s22, s41
    s_mov_b32 s52, s47
    s_add_u32 s41, s52, 0
    buffer_load_dwordx4 v[16:19], v2, s[12:15], s41 offen offset:0 sc1
    s_add_u32 s41, s52, 0
    buffer_load_dwordx4 v[20:23], v2, s[12:15], s41 offen offset:1024 sc1
    s_add_u32 s41, s52, 0
    buffer_load_dwordx4 v[24:27], v2, s[12:15], s41 offen offset:2048 sc1
    s_add_u32 s41, s52, 0
    buffer_load_dwordx4 v[28:31], v2, s[12:15], s41 offen offset:3072 sc1
    s_add_u32 s41, s54, 20480
    s_mov_b32 s48, s41
    s_sub_u32 s41, s55, s37
    s_lshl_b32 s41, s41, 3
    s_add_u32 s46, s41, s36
    s_add_u32 s46, s46, 1581056
    s_barrier
    ds_read_b128 v[96:99], v15 offset:36864
    ds_read_b128 v[100:103], v15 offset:37888
    ds_read_b128 v[104:107], v15 offset:38912
    ds_read_b128 v[108:111], v15 offset:39936
    ds_read_b128 v[112:115], v15 offset:40960
    ds_read_b128 v[116:119], v15 offset:41984
    ds_read_b128 v[120:123], v15 offset:43008
    ds_read_b128 v[124:127], v15 offset:44032
    ds_read_b128 v[128:131], v15 offset:45056
    ds_read_b128 v[132:135], v15 offset:46080
    s_waitcnt vmcnt(3)
    s_waitcnt lgkmcnt(5)
    v_mfma_f32_16x16x32_bf16 v[156:159], v[96:99], v[16:19], 0
    s_add_u32 s41, s52, 4096
    buffer_load_dwordx4 v[32:35], v2, s[12:15], s41 offen offset:0 sc1
    v_mfma_f32_16x16x32_bf16 v[160:163], v[100:103], v[16:19], 0
    ds_read_b128 v[136:139], v15 offset:47104
    v_mfma_f32_16x16x32_bf16 v[164:167], v[104:107], v[16:19], 0
    ds_read_b128 v[140:143], v15 offset:48128
    v_mfma_f32_16x16x32_bf16 v[168:171], v[108:111], v[16:19], 0
    ds_read_b128 v[144:147], v15 offset:49152
    s_add_u32 s41, s52, 4096
    buffer_load_dwordx4 v[36:39], v2, s[12:15], s41 offen offset:1024 sc1
    v_mfma_f32_16x16x32_bf16 v[172:175], v[112:115], v[16:19], 0
    ds_read_b128 v[148:151], v15 offset:50176
    ds_read_b128 v[152:155], v15 offset:51200
    s_waitcnt vmcnt(4)
    s_waitcnt lgkmcnt(5)
    v_mfma_f32_16x16x32_bf16 v[156:159], v[116:119], v[20:23], v[156:159]
    s_add_u32 s41, s52, 4096
    buffer_load_dwordx4 v[40:43], v2, s[12:15], s41 offen offset:2048 sc1
    v_mfma_f32_16x16x32_bf16 v[160:163], v[120:123], v[20:23], v[160:163]
    ds_read_b128 v[96:99], v15 offset:52224
    v_mfma_f32_16x16x32_bf16 v[164:167], v[124:127], v[20:23], v[164:167]
    ds_read_b128 v[100:103], v15 offset:53248
    v_mfma_f32_16x16x32_bf16 v[168:171], v[128:131], v[20:23], v[168:171]
    ds_read_b128 v[104:107], v15 offset:54272
    s_add_u32 s41, s52, 4096
    buffer_load_dwordx4 v[44:47], v2, s[12:15], s41 offen offset:3072 sc1
    v_mfma_f32_16x16x32_bf16 v[172:175], v[132:135], v[20:23], v[172:175]
    ds_read_b128 v[108:111], v15 offset:55296
    ds_read_b128 v[112:115], v15 offset:56320
    s_waitcnt vmcnt(5)
    s_waitcnt lgkmcnt(5)
    v_mfma_f32_16x16x32_bf16 v[156:159], v[136:139], v[24:27], v[156:159]
    s_add_u32 s41, s52, 8192
    buffer_load_dwordx4 v[48:51], v2, s[12:15], s41 offen offset:0 sc1
    v_mfma_f32_16x16x32_bf16 v[160:163], v[140:143], v[24:27], v[160:163]
    ds_read_b128 v[116:119], v15 offset:57344
    v_mfma_f32_16x16x32_bf16 v[164:167], v[144:147], v[24:27], v[164:167]
    ds_read_b128 v[120:123], v15 offset:58368
    v_mfma_f32_16x16x32_bf16 v[168:171], v[148:151], v[24:27], v[168:171]
    ds_read_b128 v[124:127], v15 offset:59392
    s_add_u32 s41, s52, 8192
    buffer_load_dwordx4 v[52:55], v2, s[12:15], s41 offen offset:1024 sc1
    v_mfma_f32_16x16x32_bf16 v[172:175], v[152:155], v[24:27], v[172:175]
    ds_read_b128 v[128:131], v15 offset:60416
    ds_read_b128 v[132:135], v15 offset:61440
    s_waitcnt vmcnt(6)
    s_waitcnt lgkmcnt(5)
    v_mfma_f32_16x16x32_bf16 v[156:159], v[96:99], v[28:31], v[156:159]
    s_add_u32 s41, s52, 8192
    buffer_load_dwordx4 v[56:59], v2, s[12:15], s41 offen offset:2048 sc1
    v_mfma_f32_16x16x32_bf16 v[160:163], v[100:103], v[28:31], v[160:163]
    ds_read_b128 v[136:139], v15 offset:62464
    v_mfma_f32_16x16x32_bf16 v[164:167], v[104:107], v[28:31], v[164:167]
    ds_read_b128 v[140:143], v15 offset:63488
    v_mfma_f32_16x16x32_bf16 v[168:171], v[108:111], v[28:31], v[168:171]
    ds_read_b128 v[144:147], v15 offset:64512
    s_add_u32 s41, s52, 8192
    buffer_load_dwordx4 v[60:63], v2, s[12:15], s41 offen offset:3072 sc1
    v_mfma_f32_16x16x32_bf16 v[172:175], v[112:115], v[28:31], v[172:175]
    ds_read_b128 v[148:151], v11 offset:0
    ds_read_b128 v[152:155], v11 offset:1024
    s_waitcnt vmcnt(7)
    s_waitcnt lgkmcnt(5)
    v_mfma_f32_16x16x32_bf16 v[156:159], v[116:119], v[32:35], v[156:159]
    s_add_u32 s41, s52, 12288
    buffer_load_dwordx4 v[64:67], v2, s[12:15], s41 offen offset:0 sc1
    v_mfma_f32_16x16x32_bf16 v[160:163], v[120:123], v[32:35], v[160:163]
    ds_read_b128 v[96:99], v11 offset:2048
    v_mfma_f32_16x16x32_bf16 v[164:167], v[124:127], v[32:35], v[164:167]
    ds_read_b128 v[100:103], v11 offset:3072
    v_mfma_f32_16x16x32_bf16 v[168:171], v[128:131], v[32:35], v[168:171]
    ds_read_b128 v[104:107], v11 offset:4096
    s_add_u32 s41, s52, 12288
    buffer_load_dwordx4 v[68:71], v2, s[12:15], s41 offen offset:1024 sc1
    v_mfma_f32_16x16x32_bf16 v[172:175], v[132:135], v[32:35], v[172:175]
    ds_read_b128 v[108:111], v11 offset:5120
    ds_read_b128 v[112:115], v11 offset:6144
    s_waitcnt vmcnt(8)
    s_waitcnt lgkmcnt(5)
    v_mfma_f32_16x16x32_bf16 v[156:159], v[136:139], v[36:39], v[156:159]
    s_add_u32 s41, s52, 12288
    buffer_load_dwordx4 v[72:75], v2, s[12:15], s41 offen offset:2048 sc1
    v_mfma_f32_16x16x32_bf16 v[160:163], v[140:143], v[36:39], v[160:163]
    ds_read_b128 v[116:119], v11 offset:7168
    v_mfma_f32_16x16x32_bf16 v[164:167], v[144:147], v[36:39], v[164:167]
    ds_read_b128 v[120:123], v11 offset:8192
    v_mfma_f32_16x16x32_bf16 v[168:171], v[148:151], v[36:39], v[168:171]
    ds_read_b128 v[124:127], v11 offset:9216
    s_add_u32 s41, s52, 12288
    buffer_load_dwordx4 v[76:79], v2, s[12:15], s41 offen offset:3072 sc1
    v_mfma_f32_16x16x32_bf16 v[172:175], v[152:155], v[36:39], v[172:175]
    ds_read_b128 v[128:131], v11 offset:10240
    ds_read_b128 v[132:135], v11 offset:11264
    s_waitcnt vmcnt(9)
    s_waitcnt lgkmcnt(5)
    v_mfma_f32_16x16x32_bf16 v[156:159], v[96:99], v[40:43], v[156:159]
    s_add_u32 s41, s52, 16384
    buffer_load_dwordx4 v[80:83], v2, s[12:15], s41 offen offset:0 sc1
    v_mfma_f32_16x16x32_bf16 v[160:163], v[100:103], v[40:43], v[160:163]
    ds_read_b128 v[136:139], v11 offset:12288
    v_mfma_f32_16x16x32_bf16 v[164:167], v[104:107], v[40:43], v[164:167]
    ds_read_b128 v[140:143], v11 offset:13312
    v_mfma_f32_16x16x32_bf16 v[168:171], v[108:111], v[40:43], v[168:171]
    ds_read_b128 v[144:147], v11 offset:14336
    s_add_u32 s41, s52, 16384
    buffer_load_dwordx4 v[84:87], v2, s[12:15], s41 offen offset:1024 sc1
    v_mfma_f32_16x16x32_bf16 v[172:175], v[112:115], v[40:43], v[172:175]
    ds_read_b128 v[148:151], v11 offset:15360
    ds_read_b128 v[152:155], v11 offset:16384
    s_waitcnt vmcnt(10)
    s_waitcnt lgkmcnt(5)
    v_mfma_f32_16x16x32_bf16 v[156:159], v[116:119], v[44:47], v[156:159]
    s_add_u32 s41, s52, 16384
    buffer_load_dwordx4 v[88:91], v2, s[12:15], s41 offen offset:2048 sc1
    v_mfma_f32_16x16x32_bf16 v[160:163], v[120:123], v[44:47], v[160:163]
    ds_read_b128 v[96:99], v11 offset:17408
    v_mfma_f32_16x16x32_bf16 v[164:167], v[124:127], v[44:47], v[164:167]
    ds_read_b128 v[100:103], v11 offset:18432
    v_mfma_f32_16x16x32_bf16 v[168:171], v[128:131], v[44:47], v[168:171]
    ds_read_b128 v[104:107], v11 offset:19456
    s_add_u32 s41, s52, 16384
    buffer_load_dwordx4 v[92:95], v2, s[12:15], s41 offen offset:3072 sc1
    v_mfma_f32_16x16x32_bf16 v[172:175], v[132:135], v[44:47], v[172:175]
    ds_read_b128 v[108:111], v11 offset:20480
    ds_read_b128 v[112:115], v11 offset:21504
    s_waitcnt vmcnt(11)
    s_waitcnt lgkmcnt(5)
    v_mfma_f32_16x16x32_bf16 v[156:159], v[136:139], v[48:51], v[156:159]
    v_mfma_f32_16x16x32_bf16 v[160:163], v[140:143], v[48:51], v[160:163]
    ds_read_b128 v[116:119], v11 offset:22528
    buffer_load_dwordx4 v[176:179], v254, s[12:15], s48 offen sc1
    buffer_load_dwordx4 v[180:183], v254, s[12:15], s48 offen offset:1024 sc1
    buffer_load_dwordx2 v[184:185], v8, s[12:15], s48 offen offset:2048 sc1
    v_mfma_f32_16x16x32_bf16 v[164:167], v[144:147], v[48:51], v[164:167]
    ds_read_b128 v[120:123], v11 offset:23552
    v_mfma_f32_16x16x32_bf16 v[168:171], v[148:151], v[48:51], v[168:171]
    ds_read_b128 v[124:127], v14 offset:0
    v_mfma_f32_16x16x32_bf16 v[172:175], v[152:155], v[48:51], v[172:175]
    ds_read_b128 v[128:131], v14 offset:1024
    ds_read_b128 v[132:135], v14 offset:2048
    s_waitcnt vmcnt(13)
    s_waitcnt lgkmcnt(5)
    s_barrier
    v_mfma_f32_16x16x32_bf16 v[156:159], v[96:99], v[52:55], v[156:159]
    v_mfma_f32_16x16x32_bf16 v[160:163], v[100:103], v[52:55], v[160:163]
    ds_read_b128 v[136:139], v14 offset:3072
    v_mfma_f32_16x16x32_bf16 v[164:167], v[104:107], v[52:55], v[164:167]
    ds_read_b128 v[140:143], v14 offset:4096
    v_mfma_f32_16x16x32_bf16 v[168:171], v[108:111], v[52:55], v[168:171]
    ds_read_b128 v[144:147], v14 offset:5120
    v_mfma_f32_16x16x32_bf16 v[172:175], v[112:115], v[52:55], v[172:175]
    ds_read_b128 v[148:151], v14 offset:6144
    ds_read_b128 v[152:155], v14 offset:7168
    s_waitcnt vmcnt(12)
    s_waitcnt lgkmcnt(5)
    v_mfma_f32_16x16x32_bf16 v[156:159], v[116:119], v[56:59], v[156:159]
    v_mfma_f32_16x16x32_bf16 v[160:163], v[120:123], v[56:59], v[160:163]
    ds_read_b128 v[96:99], v14 offset:8192
    s_mul_i32 s38, s30, 12288
    s_add_u32 s39, s38, s45
    s_add_u32 s39, s39, 53248
    s_add_u32 s38, s38, 102400
    s_mov_b32 m0, s38
    s_nop 0
    buffer_load_dwordx4 v2, s[12:15], s39 offen offset:0 lds
    v_mfma_f32_16x16x32_bf16 v[164:167], v[124:127], v[56:59], v[164:167]
    ds_read_b128 v[100:103], v14 offset:9216
    v_mfma_f32_16x16x32_bf16 v[168:171], v[128:131], v[56:59], v[168:171]
    ds_read_b128 v[104:107], v14 offset:10240
    v_mfma_f32_16x16x32_bf16 v[172:175], v[132:135], v[56:59], v[172:175]
    ds_read_b128 v[108:111], v14 offset:11264
    ds_read_b128 v[112:115], v14 offset:12288
    s_mov_b32 m0, s38
    s_nop 0
    buffer_load_dwordx4 v2, s[12:15], s39 offen offset:1024 lds
    s_waitcnt vmcnt(13)
    s_waitcnt lgkmcnt(5)
    v_mfma_f32_16x16x32_bf16 v[156:159], v[136:139], v[60:63], v[156:159]
    v_mfma_f32_16x16x32_bf16 v[160:163], v[140:143], v[60:63], v[160:163]
    ds_read_b128 v[116:119], v14 offset:13312
    s_mov_b32 m0, s38
    s_nop 0
    buffer_load_dwordx4 v2, s[12:15], s39 offen offset:2048 lds
    v_mfma_f32_16x16x32_bf16 v[164:167], v[144:147], v[60:63], v[164:167]
    ds_read_b128 v[120:123], v14 offset:14336
    v_mfma_f32_16x16x32_bf16 v[168:171], v[148:151], v[60:63], v[168:171]
    ds_read_b128 v[124:127], v14 offset:15360
    v_mfma_f32_16x16x32_bf16 v[172:175], v[152:155], v[60:63], v[172:175]
    ds_read_b128 v[128:131], v14 offset:16384
    ds_read_b128 v[132:135], v14 offset:17408
    s_mov_b32 m0, s38
    s_nop 0
    buffer_load_dwordx4 v2, s[12:15], s39 offen offset:3072 lds
    s_add_u32 s38, s38, 4096
    s_add_u32 s39, s39, 4096
    s_waitcnt vmcnt(14)
    s_waitcnt lgkmcnt(5)
    v_mfma_f32_16x16x32_bf16 v[156:159], v[96:99], v[64:67], v[156:159]
    v_mfma_f32_16x16x32_bf16 v[160:163], v[100:103], v[64:67], v[160:163]
    ds_read_b128 v[136:139], v14 offset:18432
    s_mov_b32 m0, s38
    s_nop 0
    buffer_load_dwordx4 v2, s[12:15], s39 offen offset:0 lds
    v_mfma_f32_16x16x32_bf16 v[164:167], v[104:107], v[64:67], v[164:167]
    ds_read_b128 v[140:143], v14 offset:19456
    v_mfma_f32_16x16x32_bf16 v[168:171], v[108:111], v[64:67], v[168:171]
    ds_read_b128 v[144:147], v14 offset:20480
    v_mfma_f32_16x16x32_bf16 v[172:175], v[112:115], v[64:67], v[172:175]
    ds_read_b128 v[148:151], v14 offset:21504
    ds_read_b128 v[152:155], v14 offset:22528
    s_mov_b32 m0, s38
    s_nop 0
    buffer_load_dwordx4 v2, s[12:15], s39 offen offset:1024 lds
    s_waitcnt vmcnt(15)
    s_waitcnt lgkmcnt(5)
    v_mfma_f32_16x16x32_bf16 v[156:159], v[116:119], v[68:71], v[156:159]
    v_mfma_f32_16x16x32_bf16 v[160:163], v[120:123], v[68:71], v[160:163]
    ds_read_b128 v[96:99], v14 offset:23552
    s_mov_b32 m0, s38
    s_nop 0
    buffer_load_dwordx4 v2, s[12:15], s39 offen offset:2048 lds
    v_mfma_f32_16x16x32_bf16 v[164:167], v[124:127], v[68:71], v[164:167]
    ds_read_b128 v[100:103], v14 offset:24576
    v_mfma_f32_16x16x32_bf16 v[168:171], v[128:131], v[68:71], v[168:171]
    ds_read_b128 v[104:107], v14 offset:25600
    v_mfma_f32_16x16x32_bf16 v[172:175], v[132:135], v[68:71], v[172:175]
    ds_read_b128 v[108:111], v14 offset:26624
    ds_read_b128 v[112:115], v14 offset:27648
    s_mov_b32 m0, s38
    s_nop 0
    buffer_load_dwordx4 v2, s[12:15], s39 offen offset:3072 lds
    s_add_u32 s38, s38, 4096
    s_add_u32 s39, s39, 4096
    s_waitcnt vmcnt(16)
    s_waitcnt lgkmcnt(5)
    v_mfma_f32_16x16x32_bf16 v[156:159], v[136:139], v[72:75], v[156:159]
    v_mfma_f32_16x16x32_bf16 v[160:163], v[140:143], v[72:75], v[160:163]
    ds_read_b128 v[116:119], v14 offset:28672
    s_mov_b32 m0, s38
    s_nop 0
    buffer_load_dwordx4 v2, s[12:15], s39 offen offset:0 lds
    v_mfma_f32_16x16x32_bf16 v[164:167], v[144:147], v[72:75], v[164:167]
    ds_read_b128 v[120:123], v14 offset:29696
    v_mfma_f32_16x16x32_bf16 v[168:171], v[148:151], v[72:75], v[168:171]
    ds_read_b128 v[124:127], v14 offset:30720
    v_mfma_f32_16x16x32_bf16 v[172:175], v[152:155], v[72:75], v[172:175]
    ds_read_b128 v[128:131], v14 offset:31744
    ds_read_b128 v[132:135], v14 offset:32768
    s_mov_b32 m0, s38
    s_nop 0
    buffer_load_dwordx4 v2, s[12:15], s39 offen offset:1024 lds
    s_waitcnt vmcnt(17)
    s_waitcnt lgkmcnt(5)
    v_mfma_f32_16x16x32_bf16 v[156:159], v[96:99], v[76:79], v[156:159]
    v_mfma_f32_16x16x32_bf16 v[160:163], v[100:103], v[76:79], v[160:163]
    ds_read_b128 v[136:139], v14 offset:33792
    s_mov_b32 m0, s38
    s_nop 0
    buffer_load_dwordx4 v2, s[12:15], s39 offen offset:2048 lds
    v_mfma_f32_16x16x32_bf16 v[164:167], v[104:107], v[76:79], v[164:167]
    ds_read_b128 v[140:143], v14 offset:34816
    v_mfma_f32_16x16x32_bf16 v[168:171], v[108:111], v[76:79], v[168:171]
    ds_read_b128 v[144:147], v14 offset:35840
    v_mfma_f32_16x16x32_bf16 v[172:175], v[112:115], v[76:79], v[172:175]
    ds_read_b128 v[148:151], v14 offset:36864
    ds_read_b128 v[152:155], v14 offset:37888
    s_mov_b32 m0, s38
    s_nop 0
    buffer_load_dwordx4 v2, s[12:15], s39 offen offset:3072 lds
    s_waitcnt vmcnt(18)
    s_waitcnt lgkmcnt(5)
    v_mfma_f32_16x16x32_bf16 v[156:159], v[116:119], v[80:83], v[156:159]
    v_mfma_f32_16x16x32_bf16 v[160:163], v[120:123], v[80:83], v[160:163]
    ds_read_b128 v[96:99], v14 offset:38912
    v_mfma_f32_16x16x32_bf16 v[164:167], v[124:127], v[80:83], v[164:167]
    ds_read_b128 v[100:103], v14 offset:39936
    v_mfma_f32_16x16x32_bf16 v[168:171], v[128:131], v[80:83], v[168:171]
    ds_read_b128 v[104:107], v14 offset:40960
    v_mfma_f32_16x16x32_bf16 v[172:175], v[132:135], v[80:83], v[172:175]
    ds_read_b128 v[108:111], v14 offset:41984
    ds_read_b128 v[112:115], v14 offset:43008
    s_waitcnt vmcnt(17)
    s_waitcnt lgkmcnt(5)
    v_mfma_f32_16x16x32_bf16 v[156:159], v[136:139], v[84:87], v[156:159]
    v_mfma_f32_16x16x32_bf16 v[160:163], v[140:143], v[84:87], v[160:163]
    ds_read_b128 v[116:119], v14 offset:44032
    v_mfma_f32_16x16x32_bf16 v[164:167], v[144:147], v[84:87], v[164:167]
    ds_read_b128 v[120:123], v14 offset:45056
    v_mfma_f32_16x16x32_bf16 v[168:171], v[148:151], v[84:87], v[168:171]
    ds_read_b128 v[124:127], v14 offset:46080
    v_mfma_f32_16x16x32_bf16 v[172:175], v[152:155], v[84:87], v[172:175]
    ds_read_b128 v[128:131], v14 offset:47104
    ds_read_b128 v[132:135], v14 offset:48128
    s_waitcnt vmcnt(16)
    s_waitcnt lgkmcnt(5)
    v_mfma_f32_16x16x32_bf16 v[156:159], v[96:99], v[88:91], v[156:159]
    v_mfma_f32_16x16x32_bf16 v[160:163], v[100:103], v[88:91], v[160:163]
    v_mfma_f32_16x16x32_bf16 v[164:167], v[104:107], v[88:91], v[164:167]
    v_mfma_f32_16x16x32_bf16 v[168:171], v[108:111], v[88:91], v[168:171]
    v_mfma_f32_16x16x32_bf16 v[172:175], v[112:115], v[88:91], v[172:175]
    s_waitcnt vmcnt(15)
    s_waitcnt lgkmcnt(0)
    v_mfma_f32_16x16x32_bf16 v[156:159], v[116:119], v[92:95], v[156:159]
    v_mfma_f32_16x16x32_bf16 v[160:163], v[120:123], v[92:95], v[160:163]
    v_mfma_f32_16x16x32_bf16 v[164:167], v[124:127], v[92:95], v[164:167]
    v_mfma_f32_16x16x32_bf16 v[168:171], v[128:131], v[92:95], v[168:171]
    v_mfma_f32_16x16x32_bf16 v[172:175], v[132:135], v[92:95], v[172:175]
    s_barrier
    s_mul_i32 s38, s30, 1024
    s_add_u32 s39, s38, s45
    s_add_u32 s39, s39, 102400
    s_add_u32 s38, s38, 151552
    s_mov_b32 m0, s38
    s_nop 0
    buffer_load_dwordx4 v2, s[12:15], s39 offen offset:0 lds
    s_mul_i32 s38, s30, 9216
    s_add_u32 s39, s38, s45
    s_add_u32 s39, s39, 106496
    s_add_u32 s38, s38, 0
    s_mov_b32 m0, s38
    s_nop 0
    buffer_load_dwordx4 v2, s[12:15], s39 offen offset:0 lds
    s_mov_b32 m0, s38
    s_nop 0
    buffer_load_dwordx4 v2, s[12:15], s39 offen offset:1024 lds
    s_mov_b32 m0, s38
    s_nop 0
    buffer_load_dwordx4 v2, s[12:15], s39 offen offset:2048 lds
    s_mov_b32 m0, s38
    s_nop 0
    buffer_load_dwordx4 v2, s[12:15], s39 offen offset:3072 lds
    s_add_u32 s38, s38, 4096
    s_add_u32 s39, s39, 4096
    s_mov_b32 m0, s38
    s_nop 0
    buffer_load_dwordx4 v2, s[12:15], s39 offen offset:0 lds
    s_mov_b32 m0, s38
    s_nop 0
    buffer_load_dwordx4 v2, s[12:15], s39 offen offset:1024 lds
    s_mov_b32 m0, s38
    s_nop 0
    buffer_load_dwordx4 v2, s[12:15], s39 offen offset:2048 lds
    s_mov_b32 m0, s38
    s_nop 0
    buffer_load_dwordx4 v2, s[12:15], s39 offen offset:3072 lds
    s_add_u32 s38, s38, 4096
    s_add_u32 s39, s39, 4096
    s_mov_b32 m0, s38
    s_nop 0
    buffer_load_dwordx4 v2, s[12:15], s39 offen offset:0 lds
    v_mov_b32 v196, 0x3f803f80
    v_mov_b32 v198, 0
    v_mov_b32 v199, 0
    s_waitcnt vmcnt(22)
    s_nop 1
    v_permlane16_swap_b32 v176, v178
    v_permlane16_swap_b32 v177, v179
    v_permlane16_swap_b32 v180, v182
    v_permlane16_swap_b32 v181, v183
    s_nop 1
    v_lshlrev_b32 v200, 16, v176
    v_and_b32 v201, 0xffff0000, v176
    v_lshlrev_b32 v202, 16, v177
    v_and_b32 v203, 0xffff0000, v177
    v_lshlrev_b32 v204, 16, v178
    v_and_b32 v205, 0xffff0000, v178
    v_lshlrev_b32 v206, 16, v179
    v_and_b32 v207, 0xffff0000, v179
    v_lshlrev_b32 v208, 16, v180
    v_and_b32 v209, 0xffff0000, v180
    v_lshlrev_b32 v210, 16, v181
    v_and_b32 v211, 0xffff0000, v181
    v_lshlrev_b32 v212, 16, v182
    v_and_b32 v213, 0xffff0000, v182
    v_lshlrev_b32 v214, 16, v183
    v_and_b32 v215, 0xffff0000, v183
    v_lshlrev_b32 v216, 16, v184
    v_and_b32 v217, 0xffff0000, v184
    v_lshlrev_b32 v218, 16, v185
    v_and_b32 v219, 0xffff0000, v185
    v_pk_add_f32 v[156:157], v[156:157], v[200:201]
    v_pk_add_f32 v[158:159], v[158:159], v[202:203]
    v_pk_add_f32 v[160:161], v[160:161], v[204:205]
    v_pk_add_f32 v[162:163], v[162:163], v[206:207]
    v_pk_add_f32 v[164:165], v[164:165], v[208:209]
    v_pk_add_f32 v[166:167], v[166:167], v[210:211]
    v_pk_add_f32 v[168:169], v[168:169], v[212:213]
    v_pk_add_f32 v[170:171], v[170:171], v[214:215]
    v_pk_add_f32 v[172:173], v[172:173], v[216:217]
    v_pk_add_f32 v[174:175], v[174:175], v[218:219]
    v_cvt_pk_bf16_f32 v156, v156, v157
    v_cvt_pk_bf16_f32 v157, v158, v159
    v_cvt_pk_bf16_f32 v158, v160, v161
    v_cvt_pk_bf16_f32 v159, v162, v163
    v_cvt_pk_bf16_f32 v164, v164, v165
    v_cvt_pk_bf16_f32 v165, v166, v167
    v_cvt_pk_bf16_f32 v166, v168, v169
    v_cvt_pk_bf16_f32 v167, v170, v171
    v_cvt_pk_bf16_f32 v172, v172, v173
    v_cvt_pk_bf16_f32 v173, v174, v175
    v_dot2_f32_bf16 v198, v156, v196, v198
    v_dot2_f32_bf16 v199, v156, v156, v199
    v_dot2_f32_bf16 v198, v157, v196, v198
    v_dot2_f32_bf16 v199, v157, v157, v199
    v_dot2_f32_bf16 v198, v158, v196, v198
    v_dot2_f32_bf16 v199, v158, v158, v199
    v_dot2_f32_bf16 v198, v159, v196, v198
    v_dot2_f32_bf16 v199, v159, v159, v199
    v_dot2_f32_bf16 v198, v164, v196, v198
    v_dot2_f32_bf16 v199, v164, v164, v199
    v_dot2_f32_bf16 v198, v165, v196, v198
    v_dot2_f32_bf16 v199, v165, v165, v199
    v_dot2_f32_bf16 v198, v166, v196, v198
    v_dot2_f32_bf16 v199, v166, v166, v199
    v_dot2_f32_bf16 v198, v167, v196, v198
    v_dot2_f32_bf16 v199, v167, v167, v199
    v_dot2_f32_bf16 v198, v172, v196, v198
    v_dot2_f32_bf16 v199, v172, v172, v199
    v_dot2_f32_bf16 v198, v173, v196, v198
    v_dot2_f32_bf16 v199, v173, v173, v199
    s_nop 1
    s_nop 1
    v_permlane16_swap_b32 v156, v158
    v_permlane16_swap_b32 v157, v159
    v_permlane16_swap_b32 v164, v166
    v_permlane16_swap_b32 v165, v167
    s_nop 2
    v_mov_b32 v188, v198
    v_mov_b32 v189, v199
    s_nop 1
    v_permlane32_swap_b32 v188, v198
    v_permlane32_swap_b32 v189, v199
    s_nop 0
    v_add_f32 v198, v198, v188
    v_add_f32 v199, v199, v189
    v_mov_b32 v188, v198
    v_mov_b32 v189, v199
    s_nop 1
    v_permlane16_swap_b32 v188, v198
    v_permlane16_swap_b32 v189, v199
    s_nop 0
    v_add_f32 v198, v198, v188
    v_add_f32 v199, v199, v189
    s_add_u32 s47, s54, 20480
    v_lshlrev_b32 v9, 6, v4
    s_lshl_b32 s41, s33, 3
    s_add_u32 s46, s46, s41
    s_lshl_b32 s41, s33, 2
    s_add_u32 s49, s55, s41
    v_mov_b32 v11, v9
    s_cmp_eq_u32 s31, 0
    s_cbranch_scc1 k2_kernel_slow26
    buffer_store_dwordx4 v[156:159], v254, s[12:15], s47 offen offset:0
    buffer_store_dwordx4 v[164:167], v254, s[12:15], s47 offen offset:1024
    buffer_store_dwordx2 v[172:173], v8, s[12:15], s47 offen offset:2048
    s_mov_b64 exec, 0xffff
    buffer_store_dwordx2 v[198:199], v11, s[12:15], s46 offen
    s_mov_b64 exec, -1
    s_waitcnt vmcnt(0)
    v_mov_b32 v9, 1
    v_mov_b32 v10, 4352
    s_mov_b64 exec, 1
    buffer_store_dword v9, v10, s[12:15], s49 offen
    s_mov_b64 exec, -1
    s_branch k2_kernel_sent27
k2_kernel_slow26:
    buffer_store_dwordx4 v[156:159], v254, s[12:15], s47 offen offset:0 sc1
    buffer_store_dwordx4 v[164:167], v254, s[12:15], s47 offen offset:1024 sc1
    buffer_store_dwordx2 v[172:173], v8, s[12:15], s47 offen offset:2048 sc1
    s_mov_b64 exec, 0xffff
    buffer_store_dwordx2 v[198:199], v11, s[12:15], s46 offen sc1
    s_mov_b64 exec, -1
    s_waitcnt vmcnt(0)
    v_mov_b32 v9, 1
    v_mov_b32 v10, 4352
    s_mov_b64 exec, 1
    buffer_store_dword v9, v10, s[12:15], s49 offen sc1
    s_mov_b64 exec, -1
k2_kernel_sent27:
    s_lshl_b32 s46, s34, 3
    s_lshl_b32 s47, s30, 1
    s_add_u32 s46, s46, s47
    s_lshl_b32 s49, s46, 7
    s_add_u32 s49, s49, 4352
    v_bfe_u32 v7, v1, 3, 1
    v_lshlrev_b32 v7, 7, v7
    v_and_b32 v9, 7, v1
    v_lshl_add_u32 v7, v9, 2, v7
    v_add_u32 v7, s49, v7
    s_sub_u32 s49, s55, s37
    s_add_u32 s49, s49, 128
    v_and_b32 v9, 3, v1
    v_lshlrev_b32 v9, 2, v9
    v_add_u32 v9, s49, v9
    v_and_b32 v10, 16, v1
    v_cmp_ne_u32 vcc, 0, v10
    v_mov_b32 v11, 1
    v_mov_b32 v10, 3
    v_cndmask_b32 v7, v7, v9, vcc
    v_cndmask_b32 v10, v11, v10, vcc
    s_mov_b32 s43, 200000
k2_kernel_poll28:
    buffer_load_dword v9, v7, s[12:15], s37 offen sc1
    s_waitcnt vmcnt(0)
    v_cmp_le_u32 vcc, v10, v9
    s_sub_u32 s43, s43, 1
    s_cmp_eq_u64 vcc, -1
    s_cbranch_scc1 k2_kernel_go29
    s_cmp_lg_u32 s43, 0
    s_cbranch_scc1 k2_kernel_poll28
k2_kernel_go29:
    s_mul_i32 s47, s46, 20480
    s_add_u32 s47, s47, s36
    s_add_u32 s47, s47, 20480
    s_add_u32 s48, s47, 20480
    s_add_u32 s41, s47, 0
    buffer_load_dwordx4 v[72:75], v2, s[12:15], s41 offen offset:0 sc1
    s_add_u32 s41, s48, 0
    buffer_load_dwordx4 v[76:79], v2, s[12:15], s41 offen offset:0 sc1
    s_add_u32 s41, s47, 0
    buffer_load_dwordx4 v[80:83], v2, s[12:15], s41 offen offset:1024 sc1
    s_add_u32 s41, s48, 0
    buffer_load_dwordx4 v[84:87], v2, s[12:15], s41 offen offset:1024 sc1
    s_add_u32 s41, s47, 0
    buffer_load_dwordx4 v[88:91], v2, s[12:15], s41 offen offset:2048 sc1
    s_add_u32 s41, s48, 0
    buffer_load_dwordx4 v[92:95], v2, s[12:15], s41 offen offset:2048 sc1
    v_lshlrev_b32 v9, 6, v4
    v_lshl_add_u32 v9, v3, 4, v9
    s_lshl_b32 s41, s46, 10
    s_add_u32 s41, s41, s36
    s_add_u32 s41, s41, 1581056
    buffer_load_dwordx4 v[216:219], v9, s[12:15], s41 offen offset:0 sc1
    buffer_load_dwordx4 v[220:223], v9, s[12:15], s41 offen offset:1024 sc1
    s_mul_i32 s52, s46, 55296
    s_mul_i32 s41, s35, 3584
    s_add_u32 s52, s52, s41
    s_add_u32 s52, s52, s36
    s_add_u32 s52, s52, 696320
    s_add_u32 s53, s52, 55296
    s_barrier
    v_add_u32 v11, 0x20000, v2
    ds_read_b128 v[160:163], v14 offset:49152
    ds_read_b128 v[164:167], v14 offset:50176
    ds_read_b128 v[168:171], v14 offset:51200
    ds_read_b128 v[172:175], v14 offset:52224
    ds_read_b128 v[176:179], v14 offset:53248
    ds_read_b128 v[180:183], v14 offset:54272
    ds_read_b128 v[184:187], v14 offset:55296
    s_waitcnt vmcnt(6)
    s_waitcnt lgkmcnt(6)
    v_mfma_f32_16x16x32_bf16 v[16:19], v[160:163], v[72:75], 0
    v_mfma_f32_16x16x32_bf16 v[44:47], v[160:163], v[76:79], 0
    ds_read_b128 v[188:191], v14 offset:56320
    s_waitcnt lgkmcnt(6)
    v_mfma_f32_16x16x32_bf16 v[20:23], v[164:167], v[72:75], 0
    v_mfma_f32_16x16x32_bf16 v[48:51], v[164:167], v[76:79], 0
    ds_read_b128 v[192:195], v14 offset:57344
    s_add_u32 s41, s47, 0
    buffer_load_dwordx4 v[96:99], v2, s[12:15], s41 offen offset:3072 sc1
    s_add_u32 s41, s48, 0
    buffer_load_dwordx4 v[100:103], v2, s[12:15], s41 offen offset:3072 sc1
    s_waitcnt lgkmcnt(6)
    v_mfma_f32_16x16x32_bf16 v[24:27], v[168:171], v[72:75], 0
    v_mfma_f32_16x16x32_bf16 v[52:55], v[168:171], v[76:79], 0
    ds_read_b128 v[196:199], v14 offset:58368
    s_waitcnt lgkmcnt(6)
    v_mfma_f32_16x16x32_bf16 v[28:31], v[172:175], v[72:75], 0
    v_mfma_f32_16x16x32_bf16 v[56:59], v[172:175], v[76:79], 0
    ds_read_b128 v[200:203], v14 offset:59392
    s_waitcnt lgkmcnt(6)
    v_mfma_f32_16x16x32_bf16 v[32:35], v[176:179], v[72:75], 0
    v_mfma_f32_16x16x32_bf16 v[60:63], v[176:179], v[76:79], 0
    ds_read_b128 v[204:207], v14 offset:60416
    s_add_u32 s41, s47, 4096
    buffer_load_dwordx4 v[104:107], v2, s[12:15], s41 offen offset:0 sc1
    s_add_u32 s41, s48, 4096
    buffer_load_dwordx4 v[108:111], v2, s[12:15], s41 offen offset:0 sc1
    s_waitcnt lgkmcnt(6)
    v_mfma_f32_16x16x32_bf16 v[36:39], v[180:183], v[72:75], 0
    v_mfma_f32_16x16x32_bf16 v[64:67], v[180:183], v[76:79], 0
    ds_read_b128 v[208:211], v14 offset:61440
    s_waitcnt lgkmcnt(6)
    v_mfma_f32_16x16x32_bf16 v[40:43], v[184:187], v[72:75], 0
    v_mfma_f32_16x16x32_bf16 v[68:71], v[184:187], v[76:79], 0
    ds_read_b128 v[212:215], v14 offset:62464
    s_waitcnt vmcnt(8)
    s_waitcnt lgkmcnt(6)
    v_mfma_f32_16x16x32_bf16 v[16:19], v[188:191], v[80:83], v[16:19]
    v_mfma_f32_16x16x32_bf16 v[44:47], v[188:191], v[84:87], v[44:47]
    ds_read_b128 v[160:163], v14 offset:63488
    s_waitcnt lgkmcnt(6)
    v_mfma_f32_16x16x32_bf16 v[20:23], v[192:195], v[80:83], v[20:23]
    v_mfma_f32_16x16x32_bf16 v[48:51], v[192:195], v[84:87], v[48:51]
    ds_read_b128 v[164:167], v14 offset:64512
    s_add_u32 s41, s47, 4096
    buffer_load_dwordx4 v[112:115], v2, s[12:15], s41 offen offset:1024 sc1
    s_add_u32 s41, s48, 4096
    buffer_load_dwordx4 v[116:119], v2, s[12:15], s41 offen offset:1024 sc1
    s_waitcnt lgkmcnt(6)
    v_mfma_f32_16x16x32_bf16 v[24:27], v[196:199], v[80:83], v[24:27]
    v_mfma_f32_16x16x32_bf16 v[52:55], v[196:199], v[84:87], v[52:55]
    ds_read_b128 v[168:171], v15 offset:0
    buffer_load_dwordx4 a[0:3], v2, s[12:15], s40 offen offset:0
    s_waitcnt lgkmcnt(6)
    v_mfma_f32_16x16x32_bf16 v[28:31], v[200:203], v[80:83], v[28:31]
    v_mfma_f32_16x16x32_bf16 v[56:59], v[200:203], v[84:87], v[56:59]
    ds_read_b128 v[172:175], v15 offset:1024
    buffer_load_dwordx4 a[4:7], v2, s[12:15], s40 offen offset:1024
    s_waitcnt lgkmcnt(6)
    v_mfma_f32_16x16x32_bf16 v[32:35], v[204:207], v[80:83], v[32:35]
    v_mfma_f32_16x16x32_bf16 v[60:63], v[204:207], v[84:87], v[60:63]
    ds_read_b128 v[176:179], v15 offset:2048
    s_add_u32 s41, s47, 4096
    buffer_load_dwordx4 v[120:123], v2, s[12:15], s41 offen offset:2048 sc1
    s_add_u32 s41, s48, 4096
    buffer_load_dwordx4 v[124:127], v2, s[12:15], s41 offen offset:2048 sc1
    s_waitcnt lgkmcnt(6)
    v_mfma_f32_16x16x32_bf16 v[36:39], v[208:211], v[80:83], v[36:39]
    v_mfma_f32_16x16x32_bf16 v[64:67], v[208:211], v[84:87], v[64:67]
    ds_read_b128 v[180:183], v15 offset:3072
    buffer_load_dwordx4 a[8:11], v2, s[12:15], s40 offen offset:2048
    s_waitcnt lgkmcnt(6)
    v_mfma_f32_16x16x32_bf16 v[40:43], v[212:215], v[80:83], v[40:43]
    v_mfma_f32_16x16x32_bf16 v[68:71], v[212:215], v[84:87], v[68:71]
    ds_read_b128 v[184:187], v15 offset:4096
    s_waitcnt vmcnt(13)
    s_waitcnt lgkmcnt(6)
    v_mfma_f32_16x16x32_bf16 v[16:19], v[160:163], v[88:91], v[16:19]
    v_mfma_f32_16x16x32_bf16 v[44:47], v[160:163], v[92:95], v[44:47]
    ds_read_b128 v[188:191], v15 offset:5120
    s_waitcnt lgkmcnt(6)
    v_mfma_f32_16x16x32_bf16 v[20:23], v[164:167], v[88:91], v[20:23]
    v_mfma_f32_16x16x32_bf16 v[48:51], v[164:167], v[92:95], v[48:51]
    ds_read_b128 v[192:195], v15 offset:6144
    s_add_u32 s41, s47, 4096
    buffer_load_dwordx4 v[128:131], v2, s[12:15], s41 offen offset:3072 sc1
    s_add_u32 s41, s48, 4096
    buffer_load_dwordx4 v[132:135], v2, s[12:15], s41 offen offset:3072 sc1
    s_waitcnt lgkmcnt(6)
    v_mfma_f32_16x16x32_bf16 v[24:27], v[168:171], v[88:91], v[24:27]
    v_mfma_f32_16x16x32_bf16 v[52:55], v[168:171], v[92:95], v[52:55]
    ds_read_b128 v[196:199], v15 offset:7168
    buffer_load_dwordx4 a[12:15], v2, s[12:15], s40 offen offset:3072
    s_add_u32 s40, s40, 4096
    s_waitcnt lgkmcnt(6)
    v_mfma_f32_16x16x32_bf16 v[28:31], v[172:175], v[88:91], v[28:31]
    v_mfma_f32_16x16x32_bf16 v[56:59], v[172:175], v[92:95], v[56:59]
    ds_read_b128 v[200:203], v15 offset:8192
    buffer_load_dwordx4 a[16:19], v2, s[12:15], s40 offen offset:0
    s_waitcnt lgkmcnt(6)
    v_mfma_f32_16x16x32_bf16 v[32:35], v[176:179], v[88:91], v[32:35]
    v_mfma_f32_16x16x32_bf16 v[60:63], v[176:179], v[92:95], v[60:63]
    ds_read_b128 v[204:207], v15 offset:9216
    s_add_u32 s41, s47, 8192
    buffer_load_dwordx4 v[136:139], v2, s[12:15], s41 offen offset:0 sc1
    s_add_u32 s41, s48, 8192
    buffer_load_dwordx4 v[140:143], v2, s[12:15], s41 offen offset:0 sc1
    s_waitcnt lgkmcnt(6)
    v_mfma_f32_16x16x32_bf16 v[36:39], v[180:183], v[88:91], v[36:39]
    v_mfma_f32_16x16x32_bf16 v[64:67], v[180:183], v[92:95], v[64:67]
    ds_read_b128 v[208:211], v15 offset:10240
    buffer_load_dwordx4 a[20:23], v2, s[12:15], s40 offen offset:1024
    s_waitcnt lgkmcnt(6)
    v_mfma_f32_16x16x32_bf16 v[40:43], v[184:187], v[88:91], v[40:43]
    v_mfma_f32_16x16x32_bf16 v[68:71], v[184:187], v[92:95], v[68:71]
    ds_read_b128 v[212:215], v15 offset:11264
    s_waitcnt vmcnt(16)
    s_waitcnt lgkmcnt(6)
    v_mfma_f32_16x16x32_bf16 v[16:19], v[188:191], v[96:99], v[16:19]
    v_mfma_f32_16x16x32_bf16 v[44:47], v[188:191], v[100:103], v[44:47]
    ds_read_b128 v[160:163], v15 offset:12288
    s_waitcnt lgkmcnt(6)
    v_mfma_f32_16x16x32_bf16 v[20:23], v[192:195], v[96:99], v[20:23]
    v_mfma_f32_16x16x32_bf16 v[48:51], v[192:195], v[100:103], v[48:51]
    ds_read_b128 v[164:167], v15 offset:13312
    s_add_u32 s41, s47, 8192
    buffer_load_dwordx4 v[144:147], v2, s[12:15], s41 offen offset:1024 sc1
    s_add_u32 s41, s48, 8192
    buffer_load_dwordx4 v[148:151], v2, s[12:15], s41 offen offset:1024 sc1
    s_waitcnt lgkmcnt(6)
    v_mfma_f32_16x16x32_bf16 v[24:27], v[196:199], v[96:99], v[24:27]
    v_mfma_f32_16x16x32_bf16 v[52:55], v[196:199], v[100:103], v[52:55]
    ds_read_b128 v[168:171], v15 offset:14336
    buffer_load_dwordx4 a[24:27], v2, s[12:15], s40 offen offset:2048
    s_waitcnt lgkmcnt(6)
    v_mfma_f32_16x16x32_bf16 v[28:31], v[200:203], v[96:99], v[28:31]
    v_mfma_f32_16x16x32_bf16 v[56:59], v[200:203], v[100:103], v[56:59]
    ds_read_b128 v[172:175], v15 offset:15360
    buffer_load_dwordx4 a[28:31], v2, s[12:15], s40 offen offset:3072
    s_add_u32 s40, s40, 4096
    s_waitcnt lgkmcnt(6)
    v_mfma_f32_16x16x32_bf16 v[32:35], v[204:207], v[96:99], v[32:35]
    v_mfma_f32_16x16x32_bf16 v[60:63], v[204:207], v[100:103], v[60:63]
    ds_read_b128 v[176:179], v15 offset:16384
    s_waitcnt lgkmcnt(6)
    v_mfma_f32_16x16x32_bf16 v[36:39], v[208:211], v[96:99], v[36:39]
    v_mfma_f32_16x16x32_bf16 v[64:67], v[208:211], v[100:103], v[64:67]
    ds_read_b128 v[180:183], v15 offset:17408
    buffer_load_dwordx4 a[32:35], v2, s[12:15], s40 offen offset:0
    s_waitcnt lgkmcnt(6)
    v_mfma_f32_16x16x32_bf16 v[40:43], v[212:215], v[96:99], v[40:43]
    v_mfma_f32_16x16x32_bf16 v[68:71], v[212:215], v[100:103], v[68:71]
    ds_read_b128 v[184:187], v15 offset:18432
    s_waitcnt vmcnt(19)
    s_waitcnt lgkmcnt(6)
    v_mfma_f32_16x16x32_bf16 v[16:19], v[160:163], v[104:107], v[16:19]
    v_mfma_f32_16x16x32_bf16 v[44:47], v[160:163], v[108:111], v[44:47]
    ds_read_b128 v[188:191], v15 offset:19456
    s_waitcnt lgkmcnt(6)
    v_mfma_f32_16x16x32_bf16 v[20:23], v[164:167], v[104:107], v[20:23]
    v_mfma_f32_16x16x32_bf16 v[48:51], v[164:167], v[108:111], v[48:51]
    ds_read_b128 v[192:195], v15 offset:20480
    s_add_u32 s41, s47, 8192
    buffer_load_dwordx4 v[152:155], v2, s[12:15], s41 offen offset:2048 sc1
    s_add_u32 s41, s48, 8192
    buffer_load_dwordx4 v[156:159], v2, s[12:15], s41 offen offset:2048 sc1
    s_waitcnt lgkmcnt(6)
    v_mfma_f32_16x16x32_bf16 v[24:27], v[168:171], v[104:107], v[24:27]
    v_mfma_f32_16x16x32_bf16 v[52:55], v[168:171], v[108:111], v[52:55]
    ds_read_b128 v[196:199], v15 offset:21504
    buffer_load_dwordx4 a[36:39], v2, s[12:15], s40 offen offset:1024
    s_waitcnt lgkmcnt(6)
    v_mfma_f32_16x16x32_bf16 v[28:31], v[172:175], v[104:107], v[28:31]
    v_mfma_f32_16x16x32_bf16 v[56:59], v[172:175], v[108:111], v[56:59]
    ds_read_b128 v[200:203], v15 offset:22528
    buffer_load_dwordx4 a[40:43], v2, s[12:15], s40 offen offset:2048
    s_waitcnt lgkmcnt(6)
    v_mfma_f32_16x16x32_bf16 v[32:35], v[176:179], v[104:107], v[32:35]
    v_mfma_f32_16x16x32_bf16 v[60:63], v[176:179], v[108:111], v[60:63]
    ds_read_b128 v[204:207], v15 offset:23552
    s_waitcnt lgkmcnt(6)
    v_mfma_f32_16x16x32_bf16 v[36:39], v[180:183], v[104:107], v[36:39]
    v_mfma_f32_16x16x32_bf16 v[64:67], v[180:183], v[108:111], v[64:67]
    ds_read_b128 v[208:211], v15 offset:24576
    buffer_load_dwordx4 a[44:47], v2, s[12:15], s40 offen offset:3072
    s_add_u32 s40, s40, 4096
    s_waitcnt lgkmcnt(6)
    v_mfma_f32_16x16x32_bf16 v[40:43], v[184:187], v[104:107], v[40:43]
    v_mfma_f32_16x16x32_bf16 v[68:71], v[184:187], v[108:111], v[68:71]
    ds_read_b128 v[212:215], v15 offset:25600
    s_waitcnt vmcnt(22)
    s_waitcnt lgkmcnt(6)
    v_mfma_f32_16x16x32_bf16 v[16:19], v[188:191], v[112:115], v[16:19]
    v_mfma_f32_16x16x32_bf16 v[44:47], v[188:191], v[116:119], v[44:47]
    ds_read_b128 v[160:163], v15 offset:26624
    s_waitcnt lgkmcnt(6)
    v_mfma_f32_16x16x32_bf16 v[20:23], v[192:195], v[112:115], v[20:23]
    v_mfma_f32_16x16x32_bf16 v[48:51], v[192:195], v[116:119], v[48:51]
    ds_read_b128 v[164:167], v15 offset:27648
    s_add_u32 s41, s47, 8192
    buffer_load_dwordx4 v[72:75], v2, s[12:15], s41 offen offset:3072 sc1
    s_add_u32 s41, s48, 8192
    buffer_load_dwordx4 v[76:79], v2, s[12:15], s41 offen offset:3072 sc1
    s_waitcnt lgkmcnt(6)
    v_mfma_f32_16x16x32_bf16 v[24:27], v[196:199], v[112:115], v[24:27]
    v_mfma_f32_16x16x32_bf16 v[52:55], v[196:199], v[116:119], v[52:55]
    ds_read_b128 v[168:171], v15 offset:28672
    buffer_load_dwordx4 a[48:51], v2, s[12:15], s40 offen offset:0
    s_waitcnt lgkmcnt(6)
    v_mfma_f32_16x16x32_bf16 v[28:31], v[200:203], v[112:115], v[28:31]
    v_mfma_f32_16x16x32_bf16 v[56:59], v[200:203], v[116:119], v[56:59]
    ds_read_b128 v[172:175], v15 offset:29696
    buffer_load_dwordx4 a[52:55], v2, s[12:15], s40 offen offset:1024
    s_waitcnt lgkmcnt(6)
    v_mfma_f32_16x16x32_bf16 v[32:35], v[204:207], v[112:115], v[32:35]
    v_mfma_f32_16x16x32_bf16 v[60:63], v[204:207], v[116:119], v[60:63]
    ds_read_b128 v[176:179], v15 offset:30720
    s_waitcnt lgkmcnt(6)
    v_mfma_f32_16x16x32_bf16 v[36:39], v[208:211], v[112:115], v[36:39]
    v_mfma_f32_16x16x32_bf16 v[64:67], v[208:211], v[116:119], v[64:67]
    ds_read_b128 v[180:183], v15 offset:31744
    buffer_load_dwordx4 a[56:59], v2, s[12:15], s40 offen offset:2048
    s_waitcnt lgkmcnt(6)
    v_mfma_f32_16x16x32_bf16 v[40:43], v[212:215], v[112:115], v[40:43]
    v_mfma_f32_16x16x32_bf16 v[68:71], v[212:215], v[116:119], v[68:71]
    ds_read_b128 v[184:187], v15 offset:32768
    s_waitcnt vmcnt(23)
    s_waitcnt lgkmcnt(6)
    v_mfma_f32_16x16x32_bf16 v[16:19], v[160:163], v[120:123], v[16:19]
    v_mfma_f32_16x16x32_bf16 v[44:47], v[160:163], v[124:127], v[44:47]
    ds_read_b128 v[188:191], v15 offset:33792
    s_waitcnt lgkmcnt(6)
    v_mfma_f32_16x16x32_bf16 v[20:23], v[164:167], v[120:123], v[20:23]
    v_mfma_f32_16x16x32_bf16 v[48:51], v[164:167], v[124:127], v[48:51]
    ds_read_b128 v[192:195], v15 offset:34816
    s_add_u32 s41, s47, 12288
    buffer_load_dwordx4 v[80:83], v2, s[12:15], s41 offen offset:0 sc1
    s_add_u32 s41, s48, 12288
    buffer_load_dwordx4 v[84:87], v2, s[12:15], s41 offen offset:0 sc1
    s_waitcnt lgkmcnt(6)
    v_mfma_f32_16x16x32_bf16 v[24:27], v[168:171], v[120:123], v[24:27]
    v_mfma_f32_16x16x32_bf16 v[52:55], v[168:171], v[124:127], v[52:55]
    ds_read_b128 v[196:199], v15 offset:35840
    buffer_load_dwordx4 a[60:63], v2, s[12:15], s40 offen offset:3072
    s_add_u32 s40, s40, 4096
    s_waitcnt lgkmcnt(6)
    v_mfma_f32_16x16x32_bf16 v[28:31], v[172:175], v[120:123], v[28:31]
    v_mfma_f32_16x16x32_bf16 v[56:59], v[172:175], v[124:127], v[56:59]
    ds_read_b128 v[200:203], v15 offset:36864
    buffer_load_dwordx4 a[64:67], v2, s[12:15], s40 offen offset:0
    s_waitcnt lgkmcnt(6)
    v_mfma_f32_16x16x32_bf16 v[32:35], v[176:179], v[120:123], v[32:35]
    v_mfma_f32_16x16x32_bf16 v[60:63], v[176:179], v[124:127], v[60:63]
    ds_read_b128 v[204:207], v15 offset:37888
    s_waitcnt lgkmcnt(6)
    v_mfma_f32_16x16x32_bf16 v[36:39], v[180:183], v[120:123], v[36:39]
    v_mfma_f32_16x16x32_bf16 v[64:67], v[180:183], v[124:127], v[64:67]
    ds_read_b128 v[208:211], v15 offset:38912
    buffer_load_dwordx4 a[68:71], v2, s[12:15], s40 offen offset:1024
    s_waitcnt lgkmcnt(6)
    v_mfma_f32_16x16x32_bf16 v[40:43], v[184:187], v[120:123], v[40:43]
    v_mfma_f32_16x16x32_bf16 v[68:71], v[184:187], v[124:127], v[68:71]
    ds_read_b128 v[212:215], v15 offset:39936
    s_waitcnt vmcnt(25)
    s_waitcnt lgkmcnt(6)
    v_mfma_f32_16x16x32_bf16 v[16:19], v[188:191], v[128:131], v[16:19]
    v_mfma_f32_16x16x32_bf16 v[44:47], v[188:191], v[132:135], v[44:47]
    ds_read_b128 v[160:163], v15 offset:40960
    s_waitcnt lgkmcnt(6)
    v_mfma_f32_16x16x32_bf16 v[20:23], v[192:195], v[128:131], v[20:23]
    v_mfma_f32_16x16x32_bf16 v[48:51], v[192:195], v[132:135], v[48:51]
    ds_read_b128 v[164:167], v15 offset:41984
    s_add_u32 s41, s47, 12288
    buffer_load_dwordx4 v[88:91], v2, s[12:15], s41 offen offset:1024 sc1
    s_add_u32 s41, s48, 12288
    buffer_load_dwordx4 v[92:95], v2, s[12:15], s41 offen offset:1024 sc1
    s_waitcnt lgkmcnt(6)
    v_mfma_f32_16x16x32_bf16 v[24:27], v[196:199], v[128:131], v[24:27]
    v_mfma_f32_16x16x32_bf16 v[52:55], v[196:199], v[132:135], v[52:55]
    ds_read_b128 v[168:171], v15 offset:43008
    buffer_load_dwordx4 a[72:75], v2, s[12:15], s40 offen offset:2048
    s_waitcnt lgkmcnt(6)
    v_mfma_f32_16x16x32_bf16 v[28:31], v[200:203], v[128:131], v[28:31]
    v_mfma_f32_16x16x32_bf16 v[56:59], v[200:203], v[132:135], v[56:59]
    ds_read_b128 v[172:175], v15 offset:44032
    buffer_load_dwordx4 a[76:79], v2, s[12:15], s40 offen offset:3072
    s_add_u32 s40, s40, 4096
    s_waitcnt lgkmcnt(6)
    v_mfma_f32_16x16x32_bf16 v[32:35], v[204:207], v[128:131], v[32:35]
    v_mfma_f32_16x16x32_bf16 v[60:63], v[204:207], v[132:135], v[60:63]
    ds_read_b128 v[176:179], v15 offset:45056
    s_waitcnt lgkmcnt(6)
    v_mfma_f32_16x16x32_bf16 v[36:39], v[208:211], v[128:131], v[36:39]
    v_mfma_f32_16x16x32_bf16 v[64:67], v[208:211], v[132:135], v[64:67]
    ds_read_b128 v[180:183], v15 offset:46080
    buffer_load_dwordx4 a[80:83], v2, s[12:15], s40 offen offset:0
    s_waitcnt lgkmcnt(6)
    v_mfma_f32_16x16x32_bf16 v[40:43], v[212:215], v[128:131], v[40:43]
    v_mfma_f32_16x16x32_bf16 v[68:71], v[212:215], v[132:135], v[68:71]
    ds_read_b128 v[184:187], v15 offset:47104
    s_waitcnt vmcnt(26)
    s_waitcnt lgkmcnt(6)
    v_mfma_f32_16x16x32_bf16 v[16:19], v[160:163], v[136:139], v[16:19]
    v_mfma_f32_16x16x32_bf16 v[44:47], v[160:163], v[140:143], v[44:47]
    ds_read_b128 v[188:191], v15 offset:48128
    s_waitcnt lgkmcnt(6)
    v_mfma_f32_16x16x32_bf16 v[20:23], v[164:167], v[136:139], v[20:23]
    v_mfma_f32_16x16x32_bf16 v[48:51], v[164:167], v[140:143], v[48:51]
    ds_read_b128 v[192:195], v15 offset:49152
    s_add_u32 s41, s47, 12288
    buffer_load_dwordx4 v[96:99], v2, s[12:15], s41 offen offset:2048 sc1
    s_add_u32 s41, s48, 12288
    buffer_load_dwordx4 v[100:103], v2, s[12:15], s41 offen offset:2048 sc1
    s_waitcnt lgkmcnt(6)
    v_mfma_f32_16x16x32_bf16 v[24:27], v[168:171], v[136:139], v[24:27]
    v_mfma_f32_16x16x32_bf16 v[52:55], v[168:171], v[140:143], v[52:55]
    ds_read_b128 v[196:199], v15 offset:50176
    buffer_load_dwordx4 a[84:87], v2, s[12:15], s40 offen offset:1024
    s_waitcnt lgkmcnt(6)
    v_mfma_f32_16x16x32_bf16 v[28:31], v[172:175], v[136:139], v[28:31]
    v_mfma_f32_16x16x32_bf16 v[56:59], v[172:175], v[140:143], v[56:59]
    ds_read_b128 v[200:203], v15 offset:51200
    buffer_load_dwordx4 a[88:91], v2, s[12:15], s40 offen offset:2048
    s_waitcnt lgkmcnt(6)
    v_mfma_f32_16x16x32_bf16 v[32:35], v[176:179], v[136:139], v[32:35]
    v_mfma_f32_16x16x32_bf16 v[60:63], v[176:179], v[140:143], v[60:63]
    ds_read_b128 v[204:207], v15 offset:52224
    s_waitcnt lgkmcnt(6)
    v_mfma_f32_16x16x32_bf16 v[36:39], v[180:183], v[136:139], v[36:39]
    v_mfma_f32_16x16x32_bf16 v[64:67], v[180:183], v[140:143], v[64:67]
    ds_read_b128 v[208:211], v15 offset:53248
    buffer_load_dwordx4 a[92:95], v2, s[12:15], s40 offen offset:3072
    s_add_u32 s40, s40, 4096
    s_waitcnt lgkmcnt(6)
    v_mfma_f32_16x16x32_bf16 v[40:43], v[184:187], v[136:139], v[40:43]
    v_mfma_f32_16x16x32_bf16 v[68:71], v[184:187], v[140:143], v[68:71]
    ds_read_b128 v[212:215], v15 offset:54272
    s_waitcnt vmcnt(28)
    s_waitcnt lgkmcnt(6)
    v_mfma_f32_16x16x32_bf16 v[16:19], v[188:191], v[144:147], v[16:19]
    v_mfma_f32_16x16x32_bf16 v[44:47], v[188:191], v[148:151], v[44:47]
    ds_read_b128 v[160:163], v15 offset:55296
    s_waitcnt lgkmcnt(6)
    v_mfma_f32_16x16x32_bf16 v[20:23], v[192:195], v[144:147], v[20:23]
    v_mfma_f32_16x16x32_bf16 v[48:51], v[192:195], v[148:151], v[48:51]
    ds_read_b128 v[164:167], v15 offset:56320
    s_add_u32 s41, s47, 12288
    buffer_load_dwordx4 v[104:107], v2, s[12:15], s41 offen offset:3072 sc1
    s_add_u32 s41, s48, 12288
    buffer_load_dwordx4 v[108:111], v2, s[12:15], s41 offen offset:3072 sc1
    s_waitcnt lgkmcnt(6)
    v_mfma_f32_16x16x32_bf16 v[24:27], v[196:199], v[144:147], v[24:27]
    v_mfma_f32_16x16x32_bf16 v[52:55], v[196:199], v[148:151], v[52:55]
    ds_read_b128 v[168:171], v15 offset:57344
    buffer_load_dwordx4 a[96:99], v2, s[12:15], s40 offen offset:0
    s_waitcnt lgkmcnt(6)
    v_mfma_f32_16x16x32_bf16 v[28:31], v[200:203], v[144:147], v[28:31]
    v_mfma_f32_16x16x32_bf16 v[56:59], v[200:203], v[148:151], v[56:59]
    ds_read_b128 v[172:175], v15 offset:58368
    buffer_load_dwordx4 a[100:103], v2, s[12:15], s40 offen offset:1024
    s_waitcnt lgkmcnt(6)
    v_mfma_f32_16x16x32_bf16 v[32:35], v[204:207], v[144:147], v[32:35]
    v_mfma_f32_16x16x32_bf16 v[60:63], v[204:207], v[148:151], v[60:63]
    ds_read_b128 v[176:179], v15 offset:59392
    s_waitcnt lgkmcnt(6)
    v_mfma_f32_16x16x32_bf16 v[36:39], v[208:211], v[144:147], v[36:39]
    v_mfma_f32_16x16x32_bf16 v[64:67], v[208:211], v[148:151], v[64:67]
    ds_read_b128 v[180:183], v15 offset:60416
    buffer_load_dwordx4 a[104:107], v2, s[12:15], s40 offen offset:2048
    s_waitcnt lgkmcnt(6)
    v_mfma_f32_16x16x32_bf16 v[40:43], v[212:215], v[144:147], v[40:43]
    v_mfma_f32_16x16x32_bf16 v[68:71], v[212:215], v[148:151], v[68:71]
    ds_read_b128 v[184:187], v15 offset:61440
    s_waitcnt vmcnt(28)
    s_waitcnt lgkmcnt(6)
    v_mfma_f32_16x16x32_bf16 v[16:19], v[160:163], v[152:155], v[16:19]
    v_mfma_f32_16x16x32_bf16 v[44:47], v[160:163], v[156:159], v[44:47]
    ds_read_b128 v[188:191], v15 offset:62464
    s_waitcnt lgkmcnt(6)
    v_mfma_f32_16x16x32_bf16 v[20:23], v[164:167], v[152:155], v[20:23]
    v_mfma_f32_16x16x32_bf16 v[48:51], v[164:167], v[156:159], v[48:51]
    ds_read_b128 v[192:195], v15 offset:63488
    s_add_u32 s41, s47, 16384
    buffer_load_dwordx4 v[112:115], v2, s[12:15], s41 offen offset:0 sc1
    s_add_u32 s41, s48, 16384
    buffer_load_dwordx4 v[116:119], v2, s[12:15], s41 offen offset:0 sc1
    s_waitcnt lgkmcnt(6)
    v_mfma_f32_16x16x32_bf16 v[24:27], v[168:171], v[152:155], v[24:27]
    v_mfma_f32_16x16x32_bf16 v[52:55], v[168:171], v[156:159], v[52:55]
    ds_read_b128 v[196:199], v15 offset:64512
    buffer_load_dwordx4 a[108:111], v2, s[12:15], s40 offen offset:3072
    s_add_u32 s40, s40, 4096
    s_waitcnt lgkmcnt(6)
    v_mfma_f32_16x16x32_bf16 v[28:31], v[172:175], v[152:155], v[28:31]
    v_mfma_f32_16x16x32_bf16 v[56:59], v[172:175], v[156:159], v[56:59]
    ds_read_b128 v[200:203], v11 offset:0
    buffer_load_dwordx4 a[112:115], v2, s[12:15], s40 offen offset:0
    s_waitcnt lgkmcnt(6)
    v_mfma_f32_16x16x32_bf16 v[32:35], v[176:179], v[152:155], v[32:35]
    v_mfma_f32_16x16x32_bf16 v[60:63], v[176:179], v[156:159], v[60:63]
    ds_read_b128 v[204:207], v11 offset:1024
    s_waitcnt lgkmcnt(6)
    v_mfma_f32_16x16x32_bf16 v[36:39], v[180:183], v[152:155], v[36:39]
    v_mfma_f32_16x16x32_bf16 v[64:67], v[180:183], v[156:159], v[64:67]
    ds_read_b128 v[208:211], v11 offset:2048
    buffer_load_dwordx4 a[116:119], v2, s[12:15], s40 offen offset:1024
    s_waitcnt lgkmcnt(6)
    v_mfma_f32_16x16x32_bf16 v[40:43], v[184:187], v[152:155], v[40:43]
    v_mfma_f32_16x16x32_bf16 v[68:71], v[184:187], v[156:159], v[68:71]
    ds_read_b128 v[212:215], v11 offset:3072
    s_waitcnt vmcnt(28)
    s_waitcnt lgkmcnt(6)
    v_mfma_f32_16x16x32_bf16 v[16:19], v[188:191], v[72:75], v[16:19]
    v_mfma_f32_16x16x32_bf16 v[44:47], v[188:191], v[76:79], v[44:47]
    ds_read_b128 v[160:163], v11 offset:4096
    s_waitcnt lgkmcnt(6)
    v_mfma_f32_16x16x32_bf16 v[20:23], v[192:195], v[72:75], v[20:23]
    v_mfma_f32_16x16x32_bf16 v[48:51], v[192:195], v[76:79], v[48:51]
    ds_read_b128 v[164:167], v11 offset:5120
    s_add_u32 s41, s47, 16384
    buffer_load_dwordx4 v[120:123], v2, s[12:15], s41 offen offset:1024 sc1
    s_add_u32 s41, s48, 16384
    buffer_load_dwordx4 v[124:127], v2, s[12:15], s41 offen offset:1024 sc1
    s_waitcnt lgkmcnt(6)
    v_mfma_f32_16x16x32_bf16 v[24:27], v[196:199], v[72:75], v[24:27]
    v_mfma_f32_16x16x32_bf16 v[52:55], v[196:199], v[76:79], v[52:55]
    ds_read_b128 v[168:171], v11 offset:6144
    buffer_load_dwordx4 a[120:123], v2, s[12:15], s40 offen offset:2048
    s_waitcnt lgkmcnt(6)
    v_mfma_f32_16x16x32_bf16 v[28:31], v[200:203], v[72:75], v[28:31]
    v_mfma_f32_16x16x32_bf16 v[56:59], v[200:203], v[76:79], v[56:59]
    ds_read_b128 v[172:175], v11 offset:7168
    buffer_load_dwordx4 a[124:127], v2, s[12:15], s40 offen offset:3072
    s_add_u32 s40, s40, 4096
    s_waitcnt lgkmcnt(6)
    v_mfma_f32_16x16x32_bf16 v[32:35], v[204:207], v[72:75], v[32:35]
    v_mfma_f32_16x16x32_bf16 v[60:63], v[204:207], v[76:79], v[60:63]
    ds_read_b128 v[176:179], v11 offset:8192
    s_waitcnt lgkmcnt(6)
    v_mfma_f32_16x16x32_bf16 v[36:39], v[208:211], v[72:75], v[36:39]
    v_mfma_f32_16x16x32_bf16 v[64:67], v[208:211], v[76:79], v[64:67]
    ds_read_b128 v[180:183], v11 offset:9216
    buffer_load_dwordx4 a[128:131], v2, s[12:15], s40 offen offset:0
    s_waitcnt lgkmcnt(6)
    v_mfma_f32_16x16x32_bf16 v[40:43], v[212:215], v[72:75], v[40:43]
    v_mfma_f32_16x16x32_bf16 v[68:71], v[212:215], v[76:79], v[68:71]
    ds_read_b128 v[184:187], v11 offset:10240
    s_waitcnt vmcnt(28)
    s_waitcnt lgkmcnt(6)
    v_mfma_f32_16x16x32_bf16 v[16:19], v[160:163], v[80:83], v[16:19]
    v_mfma_f32_16x16x32_bf16 v[44:47], v[160:163], v[84:87], v[44:47]
    ds_read_b128 v[188:191], v11 offset:11264
    s_waitcnt lgkmcnt(6)
    v_mfma_f32_16x16x32_bf16 v[20:23], v[164:167], v[80:83], v[20:23]
    v_mfma_f32_16x16x32_bf16 v[48:51], v[164:167], v[84:87], v[48:51]
    ds_read_b128 v[192:195], v11 offset:12288
    s_add_u32 s41, s47, 16384
    buffer_load_dwordx4 v[128:131], v2, s[12:15], s41 offen offset:2048 sc1
    s_add_u32 s41, s48, 16384
    buffer_load_dwordx4 v[132:135], v2, s[12:15], s41 offen offset:2048 sc1
    s_waitcnt lgkmcnt(6)
    v_mfma_f32_16x16x32_bf16 v[24:27], v[168:171], v[80:83], v[24:27]
    v_mfma_f32_16x16x32_bf16 v[52:55], v[168:171], v[84:87], v[52:55]
    ds_read_b128 v[196:199], v11 offset:13312
    buffer_load_dwordx4 a[132:135], v2, s[12:15], s40 offen offset:1024
    s_waitcnt lgkmcnt(6)
    v_mfma_f32_16x16x32_bf16 v[28:31], v[172:175], v[80:83], v[28:31]
    v_mfma_f32_16x16x32_bf16 v[56:59], v[172:175], v[84:87], v[56:59]
    ds_read_b128 v[200:203], v11 offset:14336
    buffer_load_dwordx4 a[136:139], v2, s[12:15], s40 offen offset:2048
    s_waitcnt lgkmcnt(6)
    v_mfma_f32_16x16x32_bf16 v[32:35], v[176:179], v[80:83], v[32:35]
    v_mfma_f32_16x16x32_bf16 v[60:63], v[176:179], v[84:87], v[60:63]
    ds_read_b128 v[204:207], v11 offset:15360
    s_waitcnt lgkmcnt(6)
    v_mfma_f32_16x16x32_bf16 v[36:39], v[180:183], v[80:83], v[36:39]
    v_mfma_f32_16x16x32_bf16 v[64:67], v[180:183], v[84:87], v[64:67]
    ds_read_b128 v[208:211], v11 offset:16384
    buffer_load_dwordx4 a[140:143], v2, s[12:15], s40 offen offset:3072
    s_add_u32 s40, s40, 4096
    s_waitcnt lgkmcnt(6)
    v_mfma_f32_16x16x32_bf16 v[40:43], v[184:187], v[80:83], v[40:43]
    v_mfma_f32_16x16x32_bf16 v[68:71], v[184:187], v[84:87], v[68:71]
    ds_read_b128 v[212:215], v11 offset:17408
    buffer_load_dwordx4 a[144:147], v2, s[12:15], s40 offen offset:0
    s_waitcnt vmcnt(29)
    s_waitcnt lgkmcnt(6)
    v_mfma_f32_16x16x32_bf16 v[16:19], v[188:191], v[88:91], v[16:19]
    v_mfma_f32_16x16x32_bf16 v[44:47], v[188:191], v[92:95], v[44:47]
    ds_read_b128 v[160:163], v11 offset:18432
    s_waitcnt lgkmcnt(6)
    v_mfma_f32_16x16x32_bf16 v[20:23], v[192:195], v[88:91], v[20:23]
    v_mfma_f32_16x16x32_bf16 v[48:51], v[192:195], v[92:95], v[48:51]
    ds_read_b128 v[164:167], v11 offset:19456
    s_add_u32 s41, s47, 16384
    buffer_load_dwordx4 v[136:139], v2, s[12:15], s41 offen offset:3072 sc1
    s_add_u32 s41, s48, 16384
    buffer_load_dwordx4 v[140:143], v2, s[12:15], s41 offen offset:3072 sc1
    s_waitcnt lgkmcnt(6)
    v_mfma_f32_16x16x32_bf16 v[24:27], v[196:199], v[88:91], v[24:27]
    v_mfma_f32_16x16x32_bf16 v[52:55], v[196:199], v[92:95], v[52:55]
    ds_read_b128 v[168:171], v11 offset:20480
    buffer_load_dwordx4 a[148:151], v2, s[12:15], s40 offen offset:1024
    s_waitcnt lgkmcnt(6)
    v_mfma_f32_16x16x32_bf16 v[28:31], v[200:203], v[88:91], v[28:31]
    v_mfma_f32_16x16x32_bf16 v[56:59], v[200:203], v[92:95], v[56:59]
    ds_read_b128 v[172:175], v11 offset:21504
    buffer_load_dwordx4 a[152:155], v2, s[12:15], s40 offen offset:2048
    s_waitcnt lgkmcnt(6)
    v_mfma_f32_16x16x32_bf16 v[32:35], v[204:207], v[88:91], v[32:35]
    v_mfma_f32_16x16x32_bf16 v[60:63], v[204:207], v[92:95], v[60:63]
    ds_read_b128 v[176:179], v11 offset:22528
    s_waitcnt lgkmcnt(6)
    v_mfma_f32_16x16x32_bf16 v[36:39], v[208:211], v[88:91], v[36:39]
    v_mfma_f32_16x16x32_bf16 v[64:67], v[208:211], v[92:95], v[64:67]
    ds_read_b128 v[180:183], v11 offset:23552
    buffer_load_dwordx4 a[156:159], v2, s[12:15], s40 offen offset:3072
    s_add_u32 s40, s40, 4096
    s_waitcnt lgkmcnt(6)
    v_mfma_f32_16x16x32_bf16 v[40:43], v[212:215], v[88:91], v[40:43]
    v_mfma_f32_16x16x32_bf16 v[68:71], v[212:215], v[92:95], v[68:71]
    ds_read_b128 v[184:187], v14 offset:0
    buffer_load_dwordx4 a[160:163], v2, s[12:15], s40 offen offset:0
    s_add_u32 s48, s54, 368640
    buffer_load_dwordx4 v[228:231], v254, s[12:15], s48 offen sc1
    buffer_load_dwordx4 v[232:235], v254, s[12:15], s48 offen offset:1024 sc1
    buffer_load_dwordx2 v[236:237], v8, s[12:15], s48 offen offset:2048 sc1
    s_waitcnt vmcnt(33)
    s_waitcnt lgkmcnt(6)
    v_mfma_f32_16x16x32_bf16 v[16:19], v[160:163], v[96:99], v[16:19]
    v_mfma_f32_16x16x32_bf16 v[44:47], v[160:163], v[100:103], v[44:47]
    ds_read_b128 v[188:191], v14 offset:1024
    s_waitcnt lgkmcnt(6)
    v_mfma_f32_16x16x32_bf16 v[20:23], v[164:167], v[96:99], v[20:23]
    v_mfma_f32_16x16x32_bf16 v[48:51], v[164:167], v[100:103], v[48:51]
    ds_read_b128 v[192:195], v14 offset:2048
    s_waitcnt lgkmcnt(6)
    v_mfma_f32_16x16x32_bf16 v[24:27], v[168:171], v[96:99], v[24:27]
    v_mfma_f32_16x16x32_bf16 v[52:55], v[168:171], v[100:103], v[52:55]
    ds_read_b128 v[196:199], v14 offset:3072
    buffer_load_dwordx4 a[164:167], v2, s[12:15], s40 offen offset:1024
    s_waitcnt lgkmcnt(6)
    v_mfma_f32_16x16x32_bf16 v[28:31], v[172:175], v[96:99], v[28:31]
    v_mfma_f32_16x16x32_bf16 v[56:59], v[172:175], v[100:103], v[56:59]
    ds_read_b128 v[200:203], v14 offset:4096
    buffer_load_dwordx4 a[168:171], v2, s[12:15], s40 offen offset:2048
    s_waitcnt lgkmcnt(6)
    v_mfma_f32_16x16x32_bf16 v[32:35], v[176:179], v[96:99], v[32:35]
    v_mfma_f32_16x16x32_bf16 v[60:63], v[176:179], v[100:103], v[60:63]
    ds_read_b128 v[204:207], v14 offset:5120
    s_waitcnt lgkmcnt(6)
    v_mfma_f32_16x16x32_bf16 v[36:39], v[180:183], v[96:99], v[36:39]
    v_mfma_f32_16x16x32_bf16 v[64:67], v[180:183], v[100:103], v[64:67]
    ds_read_b128 v[208:211], v14 offset:6144
    buffer_load_dwordx4 a[172:175], v2, s[12:15], s40 offen offset:3072
    s_add_u32 s40, s40, 4096
    s_waitcnt lgkmcnt(6)
    v_mfma_f32_16x16x32_bf16 v[40:43], v[184:187], v[96:99], v[40:43]
    v_mfma_f32_16x16x32_bf16 v[68:71], v[184:187], v[100:103], v[68:71]
    ds_read_b128 v[212:215], v14 offset:7168
    buffer_load_dwordx4 a[176:179], v2, s[12:15], s40 offen offset:0
    s_add_u32 s48, s54, 20480
    buffer_load_dwordx4 v[238:241], v254, s[12:15], s48 offen sc1
    buffer_load_dwordx4 v[242:245], v254, s[12:15], s48 offen offset:1024 sc1
    buffer_load_dwordx2 v[246:247], v8, s[12:15], s48 offen offset:2048 sc1
    s_waitcnt vmcnt(35)
    s_waitcnt lgkmcnt(6)
    v_mfma_f32_16x16x32_bf16 v[16:19], v[188:191], v[104:107], v[16:19]
    v_mfma_f32_16x16x32_bf16 v[44:47], v[188:191], v[108:111], v[44:47]
    ds_read_b128 v[160:163], v14 offset:8192
    s_waitcnt lgkmcnt(6)
    v_mfma_f32_16x16x32_bf16 v[20:23], v[192:195], v[104:107], v[20:23]
    v_mfma_f32_16x16x32_bf16 v[48:51], v[192:195], v[108:111], v[48:51]
    ds_read_b128 v[164:167], v14 offset:9216
    s_waitcnt lgkmcnt(6)
    v_mfma_f32_16x16x32_bf16 v[24:27], v[196:199], v[104:107], v[24:27]
    v_mfma_f32_16x16x32_bf16 v[52:55], v[196:199], v[108:111], v[52:55]
    ds_read_b128 v[168:171], v14 offset:10240
    buffer_load_dwordx4 a[180:183], v2, s[12:15], s40 offen offset:1024
    s_waitcnt lgkmcnt(6)
    v_mfma_f32_16x16x32_bf16 v[28:31], v[200:203], v[104:107], v[28:31]
    v_mfma_f32_16x16x32_bf16 v[56:59], v[200:203], v[108:111], v[56:59]
    ds_read_b128 v[172:175], v14 offset:11264
    buffer_load_dwordx4 a[184:187], v2, s[12:15], s40 offen offset:2048
    s_waitcnt lgkmcnt(6)
    v_mfma_f32_16x16x32_bf16 v[32:35], v[204:207], v[104:107], v[32:35]
    v_mfma_f32_16x16x32_bf16 v[60:63], v[204:207], v[108:111], v[60:63]
    ds_read_b128 v[176:179], v14 offset:12288
    s_waitcnt lgkmcnt(6)
    v_mfma_f32_16x16x32_bf16 v[36:39], v[208:211], v[104:107], v[36:39]
    v_mfma_f32_16x16x32_bf16 v[64:67], v[208:211], v[108:111], v[64:67]
    ds_read_b128 v[180:183], v14 offset:13312
    buffer_load_dwordx4 a[188:191], v2, s[12:15], s40 offen offset:3072
    s_add_u32 s40, s40, 4096
    s_waitcnt lgkmcnt(6)
    v_mfma_f32_16x16x32_bf16 v[40:43], v[212:215], v[104:107], v[40:43]
    v_mfma_f32_16x16x32_bf16 v[68:71], v[212:215], v[108:111], v[68:71]
    ds_read_b128 v[184:187], v14 offset:14336
    buffer_load_dwordx4 a[192:195], v2, s[12:15], s40 offen offset:0
    s_waitcnt vmcnt(34)
    s_waitcnt lgkmcnt(6)
    v_mfma_f32_16x16x32_bf16 v[16:19], v[160:163], v[112:115], v[16:19]
    v_mfma_f32_16x16x32_bf16 v[44:47], v[160:163], v[116:119], v[44:47]
    ds_read_b128 v[188:191], v14 offset:15360
    s_waitcnt lgkmcnt(6)
    v_mfma_f32_16x16x32_bf16 v[20:23], v[164:167], v[112:115], v[20:23]
    v_mfma_f32_16x16x32_bf16 v[48:51], v[164:167], v[116:119], v[48:51]
    ds_read_b128 v[192:195], v14 offset:16384
    s_waitcnt lgkmcnt(6)
    v_mfma_f32_16x16x32_bf16 v[24:27], v[168:171], v[112:115], v[24:27]
    v_mfma_f32_16x16x32_bf16 v[52:55], v[168:171], v[116:119], v[52:55]
    ds_read_b128 v[196:199], v14 offset:17408
    buffer_load_dwordx4 a[196:199], v2, s[12:15], s40 offen offset:1024
    s_waitcnt lgkmcnt(6)
    v_mfma_f32_16x16x32_bf16 v[28:31], v[172:175], v[112:115], v[28:31]
    v_mfma_f32_16x16x32_bf16 v[56:59], v[172:175], v[116:119], v[56:59]
    ds_read_b128 v[200:203], v14 offset:18432
    buffer_load_dwordx4 a[200:203], v2, s[12:15], s40 offen offset:2048
    s_waitcnt lgkmcnt(6)
    v_mfma_f32_16x16x32_bf16 v[32:35], v[176:179], v[112:115], v[32:35]
    v_mfma_f32_16x16x32_bf16 v[60:63], v[176:179], v[116:119], v[60:63]
    ds_read_b128 v[204:207], v14 offset:19456
    s_waitcnt lgkmcnt(6)
    v_mfma_f32_16x16x32_bf16 v[36:39], v[180:183], v[112:115], v[36:39]
    v_mfma_f32_16x16x32_bf16 v[64:67], v[180:183], v[116:119], v[64:67]
    ds_read_b128 v[208:211], v14 offset:20480
    buffer_load_dwordx4 a[204:207], v2, s[12:15], s40 offen offset:3072
    s_add_u32 s40, s40, 4096
    s_waitcnt lgkmcnt(6)
    v_mfma_f32_16x16x32_bf16 v[40:43], v[184:187], v[112:115], v[40:43]
    v_mfma_f32_16x16x32_bf16 v[68:71], v[184:187], v[116:119], v[68:71]
    ds_read_b128 v[212:215], v14 offset:21504
    buffer_load_dwordx4 a[208:211], v2, s[12:15], s40 offen offset:0
    s_waitcnt vmcnt(33)
    s_waitcnt lgkmcnt(6)
    v_mfma_f32_16x16x32_bf16 v[16:19], v[188:191], v[120:123], v[16:19]
    v_mfma_f32_16x16x32_bf16 v[44:47], v[188:191], v[124:127], v[44:47]
    ds_read_b128 v[160:163], v14 offset:22528
    s_waitcnt lgkmcnt(6)
    v_mfma_f32_16x16x32_bf16 v[20:23], v[192:195], v[120:123], v[20:23]
    v_mfma_f32_16x16x32_bf16 v[48:51], v[192:195], v[124:127], v[48:51]
    ds_read_b128 v[164:167], v14 offset:23552
    s_waitcnt lgkmcnt(6)
    v_mfma_f32_16x16x32_bf16 v[24:27], v[196:199], v[120:123], v[24:27]
    v_mfma_f32_16x16x32_bf16 v[52:55], v[196:199], v[124:127], v[52:55]
    ds_read_b128 v[168:171], v14 offset:24576
    buffer_load_dwordx4 a[212:215], v2, s[12:15], s40 offen offset:1024
    s_waitcnt lgkmcnt(6)
    v_mfma_f32_16x16x32_bf16 v[28:31], v[200:203], v[120:123], v[28:31]
    v_mfma_f32_16x16x32_bf16 v[56:59], v[200:203], v[124:127], v[56:59]
    ds_read_b128 v[172:175], v14 offset:25600
    buffer_load_dwordx4 a[216:219], v2, s[12:15], s40 offen offset:2048
    s_waitcnt lgkmcnt(6)
    v_mfma_f32_16x16x32_bf16 v[32:35], v[204:207], v[120:123], v[32:35]
    v_mfma_f32_16x16x32_bf16 v[60:63], v[204:207], v[124:127], v[60:63]
    ds_read_b128 v[176:179], v14 offset:26624
    s_waitcnt lgkmcnt(6)
    v_mfma_f32_16x16x32_bf16 v[36:39], v[208:211], v[120:123], v[36:39]
    v_mfma_f32_16x16x32_bf16 v[64:67], v[208:211], v[124:127], v[64:67]
    ds_read_b128 v[180:183], v14 offset:27648
    buffer_load_dwordx4 a[220:223], v2, s[12:15], s40 offen offset:3072
    s_add_u32 s40, s40, 4096
    s_waitcnt lgkmcnt(6)
    v_mfma_f32_16x16x32_bf16 v[40:43], v[212:215], v[120:123], v[40:43]
    v_mfma_f32_16x16x32_bf16 v[68:71], v[212:215], v[124:127], v[68:71]
    ds_read_b128 v[184:187], v14 offset:28672
    buffer_load_dwordx4 a[224:227], v2, s[12:15], s40 offen offset:0
    s_waitcnt vmcnt(32)
    s_waitcnt lgkmcnt(6)
    v_mfma_f32_16x16x32_bf16 v[16:19], v[160:163], v[128:131], v[16:19]
    v_mfma_f32_16x16x32_bf16 v[44:47], v[160:163], v[132:135], v[44:47]
    ds_read_b128 v[188:191], v14 offset:29696
    s_waitcnt lgkmcnt(6)
    v_mfma_f32_16x16x32_bf16 v[20:23], v[164:167], v[128:131], v[20:23]
    v_mfma_f32_16x16x32_bf16 v[48:51], v[164:167], v[132:135], v[48:51]
    ds_read_b128 v[192:195], v14 offset:30720
    s_waitcnt lgkmcnt(6)
    v_mfma_f32_16x16x32_bf16 v[24:27], v[168:171], v[128:131], v[24:27]
    v_mfma_f32_16x16x32_bf16 v[52:55], v[168:171], v[132:135], v[52:55]
    ds_read_b128 v[196:199], v14 offset:31744
    buffer_load_dwordx4 a[228:231], v2, s[12:15], s40 offen offset:1024
    s_waitcnt lgkmcnt(6)
    v_mfma_f32_16x16x32_bf16 v[28:31], v[172:175], v[128:131], v[28:31]
    v_mfma_f32_16x16x32_bf16 v[56:59], v[172:175], v[132:135], v[56:59]
    ds_read_b128 v[200:203], v14 offset:32768
    buffer_load_dwordx4 a[232:235], v2, s[12:15], s40 offen offset:2048
    s_waitcnt lgkmcnt(6)
    v_mfma_f32_16x16x32_bf16 v[32:35], v[176:179], v[128:131], v[32:35]
    v_mfma_f32_16x16x32_bf16 v[60:63], v[176:179], v[132:135], v[60:63]
    ds_read_b128 v[204:207], v14 offset:33792
    s_waitcnt lgkmcnt(6)
    v_mfma_f32_16x16x32_bf16 v[36:39], v[180:183], v[128:131], v[36:39]
    v_mfma_f32_16x16x32_bf16 v[64:67], v[180:183], v[132:135], v[64:67]
    ds_read_b128 v[208:211], v14 offset:34816
    buffer_load_dwordx4 a[236:239], v2, s[12:15], s40 offen offset:3072
    s_add_u32 s40, s40, 4096
    s_waitcnt lgkmcnt(6)
    v_mfma_f32_16x16x32_bf16 v[40:43], v[184:187], v[128:131], v[40:43]
    v_mfma_f32_16x16x32_bf16 v[68:71], v[184:187], v[132:135], v[68:71]
    ds_read_b128 v[212:215], v14 offset:35840
    buffer_load_dwordx4 a[240:243], v2, s[12:15], s40 offen offset:0
    s_waitcnt vmcnt(30)
    s_waitcnt lgkmcnt(6)
    v_mfma_f32_16x16x32_bf16 v[16:19], v[188:191], v[136:139], v[16:19]
    v_mfma_f32_16x16x32_bf16 v[44:47], v[188:191], v[140:143], v[44:47]
    s_waitcnt lgkmcnt(5)
    v_mfma_f32_16x16x32_bf16 v[20:23], v[192:195], v[136:139], v[20:23]
    v_mfma_f32_16x16x32_bf16 v[48:51], v[192:195], v[140:143], v[48:51]
    s_waitcnt lgkmcnt(4)
    v_mfma_f32_16x16x32_bf16 v[24:27], v[196:199], v[136:139], v[24:27]
    v_mfma_f32_16x16x32_bf16 v[52:55], v[196:199], v[140:143], v[52:55]
    buffer_load_dwordx4 a[244:247], v2, s[12:15], s40 offen offset:1024
    s_waitcnt lgkmcnt(3)
    v_mfma_f32_16x16x32_bf16 v[28:31], v[200:203], v[136:139], v[28:31]
    v_mfma_f32_16x16x32_bf16 v[56:59], v[200:203], v[140:143], v[56:59]
    buffer_load_dwordx4 a[248:251], v2, s[12:15], s40 offen offset:2048
    s_waitcnt lgkmcnt(2)
    v_mfma_f32_16x16x32_bf16 v[32:35], v[204:207], v[136:139], v[32:35]
    v_mfma_f32_16x16x32_bf16 v[60:63], v[204:207], v[140:143], v[60:63]
    s_waitcnt lgkmcnt(1)
    v_mfma_f32_16x16x32_bf16 v[36:39], v[208:211], v[136:139], v[36:39]
    v_mfma_f32_16x16x32_bf16 v[64:67], v[208:211], v[140:143], v[64:67]
    buffer_load_dwordx4 a[252:255], v2, s[12:15], s40 offen offset:3072
    s_add_u32 s40, s40, 4096
    s_waitcnt lgkmcnt(0)
    v_mfma_f32_16x16x32_bf16 v[40:43], v[212:215], v[136:139], v[40:43]
    v_mfma_f32_16x16x32_bf16 v[68:71], v[212:215], v[140:143], v[68:71]
    v_add_f32 v224, v216, v218
    v_add_f32 v225, v217, v219
    v_mov_b32 v216, v224
    v_mov_b32 v217, v225
    s_nop 1
    v_permlane32_swap_b32 v216, v224
    v_permlane32_swap_b32 v217, v225
    s_nop 0
    v_add_f32 v224, v224, v216
    v_add_f32 v225, v225, v217
    v_mov_b32 v216, v224
    v_mov_b32 v217, v225
    s_nop 1
    v_permlane16_swap_b32 v216, v224
    v_permlane16_swap_b32 v217, v225
    s_nop 0
    v_add_f32 v224, v224, v216
    v_add_f32 v225, v225, v217
    v_mul_f32 v224, 0x3acccccd, v224
    v_mul_f32 v225, 0x3acccccd, v225
    v_fma_f32 v225, -v224, v224, v225
    v_max_f32 v225, 0, v225
    v_cvt_pk_bf16_f32 v216, v224, v225
    v_lshlrev_b32 v224, 16, v216
    v_and_b32 v225, 0xffff0000, v216
    v_add_f32 v225, 0x3727c5ac, v225
    v_cvt_pk_bf16_f32 v216, v225, v225
    v_lshlrev_b32 v225, 16, v216
    v_sqrt_f32 v225, v225
    s_nop 0
    v_cvt_pk_bf16_f32 v216, v225, v225
    v_lshlrev_b32 v225, 16, v216
    v_rcp_f32 v225, v225
    s_nop 0
    v_mul_f32 v224, v224, v225
    v_sub_f32 v224, 0, v224
    v_add_f32 v226, v220, v222
    v_add_f32 v227, v221, v223
    v_mov_b32 v216, v226
    v_mov_b32 v217, v227
    s_nop 1
    v_permlane32_swap_b32 v216, v226
    v_permlane32_swap_b32 v217, v227
    s_nop 0
    v_add_f32 v226, v226, v216
    v_add_f32 v227, v227, v217
    v_mov_b32 v216, v226
    v_mov_b32 v217, v227
    s_nop 1
    v_permlane16_swap_b32 v216, v226
    v_permlane16_swap_b32 v217, v227
    s_nop 0
    v_add_f32 v226, v226, v216
    v_add_f32 v227, v227, v217
    v_mul_f32 v226, 0x3acccccd, v226
    v_mul_f32 v227, 0x3acccccd, v227
    v_fma_f32 v227, -v226, v226, v227
    v_max_f32 v227, 0, v227
    v_cvt_pk_bf16_f32 v216, v226, v227
    v_lshlrev_b32 v226, 16, v216
    v_and_b32 v227, 0xffff0000, v216
    v_add_f32 v227, 0x3727c5ac, v227
    v_cvt_pk_bf16_f32 v216, v227, v227
    v_lshlrev_b32 v227, 16, v216
    v_sqrt_f32 v227, v227
    s_nop 0
    v_cvt_pk_bf16_f32 v216, v227, v227
    v_lshlrev_b32 v227, 16, v216
    v_rcp_f32 v227, v227
    s_nop 0
    v_mul_f32 v226, v226, v227
    v_sub_f32 v226, 0, v226
    v_lshlrev_b32 v9, 4, v3
    v_add_u32 v9, 156672, v9
    v_mov_b32 v12, 0xbdd2d3e8
    v_mov_b32 v13, 0xc0135761
    ds_read_b128 v[72:75], v9 offset:0
    ds_read_b128 v[100:103], v9 offset:512
    ds_read_b128 v[76:79], v9 offset:64
    ds_read_b128 v[104:107], v9 offset:576
    ds_read_b128 v[80:83], v9 offset:128
    ds_read_b128 v[108:111], v9 offset:640
    ds_read_b128 v[84:87], v9 offset:192
    ds_read_b128 v[112:115], v9 offset:704
    ds_read_b128 v[88:91], v9 offset:256
    ds_read_b128 v[116:119], v9 offset:768
    ds_read_b128 v[92:95], v9 offset:320
    ds_read_b128 v[120:123], v9 offset:832
    ds_read_b128 v[96:99], v9 offset:384
    ds_read_b128 v[124:127], v9 offset:896
    s_waitcnt lgkmcnt(0)
    v_pk_add_f32 v[72:73], v[72:73], v[100:101]
    v_pk_add_f32 v[74:75], v[74:75], v[102:103]
    v_pk_add_f32 v[76:77], v[76:77], v[104:105]
    v_pk_add_f32 v[78:79], v[78:79], v[106:107]
    v_pk_add_f32 v[80:81], v[80:81], v[108:109]
    v_pk_add_f32 v[82:83], v[82:83], v[110:111]
    v_pk_add_f32 v[84:85], v[84:85], v[112:113]
    v_pk_add_f32 v[86:87], v[86:87], v[114:115]
    v_pk_add_f32 v[88:89], v[88:89], v[116:117]
    v_pk_add_f32 v[90:91], v[90:91], v[118:119]
    v_pk_add_f32 v[92:93], v[92:93], v[120:121]
    v_pk_add_f32 v[94:95], v[94:95], v[122:123]
    v_pk_add_f32 v[96:97], v[96:97], v[124:125]
    v_pk_add_f32 v[98:99], v[98:99], v[126:127]
    s_lshl_b32 s49, s34, 2
    s_add_u32 s49, s49, s30
    s_lshl_b32 s49, s49, 7
    s_add_u32 s49, s49, s37
    s_lshl_b32 s41, s35, 2
    s_add_u32 s49, s49, s41
    v_pk_mul_f32 v[160:161], v[72:73], v[224:225] op_sel_hi:[1,0]
    v_pk_mul_f32 v[162:163], v[74:75], v[224:225] op_sel_hi:[1,0]
    v_pk_mul_f32 v[164:165], v[72:73], v[226:227] op_sel_hi:[1,0]
    v_pk_mul_f32 v[166:167], v[74:75], v[226:227] op_sel_hi:[1,0]
    v_pk_mul_f32 v[168:169], v[76:77], v[224:225] op_sel_hi:[1,0]
    v_pk_mul_f32 v[170:171], v[78:79], v[224:225] op_sel_hi:[1,0]
    v_pk_mul_f32 v[172:173], v[76:77], v[226:227] op_sel_hi:[1,0]
    v_pk_mul_f32 v[174:175], v[78:79], v[226:227] op_sel_hi:[1,0]
    v_pk_fma_f32 v[16:17], v[16:17], v[224:225], v[160:161] op_sel:[0,1,0] op_sel_hi:[1,1,1]
    v_pk_fma_f32 v[18:19], v[18:19], v[224:225], v[162:163] op_sel:[0,1,0] op_sel_hi:[1,1,1]
    v_pk_fma_f32 v[44:45], v[44:45], v[226:227], v[164:165] op_sel:[0,1,0] op_sel_hi:[1,1,1]
    v_pk_fma_f32 v[46:47], v[46:47], v[226:227], v[166:167] op_sel:[0,1,0] op_sel_hi:[1,1,1]
    v_pk_fma_f32 v[20:21], v[20:21], v[224:225], v[168:169] op_sel:[0,1,0] op_sel_hi:[1,1,1]
    v_pk_fma_f32 v[22:23], v[22:23], v[224:225], v[170:171] op_sel:[0,1,0] op_sel_hi:[1,1,1]
    v_pk_fma_f32 v[48:49], v[48:49], v[226:227], v[172:173] op_sel:[0,1,0] op_sel_hi:[1,1,1]
    v_pk_fma_f32 v[50:51], v[50:51], v[226:227], v[174:175] op_sel:[0,1,0] op_sel_hi:[1,1,1]
    v_pk_mul_f32 v[160:161], v[16:17], v[16:17]
    v_pk_mul_f32 v[162:163], v[18:19], v[18:19]
    v_pk_mul_f32 v[164:165], v[44:45], v[44:45]
    v_pk_mul_f32 v[166:167], v[46:47], v[46:47]
    v_pk_mul_f32 v[168:169], v[20:21], v[20:21]
    v_pk_mul_f32 v[170:171], v[22:23], v[22:23]
    v_pk_mul_f32 v[172:173], v[48:49], v[48:49]
    v_pk_mul_f32 v[174:175], v[50:51], v[50:51]
    v_pk_fma_f32 v[160:161], v[160:161], v[12:13], v[12:13] op_sel:[0,0,1] op_sel_hi:[1,0,1]
    v_pk_fma_f32 v[162:163], v[162:163], v[12:13], v[12:13] op_sel:[0,0,1] op_sel_hi:[1,0,1]
    v_pk_fma_f32 v[164:165], v[164:165], v[12:13], v[12:13] op_sel:[0,0,1] op_sel_hi:[1,0,1]
    v_pk_fma_f32 v[166:167], v[166:167], v[12:13], v[12:13] op_sel:[0,0,1] op_sel_hi:[1,0,1]
    v_pk_fma_f32 v[168:169], v[168:169], v[12:13], v[12:13] op_sel:[0,0,1] op_sel_hi:[1,0,1]
    v_pk_fma_f32 v[170:171], v[170:171], v[12:13], v[12:13] op_sel:[0,0,1] op_sel_hi:[1,0,1]
    v_pk_fma_f32 v[172:173], v[172:173], v[12:13], v[12:13] op_sel:[0,0,1] op_sel_hi:[1,0,1]
    v_pk_fma_f32 v[174:175], v[174:175], v[12:13], v[12:13] op_sel:[0,0,1] op_sel_hi:[1,0,1]
    v_pk_mul_f32 v[160:161], v[160:161], v[16:17]
    v_pk_mul_f32 v[162:163], v[162:163], v[18:19]
    v_pk_mul_f32 v[164:165], v[164:165], v[44:45]
    v_pk_mul_f32 v[166:167], v[166:167], v[46:47]
    v_pk_mul_f32 v[168:169], v[168:169], v[20:21]
    v_pk_mul_f32 v[170:171], v[170:171], v[22:23]
    v_pk_mul_f32 v[172:173], v[172:173], v[48:49]
    v_pk_mul_f32 v[174:175], v[174:175], v[50:51]
    v_exp_f32 v160, v160
    v_exp_f32 v161, v161
    v_exp_f32 v162, v162
    v_exp_f32 v163, v163
    v_exp_f32 v164, v164
    v_exp_f32 v165, v165
    v_exp_f32 v166, v166
    v_exp_f32 v167, v167
    v_exp_f32 v168, v168
    v_exp_f32 v169, v169
    v_exp_f32 v170, v170
    v_exp_f32 v171, v171
    v_exp_f32 v172, v172
    v_exp_f32 v173, v173
    v_exp_f32 v174, v174
    v_exp_f32 v175, v175
    v_pk_add_f32 v[160:161], v[160:161], 1.0 op_sel_hi:[1,0]
    v_pk_add_f32 v[162:163], v[162:163], 1.0 op_sel_hi:[1,0]
    v_pk_add_f32 v[164:165], v[164:165], 1.0 op_sel_hi:[1,0]
    v_pk_add_f32 v[166:167], v[166:167], 1.0 op_sel_hi:[1,0]
    v_pk_add_f32 v[168:169], v[168:169], 1.0 op_sel_hi:[1,0]
    v_pk_add_f32 v[170:171], v[170:171], 1.0 op_sel_hi:[1,0]
    v_pk_add_f32 v[172:173], v[172:173], 1.0 op_sel_hi:[1,0]
    v_pk_add_f32 v[174:175], v[174:175], 1.0 op_sel_hi:[1,0]
    v_rcp_f32 v160, v160
    v_rcp_f32 v161, v161
    v_rcp_f32 v162, v162
    v_rcp_f32 v163, v163
    v_rcp_f32 v164, v164
    v_rcp_f32 v165, v165
    v_rcp_f32 v166, v166
    v_rcp_f32 v167, v167
    v_rcp_f32 v168, v168
    v_rcp_f32 v169, v169
    v_rcp_f32 v170, v170
    v_rcp_f32 v171, v171
    v_rcp_f32 v172, v172
    v_rcp_f32 v173, v173
    v_rcp_f32 v174, v174
    v_rcp_f32 v175, v175
    s_nop 0
    v_pk_mul_f32 v[16:17], v[16:17], v[160:161]
    v_pk_mul_f32 v[18:19], v[18:19], v[162:163]
    v_pk_mul_f32 v[44:45], v[44:45], v[164:165]
    v_pk_mul_f32 v[46:47], v[46:47], v[166:167]
    v_pk_mul_f32 v[20:21], v[20:21], v[168:169]
    v_pk_mul_f32 v[22:23], v[22:23], v[170:171]
    v_pk_mul_f32 v[48:49], v[48:49], v[172:173]
    v_pk_mul_f32 v[50:51], v[50:51], v[174:175]
    v_cvt_pk_bf16_f32 v16, v16, v17
    v_cvt_pk_bf16_f32 v17, v18, v19
    v_cvt_pk_bf16_f32 v18, v20, v21
    v_cvt_pk_bf16_f32 v19, v22, v23
    v_cvt_pk_bf16_f32 v44, v44, v45
    v_cvt_pk_bf16_f32 v45, v46, v47
    v_cvt_pk_bf16_f32 v46, v48, v49
    v_cvt_pk_bf16_f32 v47, v50, v51
    s_nop 1
    v_permlane16_swap_b32 v16, v18
    v_permlane16_swap_b32 v17, v19
    v_permlane16_swap_b32 v44, v46
    v_permlane16_swap_b32 v45, v47
    buffer_store_dwordx4 v[16:19], v254, s[12:15], s52 offen offset:0 sc1
    buffer_store_dwordx4 v[44:47], v254, s[12:15], s53 offen offset:0 sc1
k2_kernel_gs30:
    v_pk_mul_f32 v[160:161], v[80:81], v[224:225] op_sel_hi:[1,0]
    v_pk_mul_f32 v[162:163], v[82:83], v[224:225] op_sel_hi:[1,0]
    v_pk_mul_f32 v[164:165], v[80:81], v[226:227] op_sel_hi:[1,0]
    v_pk_mul_f32 v[166:167], v[82:83], v[226:227] op_sel_hi:[1,0]
    v_pk_mul_f32 v[168:169], v[84:85], v[224:225] op_sel_hi:[1,0]
    v_pk_mul_f32 v[170:171], v[86:87], v[224:225] op_sel_hi:[1,0]
    v_pk_mul_f32 v[172:173], v[84:85], v[226:227] op_sel_hi:[1,0]
    v_pk_mul_f32 v[174:175], v[86:87], v[226:227] op_sel_hi:[1,0]
    v_pk_fma_f32 v[24:25], v[24:25], v[224:225], v[160:161] op_sel:[0,1,0] op_sel_hi:[1,1,1]
    v_pk_fma_f32 v[26:27], v[26:27], v[224:225], v[162:163] op_sel:[0,1,0] op_sel_hi:[1,1,1]
    v_pk_fma_f32 v[52:53], v[52:53], v[226:227], v[164:165] op_sel:[0,1,0] op_sel_hi:[1,1,1]
    v_pk_fma_f32 v[54:55], v[54:55], v[226:227], v[166:167] op_sel:[0,1,0] op_sel_hi:[1,1,1]
    v_pk_fma_f32 v[28:29], v[28:29], v[224:225], v[168:169] op_sel:[0,1,0] op_sel_hi:[1,1,1]
    v_pk_fma_f32 v[30:31], v[30:31], v[224:225], v[170:171] op_sel:[0,1,0] op_sel_hi:[1,1,1]
    v_pk_fma_f32 v[56:57], v[56:57], v[226:227], v[172:173] op_sel:[0,1,0] op_sel_hi:[1,1,1]
    v_pk_fma_f32 v[58:59], v[58:59], v[226:227], v[174:175] op_sel:[0,1,0] op_sel_hi:[1,1,1]
    v_pk_mul_f32 v[160:161], v[24:25], v[24:25]
    v_pk_mul_f32 v[162:163], v[26:27], v[26:27]
    v_pk_mul_f32 v[164:165], v[52:53], v[52:53]
    v_pk_mul_f32 v[166:167], v[54:55], v[54:55]
    v_pk_mul_f32 v[168:169], v[28:29], v[28:29]
    v_pk_mul_f32 v[170:171], v[30:31], v[30:31]
    v_pk_mul_f32 v[172:173], v[56:57], v[56:57]
    v_pk_mul_f32 v[174:175], v[58:59], v[58:59]
    v_pk_fma_f32 v[160:161], v[160:161], v[12:13], v[12:13] op_sel:[0,0,1] op_sel_hi:[1,0,1]
    v_pk_fma_f32 v[162:163], v[162:163], v[12:13], v[12:13] op_sel:[0,0,1] op_sel_hi:[1,0,1]
    v_pk_fma_f32 v[164:165], v[164:165], v[12:13], v[12:13] op_sel:[0,0,1] op_sel_hi:[1,0,1]
    v_pk_fma_f32 v[166:167], v[166:167], v[12:13], v[12:13] op_sel:[0,0,1] op_sel_hi:[1,0,1]
    v_pk_fma_f32 v[168:169], v[168:169], v[12:13], v[12:13] op_sel:[0,0,1] op_sel_hi:[1,0,1]
    v_pk_fma_f32 v[170:171], v[170:171], v[12:13], v[12:13] op_sel:[0,0,1] op_sel_hi:[1,0,1]
    v_pk_fma_f32 v[172:173], v[172:173], v[12:13], v[12:13] op_sel:[0,0,1] op_sel_hi:[1,0,1]
    v_pk_fma_f32 v[174:175], v[174:175], v[12:13], v[12:13] op_sel:[0,0,1] op_sel_hi:[1,0,1]
    v_pk_mul_f32 v[160:161], v[160:161], v[24:25]
    v_pk_mul_f32 v[162:163], v[162:163], v[26:27]
    v_pk_mul_f32 v[164:165], v[164:165], v[52:53]
    v_pk_mul_f32 v[166:167], v[166:167], v[54:55]
    v_pk_mul_f32 v[168:169], v[168:169], v[28:29]
    v_pk_mul_f32 v[170:171], v[170:171], v[30:31]
    v_pk_mul_f32 v[172:173], v[172:173], v[56:57]
    v_pk_mul_f32 v[174:175], v[174:175], v[58:59]
    v_exp_f32 v160, v160
    v_exp_f32 v161, v161
    v_exp_f32 v162, v162
    v_exp_f32 v163, v163
    v_exp_f32 v164, v164
    v_exp_f32 v165, v165
    v_exp_f32 v166, v166
    v_exp_f32 v167, v167
    v_exp_f32 v168, v168
    v_exp_f32 v169, v169
    v_exp_f32 v170, v170
    v_exp_f32 v171, v171
    v_exp_f32 v172, v172
    v_exp_f32 v173, v173
    v_exp_f32 v174, v174
    v_exp_f32 v175, v175
    v_pk_add_f32 v[160:161], v[160:161], 1.0 op_sel_hi:[1,0]
    v_pk_add_f32 v[162:163], v[162:163], 1.0 op_sel_hi:[1,0]
    v_pk_add_f32 v[164:165], v[164:165], 1.0 op_sel_hi:[1,0]
    v_pk_add_f32 v[166:167], v[166:167], 1.0 op_sel_hi:[1,0]
    v_pk_add_f32 v[168:169], v[168:169], 1.0 op_sel_hi:[1,0]
    v_pk_add_f32 v[170:171], v[170:171], 1.0 op_sel_hi:[1,0]
    v_pk_add_f32 v[172:173], v[172:173], 1.0 op_sel_hi:[1,0]
    v_pk_add_f32 v[174:175], v[174:175], 1.0 op_sel_hi:[1,0]
    v_rcp_f32 v160, v160
    v_rcp_f32 v161, v161
    v_rcp_f32 v162, v162
    v_rcp_f32 v163, v163
    v_rcp_f32 v164, v164
    v_rcp_f32 v165, v165
    v_rcp_f32 v166, v166
    v_rcp_f32 v167, v167
    v_rcp_f32 v168, v168
    v_rcp_f32 v169, v169
    v_rcp_f32 v170, v170
    v_rcp_f32 v171, v171
    v_rcp_f32 v172, v172
    v_rcp_f32 v173, v173
    v_rcp_f32 v174, v174
    v_rcp_f32 v175, v175
    s_nop 0
    v_pk_mul_f32 v[24:25], v[24:25], v[160:161]
    v_pk_mul_f32 v[26:27], v[26:27], v[162:163]
    v_pk_mul_f32 v[52:53], v[52:53], v[164:165]
    v_pk_mul_f32 v[54:55], v[54:55], v[166:167]
    v_pk_mul_f32 v[28:29], v[28:29], v[168:169]
    v_pk_mul_f32 v[30:31], v[30:31], v[170:171]
    v_pk_mul_f32 v[56:57], v[56:57], v[172:173]
    v_pk_mul_f32 v[58:59], v[58:59], v[174:175]
    v_cvt_pk_bf16_f32 v24, v24, v25
    v_cvt_pk_bf16_f32 v25, v26, v27
    v_cvt_pk_bf16_f32 v26, v28, v29
    v_cvt_pk_bf16_f32 v27, v30, v31
    v_cvt_pk_bf16_f32 v52, v52, v53
    v_cvt_pk_bf16_f32 v53, v54, v55
    v_cvt_pk_bf16_f32 v54, v56, v57
    v_cvt_pk_bf16_f32 v55, v58, v59
    s_nop 1
    v_permlane16_swap_b32 v24, v26
    v_permlane16_swap_b32 v25, v27
    v_permlane16_swap_b32 v52, v54
    v_permlane16_swap_b32 v53, v55
    s_cmp_eq_u32 s35, 15
    s_cselect_b32 s46, 0xffff, -1
    s_mov_b32 exec_lo, s46
    s_mov_b32 exec_hi, s46
    buffer_store_dwordx4 v[24:27], v254, s[12:15], s52 offen offset:1024 sc1
    buffer_store_dwordx4 v[52:55], v254, s[12:15], s53 offen offset:1024 sc1
    s_mov_b64 exec, -1
k2_kernel_gs31:
    v_pk_mul_f32 v[160:161], v[88:89], v[224:225] op_sel_hi:[1,0]
    v_pk_mul_f32 v[162:163], v[90:91], v[224:225] op_sel_hi:[1,0]
    v_pk_mul_f32 v[164:165], v[88:89], v[226:227] op_sel_hi:[1,0]
    v_pk_mul_f32 v[166:167], v[90:91], v[226:227] op_sel_hi:[1,0]
    v_pk_mul_f32 v[168:169], v[92:93], v[224:225] op_sel_hi:[1,0]
    v_pk_mul_f32 v[170:171], v[94:95], v[224:225] op_sel_hi:[1,0]
    v_pk_mul_f32 v[172:173], v[92:93], v[226:227] op_sel_hi:[1,0]
    v_pk_mul_f32 v[174:175], v[94:95], v[226:227] op_sel_hi:[1,0]
    v_pk_fma_f32 v[32:33], v[32:33], v[224:225], v[160:161] op_sel:[0,1,0] op_sel_hi:[1,1,1]
    v_pk_fma_f32 v[34:35], v[34:35], v[224:225], v[162:163] op_sel:[0,1,0] op_sel_hi:[1,1,1]
    v_pk_fma_f32 v[60:61], v[60:61], v[226:227], v[164:165] op_sel:[0,1,0] op_sel_hi:[1,1,1]
    v_pk_fma_f32 v[62:63], v[62:63], v[226:227], v[166:167] op_sel:[0,1,0] op_sel_hi:[1,1,1]
    v_pk_fma_f32 v[36:37], v[36:37], v[224:225], v[168:169] op_sel:[0,1,0] op_sel_hi:[1,1,1]
    v_pk_fma_f32 v[38:39], v[38:39], v[224:225], v[170:171] op_sel:[0,1,0] op_sel_hi:[1,1,1]
    v_pk_fma_f32 v[64:65], v[64:65], v[226:227], v[172:173] op_sel:[0,1,0] op_sel_hi:[1,1,1]
    v_pk_fma_f32 v[66:67], v[66:67], v[226:227], v[174:175] op_sel:[0,1,0] op_sel_hi:[1,1,1]
    v_pk_mul_f32 v[160:161], v[32:33], v[32:33]
    v_pk_mul_f32 v[162:163], v[34:35], v[34:35]
    v_pk_mul_f32 v[164:165], v[60:61], v[60:61]
    v_pk_mul_f32 v[166:167], v[62:63], v[62:63]
    v_pk_mul_f32 v[168:169], v[36:37], v[36:37]
    v_pk_mul_f32 v[170:171], v[38:39], v[38:39]
    v_pk_mul_f32 v[172:173], v[64:65], v[64:65]
    v_pk_mul_f32 v[174:175], v[66:67], v[66:67]
    v_pk_fma_f32 v[160:161], v[160:161], v[12:13], v[12:13] op_sel:[0,0,1] op_sel_hi:[1,0,1]
    v_pk_fma_f32 v[162:163], v[162:163], v[12:13], v[12:13] op_sel:[0,0,1] op_sel_hi:[1,0,1]
    v_pk_fma_f32 v[164:165], v[164:165], v[12:13], v[12:13] op_sel:[0,0,1] op_sel_hi:[1,0,1]
    v_pk_fma_f32 v[166:167], v[166:167], v[12:13], v[12:13] op_sel:[0,0,1] op_sel_hi:[1,0,1]
    v_pk_fma_f32 v[168:169], v[168:169], v[12:13], v[12:13] op_sel:[0,0,1] op_sel_hi:[1,0,1]
    v_pk_fma_f32 v[170:171], v[170:171], v[12:13], v[12:13] op_sel:[0,0,1] op_sel_hi:[1,0,1]
    v_pk_fma_f32 v[172:173], v[172:173], v[12:13], v[12:13] op_sel:[0,0,1] op_sel_hi:[1,0,1]
    v_pk_fma_f32 v[174:175], v[174:175], v[12:13], v[12:13] op_sel:[0,0,1] op_sel_hi:[1,0,1]
    v_pk_mul_f32 v[160:161], v[160:161], v[32:33]
    v_pk_mul_f32 v[162:163], v[162:163], v[34:35]
    v_pk_mul_f32 v[164:165], v[164:165], v[60:61]
    v_pk_mul_f32 v[166:167], v[166:167], v[62:63]
    v_pk_mul_f32 v[168:169], v[168:169], v[36:37]
    v_pk_mul_f32 v[170:171], v[170:171], v[38:39]
    v_pk_mul_f32 v[172:173], v[172:173], v[64:65]
    v_pk_mul_f32 v[174:175], v[174:175], v[66:67]
    v_exp_f32 v160, v160
    v_exp_f32 v161, v161
    v_exp_f32 v162, v162
    v_exp_f32 v163, v163
    v_exp_f32 v164, v164
    v_exp_f32 v165, v165
    v_exp_f32 v166, v166
    v_exp_f32 v167, v167
    v_exp_f32 v168, v168
    v_exp_f32 v169, v169
    v_exp_f32 v170, v170
    v_exp_f32 v171, v171
    v_exp_f32 v172, v172
    v_exp_f32 v173, v173
    v_exp_f32 v174, v174
    v_exp_f32 v175, v175
    v_pk_add_f32 v[160:161], v[160:161], 1.0 op_sel_hi:[1,0]
    v_pk_add_f32 v[162:163], v[162:163], 1.0 op_sel_hi:[1,0]
    v_pk_add_f32 v[164:165], v[164:165], 1.0 op_sel_hi:[1,0]
    v_pk_add_f32 v[166:167], v[166:167], 1.0 op_sel_hi:[1,0]
    v_pk_add_f32 v[168:169], v[168:169], 1.0 op_sel_hi:[1,0]
    v_pk_add_f32 v[170:171], v[170:171], 1.0 op_sel_hi:[1,0]
    v_pk_add_f32 v[172:173], v[172:173], 1.0 op_sel_hi:[1,0]
    v_pk_add_f32 v[174:175], v[174:175], 1.0 op_sel_hi:[1,0]
    v_rcp_f32 v160, v160
    v_rcp_f32 v161, v161
    v_rcp_f32 v162, v162
    v_rcp_f32 v163, v163
    v_rcp_f32 v164, v164
    v_rcp_f32 v165, v165
    v_rcp_f32 v166, v166
    v_rcp_f32 v167, v167
    v_rcp_f32 v168, v168
    v_rcp_f32 v169, v169
    v_rcp_f32 v170, v170
    v_rcp_f32 v171, v171
    v_rcp_f32 v172, v172
    v_rcp_f32 v173, v173
    v_rcp_f32 v174, v174
    v_rcp_f32 v175, v175
    s_nop 0
    v_pk_mul_f32 v[32:33], v[32:33], v[160:161]
    v_pk_mul_f32 v[34:35], v[34:35], v[162:163]
    v_pk_mul_f32 v[60:61], v[60:61], v[164:165]
    v_pk_mul_f32 v[62:63], v[62:63], v[166:167]
    v_pk_mul_f32 v[36:37], v[36:37], v[168:169]
    v_pk_mul_f32 v[38:39], v[38:39], v[170:171]
    v_pk_mul_f32 v[64:65], v[64:65], v[172:173]
    v_pk_mul_f32 v[66:67], v[66:67], v[174:175]
    v_cvt_pk_bf16_f32 v32, v32, v33
    v_cvt_pk_bf16_f32 v33, v34, v35
    v_cvt_pk_bf16_f32 v34, v36, v37
    v_cvt_pk_bf16_f32 v35, v38, v39
    v_cvt_pk_bf16_f32 v60, v60, v61
    v_cvt_pk_bf16_f32 v61, v62, v63
    v_cvt_pk_bf16_f32 v62, v64, v65
    v_cvt_pk_bf16_f32 v63, v66, v67
    s_nop 1
    v_permlane16_swap_b32 v32, v34
    v_permlane16_swap_b32 v33, v35
    v_permlane16_swap_b32 v60, v62
    v_permlane16_swap_b32 v61, v63
    s_cmp_eq_u32 s35, 15
    s_cbranch_scc1 k2_kernel_gs32
    buffer_store_dwordx4 v[32:35], v254, s[12:15], s52 offen offset:2048 sc1
    buffer_store_dwordx4 v[60:63], v254, s[12:15], s53 offen offset:2048 sc1
k2_kernel_gs32:
    v_pk_mul_f32 v[160:161], v[96:97], v[224:225] op_sel_hi:[1,0]
    v_pk_mul_f32 v[162:163], v[98:99], v[224:225] op_sel_hi:[1,0]
    v_pk_mul_f32 v[164:165], v[96:97], v[226:227] op_sel_hi:[1,0]
    v_pk_mul_f32 v[166:167], v[98:99], v[226:227] op_sel_hi:[1,0]
    v_pk_fma_f32 v[40:41], v[40:41], v[224:225], v[160:161] op_sel:[0,1,0] op_sel_hi:[1,1,1]
    v_pk_fma_f32 v[42:43], v[42:43], v[224:225], v[162:163] op_sel:[0,1,0] op_sel_hi:[1,1,1]
    v_pk_fma_f32 v[68:69], v[68:69], v[226:227], v[164:165] op_sel:[0,1,0] op_sel_hi:[1,1,1]
    v_pk_fma_f32 v[70:71], v[70:71], v[226:227], v[166:167] op_sel:[0,1,0] op_sel_hi:[1,1,1]
    v_pk_mul_f32 v[160:161], v[40:41], v[40:41]
    v_pk_mul_f32 v[162:163], v[42:43], v[42:43]
    v_pk_mul_f32 v[164:165], v[68:69], v[68:69]
    v_pk_mul_f32 v[166:167], v[70:71], v[70:71]
    v_pk_fma_f32 v[160:161], v[160:161], v[12:13], v[12:13] op_sel:[0,0,1] op_sel_hi:[1,0,1]
    v_pk_fma_f32 v[162:163], v[162:163], v[12:13], v[12:13] op_sel:[0,0,1] op_sel_hi:[1,0,1]
    v_pk_fma_f32 v[164:165], v[164:165], v[12:13], v[12:13] op_sel:[0,0,1] op_sel_hi:[1,0,1]
    v_pk_fma_f32 v[166:167], v[166:167], v[12:13], v[12:13] op_sel:[0,0,1] op_sel_hi:[1,0,1]
    v_pk_mul_f32 v[160:161], v[160:161], v[40:41]
    v_pk_mul_f32 v[162:163], v[162:163], v[42:43]
    v_pk_mul_f32 v[164:165], v[164:165], v[68:69]
    v_pk_mul_f32 v[166:167], v[166:167], v[70:71]
    v_exp_f32 v160, v160
    v_exp_f32 v161, v161
    v_exp_f32 v162, v162
    v_exp_f32 v163, v163
    v_exp_f32 v164, v164
    v_exp_f32 v165, v165
    v_exp_f32 v166, v166
    v_exp_f32 v167, v167
    v_pk_add_f32 v[160:161], v[160:161], 1.0 op_sel_hi:[1,0]
    v_pk_add_f32 v[162:163], v[162:163], 1.0 op_sel_hi:[1,0]
    v_pk_add_f32 v[164:165], v[164:165], 1.0 op_sel_hi:[1,0]
    v_pk_add_f32 v[166:167], v[166:167], 1.0 op_sel_hi:[1,0]
    v_rcp_f32 v160, v160
    v_rcp_f32 v161, v161
    v_rcp_f32 v162, v162
    v_rcp_f32 v163, v163
    v_rcp_f32 v164, v164
    v_rcp_f32 v165, v165
    v_rcp_f32 v166, v166
    v_rcp_f32 v167, v167
    s_nop 0
    v_pk_mul_f32 v[40:41], v[40:41], v[160:161]
    v_pk_mul_f32 v[42:43], v[42:43], v[162:163]
    v_pk_mul_f32 v[68:69], v[68:69], v[164:165]
    v_pk_mul_f32 v[70:71], v[70:71], v[166:167]
    v_cvt_pk_bf16_f32 v40, v40, v41
    v_cvt_pk_bf16_f32 v41, v42, v43
    v_cvt_pk_bf16_f32 v68, v68, v69
    v_cvt_pk_bf16_f32 v69, v70, v71
    s_cmp_eq_u32 s35, 15
    s_cbranch_scc1 k2_kernel_gs33
    buffer_store_dwordx2 v[40:41], v8, s[12:15], s52 offen offset:3072 sc1
    buffer_store_dwordx2 v[68:69], v8, s[12:15], s53 offen offset:3072 sc1
k2_kernel_gs33:
    s_waitcnt vmcnt(0)
    v_mov_b32 v9, 1
    v_mov_b32 v10, 6400
    s_mov_b64 exec, 1
    s_cmp_eq_u32 s31, 0
    s_cbranch_scc1 k2_kernel_slow34
    buffer_store_dword v9, v10, s[12:15], s49 offen
    s_branch k2_kernel_sent35
k2_kernel_slow34:
    buffer_store_dword v9, v10, s[12:15], s49 offen sc1
k2_kernel_sent35:
    s_mov_b64 exec, -1
    buffer_load_dwordx4 v[192:195], v2, s[12:15], s40 offen offset:0
    buffer_load_dwordx4 v[196:199], v2, s[12:15], s40 offen offset:1024
    buffer_load_dwordx4 v[200:203], v2, s[12:15], s40 offen offset:2048
    buffer_load_dwordx4 v[204:207], v2, s[12:15], s40 offen offset:3072
    s_add_u32 s40, s40, 4096
    buffer_load_dwordx4 v[208:211], v2, s[12:15], s40 offen offset:0
    buffer_load_dwordx4 v[212:215], v2, s[12:15], s40 offen offset:1024
    s_and_b32 s41, s32, 1
    s_lshl_b32 s41, s41, 1
    s_lshl_b32 s49, s34, 2
    s_add_u32 s49, s49, s41
    s_lshl_b32 s49, s49, 7
    s_add_u32 s49, s49, s37
    s_lshl_b32 s41, s30, 4
    s_add_u32 s49, s49, s41
    s_add_u32 s49, s49, 6400
    v_bfe_u32 v7, v1, 2, 1
    v_lshlrev_b32 v7, 7, v7
    v_and_b32 v9, 3, v1
    v_lshl_add_u32 v7, v9, 2, v7
    s_add_u32 s41, s30, 0
    s_and_b32 s41, s41, 3
    s_lshl_b32 s46, s32, 2
    s_add_u32 s41, s41, s46
    s_mul_i32 s41, s41, 55296
    s_mul_i32 s46, s30, 14336
    s_add_u32 s41, s41, s46
    s_add_u32 s41, s41, s36
    s_add_u32 s50, s41, 696320
    s_add_u32 s41, s30, 1
    s_and_b32 s41, s41, 3
    s_lshl_b32 s46, s32, 2
    s_add_u32 s41, s41, s46
    s_mul_i32 s41, s41, 55296
    s_mul_i32 s46, s30, 14336
    s_add_u32 s41, s41, s46
    s_add_u32 s41, s41, s36
    s_add_u32 s51, s41, 696320
    s_add_u32 s41, s30, 2
    s_and_b32 s41, s41, 3
    s_lshl_b32 s46, s32, 2
    s_add_u32 s41, s41, s46
    s_mul_i32 s41, s41, 55296
    s_mul_i32 s46, s30, 14336
    s_add_u32 s41, s41, s46
    s_add_u32 s41, s41, s36
    s_add_u32 s52, s41, 696320
    s_add_u32 s41, s30, 3
    s_and_b32 s41, s41, 3
    s_lshl_b32 s46, s32, 2
    s_add_u32 s41, s41, s46
    s_mul_i32 s41, s41, 55296
    s_mul_i32 s46, s30, 14336
    s_add_u32 s41, s41, s46
    s_add_u32 s41, s41, s36
    s_add_u32 s53, s41, 696320
    s_mov_b32 s43, 200000
k2_kernel_poll36:
    buffer_load_dword v9, v7, s[12:15], s49 offen sc1
    s_waitcnt vmcnt(0)
    v_cmp_ne_u32 vcc, 0, v9
    s_sub_u32 s43, s43, 1
    s_cmp_eq_u64 vcc, -1
    s_cbranch_scc1 k2_kernel_go37
    s_cmp_lg_u32 s43, 0
    s_cbranch_scc1 k2_kernel_poll36
k2_kernel_go37:
    s_add_u32 s41, s50, 0
    buffer_load_dwordx4 v[96:99], v2, s[12:15], s41 offen offset:0 sc1
    s_add_u32 s41, s51, 0
    buffer_load_dwordx4 v[100:103], v2, s[12:15], s41 offen offset:0 sc1
    s_add_u32 s41, s52, 0
    buffer_load_dwordx4 v[104:107], v2, s[12:15], s41 offen offset:0 sc1
    s_add_u32 s41, s53, 0
    buffer_load_dwordx4 v[108:111], v2, s[12:15], s41 offen offset:0 sc1
    s_add_u32 s41, s50, 0
    buffer_load_dwordx4 v[112:115], v2, s[12:15], s41 offen offset:1024 sc1
    s_add_u32 s41, s51, 0
    buffer_load_dwordx4 v[116:119], v2, s[12:15], s41 offen offset:1024 sc1
    s_add_u32 s41, s52, 0
    buffer_load_dwordx4 v[120:123], v2, s[12:15], s41 offen offset:1024 sc1
    s_add_u32 s41, s53, 0
    buffer_load_dwordx4 v[124:127], v2, s[12:15], s41 offen offset:1024 sc1
    s_waitcnt vmcnt(4)
    v_mfma_f32_16x16x32_bf16 v[16:19], a[0:3], v[96:99], 0
    v_mfma_f32_16x16x32_bf16 v[36:39], a[0:3], v[100:103], 0
    v_mfma_f32_16x16x32_bf16 v[56:59], a[0:3], v[104:107], 0
    v_mfma_f32_16x16x32_bf16 v[76:79], a[0:3], v[108:111], 0
    s_add_u32 s41, s50, 0
    buffer_load_dwordx4 v[128:131], v2, s[12:15], s41 offen offset:2048 sc1
    v_mfma_f32_16x16x32_bf16 v[20:23], a[4:7], v[96:99], 0
    v_mfma_f32_16x16x32_bf16 v[40:43], a[4:7], v[100:103], 0
    v_mfma_f32_16x16x32_bf16 v[60:63], a[4:7], v[104:107], 0
    v_mfma_f32_16x16x32_bf16 v[80:83], a[4:7], v[108:111], 0
    s_add_u32 s41, s51, 0
    buffer_load_dwordx4 v[132:135], v2, s[12:15], s41 offen offset:2048 sc1
    s_add_u32 s41, s52, 0
    buffer_load_dwordx4 v[136:139], v2, s[12:15], s41 offen offset:2048 sc1
    v_mfma_f32_16x16x32_bf16 v[24:27], a[8:11], v[96:99], 0
    v_mfma_f32_16x16x32_bf16 v[44:47], a[8:11], v[100:103], 0
    v_mfma_f32_16x16x32_bf16 v[64:67], a[8:11], v[104:107], 0
    v_mfma_f32_16x16x32_bf16 v[84:87], a[8:11], v[108:111], 0
    s_add_u32 s41, s53, 0
    buffer_load_dwordx4 v[140:143], v2, s[12:15], s41 offen offset:2048 sc1
    v_mfma_f32_16x16x32_bf16 v[28:31], a[12:15], v[96:99], 0
    v_mfma_f32_16x16x32_bf16 v[48:51], a[12:15], v[100:103], 0
    v_mfma_f32_16x16x32_bf16 v[68:71], a[12:15], v[104:107], 0
    v_mfma_f32_16x16x32_bf16 v[88:91], a[12:15], v[108:111], 0
    s_add_u32 s41, s50, 0
    buffer_load_dwordx4 v[144:147], v2, s[12:15], s41 offen offset:3072 sc1
    s_add_u32 s41, s51, 0
    buffer_load_dwordx4 v[148:151], v2, s[12:15], s41 offen offset:3072 sc1
    v_mfma_f32_16x16x32_bf16 v[32:35], a[16:19], v[96:99], 0
    v_mfma_f32_16x16x32_bf16 v[52:55], a[16:19], v[100:103], 0
    v_mfma_f32_16x16x32_bf16 v[72:75], a[16:19], v[104:107], 0
    v_mfma_f32_16x16x32_bf16 v[92:95], a[16:19], v[108:111], 0
    s_add_u32 s41, s52, 0
    buffer_load_dwordx4 v[152:155], v2, s[12:15], s41 offen offset:3072 sc1
    s_waitcnt vmcnt(7)
    v_mfma_f32_16x16x32_bf16 v[16:19], a[20:23], v[112:115], v[16:19]
    v_mfma_f32_16x16x32_bf16 v[36:39], a[20:23], v[116:119], v[36:39]
    v_mfma_f32_16x16x32_bf16 v[56:59], a[20:23], v[120:123], v[56:59]
    v_mfma_f32_16x16x32_bf16 v[76:79], a[20:23], v[124:127], v[76:79]
    s_add_u32 s41, s53, 0
    buffer_load_dwordx4 v[156:159], v2, s[12:15], s41 offen offset:3072 sc1
    v_mfma_f32_16x16x32_bf16 v[20:23], a[24:27], v[112:115], v[20:23]
    v_mfma_f32_16x16x32_bf16 v[40:43], a[24:27], v[116:119], v[40:43]
    v_mfma_f32_16x16x32_bf16 v[60:63], a[24:27], v[120:123], v[60:63]
    v_mfma_f32_16x16x32_bf16 v[80:83], a[24:27], v[124:127], v[80:83]
    s_add_u32 s41, s50, 4096
    buffer_load_dwordx4 v[160:163], v2, s[12:15], s41 offen offset:0 sc1
    s_add_u32 s41, s51, 4096
    buffer_load_dwordx4 v[164:167], v2, s[12:15], s41 offen offset:0 sc1
    v_mfma_f32_16x16x32_bf16 v[24:27], a[28:31], v[112:115], v[24:27]
    v_mfma_f32_16x16x32_bf16 v[44:47], a[28:31], v[116:119], v[44:47]
    v_mfma_f32_16x16x32_bf16 v[64:67], a[28:31], v[120:123], v[64:67]
    v_mfma_f32_16x16x32_bf16 v[84:87], a[28:31], v[124:127], v[84:87]
    s_add_u32 s41, s52, 4096
    buffer_load_dwordx4 v[168:171], v2, s[12:15], s41 offen offset:0 sc1
    v_mfma_f32_16x16x32_bf16 v[28:31], a[32:35], v[112:115], v[28:31]
    v_mfma_f32_16x16x32_bf16 v[48:51], a[32:35], v[116:119], v[48:51]
    v_mfma_f32_16x16x32_bf16 v[68:71], a[32:35], v[120:123], v[68:71]
    v_mfma_f32_16x16x32_bf16 v[88:91], a[32:35], v[124:127], v[88:91]
    s_add_u32 s41, s53, 4096
    buffer_load_dwordx4 v[172:175], v2, s[12:15], s41 offen offset:0 sc1
    s_add_u32 s41, s50, 4096
    buffer_load_dwordx4 v[176:179], v2, s[12:15], s41 offen offset:1024 sc1
    v_mfma_f32_16x16x32_bf16 v[32:35], a[36:39], v[112:115], v[32:35]
    v_mfma_f32_16x16x32_bf16 v[52:55], a[36:39], v[116:119], v[52:55]
    v_mfma_f32_16x16x32_bf16 v[72:75], a[36:39], v[120:123], v[72:75]
    v_mfma_f32_16x16x32_bf16 v[92:95], a[36:39], v[124:127], v[92:95]
    s_add_u32 s41, s51, 4096
    buffer_load_dwordx4 v[180:183], v2, s[12:15], s41 offen offset:1024 sc1
    s_waitcnt vmcnt(10)
    v_mfma_f32_16x16x32_bf16 v[16:19], a[40:43], v[128:131], v[16:19]
    v_mfma_f32_16x16x32_bf16 v[36:39], a[40:43], v[132:135], v[36:39]
    v_mfma_f32_16x16x32_bf16 v[56:59], a[40:43], v[136:139], v[56:59]
    v_mfma_f32_16x16x32_bf16 v[76:79], a[40:43], v[140:143], v[76:79]
    s_add_u32 s41, s52, 4096
    buffer_load_dwordx4 v[184:187], v2, s[12:15], s41 offen offset:1024 sc1
    v_mfma_f32_16x16x32_bf16 v[20:23], a[44:47], v[128:131], v[20:23]
    v_mfma_f32_16x16x32_bf16 v[40:43], a[44:47], v[132:135], v[40:43]
    v_mfma_f32_16x16x32_bf16 v[60:63], a[44:47], v[136:139], v[60:63]
    v_mfma_f32_16x16x32_bf16 v[80:83], a[44:47], v[140:143], v[80:83]
    s_add_u32 s41, s53, 4096
    buffer_load_dwordx4 v[188:191], v2, s[12:15], s41 offen offset:1024 sc1
    s_add_u32 s41, s50, 4096
    buffer_load_dwordx4 v[96:99], v2, s[12:15], s41 offen offset:2048 sc1
    v_mfma_f32_16x16x32_bf16 v[24:27], a[48:51], v[128:131], v[24:27]
    v_mfma_f32_16x16x32_bf16 v[44:47], a[48:51], v[132:135], v[44:47]
    v_mfma_f32_16x16x32_bf16 v[64:67], a[48:51], v[136:139], v[64:67]
    v_mfma_f32_16x16x32_bf16 v[84:87], a[48:51], v[140:143], v[84:87]
    s_add_u32 s41, s51, 4096
    buffer_load_dwordx4 v[100:103], v2, s[12:15], s41 offen offset:2048 sc1
    v_mfma_f32_16x16x32_bf16 v[28:31], a[52:55], v[128:131], v[28:31]
    v_mfma_f32_16x16x32_bf16 v[48:51], a[52:55], v[132:135], v[48:51]
    v_mfma_f32_16x16x32_bf16 v[68:71], a[52:55], v[136:139], v[68:71]
    v_mfma_f32_16x16x32_bf16 v[88:91], a[52:55], v[140:143], v[88:91]
    s_add_u32 s41, s52, 4096
    buffer_load_dwordx4 v[104:107], v2, s[12:15], s41 offen offset:2048 sc1
    v_mfma_f32_16x16x32_bf16 v[32:35], a[56:59], v[128:131], v[32:35]
    v_mfma_f32_16x16x32_bf16 v[52:55], a[56:59], v[132:135], v[52:55]
    v_mfma_f32_16x16x32_bf16 v[72:75], a[56:59], v[136:139], v[72:75]
    v_mfma_f32_16x16x32_bf16 v[92:95], a[56:59], v[140:143], v[92:95]
    s_add_u32 s41, s53, 4096
    buffer_load_dwordx4 v[108:111], v2, s[12:15], s41 offen offset:2048 sc1
    s_waitcnt vmcnt(12)
    v_mfma_f32_16x16x32_bf16 v[16:19], a[60:63], v[144:147], v[16:19]
    v_mfma_f32_16x16x32_bf16 v[36:39], a[60:63], v[148:151], v[36:39]
    v_mfma_f32_16x16x32_bf16 v[56:59], a[60:63], v[152:155], v[56:59]
    v_mfma_f32_16x16x32_bf16 v[76:79], a[60:63], v[156:159], v[76:79]
    s_add_u32 s41, s50, 4096
    buffer_load_dwordx4 v[112:115], v2, s[12:15], s41 offen offset:3072 sc1
    v_mfma_f32_16x16x32_bf16 v[20:23], a[64:67], v[144:147], v[20:23]
    v_mfma_f32_16x16x32_bf16 v[40:43], a[64:67], v[148:151], v[40:43]
    v_mfma_f32_16x16x32_bf16 v[60:63], a[64:67], v[152:155], v[60:63]
    v_mfma_f32_16x16x32_bf16 v[80:83], a[64:67], v[156:159], v[80:83]
    s_add_u32 s41, s51, 4096
    buffer_load_dwordx4 v[116:119], v2, s[12:15], s41 offen offset:3072 sc1
    v_mfma_f32_16x16x32_bf16 v[24:27], a[68:71], v[144:147], v[24:27]
    v_mfma_f32_16x16x32_bf16 v[44:47], a[68:71], v[148:151], v[44:47]
    v_mfma_f32_16x16x32_bf16 v[64:67], a[68:71], v[152:155], v[64:67]
    v_mfma_f32_16x16x32_bf16 v[84:87], a[68:71], v[156:159], v[84:87]
    s_add_u32 s41, s52, 4096
    buffer_load_dwordx4 v[120:123], v2, s[12:15], s41 offen offset:3072 sc1
    v_mfma_f32_16x16x32_bf16 v[28:31], a[72:75], v[144:147], v[28:31]
    v_mfma_f32_16x16x32_bf16 v[48:51], a[72:75], v[148:151], v[48:51]
    v_mfma_f32_16x16x32_bf16 v[68:71], a[72:75], v[152:155], v[68:71]
    v_mfma_f32_16x16x32_bf16 v[88:91], a[72:75], v[156:159], v[88:91]
    s_add_u32 s41, s53, 4096
    buffer_load_dwordx4 v[124:127], v2, s[12:15], s41 offen offset:3072 sc1
    v_mfma_f32_16x16x32_bf16 v[32:35], a[76:79], v[144:147], v[32:35]
    v_mfma_f32_16x16x32_bf16 v[52:55], a[76:79], v[148:151], v[52:55]
    v_mfma_f32_16x16x32_bf16 v[72:75], a[76:79], v[152:155], v[72:75]
    v_mfma_f32_16x16x32_bf16 v[92:95], a[76:79], v[156:159], v[92:95]
    s_add_u32 s41, s50, 8192
    buffer_load_dwordx4 v[128:131], v2, s[12:15], s41 offen offset:0 sc1
    s_waitcnt vmcnt(13)
    v_mfma_f32_16x16x32_bf16 v[16:19], a[80:83], v[160:163], v[16:19]
    v_mfma_f32_16x16x32_bf16 v[36:39], a[80:83], v[164:167], v[36:39]
    v_mfma_f32_16x16x32_bf16 v[56:59], a[80:83], v[168:171], v[56:59]
    v_mfma_f32_16x16x32_bf16 v[76:79], a[80:83], v[172:175], v[76:79]
    s_add_u32 s41, s51, 8192
    buffer_load_dwordx4 v[132:135], v2, s[12:15], s41 offen offset:0 sc1
    v_mfma_f32_16x16x32_bf16 v[20:23], a[84:87], v[160:163], v[20:23]
    v_mfma_f32_16x16x32_bf16 v[40:43], a[84:87], v[164:167], v[40:43]
    v_mfma_f32_16x16x32_bf16 v[60:63], a[84:87], v[168:171], v[60:63]
    v_mfma_f32_16x16x32_bf16 v[80:83], a[84:87], v[172:175], v[80:83]
    s_add_u32 s41, s52, 8192
    buffer_load_dwordx4 v[136:139], v2, s[12:15], s41 offen offset:0 sc1
    v_mfma_f32_16x16x32_bf16 v[24:27], a[88:91], v[160:163], v[24:27]
    v_mfma_f32_16x16x32_bf16 v[44:47], a[88:91], v[164:167], v[44:47]
    v_mfma_f32_16x16x32_bf16 v[64:67], a[88:91], v[168:171], v[64:67]
    v_mfma_f32_16x16x32_bf16 v[84:87], a[88:91], v[172:175], v[84:87]
    s_add_u32 s41, s53, 8192
    buffer_load_dwordx4 v[140:143], v2, s[12:15], s41 offen offset:0 sc1
    v_mfma_f32_16x16x32_bf16 v[28:31], a[92:95], v[160:163], v[28:31]
    v_mfma_f32_16x16x32_bf16 v[48:51], a[92:95], v[164:167], v[48:51]
    v_mfma_f32_16x16x32_bf16 v[68:71], a[92:95], v[168:171], v[68:71]
    v_mfma_f32_16x16x32_bf16 v[88:91], a[92:95], v[172:175], v[88:91]
    s_add_u32 s41, s50, 8192
    buffer_load_dwordx4 v[144:147], v2, s[12:15], s41 offen offset:1024 sc1
    v_mfma_f32_16x16x32_bf16 v[32:35], a[96:99], v[160:163], v[32:35]
    v_mfma_f32_16x16x32_bf16 v[52:55], a[96:99], v[164:167], v[52:55]
    v_mfma_f32_16x16x32_bf16 v[72:75], a[96:99], v[168:171], v[72:75]
    v_mfma_f32_16x16x32_bf16 v[92:95], a[96:99], v[172:175], v[92:95]
    s_add_u32 s41, s51, 8192
    buffer_load_dwordx4 v[148:151], v2, s[12:15], s41 offen offset:1024 sc1
    s_waitcnt vmcnt(14)
    v_mfma_f32_16x16x32_bf16 v[16:19], a[100:103], v[176:179], v[16:19]
    v_mfma_f32_16x16x32_bf16 v[36:39], a[100:103], v[180:183], v[36:39]
    v_mfma_f32_16x16x32_bf16 v[56:59], a[100:103], v[184:187], v[56:59]
    v_mfma_f32_16x16x32_bf16 v[76:79], a[100:103], v[188:191], v[76:79]
    s_add_u32 s41, s52, 8192
    buffer_load_dwordx4 v[152:155], v2, s[12:15], s41 offen offset:1024 sc1
    v_mfma_f32_16x16x32_bf16 v[20:23], a[104:107], v[176:179], v[20:23]
    v_mfma_f32_16x16x32_bf16 v[40:43], a[104:107], v[180:183], v[40:43]
    v_mfma_f32_16x16x32_bf16 v[60:63], a[104:107], v[184:187], v[60:63]
    v_mfma_f32_16x16x32_bf16 v[80:83], a[104:107], v[188:191], v[80:83]
    s_add_u32 s41, s53, 8192
    buffer_load_dwordx4 v[156:159], v2, s[12:15], s41 offen offset:1024 sc1
    v_mfma_f32_16x16x32_bf16 v[24:27], a[108:111], v[176:179], v[24:27]
    v_mfma_f32_16x16x32_bf16 v[44:47], a[108:111], v[180:183], v[44:47]
    v_mfma_f32_16x16x32_bf16 v[64:67], a[108:111], v[184:187], v[64:67]
    v_mfma_f32_16x16x32_bf16 v[84:87], a[108:111], v[188:191], v[84:87]
    s_add_u32 s41, s50, 8192
    buffer_load_dwordx4 v[160:163], v2, s[12:15], s41 offen offset:2048 sc1
    v_mfma_f32_16x16x32_bf16 v[28:31], a[112:115], v[176:179], v[28:31]
    v_mfma_f32_16x16x32_bf16 v[48:51], a[112:115], v[180:183], v[48:51]
    v_mfma_f32_16x16x32_bf16 v[68:71], a[112:115], v[184:187], v[68:71]
    v_mfma_f32_16x16x32_bf16 v[88:91], a[112:115], v[188:191], v[88:91]
    s_add_u32 s41, s51, 8192
    buffer_load_dwordx4 v[164:167], v2, s[12:15], s41 offen offset:2048 sc1
    v_mfma_f32_16x16x32_bf16 v[32:35], a[116:119], v[176:179], v[32:35]
    v_mfma_f32_16x16x32_bf16 v[52:55], a[116:119], v[180:183], v[52:55]
    v_mfma_f32_16x16x32_bf16 v[72:75], a[116:119], v[184:187], v[72:75]
    v_mfma_f32_16x16x32_bf16 v[92:95], a[116:119], v[188:191], v[92:95]
    s_add_u32 s41, s52, 8192
    buffer_load_dwordx4 v[168:171], v2, s[12:15], s41 offen offset:2048 sc1
    s_waitcnt vmcnt(15)
    v_mfma_f32_16x16x32_bf16 v[16:19], a[120:123], v[96:99], v[16:19]
    v_mfma_f32_16x16x32_bf16 v[36:39], a[120:123], v[100:103], v[36:39]
    v_mfma_f32_16x16x32_bf16 v[56:59], a[120:123], v[104:107], v[56:59]
    v_mfma_f32_16x16x32_bf16 v[76:79], a[120:123], v[108:111], v[76:79]
    s_add_u32 s41, s53, 8192
    buffer_load_dwordx4 v[172:175], v2, s[12:15], s41 offen offset:2048 sc1
    v_mfma_f32_16x16x32_bf16 v[20:23], a[124:127], v[96:99], v[20:23]
    v_mfma_f32_16x16x32_bf16 v[40:43], a[124:127], v[100:103], v[40:43]
    v_mfma_f32_16x16x32_bf16 v[60:63], a[124:127], v[104:107], v[60:63]
    v_mfma_f32_16x16x32_bf16 v[80:83], a[124:127], v[108:111], v[80:83]
    s_add_u32 s41, s50, 8192
    buffer_load_dwordx4 v[176:179], v2, s[12:15], s41 offen offset:3072 sc1
    v_mfma_f32_16x16x32_bf16 v[24:27], a[128:131], v[96:99], v[24:27]
    v_mfma_f32_16x16x32_bf16 v[44:47], a[128:131], v[100:103], v[44:47]
    v_mfma_f32_16x16x32_bf16 v[64:67], a[128:131], v[104:107], v[64:67]
    v_mfma_f32_16x16x32_bf16 v[84:87], a[128:131], v[108:111], v[84:87]
    s_add_u32 s41, s51, 8192
    buffer_load_dwordx4 v[180:183], v2, s[12:15], s41 offen offset:3072 sc1
    v_mfma_f32_16x16x32_bf16 v[28:31], a[132:135], v[96:99], v[28:31]
    v_mfma_f32_16x16x32_bf16 v[48:51], a[132:135], v[100:103], v[48:51]
    v_mfma_f32_16x16x32_bf16 v[68:71], a[132:135], v[104:107], v[68:71]
    v_mfma_f32_16x16x32_bf16 v[88:91], a[132:135], v[108:111], v[88:91]
    s_add_u32 s41, s52, 8192
    buffer_load_dwordx4 v[184:187], v2, s[12:15], s41 offen offset:3072 sc1
    v_mfma_f32_16x16x32_bf16 v[32:35], a[136:139], v[96:99], v[32:35]
    v_mfma_f32_16x16x32_bf16 v[52:55], a[136:139], v[100:103], v[52:55]
    v_mfma_f32_16x16x32_bf16 v[72:75], a[136:139], v[104:107], v[72:75]
    v_mfma_f32_16x16x32_bf16 v[92:95], a[136:139], v[108:111], v[92:95]
    s_add_u32 s41, s53, 8192
    buffer_load_dwordx4 v[188:191], v2, s[12:15], s41 offen offset:3072 sc1
    s_waitcnt vmcnt(16)
    v_mfma_f32_16x16x32_bf16 v[16:19], a[140:143], v[112:115], v[16:19]
    v_mfma_f32_16x16x32_bf16 v[36:39], a[140:143], v[116:119], v[36:39]
    v_mfma_f32_16x16x32_bf16 v[56:59], a[140:143], v[120:123], v[56:59]
    v_mfma_f32_16x16x32_bf16 v[76:79], a[140:143], v[124:127], v[76:79]
    v_mfma_f32_16x16x32_bf16 v[20:23], a[144:147], v[112:115], v[20:23]
    v_mfma_f32_16x16x32_bf16 v[40:43], a[144:147], v[116:119], v[40:43]
    v_mfma_f32_16x16x32_bf16 v[60:63], a[144:147], v[120:123], v[60:63]
    v_mfma_f32_16x16x32_bf16 v[80:83], a[144:147], v[124:127], v[80:83]
    s_add_u32 s41, s50, 12288
    buffer_load_dwordx4 v[96:99], v2, s[12:15], s41 offen offset:0 sc1
    v_mfma_f32_16x16x32_bf16 v[24:27], a[148:151], v[112:115], v[24:27]
    v_mfma_f32_16x16x32_bf16 v[44:47], a[148:151], v[116:119], v[44:47]
    v_mfma_f32_16x16x32_bf16 v[64:67], a[148:151], v[120:123], v[64:67]
    v_mfma_f32_16x16x32_bf16 v[84:87], a[148:151], v[124:127], v[84:87]
    s_add_u32 s41, s51, 12288
    buffer_load_dwordx4 v[100:103], v2, s[12:15], s41 offen offset:0 sc1
    v_mfma_f32_16x16x32_bf16 v[28:31], a[152:155], v[112:115], v[28:31]
    v_mfma_f32_16x16x32_bf16 v[48:51], a[152:155], v[116:119], v[48:51]
    v_mfma_f32_16x16x32_bf16 v[68:71], a[152:155], v[120:123], v[68:71]
    v_mfma_f32_16x16x32_bf16 v[88:91], a[152:155], v[124:127], v[88:91]
    s_add_u32 s41, s52, 12288
    buffer_load_dwordx4 v[104:107], v2, s[12:15], s41 offen offset:0 sc1
    v_mfma_f32_16x16x32_bf16 v[32:35], a[156:159], v[112:115], v[32:35]
    v_mfma_f32_16x16x32_bf16 v[52:55], a[156:159], v[116:119], v[52:55]
    v_mfma_f32_16x16x32_bf16 v[72:75], a[156:159], v[120:123], v[72:75]
    v_mfma_f32_16x16x32_bf16 v[92:95], a[156:159], v[124:127], v[92:95]
    s_add_u32 s41, s53, 12288
    buffer_load_dwordx4 v[108:111], v2, s[12:15], s41 offen offset:0 sc1
    s_waitcnt vmcnt(16)
    v_mfma_f32_16x16x32_bf16 v[16:19], a[160:163], v[128:131], v[16:19]
    v_mfma_f32_16x16x32_bf16 v[36:39], a[160:163], v[132:135], v[36:39]
    v_mfma_f32_16x16x32_bf16 v[56:59], a[160:163], v[136:139], v[56:59]
    v_mfma_f32_16x16x32_bf16 v[76:79], a[160:163], v[140:143], v[76:79]
    v_mfma_f32_16x16x32_bf16 v[20:23], a[164:167], v[128:131], v[20:23]
    v_mfma_f32_16x16x32_bf16 v[40:43], a[164:167], v[132:135], v[40:43]
    v_mfma_f32_16x16x32_bf16 v[60:63], a[164:167], v[136:139], v[60:63]
    v_mfma_f32_16x16x32_bf16 v[80:83], a[164:167], v[140:143], v[80:83]
    s_add_u32 s41, s50, 12288
    buffer_load_dwordx4 v[112:115], v2, s[12:15], s41 offen offset:1024 sc1
    v_mfma_f32_16x16x32_bf16 v[24:27], a[168:171], v[128:131], v[24:27]
    v_mfma_f32_16x16x32_bf16 v[44:47], a[168:171], v[132:135], v[44:47]
    v_mfma_f32_16x16x32_bf16 v[64:67], a[168:171], v[136:139], v[64:67]
    v_mfma_f32_16x16x32_bf16 v[84:87], a[168:171], v[140:143], v[84:87]
    s_add_u32 s41, s51, 12288
    buffer_load_dwordx4 v[116:119], v2, s[12:15], s41 offen offset:1024 sc1
    v_mfma_f32_16x16x32_bf16 v[28:31], a[172:175], v[128:131], v[28:31]
    v_mfma_f32_16x16x32_bf16 v[48:51], a[172:175], v[132:135], v[48:51]
    v_mfma_f32_16x16x32_bf16 v[68:71], a[172:175], v[136:139], v[68:71]
    v_mfma_f32_16x16x32_bf16 v[88:91], a[172:175], v[140:143], v[88:91]
    s_add_u32 s41, s52, 12288
    buffer_load_dwordx4 v[120:123], v2, s[12:15], s41 offen offset:1024 sc1
    v_mfma_f32_16x16x32_bf16 v[32:35], a[176:179], v[128:131], v[32:35]
    v_mfma_f32_16x16x32_bf16 v[52:55], a[176:179], v[132:135], v[52:55]
    v_mfma_f32_16x16x32_bf16 v[72:75], a[176:179], v[136:139], v[72:75]
    v_mfma_f32_16x16x32_bf16 v[92:95], a[176:179], v[140:143], v[92:95]
    s_add_u32 s41, s53, 12288
    buffer_load_dwordx4 v[124:127], v2, s[12:15], s41 offen offset:1024 sc1
    s_waitcnt vmcnt(16)
    v_mfma_f32_16x16x32_bf16 v[16:19], a[180:183], v[144:147], v[16:19]
    v_mfma_f32_16x16x32_bf16 v[36:39], a[180:183], v[148:151], v[36:39]
    v_mfma_f32_16x16x32_bf16 v[56:59], a[180:183], v[152:155], v[56:59]
    v_mfma_f32_16x16x32_bf16 v[76:79], a[180:183], v[156:159], v[76:79]
    v_mfma_f32_16x16x32_bf16 v[20:23], a[184:187], v[144:147], v[20:23]
    v_mfma_f32_16x16x32_bf16 v[40:43], a[184:187], v[148:151], v[40:43]
    v_mfma_f32_16x16x32_bf16 v[60:63], a[184:187], v[152:155], v[60:63]
    v_mfma_f32_16x16x32_bf16 v[80:83], a[184:187], v[156:159], v[80:83]
    v_mfma_f32_16x16x32_bf16 v[24:27], a[188:191], v[144:147], v[24:27]
    v_mfma_f32_16x16x32_bf16 v[44:47], a[188:191], v[148:151], v[44:47]
    v_mfma_f32_16x16x32_bf16 v[64:67], a[188:191], v[152:155], v[64:67]
    v_mfma_f32_16x16x32_bf16 v[84:87], a[188:191], v[156:159], v[84:87]
    v_mfma_f32_16x16x32_bf16 v[28:31], a[192:195], v[144:147], v[28:31]
    v_mfma_f32_16x16x32_bf16 v[48:51], a[192:195], v[148:151], v[48:51]
    v_mfma_f32_16x16x32_bf16 v[68:71], a[192:195], v[152:155], v[68:71]
    v_mfma_f32_16x16x32_bf16 v[88:91], a[192:195], v[156:159], v[88:91]
    v_mfma_f32_16x16x32_bf16 v[32:35], a[196:199], v[144:147], v[32:35]
    v_mfma_f32_16x16x32_bf16 v[52:55], a[196:199], v[148:151], v[52:55]
    v_mfma_f32_16x16x32_bf16 v[72:75], a[196:199], v[152:155], v[72:75]
    v_mfma_f32_16x16x32_bf16 v[92:95], a[196:199], v[156:159], v[92:95]
    s_waitcnt vmcnt(12)
    v_mfma_f32_16x16x32_bf16 v[16:19], a[200:203], v[160:163], v[16:19]
    v_mfma_f32_16x16x32_bf16 v[36:39], a[200:203], v[164:167], v[36:39]
    v_mfma_f32_16x16x32_bf16 v[56:59], a[200:203], v[168:171], v[56:59]
    v_mfma_f32_16x16x32_bf16 v[76:79], a[200:203], v[172:175], v[76:79]
    v_mfma_f32_16x16x32_bf16 v[20:23], a[204:207], v[160:163], v[20:23]
    v_mfma_f32_16x16x32_bf16 v[40:43], a[204:207], v[164:167], v[40:43]
    v_mfma_f32_16x16x32_bf16 v[60:63], a[204:207], v[168:171], v[60:63]
    v_mfma_f32_16x16x32_bf16 v[80:83], a[204:207], v[172:175], v[80:83]
    v_mfma_f32_16x16x32_bf16 v[24:27], a[208:211], v[160:163], v[24:27]
    v_mfma_f32_16x16x32_bf16 v[44:47], a[208:211], v[164:167], v[44:47]
    v_mfma_f32_16x16x32_bf16 v[64:67], a[208:211], v[168:171], v[64:67]
    v_mfma_f32_16x16x32_bf16 v[84:87], a[208:211], v[172:175], v[84:87]
    v_mfma_f32_16x16x32_bf16 v[28:31], a[212:215], v[160:163], v[28:31]
    v_mfma_f32_16x16x32_bf16 v[48:51], a[212:215], v[164:167], v[48:51]
    v_mfma_f32_16x16x32_bf16 v[68:71], a[212:215], v[168:171], v[68:71]
    v_mfma_f32_16x16x32_bf16 v[88:91], a[212:215], v[172:175], v[88:91]
    v_mfma_f32_16x16x32_bf16 v[32:35], a[216:219], v[160:163], v[32:35]
    v_mfma_f32_16x16x32_bf16 v[52:55], a[216:219], v[164:167], v[52:55]
    v_mfma_f32_16x16x32_bf16 v[72:75], a[216:219], v[168:171], v[72:75]
    v_mfma_f32_16x16x32_bf16 v[92:95], a[216:219], v[172:175], v[92:95]
    s_waitcnt vmcnt(8)
    v_mfma_f32_16x16x32_bf16 v[16:19], a[220:223], v[176:179], v[16:19]
    v_mfma_f32_16x16x32_bf16 v[36:39], a[220:223], v[180:183], v[36:39]
    v_mfma_f32_16x16x32_bf16 v[56:59], a[220:223], v[184:187], v[56:59]
    v_mfma_f32_16x16x32_bf16 v[76:79], a[220:223], v[188:191], v[76:79]
    v_mfma_f32_16x16x32_bf16 v[20:23], a[224:227], v[176:179], v[20:23]
    v_mfma_f32_16x16x32_bf16 v[40:43], a[224:227], v[180:183], v[40:43]
    v_mfma_f32_16x16x32_bf16 v[60:63], a[224:227], v[184:187], v[60:63]
    v_mfma_f32_16x16x32_bf16 v[80:83], a[224:227], v[188:191], v[80:83]
    v_mfma_f32_16x16x32_bf16 v[24:27], a[228:231], v[176:179], v[24:27]
    v_mfma_f32_16x16x32_bf16 v[44:47], a[228:231], v[180:183], v[44:47]
    v_mfma_f32_16x16x32_bf16 v[64:67], a[228:231], v[184:187], v[64:67]
    v_mfma_f32_16x16x32_bf16 v[84:87], a[228:231], v[188:191], v[84:87]
    v_mfma_f32_16x16x32_bf16 v[28:31], a[232:235], v[176:179], v[28:31]
    v_mfma_f32_16x16x32_bf16 v[48:51], a[232:235], v[180:183], v[48:51]
    v_mfma_f32_16x16x32_bf16 v[68:71], a[232:235], v[184:187], v[68:71]
    v_mfma_f32_16x16x32_bf16 v[88:91], a[232:235], v[188:191], v[88:91]
    v_mfma_f32_16x16x32_bf16 v[32:35], a[236:239], v[176:179], v[32:35]
    v_mfma_f32_16x16x32_bf16 v[52:55], a[236:239], v[180:183], v[52:55]
    v_mfma_f32_16x16x32_bf16 v[72:75], a[236:239], v[184:187], v[72:75]
    v_mfma_f32_16x16x32_bf16 v[92:95], a[236:239], v[188:191], v[92:95]
    s_cmp_eq_u32 s30, 3
    s_cbranch_scc1 k2_kernel_k4skip38
    s_waitcnt vmcnt(4)
    v_mfma_f32_16x16x32_bf16 v[16:19], a[240:243], v[96:99], v[16:19]
    v_mfma_f32_16x16x32_bf16 v[36:39], a[240:243], v[100:103], v[36:39]
    v_mfma_f32_16x16x32_bf16 v[56:59], a[240:243], v[104:107], v[56:59]
    v_mfma_f32_16x16x32_bf16 v[76:79], a[240:243], v[108:111], v[76:79]
    v_mfma_f32_16x16x32_bf16 v[20:23], a[244:247], v[96:99], v[20:23]
    v_mfma_f32_16x16x32_bf16 v[40:43], a[244:247], v[100:103], v[40:43]
    v_mfma_f32_16x16x32_bf16 v[60:63], a[244:247], v[104:107], v[60:63]
    v_mfma_f32_16x16x32_bf16 v[80:83], a[244:247], v[108:111], v[80:83]
    v_mfma_f32_16x16x32_bf16 v[24:27], a[248:251], v[96:99], v[24:27]
    v_mfma_f32_16x16x32_bf16 v[44:47], a[248:251], v[100:103], v[44:47]
    v_mfma_f32_16x16x32_bf16 v[64:67], a[248:251], v[104:107], v[64:67]
    v_mfma_f32_16x16x32_bf16 v[84:87], a[248:251], v[108:111], v[84:87]
    v_mfma_f32_16x16x32_bf16 v[28:31], a[252:255], v[96:99], v[28:31]
    v_mfma_f32_16x16x32_bf16 v[48:51], a[252:255], v[100:103], v[48:51]
    v_mfma_f32_16x16x32_bf16 v[68:71], a[252:255], v[104:107], v[68:71]
    v_mfma_f32_16x16x32_bf16 v[88:91], a[252:255], v[108:111], v[88:91]
    v_mfma_f32_16x16x32_bf16 v[32:35], v[192:195], v[96:99], v[32:35]
    v_mfma_f32_16x16x32_bf16 v[52:55], v[192:195], v[100:103], v[52:55]
    v_mfma_f32_16x16x32_bf16 v[72:75], v[192:195], v[104:107], v[72:75]
    v_mfma_f32_16x16x32_bf16 v[92:95], v[192:195], v[108:111], v[92:95]
    s_waitcnt vmcnt(0)
    v_mfma_f32_16x16x32_bf16 v[16:19], v[196:199], v[112:115], v[16:19]
    v_mfma_f32_16x16x32_bf16 v[36:39], v[196:199], v[116:119], v[36:39]
    v_mfma_f32_16x16x32_bf16 v[56:59], v[196:199], v[120:123], v[56:59]
    v_mfma_f32_16x16x32_bf16 v[76:79], v[196:199], v[124:127], v[76:79]
    v_mfma_f32_16x16x32_bf16 v[20:23], v[200:203], v[112:115], v[20:23]
    v_mfma_f32_16x16x32_bf16 v[40:43], v[200:203], v[116:119], v[40:43]
    v_mfma_f32_16x16x32_bf16 v[60:63], v[200:203], v[120:123], v[60:63]
    v_mfma_f32_16x16x32_bf16 v[80:83], v[200:203], v[124:127], v[80:83]
    v_mfma_f32_16x16x32_bf16 v[24:27], v[204:207], v[112:115], v[24:27]
    v_mfma_f32_16x16x32_bf16 v[44:47], v[204:207], v[116:119], v[44:47]
    v_mfma_f32_16x16x32_bf16 v[64:67], v[204:207], v[120:123], v[64:67]
    v_mfma_f32_16x16x32_bf16 v[84:87], v[204:207], v[124:127], v[84:87]
    v_mfma_f32_16x16x32_bf16 v[28:31], v[208:211], v[112:115], v[28:31]
    v_mfma_f32_16x16x32_bf16 v[48:51], v[208:211], v[116:119], v[48:51]
    v_mfma_f32_16x16x32_bf16 v[68:71], v[208:211], v[120:123], v[68:71]
    v_mfma_f32_16x16x32_bf16 v[88:91], v[208:211], v[124:127], v[88:91]
    v_mfma_f32_16x16x32_bf16 v[32:35], v[212:215], v[112:115], v[32:35]
    v_mfma_f32_16x16x32_bf16 v[52:55], v[212:215], v[116:119], v[52:55]
    v_mfma_f32_16x16x32_bf16 v[72:75], v[212:215], v[120:123], v[72:75]
    v_mfma_f32_16x16x32_bf16 v[92:95], v[212:215], v[124:127], v[92:95]
k2_kernel_k4skip38:
    s_waitcnt vmcnt(0)
    s_barrier
    s_add_u32 s41, s30, 1
    s_and_b32 s41, s41, 3
    s_mul_i32 s41, s41, 15360
    s_add_u32 s41, s41, 0
    v_add_u32 v9, s41, v2
    ds_write_b128 v9, v[36:39] offset:0
    ds_write_b128 v9, v[40:43] offset:1024
    ds_write_b128 v9, v[44:47] offset:2048
    ds_write_b128 v9, v[48:51] offset:3072
    ds_write_b128 v9, v[52:55] offset:4096
    s_add_u32 s41, s30, 2
    s_and_b32 s41, s41, 3
    s_mul_i32 s41, s41, 15360
    s_add_u32 s41, s41, 5120
    v_add_u32 v9, s41, v2
    ds_write_b128 v9, v[56:59] offset:0
    ds_write_b128 v9, v[60:63] offset:1024
    ds_write_b128 v9, v[64:67] offset:2048
    ds_write_b128 v9, v[68:71] offset:3072
    ds_write_b128 v9, v[72:75] offset:4096
    s_add_u32 s41, s30, 3
    s_and_b32 s41, s41, 3
    s_mul_i32 s41, s41, 15360
    s_add_u32 s41, s41, 10240
    v_add_u32 v9, s41, v2
    ds_write_b128 v9, v[76:79] offset:0
    ds_write_b128 v9, v[80:83] offset:1024
    ds_write_b128 v9, v[84:87] offset:2048
    ds_write_b128 v9, v[88:91] offset:3072
    ds_write_b128 v9, v[92:95] offset:4096
    v_lshlrev_b32 v10, 4, v3
    v_add_u32 v10, 157696, v10
    ds_read_b128 v[96:99], v10 offset:0
    ds_read_b128 v[100:103], v10 offset:64
    ds_read_b128 v[104:107], v10 offset:128
    ds_read_b128 v[108:111], v10 offset:192
    ds_read_b128 v[112:115], v10 offset:256
    s_mul_i32 s41, s30, 15360
    v_add_u32 v9, s41, v2
    s_waitcnt lgkmcnt(0)
    s_barrier
    ds_read_b128 v[116:119], v9 offset:0
    ds_read_b128 v[120:123], v9 offset:1024
    ds_read_b128 v[124:127], v9 offset:2048
    ds_read_b128 v[128:131], v9 offset:3072
    ds_read_b128 v[132:135], v9 offset:4096
    ds_read_b128 v[136:139], v9 offset:5120
    ds_read_b128 v[140:143], v9 offset:6144
    ds_read_b128 v[144:147], v9 offset:7168
    ds_read_b128 v[148:151], v9 offset:8192
    ds_read_b128 v[152:155], v9 offset:9216
    ds_read_b128 v[156:159], v9 offset:10240
    ds_read_b128 v[160:163], v9 offset:11264
    ds_read_b128 v[164:167], v9 offset:12288
    ds_read_b128 v[168:171], v9 offset:13312
    ds_read_b128 v[172:175], v9 offset:14336
    s_lshl_b32 s46, s32, 2
    s_add_u32 s46, s46, s30
    s_lshl_b32 s46, s46, 4
    s_lshl_b32 s47, s28, 8
    s_add_u32 s46, s46, s47
    v_add_u32 v10, s46, v4
    v_mul_u32_u24 v10, 1280, v10
    v_lshl_add_u32 v10, v3, 3, v10
    s_mul_i32 s47, s33, 160
    s_nop 1
    v_permlane16_swap_b32 v228, v230
    v_permlane16_swap_b32 v229, v231
    v_permlane16_swap_b32 v232, v234
    v_permlane16_swap_b32 v233, v235
    v_permlane16_swap_b32 v238, v240
    v_permlane16_swap_b32 v239, v241
    v_permlane16_swap_b32 v242, v244
    v_permlane16_swap_b32 v243, v245
    s_waitcnt lgkmcnt(0)
    v_pk_add_f32 v[16:17], v[16:17], v[116:117]
    v_pk_add_f32 v[18:19], v[18:19], v[118:119]
    v_pk_add_f32 v[20:21], v[20:21], v[120:121]
    v_pk_add_f32 v[22:23], v[22:23], v[122:123]
    v_pk_add_f32 v[24:25], v[24:25], v[124:125]
    v_pk_add_f32 v[26:27], v[26:27], v[126:127]
    v_pk_add_f32 v[28:29], v[28:29], v[128:129]
    v_pk_add_f32 v[30:31], v[30:31], v[130:131]
    v_pk_add_f32 v[32:33], v[32:33], v[132:133]
    v_pk_add_f32 v[34:35], v[34:35], v[134:135]
    v_pk_add_f32 v[16:17], v[16:17], v[136:137]
    v_pk_add_f32 v[18:19], v[18:19], v[138:139]
    v_pk_add_f32 v[20:21], v[20:21], v[140:141]
    v_pk_add_f32 v[22:23], v[22:23], v[142:143]
    v_pk_add_f32 v[24:25], v[24:25], v[144:145]
    v_pk_add_f32 v[26:27], v[26:27], v[146:147]
    v_pk_add_f32 v[28:29], v[28:29], v[148:149]
    v_pk_add_f32 v[30:31], v[30:31], v[150:151]
    v_pk_add_f32 v[32:33], v[32:33], v[152:153]
    v_pk_add_f32 v[34:35], v[34:35], v[154:155]
    v_pk_add_f32 v[16:17], v[16:17], v[156:157]
    v_pk_add_f32 v[18:19], v[18:19], v[158:159]
    v_pk_add_f32 v[20:21], v[20:21], v[160:161]
    v_pk_add_f32 v[22:23], v[22:23], v[162:163]
    v_pk_add_f32 v[24:25], v[24:25], v[164:165]
    v_pk_add_f32 v[26:27], v[26:27], v[166:167]
    v_pk_add_f32 v[28:29], v[28:29], v[168:169]
    v_pk_add_f32 v[30:31], v[30:31], v[170:171]
    v_pk_add_f32 v[32:33], v[32:33], v[172:173]
    v_pk_add_f32 v[34:35], v[34:35], v[174:175]
    v_lshlrev_b32 v116, 16, v238
    v_and_b32 v117, 0xffff0000, v238
    v_lshlrev_b32 v118, 16, v239
    v_and_b32 v119, 0xffff0000, v239
    v_lshlrev_b32 v136, 16, v228
    v_and_b32 v137, 0xffff0000, v228
    v_lshlrev_b32 v138, 16, v229
    v_and_b32 v139, 0xffff0000, v229
    v_lshlrev_b32 v120, 16, v240
    v_and_b32 v121, 0xffff0000, v240
    v_lshlrev_b32 v122, 16, v241
    v_and_b32 v123, 0xffff0000, v241
    v_lshlrev_b32 v140, 16, v230
    v_and_b32 v141, 0xffff0000, v230
    v_lshlrev_b32 v142, 16, v231
    v_and_b32 v143, 0xffff0000, v231
    v_lshlrev_b32 v124, 16, v242
    v_and_b32 v125, 0xffff0000, v242
    v_lshlrev_b32 v126, 16, v243
    v_and_b32 v127, 0xffff0000, v243
    v_lshlrev_b32 v144, 16, v232
    v_and_b32 v145, 0xffff0000, v232
    v_lshlrev_b32 v146, 16, v233
    v_and_b32 v147, 0xffff0000, v233
    v_lshlrev_b32 v128, 16, v244
    v_and_b32 v129, 0xffff0000, v244
    v_lshlrev_b32 v130, 16, v245
    v_and_b32 v131, 0xffff0000, v245
    v_lshlrev_b32 v148, 16, v234
    v_and_b32 v149, 0xffff0000, v234
    v_lshlrev_b32 v150, 16, v235
    v_and_b32 v151, 0xffff0000, v235
    v_lshlrev_b32 v132, 16, v246
    v_and_b32 v133, 0xffff0000, v246
    v_lshlrev_b32 v134, 16, v247
    v_and_b32 v135, 0xffff0000, v247
    v_lshlrev_b32 v152, 16, v236
    v_and_b32 v153, 0xffff0000, v236
    v_lshlrev_b32 v154, 16, v237
    v_and_b32 v155, 0xffff0000, v237
    v_pk_add_f32 v[16:17], v[16:17], v[116:117]
    v_pk_add_f32 v[18:19], v[18:19], v[118:119]
    v_pk_add_f32 v[20:21], v[20:21], v[120:121]
    v_pk_add_f32 v[22:23], v[22:23], v[122:123]
    v_pk_add_f32 v[24:25], v[24:25], v[124:125]
    v_pk_add_f32 v[26:27], v[26:27], v[126:127]
    v_pk_add_f32 v[28:29], v[28:29], v[128:129]
    v_pk_add_f32 v[30:31], v[30:31], v[130:131]
    v_pk_add_f32 v[32:33], v[32:33], v[132:133]
    v_pk_add_f32 v[34:35], v[34:35], v[134:135]
    v_pk_fma_f32 v[16:17], v[16:17], v[96:97], v[136:137]
    v_pk_fma_f32 v[18:19], v[18:19], v[98:99], v[138:139]
    v_pk_fma_f32 v[20:21], v[20:21], v[100:101], v[140:141]
    v_pk_fma_f32 v[22:23], v[22:23], v[102:103], v[142:143]
    v_pk_fma_f32 v[24:25], v[24:25], v[104:105], v[144:145]
    v_pk_fma_f32 v[26:27], v[26:27], v[106:107], v[146:147]
    v_pk_fma_f32 v[28:29], v[28:29], v[108:109], v[148:149]
    v_pk_fma_f32 v[30:31], v[30:31], v[110:111], v[150:151]
    v_pk_fma_f32 v[32:33], v[32:33], v[112:113], v[152:153]
    v_pk_fma_f32 v[34:35], v[34:35], v[114:115], v[154:155]
    v_cvt_pk_bf16_f32 v16, v16, v17
    v_cvt_pk_bf16_f32 v17, v18, v19
    v_cvt_pk_bf16_f32 v18, v20, v21
    v_cvt_pk_bf16_f32 v19, v22, v23
    v_cvt_pk_bf16_f32 v24, v24, v25
    v_cvt_pk_bf16_f32 v25, v26, v27
    v_cvt_pk_bf16_f32 v26, v28, v29
    v_cvt_pk_bf16_f32 v27, v30, v31
    v_cvt_pk_bf16_f32 v32, v32, v33
    v_cvt_pk_bf16_f32 v33, v34, v35
    s_nop 1
    v_permlane16_swap_b32 v16, v18
    v_permlane16_swap_b32 v17, v19
    v_permlane16_swap_b32 v24, v26
    v_permlane16_swap_b32 v25, v27
    v_and_b32 v9, 1, v3
    v_lshlrev_b32 v9, 5, v9
    v_lshrrev_b32 v11, 1, v3
    v_lshl_add_u32 v9, v11, 4, v9
    v_lshlrev_b32 v11, 3, v3
    v_sub_u32 v11, v10, v11
    v_add_u32 v11, v11, v9
    buffer_store_dwordx4 v[16:19], v11, s[24:27], s47 offen offset:0 sc1
    buffer_store_dwordx4 v[24:27], v11, s[24:27], s47 offen offset:64 sc1
    buffer_store_dwordx2 v[32:33], v10, s[24:27], s47 offen offset:128 sc1
    s_waitcnt vmcnt(0) lgkmcnt(0)
    s_endpgm
k2_end:
    s_endpgm
CODE_END:
    s_endpgm
.section .rodata,"a"
.p2align 6
.amdhsa_kernel k1_kernel
  .amdhsa_next_free_vgpr 256
  .amdhsa_next_free_sgpr 72
  .amdhsa_accum_offset 256
  .amdhsa_group_segment_fixed_size 0
  .amdhsa_kernarg_size 128
  .amdhsa_user_sgpr_count 2
  .amdhsa_user_sgpr_kernarg_segment_ptr 1
  .amdhsa_system_sgpr_workgroup_id_x 1
  .amdhsa_float_denorm_mode_32 3
.end_amdhsa_kernel
.p2align 6
.amdhsa_kernel k2_kernel
  .amdhsa_next_free_vgpr 512
  .amdhsa_next_free_sgpr 102
  .amdhsa_accum_offset 256
  .amdhsa_group_segment_fixed_size 0
  .amdhsa_kernarg_size 128
  .amdhsa_user_sgpr_count 2
  .amdhsa_user_sgpr_kernarg_segment_ptr 1
  .amdhsa_system_sgpr_workgroup_id_x 1
  .amdhsa_float_denorm_mode_32 3
.end_amdhsa_kernel
```

```asm
; @launch kernel=k1_kernel grid=(352,1,1) block=(256,1,1) lds=48128
; @launch kernel=k2_kernel grid=(256,1,1) block=(256,1,1) lds=163840
.amdgcn_target "amdgcn-amd-amdhsa--gfx950"
.text
.globl k1_kernel
.p2align 8
.type k1_kernel,@function
k1_kernel:
    s_cmp_ge_u32 s2, 352
    s_cbranch_scc1 k1_end
    s_load_dwordx4 s[4:7], s[0:1], 32
    s_load_dwordx2 s[10:11], s[0:1], 120
    s_load_dwordx4 s[12:15], s[0:1], 8
    s_load_dwordx2 s[8:9], s[0:1], 24
    v_lshrrev_b32 v2, 6, v0
    v_and_b32 v1, 63, v0
    v_readfirstlane_b32 s20, v2
    s_sub_u32 s54, s2, 160
    s_cmp_ge_u32 s2, 256
    s_cbranch_scc1 k1_side
    s_and_b32 s55, s2, 7
    s_lshr_b32 s56, s2, 3
    s_lshl_b32 s57, s55, 9
    s_add_u32 s57, s57, 9056256
    v_mov_b32 v250, 0
    s_waitcnt lgkmcnt(0)
    s_mov_b32 s28, s10
    s_mov_b32 s29, s11
    s_mov_b32 s30, 268435456
    s_mov_b32 s31, 0x00020000
    buffer_load_dword v251, v250, s[28:31], s57 offen sc1
    s_mov_b32 s16, s12
    s_mov_b32 s17, s13
    s_mov_b32 s18, 2621440
    s_mov_b32 s19, 0x00020000
    s_mov_b32 s40, s14
    s_mov_b32 s41, s15
    s_mov_b32 s42, 2621440
    s_mov_b32 s43, 0x00020000
    s_mov_b32 s44, s8
    s_mov_b32 s45, s9
    s_mov_b32 s46, 5120
    s_mov_b32 s47, 0x00020000
    v_mul_u32_u24 v4, 3277, v0
    v_lshrrev_b32 v4, 16, v4
    v_mul_u32_u24 v5, 20, v4
    v_sub_u32 v5, v0, v5
    s_lshl_b32 s21, s56, 6
    v_lshl_add_u32 v6, v4, 3, s21
    v_mul_u32_u24 v6, 1280, v6
    s_mul_i32 s22, s55, 160
    v_lshl_add_u32 v7, v5, 3, s22
    v_add_u32 v6, v6, v7
    v_subrev_u32 v8, 3840, v6
    v_add_u32 v9, 5120, v6
    s_movk_i32 s23, 160
    v_cmp_gt_u32 vcc, s23, v0
    s_and_saveexec_b64 s[60:61], vcc
    s_cbranch_execz k1_kvld
    buffer_load_dwordx2 v[10:11], v8, s[16:19], 0 offen offset:0
    buffer_load_dwordx2 v[12:13], v8, s[16:19], 0 offen offset:1280
    buffer_load_dwordx2 v[14:15], v8, s[16:19], 0 offen offset:2560
    buffer_load_dwordx2 v[16:17], v6, s[16:19], 0 offen offset:0
    buffer_load_dwordx2 v[18:19], v6, s[16:19], 0 offen offset:1280
    buffer_load_dwordx2 v[20:21], v6, s[16:19], 0 offen offset:2560
    buffer_load_dwordx2 v[22:23], v6, s[16:19], 0 offen offset:3840
    buffer_load_dwordx2 v[24:25], v9, s[16:19], 0 offen offset:0
    buffer_load_dwordx2 v[26:27], v9, s[16:19], 0 offen offset:1280
    buffer_load_dwordx2 v[28:29], v9, s[16:19], 0 offen offset:2560
    buffer_load_dwordx2 v[30:31], v9, s[16:19], 0 offen offset:3840
    v_lshlrev_b32 v150, 2, v7
    buffer_load_dwordx4 v[48:51], v150, s[44:47], 0 offen
    buffer_load_dwordx4 v[52:55], v150, s[44:47], 0 offen offset:16
    buffer_load_dwordx2 v[32:33], v6, s[40:43], 0 offen offset:0
    buffer_load_dwordx2 v[34:35], v6, s[40:43], 0 offen offset:1280
    buffer_load_dwordx2 v[36:37], v6, s[40:43], 0 offen offset:2560
    buffer_load_dwordx2 v[38:39], v6, s[40:43], 0 offen offset:3840
    buffer_load_dwordx2 v[40:41], v9, s[40:43], 0 offen offset:0
    buffer_load_dwordx2 v[42:43], v9, s[40:43], 0 offen offset:1280
    buffer_load_dwordx2 v[44:45], v9, s[40:43], 0 offen offset:2560
    buffer_load_dwordx2 v[46:47], v9, s[40:43], 0 offen offset:3840
k1_kvld:
    s_mov_b64 exec, -1
    s_mov_b32 s24, s4
    s_mov_b32 s25, s5
    s_mov_b32 s26, 2621440
    s_mov_b32 s27, 0x00020000
    s_cmp_lt_u32 s56, 12
    s_cbranch_scc1 k1_kernel_nc1
    s_mul_i32 s58, s55, 20
    s_add_u32 s58, s58, s56
    s_sub_u32 s58, s58, 12
    s_lshl_b32 s21, s58, 2
    s_add_u32 s21, s21, s20
    s_mul_i32 s34, s20, 9472
    v_lshlrev_b32 v3, 4, v1
    s_lshl_b32 s35, s21, 12
    s_add_u32 s36, s34, 256
    s_mov_b32 m0, s36
    s_nop 0
    buffer_load_dwordx4 v3, s[24:27], s35 offen offset:0 lds
    buffer_load_dwordx4 v3, s[24:27], s35 offen offset:1024 lds
    buffer_load_dwordx4 v3, s[24:27], s35 offen offset:2048 lds
    buffer_load_dwordx4 v3, s[24:27], s35 offen offset:3072 lds
k1_kernel_nc1:
    s_mov_b64 exec, s[60:61]
    s_movk_i32 s23, 160
    v_cmp_gt_u32 vcc, s23, v0
    s_and_b64 exec, exec, vcc
    s_cbranch_execz k1_kvskip
    v_sub_u32 v150, 7, v4
    v_and_b32 v151, 7, v5
    v_xor_b32 v150, v150, v151
    v_lshlrev_b32 v150, 4, v150
    v_lshl_add_u32 v150, v5, 9, v150
    v_add_u32 v150, 37888, v150
    s_cmp_lt_u32 s56, 12
    s_cbranch_scc1 k1_w8
    s_waitcnt vmcnt(12)
    s_branch k1_w9
k1_w8:
    s_waitcnt vmcnt(8)
k1_w9:
    v_lshlrev_b32 v56, 16, v48
    v_and_b32 v60, 0xffff0000, v48
    v_lshlrev_b32 v64, 16, v49
    v_and_b32 v68, 0xffff0000, v49
    v_lshlrev_b32 v57, 16, v50
    v_and_b32 v61, 0xffff0000, v50
    v_lshlrev_b32 v65, 16, v51
    v_and_b32 v69, 0xffff0000, v51
    v_lshlrev_b32 v58, 16, v52
    v_and_b32 v62, 0xffff0000, v52
    v_lshlrev_b32 v66, 16, v53
    v_and_b32 v70, 0xffff0000, v53
    v_lshlrev_b32 v59, 16, v54
    v_and_b32 v63, 0xffff0000, v54
    v_lshlrev_b32 v67, 16, v55
    v_and_b32 v71, 0xffff0000, v55
    v_lshlrev_b32 v72, 16, v10
    v_and_b32 v73, 0xffff0000, v10
    v_lshlrev_b32 v74, 16, v11
    v_and_b32 v75, 0xffff0000, v11
    v_lshlrev_b32 v76, 16, v12
    v_and_b32 v77, 0xffff0000, v12
    v_lshlrev_b32 v78, 16, v13
    v_and_b32 v79, 0xffff0000, v13
    v_lshlrev_b32 v80, 16, v14
    v_and_b32 v81, 0xffff0000, v14
    v_lshlrev_b32 v82, 16, v15
    v_and_b32 v83, 0xffff0000, v15
    v_lshlrev_b32 v84, 16, v16
    v_and_b32 v85, 0xffff0000, v16
    v_lshlrev_b32 v86, 16, v17
    v_and_b32 v87, 0xffff0000, v17
    v_lshlrev_b32 v88, 16, v18
    v_and_b32 v89, 0xffff0000, v18
    v_lshlrev_b32 v90, 16, v19
    v_and_b32 v91, 0xffff0000, v19
    v_lshlrev_b32 v92, 16, v20
    v_and_b32 v93, 0xffff0000, v20
    v_lshlrev_b32 v94, 16, v21
    v_and_b32 v95, 0xffff0000, v21
    v_lshlrev_b32 v96, 16, v22
    v_and_b32 v97, 0xffff0000, v22
    v_lshlrev_b32 v98, 16, v23
    v_and_b32 v99, 0xffff0000, v23
    v_lshlrev_b32 v100, 16, v24
    v_and_b32 v101, 0xffff0000, v24
    v_lshlrev_b32 v102, 16, v25
    v_and_b32 v103, 0xffff0000, v25
    v_lshlrev_b32 v104, 16, v26
    v_and_b32 v105, 0xffff0000, v26
    v_lshlrev_b32 v106, 16, v27
    v_and_b32 v107, 0xffff0000, v27
    v_lshlrev_b32 v108, 16, v28
    v_and_b32 v109, 0xffff0000, v28
    v_lshlrev_b32 v110, 16, v29
    v_and_b32 v111, 0xffff0000, v29
    v_lshlrev_b32 v112, 16, v30
    v_and_b32 v113, 0xffff0000, v30
    v_lshlrev_b32 v114, 16, v31
    v_and_b32 v115, 0xffff0000, v31
    v_pk_mul_f32 v[116:117], v[72:73], v[68:69]
    v_pk_mul_f32 v[120:121], v[76:77], v[68:69]
    v_pk_mul_f32 v[124:125], v[80:81], v[68:69]
    v_pk_mul_f32 v[128:129], v[84:85], v[68:69]
    v_pk_mul_f32 v[132:133], v[88:89], v[68:69]
    v_pk_mul_f32 v[136:137], v[92:93], v[68:69]
    v_pk_mul_f32 v[140:141], v[96:97], v[68:69]
    v_pk_mul_f32 v[144:145], v[100:101], v[68:69]
    v_pk_fma_f32 v[116:117], v[76:77], v[64:65], v[116:117]
    v_pk_fma_f32 v[120:121], v[80:81], v[64:65], v[120:121]
    v_pk_fma_f32 v[124:125], v[84:85], v[64:65], v[124:125]
    v_pk_fma_f32 v[128:129], v[88:89], v[64:65], v[128:129]
    v_pk_fma_f32 v[132:133], v[92:93], v[64:65], v[132:133]
    v_pk_fma_f32 v[136:137], v[96:97], v[64:65], v[136:137]
    v_pk_fma_f32 v[140:141], v[100:101], v[64:65], v[140:141]
    v_pk_fma_f32 v[144:145], v[104:105], v[64:65], v[144:145]
    v_pk_fma_f32 v[116:117], v[80:81], v[60:61], v[116:117]
    v_pk_fma_f32 v[120:121], v[84:85], v[60:61], v[120:121]
    v_pk_fma_f32 v[124:125], v[88:89], v[60:61], v[124:125]
    v_pk_fma_f32 v[128:129], v[92:93], v[60:61], v[128:129]
    v_pk_fma_f32 v[132:133], v[96:97], v[60:61], v[132:133]
    v_pk_fma_f32 v[136:137], v[100:101], v[60:61], v[136:137]
    v_pk_fma_f32 v[140:141], v[104:105], v[60:61], v[140:141]
    v_pk_fma_f32 v[144:145], v[108:109], v[60:61], v[144:145]
    v_pk_fma_f32 v[116:117], v[84:85], v[56:57], v[116:117]
    v_pk_fma_f32 v[120:121], v[88:89], v[56:57], v[120:121]
    v_pk_fma_f32 v[124:125], v[92:93], v[56:57], v[124:125]
    v_pk_fma_f32 v[128:129], v[96:97], v[56:57], v[128:129]
    v_pk_fma_f32 v[132:133], v[100:101], v[56:57], v[132:133]
    v_pk_fma_f32 v[136:137], v[104:105], v[56:57], v[136:137]
    v_pk_fma_f32 v[140:141], v[108:109], v[56:57], v[140:141]
    v_pk_fma_f32 v[144:145], v[112:113], v[56:57], v[144:145]
    v_pk_mul_f32 v[118:119], v[74:75], v[70:71]
    v_pk_mul_f32 v[122:123], v[78:79], v[70:71]
    v_pk_mul_f32 v[126:127], v[82:83], v[70:71]
    v_pk_mul_f32 v[130:131], v[86:87], v[70:71]
    v_pk_mul_f32 v[134:135], v[90:91], v[70:71]
    v_pk_mul_f32 v[138:139], v[94:95], v[70:71]
    v_pk_mul_f32 v[142:143], v[98:99], v[70:71]
    v_pk_mul_f32 v[146:147], v[102:103], v[70:71]
    v_pk_fma_f32 v[118:119], v[78:79], v[66:67], v[118:119]
    v_pk_fma_f32 v[122:123], v[82:83], v[66:67], v[122:123]
    v_pk_fma_f32 v[126:127], v[86:87], v[66:67], v[126:127]
    v_pk_fma_f32 v[130:131], v[90:91], v[66:67], v[130:131]
    v_pk_fma_f32 v[134:135], v[94:95], v[66:67], v[134:135]
    v_pk_fma_f32 v[138:139], v[98:99], v[66:67], v[138:139]
    v_pk_fma_f32 v[142:143], v[102:103], v[66:67], v[142:143]
    v_pk_fma_f32 v[146:147], v[106:107], v[66:67], v[146:147]
    v_pk_fma_f32 v[118:119], v[82:83], v[62:63], v[118:119]
    v_pk_fma_f32 v[122:123], v[86:87], v[62:63], v[122:123]
    v_pk_fma_f32 v[126:127], v[90:91], v[62:63], v[126:127]
    v_pk_fma_f32 v[130:131], v[94:95], v[62:63], v[130:131]
    v_pk_fma_f32 v[134:135], v[98:99], v[62:63], v[134:135]
    v_pk_fma_f32 v[138:139], v[102:103], v[62:63], v[138:139]
    v_pk_fma_f32 v[142:143], v[106:107], v[62:63], v[142:143]
    v_pk_fma_f32 v[146:147], v[110:111], v[62:63], v[146:147]
    v_pk_fma_f32 v[118:119], v[86:87], v[58:59], v[118:119]
    v_pk_fma_f32 v[122:123], v[90:91], v[58:59], v[122:123]
    v_pk_fma_f32 v[126:127], v[94:95], v[58:59], v[126:127]
    v_pk_fma_f32 v[130:131], v[98:99], v[58:59], v[130:131]
    v_pk_fma_f32 v[134:135], v[102:103], v[58:59], v[134:135]
    v_pk_fma_f32 v[138:139], v[106:107], v[58:59], v[138:139]
    v_pk_fma_f32 v[142:143], v[110:111], v[58:59], v[142:143]
    v_pk_fma_f32 v[146:147], v[114:115], v[58:59], v[146:147]
    v_cvt_pk_bf16_f32 v154, v116, v117
    v_lshlrev_b32 v116, 16, v154
    v_and_b32 v117, 0xffff0000, v154
    v_cvt_pk_bf16_f32 v155, v118, v119
    v_lshlrev_b32 v118, 16, v155
    v_and_b32 v119, 0xffff0000, v155
    v_cvt_pk_bf16_f32 v156, v120, v121
    v_lshlrev_b32 v120, 16, v156
    v_and_b32 v121, 0xffff0000, v156
    v_cvt_pk_bf16_f32 v157, v122, v123
    v_lshlrev_b32 v122, 16, v157
    v_and_b32 v123, 0xffff0000, v157
    v_cvt_pk_bf16_f32 v158, v124, v125
    v_lshlrev_b32 v124, 16, v158
    v_and_b32 v125, 0xffff0000, v158
    v_cvt_pk_bf16_f32 v159, v126, v127
    v_lshlrev_b32 v126, 16, v159
    v_and_b32 v127, 0xffff0000, v159
    v_cvt_pk_bf16_f32 v160, v128, v129
    v_lshlrev_b32 v128, 16, v160
    v_and_b32 v129, 0xffff0000, v160
    v_cvt_pk_bf16_f32 v161, v130, v131
    v_lshlrev_b32 v130, 16, v161
    v_and_b32 v131, 0xffff0000, v161
    v_cvt_pk_bf16_f32 v154, v132, v133
    v_lshlrev_b32 v132, 16, v154
    v_and_b32 v133, 0xffff0000, v154
    v_cvt_pk_bf16_f32 v155, v134, v135
    v_lshlrev_b32 v134, 16, v155
    v_and_b32 v135, 0xffff0000, v155
    v_cvt_pk_bf16_f32 v156, v136, v137
    v_lshlrev_b32 v136, 16, v156
    v_and_b32 v137, 0xffff0000, v156
    v_cvt_pk_bf16_f32 v157, v138, v139
    v_lshlrev_b32 v138, 16, v157
    v_and_b32 v139, 0xffff0000, v157
    v_cvt_pk_bf16_f32 v158, v140, v141
    v_lshlrev_b32 v140, 16, v158
    v_and_b32 v141, 0xffff0000, v158
    v_cvt_pk_bf16_f32 v159, v142, v143
    v_lshlrev_b32 v142, 16, v159
    v_and_b32 v143, 0xffff0000, v159
    v_cvt_pk_bf16_f32 v160, v144, v145
    v_lshlrev_b32 v144, 16, v160
    v_and_b32 v145, 0xffff0000, v160
    v_cvt_pk_bf16_f32 v161, v146, v147
    v_lshlrev_b32 v146, 16, v161
    v_and_b32 v147, 0xffff0000, v161
    s_cmp_lt_u32 s56, 12
    s_cbranch_scc1 k1_w0
    s_waitcnt vmcnt(4)
    s_branch k1_w1
k1_w0:
    s_waitcnt vmcnt(0)
k1_w1:
    v_lshlrev_b32 v72, 16, v32
    v_and_b32 v73, 0xffff0000, v32
    v_lshlrev_b32 v74, 16, v33
    v_and_b32 v75, 0xffff0000, v33
    v_lshlrev_b32 v76, 16, v34
    v_and_b32 v77, 0xffff0000, v34
    v_lshlrev_b32 v78, 16, v35
    v_and_b32 v79, 0xffff0000, v35
    v_lshlrev_b32 v80, 16, v36
    v_and_b32 v81, 0xffff0000, v36
    v_lshlrev_b32 v82, 16, v37
    v_and_b32 v83, 0xffff0000, v37
    v_lshlrev_b32 v84, 16, v38
    v_and_b32 v85, 0xffff0000, v38
    v_lshlrev_b32 v86, 16, v39
    v_and_b32 v87, 0xffff0000, v39
    v_lshlrev_b32 v88, 16, v40
    v_and_b32 v89, 0xffff0000, v40
    v_lshlrev_b32 v90, 16, v41
    v_and_b32 v91, 0xffff0000, v41
    v_lshlrev_b32 v92, 16, v42
    v_and_b32 v93, 0xffff0000, v42
    v_lshlrev_b32 v94, 16, v43
    v_and_b32 v95, 0xffff0000, v43
    v_lshlrev_b32 v96, 16, v44
    v_and_b32 v97, 0xffff0000, v44
    v_lshlrev_b32 v98, 16, v45
    v_and_b32 v99, 0xffff0000, v45
    v_lshlrev_b32 v100, 16, v46
    v_and_b32 v101, 0xffff0000, v46
    v_lshlrev_b32 v102, 16, v47
    v_and_b32 v103, 0xffff0000, v47
    v_pk_mul_f32 v[116:117], v[116:117], v[72:73]
    v_pk_mul_f32 v[118:119], v[118:119], v[74:75]
    v_pk_mul_f32 v[120:121], v[120:121], v[76:77]
    v_pk_mul_f32 v[122:123], v[122:123], v[78:79]
    v_pk_mul_f32 v[124:125], v[124:125], v[80:81]
    v_pk_mul_f32 v[126:127], v[126:127], v[82:83]
    v_pk_mul_f32 v[128:129], v[128:129], v[84:85]
    v_pk_mul_f32 v[130:131], v[130:131], v[86:87]
    v_pk_mul_f32 v[132:133], v[132:133], v[88:89]
    v_pk_mul_f32 v[134:135], v[134:135], v[90:91]
    v_pk_mul_f32 v[136:137], v[136:137], v[92:93]
    v_pk_mul_f32 v[138:139], v[138:139], v[94:95]
    v_pk_mul_f32 v[140:141], v[140:141], v[96:97]
    v_pk_mul_f32 v[142:143], v[142:143], v[98:99]
    v_pk_mul_f32 v[144:145], v[144:145], v[100:101]
    v_pk_mul_f32 v[146:147], v[146:147], v[102:103]
    v_cvt_pk_bf16_f32 v10, v144, v140
    v_cvt_pk_bf16_f32 v11, v136, v132
    v_cvt_pk_bf16_f32 v12, v128, v124
    v_cvt_pk_bf16_f32 v13, v120, v116
    v_cvt_pk_bf16_f32 v14, v145, v141
    v_cvt_pk_bf16_f32 v15, v137, v133
    v_cvt_pk_bf16_f32 v16, v129, v125
    v_cvt_pk_bf16_f32 v17, v121, v117
    v_cvt_pk_bf16_f32 v18, v146, v142
    v_cvt_pk_bf16_f32 v19, v138, v134
    v_cvt_pk_bf16_f32 v20, v130, v126
    v_cvt_pk_bf16_f32 v21, v122, v118
    v_cvt_pk_bf16_f32 v22, v147, v143
    v_cvt_pk_bf16_f32 v23, v139, v135
    v_cvt_pk_bf16_f32 v24, v131, v127
    v_cvt_pk_bf16_f32 v25, v123, v119
    ds_write_b128 v150, v[10:13] offset:0
    ds_write_b128 v150, v[14:17] offset:128
    ds_write_b128 v150, v[18:21] offset:256
    ds_write_b128 v150, v[22:25] offset:384
k1_kvskip:
    s_mov_b64 exec, -1
    v_lshrrev_b32 v151, 3, v0
    v_and_b32 v152, 7, v0
    v_lshrrev_b32 v153, 2, v151
    v_and_b32 v153, 7, v153
    v_xor_b32 v153, v153, v152
    v_lshlrev_b32 v153, 4, v153
    v_lshl_add_u32 v153, v151, 7, v153
    v_add_u32 v153, 37888, v153
    v_mul_u32_u24 v151, 4224, v151
    v_lshl_add_u32 v154, v152, 4, v151
    s_mul_i32 s36, s55, 337920
    s_add_u32 s36, s36, 0
    s_lshl_b32 s37, s56, 7
    s_sub_u32 s38, 3968, s37
    s_add_u32 s38, s38, s36
    s_waitcnt lgkmcnt(0)
    s_barrier
    ds_read_b128 v[32:35], v153 offset:0
    ds_read_b128 v[36:39], v153 offset:4096
    ds_read_b128 v[40:43], v153 offset:8192
    s_waitcnt lgkmcnt(2)
    buffer_store_dwordx4 v[32:35], v154, s[28:31], s38 offen sc1
    s_add_u32 s38, s38, 135168
    s_waitcnt lgkmcnt(1)
    buffer_store_dwordx4 v[36:39], v154, s[28:31], s38 offen sc1
    s_add_u32 s38, s38, 135168
    s_movk_i32 s23, 128
    v_cmp_gt_u32 vcc, s23, v0
    s_and_saveexec_b64 s[60:61], vcc
    s_cbranch_execz k1_st2skip
    s_waitcnt lgkmcnt(0)
    buffer_store_dwordx4 v[40:43], v154, s[28:31], s38 offen sc1
    s_add_u32 s38, s38, 135168
k1_st2skip:
    s_mov_b64 exec, -1
    s_cmp_lg_u32 s56, 0
    s_cbranch_scc1 k1_kernel_L2
    v_mov_b32 v44, 0
    v_mov_b32 v45, 0
    v_mov_b32 v46, 0
    v_mov_b32 v47, 0
    s_add_u32 s36, s36, 4096
    buffer_store_dwordx4 v[44:47], v154, s[28:31], s36 offen sc1
    s_add_u32 s36, s36, 135168
    buffer_store_dwordx4 v[44:47], v154, s[28:31], s36 offen sc1
    s_add_u32 s36, s36, 135168
    s_movk_i32 s23, 128
    v_cmp_gt_u32 vcc, s23, v0
    s_and_b64 exec, exec, vcc
    s_cbranch_execz k1_kernel_L2
    buffer_store_dwordx4 v[44:47], v154, s[28:31], s36 offen sc1
    s_add_u32 s36, s36, 135168
k1_kernel_L2:
    s_mov_b64 exec, -1
    s_waitcnt vmcnt(0)
    v_add_u32 v251, 1, v251
    s_barrier
    s_cmp_lg_u32 s20, 0
    s_cbranch_scc1 k1_kernel_kf3
    s_lshl_b32 s23, s56, 2
    s_add_u32 s23, s23, s57
    s_mov_b64 exec, 1
    buffer_store_dword v251, v250, s[28:31], s23 offen offset:256
    buffer_store_dword v251, v250, s[28:31], s23 offen offset:128 sc1
    s_mov_b64 exec, -1
k1_kernel_kf3:
    s_lshl_b32 s54, s56, 3
    s_add_u32 s54, s54, s55
    s_cmp_lt_u32 s56, 12
    s_cbranch_scc1 k1_side2
    s_mov_b32 s2, s58
    s_setprio 3
    s_lshl_b32 s21, s2, 3
    s_add_u32 s22, s6, s21
    s_addc_u32 s23, s7, 0
    s_load_dwordx2 s[32:33], s[22:23], 0
    s_lshl_b32 s21, s2, 2
    s_add_u32 s21, s21, s20
    s_mul_i32 s34, s20, 9472
    v_lshlrev_b32 v3, 4, v1
    s_mul_i32 s37, s21, 4224
    s_add_u32 s37, s37, 0
    v_lshrrev_b32 v4, 3, v0
    v_mul_u32_u24 v4, 20480, v4
    s_lshr_b32 s38, s2, 1
    s_and_b32 s38, s38, 7
    v_and_b32 v5, 7, v0
    v_xor_b32 v5, s38, v5
    v_lshl_add_u32 v4, v5, 4, v4
    s_lshl_b32 s38, s2, 7
    v_add_u32 v20, 0, v1
    v_mul_u32_u24 v21, 3856, v20
    v_lshrrev_b32 v21, 16, v21
    v_mul_u32_u24 v22, 17, v21
    v_sub_u32 v22, v20, v22
    v_lshlrev_b32 v22, 4, v22
    v_lshlrev_b32 v21, 8, v21
    v_sub_u32 v22, v22, v21
    v_add_u32 v23, 3840, v22
    v_add_u32 v20, 64, v1
    v_mul_u32_u24 v21, 3856, v20
    v_lshrrev_b32 v21, 16, v21
    v_mul_u32_u24 v22, 17, v21
    v_sub_u32 v22, v20, v22
    v_lshlrev_b32 v22, 4, v22
    v_lshlrev_b32 v21, 8, v21
    v_sub_u32 v22, v22, v21
    v_add_u32 v24, 3840, v22
    v_add_u32 v20, 128, v1
    v_mul_u32_u24 v21, 3856, v20
    v_lshrrev_b32 v21, 16, v21
    v_mul_u32_u24 v22, 17, v21
    v_sub_u32 v22, v20, v22
    v_lshlrev_b32 v22, 4, v22
    v_lshlrev_b32 v21, 8, v21
    v_sub_u32 v22, v22, v21
    v_add_u32 v25, 3840, v22
    v_add_u32 v20, 192, v1
    v_mul_u32_u24 v21, 3856, v20
    v_lshrrev_b32 v21, 16, v21
    v_mul_u32_u24 v22, 17, v21
    v_sub_u32 v22, v20, v22
    v_lshlrev_b32 v22, 4, v22
    v_lshlrev_b32 v21, 8, v21
    v_sub_u32 v22, v22, v21
    v_add_u32 v26, 3840, v22
    v_add_u32 v20, 256, v1
    v_mul_u32_u24 v21, 3856, v20
    v_lshrrev_b32 v21, 16, v21
    v_mul_u32_u24 v22, 17, v21
    v_sub_u32 v22, v20, v22
    v_lshlrev_b32 v22, 4, v22
    v_lshlrev_b32 v21, 8, v21
    v_sub_u32 v22, v22, v21
    v_add_u32 v27, 3840, v22
    v_lshl_add_u32 v5, v1, 2, s34
    v_mov_b32 v6, 0
    ds_write_b32 v5, v6
    v_and_b32 v7, 15, v1
    v_bfe_u32 v8, v1, 4, 1
    v_lshrrev_b32 v9, 5, v1
    v_mul_u32_u24 v10, 272, v7
    v_lshl_add_u32 v10, v9, 4, v10
    v_add_u32 v10, s34, v10
    v_add_u32 v10, 4356, v10
    v_lshlrev_b32 v11, 2, v8
    v_sub_u32 v10, v10, v11
    v_and_b32 v12, 7, v1
    v_mul_u32_u24 v13, 272, v12
    v_lshl_add_u32 v13, v9, 4, v13
    v_add_u32 v13, s34, v13
    v_add_u32 v13, 4356, v13
    v_sub_u32 v13, v13, v11
    v_bfe_u32 v11, v1, 3, 1
    v_lshlrev_b32 v11, 4, v11
    v_sub_u32 v11, 16, v11
    v_and_b32 v14, 31, v1
    v_lshlrev_b32 v14, 3, v14
    v_lshl_add_u32 v14, v9, 4, v14
    v_add_u32 v14, s34, v14
    v_add_u32 v14, 8, v14
    v_cmp_ne_u32 vcc, 0, v12
    v_mov_b32 v16, 0
    s_nop 1
    v_cndmask_b32 v15, v16, -1, vcc
    s_waitcnt lgkmcnt(0)
    ds_read_b64 v[176:177], v14 offset:1792
    ds_read_b64 v[178:179], v14 offset:1800
    ds_read_b64 v[180:181], v14 offset:1824
    ds_read_b64 v[182:183], v14 offset:1832
    ds_read_b64 v[184:185], v14 offset:1856
    ds_read_b64 v[186:187], v14 offset:1864
    ds_read_b64 v[188:189], v14 offset:1888
    ds_read_b64 v[190:191], v14 offset:1896
    ds_read_b64 v[192:193], v14 offset:1920
    ds_read_b64 v[194:195], v14 offset:1928
    ds_read_b64 v[196:197], v14 offset:1952
    ds_read_b64 v[198:199], v14 offset:1960
    ds_read_b64 v[200:201], v14 offset:1984
    ds_read_b64 v[202:203], v14 offset:1992
    ds_read_b64 v[204:205], v14 offset:2016
    ds_read_b64 v[206:207], v14 offset:2024
    s_cmp_lg_u32 s20, 0
    s_cbranch_scc1 k1_kernel_kw4
    v_and_b32 v40, 31, v1
    v_lshlrev_b32 v40, 2, v40
    s_mov_b32 s23, 200000
    s_mov_b64 s[60:61], 0
k1_kernel_kp5:
    buffer_load_dword v41, v40, s[28:31], s57 offen offset:256 sc1
    s_waitcnt vmcnt(0)
    v_cmp_eq_u32 vcc, v251, v41
    s_sub_u32 s23, s23, 1
    s_or_b64 s[60:61], s[60:61], vcc
    s_cmp_eq_u64 s[60:61], -1
    s_cbranch_scc1 k1_kernel_kd6
    s_and_b32 s21, s23, 3
    s_cmp_lg_u32 s21, 0
    s_cbranch_scc1 k1_kernel_kq8
    buffer_load_dword v41, v40, s[28:31], s57 offen offset:128 sc1
    s_waitcnt vmcnt(0)
    v_cmp_eq_u32 vcc, v251, v41
    s_nop 1
    s_or_b64 s[60:61], s[60:61], vcc
    s_cmp_eq_u64 s[60:61], -1
    s_cbranch_scc1 k1_kernel_kd6
k1_kernel_kq8:
    s_sleep 2
    s_cmp_lg_u32 s23, 0
    s_cbranch_scc1 k1_kernel_kp5
k1_kernel_kd6:
    s_cmp_lg_u32 s56, 12
    s_cbranch_scc1 k1_kernel_kw4
    s_mov_b64 exec, 1
    buffer_store_dword v251, v250, s[28:31], s57 offen sc1
    s_mov_b64 exec, -1
k1_kernel_kw4:
    s_barrier
    s_add_u32 s36, s34, 4352
    s_mov_b32 m0, s36
    s_nop 0
    buffer_load_dwordx4 v23, s[28:31], s37 offen sc1 lds
    s_add_u32 s36, s34, 5376
    s_mov_b32 m0, s36
    s_nop 0
    buffer_load_dwordx4 v24, s[28:31], s37 offen sc1 lds
    s_add_u32 s36, s34, 6400
    s_mov_b32 m0, s36
    s_nop 0
    buffer_load_dwordx4 v25, s[28:31], s37 offen sc1 lds
    s_add_u32 s36, s34, 7424
    s_mov_b32 m0, s36
    s_nop 0
    buffer_load_dwordx4 v26, s[28:31], s37 offen sc1 lds
    s_add_u32 s36, s34, 8448
    s_mov_b32 m0, s36
    s_mov_b64 exec, 0xffff
    buffer_load_dwordx4 v27, s[28:31], s37 offen sc1 lds
    s_mov_b64 exec, -1
    s_waitcnt vmcnt(0) lgkmcnt(0)
    ds_read2_b32 v[64:65], v10 offset0:0 offset1:1
    ds_read2_b32 v[66:67], v10 offset0:2 offset1:3
    ds_read2_b32 v[68:69], v10 offset0:8 offset1:9
    ds_read2_b32 v[70:71], v10 offset0:10 offset1:11
    ds_read2_b32 v[72:73], v10 offset0:16 offset1:17
    ds_read2_b32 v[74:75], v10 offset0:18 offset1:19
    ds_read2_b32 v[76:77], v10 offset0:24 offset1:25
    ds_read2_b32 v[78:79], v10 offset0:26 offset1:27
    ds_read2_b32 v[80:81], v10 offset0:32 offset1:33
    ds_read2_b32 v[82:83], v10 offset0:34 offset1:35
    ds_read2_b32 v[84:85], v10 offset0:40 offset1:41
    ds_read2_b32 v[86:87], v10 offset0:42 offset1:43
    ds_read2_b32 v[88:89], v10 offset0:48 offset1:49
    ds_read2_b32 v[90:91], v10 offset0:50 offset1:51
    ds_read2_b32 v[92:93], v10 offset0:56 offset1:57
    ds_read2_b32 v[94:95], v10 offset0:58 offset1:59
    s_waitcnt lgkmcnt(0)
    v_mfma_f32_32x32x16_bf16 v[144:159], v[176:179], v[64:67], 0
    ds_read_b32 v16, v10 offset:16
    ds_read_b32 v17, v10 offset:48
    ds_read_b32 v18, v10 offset:80
    ds_read_b32 v19, v10 offset:112
    ds_read_b32 v20, v10 offset:144
    ds_read_b32 v21, v10 offset:176
    ds_read_b32 v22, v10 offset:208
    ds_read_b32 v23, v10 offset:240
    ds_read2_b32 v[96:97], v13 offset0:0 offset1:1
    ds_read2_b32 v[98:99], v13 offset0:2 offset1:3
    ds_read_b32 v24, v13 offset:16
    ds_read2_b32 v[100:101], v13 offset0:8 offset1:9
    ds_read2_b32 v[102:103], v13 offset0:10 offset1:11
    ds_read_b32 v25, v13 offset:48
    ds_read2_b32 v[104:105], v13 offset0:16 offset1:17
    ds_read2_b32 v[106:107], v13 offset0:18 offset1:19
    v_mfma_f32_32x32x16_bf16 v[144:159], v[180:183], v[68:71], v[144:159]
    ds_read_b32 v26, v13 offset:80
    ds_read2_b32 v[108:109], v13 offset0:24 offset1:25
    ds_read2_b32 v[110:111], v13 offset0:26 offset1:27
    ds_read_b32 v27, v13 offset:112
    ds_read2_b32 v[112:113], v13 offset0:32 offset1:33
    ds_read2_b32 v[114:115], v13 offset0:34 offset1:35
    ds_read_b32 v28, v13 offset:144
    ds_read2_b32 v[116:117], v13 offset0:40 offset1:41
    ds_read2_b32 v[118:119], v13 offset0:42 offset1:43
    ds_read_b32 v29, v13 offset:176
    ds_read2_b32 v[120:121], v13 offset0:48 offset1:49
    ds_read2_b32 v[122:123], v13 offset0:50 offset1:51
    ds_read_b32 v30, v13 offset:208
    ds_read2_b32 v[124:125], v13 offset0:56 offset1:57
    ds_read2_b32 v[126:127], v13 offset0:58 offset1:59
    ds_read_b32 v31, v13 offset:240
    v_mfma_f32_32x32x16_bf16 v[144:159], v[184:187], v[72:75], v[144:159]
    s_waitcnt lgkmcnt(15)
    s_waitcnt lgkmcnt(0)
    v_alignbit_b32 v32, v65, v64, 16
    v_alignbit_b32 v33, v66, v65, 16
    v_alignbit_b32 v34, v67, v66, 16
    v_alignbit_b32 v35, v16, v67, 16
    v_mfma_f32_32x32x16_bf16 v[144:159], v[188:191], v[76:79], v[144:159]
    v_alignbit_b32 v36, v69, v68, 16
    v_alignbit_b32 v37, v70, v69, 16
    v_alignbit_b32 v38, v71, v70, 16
    v_alignbit_b32 v39, v17, v71, 16
    v_alignbit_b32 v40, v73, v72, 16
    v_alignbit_b32 v41, v74, v73, 16
    v_mfma_f32_32x32x16_bf16 v[144:159], v[192:195], v[80:83], v[144:159]
    v_alignbit_b32 v42, v75, v74, 16
    v_alignbit_b32 v43, v18, v75, 16
    v_alignbit_b32 v44, v77, v76, 16
    v_alignbit_b32 v45, v78, v77, 16
    v_alignbit_b32 v46, v79, v78, 16
    v_alignbit_b32 v47, v19, v79, 16
    v_mfma_f32_32x32x16_bf16 v[144:159], v[196:199], v[84:87], v[144:159]
    v_alignbit_b32 v48, v81, v80, 16
    v_alignbit_b32 v49, v82, v81, 16
    v_alignbit_b32 v50, v83, v82, 16
    v_alignbit_b32 v51, v20, v83, 16
    v_alignbit_b32 v52, v85, v84, 16
    v_alignbit_b32 v53, v86, v85, 16
    v_mfma_f32_32x32x16_bf16 v[144:159], v[200:203], v[88:91], v[144:159]
    v_alignbit_b32 v54, v87, v86, 16
    v_alignbit_b32 v55, v21, v87, 16
    v_alignbit_b32 v56, v89, v88, 16
    v_alignbit_b32 v57, v90, v89, 16
    v_alignbit_b32 v58, v91, v90, 16
    v_alignbit_b32 v59, v22, v91, 16
    v_mfma_f32_32x32x16_bf16 v[144:159], v[204:207], v[92:95], v[144:159]
    v_alignbit_b32 v60, v93, v92, 16
    v_alignbit_b32 v61, v94, v93, 16
    v_alignbit_b32 v62, v95, v94, 16
    v_alignbit_b32 v63, v23, v95, 16
    s_nop 0
    v_mfma_f32_32x32x16_bf16 v[128:143], v[176:179], v[32:35], 0
    ds_read_b64 v[208:209], v14 offset:3840
    ds_read_b64 v[210:211], v14 offset:3848
    s_nop 2
    v_mfma_f32_32x32x16_bf16 v[128:143], v[180:183], v[36:39], v[128:143]
    ds_read_b64 v[212:213], v14 offset:3872
    ds_read_b64 v[214:215], v14 offset:3880
    s_nop 2
    v_mfma_f32_32x32x16_bf16 v[128:143], v[184:187], v[40:43], v[128:143]
    ds_read_b64 v[216:217], v14 offset:3904
    ds_read_b64 v[218:219], v14 offset:3912
    v_alignbit_b32 v96, v97, v96, v11
    v_alignbit_b32 v97, v98, v97, v11
    v_alignbit_b32 v98, v99, v98, v11
    v_alignbit_b32 v99, v24, v99, v11
    v_alignbit_b32 v100, v101, v100, v11
    v_alignbit_b32 v101, v102, v101, v11
    v_alignbit_b32 v102, v103, v102, v11
    v_alignbit_b32 v103, v25, v103, v11
    v_alignbit_b32 v104, v105, v104, v11
    v_mfma_f32_32x32x16_bf16 v[128:143], v[188:191], v[44:47], v[128:143]
    ds_read_b64 v[220:221], v14 offset:3936
    ds_read_b64 v[222:223], v14 offset:3944
    v_alignbit_b32 v105, v106, v105, v11
    v_alignbit_b32 v106, v107, v106, v11
    v_alignbit_b32 v107, v26, v107, v11
    v_alignbit_b32 v108, v109, v108, v11
    v_alignbit_b32 v109, v110, v109, v11
    v_alignbit_b32 v110, v111, v110, v11
    v_alignbit_b32 v111, v27, v111, v11
    v_mov_b32_dpp v144, v144 row_shr:1 row_mask:0xf bank_mask:0xf bound_ctrl:0
    v_mfma_f32_32x32x16_bf16 v[128:143], v[192:195], v[48:51], v[128:143]
    ds_read_b64 v[224:225], v14 offset:3968
    ds_read_b64 v[226:227], v14 offset:3976
    v_mov_b32_dpp v145, v145 row_shr:1 row_mask:0xf bank_mask:0xf bound_ctrl:0
    v_mov_b32_dpp v146, v146 row_shr:1 row_mask:0xf bank_mask:0xf bound_ctrl:0
    v_mov_b32_dpp v147, v147 row_shr:1 row_mask:0xf bank_mask:0xf bound_ctrl:0
    v_mov_b32_dpp v148, v148 row_shr:1 row_mask:0xf bank_mask:0xf bound_ctrl:0
    v_mov_b32_dpp v149, v149 row_shr:1 row_mask:0xf bank_mask:0xf bound_ctrl:0
    v_mov_b32_dpp v150, v150 row_shr:1 row_mask:0xf bank_mask:0xf bound_ctrl:0
    v_mov_b32_dpp v151, v151 row_shr:1 row_mask:0xf bank_mask:0xf bound_ctrl:0
    v_mov_b32_dpp v152, v152 row_shr:1 row_mask:0xf bank_mask:0xf bound_ctrl:0
    v_mfma_f32_32x32x16_bf16 v[128:143], v[196:199], v[52:55], v[128:143]
    ds_read_b64 v[228:229], v14 offset:4000
    ds_read_b64 v[230:231], v14 offset:4008
    v_mov_b32_dpp v153, v153 row_shr:1 row_mask:0xf bank_mask:0xf bound_ctrl:0
    v_mov_b32_dpp v154, v154 row_shr:1 row_mask:0xf bank_mask:0xf bound_ctrl:0
    v_mov_b32_dpp v155, v155 row_shr:1 row_mask:0xf bank_mask:0xf bound_ctrl:0
    v_mov_b32_dpp v156, v156 row_shr:1 row_mask:0xf bank_mask:0xf bound_ctrl:0
    v_mov_b32_dpp v157, v157 row_shr:1 row_mask:0xf bank_mask:0xf bound_ctrl:0
    v_mov_b32_dpp v158, v158 row_shr:1 row_mask:0xf bank_mask:0xf bound_ctrl:0
    v_mov_b32_dpp v159, v159 row_shr:1 row_mask:0xf bank_mask:0xf bound_ctrl:0
    v_alignbit_b32 v112, v113, v112, v11
    v_mfma_f32_32x32x16_bf16 v[128:143], v[200:203], v[56:59], v[128:143]
    ds_read_b64 v[232:233], v14 offset:4032
    ds_read_b64 v[234:235], v14 offset:4040
    v_alignbit_b32 v113, v114, v113, v11
    v_alignbit_b32 v114, v115, v114, v11
    v_alignbit_b32 v115, v28, v115, v11
    v_alignbit_b32 v116, v117, v116, v11
    v_alignbit_b32 v117, v118, v117, v11
    v_alignbit_b32 v118, v119, v118, v11
    v_alignbit_b32 v119, v29, v119, v11
    v_alignbit_b32 v120, v121, v120, v11
    v_mfma_f32_32x32x16_bf16 v[128:143], v[204:207], v[60:63], v[128:143]
    ds_read_b64 v[236:237], v14 offset:4064
    ds_read_b64 v[238:239], v14 offset:4072
    v_alignbit_b32 v121, v122, v121, v11
    v_alignbit_b32 v122, v123, v122, v11
    v_alignbit_b32 v123, v30, v123, v11
    v_alignbit_b32 v124, v125, v124, v11
    v_alignbit_b32 v125, v126, v125, v11
    v_alignbit_b32 v126, v127, v126, v11
    v_alignbit_b32 v127, v31, v127, v11
    s_nop 0
    s_waitcnt lgkmcnt(0)
    v_mfma_f32_32x32x16_bf16 v[160:175], v[208:211], v[96:99], 0
    ds_read_b64 v[176:177], v14 offset:1536
    ds_read_b64 v[178:179], v14 offset:1544
    ds_read_b64 v[180:181], v14 offset:1568
    ds_read_b64 v[182:183], v14 offset:1576
    s_nop 0
    v_mfma_f32_32x32x16_bf16 v[160:175], v[212:215], v[100:103], v[160:175]
    ds_read_b64 v[184:185], v14 offset:1600
    ds_read_b64 v[186:187], v14 offset:1608
    ds_read_b64 v[188:189], v14 offset:1632
    s_nop 1
    v_mfma_f32_32x32x16_bf16 v[160:175], v[216:219], v[104:107], v[160:175]
    ds_read_b64 v[190:191], v14 offset:1640
    ds_read_b64 v[192:193], v14 offset:1664
    ds_read_b64 v[194:195], v14 offset:1672
    v_mov_b32_dpp v128, v128 row_shr:1 row_mask:0xf bank_mask:0xf bound_ctrl:0
    v_mov_b32_dpp v129, v129 row_shr:1 row_mask:0xf bank_mask:0xf bound_ctrl:0
    v_mov_b32_dpp v130, v130 row_shr:1 row_mask:0xf bank_mask:0xf bound_ctrl:0
    v_mfma_f32_32x32x16_bf16 v[160:175], v[220:223], v[108:111], v[160:175]
    ds_read_b64 v[196:197], v14 offset:1696
    ds_read_b64 v[198:199], v14 offset:1704
    ds_read_b64 v[200:201], v14 offset:1728
    v_mov_b32_dpp v131, v131 row_shr:1 row_mask:0xf bank_mask:0xf bound_ctrl:0
    v_mov_b32_dpp v132, v132 row_shr:1 row_mask:0xf bank_mask:0xf bound_ctrl:0
    v_mov_b32_dpp v133, v133 row_shr:1 row_mask:0xf bank_mask:0xf bound_ctrl:0
    v_mfma_f32_32x32x16_bf16 v[160:175], v[224:227], v[112:115], v[160:175]
    ds_read_b64 v[202:203], v14 offset:1736
    ds_read_b64 v[204:205], v14 offset:1760
    ds_read_b64 v[206:207], v14 offset:1768
    v_mov_b32_dpp v134, v134 row_shr:1 row_mask:0xf bank_mask:0xf bound_ctrl:0
    v_mov_b32_dpp v135, v135 row_shr:1 row_mask:0xf bank_mask:0xf bound_ctrl:0
    v_mov_b32_dpp v136, v136 row_shr:1 row_mask:0xf bank_mask:0xf bound_ctrl:0
    v_mfma_f32_32x32x16_bf16 v[160:175], v[228:231], v[116:119], v[160:175]
    v_mov_b32_dpp v137, v137 row_shr:1 row_mask:0xf bank_mask:0xf bound_ctrl:0
    v_mov_b32_dpp v138, v138 row_shr:1 row_mask:0xf bank_mask:0xf bound_ctrl:0
    v_mov_b32_dpp v139, v139 row_shr:1 row_mask:0xf bank_mask:0xf bound_ctrl:0
    v_mfma_f32_32x32x16_bf16 v[160:175], v[232:235], v[120:123], v[160:175]
    v_mov_b32_dpp v140, v140 row_shr:1 row_mask:0xf bank_mask:0xf bound_ctrl:0
    v_mov_b32_dpp v141, v141 row_shr:1 row_mask:0xf bank_mask:0xf bound_ctrl:0
    v_mfma_f32_32x32x16_bf16 v[160:175], v[236:239], v[124:127], v[160:175]
    v_mov_b32_dpp v142, v142 row_shr:1 row_mask:0xf bank_mask:0xf bound_ctrl:0
    v_mov_b32_dpp v143, v143 row_shr:1 row_mask:0xf bank_mask:0xf bound_ctrl:0
    s_waitcnt lgkmcnt(0)
    v_mfma_f32_32x32x16_bf16 v[144:159], v[176:179], v[64:67], v[144:159]
    ds_read_b64 v[208:209], v14 offset:3584
    ds_read_b64 v[210:211], v14 offset:3592
    s_nop 2
    v_mfma_f32_32x32x16_bf16 v[144:159], v[180:183], v[68:71], v[144:159]
    ds_read_b64 v[212:213], v14 offset:3616
    ds_read_b64 v[214:215], v14 offset:3624
    s_nop 2
    v_mfma_f32_32x32x16_bf16 v[144:159], v[184:187], v[72:75], v[144:159]
    ds_read_b64 v[216:217], v14 offset:3648
    ds_read_b64 v[218:219], v14 offset:3656
    v_and_b32_dpp v160, v160, v15 row_shr:1 row_mask:0xf bank_mask:0xf bound_ctrl:0
    v_and_b32_dpp v161, v161, v15 row_shr:1 row_mask:0xf bank_mask:0xf bound_ctrl:0
    v_and_b32_dpp v162, v162, v15 row_shr:1 row_mask:0xf bank_mask:0xf bound_ctrl:0
    v_mfma_f32_32x32x16_bf16 v[144:159], v[188:191], v[76:79], v[144:159]
    ds_read_b64 v[220:221], v14 offset:3680
    ds_read_b64 v[222:223], v14 offset:3688
    v_and_b32_dpp v163, v163, v15 row_shr:1 row_mask:0xf bank_mask:0xf bound_ctrl:0
    v_and_b32_dpp v164, v164, v15 row_shr:1 row_mask:0xf bank_mask:0xf bound_ctrl:0
    v_and_b32_dpp v165, v165, v15 row_shr:1 row_mask:0xf bank_mask:0xf bound_ctrl:0
    v_mfma_f32_32x32x16_bf16 v[144:159], v[192:195], v[80:83], v[144:159]
    ds_read_b64 v[224:225], v14 offset:3712
    ds_read_b64 v[226:227], v14 offset:3720
    v_and_b32_dpp v166, v166, v15 row_shr:1 row_mask:0xf bank_mask:0xf bound_ctrl:0
    v_and_b32_dpp v167, v167, v15 row_shr:1 row_mask:0xf bank_mask:0xf bound_ctrl:0
    v_and_b32_dpp v168, v168, v15 row_shr:1 row_mask:0xf bank_mask:0xf bound_ctrl:0
    v_mfma_f32_32x32x16_bf16 v[144:159], v[196:199], v[84:87], v[144:159]
    ds_read_b64 v[228:229], v14 offset:3744
    ds_read_b64 v[230:231], v14 offset:3752
    v_and_b32_dpp v169, v169, v15 row_shr:1 row_mask:0xf bank_mask:0xf bound_ctrl:0
    v_and_b32_dpp v170, v170, v15 row_shr:1 row_mask:0xf bank_mask:0xf bound_ctrl:0
    v_and_b32_dpp v171, v171, v15 row_shr:1 row_mask:0xf bank_mask:0xf bound_ctrl:0
    v_mfma_f32_32x32x16_bf16 v[144:159], v[200:203], v[88:91], v[144:159]
    ds_read_b64 v[232:233], v14 offset:3776
    ds_read_b64 v[234:235], v14 offset:3784
    v_and_b32_dpp v172, v172, v15 row_shr:1 row_mask:0xf bank_mask:0xf bound_ctrl:0
    v_and_b32_dpp v173, v173, v15 row_shr:1 row_mask:0xf bank_mask:0xf bound_ctrl:0
    v_mfma_f32_32x32x16_bf16 v[144:159], v[204:207], v[92:95], v[144:159]
    ds_read_b64 v[236:237], v14 offset:3808
    ds_read_b64 v[238:239], v14 offset:3816
    v_and_b32_dpp v174, v174, v15 row_shr:1 row_mask:0xf bank_mask:0xf bound_ctrl:0
    v_and_b32_dpp v175, v175, v15 row_shr:1 row_mask:0xf bank_mask:0xf bound_ctrl:0
    v_mfma_f32_32x32x16_bf16 v[128:143], v[176:179], v[32:35], v[128:143]
    s_nop 4
    v_mfma_f32_32x32x16_bf16 v[128:143], v[180:183], v[36:39], v[128:143]
    s_nop 4
    v_mfma_f32_32x32x16_bf16 v[128:143], v[184:187], v[40:43], v[128:143]
    v_mov_b32_dpp v144, v144 row_shr:1 row_mask:0xf bank_mask:0xf bound_ctrl:0
    v_mov_b32_dpp v145, v145 row_shr:1 row_mask:0xf bank_mask:0xf bound_ctrl:0
    v_mov_b32_dpp v146, v146 row_shr:1 row_mask:0xf bank_mask:0xf bound_ctrl:0
    v_mfma_f32_32x32x16_bf16 v[128:143], v[188:191], v[44:47], v[128:143]
    v_mov_b32_dpp v147, v147 row_shr:1 row_mask:0xf bank_mask:0xf bound_ctrl:0
    v_mov_b32_dpp v148, v148 row_shr:1 row_mask:0xf bank_mask:0xf bound_ctrl:0
    v_mov_b32_dpp v149, v149 row_shr:1 row_mask:0xf bank_mask:0xf bound_ctrl:0
    v_mfma_f32_32x32x16_bf16 v[128:143], v[192:195], v[48:51], v[128:143]
    v_mov_b32_dpp v150, v150 row_shr:1 row_mask:0xf bank_mask:0xf bound_ctrl:0
    v_mov_b32_dpp v151, v151 row_shr:1 row_mask:0xf bank_mask:0xf bound_ctrl:0
    v_mov_b32_dpp v152, v152 row_shr:1 row_mask:0xf bank_mask:0xf bound_ctrl:0
    v_mfma_f32_32x32x16_bf16 v[128:143], v[196:199], v[52:55], v[128:143]
    v_mov_b32_dpp v153, v153 row_shr:1 row_mask:0xf bank_mask:0xf bound_ctrl:0
    v_mov_b32_dpp v154, v154 row_shr:1 row_mask:0xf bank_mask:0xf bound_ctrl:0
    v_mov_b32_dpp v155, v155 row_shr:1 row_mask:0xf bank_mask:0xf bound_ctrl:0
    v_mfma_f32_32x32x16_bf16 v[128:143], v[200:203], v[56:59], v[128:143]
    v_mov_b32_dpp v156, v156 row_shr:1 row_mask:0xf bank_mask:0xf bound_ctrl:0
    v_mov_b32_dpp v157, v157 row_shr:1 row_mask:0xf bank_mask:0xf bound_ctrl:0
    v_mfma_f32_32x32x16_bf16 v[128:143], v[204:207], v[60:63], v[128:143]
    v_mov_b32_dpp v158, v158 row_shr:1 row_mask:0xf bank_mask:0xf bound_ctrl:0
    v_mov_b32_dpp v159, v159 row_shr:1 row_mask:0xf bank_mask:0xf bound_ctrl:0
    s_waitcnt lgkmcnt(0)
    v_mfma_f32_32x32x16_bf16 v[160:175], v[208:211], v[96:99], v[160:175]
    ds_read_b64 v[176:177], v14 offset:1280
    ds_read_b64 v[178:179], v14 offset:1288
    ds_read_b64 v[180:181], v14 offset:1312
    ds_read_b64 v[182:183], v14 offset:1320
    s_nop 0
    v_mfma_f32_32x32x16_bf16 v[160:175], v[212:215], v[100:103], v[160:175]
    ds_read_b64 v[184:185], v14 offset:1344
    ds_read_b64 v[186:187], v14 offset:1352
    ds_read_b64 v[188:189], v14 offset:1376
    s_nop 1
    v_mfma_f32_32x32x16_bf16 v[160:175], v[216:219], v[104:107], v[160:175]
    ds_read_b64 v[190:191], v14 offset:1384
    ds_read_b64 v[192:193], v14 offset:1408
    ds_read_b64 v[194:195], v14 offset:1416
    v_mov_b32_dpp v128, v128 row_shr:1 row_mask:0xf bank_mask:0xf bound_ctrl:0
    v_mov_b32_dpp v129, v129 row_shr:1 row_mask:0xf bank_mask:0xf bound_ctrl:0
    v_mov_b32_dpp v130, v130 row_shr:1 row_mask:0xf bank_mask:0xf bound_ctrl:0
    v_mfma_f32_32x32x16_bf16 v[160:175], v[220:223], v[108:111], v[160:175]
    ds_read_b64 v[196:197], v14 offset:1440
    ds_read_b64 v[198:199], v14 offset:1448
    ds_read_b64 v[200:201], v14 offset:1472
    v_mov_b32_dpp v131, v131 row_shr:1 row_mask:0xf bank_mask:0xf bound_ctrl:0
    v_mov_b32_dpp v132, v132 row_shr:1 row_mask:0xf bank_mask:0xf bound_ctrl:0
    v_mov_b32_dpp v133, v133 row_shr:1 row_mask:0xf bank_mask:0xf bound_ctrl:0
    v_mfma_f32_32x32x16_bf16 v[160:175], v[224:227], v[112:115], v[160:175]
    ds_read_b64 v[202:203], v14 offset:1480
    ds_read_b64 v[204:205], v14 offset:1504
    ds_read_b64 v[206:207], v14 offset:1512
    v_mov_b32_dpp v134, v134 row_shr:1 row_mask:0xf bank_mask:0xf bound_ctrl:0
    v_mov_b32_dpp v135, v135 row_shr:1 row_mask:0xf bank_mask:0xf bound_ctrl:0
    v_mov_b32_dpp v136, v136 row_shr:1 row_mask:0xf bank_mask:0xf bound_ctrl:0
    v_mfma_f32_32x32x16_bf16 v[160:175], v[228:231], v[116:119], v[160:175]
    v_mov_b32_dpp v137, v137 row_shr:1 row_mask:0xf bank_mask:0xf bound_ctrl:0
    v_mov_b32_dpp v138, v138 row_shr:1 row_mask:0xf bank_mask:0xf bound_ctrl:0
    v_mov_b32_dpp v139, v139 row_shr:1 row_mask:0xf bank_mask:0xf bound_ctrl:0
    v_mfma_f32_32x32x16_bf16 v[160:175], v[232:235], v[120:123], v[160:175]
    v_mov_b32_dpp v140, v140 row_shr:1 row_mask:0xf bank_mask:0xf bound_ctrl:0
    v_mov_b32_dpp v141, v141 row_shr:1 row_mask:0xf bank_mask:0xf bound_ctrl:0
    v_mfma_f32_32x32x16_bf16 v[160:175], v[236:239], v[124:127], v[160:175]
    v_mov_b32_dpp v142, v142 row_shr:1 row_mask:0xf bank_mask:0xf bound_ctrl:0
    v_mov_b32_dpp v143, v143 row_shr:1 row_mask:0xf bank_mask:0xf bound_ctrl:0
    s_waitcnt lgkmcnt(0)
    v_mfma_f32_32x32x16_bf16 v[144:159], v[176:179], v[64:67], v[144:159]
    ds_read_b64 v[208:209], v14 offset:3328
    ds_read_b64 v[210:211], v14 offset:3336
    s_nop 2
    v_mfma_f32_32x32x16_bf16 v[144:159], v[180:183], v[68:71], v[144:159]
    ds_read_b64 v[212:213], v14 offset:3360
    ds_read_b64 v[214:215], v14 offset:3368
    s_nop 2
    v_mfma_f32_32x32x16_bf16 v[144:159], v[184:187], v[72:75], v[144:159]
    ds_read_b64 v[216:217], v14 offset:3392
    ds_read_b64 v[218:219], v14 offset:3400
    v_and_b32_dpp v160, v160, v15 row_shr:1 row_mask:0xf bank_mask:0xf bound_ctrl:0
    v_and_b32_dpp v161, v161, v15 row_shr:1 row_mask:0xf bank_mask:0xf bound_ctrl:0
    v_and_b32_dpp v162, v162, v15 row_shr:1 row_mask:0xf bank_mask:0xf bound_ctrl:0
    v_mfma_f32_32x32x16_bf16 v[144:159], v[188:191], v[76:79], v[144:159]
    ds_read_b64 v[220:221], v14 offset:3424
    ds_read_b64 v[222:223], v14 offset:3432
    v_and_b32_dpp v163, v163, v15 row_shr:1 row_mask:0xf bank_mask:0xf bound_ctrl:0
    v_and_b32_dpp v164, v164, v15 row_shr:1 row_mask:0xf bank_mask:0xf bound_ctrl:0
    v_and_b32_dpp v165, v165, v15 row_shr:1 row_mask:0xf bank_mask:0xf bound_ctrl:0
    v_mfma_f32_32x32x16_bf16 v[144:159], v[192:195], v[80:83], v[144:159]
    ds_read_b64 v[224:225], v14 offset:3456
    ds_read_b64 v[226:227], v14 offset:3464
    v_and_b32_dpp v166, v166, v15 row_shr:1 row_mask:0xf bank_mask:0xf bound_ctrl:0
    v_and_b32_dpp v167, v167, v15 row_shr:1 row_mask:0xf bank_mask:0xf bound_ctrl:0
    v_and_b32_dpp v168, v168, v15 row_shr:1 row_mask:0xf bank_mask:0xf bound_ctrl:0
    v_mfma_f32_32x32x16_bf16 v[144:159], v[196:199], v[84:87], v[144:159]
    ds_read_b64 v[228:229], v14 offset:3488
    ds_read_b64 v[230:231], v14 offset:3496
    v_and_b32_dpp v169, v169, v15 row_shr:1 row_mask:0xf bank_mask:0xf bound_ctrl:0
    v_and_b32_dpp v170, v170, v15 row_shr:1 row_mask:0xf bank_mask:0xf bound_ctrl:0
    v_and_b32_dpp v171, v171, v15 row_shr:1 row_mask:0xf bank_mask:0xf bound_ctrl:0
    v_mfma_f32_32x32x16_bf16 v[144:159], v[200:203], v[88:91], v[144:159]
    ds_read_b64 v[232:233], v14 offset:3520
    ds_read_b64 v[234:235], v14 offset:3528
    v_and_b32_dpp v172, v172, v15 row_shr:1 row_mask:0xf bank_mask:0xf bound_ctrl:0
    v_and_b32_dpp v173, v173, v15 row_shr:1 row_mask:0xf bank_mask:0xf bound_ctrl:0
    v_mfma_f32_32x32x16_bf16 v[144:159], v[204:207], v[92:95], v[144:159]
    ds_read_b64 v[236:237], v14 offset:3552
    ds_read_b64 v[238:239], v14 offset:3560
    v_and_b32_dpp v174, v174, v15 row_shr:1 row_mask:0xf bank_mask:0xf bound_ctrl:0
    v_and_b32_dpp v175, v175, v15 row_shr:1 row_mask:0xf bank_mask:0xf bound_ctrl:0
    v_mfma_f32_32x32x16_bf16 v[128:143], v[176:179], v[32:35], v[128:143]
    s_nop 4
    v_mfma_f32_32x32x16_bf16 v[128:143], v[180:183], v[36:39], v[128:143]
    s_nop 4
    v_mfma_f32_32x32x16_bf16 v[128:143], v[184:187], v[40:43], v[128:143]
    v_mov_b32_dpp v144, v144 row_shr:1 row_mask:0xf bank_mask:0xf bound_ctrl:0
    v_mov_b32_dpp v145, v145 row_shr:1 row_mask:0xf bank_mask:0xf bound_ctrl:0
    v_mov_b32_dpp v146, v146 row_shr:1 row_mask:0xf bank_mask:0xf bound_ctrl:0
    v_mfma_f32_32x32x16_bf16 v[128:143], v[188:191], v[44:47], v[128:143]
    v_mov_b32_dpp v147, v147 row_shr:1 row_mask:0xf bank_mask:0xf bound_ctrl:0
    v_mov_b32_dpp v148, v148 row_shr:1 row_mask:0xf bank_mask:0xf bound_ctrl:0
    v_mov_b32_dpp v149, v149 row_shr:1 row_mask:0xf bank_mask:0xf bound_ctrl:0
    v_mfma_f32_32x32x16_bf16 v[128:143], v[192:195], v[48:51], v[128:143]
    v_mov_b32_dpp v150, v150 row_shr:1 row_mask:0xf bank_mask:0xf bound_ctrl:0
    v_mov_b32_dpp v151, v151 row_shr:1 row_mask:0xf bank_mask:0xf bound_ctrl:0
    v_mov_b32_dpp v152, v152 row_shr:1 row_mask:0xf bank_mask:0xf bound_ctrl:0
    v_mfma_f32_32x32x16_bf16 v[128:143], v[196:199], v[52:55], v[128:143]
    v_mov_b32_dpp v153, v153 row_shr:1 row_mask:0xf bank_mask:0xf bound_ctrl:0
    v_mov_b32_dpp v154, v154 row_shr:1 row_mask:0xf bank_mask:0xf bound_ctrl:0
    v_mov_b32_dpp v155, v155 row_shr:1 row_mask:0xf bank_mask:0xf bound_ctrl:0
    v_mfma_f32_32x32x16_bf16 v[128:143], v[200:203], v[56:59], v[128:143]
    v_mov_b32_dpp v156, v156 row_shr:1 row_mask:0xf bank_mask:0xf bound_ctrl:0
    v_mov_b32_dpp v157, v157 row_shr:1 row_mask:0xf bank_mask:0xf bound_ctrl:0
    v_mfma_f32_32x32x16_bf16 v[128:143], v[204:207], v[60:63], v[128:143]
    v_mov_b32_dpp v158, v158 row_shr:1 row_mask:0xf bank_mask:0xf bound_ctrl:0
    v_mov_b32_dpp v159, v159 row_shr:1 row_mask:0xf bank_mask:0xf bound_ctrl:0
    s_waitcnt lgkmcnt(0)
    v_mfma_f32_32x32x16_bf16 v[160:175], v[208:211], v[96:99], v[160:175]
    ds_read_b64 v[176:177], v14 offset:1024
    ds_read_b64 v[178:179], v14 offset:1032
    ds_read_b64 v[180:181], v14 offset:1056
    ds_read_b64 v[182:183], v14 offset:1064
    s_nop 0
    v_mfma_f32_32x32x16_bf16 v[160:175], v[212:215], v[100:103], v[160:175]
    ds_read_b64 v[184:185], v14 offset:1088
    ds_read_b64 v[186:187], v14 offset:1096
    ds_read_b64 v[188:189], v14 offset:1120
    s_nop 1
    v_mfma_f32_32x32x16_bf16 v[160:175], v[216:219], v[104:107], v[160:175]
    ds_read_b64 v[190:191], v14 offset:1128
    ds_read_b64 v[192:193], v14 offset:1152
    ds_read_b64 v[194:195], v14 offset:1160
    v_mov_b32_dpp v128, v128 row_shr:1 row_mask:0xf bank_mask:0xf bound_ctrl:0
    v_mov_b32_dpp v129, v129 row_shr:1 row_mask:0xf bank_mask:0xf bound_ctrl:0
    v_mov_b32_dpp v130, v130 row_shr:1 row_mask:0xf bank_mask:0xf bound_ctrl:0
    v_mfma_f32_32x32x16_bf16 v[160:175], v[220:223], v[108:111], v[160:175]
    ds_read_b64 v[196:197], v14 offset:1184
    ds_read_b64 v[198:199], v14 offset:1192
    ds_read_b64 v[200:201], v14 offset:1216
    v_mov_b32_dpp v131, v131 row_shr:1 row_mask:0xf bank_mask:0xf bound_ctrl:0
    v_mov_b32_dpp v132, v132 row_shr:1 row_mask:0xf bank_mask:0xf bound_ctrl:0
    v_mov_b32_dpp v133, v133 row_shr:1 row_mask:0xf bank_mask:0xf bound_ctrl:0
    v_mfma_f32_32x32x16_bf16 v[160:175], v[224:227], v[112:115], v[160:175]
    ds_read_b64 v[202:203], v14 offset:1224
    ds_read_b64 v[204:205], v14 offset:1248
    ds_read_b64 v[206:207], v14 offset:1256
    v_mov_b32_dpp v134, v134 row_shr:1 row_mask:0xf bank_mask:0xf bound_ctrl:0
    v_mov_b32_dpp v135, v135 row_shr:1 row_mask:0xf bank_mask:0xf bound_ctrl:0
    v_mov_b32_dpp v136, v136 row_shr:1 row_mask:0xf bank_mask:0xf bound_ctrl:0
    v_mfma_f32_32x32x16_bf16 v[160:175], v[228:231], v[116:119], v[160:175]
    v_mov_b32_dpp v137, v137 row_shr:1 row_mask:0xf bank_mask:0xf bound_ctrl:0
    v_mov_b32_dpp v138, v138 row_shr:1 row_mask:0xf bank_mask:0xf bound_ctrl:0
    v_mov_b32_dpp v139, v139 row_shr:1 row_mask:0xf bank_mask:0xf bound_ctrl:0
    v_mfma_f32_32x32x16_bf16 v[160:175], v[232:235], v[120:123], v[160:175]
    v_mov_b32_dpp v140, v140 row_shr:1 row_mask:0xf bank_mask:0xf bound_ctrl:0
    v_mov_b32_dpp v141, v141 row_shr:1 row_mask:0xf bank_mask:0xf bound_ctrl:0
    v_mfma_f32_32x32x16_bf16 v[160:175], v[236:239], v[124:127], v[160:175]
    v_mov_b32_dpp v142, v142 row_shr:1 row_mask:0xf bank_mask:0xf bound_ctrl:0
    v_mov_b32_dpp v143, v143 row_shr:1 row_mask:0xf bank_mask:0xf bound_ctrl:0
    s_waitcnt lgkmcnt(0)
    v_mfma_f32_32x32x16_bf16 v[144:159], v[176:179], v[64:67], v[144:159]
    ds_read_b64 v[208:209], v14 offset:3072
    ds_read_b64 v[210:211], v14 offset:3080
    s_nop 2
    v_mfma_f32_32x32x16_bf16 v[144:159], v[180:183], v[68:71], v[144:159]
    ds_read_b64 v[212:213], v14 offset:3104
    ds_read_b64 v[214:215], v14 offset:3112
    s_nop 2
    v_mfma_f32_32x32x16_bf16 v[144:159], v[184:187], v[72:75], v[144:159]
    ds_read_b64 v[216:217], v14 offset:3136
    ds_read_b64 v[218:219], v14 offset:3144
    v_and_b32_dpp v160, v160, v15 row_shr:1 row_mask:0xf bank_mask:0xf bound_ctrl:0
    v_and_b32_dpp v161, v161, v15 row_shr:1 row_mask:0xf bank_mask:0xf bound_ctrl:0
    v_and_b32_dpp v162, v162, v15 row_shr:1 row_mask:0xf bank_mask:0xf bound_ctrl:0
    v_mfma_f32_32x32x16_bf16 v[144:159], v[188:191], v[76:79], v[144:159]
    ds_read_b64 v[220:221], v14 offset:3168
    ds_read_b64 v[222:223], v14 offset:3176
    v_and_b32_dpp v163, v163, v15 row_shr:1 row_mask:0xf bank_mask:0xf bound_ctrl:0
    v_and_b32_dpp v164, v164, v15 row_shr:1 row_mask:0xf bank_mask:0xf bound_ctrl:0
    v_and_b32_dpp v165, v165, v15 row_shr:1 row_mask:0xf bank_mask:0xf bound_ctrl:0
    v_mfma_f32_32x32x16_bf16 v[144:159], v[192:195], v[80:83], v[144:159]
    ds_read_b64 v[224:225], v14 offset:3200
    ds_read_b64 v[226:227], v14 offset:3208
    v_and_b32_dpp v166, v166, v15 row_shr:1 row_mask:0xf bank_mask:0xf bound_ctrl:0
    v_and_b32_dpp v167, v167, v15 row_shr:1 row_mask:0xf bank_mask:0xf bound_ctrl:0
    v_and_b32_dpp v168, v168, v15 row_shr:1 row_mask:0xf bank_mask:0xf bound_ctrl:0
    v_mfma_f32_32x32x16_bf16 v[144:159], v[196:199], v[84:87], v[144:159]
    ds_read_b64 v[228:229], v14 offset:3232
    ds_read_b64 v[230:231], v14 offset:3240
    v_and_b32_dpp v169, v169, v15 row_shr:1 row_mask:0xf bank_mask:0xf bound_ctrl:0
    v_and_b32_dpp v170, v170, v15 row_shr:1 row_mask:0xf bank_mask:0xf bound_ctrl:0
    v_and_b32_dpp v171, v171, v15 row_shr:1 row_mask:0xf bank_mask:0xf bound_ctrl:0
    v_mfma_f32_32x32x16_bf16 v[144:159], v[200:203], v[88:91], v[144:159]
    ds_read_b64 v[232:233], v14 offset:3264
    ds_read_b64 v[234:235], v14 offset:3272
    v_and_b32_dpp v172, v172, v15 row_shr:1 row_mask:0xf bank_mask:0xf bound_ctrl:0
    v_and_b32_dpp v173, v173, v15 row_shr:1 row_mask:0xf bank_mask:0xf bound_ctrl:0
    v_mfma_f32_32x32x16_bf16 v[144:159], v[204:207], v[92:95], v[144:159]
    ds_read_b64 v[236:237], v14 offset:3296
    ds_read_b64 v[238:239], v14 offset:3304
    v_and_b32_dpp v174, v174, v15 row_shr:1 row_mask:0xf bank_mask:0xf bound_ctrl:0
    v_and_b32_dpp v175, v175, v15 row_shr:1 row_mask:0xf bank_mask:0xf bound_ctrl:0
    v_mfma_f32_32x32x16_bf16 v[128:143], v[176:179], v[32:35], v[128:143]
    s_nop 4
    v_mfma_f32_32x32x16_bf16 v[128:143], v[180:183], v[36:39], v[128:143]
    s_nop 4
    v_mfma_f32_32x32x16_bf16 v[128:143], v[184:187], v[40:43], v[128:143]
    v_mov_b32_dpp v144, v144 row_shr:1 row_mask:0xf bank_mask:0xf bound_ctrl:0
    v_mov_b32_dpp v145, v145 row_shr:1 row_mask:0xf bank_mask:0xf bound_ctrl:0
    v_mov_b32_dpp v146, v146 row_shr:1 row_mask:0xf bank_mask:0xf bound_ctrl:0
    v_mfma_f32_32x32x16_bf16 v[128:143], v[188:191], v[44:47], v[128:143]
    v_mov_b32_dpp v147, v147 row_shr:1 row_mask:0xf bank_mask:0xf bound_ctrl:0
    v_mov_b32_dpp v148, v148 row_shr:1 row_mask:0xf bank_mask:0xf bound_ctrl:0
    v_mov_b32_dpp v149, v149 row_shr:1 row_mask:0xf bank_mask:0xf bound_ctrl:0
    v_mfma_f32_32x32x16_bf16 v[128:143], v[192:195], v[48:51], v[128:143]
    v_mov_b32_dpp v150, v150 row_shr:1 row_mask:0xf bank_mask:0xf bound_ctrl:0
    v_mov_b32_dpp v151, v151 row_shr:1 row_mask:0xf bank_mask:0xf bound_ctrl:0
    v_mov_b32_dpp v152, v152 row_shr:1 row_mask:0xf bank_mask:0xf bound_ctrl:0
    v_mfma_f32_32x32x16_bf16 v[128:143], v[196:199], v[52:55], v[128:143]
    v_mov_b32_dpp v153, v153 row_shr:1 row_mask:0xf bank_mask:0xf bound_ctrl:0
    v_mov_b32_dpp v154, v154 row_shr:1 row_mask:0xf bank_mask:0xf bound_ctrl:0
    v_mov_b32_dpp v155, v155 row_shr:1 row_mask:0xf bank_mask:0xf bound_ctrl:0
    v_mfma_f32_32x32x16_bf16 v[128:143], v[200:203], v[56:59], v[128:143]
    v_mov_b32_dpp v156, v156 row_shr:1 row_mask:0xf bank_mask:0xf bound_ctrl:0
    v_mov_b32_dpp v157, v157 row_shr:1 row_mask:0xf bank_mask:0xf bound_ctrl:0
    v_mfma_f32_32x32x16_bf16 v[128:143], v[204:207], v[60:63], v[128:143]
    v_mov_b32_dpp v158, v158 row_shr:1 row_mask:0xf bank_mask:0xf bound_ctrl:0
    v_mov_b32_dpp v159, v159 row_shr:1 row_mask:0xf bank_mask:0xf bound_ctrl:0
    s_waitcnt lgkmcnt(0)
    v_mfma_f32_32x32x16_bf16 v[160:175], v[208:211], v[96:99], v[160:175]
    ds_read_b64 v[176:177], v14 offset:768
    ds_read_b64 v[178:179], v14 offset:776
    ds_read_b64 v[180:181], v14 offset:800
    ds_read_b64 v[182:183], v14 offset:808
    s_nop 0
    v_mfma_f32_32x32x16_bf16 v[160:175], v[212:215], v[100:103], v[160:175]
    ds_read_b64 v[184:185], v14 offset:832
    ds_read_b64 v[186:187], v14 offset:840
    ds_read_b64 v[188:189], v14 offset:864
    s_nop 1
    v_mfma_f32_32x32x16_bf16 v[160:175], v[216:219], v[104:107], v[160:175]
    ds_read_b64 v[190:191], v14 offset:872
    ds_read_b64 v[192:193], v14 offset:896
    ds_read_b64 v[194:195], v14 offset:904
    v_mov_b32_dpp v128, v128 row_shr:1 row_mask:0xf bank_mask:0xf bound_ctrl:0
    v_mov_b32_dpp v129, v129 row_shr:1 row_mask:0xf bank_mask:0xf bound_ctrl:0
    v_mov_b32_dpp v130, v130 row_shr:1 row_mask:0xf bank_mask:0xf bound_ctrl:0
    v_mfma_f32_32x32x16_bf16 v[160:175], v[220:223], v[108:111], v[160:175]
    ds_read_b64 v[196:197], v14 offset:928
    ds_read_b64 v[198:199], v14 offset:936
    ds_read_b64 v[200:201], v14 offset:960
    v_mov_b32_dpp v131, v131 row_shr:1 row_mask:0xf bank_mask:0xf bound_ctrl:0
    v_mov_b32_dpp v132, v132 row_shr:1 row_mask:0xf bank_mask:0xf bound_ctrl:0
    v_mov_b32_dpp v133, v133 row_shr:1 row_mask:0xf bank_mask:0xf bound_ctrl:0
    v_mfma_f32_32x32x16_bf16 v[160:175], v[224:227], v[112:115], v[160:175]
    ds_read_b64 v[202:203], v14 offset:968
    ds_read_b64 v[204:205], v14 offset:992
    ds_read_b64 v[206:207], v14 offset:1000
    v_mov_b32_dpp v134, v134 row_shr:1 row_mask:0xf bank_mask:0xf bound_ctrl:0
    v_mov_b32_dpp v135, v135 row_shr:1 row_mask:0xf bank_mask:0xf bound_ctrl:0
    v_mov_b32_dpp v136, v136 row_shr:1 row_mask:0xf bank_mask:0xf bound_ctrl:0
    v_mfma_f32_32x32x16_bf16 v[160:175], v[228:231], v[116:119], v[160:175]
    v_mov_b32_dpp v137, v137 row_shr:1 row_mask:0xf bank_mask:0xf bound_ctrl:0
    v_mov_b32_dpp v138, v138 row_shr:1 row_mask:0xf bank_mask:0xf bound_ctrl:0
    v_mov_b32_dpp v139, v139 row_shr:1 row_mask:0xf bank_mask:0xf bound_ctrl:0
    v_mfma_f32_32x32x16_bf16 v[160:175], v[232:235], v[120:123], v[160:175]
    v_mov_b32_dpp v140, v140 row_shr:1 row_mask:0xf bank_mask:0xf bound_ctrl:0
    v_mov_b32_dpp v141, v141 row_shr:1 row_mask:0xf bank_mask:0xf bound_ctrl:0
    v_mfma_f32_32x32x16_bf16 v[160:175], v[236:239], v[124:127], v[160:175]
    v_mov_b32_dpp v142, v142 row_shr:1 row_mask:0xf bank_mask:0xf bound_ctrl:0
    v_mov_b32_dpp v143, v143 row_shr:1 row_mask:0xf bank_mask:0xf bound_ctrl:0
    s_waitcnt lgkmcnt(0)
    v_mfma_f32_32x32x16_bf16 v[144:159], v[176:179], v[64:67], v[144:159]
    ds_read_b64 v[208:209], v14 offset:2816
    ds_read_b64 v[210:211], v14 offset:2824
    s_nop 2
    v_mfma_f32_32x32x16_bf16 v[144:159], v[180:183], v[68:71], v[144:159]
    ds_read_b64 v[212:213], v14 offset:2848
    ds_read_b64 v[214:215], v14 offset:2856
    s_nop 2
    v_mfma_f32_32x32x16_bf16 v[144:159], v[184:187], v[72:75], v[144:159]
    ds_read_b64 v[216:217], v14 offset:2880
    ds_read_b64 v[218:219], v14 offset:2888
    v_and_b32_dpp v160, v160, v15 row_shr:1 row_mask:0xf bank_mask:0xf bound_ctrl:0
    v_and_b32_dpp v161, v161, v15 row_shr:1 row_mask:0xf bank_mask:0xf bound_ctrl:0
    v_and_b32_dpp v162, v162, v15 row_shr:1 row_mask:0xf bank_mask:0xf bound_ctrl:0
    v_mfma_f32_32x32x16_bf16 v[144:159], v[188:191], v[76:79], v[144:159]
    ds_read_b64 v[220:221], v14 offset:2912
    ds_read_b64 v[222:223], v14 offset:2920
    v_and_b32_dpp v163, v163, v15 row_shr:1 row_mask:0xf bank_mask:0xf bound_ctrl:0
    v_and_b32_dpp v164, v164, v15 row_shr:1 row_mask:0xf bank_mask:0xf bound_ctrl:0
    v_and_b32_dpp v165, v165, v15 row_shr:1 row_mask:0xf bank_mask:0xf bound_ctrl:0
    v_mfma_f32_32x32x16_bf16 v[144:159], v[192:195], v[80:83], v[144:159]
    ds_read_b64 v[224:225], v14 offset:2944
    ds_read_b64 v[226:227], v14 offset:2952
    v_and_b32_dpp v166, v166, v15 row_shr:1 row_mask:0xf bank_mask:0xf bound_ctrl:0
    v_and_b32_dpp v167, v167, v15 row_shr:1 row_mask:0xf bank_mask:0xf bound_ctrl:0
    v_and_b32_dpp v168, v168, v15 row_shr:1 row_mask:0xf bank_mask:0xf bound_ctrl:0
    v_mfma_f32_32x32x16_bf16 v[144:159], v[196:199], v[84:87], v[144:159]
    ds_read_b64 v[228:229], v14 offset:2976
    ds_read_b64 v[230:231], v14 offset:2984
    v_and_b32_dpp v169, v169, v15 row_shr:1 row_mask:0xf bank_mask:0xf bound_ctrl:0
    v_and_b32_dpp v170, v170, v15 row_shr:1 row_mask:0xf bank_mask:0xf bound_ctrl:0
    v_and_b32_dpp v171, v171, v15 row_shr:1 row_mask:0xf bank_mask:0xf bound_ctrl:0
    v_mfma_f32_32x32x16_bf16 v[144:159], v[200:203], v[88:91], v[144:159]
    ds_read_b64 v[232:233], v14 offset:3008
    ds_read_b64 v[234:235], v14 offset:3016
    v_and_b32_dpp v172, v172, v15 row_shr:1 row_mask:0xf bank_mask:0xf bound_ctrl:0
    v_and_b32_dpp v173, v173, v15 row_shr:1 row_mask:0xf bank_mask:0xf bound_ctrl:0
    v_mfma_f32_32x32x16_bf16 v[144:159], v[204:207], v[92:95], v[144:159]
    ds_read_b64 v[236:237], v14 offset:3040
    ds_read_b64 v[238:239], v14 offset:3048
    v_and_b32_dpp v174, v174, v15 row_shr:1 row_mask:0xf bank_mask:0xf bound_ctrl:0
    v_and_b32_dpp v175, v175, v15 row_shr:1 row_mask:0xf bank_mask:0xf bound_ctrl:0
    v_mfma_f32_32x32x16_bf16 v[128:143], v[176:179], v[32:35], v[128:143]
    s_nop 4
    v_mfma_f32_32x32x16_bf16 v[128:143], v[180:183], v[36:39], v[128:143]
    s_nop 4
    v_mfma_f32_32x32x16_bf16 v[128:143], v[184:187], v[40:43], v[128:143]
    v_mov_b32_dpp v144, v144 row_shr:1 row_mask:0xf bank_mask:0xf bound_ctrl:0
    v_mov_b32_dpp v145, v145 row_shr:1 row_mask:0xf bank_mask:0xf bound_ctrl:0
    v_mov_b32_dpp v146, v146 row_shr:1 row_mask:0xf bank_mask:0xf bound_ctrl:0
    v_mfma_f32_32x32x16_bf16 v[128:143], v[188:191], v[44:47], v[128:143]
    v_mov_b32_dpp v147, v147 row_shr:1 row_mask:0xf bank_mask:0xf bound_ctrl:0
    v_mov_b32_dpp v148, v148 row_shr:1 row_mask:0xf bank_mask:0xf bound_ctrl:0
    v_mov_b32_dpp v149, v149 row_shr:1 row_mask:0xf bank_mask:0xf bound_ctrl:0
    v_mfma_f32_32x32x16_bf16 v[128:143], v[192:195], v[48:51], v[128:143]
    v_mov_b32_dpp v150, v150 row_shr:1 row_mask:0xf bank_mask:0xf bound_ctrl:0
    v_mov_b32_dpp v151, v151 row_shr:1 row_mask:0xf bank_mask:0xf bound_ctrl:0
    v_mov_b32_dpp v152, v152 row_shr:1 row_mask:0xf bank_mask:0xf bound_ctrl:0
    v_mfma_f32_32x32x16_bf16 v[128:143], v[196:199], v[52:55], v[128:143]
    v_mov_b32_dpp v153, v153 row_shr:1 row_mask:0xf bank_mask:0xf bound_ctrl:0
    v_mov_b32_dpp v154, v154 row_shr:1 row_mask:0xf bank_mask:0xf bound_ctrl:0
    v_mov_b32_dpp v155, v155 row_shr:1 row_mask:0xf bank_mask:0xf bound_ctrl:0
    v_mfma_f32_32x32x16_bf16 v[128:143], v[200:203], v[56:59], v[128:143]
    v_mov_b32_dpp v156, v156 row_shr:1 row_mask:0xf bank_mask:0xf bound_ctrl:0
    v_mov_b32_dpp v157, v157 row_shr:1 row_mask:0xf bank_mask:0xf bound_ctrl:0
    v_mfma_f32_32x32x16_bf16 v[128:143], v[204:207], v[60:63], v[128:143]
    v_mov_b32_dpp v158, v158 row_shr:1 row_mask:0xf bank_mask:0xf bound_ctrl:0
    v_mov_b32_dpp v159, v159 row_shr:1 row_mask:0xf bank_mask:0xf bound_ctrl:0
    s_waitcnt lgkmcnt(0)
    v_mfma_f32_32x32x16_bf16 v[160:175], v[208:211], v[96:99], v[160:175]
    ds_read_b64 v[176:177], v14 offset:512
    ds_read_b64 v[178:179], v14 offset:520
    ds_read_b64 v[180:181], v14 offset:544
    ds_read_b64 v[182:183], v14 offset:552
    s_nop 0
    v_mfma_f32_32x32x16_bf16 v[160:175], v[212:215], v[100:103], v[160:175]
    ds_read_b64 v[184:185], v14 offset:576
    ds_read_b64 v[186:187], v14 offset:584
    ds_read_b64 v[188:189], v14 offset:608
    s_nop 1
    v_mfma_f32_32x32x16_bf16 v[160:175], v[216:219], v[104:107], v[160:175]
    ds_read_b64 v[190:191], v14 offset:616
    ds_read_b64 v[192:193], v14 offset:640
    ds_read_b64 v[194:195], v14 offset:648
    v_mov_b32_dpp v128, v128 row_shr:1 row_mask:0xf bank_mask:0xf bound_ctrl:0
    v_mov_b32_dpp v129, v129 row_shr:1 row_mask:0xf bank_mask:0xf bound_ctrl:0
    v_mov_b32_dpp v130, v130 row_shr:1 row_mask:0xf bank_mask:0xf bound_ctrl:0
    v_mfma_f32_32x32x16_bf16 v[160:175], v[220:223], v[108:111], v[160:175]
    ds_read_b64 v[196:197], v14 offset:672
    ds_read_b64 v[198:199], v14 offset:680
    ds_read_b64 v[200:201], v14 offset:704
    v_mov_b32_dpp v131, v131 row_shr:1 row_mask:0xf bank_mask:0xf bound_ctrl:0
    v_mov_b32_dpp v132, v132 row_shr:1 row_mask:0xf bank_mask:0xf bound_ctrl:0
    v_mov_b32_dpp v133, v133 row_shr:1 row_mask:0xf bank_mask:0xf bound_ctrl:0
    v_mfma_f32_32x32x16_bf16 v[160:175], v[224:227], v[112:115], v[160:175]
    ds_read_b64 v[202:203], v14 offset:712
    ds_read_b64 v[204:205], v14 offset:736
    ds_read_b64 v[206:207], v14 offset:744
    v_mov_b32_dpp v134, v134 row_shr:1 row_mask:0xf bank_mask:0xf bound_ctrl:0
    v_mov_b32_dpp v135, v135 row_shr:1 row_mask:0xf bank_mask:0xf bound_ctrl:0
    v_mov_b32_dpp v136, v136 row_shr:1 row_mask:0xf bank_mask:0xf bound_ctrl:0
    v_mfma_f32_32x32x16_bf16 v[160:175], v[228:231], v[116:119], v[160:175]
    v_mov_b32_dpp v137, v137 row_shr:1 row_mask:0xf bank_mask:0xf bound_ctrl:0
    v_mov_b32_dpp v138, v138 row_shr:1 row_mask:0xf bank_mask:0xf bound_ctrl:0
    v_mov_b32_dpp v139, v139 row_shr:1 row_mask:0xf bank_mask:0xf bound_ctrl:0
    v_mfma_f32_32x32x16_bf16 v[160:175], v[232:235], v[120:123], v[160:175]
    v_mov_b32_dpp v140, v140 row_shr:1 row_mask:0xf bank_mask:0xf bound_ctrl:0
    v_mov_b32_dpp v141, v141 row_shr:1 row_mask:0xf bank_mask:0xf bound_ctrl:0
    v_mfma_f32_32x32x16_bf16 v[160:175], v[236:239], v[124:127], v[160:175]
    v_mov_b32_dpp v142, v142 row_shr:1 row_mask:0xf bank_mask:0xf bound_ctrl:0
    v_mov_b32_dpp v143, v143 row_shr:1 row_mask:0xf bank_mask:0xf bound_ctrl:0
    s_waitcnt lgkmcnt(0)
    v_mfma_f32_32x32x16_bf16 v[144:159], v[176:179], v[64:67], v[144:159]
    ds_read_b64 v[208:209], v14 offset:2560
    ds_read_b64 v[210:211], v14 offset:2568
    s_nop 2
    v_mfma_f32_32x32x16_bf16 v[144:159], v[180:183], v[68:71], v[144:159]
    ds_read_b64 v[212:213], v14 offset:2592
    ds_read_b64 v[214:215], v14 offset:2600
    s_nop 2
    v_mfma_f32_32x32x16_bf16 v[144:159], v[184:187], v[72:75], v[144:159]
    ds_read_b64 v[216:217], v14 offset:2624
    ds_read_b64 v[218:219], v14 offset:2632
    v_and_b32_dpp v160, v160, v15 row_shr:1 row_mask:0xf bank_mask:0xf bound_ctrl:0
    v_and_b32_dpp v161, v161, v15 row_shr:1 row_mask:0xf bank_mask:0xf bound_ctrl:0
    v_and_b32_dpp v162, v162, v15 row_shr:1 row_mask:0xf bank_mask:0xf bound_ctrl:0
    v_mfma_f32_32x32x16_bf16 v[144:159], v[188:191], v[76:79], v[144:159]
    ds_read_b64 v[220:221], v14 offset:2656
    ds_read_b64 v[222:223], v14 offset:2664
    v_and_b32_dpp v163, v163, v15 row_shr:1 row_mask:0xf bank_mask:0xf bound_ctrl:0
    v_and_b32_dpp v164, v164, v15 row_shr:1 row_mask:0xf bank_mask:0xf bound_ctrl:0
    v_and_b32_dpp v165, v165, v15 row_shr:1 row_mask:0xf bank_mask:0xf bound_ctrl:0
    v_mfma_f32_32x32x16_bf16 v[144:159], v[192:195], v[80:83], v[144:159]
    ds_read_b64 v[224:225], v14 offset:2688
    ds_read_b64 v[226:227], v14 offset:2696
    v_and_b32_dpp v166, v166, v15 row_shr:1 row_mask:0xf bank_mask:0xf bound_ctrl:0
    v_and_b32_dpp v167, v167, v15 row_shr:1 row_mask:0xf bank_mask:0xf bound_ctrl:0
    v_and_b32_dpp v168, v168, v15 row_shr:1 row_mask:0xf bank_mask:0xf bound_ctrl:0
    v_mfma_f32_32x32x16_bf16 v[144:159], v[196:199], v[84:87], v[144:159]
    ds_read_b64 v[228:229], v14 offset:2720
    ds_read_b64 v[230:231], v14 offset:2728
    v_and_b32_dpp v169, v169, v15 row_shr:1 row_mask:0xf bank_mask:0xf bound_ctrl:0
    v_and_b32_dpp v170, v170, v15 row_shr:1 row_mask:0xf bank_mask:0xf bound_ctrl:0
    v_and_b32_dpp v171, v171, v15 row_shr:1 row_mask:0xf bank_mask:0xf bound_ctrl:0
    v_mfma_f32_32x32x16_bf16 v[144:159], v[200:203], v[88:91], v[144:159]
    ds_read_b64 v[232:233], v14 offset:2752
    ds_read_b64 v[234:235], v14 offset:2760
    v_and_b32_dpp v172, v172, v15 row_shr:1 row_mask:0xf bank_mask:0xf bound_ctrl:0
    v_and_b32_dpp v173, v173, v15 row_shr:1 row_mask:0xf bank_mask:0xf bound_ctrl:0
    v_mfma_f32_32x32x16_bf16 v[144:159], v[204:207], v[92:95], v[144:159]
    ds_read_b64 v[236:237], v14 offset:2784
    ds_read_b64 v[238:239], v14 offset:2792
    v_and_b32_dpp v174, v174, v15 row_shr:1 row_mask:0xf bank_mask:0xf bound_ctrl:0
    v_and_b32_dpp v175, v175, v15 row_shr:1 row_mask:0xf bank_mask:0xf bound_ctrl:0
    v_mfma_f32_32x32x16_bf16 v[128:143], v[176:179], v[32:35], v[128:143]
    s_nop 4
    v_mfma_f32_32x32x16_bf16 v[128:143], v[180:183], v[36:39], v[128:143]
    s_nop 4
    v_mfma_f32_32x32x16_bf16 v[128:143], v[184:187], v[40:43], v[128:143]
    v_mov_b32_dpp v144, v144 row_shr:1 row_mask:0xf bank_mask:0xf bound_ctrl:0
    v_mov_b32_dpp v145, v145 row_shr:1 row_mask:0xf bank_mask:0xf bound_ctrl:0
    v_mov_b32_dpp v146, v146 row_shr:1 row_mask:0xf bank_mask:0xf bound_ctrl:0
    v_mfma_f32_32x32x16_bf16 v[128:143], v[188:191], v[44:47], v[128:143]
    v_mov_b32_dpp v147, v147 row_shr:1 row_mask:0xf bank_mask:0xf bound_ctrl:0
    v_mov_b32_dpp v148, v148 row_shr:1 row_mask:0xf bank_mask:0xf bound_ctrl:0
    v_mov_b32_dpp v149, v149 row_shr:1 row_mask:0xf bank_mask:0xf bound_ctrl:0
    v_mfma_f32_32x32x16_bf16 v[128:143], v[192:195], v[48:51], v[128:143]
    v_mov_b32_dpp v150, v150 row_shr:1 row_mask:0xf bank_mask:0xf bound_ctrl:0
    v_mov_b32_dpp v151, v151 row_shr:1 row_mask:0xf bank_mask:0xf bound_ctrl:0
    v_mov_b32_dpp v152, v152 row_shr:1 row_mask:0xf bank_mask:0xf bound_ctrl:0
    v_mfma_f32_32x32x16_bf16 v[128:143], v[196:199], v[52:55], v[128:143]
    v_mov_b32_dpp v153, v153 row_shr:1 row_mask:0xf bank_mask:0xf bound_ctrl:0
    v_mov_b32_dpp v154, v154 row_shr:1 row_mask:0xf bank_mask:0xf bound_ctrl:0
    v_mov_b32_dpp v155, v155 row_shr:1 row_mask:0xf bank_mask:0xf bound_ctrl:0
    v_mfma_f32_32x32x16_bf16 v[128:143], v[200:203], v[56:59], v[128:143]
    v_mov_b32_dpp v156, v156 row_shr:1 row_mask:0xf bank_mask:0xf bound_ctrl:0
    v_mov_b32_dpp v157, v157 row_shr:1 row_mask:0xf bank_mask:0xf bound_ctrl:0
    v_mfma_f32_32x32x16_bf16 v[128:143], v[204:207], v[60:63], v[128:143]
    v_mov_b32_dpp v158, v158 row_shr:1 row_mask:0xf bank_mask:0xf bound_ctrl:0
    v_mov_b32_dpp v159, v159 row_shr:1 row_mask:0xf bank_mask:0xf bound_ctrl:0
    s_waitcnt lgkmcnt(0)
    v_mfma_f32_32x32x16_bf16 v[160:175], v[208:211], v[96:99], v[160:175]
    ds_read_b64 v[176:177], v14 offset:256
    ds_read_b64 v[178:179], v14 offset:264
    ds_read_b64 v[180:181], v14 offset:288
    ds_read_b64 v[182:183], v14 offset:296
    s_nop 0
    v_mfma_f32_32x32x16_bf16 v[160:175], v[212:215], v[100:103], v[160:175]
    ds_read_b64 v[184:185], v14 offset:320
    ds_read_b64 v[186:187], v14 offset:328
    ds_read_b64 v[188:189], v14 offset:352
    s_nop 1
    v_mfma_f32_32x32x16_bf16 v[160:175], v[216:219], v[104:107], v[160:175]
    ds_read_b64 v[190:191], v14 offset:360
    ds_read_b64 v[192:193], v14 offset:384
    ds_read_b64 v[194:195], v14 offset:392
    v_mov_b32_dpp v128, v128 row_shr:1 row_mask:0xf bank_mask:0xf bound_ctrl:0
    v_mov_b32_dpp v129, v129 row_shr:1 row_mask:0xf bank_mask:0xf bound_ctrl:0
    v_mov_b32_dpp v130, v130 row_shr:1 row_mask:0xf bank_mask:0xf bound_ctrl:0
    v_mfma_f32_32x32x16_bf16 v[160:175], v[220:223], v[108:111], v[160:175]
    ds_read_b64 v[196:197], v14 offset:416
    ds_read_b64 v[198:199], v14 offset:424
    ds_read_b64 v[200:201], v14 offset:448
    v_mov_b32_dpp v131, v131 row_shr:1 row_mask:0xf bank_mask:0xf bound_ctrl:0
    v_mov_b32_dpp v132, v132 row_shr:1 row_mask:0xf bank_mask:0xf bound_ctrl:0
    v_mov_b32_dpp v133, v133 row_shr:1 row_mask:0xf bank_mask:0xf bound_ctrl:0
    v_mfma_f32_32x32x16_bf16 v[160:175], v[224:227], v[112:115], v[160:175]
    ds_read_b64 v[202:203], v14 offset:456
    ds_read_b64 v[204:205], v14 offset:480
    ds_read_b64 v[206:207], v14 offset:488
    v_mov_b32_dpp v134, v134 row_shr:1 row_mask:0xf bank_mask:0xf bound_ctrl:0
    v_mov_b32_dpp v135, v135 row_shr:1 row_mask:0xf bank_mask:0xf bound_ctrl:0
    v_mov_b32_dpp v136, v136 row_shr:1 row_mask:0xf bank_mask:0xf bound_ctrl:0
    v_mfma_f32_32x32x16_bf16 v[160:175], v[228:231], v[116:119], v[160:175]
    v_mov_b32_dpp v137, v137 row_shr:1 row_mask:0xf bank_mask:0xf bound_ctrl:0
    v_mov_b32_dpp v138, v138 row_shr:1 row_mask:0xf bank_mask:0xf bound_ctrl:0
    v_mov_b32_dpp v139, v139 row_shr:1 row_mask:0xf bank_mask:0xf bound_ctrl:0
    v_mfma_f32_32x32x16_bf16 v[160:175], v[232:235], v[120:123], v[160:175]
    v_mov_b32_dpp v140, v140 row_shr:1 row_mask:0xf bank_mask:0xf bound_ctrl:0
    v_mov_b32_dpp v141, v141 row_shr:1 row_mask:0xf bank_mask:0xf bound_ctrl:0
    v_mfma_f32_32x32x16_bf16 v[160:175], v[236:239], v[124:127], v[160:175]
    v_mov_b32_dpp v142, v142 row_shr:1 row_mask:0xf bank_mask:0xf bound_ctrl:0
    v_mov_b32_dpp v143, v143 row_shr:1 row_mask:0xf bank_mask:0xf bound_ctrl:0
    s_waitcnt lgkmcnt(0)
    v_mfma_f32_32x32x16_bf16 v[144:159], v[176:179], v[64:67], v[144:159]
    ds_read_b64 v[208:209], v14 offset:2304
    ds_read_b64 v[210:211], v14 offset:2312
    s_nop 2
    v_mfma_f32_32x32x16_bf16 v[144:159], v[180:183], v[68:71], v[144:159]
    ds_read_b64 v[212:213], v14 offset:2336
    ds_read_b64 v[214:215], v14 offset:2344
    s_nop 2
    v_mfma_f32_32x32x16_bf16 v[144:159], v[184:187], v[72:75], v[144:159]
    ds_read_b64 v[216:217], v14 offset:2368
    ds_read_b64 v[218:219], v14 offset:2376
    v_and_b32_dpp v160, v160, v15 row_shr:1 row_mask:0xf bank_mask:0xf bound_ctrl:0
    v_and_b32_dpp v161, v161, v15 row_shr:1 row_mask:0xf bank_mask:0xf bound_ctrl:0
    v_and_b32_dpp v162, v162, v15 row_shr:1 row_mask:0xf bank_mask:0xf bound_ctrl:0
    v_mfma_f32_32x32x16_bf16 v[144:159], v[188:191], v[76:79], v[144:159]
    ds_read_b64 v[220:221], v14 offset:2400
    ds_read_b64 v[222:223], v14 offset:2408
    v_and_b32_dpp v163, v163, v15 row_shr:1 row_mask:0xf bank_mask:0xf bound_ctrl:0
    v_and_b32_dpp v164, v164, v15 row_shr:1 row_mask:0xf bank_mask:0xf bound_ctrl:0
    v_and_b32_dpp v165, v165, v15 row_shr:1 row_mask:0xf bank_mask:0xf bound_ctrl:0
    v_mfma_f32_32x32x16_bf16 v[144:159], v[192:195], v[80:83], v[144:159]
    ds_read_b64 v[224:225], v14 offset:2432
    ds_read_b64 v[226:227], v14 offset:2440
    v_and_b32_dpp v166, v166, v15 row_shr:1 row_mask:0xf bank_mask:0xf bound_ctrl:0
    v_and_b32_dpp v167, v167, v15 row_shr:1 row_mask:0xf bank_mask:0xf bound_ctrl:0
    v_and_b32_dpp v168, v168, v15 row_shr:1 row_mask:0xf bank_mask:0xf bound_ctrl:0
    v_mfma_f32_32x32x16_bf16 v[144:159], v[196:199], v[84:87], v[144:159]
    ds_read_b64 v[228:229], v14 offset:2464
    ds_read_b64 v[230:231], v14 offset:2472
    v_and_b32_dpp v169, v169, v15 row_shr:1 row_mask:0xf bank_mask:0xf bound_ctrl:0
    v_and_b32_dpp v170, v170, v15 row_shr:1 row_mask:0xf bank_mask:0xf bound_ctrl:0
    v_and_b32_dpp v171, v171, v15 row_shr:1 row_mask:0xf bank_mask:0xf bound_ctrl:0
    v_mfma_f32_32x32x16_bf16 v[144:159], v[200:203], v[88:91], v[144:159]
    ds_read_b64 v[232:233], v14 offset:2496
    ds_read_b64 v[234:235], v14 offset:2504
    v_and_b32_dpp v172, v172, v15 row_shr:1 row_mask:0xf bank_mask:0xf bound_ctrl:0
    v_and_b32_dpp v173, v173, v15 row_shr:1 row_mask:0xf bank_mask:0xf bound_ctrl:0
    v_mfma_f32_32x32x16_bf16 v[144:159], v[204:207], v[92:95], v[144:159]
    ds_read_b64 v[236:237], v14 offset:2528
    ds_read_b64 v[238:239], v14 offset:2536
    v_and_b32_dpp v174, v174, v15 row_shr:1 row_mask:0xf bank_mask:0xf bound_ctrl:0
    v_and_b32_dpp v175, v175, v15 row_shr:1 row_mask:0xf bank_mask:0xf bound_ctrl:0
    v_mfma_f32_32x32x16_bf16 v[128:143], v[176:179], v[32:35], v[128:143]
    s_nop 4
    v_mfma_f32_32x32x16_bf16 v[128:143], v[180:183], v[36:39], v[128:143]
    s_nop 4
    v_mfma_f32_32x32x16_bf16 v[128:143], v[184:187], v[40:43], v[128:143]
    v_mov_b32_dpp v144, v144 row_shr:1 row_mask:0xf bank_mask:0xf bound_ctrl:0
    v_mov_b32_dpp v145, v145 row_shr:1 row_mask:0xf bank_mask:0xf bound_ctrl:0
    v_mov_b32_dpp v146, v146 row_shr:1 row_mask:0xf bank_mask:0xf bound_ctrl:0
    v_mfma_f32_32x32x16_bf16 v[128:143], v[188:191], v[44:47], v[128:143]
    v_mov_b32_dpp v147, v147 row_shr:1 row_mask:0xf bank_mask:0xf bound_ctrl:0
    v_mov_b32_dpp v148, v148 row_shr:1 row_mask:0xf bank_mask:0xf bound_ctrl:0
    v_mov_b32_dpp v149, v149 row_shr:1 row_mask:0xf bank_mask:0xf bound_ctrl:0
    v_mfma_f32_32x32x16_bf16 v[128:143], v[192:195], v[48:51], v[128:143]
    v_mov_b32_dpp v150, v150 row_shr:1 row_mask:0xf bank_mask:0xf bound_ctrl:0
    v_mov_b32_dpp v151, v151 row_shr:1 row_mask:0xf bank_mask:0xf bound_ctrl:0
    v_mov_b32_dpp v152, v152 row_shr:1 row_mask:0xf bank_mask:0xf bound_ctrl:0
    v_mfma_f32_32x32x16_bf16 v[128:143], v[196:199], v[52:55], v[128:143]
    v_mov_b32_dpp v153, v153 row_shr:1 row_mask:0xf bank_mask:0xf bound_ctrl:0
    v_mov_b32_dpp v154, v154 row_shr:1 row_mask:0xf bank_mask:0xf bound_ctrl:0
    v_mov_b32_dpp v155, v155 row_shr:1 row_mask:0xf bank_mask:0xf bound_ctrl:0
    v_mfma_f32_32x32x16_bf16 v[128:143], v[200:203], v[56:59], v[128:143]
    v_mov_b32_dpp v156, v156 row_shr:1 row_mask:0xf bank_mask:0xf bound_ctrl:0
    v_mov_b32_dpp v157, v157 row_shr:1 row_mask:0xf bank_mask:0xf bound_ctrl:0
    v_mfma_f32_32x32x16_bf16 v[128:143], v[204:207], v[60:63], v[128:143]
    v_mov_b32_dpp v158, v158 row_shr:1 row_mask:0xf bank_mask:0xf bound_ctrl:0
    v_mov_b32_dpp v159, v159 row_shr:1 row_mask:0xf bank_mask:0xf bound_ctrl:0
    s_waitcnt lgkmcnt(0)
    v_mfma_f32_32x32x16_bf16 v[160:175], v[208:211], v[96:99], v[160:175]
    ds_read_b64 v[176:177], v14 offset:0
    ds_read_b64 v[178:179], v14 offset:8
    ds_read_b64 v[180:181], v14 offset:32
    ds_read_b64 v[182:183], v14 offset:40
    s_nop 0
    v_mfma_f32_32x32x16_bf16 v[160:175], v[212:215], v[100:103], v[160:175]
    ds_read_b64 v[184:185], v14 offset:64
    ds_read_b64 v[186:187], v14 offset:72
    ds_read_b64 v[188:189], v14 offset:96
    s_nop 1
    v_mfma_f32_32x32x16_bf16 v[160:175], v[216:219], v[104:107], v[160:175]
    ds_read_b64 v[190:191], v14 offset:104
    ds_read_b64 v[192:193], v14 offset:128
    ds_read_b64 v[194:195], v14 offset:136
    v_mov_b32_dpp v128, v128 row_shr:1 row_mask:0xf bank_mask:0xf bound_ctrl:0
    v_mov_b32_dpp v129, v129 row_shr:1 row_mask:0xf bank_mask:0xf bound_ctrl:0
    v_mov_b32_dpp v130, v130 row_shr:1 row_mask:0xf bank_mask:0xf bound_ctrl:0
    v_mfma_f32_32x32x16_bf16 v[160:175], v[220:223], v[108:111], v[160:175]
    ds_read_b64 v[196:197], v14 offset:160
    ds_read_b64 v[198:199], v14 offset:168
    ds_read_b64 v[200:201], v14 offset:192
    v_mov_b32_dpp v131, v131 row_shr:1 row_mask:0xf bank_mask:0xf bound_ctrl:0
    v_mov_b32_dpp v132, v132 row_shr:1 row_mask:0xf bank_mask:0xf bound_ctrl:0
    v_mov_b32_dpp v133, v133 row_shr:1 row_mask:0xf bank_mask:0xf bound_ctrl:0
    v_mfma_f32_32x32x16_bf16 v[160:175], v[224:227], v[112:115], v[160:175]
    ds_read_b64 v[202:203], v14 offset:200
    ds_read_b64 v[204:205], v14 offset:224
    ds_read_b64 v[206:207], v14 offset:232
    v_mov_b32_dpp v134, v134 row_shr:1 row_mask:0xf bank_mask:0xf bound_ctrl:0
    v_mov_b32_dpp v135, v135 row_shr:1 row_mask:0xf bank_mask:0xf bound_ctrl:0
    v_mov_b32_dpp v136, v136 row_shr:1 row_mask:0xf bank_mask:0xf bound_ctrl:0
    v_mfma_f32_32x32x16_bf16 v[160:175], v[228:231], v[116:119], v[160:175]
    v_mov_b32_dpp v137, v137 row_shr:1 row_mask:0xf bank_mask:0xf bound_ctrl:0
    v_mov_b32_dpp v138, v138 row_shr:1 row_mask:0xf bank_mask:0xf bound_ctrl:0
    v_mov_b32_dpp v139, v139 row_shr:1 row_mask:0xf bank_mask:0xf bound_ctrl:0
    v_mfma_f32_32x32x16_bf16 v[160:175], v[232:235], v[120:123], v[160:175]
    v_mov_b32_dpp v140, v140 row_shr:1 row_mask:0xf bank_mask:0xf bound_ctrl:0
    v_mov_b32_dpp v141, v141 row_shr:1 row_mask:0xf bank_mask:0xf bound_ctrl:0
    v_mfma_f32_32x32x16_bf16 v[160:175], v[236:239], v[124:127], v[160:175]
    v_mov_b32_dpp v142, v142 row_shr:1 row_mask:0xf bank_mask:0xf bound_ctrl:0
    v_mov_b32_dpp v143, v143 row_shr:1 row_mask:0xf bank_mask:0xf bound_ctrl:0
    s_waitcnt lgkmcnt(0)
    v_mfma_f32_32x32x16_bf16 v[144:159], v[176:179], v[64:67], v[144:159]
    ds_read_b64 v[208:209], v14 offset:2048
    ds_read_b64 v[210:211], v14 offset:2056
    s_nop 2
    v_mfma_f32_32x32x16_bf16 v[144:159], v[180:183], v[68:71], v[144:159]
    ds_read_b64 v[212:213], v14 offset:2080
    ds_read_b64 v[214:215], v14 offset:2088
    s_nop 2
    v_mfma_f32_32x32x16_bf16 v[144:159], v[184:187], v[72:75], v[144:159]
    ds_read_b64 v[216:217], v14 offset:2112
    ds_read_b64 v[218:219], v14 offset:2120
    v_and_b32_dpp v160, v160, v15 row_shr:1 row_mask:0xf bank_mask:0xf bound_ctrl:0
    v_and_b32_dpp v161, v161, v15 row_shr:1 row_mask:0xf bank_mask:0xf bound_ctrl:0
    v_and_b32_dpp v162, v162, v15 row_shr:1 row_mask:0xf bank_mask:0xf bound_ctrl:0
    v_mfma_f32_32x32x16_bf16 v[144:159], v[188:191], v[76:79], v[144:159]
    ds_read_b64 v[220:221], v14 offset:2144
    ds_read_b64 v[222:223], v14 offset:2152
    v_and_b32_dpp v163, v163, v15 row_shr:1 row_mask:0xf bank_mask:0xf bound_ctrl:0
    v_and_b32_dpp v164, v164, v15 row_shr:1 row_mask:0xf bank_mask:0xf bound_ctrl:0
    v_and_b32_dpp v165, v165, v15 row_shr:1 row_mask:0xf bank_mask:0xf bound_ctrl:0
    v_mfma_f32_32x32x16_bf16 v[144:159], v[192:195], v[80:83], v[144:159]
    ds_read_b64 v[224:225], v14 offset:2176
    ds_read_b64 v[226:227], v14 offset:2184
    v_and_b32_dpp v166, v166, v15 row_shr:1 row_mask:0xf bank_mask:0xf bound_ctrl:0
    v_and_b32_dpp v167, v167, v15 row_shr:1 row_mask:0xf bank_mask:0xf bound_ctrl:0
    v_and_b32_dpp v168, v168, v15 row_shr:1 row_mask:0xf bank_mask:0xf bound_ctrl:0
    v_mfma_f32_32x32x16_bf16 v[144:159], v[196:199], v[84:87], v[144:159]
    ds_read_b64 v[228:229], v14 offset:2208
    ds_read_b64 v[230:231], v14 offset:2216
    v_and_b32_dpp v169, v169, v15 row_shr:1 row_mask:0xf bank_mask:0xf bound_ctrl:0
    v_and_b32_dpp v170, v170, v15 row_shr:1 row_mask:0xf bank_mask:0xf bound_ctrl:0
    v_and_b32_dpp v171, v171, v15 row_shr:1 row_mask:0xf bank_mask:0xf bound_ctrl:0
    v_mfma_f32_32x32x16_bf16 v[144:159], v[200:203], v[88:91], v[144:159]
    ds_read_b64 v[232:233], v14 offset:2240
    ds_read_b64 v[234:235], v14 offset:2248
    v_and_b32_dpp v172, v172, v15 row_shr:1 row_mask:0xf bank_mask:0xf bound_ctrl:0
    v_and_b32_dpp v173, v173, v15 row_shr:1 row_mask:0xf bank_mask:0xf bound_ctrl:0
    v_mfma_f32_32x32x16_bf16 v[144:159], v[204:207], v[92:95], v[144:159]
    ds_read_b64 v[236:237], v14 offset:2272
    ds_read_b64 v[238:239], v14 offset:2280
    v_and_b32_dpp v174, v174, v15 row_shr:1 row_mask:0xf bank_mask:0xf bound_ctrl:0
    v_and_b32_dpp v175, v175, v15 row_shr:1 row_mask:0xf bank_mask:0xf bound_ctrl:0
    v_mfma_f32_32x32x16_bf16 v[128:143], v[176:179], v[32:35], v[128:143]
    v_mfma_f32_32x32x16_bf16 v[128:143], v[180:183], v[36:39], v[128:143]
    v_mfma_f32_32x32x16_bf16 v[128:143], v[184:187], v[40:43], v[128:143]
    v_mul_u32_u24 v16, 272, v7
    v_add_u32 v16, s34, v16
    v_add_u32 v16, 4388, v16
    v_lshlrev_b32 v17, 2, v8
    v_sub_u32 v16, v16, v17
    v_lshlrev_b32 v17, 5, v9
    v_sub_u32 v16, v16, v17
    v_mfma_f32_32x32x16_bf16 v[128:143], v[188:191], v[44:47], v[128:143]
    ds_read_b32 v64, v16 offset:216
    ds_read_b32 v65, v16 offset:208
    ds_read_b32 v66, v16 offset:200
    ds_read_b32 v67, v16 offset:192
    ds_read_b32 v68, v16 offset:152
    ds_read_b32 v69, v16 offset:144
    v_mfma_f32_32x32x16_bf16 v[128:143], v[192:195], v[48:51], v[128:143]
    ds_read_b32 v70, v16 offset:136
    ds_read_b32 v71, v16 offset:128
    ds_read_b32 v72, v16 offset:88
    ds_read_b32 v73, v16 offset:80
    ds_read_b32 v74, v16 offset:72
    ds_read_b32 v75, v16 offset:64
    v_mfma_f32_32x32x16_bf16 v[128:143], v[196:199], v[52:55], v[128:143]
    ds_read_b32 v76, v16 offset:24
    ds_read_b32 v77, v16 offset:16
    ds_read_b32 v78, v16 offset:8
    ds_read_b32 v79, v16 offset:0
    s_lshr_b32 s44, s20, 1
    s_and_b32 s45, s20, 1
    v_mfma_f32_32x32x16_bf16 v[128:143], v[200:203], v[56:59], v[128:143]
    s_cmp_eq_u32 s44, 1
    s_cselect_b32 s44, s33, s32
    s_lshl_b32 s46, s44, 16
    s_and_b32 s47, s44, 0xffff0000
    s_cmp_eq_u32 s45, 1
    s_cselect_b32 s44, s47, s46
    v_mfma_f32_32x32x16_bf16 v[128:143], v[204:207], v[60:63], v[128:143]
    v_mul_u32_u24 v18, 264, v7
    v_lshl_add_u32 v18, v9, 5, v18
    v_lshl_add_u32 v18, v8, 2, v18
    v_add_u32 v18, s34, v18
    v_mul_u32_u24 v17, 264, v2
    v_lshl_add_u32 v17, v1, 2, v17
    s_waitcnt lgkmcnt(0)
    v_mfma_f32_32x32x16_bf16 v[160:175], v[208:211], v[96:99], v[160:175]
    v_mfma_f32_32x32x16_bf16 v[160:175], v[212:215], v[100:103], v[160:175]
    v_mfma_f32_32x32x16_bf16 v[160:175], v[216:219], v[104:107], v[160:175]
    v_and_b32 v80, 0xffff0000, v64
    v_lshlrev_b32 v64, 16, v64
    v_and_b32 v81, 0xffff0000, v65
    v_lshlrev_b32 v65, 16, v65
    v_and_b32 v82, 0xffff0000, v66
    v_lshlrev_b32 v66, 16, v66
    v_mfma_f32_32x32x16_bf16 v[160:175], v[220:223], v[108:111], v[160:175]
    v_and_b32 v83, 0xffff0000, v67
    v_lshlrev_b32 v67, 16, v67
    v_and_b32 v84, 0xffff0000, v68
    v_lshlrev_b32 v68, 16, v68
    v_and_b32 v85, 0xffff0000, v69
    v_lshlrev_b32 v69, 16, v69
    v_mfma_f32_32x32x16_bf16 v[160:175], v[224:227], v[112:115], v[160:175]
    v_and_b32 v86, 0xffff0000, v70
    v_lshlrev_b32 v70, 16, v70
    v_and_b32 v87, 0xffff0000, v71
    v_lshlrev_b32 v71, 16, v71
    v_and_b32 v88, 0xffff0000, v72
    v_mfma_f32_32x32x16_bf16 v[160:175], v[228:231], v[116:119], v[160:175]
    v_lshlrev_b32 v72, 16, v72
    v_and_b32 v89, 0xffff0000, v73
    v_lshlrev_b32 v73, 16, v73
    v_and_b32 v90, 0xffff0000, v74
    v_lshlrev_b32 v74, 16, v74
    v_mfma_f32_32x32x16_bf16 v[160:175], v[232:235], v[120:123], v[160:175]
    v_and_b32 v91, 0xffff0000, v75
    v_lshlrev_b32 v75, 16, v75
    v_and_b32 v92, 0xffff0000, v76
    v_lshlrev_b32 v76, 16, v76
    v_and_b32 v93, 0xffff0000, v77
    v_mfma_f32_32x32x16_bf16 v[160:175], v[236:239], v[124:127], v[160:175]
    v_lshlrev_b32 v77, 16, v77
    v_and_b32 v94, 0xffff0000, v78
    v_lshlrev_b32 v78, 16, v78
    v_and_b32 v95, 0xffff0000, v79
    v_lshlrev_b32 v79, 16, v79
    s_mov_b32 s48, 0x05040100
    s_mov_b32 s49, 0x07060302
    s_nop 11
    v_add_f32_dpp v128, v160, v128 row_shr:8 row_mask:0xf bank_mask:0xf bound_ctrl:0
    v_add_f32_dpp v129, v161, v129 row_shr:8 row_mask:0xf bank_mask:0xf bound_ctrl:0
    v_add_f32_dpp v130, v162, v130 row_shr:8 row_mask:0xf bank_mask:0xf bound_ctrl:0
    v_add_f32_dpp v131, v163, v131 row_shr:8 row_mask:0xf bank_mask:0xf bound_ctrl:0
    v_add_f32_dpp v132, v164, v132 row_shr:8 row_mask:0xf bank_mask:0xf bound_ctrl:0
    v_add_f32_dpp v133, v165, v133 row_shr:8 row_mask:0xf bank_mask:0xf bound_ctrl:0
    v_add_f32_dpp v134, v166, v134 row_shr:8 row_mask:0xf bank_mask:0xf bound_ctrl:0
    v_add_f32_dpp v135, v167, v135 row_shr:8 row_mask:0xf bank_mask:0xf bound_ctrl:0
    v_add_f32_dpp v136, v168, v136 row_shr:8 row_mask:0xf bank_mask:0xf bound_ctrl:0
    v_add_f32_dpp v137, v169, v137 row_shr:8 row_mask:0xf bank_mask:0xf bound_ctrl:0
    v_add_f32_dpp v138, v170, v138 row_shr:8 row_mask:0xf bank_mask:0xf bound_ctrl:0
    v_add_f32_dpp v139, v171, v139 row_shr:8 row_mask:0xf bank_mask:0xf bound_ctrl:0
    v_add_f32_dpp v140, v172, v140 row_shr:8 row_mask:0xf bank_mask:0xf bound_ctrl:0
    v_add_f32_dpp v141, v173, v141 row_shr:8 row_mask:0xf bank_mask:0xf bound_ctrl:0
    v_add_f32_dpp v142, v174, v142 row_shr:8 row_mask:0xf bank_mask:0xf bound_ctrl:0
    v_add_f32_dpp v143, v175, v143 row_shr:8 row_mask:0xf bank_mask:0xf bound_ctrl:0
    s_mov_b32 s42, 0xff00ff00
    s_mov_b32 s43, 0xff00ff00
    s_mov_b64 exec, s[42:43]
    v_add_f32 v144, v160, v144
    v_add_f32 v145, v161, v145
    v_add_f32 v146, v162, v146
    v_add_f32 v147, v163, v147
    v_add_f32 v148, v164, v148
    v_add_f32 v149, v165, v149
    v_add_f32 v150, v166, v150
    v_add_f32 v151, v167, v151
    v_add_f32 v152, v168, v152
    v_add_f32 v153, v169, v153
    v_add_f32 v154, v170, v154
    v_add_f32 v155, v171, v155
    v_add_f32 v156, v172, v156
    v_add_f32 v157, v173, v157
    v_add_f32 v158, v174, v158
    v_add_f32 v159, v175, v159
    s_mov_b64 exec, -1
    v_fma_f32 v128, v80, s44, v128
    v_fma_f32 v144, v64, s44, v144
    v_fma_f32 v129, v81, s44, v129
    v_fma_f32 v145, v65, s44, v145
    v_fma_f32 v130, v82, s44, v130
    v_fma_f32 v146, v66, s44, v146
    v_fma_f32 v131, v83, s44, v131
    v_fma_f32 v147, v67, s44, v147
    v_fma_f32 v132, v84, s44, v132
    v_fma_f32 v148, v68, s44, v148
    v_fma_f32 v133, v85, s44, v133
    v_fma_f32 v149, v69, s44, v149
    v_fma_f32 v134, v86, s44, v134
    v_fma_f32 v150, v70, s44, v150
    v_fma_f32 v135, v87, s44, v135
    v_fma_f32 v151, v71, s44, v151
    v_fma_f32 v136, v88, s44, v136
    v_fma_f32 v152, v72, s44, v152
    v_fma_f32 v137, v89, s44, v137
    v_fma_f32 v153, v73, s44, v153
    v_fma_f32 v138, v90, s44, v138
    v_fma_f32 v154, v74, s44, v154
    v_fma_f32 v139, v91, s44, v139
    v_fma_f32 v155, v75, s44, v155
    v_fma_f32 v140, v92, s44, v140
    v_fma_f32 v156, v76, s44, v156
    v_fma_f32 v141, v93, s44, v141
    v_fma_f32 v157, v77, s44, v157
    v_fma_f32 v142, v94, s44, v142
    v_fma_f32 v158, v78, s44, v158
    v_fma_f32 v143, v95, s44, v143
    v_fma_f32 v159, v79, s44, v159
    v_cvt_pk_bf16_f32 v32, v128, v144
    v_cvt_pk_bf16_f32 v33, v129, v145
    v_cvt_pk_bf16_f32 v34, v130, v146
    v_cvt_pk_bf16_f32 v35, v131, v147
    v_cvt_pk_bf16_f32 v36, v132, v148
    v_cvt_pk_bf16_f32 v37, v133, v149
    v_cvt_pk_bf16_f32 v38, v134, v150
    v_cvt_pk_bf16_f32 v39, v135, v151
    v_cvt_pk_bf16_f32 v40, v136, v152
    v_cvt_pk_bf16_f32 v41, v137, v153
    v_cvt_pk_bf16_f32 v42, v138, v154
    v_cvt_pk_bf16_f32 v43, v139, v155
    v_cvt_pk_bf16_f32 v44, v140, v156
    v_cvt_pk_bf16_f32 v45, v141, v157
    v_cvt_pk_bf16_f32 v46, v142, v158
    v_cvt_pk_bf16_f32 v47, v143, v159
    ds_write_b32 v18, v32 offset:0
    ds_write_b32 v18, v33 offset:8
    ds_write_b32 v18, v34 offset:16
    ds_write_b32 v18, v35 offset:24
    ds_write_b32 v18, v36 offset:64
    ds_write_b32 v18, v37 offset:72
    ds_write_b32 v18, v38 offset:80
    ds_write_b32 v18, v39 offset:88
    ds_write_b32 v18, v40 offset:128
    ds_write_b32 v18, v41 offset:136
    ds_write_b32 v18, v42 offset:144
    ds_write_b32 v18, v43 offset:152
    ds_write_b32 v18, v44 offset:192
    ds_write_b32 v18, v45 offset:200
    ds_write_b32 v18, v46 offset:208
    ds_write_b32 v18, v47 offset:216
    s_waitcnt lgkmcnt(0)
    s_barrier
    ds_read_b32 v48, v17 offset:0
    ds_read_b32 v49, v17 offset:9472
    ds_read_b32 v50, v17 offset:18944
    ds_read_b32 v51, v17 offset:28416
    ds_read_b32 v52, v17 offset:1056
    ds_read_b32 v53, v17 offset:10528
    ds_read_b32 v54, v17 offset:20000
    ds_read_b32 v55, v17 offset:29472
    ds_read_b32 v56, v17 offset:2112
    ds_read_b32 v57, v17 offset:11584
    ds_read_b32 v58, v17 offset:21056
    ds_read_b32 v59, v17 offset:30528
    ds_read_b32 v60, v17 offset:3168
    ds_read_b32 v61, v17 offset:12640
    ds_read_b32 v62, v17 offset:22112
    ds_read_b32 v63, v17 offset:31584
    s_waitcnt lgkmcnt(0)
    v_perm_b32 v96, v49, v48, s48
    v_perm_b32 v98, v49, v48, s49
    v_perm_b32 v97, v51, v50, s48
    v_perm_b32 v99, v51, v50, s49
    v_perm_b32 v100, v53, v52, s48
    v_perm_b32 v102, v53, v52, s49
    v_perm_b32 v101, v55, v54, s48
    v_perm_b32 v103, v55, v54, s49
    v_perm_b32 v104, v57, v56, s48
    v_perm_b32 v106, v57, v56, s49
    v_perm_b32 v105, v59, v58, s48
    v_perm_b32 v107, v59, v58, s49
    v_perm_b32 v108, v61, v60, s48
    v_perm_b32 v110, v61, v60, s49
    v_perm_b32 v109, v63, v62, s48
    v_perm_b32 v111, v63, v62, s49
    v_lshrrev_b32 v20, 3, v0
    v_lshrrev_b32 v21, 4, v20
    v_and_b32 v22, 15, v20
    v_mul_u32_u24 v23, 20480, v20
    v_sub_u32 v23, v4, v23
    s_mov_b32 s40, 1601536
    v_mul_lo_u32 v24, v21, s40
    v_add_u32 v24, v24, v23
    v_add_u32 v25, 1, v22
    v_mul_u32_u24 v25, 20480, v25
    v_add_u32 v25, v25, v24
    v_cmp_eq_u32 s[42:43], 15, v22
    v_cmp_eq_u32 s[44:45], 0, v22
    v_add_u32 v26, 3203072, v24
    v_add_u32 v27, 348160, v24
    v_cndmask_b32 v26, v27, v26, s[42:43]
    v_cmp_ne_u32 vcc, 0, v20
    s_and_b64 s[46:47], s[44:45], vcc
    s_or_b64 s[46:47], s[46:47], s[42:43]
    v_cmp_ne_u32 vcc, 31, v20
    s_and_b64 s[52:53], s[42:43], vcc
    s_or_b64 s[52:53], s[52:53], s[44:45]
    s_or_b64 s[44:45], s[44:45], s[42:43]
    s_add_u32 s39, s38, 9060352
    buffer_store_dwordx4 v[96:99], v25, s[28:31], s39 offen sc1
    s_mov_b64 exec, s[46:47]
    s_cbranch_execz k1_kernel_halo9
    s_sub_u32 s41, s39, 1601536
    buffer_store_dwordx4 v[96:99], v26, s[28:31], s41 offen sc1
k1_kernel_halo9:
    s_mov_b64 exec, -1
    s_add_u32 s39, s39, 3203072
    buffer_store_dwordx4 v[100:103], v25, s[28:31], s39 offen sc1
    s_mov_b64 exec, s[44:45]
    s_cbranch_execz k1_kernel_halo10
    s_sub_u32 s41, s39, 1601536
    buffer_store_dwordx4 v[100:103], v26, s[28:31], s41 offen sc1
k1_kernel_halo10:
    s_mov_b64 exec, -1
    s_add_u32 s39, s39, 3203072
    buffer_store_dwordx4 v[104:107], v25, s[28:31], s39 offen sc1
    s_mov_b64 exec, s[44:45]
    s_cbranch_execz k1_kernel_halo11
    s_sub_u32 s41, s39, 1601536
    buffer_store_dwordx4 v[104:107], v26, s[28:31], s41 offen sc1
k1_kernel_halo11:
    s_mov_b64 exec, -1
    s_add_u32 s39, s39, 3203072
    buffer_store_dwordx4 v[108:111], v25, s[28:31], s39 offen sc1
    s_mov_b64 exec, s[52:53]
    s_cbranch_execz k1_kernel_halo12
    s_sub_u32 s41, s39, 1601536
    buffer_store_dwordx4 v[108:111], v26, s[28:31], s41 offen sc1
k1_kernel_halo12:
    s_mov_b64 exec, -1
    s_add_u32 s39, s39, 3203072
    s_waitcnt vmcnt(0)
    s_endpgm
k1_side:
    s_cmp_ge_u32 s54, 188
    s_cbranch_scc1 k1_end
    s_cmp_lt_u32 s54, 128
    s_cbranch_scc1 k1_kernel_sx13
    s_mov_b32 s61, s54
    s_cmp_lg_u32 s20, 0
    s_cbranch_scc1 k1_kernel_sw15
    s_and_b32 s55, s2, 7
    s_lshl_b32 s57, s55, 9
    s_add_u32 s57, s57, 9056256
    v_mov_b32 v250, 0
    v_and_b32 v248, 31, v0
    v_lshlrev_b32 v248, 2, v248
    s_waitcnt lgkmcnt(0)
    s_mov_b32 s28, s10
    s_mov_b32 s29, s11
    s_mov_b32 s30, 268435456
    s_mov_b32 s31, 0x00020000
    buffer_load_dword v251, v250, s[28:31], s57 offen sc1
    s_mov_b32 s23, 30
    s_waitcnt vmcnt(0)
    v_add_u32 v251, 1, v251
k1_kernel_sw14:
    buffer_load_dword v249, v248, s[28:31], s57 offen offset:256 sc1
    s_waitcnt vmcnt(0)
    v_cmp_eq_u32 vcc, v251, v249
    s_sub_u32 s23, s23, 1
    s_cmp_eq_u64 vcc, -1
    s_cbranch_scc1 k1_kernel_sw15
    s_sleep 16
    s_cmp_lg_u32 s23, 0
    s_cbranch_scc1 k1_kernel_sw14
k1_kernel_sw15:
    s_barrier
    s_mov_b32 s54, s61
k1_kernel_sx13:
    s_cmp_lt_u32 s54, 128
    s_cbranch_scc1 k1_pf
    s_branch k1_mod0
k1_side2:
    s_load_dwordx2 s[10:11], s[0:1], 120
    s_load_dwordx8 s[12:19], s[0:1], 56
    v_lshrrev_b32 v2, 6, v0
    v_and_b32 v1, 63, v0
    v_readfirstlane_b32 s20, v2
    s_waitcnt lgkmcnt(0)
    s_mov_b32 s28, s10
    s_mov_b32 s29, s11
    s_mov_b32 s30, 268435456
    s_mov_b32 s31, 0x00020000
    s_sub_u32 s21, s54, 0
    v_lshrrev_b32 v3, 3, v0
    v_and_b32 v4, 7, v0
    v_mul_u32_u24 v5, 144, v3
    v_lshl_add_u32 v5, v4, 4, v5
    v_and_b32 v6, 15, v1
    v_lshrrev_b32 v7, 4, v1
    v_lshrrev_b32 v8, 2, v6
    v_lshl_add_u32 v8, v7, 3, v8
    v_mul_u32_u24 v8, 144, v8
    v_and_b32 v9, 3, v6
    v_lshl_add_u32 v8, v9, 3, v8
    s_lshl_b32 s22, s20, 5
    v_add_u32 v8, s22, v8
    v_lshlrev_b32 v9, 4, v1
    s_cmp_lt_u32 s21, 10
    s_cbranch_scc1 k1_kernel_pk16
    s_cmp_lt_u32 s21, 20
    s_cbranch_scc1 k1_kernel_pk17
    s_cmp_lt_u32 s21, 48
    s_cbranch_scc1 k1_kernel_pk18
    s_cmp_lt_u32 s21, 78
    s_cbranch_scc1 k1_kernel_pk19
    s_branch k1_kernel_pke20
k1_kernel_pk16:
    s_mov_b32 s24, s12
    s_mov_b32 s25, s13
    s_mov_b32 s26, 819200
    s_mov_b32 s27, 0x00020000
    s_sub_u32 s32, s21, 0
    s_mul_i32 s33, s32, 52429
    s_lshr_b32 s33, s33, 18
    s_mul_i32 s34, s33, 5
    s_sub_u32 s34, s32, s34
    s_lshl_b32 s34, s34, 1
    v_mul_u32_u24 v10, 1280, v3
    v_lshl_add_u32 v10, v4, 4, v10
    s_mul_i32 s35, s33, 409600
    s_lshl_b32 s36, s34, 7
    s_add_u32 s35, s35, s36
    buffer_load_dwordx4 v[32:35], v10, s[24:27], s35 offen offset:0
    s_add_u32 s35, s35, 40960
    buffer_load_dwordx4 v[36:39], v10, s[24:27], s35 offen offset:0
    s_add_u32 s35, s35, 40960
    buffer_load_dwordx4 v[40:43], v10, s[24:27], s35 offen offset:0
    s_add_u32 s35, s35, 40960
    buffer_load_dwordx4 v[44:47], v10, s[24:27], s35 offen offset:0
    s_add_u32 s35, s35, 40960
    buffer_load_dwordx4 v[48:51], v10, s[24:27], s35 offen offset:0
    s_add_u32 s35, s35, 40960
    buffer_load_dwordx4 v[52:55], v10, s[24:27], s35 offen offset:0
    s_add_u32 s35, s35, 40960
    buffer_load_dwordx4 v[56:59], v10, s[24:27], s35 offen offset:0
    s_add_u32 s35, s35, 40960
    buffer_load_dwordx4 v[60:63], v10, s[24:27], s35 offen offset:0
    s_add_u32 s35, s35, 40960
    buffer_load_dwordx4 v[64:67], v10, s[24:27], s35 offen offset:0
    s_add_u32 s35, s35, 40960
    buffer_load_dwordx4 v[68:71], v10, s[24:27], s35 offen offset:0
    s_sub_u32 s35, s35, 368640
    buffer_load_dwordx4 v[72:75], v10, s[24:27], s35 offen offset:128
    s_add_u32 s35, s35, 40960
    buffer_load_dwordx4 v[76:79], v10, s[24:27], s35 offen offset:128
    s_add_u32 s35, s35, 40960
    buffer_load_dwordx4 v[80:83], v10, s[24:27], s35 offen offset:128
    s_add_u32 s35, s35, 40960
    buffer_load_dwordx4 v[84:87], v10, s[24:27], s35 offen offset:128
    s_add_u32 s35, s35, 40960
    buffer_load_dwordx4 v[88:91], v10, s[24:27], s35 offen offset:128
    s_add_u32 s35, s35, 40960
    buffer_load_dwordx4 v[92:95], v10, s[24:27], s35 offen offset:128
    s_add_u32 s35, s35, 40960
    buffer_load_dwordx4 v[96:99], v10, s[24:27], s35 offen offset:128
    s_add_u32 s35, s35, 40960
    buffer_load_dwordx4 v[100:103], v10, s[24:27], s35 offen offset:128
    s_add_u32 s35, s35, 40960
    buffer_load_dwordx4 v[104:107], v10, s[24:27], s35 offen offset:128
    s_add_u32 s35, s35, 40960
    buffer_load_dwordx4 v[108:111], v10, s[24:27], s35 offen offset:128
    s_lshl_b32 s36, s34, 2
    s_add_u32 s36, s36, s20
    s_mul_i32 s38, s36, 52429
    s_lshr_b32 s38, s38, 18
    s_mul_i32 s39, s38, 5
    s_sub_u32 s39, s36, s39
    s_mul_i32 s37, s38, 100
    s_mul_i32 s40, s33, 50
    s_add_u32 s37, s37, s40
    s_add_u32 s37, s37, s39
    s_lshl_b32 s37, s37, 10
    s_add_u32 s37, s37, 2764800
    s_waitcnt vmcnt(19)
    ds_write_b128 v5, v[32:35] offset:0
    s_waitcnt vmcnt(18)
    ds_write_b128 v5, v[36:39] offset:4608
    s_waitcnt vmcnt(17)
    ds_write_b128 v5, v[40:43] offset:9216
    s_waitcnt vmcnt(16)
    ds_write_b128 v5, v[44:47] offset:13824
    s_waitcnt vmcnt(15)
    ds_write_b128 v5, v[48:51] offset:18432
    s_waitcnt vmcnt(14)
    ds_write_b128 v5, v[52:55] offset:23040
    s_waitcnt vmcnt(13)
    ds_write_b128 v5, v[56:59] offset:27648
    s_waitcnt vmcnt(12)
    ds_write_b128 v5, v[60:63] offset:32256
    s_waitcnt vmcnt(11)
    ds_write_b128 v5, v[64:67] offset:36864
    s_waitcnt vmcnt(10)
    ds_write_b128 v5, v[68:71] offset:41472
    s_waitcnt lgkmcnt(0)
    s_barrier
    ds_read_b64_tr_b16 v[32:33], v8 offset:0
    ds_read_b64_tr_b16 v[34:35], v8 offset:576
    ds_read_b64_tr_b16 v[36:37], v8 offset:4608
    ds_read_b64_tr_b16 v[38:39], v8 offset:5184
    ds_read_b64_tr_b16 v[40:41], v8 offset:9216
    ds_read_b64_tr_b16 v[42:43], v8 offset:9792
    ds_read_b64_tr_b16 v[44:45], v8 offset:13824
    ds_read_b64_tr_b16 v[46:47], v8 offset:14400
    ds_read_b64_tr_b16 v[48:49], v8 offset:18432
    ds_read_b64_tr_b16 v[50:51], v8 offset:19008
    ds_read_b64_tr_b16 v[52:53], v8 offset:23040
    ds_read_b64_tr_b16 v[54:55], v8 offset:23616
    ds_read_b64_tr_b16 v[56:57], v8 offset:27648
    ds_read_b64_tr_b16 v[58:59], v8 offset:28224
    ds_read_b64_tr_b16 v[60:61], v8 offset:32256
    ds_read_b64_tr_b16 v[62:63], v8 offset:32832
    ds_read_b64_tr_b16 v[64:65], v8 offset:36864
    ds_read_b64_tr_b16 v[66:67], v8 offset:37440
    ds_read_b64_tr_b16 v[68:69], v8 offset:41472
    ds_read_b64_tr_b16 v[70:71], v8 offset:42048
    v_mov_b32 v12, 0
    v_mov_b32 v13, 0x3f803f80
    s_waitcnt lgkmcnt(15)
    s_add_u32 s38, s37, 0
    buffer_store_dwordx4 v[32:35], v9, s[28:31], s38 offen sc1
    v_dot2_f32_bf16 v12, v32, v13, v12
    v_dot2_f32_bf16 v12, v33, v13, v12
    v_dot2_f32_bf16 v12, v34, v13, v12
    v_dot2_f32_bf16 v12, v35, v13, v12
    s_waitcnt lgkmcnt(15)
    s_add_u32 s38, s37, 5120
    buffer_store_dwordx4 v[36:39], v9, s[28:31], s38 offen sc1
    v_dot2_f32_bf16 v12, v36, v13, v12
    v_dot2_f32_bf16 v12, v37, v13, v12
    v_dot2_f32_bf16 v12, v38, v13, v12
    v_dot2_f32_bf16 v12, v39, v13, v12
    s_waitcnt lgkmcnt(14)
    s_add_u32 s38, s37, 10240
    buffer_store_dwordx4 v[40:43], v9, s[28:31], s38 offen sc1
    v_dot2_f32_bf16 v12, v40, v13, v12
    v_dot2_f32_bf16 v12, v41, v13, v12
    v_dot2_f32_bf16 v12, v42, v13, v12
    v_dot2_f32_bf16 v12, v43, v13, v12
    s_waitcnt lgkmcnt(12)
    s_add_u32 s38, s37, 15360
    buffer_store_dwordx4 v[44:47], v9, s[28:31], s38 offen sc1
    v_dot2_f32_bf16 v12, v44, v13, v12
    v_dot2_f32_bf16 v12, v45, v13, v12
    v_dot2_f32_bf16 v12, v46, v13, v12
    v_dot2_f32_bf16 v12, v47, v13, v12
    s_waitcnt lgkmcnt(10)
    s_add_u32 s38, s37, 20480
    buffer_store_dwordx4 v[48:51], v9, s[28:31], s38 offen sc1
    v_dot2_f32_bf16 v12, v48, v13, v12
    v_dot2_f32_bf16 v12, v49, v13, v12
    v_dot2_f32_bf16 v12, v50, v13, v12
    v_dot2_f32_bf16 v12, v51, v13, v12
    s_waitcnt lgkmcnt(8)
    s_add_u32 s38, s37, 25600
    buffer_store_dwordx4 v[52:55], v9, s[28:31], s38 offen sc1
    v_dot2_f32_bf16 v12, v52, v13, v12
    v_dot2_f32_bf16 v12, v53, v13, v12
    v_dot2_f32_bf16 v12, v54, v13, v12
    v_dot2_f32_bf16 v12, v55, v13, v12
    s_waitcnt lgkmcnt(6)
    s_add_u32 s38, s37, 30720
    buffer_store_dwordx4 v[56:59], v9, s[28:31], s38 offen sc1
    v_dot2_f32_bf16 v12, v56, v13, v12
    v_dot2_f32_bf16 v12, v57, v13, v12
    v_dot2_f32_bf16 v12, v58, v13, v12
    v_dot2_f32_bf16 v12, v59, v13, v12
    s_waitcnt lgkmcnt(4)
    s_add_u32 s38, s37, 35840
    buffer_store_dwordx4 v[60:63], v9, s[28:31], s38 offen sc1
    v_dot2_f32_bf16 v12, v60, v13, v12
    v_dot2_f32_bf16 v12, v61, v13, v12
    v_dot2_f32_bf16 v12, v62, v13, v12
    v_dot2_f32_bf16 v12, v63, v13, v12
    s_waitcnt lgkmcnt(2)
    s_add_u32 s38, s37, 40960
    buffer_store_dwordx4 v[64:67], v9, s[28:31], s38 offen sc1
    v_dot2_f32_bf16 v12, v64, v13, v12
    v_dot2_f32_bf16 v12, v65, v13, v12
    v_dot2_f32_bf16 v12, v66, v13, v12
    v_dot2_f32_bf16 v12, v67, v13, v12
    s_waitcnt lgkmcnt(0)
    s_add_u32 s38, s37, 46080
    buffer_store_dwordx4 v[68:71], v9, s[28:31], s38 offen sc1
    v_dot2_f32_bf16 v12, v68, v13, v12
    v_dot2_f32_bf16 v12, v69, v13, v12
    v_dot2_f32_bf16 v12, v70, v13, v12
    v_dot2_f32_bf16 v12, v71, v13, v12
    s_nop 2
    v_mov_b32 v13, v12
    s_nop 1
    v_permlane32_swap_b32 v13, v12
    v_add_f32 v12, v12, v13
    v_mov_b32 v13, v12
    s_nop 1
    v_permlane16_swap_b32 v13, v12
    v_add_f32 v12, v12, v13
    s_mul_i32 s38, s33, 7168
    s_lshl_b32 s39, s36, 6
    s_add_u32 s38, s38, s39
    s_add_u32 s38, s38, 2748416
    v_lshlrev_b32 v14, 2, v1
    v_cmp_gt_u32 vcc, 16, v1
    s_and_saveexec_b64 s[40:41], vcc
    buffer_store_dword v12, v14, s[28:31], s38 offen sc1
    s_mov_b64 exec, -1
    s_add_u32 s34, s34, 1
    s_barrier
    s_lshl_b32 s36, s34, 2
    s_add_u32 s36, s36, s20
    s_mul_i32 s38, s36, 52429
    s_lshr_b32 s38, s38, 18
    s_mul_i32 s39, s38, 5
    s_sub_u32 s39, s36, s39
    s_mul_i32 s37, s38, 100
    s_mul_i32 s40, s33, 50
    s_add_u32 s37, s37, s40
    s_add_u32 s37, s37, s39
    s_lshl_b32 s37, s37, 10
    s_add_u32 s37, s37, 2764800
    s_waitcnt vmcnt(20)
    ds_write_b128 v5, v[72:75] offset:0
    s_waitcnt vmcnt(19)
    ds_write_b128 v5, v[76:79] offset:4608
    s_waitcnt vmcnt(18)
    ds_write_b128 v5, v[80:83] offset:9216
    s_waitcnt vmcnt(17)
    ds_write_b128 v5, v[84:87] offset:13824
    s_waitcnt vmcnt(16)
    ds_write_b128 v5, v[88:91] offset:18432
    s_waitcnt vmcnt(15)
    ds_write_b128 v5, v[92:95] offset:23040
    s_waitcnt vmcnt(14)
    ds_write_b128 v5, v[96:99] offset:27648
    s_waitcnt vmcnt(13)
    ds_write_b128 v5, v[100:103] offset:32256
    s_waitcnt vmcnt(12)
    ds_write_b128 v5, v[104:107] offset:36864
    s_waitcnt vmcnt(11)
    ds_write_b128 v5, v[108:111] offset:41472
    s_waitcnt lgkmcnt(0)
    s_barrier
    ds_read_b64_tr_b16 v[72:73], v8 offset:0
    ds_read_b64_tr_b16 v[74:75], v8 offset:576
    ds_read_b64_tr_b16 v[76:77], v8 offset:4608
    ds_read_b64_tr_b16 v[78:79], v8 offset:5184
    ds_read_b64_tr_b16 v[80:81], v8 offset:9216
    ds_read_b64_tr_b16 v[82:83], v8 offset:9792
    ds_read_b64_tr_b16 v[84:85], v8 offset:13824
    ds_read_b64_tr_b16 v[86:87], v8 offset:14400
    ds_read_b64_tr_b16 v[88:89], v8 offset:18432
    ds_read_b64_tr_b16 v[90:91], v8 offset:19008
    ds_read_b64_tr_b16 v[92:93], v8 offset:23040
    ds_read_b64_tr_b16 v[94:95], v8 offset:23616
    ds_read_b64_tr_b16 v[96:97], v8 offset:27648
    ds_read_b64_tr_b16 v[98:99], v8 offset:28224
    ds_read_b64_tr_b16 v[100:101], v8 offset:32256
    ds_read_b64_tr_b16 v[102:103], v8 offset:32832
    ds_read_b64_tr_b16 v[104:105], v8 offset:36864
    ds_read_b64_tr_b16 v[106:107], v8 offset:37440
    ds_read_b64_tr_b16 v[108:109], v8 offset:41472
    ds_read_b64_tr_b16 v[110:111], v8 offset:42048
    v_mov_b32 v12, 0
    v_mov_b32 v13, 0x3f803f80
    s_waitcnt lgkmcnt(15)
    s_add_u32 s38, s37, 0
    buffer_store_dwordx4 v[72:75], v9, s[28:31], s38 offen sc1
    v_dot2_f32_bf16 v12, v72, v13, v12
    v_dot2_f32_bf16 v12, v73, v13, v12
    v_dot2_f32_bf16 v12, v74, v13, v12
    v_dot2_f32_bf16 v12, v75, v13, v12
    s_waitcnt lgkmcnt(15)
    s_add_u32 s38, s37, 5120
    buffer_store_dwordx4 v[76:79], v9, s[28:31], s38 offen sc1
    v_dot2_f32_bf16 v12, v76, v13, v12
    v_dot2_f32_bf16 v12, v77, v13, v12
    v_dot2_f32_bf16 v12, v78, v13, v12
    v_dot2_f32_bf16 v12, v79, v13, v12
    s_waitcnt lgkmcnt(14)
    s_add_u32 s38, s37, 10240
    buffer_store_dwordx4 v[80:83], v9, s[28:31], s38 offen sc1
    v_dot2_f32_bf16 v12, v80, v13, v12
    v_dot2_f32_bf16 v12, v81, v13, v12
    v_dot2_f32_bf16 v12, v82, v13, v12
    v_dot2_f32_bf16 v12, v83, v13, v12
    s_waitcnt lgkmcnt(12)
    s_add_u32 s38, s37, 15360
    buffer_store_dwordx4 v[84:87], v9, s[28:31], s38 offen sc1
    v_dot2_f32_bf16 v12, v84, v13, v12
    v_dot2_f32_bf16 v12, v85, v13, v12
    v_dot2_f32_bf16 v12, v86, v13, v12
    v_dot2_f32_bf16 v12, v87, v13, v12
    s_waitcnt lgkmcnt(10)
    s_add_u32 s38, s37, 20480
    buffer_store_dwordx4 v[88:91], v9, s[28:31], s38 offen sc1
    v_dot2_f32_bf16 v12, v88, v13, v12
    v_dot2_f32_bf16 v12, v89, v13, v12
    v_dot2_f32_bf16 v12, v90, v13, v12
    v_dot2_f32_bf16 v12, v91, v13, v12
    s_waitcnt lgkmcnt(8)
    s_add_u32 s38, s37, 25600
    buffer_store_dwordx4 v[92:95], v9, s[28:31], s38 offen sc1
    v_dot2_f32_bf16 v12, v92, v13, v12
    v_dot2_f32_bf16 v12, v93, v13, v12
    v_dot2_f32_bf16 v12, v94, v13, v12
    v_dot2_f32_bf16 v12, v95, v13, v12
    s_waitcnt lgkmcnt(6)
    s_add_u32 s38, s37, 30720
    buffer_store_dwordx4 v[96:99], v9, s[28:31], s38 offen sc1
    v_dot2_f32_bf16 v12, v96, v13, v12
    v_dot2_f32_bf16 v12, v97, v13, v12
    v_dot2_f32_bf16 v12, v98, v13, v12
    v_dot2_f32_bf16 v12, v99, v13, v12
    s_waitcnt lgkmcnt(4)
    s_add_u32 s38, s37, 35840
    buffer_store_dwordx4 v[100:103], v9, s[28:31], s38 offen sc1
    v_dot2_f32_bf16 v12, v100, v13, v12
    v_dot2_f32_bf16 v12, v101, v13, v12
    v_dot2_f32_bf16 v12, v102, v13, v12
    v_dot2_f32_bf16 v12, v103, v13, v12
    s_waitcnt lgkmcnt(2)
    s_add_u32 s38, s37, 40960
    buffer_store_dwordx4 v[104:107], v9, s[28:31], s38 offen sc1
    v_dot2_f32_bf16 v12, v104, v13, v12
    v_dot2_f32_bf16 v12, v105, v13, v12
    v_dot2_f32_bf16 v12, v106, v13, v12
    v_dot2_f32_bf16 v12, v107, v13, v12
    s_waitcnt lgkmcnt(0)
    s_add_u32 s38, s37, 46080
    buffer_store_dwordx4 v[108:111], v9, s[28:31], s38 offen sc1
    v_dot2_f32_bf16 v12, v108, v13, v12
    v_dot2_f32_bf16 v12, v109, v13, v12
    v_dot2_f32_bf16 v12, v110, v13, v12
    v_dot2_f32_bf16 v12, v111, v13, v12
    s_nop 2
    v_mov_b32 v13, v12
    s_nop 1
    v_permlane32_swap_b32 v13, v12
    v_add_f32 v12, v12, v13
    v_mov_b32 v13, v12
    s_nop 1
    v_permlane16_swap_b32 v13, v12
    v_add_f32 v12, v12, v13
    s_mul_i32 s38, s33, 7168
    s_lshl_b32 s39, s36, 6
    s_add_u32 s38, s38, s39
    s_add_u32 s38, s38, 2748416
    v_lshlrev_b32 v14, 2, v1
    v_cmp_gt_u32 vcc, 16, v1
    s_and_saveexec_b64 s[40:41], vcc
    buffer_store_dword v12, v14, s[28:31], s38 offen sc1
    s_mov_b64 exec, -1
    s_endpgm
k1_kernel_pk17:
    s_mov_b32 s24, s14
    s_mov_b32 s25, s15
    s_mov_b32 s26, 819200
    s_mov_b32 s27, 0x00020000
    s_sub_u32 s32, s21, 10
    s_mul_i32 s33, s32, 52429
    s_lshr_b32 s33, s33, 18
    s_mul_i32 s34, s33, 5
    s_sub_u32 s34, s32, s34
    s_lshl_b32 s34, s34, 1
    v_mul_u32_u24 v10, 1280, v3
    v_lshl_add_u32 v10, v4, 4, v10
    s_mul_i32 s35, s33, 409600
    s_lshl_b32 s36, s34, 7
    s_add_u32 s35, s35, s36
    buffer_load_dwordx4 v[32:35], v10, s[24:27], s35 offen offset:0
    s_add_u32 s35, s35, 40960
    buffer_load_dwordx4 v[36:39], v10, s[24:27], s35 offen offset:0
    s_add_u32 s35, s35, 40960
    buffer_load_dwordx4 v[40:43], v10, s[24:27], s35 offen offset:0
    s_add_u32 s35, s35, 40960
    buffer_load_dwordx4 v[44:47], v10, s[24:27], s35 offen offset:0
    s_add_u32 s35, s35, 40960
    buffer_load_dwordx4 v[48:51], v10, s[24:27], s35 offen offset:0
    s_add_u32 s35, s35, 40960
    buffer_load_dwordx4 v[52:55], v10, s[24:27], s35 offen offset:0
    s_add_u32 s35, s35, 40960
    buffer_load_dwordx4 v[56:59], v10, s[24:27], s35 offen offset:0
    s_add_u32 s35, s35, 40960
    buffer_load_dwordx4 v[60:63], v10, s[24:27], s35 offen offset:0
    s_add_u32 s35, s35, 40960
    buffer_load_dwordx4 v[64:67], v10, s[24:27], s35 offen offset:0
    s_add_u32 s35, s35, 40960
    buffer_load_dwordx4 v[68:71], v10, s[24:27], s35 offen offset:0
    s_sub_u32 s35, s35, 368640
    buffer_load_dwordx4 v[72:75], v10, s[24:27], s35 offen offset:128
    s_add_u32 s35, s35, 40960
    buffer_load_dwordx4 v[76:79], v10, s[24:27], s35 offen offset:128
    s_add_u32 s35, s35, 40960
    buffer_load_dwordx4 v[80:83], v10, s[24:27], s35 offen offset:128
    s_add_u32 s35, s35, 40960
    buffer_load_dwordx4 v[84:87], v10, s[24:27], s35 offen offset:128
    s_add_u32 s35, s35, 40960
    buffer_load_dwordx4 v[88:91], v10, s[24:27], s35 offen offset:128
    s_add_u32 s35, s35, 40960
    buffer_load_dwordx4 v[92:95], v10, s[24:27], s35 offen offset:128
    s_add_u32 s35, s35, 40960
    buffer_load_dwordx4 v[96:99], v10, s[24:27], s35 offen offset:128
    s_add_u32 s35, s35, 40960
    buffer_load_dwordx4 v[100:103], v10, s[24:27], s35 offen offset:128
    s_add_u32 s35, s35, 40960
    buffer_load_dwordx4 v[104:107], v10, s[24:27], s35 offen offset:128
    s_add_u32 s35, s35, 40960
    buffer_load_dwordx4 v[108:111], v10, s[24:27], s35 offen offset:128
    s_lshl_b32 s36, s34, 2
    s_add_u32 s36, s36, s20
    s_mul_i32 s38, s36, 52429
    s_lshr_b32 s38, s38, 18
    s_mul_i32 s39, s38, 5
    s_sub_u32 s39, s36, s39
    s_mul_i32 s37, s38, 100
    s_mul_i32 s40, s33, 50
    s_add_u32 s37, s37, s40
    s_add_u32 s37, s37, s39
    s_lshl_b32 s37, s37, 10
    s_add_u32 s37, s37, 3584000
    s_waitcnt vmcnt(19)
    ds_write_b128 v5, v[32:35] offset:0
    s_waitcnt vmcnt(18)
    ds_write_b128 v5, v[36:39] offset:4608
    s_waitcnt vmcnt(17)
    ds_write_b128 v5, v[40:43] offset:9216
    s_waitcnt vmcnt(16)
    ds_write_b128 v5, v[44:47] offset:13824
    s_waitcnt vmcnt(15)
    ds_write_b128 v5, v[48:51] offset:18432
    s_waitcnt vmcnt(14)
    ds_write_b128 v5, v[52:55] offset:23040
    s_waitcnt vmcnt(13)
    ds_write_b128 v5, v[56:59] offset:27648
    s_waitcnt vmcnt(12)
    ds_write_b128 v5, v[60:63] offset:32256
    s_waitcnt vmcnt(11)
    ds_write_b128 v5, v[64:67] offset:36864
    s_waitcnt vmcnt(10)
    ds_write_b128 v5, v[68:71] offset:41472
    s_waitcnt lgkmcnt(0)
    s_barrier
    ds_read_b64_tr_b16 v[32:33], v8 offset:0
    ds_read_b64_tr_b16 v[34:35], v8 offset:576
    ds_read_b64_tr_b16 v[36:37], v8 offset:4608
    ds_read_b64_tr_b16 v[38:39], v8 offset:5184
    ds_read_b64_tr_b16 v[40:41], v8 offset:9216
    ds_read_b64_tr_b16 v[42:43], v8 offset:9792
    ds_read_b64_tr_b16 v[44:45], v8 offset:13824
    ds_read_b64_tr_b16 v[46:47], v8 offset:14400
    ds_read_b64_tr_b16 v[48:49], v8 offset:18432
    ds_read_b64_tr_b16 v[50:51], v8 offset:19008
    ds_read_b64_tr_b16 v[52:53], v8 offset:23040
    ds_read_b64_tr_b16 v[54:55], v8 offset:23616
    ds_read_b64_tr_b16 v[56:57], v8 offset:27648
    ds_read_b64_tr_b16 v[58:59], v8 offset:28224
    ds_read_b64_tr_b16 v[60:61], v8 offset:32256
    ds_read_b64_tr_b16 v[62:63], v8 offset:32832
    ds_read_b64_tr_b16 v[64:65], v8 offset:36864
    ds_read_b64_tr_b16 v[66:67], v8 offset:37440
    ds_read_b64_tr_b16 v[68:69], v8 offset:41472
    ds_read_b64_tr_b16 v[70:71], v8 offset:42048
    s_waitcnt lgkmcnt(15)
    s_add_u32 s38, s37, 0
    buffer_store_dwordx4 v[32:35], v9, s[28:31], s38 offen sc1
    s_waitcnt lgkmcnt(15)
    s_add_u32 s38, s37, 5120
    buffer_store_dwordx4 v[36:39], v9, s[28:31], s38 offen sc1
    s_waitcnt lgkmcnt(14)
    s_add_u32 s38, s37, 10240
    buffer_store_dwordx4 v[40:43], v9, s[28:31], s38 offen sc1
    s_waitcnt lgkmcnt(12)
    s_add_u32 s38, s37, 15360
    buffer_store_dwordx4 v[44:47], v9, s[28:31], s38 offen sc1
    s_waitcnt lgkmcnt(10)
    s_add_u32 s38, s37, 20480
    buffer_store_dwordx4 v[48:51], v9, s[28:31], s38 offen sc1
    s_waitcnt lgkmcnt(8)
    s_add_u32 s38, s37, 25600
    buffer_store_dwordx4 v[52:55], v9, s[28:31], s38 offen sc1
    s_waitcnt lgkmcnt(6)
    s_add_u32 s38, s37, 30720
    buffer_store_dwordx4 v[56:59], v9, s[28:31], s38 offen sc1
    s_waitcnt lgkmcnt(4)
    s_add_u32 s38, s37, 35840
    buffer_store_dwordx4 v[60:63], v9, s[28:31], s38 offen sc1
    s_waitcnt lgkmcnt(2)
    s_add_u32 s38, s37, 40960
    buffer_store_dwordx4 v[64:67], v9, s[28:31], s38 offen sc1
    s_waitcnt lgkmcnt(0)
    s_add_u32 s38, s37, 46080
    buffer_store_dwordx4 v[68:71], v9, s[28:31], s38 offen sc1
    s_add_u32 s34, s34, 1
    s_barrier
    s_lshl_b32 s36, s34, 2
    s_add_u32 s36, s36, s20
    s_mul_i32 s38, s36, 52429
    s_lshr_b32 s38, s38, 18
    s_mul_i32 s39, s38, 5
    s_sub_u32 s39, s36, s39
    s_mul_i32 s37, s38, 100
    s_mul_i32 s40, s33, 50
    s_add_u32 s37, s37, s40
    s_add_u32 s37, s37, s39
    s_lshl_b32 s37, s37, 10
    s_add_u32 s37, s37, 3584000
    s_waitcnt vmcnt(19)
    ds_write_b128 v5, v[72:75] offset:0
    s_waitcnt vmcnt(18)
    ds_write_b128 v5, v[76:79] offset:4608
    s_waitcnt vmcnt(17)
    ds_write_b128 v5, v[80:83] offset:9216
    s_waitcnt vmcnt(16)
    ds_write_b128 v5, v[84:87] offset:13824
    s_waitcnt vmcnt(15)
    ds_write_b128 v5, v[88:91] offset:18432
    s_waitcnt vmcnt(14)
    ds_write_b128 v5, v[92:95] offset:23040
    s_waitcnt vmcnt(13)
    ds_write_b128 v5, v[96:99] offset:27648
    s_waitcnt vmcnt(12)
    ds_write_b128 v5, v[100:103] offset:32256
    s_waitcnt vmcnt(11)
    ds_write_b128 v5, v[104:107] offset:36864
    s_waitcnt vmcnt(10)
    ds_write_b128 v5, v[108:111] offset:41472
    s_waitcnt lgkmcnt(0)
    s_barrier
    ds_read_b64_tr_b16 v[72:73], v8 offset:0
    ds_read_b64_tr_b16 v[74:75], v8 offset:576
    ds_read_b64_tr_b16 v[76:77], v8 offset:4608
    ds_read_b64_tr_b16 v[78:79], v8 offset:5184
    ds_read_b64_tr_b16 v[80:81], v8 offset:9216
    ds_read_b64_tr_b16 v[82:83], v8 offset:9792
    ds_read_b64_tr_b16 v[84:85], v8 offset:13824
    ds_read_b64_tr_b16 v[86:87], v8 offset:14400
    ds_read_b64_tr_b16 v[88:89], v8 offset:18432
    ds_read_b64_tr_b16 v[90:91], v8 offset:19008
    ds_read_b64_tr_b16 v[92:93], v8 offset:23040
    ds_read_b64_tr_b16 v[94:95], v8 offset:23616
    ds_read_b64_tr_b16 v[96:97], v8 offset:27648
    ds_read_b64_tr_b16 v[98:99], v8 offset:28224
    ds_read_b64_tr_b16 v[100:101], v8 offset:32256
    ds_read_b64_tr_b16 v[102:103], v8 offset:32832
    ds_read_b64_tr_b16 v[104:105], v8 offset:36864
    ds_read_b64_tr_b16 v[106:107], v8 offset:37440
    ds_read_b64_tr_b16 v[108:109], v8 offset:41472
    ds_read_b64_tr_b16 v[110:111], v8 offset:42048
    s_waitcnt lgkmcnt(15)
    s_add_u32 s38, s37, 0
    buffer_store_dwordx4 v[72:75], v9, s[28:31], s38 offen sc1
    s_waitcnt lgkmcnt(15)
    s_add_u32 s38, s37, 5120
    buffer_store_dwordx4 v[76:79], v9, s[28:31], s38 offen sc1
    s_waitcnt lgkmcnt(14)
    s_add_u32 s38, s37, 10240
    buffer_store_dwordx4 v[80:83], v9, s[28:31], s38 offen sc1
    s_waitcnt lgkmcnt(12)
    s_add_u32 s38, s37, 15360
    buffer_store_dwordx4 v[84:87], v9, s[28:31], s38 offen sc1
    s_waitcnt lgkmcnt(10)
    s_add_u32 s38, s37, 20480
    buffer_store_dwordx4 v[88:91], v9, s[28:31], s38 offen sc1
    s_waitcnt lgkmcnt(8)
    s_add_u32 s38, s37, 25600
    buffer_store_dwordx4 v[92:95], v9, s[28:31], s38 offen sc1
    s_waitcnt lgkmcnt(6)
    s_add_u32 s38, s37, 30720
    buffer_store_dwordx4 v[96:99], v9, s[28:31], s38 offen sc1
    s_waitcnt lgkmcnt(4)
    s_add_u32 s38, s37, 35840
    buffer_store_dwordx4 v[100:103], v9, s[28:31], s38 offen sc1
    s_waitcnt lgkmcnt(2)
    s_add_u32 s38, s37, 40960
    buffer_store_dwordx4 v[104:107], v9, s[28:31], s38 offen sc1
    s_waitcnt lgkmcnt(0)
    s_add_u32 s38, s37, 46080
    buffer_store_dwordx4 v[108:111], v9, s[28:31], s38 offen sc1
    s_endpgm
k1_kernel_pk18:
    s_mov_b32 s24, s16
    s_mov_b32 s25, s17
    s_mov_b32 s26, 2211840
    s_mov_b32 s27, 0x00020000
    s_sub_u32 s32, s21, 20
    s_mul_i32 s33, s32, 4682
    s_lshr_b32 s33, s33, 16
    s_mul_i32 s34, s33, 14
    s_sub_u32 s34, s32, s34
    s_lshl_b32 s34, s34, 1
    v_mul_u32_u24 v10, 3456, v3
    v_lshl_add_u32 v10, v4, 4, v10
    s_mul_i32 s35, s33, 1105920
    s_lshl_b32 s36, s34, 7
    s_add_u32 s35, s35, s36
    buffer_load_dwordx4 v[32:35], v10, s[24:27], s35 offen offset:0
    s_add_u32 s35, s35, 110592
    buffer_load_dwordx4 v[36:39], v10, s[24:27], s35 offen offset:0
    s_add_u32 s35, s35, 110592
    buffer_load_dwordx4 v[40:43], v10, s[24:27], s35 offen offset:0
    s_add_u32 s35, s35, 110592
    buffer_load_dwordx4 v[44:47], v10, s[24:27], s35 offen offset:0
    s_add_u32 s35, s35, 110592
    buffer_load_dwordx4 v[48:51], v10, s[24:27], s35 offen offset:0
    s_add_u32 s35, s35, 110592
    buffer_load_dwordx4 v[52:55], v10, s[24:27], s35 offen offset:0
    s_add_u32 s35, s35, 110592
    buffer_load_dwordx4 v[56:59], v10, s[24:27], s35 offen offset:0
    s_add_u32 s35, s35, 110592
    buffer_load_dwordx4 v[60:63], v10, s[24:27], s35 offen offset:0
    s_add_u32 s35, s35, 110592
    buffer_load_dwordx4 v[64:67], v10, s[24:27], s35 offen offset:0
    s_add_u32 s35, s35, 110592
    buffer_load_dwordx4 v[68:71], v10, s[24:27], s35 offen offset:0
    s_sub_u32 s35, s35, 995328
    buffer_load_dwordx4 v[72:75], v10, s[24:27], s35 offen offset:128
    s_add_u32 s35, s35, 110592
    buffer_load_dwordx4 v[76:79], v10, s[24:27], s35 offen offset:128
    s_add_u32 s35, s35, 110592
    buffer_load_dwordx4 v[80:83], v10, s[24:27], s35 offen offset:128
    s_add_u32 s35, s35, 110592
    buffer_load_dwordx4 v[84:87], v10, s[24:27], s35 offen offset:128
    s_add_u32 s35, s35, 110592
    buffer_load_dwordx4 v[88:91], v10, s[24:27], s35 offen offset:128
    s_add_u32 s35, s35, 110592
    buffer_load_dwordx4 v[92:95], v10, s[24:27], s35 offen offset:128
    s_add_u32 s35, s35, 110592
    buffer_load_dwordx4 v[96:99], v10, s[24:27], s35 offen offset:128
    s_add_u32 s35, s35, 110592
    buffer_load_dwordx4 v[100:103], v10, s[24:27], s35 offen offset:128
    s_add_u32 s35, s35, 110592
    buffer_load_dwordx4 v[104:107], v10, s[24:27], s35 offen offset:128
    s_add_u32 s35, s35, 110592
    buffer_load_dwordx4 v[108:111], v10, s[24:27], s35 offen offset:128
    s_lshl_b32 s36, s34, 2
    s_add_u32 s36, s36, s20
    s_mul_i32 s38, s36, 9363
    s_lshr_b32 s38, s38, 16
    s_mul_i32 s39, s38, 7
    s_sub_u32 s39, s36, s39
    s_mul_i32 s37, s38, 140
    s_mul_i32 s40, s33, 70
    s_add_u32 s37, s37, s40
    s_add_u32 s37, s37, s39
    s_lshl_b32 s37, s37, 10
    s_add_u32 s37, s37, 4403200
    s_waitcnt vmcnt(19)
    ds_write_b128 v5, v[32:35] offset:0
    s_waitcnt vmcnt(18)
    ds_write_b128 v5, v[36:39] offset:4608
    s_waitcnt vmcnt(17)
    ds_write_b128 v5, v[40:43] offset:9216
    s_waitcnt vmcnt(16)
    ds_write_b128 v5, v[44:47] offset:13824
    s_waitcnt vmcnt(15)
    ds_write_b128 v5, v[48:51] offset:18432
    s_waitcnt vmcnt(14)
    ds_write_b128 v5, v[52:55] offset:23040
    s_waitcnt vmcnt(13)
    ds_write_b128 v5, v[56:59] offset:27648
    s_waitcnt vmcnt(12)
    ds_write_b128 v5, v[60:63] offset:32256
    s_waitcnt vmcnt(11)
    ds_write_b128 v5, v[64:67] offset:36864
    s_waitcnt vmcnt(10)
    ds_write_b128 v5, v[68:71] offset:41472
    s_waitcnt lgkmcnt(0)
    s_barrier
    ds_read_b64_tr_b16 v[32:33], v8 offset:0
    ds_read_b64_tr_b16 v[34:35], v8 offset:576
    ds_read_b64_tr_b16 v[36:37], v8 offset:4608
    ds_read_b64_tr_b16 v[38:39], v8 offset:5184
    ds_read_b64_tr_b16 v[40:41], v8 offset:9216
    ds_read_b64_tr_b16 v[42:43], v8 offset:9792
    ds_read_b64_tr_b16 v[44:45], v8 offset:13824
    ds_read_b64_tr_b16 v[46:47], v8 offset:14400
    ds_read_b64_tr_b16 v[48:49], v8 offset:18432
    ds_read_b64_tr_b16 v[50:51], v8 offset:19008
    ds_read_b64_tr_b16 v[52:53], v8 offset:23040
    ds_read_b64_tr_b16 v[54:55], v8 offset:23616
    ds_read_b64_tr_b16 v[56:57], v8 offset:27648
    ds_read_b64_tr_b16 v[58:59], v8 offset:28224
    ds_read_b64_tr_b16 v[60:61], v8 offset:32256
    ds_read_b64_tr_b16 v[62:63], v8 offset:32832
    ds_read_b64_tr_b16 v[64:65], v8 offset:36864
    ds_read_b64_tr_b16 v[66:67], v8 offset:37440
    ds_read_b64_tr_b16 v[68:69], v8 offset:41472
    ds_read_b64_tr_b16 v[70:71], v8 offset:42048
    v_mov_b32 v12, 0
    v_mov_b32 v13, 0x3f803f80
    s_waitcnt lgkmcnt(15)
    s_add_u32 s38, s37, 0
    buffer_store_dwordx4 v[32:35], v9, s[28:31], s38 offen sc1
    v_dot2_f32_bf16 v12, v32, v13, v12
    v_dot2_f32_bf16 v12, v33, v13, v12
    v_dot2_f32_bf16 v12, v34, v13, v12
    v_dot2_f32_bf16 v12, v35, v13, v12
    s_waitcnt lgkmcnt(15)
    s_add_u32 s38, s37, 7168
    buffer_store_dwordx4 v[36:39], v9, s[28:31], s38 offen sc1
    v_dot2_f32_bf16 v12, v36, v13, v12
    v_dot2_f32_bf16 v12, v37, v13, v12
    v_dot2_f32_bf16 v12, v38, v13, v12
    v_dot2_f32_bf16 v12, v39, v13, v12
    s_waitcnt lgkmcnt(14)
    s_add_u32 s38, s37, 14336
    buffer_store_dwordx4 v[40:43], v9, s[28:31], s38 offen sc1
    v_dot2_f32_bf16 v12, v40, v13, v12
    v_dot2_f32_bf16 v12, v41, v13, v12
    v_dot2_f32_bf16 v12, v42, v13, v12
    v_dot2_f32_bf16 v12, v43, v13, v12
    s_waitcnt lgkmcnt(12)
    s_add_u32 s38, s37, 21504
    buffer_store_dwordx4 v[44:47], v9, s[28:31], s38 offen sc1
    v_dot2_f32_bf16 v12, v44, v13, v12
    v_dot2_f32_bf16 v12, v45, v13, v12
    v_dot2_f32_bf16 v12, v46, v13, v12
    v_dot2_f32_bf16 v12, v47, v13, v12
    s_waitcnt lgkmcnt(10)
    s_add_u32 s38, s37, 28672
    buffer_store_dwordx4 v[48:51], v9, s[28:31], s38 offen sc1
    v_dot2_f32_bf16 v12, v48, v13, v12
    v_dot2_f32_bf16 v12, v49, v13, v12
    v_dot2_f32_bf16 v12, v50, v13, v12
    v_dot2_f32_bf16 v12, v51, v13, v12
    s_waitcnt lgkmcnt(8)
    s_add_u32 s38, s37, 35840
    buffer_store_dwordx4 v[52:55], v9, s[28:31], s38 offen sc1
    v_dot2_f32_bf16 v12, v52, v13, v12
    v_dot2_f32_bf16 v12, v53, v13, v12
    v_dot2_f32_bf16 v12, v54, v13, v12
    v_dot2_f32_bf16 v12, v55, v13, v12
    s_waitcnt lgkmcnt(6)
    s_add_u32 s38, s37, 43008
    buffer_store_dwordx4 v[56:59], v9, s[28:31], s38 offen sc1
    v_dot2_f32_bf16 v12, v56, v13, v12
    v_dot2_f32_bf16 v12, v57, v13, v12
    v_dot2_f32_bf16 v12, v58, v13, v12
    v_dot2_f32_bf16 v12, v59, v13, v12
    s_waitcnt lgkmcnt(4)
    s_add_u32 s38, s37, 50176
    buffer_store_dwordx4 v[60:63], v9, s[28:31], s38 offen sc1
    v_dot2_f32_bf16 v12, v60, v13, v12
    v_dot2_f32_bf16 v12, v61, v13, v12
    v_dot2_f32_bf16 v12, v62, v13, v12
    v_dot2_f32_bf16 v12, v63, v13, v12
    s_waitcnt lgkmcnt(2)
    s_add_u32 s38, s37, 57344
    buffer_store_dwordx4 v[64:67], v9, s[28:31], s38 offen sc1
    v_dot2_f32_bf16 v12, v64, v13, v12
    v_dot2_f32_bf16 v12, v65, v13, v12
    v_dot2_f32_bf16 v12, v66, v13, v12
    v_dot2_f32_bf16 v12, v67, v13, v12
    s_waitcnt lgkmcnt(0)
    s_add_u32 s38, s37, 64512
    buffer_store_dwordx4 v[68:71], v9, s[28:31], s38 offen sc1
    v_dot2_f32_bf16 v12, v68, v13, v12
    v_dot2_f32_bf16 v12, v69, v13, v12
    v_dot2_f32_bf16 v12, v70, v13, v12
    v_dot2_f32_bf16 v12, v71, v13, v12
    s_nop 2
    v_mov_b32 v13, v12
    s_nop 1
    v_permlane32_swap_b32 v13, v12
    v_add_f32 v12, v12, v13
    v_mov_b32 v13, v12
    s_nop 1
    v_permlane16_swap_b32 v13, v12
    v_add_f32 v12, v12, v13
    s_mul_i32 s38, s33, 7168
    s_lshl_b32 s39, s36, 6
    s_add_u32 s38, s38, s39
    s_add_u32 s38, s38, 2732032
    v_lshlrev_b32 v14, 2, v1
    v_cmp_gt_u32 vcc, 16, v1
    s_and_saveexec_b64 s[40:41], vcc
    buffer_store_dword v12, v14, s[28:31], s38 offen sc1
    s_mov_b64 exec, -1
    s_cmp_ge_u32 s34, 26
    s_cbranch_scc1 k1_kernel_pke20
    s_add_u32 s34, s34, 1
    s_barrier
    s_lshl_b32 s36, s34, 2
    s_add_u32 s36, s36, s20
    s_mul_i32 s38, s36, 9363
    s_lshr_b32 s38, s38, 16
    s_mul_i32 s39, s38, 7
    s_sub_u32 s39, s36, s39
    s_mul_i32 s37, s38, 140
    s_mul_i32 s40, s33, 70
    s_add_u32 s37, s37, s40
    s_add_u32 s37, s37, s39
    s_lshl_b32 s37, s37, 10
    s_add_u32 s37, s37, 4403200
    s_waitcnt vmcnt(20)
    ds_write_b128 v5, v[72:75] offset:0
    s_waitcnt vmcnt(19)
    ds_write_b128 v5, v[76:79] offset:4608
    s_waitcnt vmcnt(18)
    ds_write_b128 v5, v[80:83] offset:9216
    s_waitcnt vmcnt(17)
    ds_write_b128 v5, v[84:87] offset:13824
    s_waitcnt vmcnt(16)
    ds_write_b128 v5, v[88:91] offset:18432
    s_waitcnt vmcnt(15)
    ds_write_b128 v5, v[92:95] offset:23040
    s_waitcnt vmcnt(14)
    ds_write_b128 v5, v[96:99] offset:27648
    s_waitcnt vmcnt(13)
    ds_write_b128 v5, v[100:103] offset:32256
    s_waitcnt vmcnt(12)
    ds_write_b128 v5, v[104:107] offset:36864
    s_waitcnt vmcnt(11)
    ds_write_b128 v5, v[108:111] offset:41472
    s_waitcnt lgkmcnt(0)
    s_barrier
    ds_read_b64_tr_b16 v[72:73], v8 offset:0
    ds_read_b64_tr_b16 v[74:75], v8 offset:576
    ds_read_b64_tr_b16 v[76:77], v8 offset:4608
    ds_read_b64_tr_b16 v[78:79], v8 offset:5184
    ds_read_b64_tr_b16 v[80:81], v8 offset:9216
    ds_read_b64_tr_b16 v[82:83], v8 offset:9792
    ds_read_b64_tr_b16 v[84:85], v8 offset:13824
    ds_read_b64_tr_b16 v[86:87], v8 offset:14400
    ds_read_b64_tr_b16 v[88:89], v8 offset:18432
    ds_read_b64_tr_b16 v[90:91], v8 offset:19008
    ds_read_b64_tr_b16 v[92:93], v8 offset:23040
    ds_read_b64_tr_b16 v[94:95], v8 offset:23616
    ds_read_b64_tr_b16 v[96:97], v8 offset:27648
    ds_read_b64_tr_b16 v[98:99], v8 offset:28224
    ds_read_b64_tr_b16 v[100:101], v8 offset:32256
    ds_read_b64_tr_b16 v[102:103], v8 offset:32832
    ds_read_b64_tr_b16 v[104:105], v8 offset:36864
    ds_read_b64_tr_b16 v[106:107], v8 offset:37440
    ds_read_b64_tr_b16 v[108:109], v8 offset:41472
    ds_read_b64_tr_b16 v[110:111], v8 offset:42048
    v_mov_b32 v12, 0
    v_mov_b32 v13, 0x3f803f80
    s_waitcnt lgkmcnt(15)
    s_add_u32 s38, s37, 0
    buffer_store_dwordx4 v[72:75], v9, s[28:31], s38 offen sc1
    v_dot2_f32_bf16 v12, v72, v13, v12
    v_dot2_f32_bf16 v12, v73, v13, v12
    v_dot2_f32_bf16 v12, v74, v13, v12
    v_dot2_f32_bf16 v12, v75, v13, v12
    s_waitcnt lgkmcnt(15)
    s_add_u32 s38, s37, 7168
    buffer_store_dwordx4 v[76:79], v9, s[28:31], s38 offen sc1
    v_dot2_f32_bf16 v12, v76, v13, v12
    v_dot2_f32_bf16 v12, v77, v13, v12
    v_dot2_f32_bf16 v12, v78, v13, v12
    v_dot2_f32_bf16 v12, v79, v13, v12
    s_waitcnt lgkmcnt(14)
    s_add_u32 s38, s37, 14336
    buffer_store_dwordx4 v[80:83], v9, s[28:31], s38 offen sc1
    v_dot2_f32_bf16 v12, v80, v13, v12
    v_dot2_f32_bf16 v12, v81, v13, v12
    v_dot2_f32_bf16 v12, v82, v13, v12
    v_dot2_f32_bf16 v12, v83, v13, v12
    s_waitcnt lgkmcnt(12)
    s_add_u32 s38, s37, 21504
    buffer_store_dwordx4 v[84:87], v9, s[28:31], s38 offen sc1
    v_dot2_f32_bf16 v12, v84, v13, v12
    v_dot2_f32_bf16 v12, v85, v13, v12
    v_dot2_f32_bf16 v12, v86, v13, v12
    v_dot2_f32_bf16 v12, v87, v13, v12
    s_waitcnt lgkmcnt(10)
    s_add_u32 s38, s37, 28672
    buffer_store_dwordx4 v[88:91], v9, s[28:31], s38 offen sc1
    v_dot2_f32_bf16 v12, v88, v13, v12
    v_dot2_f32_bf16 v12, v89, v13, v12
    v_dot2_f32_bf16 v12, v90, v13, v12
    v_dot2_f32_bf16 v12, v91, v13, v12
    s_waitcnt lgkmcnt(8)
    s_add_u32 s38, s37, 35840
    buffer_store_dwordx4 v[92:95], v9, s[28:31], s38 offen sc1
    v_dot2_f32_bf16 v12, v92, v13, v12
    v_dot2_f32_bf16 v12, v93, v13, v12
    v_dot2_f32_bf16 v12, v94, v13, v12
    v_dot2_f32_bf16 v12, v95, v13, v12
    s_waitcnt lgkmcnt(6)
    s_add_u32 s38, s37, 43008
    buffer_store_dwordx4 v[96:99], v9, s[28:31], s38 offen sc1
    v_dot2_f32_bf16 v12, v96, v13, v12
    v_dot2_f32_bf16 v12, v97, v13, v12
    v_dot2_f32_bf16 v12, v98, v13, v12
    v_dot2_f32_bf16 v12, v99, v13, v12
    s_waitcnt lgkmcnt(4)
    s_add_u32 s38, s37, 50176
    buffer_store_dwordx4 v[100:103], v9, s[28:31], s38 offen sc1
    v_dot2_f32_bf16 v12, v100, v13, v12
    v_dot2_f32_bf16 v12, v101, v13, v12
    v_dot2_f32_bf16 v12, v102, v13, v12
    v_dot2_f32_bf16 v12, v103, v13, v12
    s_waitcnt lgkmcnt(2)
    s_add_u32 s38, s37, 57344
    buffer_store_dwordx4 v[104:107], v9, s[28:31], s38 offen sc1
    v_dot2_f32_bf16 v12, v104, v13, v12
    v_dot2_f32_bf16 v12, v105, v13, v12
    v_dot2_f32_bf16 v12, v106, v13, v12
    v_dot2_f32_bf16 v12, v107, v13, v12
    s_waitcnt lgkmcnt(0)
    s_add_u32 s38, s37, 64512
    buffer_store_dwordx4 v[108:111], v9, s[28:31], s38 offen sc1
    v_dot2_f32_bf16 v12, v108, v13, v12
    v_dot2_f32_bf16 v12, v109, v13, v12
    v_dot2_f32_bf16 v12, v110, v13, v12
    v_dot2_f32_bf16 v12, v111, v13, v12
    s_nop 2
    v_mov_b32 v13, v12
    s_nop 1
    v_permlane32_swap_b32 v13, v12
    v_add_f32 v12, v12, v13
    v_mov_b32 v13, v12
    s_nop 1
    v_permlane16_swap_b32 v13, v12
    v_add_f32 v12, v12, v13
    s_mul_i32 s38, s33, 7168
    s_lshl_b32 s39, s36, 6
    s_add_u32 s38, s38, s39
    s_add_u32 s38, s38, 2732032
    v_lshlrev_b32 v14, 2, v1
    v_cmp_gt_u32 vcc, 16, v1
    s_and_saveexec_b64 s[40:41], vcc
    buffer_store_dword v12, v14, s[28:31], s38 offen sc1
    s_mov_b64 exec, -1
    s_endpgm
k1_kernel_pk19:
    s_mov_b32 s24, s18
    s_mov_b32 s25, s19
    s_mov_b32 s26, 2211840
    s_mov_b32 s27, 0x00020000
    s_sub_u32 s32, s21, 48
    s_mul_i32 s33, s32, 52429
    s_lshr_b32 s33, s33, 18
    s_mul_i32 s34, s33, 5
    s_sub_u32 s34, s32, s34
    s_lshl_b32 s34, s34, 1
    v_mul_u32_u24 v10, 1280, v3
    v_lshl_add_u32 v10, v4, 4, v10
    s_mul_i32 s35, s33, 368640
    s_lshl_b32 s36, s34, 7
    s_add_u32 s35, s35, s36
    buffer_load_dwordx4 v[32:35], v10, s[24:27], s35 offen offset:0
    s_add_u32 s35, s35, 40960
    buffer_load_dwordx4 v[36:39], v10, s[24:27], s35 offen offset:0
    s_add_u32 s35, s35, 40960
    buffer_load_dwordx4 v[40:43], v10, s[24:27], s35 offen offset:0
    s_add_u32 s35, s35, 40960
    buffer_load_dwordx4 v[44:47], v10, s[24:27], s35 offen offset:0
    s_add_u32 s35, s35, 40960
    buffer_load_dwordx4 v[48:51], v10, s[24:27], s35 offen offset:0
    s_add_u32 s35, s35, 40960
    buffer_load_dwordx4 v[52:55], v10, s[24:27], s35 offen offset:0
    s_add_u32 s35, s35, 40960
    buffer_load_dwordx4 v[56:59], v10, s[24:27], s35 offen offset:0
    s_add_u32 s35, s35, 40960
    buffer_load_dwordx4 v[60:63], v10, s[24:27], s35 offen offset:0
    s_add_u32 s35, s35, 40960
    buffer_load_dwordx4 v[64:67], v10, s[24:27], s35 offen offset:0
    s_sub_u32 s35, s35, 327680
    buffer_load_dwordx4 v[72:75], v10, s[24:27], s35 offen offset:128
    s_add_u32 s35, s35, 40960
    buffer_load_dwordx4 v[76:79], v10, s[24:27], s35 offen offset:128
    s_add_u32 s35, s35, 40960
    buffer_load_dwordx4 v[80:83], v10, s[24:27], s35 offen offset:128
    s_add_u32 s35, s35, 40960
    buffer_load_dwordx4 v[84:87], v10, s[24:27], s35 offen offset:128
    s_add_u32 s35, s35, 40960
    buffer_load_dwordx4 v[88:91], v10, s[24:27], s35 offen offset:128
    s_add_u32 s35, s35, 40960
    buffer_load_dwordx4 v[92:95], v10, s[24:27], s35 offen offset:128
    s_add_u32 s35, s35, 40960
    buffer_load_dwordx4 v[96:99], v10, s[24:27], s35 offen offset:128
    s_add_u32 s35, s35, 40960
    buffer_load_dwordx4 v[100:103], v10, s[24:27], s35 offen offset:128
    s_add_u32 s35, s35, 40960
    buffer_load_dwordx4 v[104:107], v10, s[24:27], s35 offen offset:128
    s_lshl_b32 s36, s34, 2
    s_add_u32 s36, s36, s20
    s_mul_i32 s38, s36, 52429
    s_lshr_b32 s38, s38, 18
    s_mul_i32 s39, s38, 5
    s_sub_u32 s39, s36, s39
    s_mul_i32 s37, s38, 280
    s_mul_i32 s40, s33, 45
    s_add_u32 s37, s37, s40
    s_add_u32 s37, s37, s39
    s_lshl_b32 s37, s37, 10
    s_add_u32 s37, s37, 6696960
    s_waitcnt vmcnt(17)
    ds_write_b128 v5, v[32:35] offset:0
    s_waitcnt vmcnt(16)
    ds_write_b128 v5, v[36:39] offset:4608
    s_waitcnt vmcnt(15)
    ds_write_b128 v5, v[40:43] offset:9216
    s_waitcnt vmcnt(14)
    ds_write_b128 v5, v[44:47] offset:13824
    s_waitcnt vmcnt(13)
    ds_write_b128 v5, v[48:51] offset:18432
    s_waitcnt vmcnt(12)
    ds_write_b128 v5, v[52:55] offset:23040
    s_waitcnt vmcnt(11)
    ds_write_b128 v5, v[56:59] offset:27648
    s_waitcnt vmcnt(10)
    ds_write_b128 v5, v[60:63] offset:32256
    s_waitcnt vmcnt(9)
    ds_write_b128 v5, v[64:67] offset:36864
    s_waitcnt lgkmcnt(0)
    s_barrier
    ds_read_b64_tr_b16 v[32:33], v8 offset:0
    ds_read_b64_tr_b16 v[34:35], v8 offset:576
    ds_read_b64_tr_b16 v[36:37], v8 offset:4608
    ds_read_b64_tr_b16 v[38:39], v8 offset:5184
    ds_read_b64_tr_b16 v[40:41], v8 offset:9216
    ds_read_b64_tr_b16 v[42:43], v8 offset:9792
    ds_read_b64_tr_b16 v[44:45], v8 offset:13824
    ds_read_b64_tr_b16 v[46:47], v8 offset:14400
    ds_read_b64_tr_b16 v[48:49], v8 offset:18432
    ds_read_b64_tr_b16 v[50:51], v8 offset:19008
    ds_read_b64_tr_b16 v[52:53], v8 offset:23040
    ds_read_b64_tr_b16 v[54:55], v8 offset:23616
    ds_read_b64_tr_b16 v[56:57], v8 offset:27648
    ds_read_b64_tr_b16 v[58:59], v8 offset:28224
    ds_read_b64_tr_b16 v[60:61], v8 offset:32256
    ds_read_b64_tr_b16 v[62:63], v8 offset:32832
    ds_read_b64_tr_b16 v[64:65], v8 offset:36864
    ds_read_b64_tr_b16 v[66:67], v8 offset:37440
    s_waitcnt lgkmcnt(15)
    s_add_u32 s38, s37, 0
    buffer_store_dwordx4 v[32:35], v9, s[28:31], s38 offen sc1
    s_waitcnt lgkmcnt(14)
    s_add_u32 s38, s37, 5120
    buffer_store_dwordx4 v[36:39], v9, s[28:31], s38 offen sc1
    s_waitcnt lgkmcnt(12)
    s_add_u32 s38, s37, 10240
    buffer_store_dwordx4 v[40:43], v9, s[28:31], s38 offen sc1
    s_waitcnt lgkmcnt(10)
    s_add_u32 s38, s37, 15360
    buffer_store_dwordx4 v[44:47], v9, s[28:31], s38 offen sc1
    s_waitcnt lgkmcnt(8)
    s_add_u32 s38, s37, 20480
    buffer_store_dwordx4 v[48:51], v9, s[28:31], s38 offen sc1
    s_waitcnt lgkmcnt(6)
    s_add_u32 s38, s37, 25600
    buffer_store_dwordx4 v[52:55], v9, s[28:31], s38 offen sc1
    s_waitcnt lgkmcnt(4)
    s_add_u32 s38, s37, 30720
    buffer_store_dwordx4 v[56:59], v9, s[28:31], s38 offen sc1
    s_waitcnt lgkmcnt(2)
    s_add_u32 s38, s37, 35840
    buffer_store_dwordx4 v[60:63], v9, s[28:31], s38 offen sc1
    s_waitcnt lgkmcnt(0)
    s_add_u32 s38, s37, 40960
    buffer_store_dwordx4 v[64:67], v9, s[28:31], s38 offen sc1
    s_add_u32 s34, s34, 1
    s_barrier
    s_lshl_b32 s36, s34, 2
    s_add_u32 s36, s36, s20
    s_mul_i32 s38, s36, 52429
    s_lshr_b32 s38, s38, 18
    s_mul_i32 s39, s38, 5
    s_sub_u32 s39, s36, s39
    s_mul_i32 s37, s38, 280
    s_mul_i32 s40, s33, 45
    s_add_u32 s37, s37, s40
    s_add_u32 s37, s37, s39
    s_lshl_b32 s37, s37, 10
    s_add_u32 s37, s37, 6696960
    s_waitcnt vmcnt(17)
    ds_write_b128 v5, v[72:75] offset:0
    s_waitcnt vmcnt(16)
    ds_write_b128 v5, v[76:79] offset:4608
    s_waitcnt vmcnt(15)
    ds_write_b128 v5, v[80:83] offset:9216
    s_waitcnt vmcnt(14)
    ds_write_b128 v5, v[84:87] offset:13824
    s_waitcnt vmcnt(13)
    ds_write_b128 v5, v[88:91] offset:18432
    s_waitcnt vmcnt(12)
    ds_write_b128 v5, v[92:95] offset:23040
    s_waitcnt vmcnt(11)
    ds_write_b128 v5, v[96:99] offset:27648
    s_waitcnt vmcnt(10)
    ds_write_b128 v5, v[100:103] offset:32256
    s_waitcnt vmcnt(9)
    ds_write_b128 v5, v[104:107] offset:36864
    s_waitcnt lgkmcnt(0)
    s_barrier
    ds_read_b64_tr_b16 v[72:73], v8 offset:0
    ds_read_b64_tr_b16 v[74:75], v8 offset:576
    ds_read_b64_tr_b16 v[76:77], v8 offset:4608
    ds_read_b64_tr_b16 v[78:79], v8 offset:5184
    ds_read_b64_tr_b16 v[80:81], v8 offset:9216
    ds_read_b64_tr_b16 v[82:83], v8 offset:9792
    ds_read_b64_tr_b16 v[84:85], v8 offset:13824
    ds_read_b64_tr_b16 v[86:87], v8 offset:14400
    ds_read_b64_tr_b16 v[88:89], v8 offset:18432
    ds_read_b64_tr_b16 v[90:91], v8 offset:19008
    ds_read_b64_tr_b16 v[92:93], v8 offset:23040
    ds_read_b64_tr_b16 v[94:95], v8 offset:23616
    ds_read_b64_tr_b16 v[96:97], v8 offset:27648
    ds_read_b64_tr_b16 v[98:99], v8 offset:28224
    ds_read_b64_tr_b16 v[100:101], v8 offset:32256
    ds_read_b64_tr_b16 v[102:103], v8 offset:32832
    ds_read_b64_tr_b16 v[104:105], v8 offset:36864
    ds_read_b64_tr_b16 v[106:107], v8 offset:37440
    s_waitcnt lgkmcnt(15)
    s_add_u32 s38, s37, 0
    buffer_store_dwordx4 v[72:75], v9, s[28:31], s38 offen sc1
    s_waitcnt lgkmcnt(14)
    s_add_u32 s38, s37, 5120
    buffer_store_dwordx4 v[76:79], v9, s[28:31], s38 offen sc1
    s_waitcnt lgkmcnt(12)
    s_add_u32 s38, s37, 10240
    buffer_store_dwordx4 v[80:83], v9, s[28:31], s38 offen sc1
    s_waitcnt lgkmcnt(10)
    s_add_u32 s38, s37, 15360
    buffer_store_dwordx4 v[84:87], v9, s[28:31], s38 offen sc1
    s_waitcnt lgkmcnt(8)
    s_add_u32 s38, s37, 20480
    buffer_store_dwordx4 v[88:91], v9, s[28:31], s38 offen sc1
    s_waitcnt lgkmcnt(6)
    s_add_u32 s38, s37, 25600
    buffer_store_dwordx4 v[92:95], v9, s[28:31], s38 offen sc1
    s_waitcnt lgkmcnt(4)
    s_add_u32 s38, s37, 30720
    buffer_store_dwordx4 v[96:99], v9, s[28:31], s38 offen sc1
    s_waitcnt lgkmcnt(2)
    s_add_u32 s38, s37, 35840
    buffer_store_dwordx4 v[100:103], v9, s[28:31], s38 offen sc1
    s_waitcnt lgkmcnt(0)
    s_add_u32 s38, s37, 40960
    buffer_store_dwordx4 v[104:107], v9, s[28:31], s38 offen sc1
    s_endpgm
k1_kernel_pke20:
    s_endpgm
k1_mod0:
    s_sub_u32 s54, s54, 128
    s_waitcnt lgkmcnt(0)
    s_mov_b32 s28, s10
    s_mov_b32 s29, s11
    s_mov_b32 s30, 268435456
    s_mov_b32 s31, 0x00020000
k1_modf:
    s_load_dwordx4 s[12:15], s[0:1], 88
    s_mov_b32 s32, s54
    v_and_b32 v3, 7, v0
    v_lshrrev_b32 v4, 3, v0
    v_lshlrev_b32 v5, 1, v4
    v_mul_u32_u24 v6, 7680, v4
    s_lshl_b32 s36, s32, 7
    v_lshl_add_u32 v7, v3, 4, s36
    v_add_u32 v6, v6, v7
    s_waitcnt lgkmcnt(0)
    s_mov_b32 s16, s12
    s_mov_b32 s17, s13
    s_mov_b32 s18, 1280
    s_mov_b32 s19, 0x00020000
    s_mov_b32 s20, s14
    s_mov_b32 s21, s15
    s_mov_b32 s22, 4915200
    s_mov_b32 s23, 0x00020000
    buffer_load_ushort v10, v5, s[16:19], 0 offen offset:0
    buffer_load_ushort v11, v5, s[16:19], 0 offen offset:64
    buffer_load_ushort v12, v5, s[16:19], 0 offen offset:128
    buffer_load_ushort v13, v5, s[16:19], 0 offen offset:192
    buffer_load_ushort v14, v5, s[16:19], 0 offen offset:256
    buffer_load_ushort v15, v5, s[16:19], 0 offen offset:320
    buffer_load_ushort v16, v5, s[16:19], 0 offen offset:384
    buffer_load_ushort v17, v5, s[16:19], 0 offen offset:448
    buffer_load_ushort v18, v5, s[16:19], 0 offen offset:512
    buffer_load_ushort v19, v5, s[16:19], 0 offen offset:576
    buffer_load_ushort v20, v5, s[16:19], 0 offen offset:640
    buffer_load_ushort v21, v5, s[16:19], 0 offen offset:704
    buffer_load_ushort v22, v5, s[16:19], 0 offen offset:768
    buffer_load_ushort v23, v5, s[16:19], 0 offen offset:832
    buffer_load_ushort v24, v5, s[16:19], 0 offen offset:896
    buffer_load_ushort v25, v5, s[16:19], 0 offen offset:960
    buffer_load_ushort v26, v5, s[16:19], 0 offen offset:1024
    buffer_load_ushort v27, v5, s[16:19], 0 offen offset:1088
    buffer_load_ushort v28, v5, s[16:19], 0 offen offset:1152
    buffer_load_ushort v29, v5, s[16:19], 0 offen offset:1216
    s_mov_b32 s37, 0
    buffer_load_dwordx4 v[32:35], v6, s[20:23], s37 offen
    s_mov_b32 s37, 245760
    buffer_load_dwordx4 v[36:39], v6, s[20:23], s37 offen
    s_mov_b32 s37, 491520
    buffer_load_dwordx4 v[40:43], v6, s[20:23], s37 offen
    s_mov_b32 s37, 737280
    buffer_load_dwordx4 v[44:47], v6, s[20:23], s37 offen
    s_mov_b32 s37, 983040
    buffer_load_dwordx4 v[48:51], v6, s[20:23], s37 offen
    s_mov_b32 s37, 1228800
    buffer_load_dwordx4 v[52:55], v6, s[20:23], s37 offen
    s_mov_b32 s37, 1474560
    buffer_load_dwordx4 v[56:59], v6, s[20:23], s37 offen
    s_mov_b32 s37, 1720320
    buffer_load_dwordx4 v[60:63], v6, s[20:23], s37 offen
    s_mov_b32 s37, 1966080
    buffer_load_dwordx4 v[64:67], v6, s[20:23], s37 offen
    s_mov_b32 s37, 2211840
    buffer_load_dwordx4 v[68:71], v6, s[20:23], s37 offen
    s_mov_b32 s37, 2457600
    buffer_load_dwordx4 v[72:75], v6, s[20:23], s37 offen
    s_mov_b32 s37, 2703360
    buffer_load_dwordx4 v[76:79], v6, s[20:23], s37 offen
    s_mov_b32 s37, 2949120
    buffer_load_dwordx4 v[80:83], v6, s[20:23], s37 offen
    s_mov_b32 s37, 3194880
    buffer_load_dwordx4 v[84:87], v6, s[20:23], s37 offen
    s_mov_b32 s37, 3440640
    buffer_load_dwordx4 v[88:91], v6, s[20:23], s37 offen
    s_mov_b32 s37, 3686400
    buffer_load_dwordx4 v[92:95], v6, s[20:23], s37 offen
    s_mov_b32 s37, 3932160
    buffer_load_dwordx4 v[96:99], v6, s[20:23], s37 offen
    s_mov_b32 s37, 4177920
    buffer_load_dwordx4 v[100:103], v6, s[20:23], s37 offen
    s_mov_b32 s37, 4423680
    buffer_load_dwordx4 v[104:107], v6, s[20:23], s37 offen
    s_mov_b32 s37, 4669440
    buffer_load_dwordx4 v[108:111], v6, s[20:23], s37 offen
    s_waitcnt vmcnt(20)
    v_lshlrev_b32 v10, 16, v10
    v_mul_f32 v120, 0xbfb8aa3b, v10
    v_exp_f32 v120, v120
    v_lshlrev_b32 v11, 16, v11
    v_mul_f32 v121, 0xbfb8aa3b, v11
    v_exp_f32 v121, v121
    v_lshlrev_b32 v12, 16, v12
    v_mul_f32 v122, 0xbfb8aa3b, v12
    v_exp_f32 v122, v122
    v_lshlrev_b32 v13, 16, v13
    v_mul_f32 v123, 0xbfb8aa3b, v13
    v_exp_f32 v123, v123
    v_lshlrev_b32 v14, 16, v14
    v_mul_f32 v124, 0xbfb8aa3b, v14
    v_exp_f32 v124, v124
    v_lshlrev_b32 v15, 16, v15
    v_mul_f32 v125, 0xbfb8aa3b, v15
    v_exp_f32 v125, v125
    v_lshlrev_b32 v16, 16, v16
    v_mul_f32 v126, 0xbfb8aa3b, v16
    v_exp_f32 v126, v126
    v_lshlrev_b32 v17, 16, v17
    v_mul_f32 v127, 0xbfb8aa3b, v17
    v_exp_f32 v127, v127
    v_lshlrev_b32 v18, 16, v18
    v_mul_f32 v128, 0xbfb8aa3b, v18
    v_exp_f32 v128, v128
    v_lshlrev_b32 v19, 16, v19
    v_mul_f32 v129, 0xbfb8aa3b, v19
    v_exp_f32 v129, v129
    v_lshlrev_b32 v20, 16, v20
    v_mul_f32 v130, 0xbfb8aa3b, v20
    v_exp_f32 v130, v130
    v_lshlrev_b32 v21, 16, v21
    v_mul_f32 v131, 0xbfb8aa3b, v21
    v_exp_f32 v131, v131
    v_lshlrev_b32 v22, 16, v22
    v_mul_f32 v132, 0xbfb8aa3b, v22
    v_exp_f32 v132, v132
    v_lshlrev_b32 v23, 16, v23
    v_mul_f32 v133, 0xbfb8aa3b, v23
    v_exp_f32 v133, v133
    v_lshlrev_b32 v24, 16, v24
    v_mul_f32 v134, 0xbfb8aa3b, v24
    v_exp_f32 v134, v134
    v_lshlrev_b32 v25, 16, v25
    v_mul_f32 v135, 0xbfb8aa3b, v25
    v_exp_f32 v135, v135
    v_lshlrev_b32 v26, 16, v26
    v_mul_f32 v136, 0xbfb8aa3b, v26
    v_exp_f32 v136, v136
    v_lshlrev_b32 v27, 16, v27
    v_mul_f32 v137, 0xbfb8aa3b, v27
    v_exp_f32 v137, v137
    v_lshlrev_b32 v28, 16, v28
    v_mul_f32 v138, 0xbfb8aa3b, v28
    v_exp_f32 v138, v138
    v_lshlrev_b32 v29, 16, v29
    v_mul_f32 v139, 0xbfb8aa3b, v29
    v_exp_f32 v139, v139
    v_add_f32 v120, 1.0, v120
    v_rcp_f32 v120, v120
    v_add_f32 v121, 1.0, v121
    v_rcp_f32 v121, v121
    v_add_f32 v122, 1.0, v122
    v_rcp_f32 v122, v122
    v_add_f32 v123, 1.0, v123
    v_rcp_f32 v123, v123
    v_add_f32 v124, 1.0, v124
    v_rcp_f32 v124, v124
    v_add_f32 v125, 1.0, v125
    v_rcp_f32 v125, v125
    v_add_f32 v126, 1.0, v126
    v_rcp_f32 v126, v126
    v_add_f32 v127, 1.0, v127
    v_rcp_f32 v127, v127
    v_add_f32 v128, 1.0, v128
    v_rcp_f32 v128, v128
    v_add_f32 v129, 1.0, v129
    v_rcp_f32 v129, v129
    v_add_f32 v130, 1.0, v130
    v_rcp_f32 v130, v130
    v_add_f32 v131, 1.0, v131
    v_rcp_f32 v131, v131
    v_add_f32 v132, 1.0, v132
    v_rcp_f32 v132, v132
    v_add_f32 v133, 1.0, v133
    v_rcp_f32 v133, v133
    v_add_f32 v134, 1.0, v134
    v_rcp_f32 v134, v134
    v_add_f32 v135, 1.0, v135
    v_rcp_f32 v135, v135
    v_add_f32 v136, 1.0, v136
    v_rcp_f32 v136, v136
    v_add_f32 v137, 1.0, v137
    v_rcp_f32 v137, v137
    v_add_f32 v138, 1.0, v138
    v_rcp_f32 v138, v138
    v_add_f32 v139, 1.0, v139
    v_rcp_f32 v139, v139
    s_nop 0
    v_mul_f32 v10, v10, v120
    v_mul_f32 v11, v11, v121
    v_mul_f32 v12, v12, v122
    v_mul_f32 v13, v13, v123
    v_mul_f32 v14, v14, v124
    v_mul_f32 v15, v15, v125
    v_mul_f32 v16, v16, v126
    v_mul_f32 v17, v17, v127
    v_mul_f32 v18, v18, v128
    v_mul_f32 v19, v19, v129
    v_mul_f32 v20, v20, v130
    v_mul_f32 v21, v21, v131
    v_mul_f32 v22, v22, v132
    v_mul_f32 v23, v23, v133
    v_mul_f32 v24, v24, v134
    v_mul_f32 v25, v25, v135
    v_mul_f32 v26, v26, v136
    v_mul_f32 v27, v27, v137
    v_mul_f32 v28, v28, v138
    v_mul_f32 v29, v29, v139
    v_cvt_pk_bf16_f32 v120, v10, v11
    v_lshlrev_b32 v10, 16, v120
    v_and_b32 v11, 0xffff0000, v120
    v_cvt_pk_bf16_f32 v120, v12, v13
    v_lshlrev_b32 v12, 16, v120
    v_and_b32 v13, 0xffff0000, v120
    v_cvt_pk_bf16_f32 v120, v14, v15
    v_lshlrev_b32 v14, 16, v120
    v_and_b32 v15, 0xffff0000, v120
    v_cvt_pk_bf16_f32 v120, v16, v17
    v_lshlrev_b32 v16, 16, v120
    v_and_b32 v17, 0xffff0000, v120
    v_cvt_pk_bf16_f32 v120, v18, v19
    v_lshlrev_b32 v18, 16, v120
    v_and_b32 v19, 0xffff0000, v120
    v_cvt_pk_bf16_f32 v120, v20, v21
    v_lshlrev_b32 v20, 16, v120
    v_and_b32 v21, 0xffff0000, v120
    v_cvt_pk_bf16_f32 v120, v22, v23
    v_lshlrev_b32 v22, 16, v120
    v_and_b32 v23, 0xffff0000, v120
    v_cvt_pk_bf16_f32 v120, v24, v25
    v_lshlrev_b32 v24, 16, v120
    v_and_b32 v25, 0xffff0000, v120
    v_cvt_pk_bf16_f32 v120, v26, v27
    v_lshlrev_b32 v26, 16, v120
    v_and_b32 v27, 0xffff0000, v120
    v_cvt_pk_bf16_f32 v120, v28, v29
    v_lshlrev_b32 v28, 16, v120
    v_and_b32 v29, 0xffff0000, v120
    v_mov_b32 v112, 0
    v_mov_b32 v113, 0
    v_mov_b32 v114, 0
    v_mov_b32 v115, 0
    v_mov_b32 v116, 0
    v_mov_b32 v117, 0
    v_mov_b32 v118, 0
    v_mov_b32 v119, 0
    s_waitcnt vmcnt(19)
    v_lshlrev_b32 v120, 16, v32
    v_and_b32 v121, 0xffff0000, v32
    v_lshlrev_b32 v122, 16, v33
    v_and_b32 v123, 0xffff0000, v33
    v_lshlrev_b32 v124, 16, v34
    v_and_b32 v125, 0xffff0000, v34
    v_lshlrev_b32 v126, 16, v35
    v_and_b32 v127, 0xffff0000, v35
    v_pk_fma_f32 v[112:113], v[120:121], v[10:11], v[112:113] op_sel:[0,0,0] op_sel_hi:[1,0,1]
    v_pk_fma_f32 v[114:115], v[122:123], v[10:11], v[114:115] op_sel:[0,0,0] op_sel_hi:[1,0,1]
    v_pk_fma_f32 v[116:117], v[124:125], v[10:11], v[116:117] op_sel:[0,0,0] op_sel_hi:[1,0,1]
    v_pk_fma_f32 v[118:119], v[126:127], v[10:11], v[118:119] op_sel:[0,0,0] op_sel_hi:[1,0,1]
    s_waitcnt vmcnt(18)
    v_lshlrev_b32 v120, 16, v36
    v_and_b32 v121, 0xffff0000, v36
    v_lshlrev_b32 v122, 16, v37
    v_and_b32 v123, 0xffff0000, v37
    v_lshlrev_b32 v124, 16, v38
    v_and_b32 v125, 0xffff0000, v38
    v_lshlrev_b32 v126, 16, v39
    v_and_b32 v127, 0xffff0000, v39
    v_pk_fma_f32 v[112:113], v[120:121], v[10:11], v[112:113] op_sel:[0,1,0] op_sel_hi:[1,1,1]
    v_pk_fma_f32 v[114:115], v[122:123], v[10:11], v[114:115] op_sel:[0,1,0] op_sel_hi:[1,1,1]
    v_pk_fma_f32 v[116:117], v[124:125], v[10:11], v[116:117] op_sel:[0,1,0] op_sel_hi:[1,1,1]
    v_pk_fma_f32 v[118:119], v[126:127], v[10:11], v[118:119] op_sel:[0,1,0] op_sel_hi:[1,1,1]
    s_waitcnt vmcnt(17)
    v_lshlrev_b32 v120, 16, v40
    v_and_b32 v121, 0xffff0000, v40
    v_lshlrev_b32 v122, 16, v41
    v_and_b32 v123, 0xffff0000, v41
    v_lshlrev_b32 v124, 16, v42
    v_and_b32 v125, 0xffff0000, v42
    v_lshlrev_b32 v126, 16, v43
    v_and_b32 v127, 0xffff0000, v43
    v_pk_fma_f32 v[112:113], v[120:121], v[12:13], v[112:113] op_sel:[0,0,0] op_sel_hi:[1,0,1]
    v_pk_fma_f32 v[114:115], v[122:123], v[12:13], v[114:115] op_sel:[0,0,0] op_sel_hi:[1,0,1]
    v_pk_fma_f32 v[116:117], v[124:125], v[12:13], v[116:117] op_sel:[0,0,0] op_sel_hi:[1,0,1]
    v_pk_fma_f32 v[118:119], v[126:127], v[12:13], v[118:119] op_sel:[0,0,0] op_sel_hi:[1,0,1]
    s_waitcnt vmcnt(16)
    v_lshlrev_b32 v120, 16, v44
    v_and_b32 v121, 0xffff0000, v44
    v_lshlrev_b32 v122, 16, v45
    v_and_b32 v123, 0xffff0000, v45
    v_lshlrev_b32 v124, 16, v46
    v_and_b32 v125, 0xffff0000, v46
    v_lshlrev_b32 v126, 16, v47
    v_and_b32 v127, 0xffff0000, v47
    v_pk_fma_f32 v[112:113], v[120:121], v[12:13], v[112:113] op_sel:[0,1,0] op_sel_hi:[1,1,1]
    v_pk_fma_f32 v[114:115], v[122:123], v[12:13], v[114:115] op_sel:[0,1,0] op_sel_hi:[1,1,1]
    v_pk_fma_f32 v[116:117], v[124:125], v[12:13], v[116:117] op_sel:[0,1,0] op_sel_hi:[1,1,1]
    v_pk_fma_f32 v[118:119], v[126:127], v[12:13], v[118:119] op_sel:[0,1,0] op_sel_hi:[1,1,1]
    s_waitcnt vmcnt(15)
    v_lshlrev_b32 v120, 16, v48
    v_and_b32 v121, 0xffff0000, v48
    v_lshlrev_b32 v122, 16, v49
    v_and_b32 v123, 0xffff0000, v49
    v_lshlrev_b32 v124, 16, v50
    v_and_b32 v125, 0xffff0000, v50
    v_lshlrev_b32 v126, 16, v51
    v_and_b32 v127, 0xffff0000, v51
    v_pk_fma_f32 v[112:113], v[120:121], v[14:15], v[112:113] op_sel:[0,0,0] op_sel_hi:[1,0,1]
    v_pk_fma_f32 v[114:115], v[122:123], v[14:15], v[114:115] op_sel:[0,0,0] op_sel_hi:[1,0,1]
    v_pk_fma_f32 v[116:117], v[124:125], v[14:15], v[116:117] op_sel:[0,0,0] op_sel_hi:[1,0,1]
    v_pk_fma_f32 v[118:119], v[126:127], v[14:15], v[118:119] op_sel:[0,0,0] op_sel_hi:[1,0,1]
    s_waitcnt vmcnt(14)
    v_lshlrev_b32 v120, 16, v52
    v_and_b32 v121, 0xffff0000, v52
    v_lshlrev_b32 v122, 16, v53
    v_and_b32 v123, 0xffff0000, v53
    v_lshlrev_b32 v124, 16, v54
    v_and_b32 v125, 0xffff0000, v54
    v_lshlrev_b32 v126, 16, v55
    v_and_b32 v127, 0xffff0000, v55
    v_pk_fma_f32 v[112:113], v[120:121], v[14:15], v[112:113] op_sel:[0,1,0] op_sel_hi:[1,1,1]
    v_pk_fma_f32 v[114:115], v[122:123], v[14:15], v[114:115] op_sel:[0,1,0] op_sel_hi:[1,1,1]
    v_pk_fma_f32 v[116:117], v[124:125], v[14:15], v[116:117] op_sel:[0,1,0] op_sel_hi:[1,1,1]
    v_pk_fma_f32 v[118:119], v[126:127], v[14:15], v[118:119] op_sel:[0,1,0] op_sel_hi:[1,1,1]
    s_waitcnt vmcnt(13)
    v_lshlrev_b32 v120, 16, v56
    v_and_b32 v121, 0xffff0000, v56
    v_lshlrev_b32 v122, 16, v57
    v_and_b32 v123, 0xffff0000, v57
    v_lshlrev_b32 v124, 16, v58
    v_and_b32 v125, 0xffff0000, v58
    v_lshlrev_b32 v126, 16, v59
    v_and_b32 v127, 0xffff0000, v59
    v_pk_fma_f32 v[112:113], v[120:121], v[16:17], v[112:113] op_sel:[0,0,0] op_sel_hi:[1,0,1]
    v_pk_fma_f32 v[114:115], v[122:123], v[16:17], v[114:115] op_sel:[0,0,0] op_sel_hi:[1,0,1]
    v_pk_fma_f32 v[116:117], v[124:125], v[16:17], v[116:117] op_sel:[0,0,0] op_sel_hi:[1,0,1]
    v_pk_fma_f32 v[118:119], v[126:127], v[16:17], v[118:119] op_sel:[0,0,0] op_sel_hi:[1,0,1]
    s_waitcnt vmcnt(12)
    v_lshlrev_b32 v120, 16, v60
    v_and_b32 v121, 0xffff0000, v60
    v_lshlrev_b32 v122, 16, v61
    v_and_b32 v123, 0xffff0000, v61
    v_lshlrev_b32 v124, 16, v62
    v_and_b32 v125, 0xffff0000, v62
    v_lshlrev_b32 v126, 16, v63
    v_and_b32 v127, 0xffff0000, v63
    v_pk_fma_f32 v[112:113], v[120:121], v[16:17], v[112:113] op_sel:[0,1,0] op_sel_hi:[1,1,1]
    v_pk_fma_f32 v[114:115], v[122:123], v[16:17], v[114:115] op_sel:[0,1,0] op_sel_hi:[1,1,1]
    v_pk_fma_f32 v[116:117], v[124:125], v[16:17], v[116:117] op_sel:[0,1,0] op_sel_hi:[1,1,1]
    v_pk_fma_f32 v[118:119], v[126:127], v[16:17], v[118:119] op_sel:[0,1,0] op_sel_hi:[1,1,1]
    s_waitcnt vmcnt(11)
    v_lshlrev_b32 v120, 16, v64
    v_and_b32 v121, 0xffff0000, v64
    v_lshlrev_b32 v122, 16, v65
    v_and_b32 v123, 0xffff0000, v65
    v_lshlrev_b32 v124, 16, v66
    v_and_b32 v125, 0xffff0000, v66
    v_lshlrev_b32 v126, 16, v67
    v_and_b32 v127, 0xffff0000, v67
    v_pk_fma_f32 v[112:113], v[120:121], v[18:19], v[112:113] op_sel:[0,0,0] op_sel_hi:[1,0,1]
    v_pk_fma_f32 v[114:115], v[122:123], v[18:19], v[114:115] op_sel:[0,0,0] op_sel_hi:[1,0,1]
    v_pk_fma_f32 v[116:117], v[124:125], v[18:19], v[116:117] op_sel:[0,0,0] op_sel_hi:[1,0,1]
    v_pk_fma_f32 v[118:119], v[126:127], v[18:19], v[118:119] op_sel:[0,0,0] op_sel_hi:[1,0,1]
    s_waitcnt vmcnt(10)
    v_lshlrev_b32 v120, 16, v68
    v_and_b32 v121, 0xffff0000, v68
    v_lshlrev_b32 v122, 16, v69
    v_and_b32 v123, 0xffff0000, v69
    v_lshlrev_b32 v124, 16, v70
    v_and_b32 v125, 0xffff0000, v70
    v_lshlrev_b32 v126, 16, v71
    v_and_b32 v127, 0xffff0000, v71
    v_pk_fma_f32 v[112:113], v[120:121], v[18:19], v[112:113] op_sel:[0,1,0] op_sel_hi:[1,1,1]
    v_pk_fma_f32 v[114:115], v[122:123], v[18:19], v[114:115] op_sel:[0,1,0] op_sel_hi:[1,1,1]
    v_pk_fma_f32 v[116:117], v[124:125], v[18:19], v[116:117] op_sel:[0,1,0] op_sel_hi:[1,1,1]
    v_pk_fma_f32 v[118:119], v[126:127], v[18:19], v[118:119] op_sel:[0,1,0] op_sel_hi:[1,1,1]
    s_waitcnt vmcnt(9)
    v_lshlrev_b32 v120, 16, v72
    v_and_b32 v121, 0xffff0000, v72
    v_lshlrev_b32 v122, 16, v73
    v_and_b32 v123, 0xffff0000, v73
    v_lshlrev_b32 v124, 16, v74
    v_and_b32 v125, 0xffff0000, v74
    v_lshlrev_b32 v126, 16, v75
    v_and_b32 v127, 0xffff0000, v75
    v_pk_fma_f32 v[112:113], v[120:121], v[20:21], v[112:113] op_sel:[0,0,0] op_sel_hi:[1,0,1]
    v_pk_fma_f32 v[114:115], v[122:123], v[20:21], v[114:115] op_sel:[0,0,0] op_sel_hi:[1,0,1]
    v_pk_fma_f32 v[116:117], v[124:125], v[20:21], v[116:117] op_sel:[0,0,0] op_sel_hi:[1,0,1]
    v_pk_fma_f32 v[118:119], v[126:127], v[20:21], v[118:119] op_sel:[0,0,0] op_sel_hi:[1,0,1]
    s_waitcnt vmcnt(8)
    v_lshlrev_b32 v120, 16, v76
    v_and_b32 v121, 0xffff0000, v76
    v_lshlrev_b32 v122, 16, v77
    v_and_b32 v123, 0xffff0000, v77
    v_lshlrev_b32 v124, 16, v78
    v_and_b32 v125, 0xffff0000, v78
    v_lshlrev_b32 v126, 16, v79
    v_and_b32 v127, 0xffff0000, v79
    v_pk_fma_f32 v[112:113], v[120:121], v[20:21], v[112:113] op_sel:[0,1,0] op_sel_hi:[1,1,1]
    v_pk_fma_f32 v[114:115], v[122:123], v[20:21], v[114:115] op_sel:[0,1,0] op_sel_hi:[1,1,1]
    v_pk_fma_f32 v[116:117], v[124:125], v[20:21], v[116:117] op_sel:[0,1,0] op_sel_hi:[1,1,1]
    v_pk_fma_f32 v[118:119], v[126:127], v[20:21], v[118:119] op_sel:[0,1,0] op_sel_hi:[1,1,1]
    s_waitcnt vmcnt(7)
    v_lshlrev_b32 v120, 16, v80
    v_and_b32 v121, 0xffff0000, v80
    v_lshlrev_b32 v122, 16, v81
    v_and_b32 v123, 0xffff0000, v81
    v_lshlrev_b32 v124, 16, v82
    v_and_b32 v125, 0xffff0000, v82
    v_lshlrev_b32 v126, 16, v83
    v_and_b32 v127, 0xffff0000, v83
    v_pk_fma_f32 v[112:113], v[120:121], v[22:23], v[112:113] op_sel:[0,0,0] op_sel_hi:[1,0,1]
    v_pk_fma_f32 v[114:115], v[122:123], v[22:23], v[114:115] op_sel:[0,0,0] op_sel_hi:[1,0,1]
    v_pk_fma_f32 v[116:117], v[124:125], v[22:23], v[116:117] op_sel:[0,0,0] op_sel_hi:[1,0,1]
    v_pk_fma_f32 v[118:119], v[126:127], v[22:23], v[118:119] op_sel:[0,0,0] op_sel_hi:[1,0,1]
    s_waitcnt vmcnt(6)
    v_lshlrev_b32 v120, 16, v84
    v_and_b32 v121, 0xffff0000, v84
    v_lshlrev_b32 v122, 16, v85
    v_and_b32 v123, 0xffff0000, v85
    v_lshlrev_b32 v124, 16, v86
    v_and_b32 v125, 0xffff0000, v86
    v_lshlrev_b32 v126, 16, v87
    v_and_b32 v127, 0xffff0000, v87
    v_pk_fma_f32 v[112:113], v[120:121], v[22:23], v[112:113] op_sel:[0,1,0] op_sel_hi:[1,1,1]
    v_pk_fma_f32 v[114:115], v[122:123], v[22:23], v[114:115] op_sel:[0,1,0] op_sel_hi:[1,1,1]
    v_pk_fma_f32 v[116:117], v[124:125], v[22:23], v[116:117] op_sel:[0,1,0] op_sel_hi:[1,1,1]
    v_pk_fma_f32 v[118:119], v[126:127], v[22:23], v[118:119] op_sel:[0,1,0] op_sel_hi:[1,1,1]
    s_waitcnt vmcnt(5)
    v_lshlrev_b32 v120, 16, v88
    v_and_b32 v121, 0xffff0000, v88
    v_lshlrev_b32 v122, 16, v89
    v_and_b32 v123, 0xffff0000, v89
    v_lshlrev_b32 v124, 16, v90
    v_and_b32 v125, 0xffff0000, v90
    v_lshlrev_b32 v126, 16, v91
    v_and_b32 v127, 0xffff0000, v91
    v_pk_fma_f32 v[112:113], v[120:121], v[24:25], v[112:113] op_sel:[0,0,0] op_sel_hi:[1,0,1]
    v_pk_fma_f32 v[114:115], v[122:123], v[24:25], v[114:115] op_sel:[0,0,0] op_sel_hi:[1,0,1]
    v_pk_fma_f32 v[116:117], v[124:125], v[24:25], v[116:117] op_sel:[0,0,0] op_sel_hi:[1,0,1]
    v_pk_fma_f32 v[118:119], v[126:127], v[24:25], v[118:119] op_sel:[0,0,0] op_sel_hi:[1,0,1]
    s_waitcnt vmcnt(4)
    v_lshlrev_b32 v120, 16, v92
    v_and_b32 v121, 0xffff0000, v92
    v_lshlrev_b32 v122, 16, v93
    v_and_b32 v123, 0xffff0000, v93
    v_lshlrev_b32 v124, 16, v94
    v_and_b32 v125, 0xffff0000, v94
    v_lshlrev_b32 v126, 16, v95
    v_and_b32 v127, 0xffff0000, v95
    v_pk_fma_f32 v[112:113], v[120:121], v[24:25], v[112:113] op_sel:[0,1,0] op_sel_hi:[1,1,1]
    v_pk_fma_f32 v[114:115], v[122:123], v[24:25], v[114:115] op_sel:[0,1,0] op_sel_hi:[1,1,1]
    v_pk_fma_f32 v[116:117], v[124:125], v[24:25], v[116:117] op_sel:[0,1,0] op_sel_hi:[1,1,1]
    v_pk_fma_f32 v[118:119], v[126:127], v[24:25], v[118:119] op_sel:[0,1,0] op_sel_hi:[1,1,1]
    s_waitcnt vmcnt(3)
    v_lshlrev_b32 v120, 16, v96
    v_and_b32 v121, 0xffff0000, v96
    v_lshlrev_b32 v122, 16, v97
    v_and_b32 v123, 0xffff0000, v97
    v_lshlrev_b32 v124, 16, v98
    v_and_b32 v125, 0xffff0000, v98
    v_lshlrev_b32 v126, 16, v99
    v_and_b32 v127, 0xffff0000, v99
    v_pk_fma_f32 v[112:113], v[120:121], v[26:27], v[112:113] op_sel:[0,0,0] op_sel_hi:[1,0,1]
    v_pk_fma_f32 v[114:115], v[122:123], v[26:27], v[114:115] op_sel:[0,0,0] op_sel_hi:[1,0,1]
    v_pk_fma_f32 v[116:117], v[124:125], v[26:27], v[116:117] op_sel:[0,0,0] op_sel_hi:[1,0,1]
    v_pk_fma_f32 v[118:119], v[126:127], v[26:27], v[118:119] op_sel:[0,0,0] op_sel_hi:[1,0,1]
    s_waitcnt vmcnt(2)
    v_lshlrev_b32 v120, 16, v100
    v_and_b32 v121, 0xffff0000, v100
    v_lshlrev_b32 v122, 16, v101
    v_and_b32 v123, 0xffff0000, v101
    v_lshlrev_b32 v124, 16, v102
    v_and_b32 v125, 0xffff0000, v102
    v_lshlrev_b32 v126, 16, v103
    v_and_b32 v127, 0xffff0000, v103
    v_pk_fma_f32 v[112:113], v[120:121], v[26:27], v[112:113] op_sel:[0,1,0] op_sel_hi:[1,1,1]
    v_pk_fma_f32 v[114:115], v[122:123], v[26:27], v[114:115] op_sel:[0,1,0] op_sel_hi:[1,1,1]
    v_pk_fma_f32 v[116:117], v[124:125], v[26:27], v[116:117] op_sel:[0,1,0] op_sel_hi:[1,1,1]
    v_pk_fma_f32 v[118:119], v[126:127], v[26:27], v[118:119] op_sel:[0,1,0] op_sel_hi:[1,1,1]
    s_waitcnt vmcnt(1)
    v_lshlrev_b32 v120, 16, v104
    v_and_b32 v121, 0xffff0000, v104
    v_lshlrev_b32 v122, 16, v105
    v_and_b32 v123, 0xffff0000, v105
    v_lshlrev_b32 v124, 16, v106
    v_and_b32 v125, 0xffff0000, v106
    v_lshlrev_b32 v126, 16, v107
    v_and_b32 v127, 0xffff0000, v107
    v_pk_fma_f32 v[112:113], v[120:121], v[28:29], v[112:113] op_sel:[0,0,0] op_sel_hi:[1,0,1]
    v_pk_fma_f32 v[114:115], v[122:123], v[28:29], v[114:115] op_sel:[0,0,0] op_sel_hi:[1,0,1]
    v_pk_fma_f32 v[116:117], v[124:125], v[28:29], v[116:117] op_sel:[0,0,0] op_sel_hi:[1,0,1]
    v_pk_fma_f32 v[118:119], v[126:127], v[28:29], v[118:119] op_sel:[0,0,0] op_sel_hi:[1,0,1]
    s_waitcnt vmcnt(0)
    v_lshlrev_b32 v120, 16, v108
    v_and_b32 v121, 0xffff0000, v108
    v_lshlrev_b32 v122, 16, v109
    v_and_b32 v123, 0xffff0000, v109
    v_lshlrev_b32 v124, 16, v110
    v_and_b32 v125, 0xffff0000, v110
    v_lshlrev_b32 v126, 16, v111
    v_and_b32 v127, 0xffff0000, v111
    v_pk_fma_f32 v[112:113], v[120:121], v[28:29], v[112:113] op_sel:[0,1,0] op_sel_hi:[1,1,1]
    v_pk_fma_f32 v[114:115], v[122:123], v[28:29], v[114:115] op_sel:[0,1,0] op_sel_hi:[1,1,1]
    v_pk_fma_f32 v[116:117], v[124:125], v[28:29], v[116:117] op_sel:[0,1,0] op_sel_hi:[1,1,1]
    v_pk_fma_f32 v[118:119], v[126:127], v[28:29], v[118:119] op_sel:[0,1,0] op_sel_hi:[1,1,1]
    v_lshlrev_b32 v7, 5, v0
    ds_write_b128 v7, v[112:115]
    ds_write_b128 v7, v[116:119] offset:16
    s_waitcnt lgkmcnt(0)
    s_barrier
    v_cmp_gt_u32 vcc, 64, v0
    s_and_saveexec_b64 s[42:43], vcc
    s_cbranch_execz k1_end
    v_lshlrev_b32 v7, 2, v0
    ds_read_b32 v32, v7 offset:0
    ds_read_b32 v33, v7 offset:256
    ds_read_b32 v34, v7 offset:512
    ds_read_b32 v35, v7 offset:768
    ds_read_b32 v36, v7 offset:1024
    ds_read_b32 v37, v7 offset:1280
    ds_read_b32 v38, v7 offset:1536
    ds_read_b32 v39, v7 offset:1792
    ds_read_b32 v40, v7 offset:2048
    ds_read_b32 v41, v7 offset:2304
    ds_read_b32 v42, v7 offset:2560
    ds_read_b32 v43, v7 offset:2816
    ds_read_b32 v44, v7 offset:3072
    ds_read_b32 v45, v7 offset:3328
    ds_read_b32 v46, v7 offset:3584
    ds_read_b32 v47, v7 offset:3840
    ds_read_b32 v48, v7 offset:4096
    ds_read_b32 v49, v7 offset:4352
    ds_read_b32 v50, v7 offset:4608
    ds_read_b32 v51, v7 offset:4864
    ds_read_b32 v52, v7 offset:5120
    ds_read_b32 v53, v7 offset:5376
    ds_read_b32 v54, v7 offset:5632
    ds_read_b32 v55, v7 offset:5888
    ds_read_b32 v56, v7 offset:6144
    ds_read_b32 v57, v7 offset:6400
    ds_read_b32 v58, v7 offset:6656
    ds_read_b32 v59, v7 offset:6912
    ds_read_b32 v60, v7 offset:7168
    ds_read_b32 v61, v7 offset:7424
    ds_read_b32 v62, v7 offset:7680
    ds_read_b32 v63, v7 offset:7936
    s_waitcnt lgkmcnt(0)
    v_add_f32 v32, v32, v48
    v_add_f32 v33, v33, v49
    v_add_f32 v34, v34, v50
    v_add_f32 v35, v35, v51
    v_add_f32 v36, v36, v52
    v_add_f32 v37, v37, v53
    v_add_f32 v38, v38, v54
    v_add_f32 v39, v39, v55
    v_add_f32 v40, v40, v56
    v_add_f32 v41, v41, v57
    v_add_f32 v42, v42, v58
    v_add_f32 v43, v43, v59
    v_add_f32 v44, v44, v60
    v_add_f32 v45, v45, v61
    v_add_f32 v46, v46, v62
    v_add_f32 v47, v47, v63
    v_add_f32 v32, v32, v40
    v_add_f32 v33, v33, v41
    v_add_f32 v34, v34, v42
    v_add_f32 v35, v35, v43
    v_add_f32 v36, v36, v44
    v_add_f32 v37, v37, v45
    v_add_f32 v38, v38, v46
    v_add_f32 v39, v39, v47
    v_add_f32 v32, v32, v36
    v_add_f32 v33, v33, v37
    v_add_f32 v34, v34, v38
    v_add_f32 v35, v35, v39
    v_add_f32 v32, v32, v34
    v_add_f32 v33, v33, v35
    v_add_f32 v32, v32, v33
    s_movk_i32 s22, 640
    v_cvt_pk_bf16_f32 v32, v32, v32
    v_lshlrev_b32 v32, 16, v32
    v_add_f32 v33, 1.0, v32
    v_cvt_pk_bf16_f32 v33, v33, v33
    v_lshlrev_b32 v33, 16, v33
    s_lshl_b32 s33, s32, 6
    v_add_u32 v34, s33, v0
    v_subrev_u32 v35, 640, v34
    v_cmp_gt_u32 vcc, 640, v35
    v_subrev_u32 v35, 2560, v34
    v_cmp_gt_u32 s[40:41], s22, v35
    s_or_b64 vcc, vcc, s[40:41]
    v_cndmask_b32 v32, v32, v33, vcc
    s_lshl_b32 s21, s32, 8
    s_add_u32 s21, s21, 2711552
    buffer_store_dword v32, v7, s[28:31], s21 offen sc1
k1_end:
    s_endpgm
k1_pf:
    s_waitcnt lgkmcnt(0)
    s_load_dwordx2 s[4:5], s[0:1], 0
    v_lshlrev_b32 v3, 7, v1
    v_lshlrev_b32 v1, 4, v1
    s_sub_u32 s24, s54, 96
    s_lshr_b32 s24, s24, 3
    s_lshl_b32 s24, s24, 2
    s_add_u32 s24, s24, s20
    s_and_b32 s22, s2, 7
    s_mul_i32 s21, s24, 20480
    s_mul_i32 s23, s22, 327680
    s_add_u32 s21, s21, s23
    s_waitcnt lgkmcnt(0)
    s_mov_b32 s16, s4
    s_mov_b32 s17, s5
    s_mov_b32 s18, 2621440
    s_mov_b32 s19, 0x00020000
    s_mov_b32 s28, s10
    s_mov_b32 s29, s11
    s_mov_b32 s30, 268435456
    s_mov_b32 s31, 0x00020000
    s_sub_u32 s36, s54, 96
    s_cmp_ge_u32 s36, 16
    s_cbranch_scc1 k1_kernel_zf22
    s_lshl_b32 s36, s36, 12
    s_add_u32 s36, s36, 8990720
    v_lshlrev_b32 v5, 4, v0
    v_mov_b32 v60, 0
    v_mov_b32 v61, 0
    v_mov_b32 v62, 0
    v_mov_b32 v63, 0
    buffer_store_dwordx4 v[60:63], v5, s[28:31], s36 offen sc1
k1_kernel_zf22:
    s_getpc_b64 s[40:41]
k1_pcref:
    s_sub_u32 s40, s40, k1_pcref-k1_kernel
    s_subb_u32 s41, s41, 0
    s_lshl_b32 s42, s24, 12
    s_add_u32 s43, s42, 0
    s_min_u32 s43, s43, (CODE_END-k1_kernel-1020)&0xfffffff0
    v_add_u32 v6, s43, v1
    global_load_dwordx4 v[64:67], v6, s[40:41]
    s_add_u32 s43, s42, 1024
    s_min_u32 s43, s43, (CODE_END-k1_kernel-1020)&0xfffffff0
    v_add_u32 v6, s43, v1
    global_load_dwordx4 v[68:71], v6, s[40:41]
    s_add_u32 s43, s42, 2048
    s_min_u32 s43, s43, (CODE_END-k1_kernel-1020)&0xfffffff0
    v_add_u32 v6, s43, v1
    global_load_dwordx4 v[72:75], v6, s[40:41]
    s_add_u32 s43, s42, 3072
    s_min_u32 s43, s43, (CODE_END-k1_kernel-1020)&0xfffffff0
    v_add_u32 v6, s43, v1
    global_load_dwordx4 v[76:79], v6, s[40:41]
    s_mov_b32 s61, s21
    s_mov_b32 s62, s24
    s_waitcnt vmcnt(0)
    s_cmp_lg_u32 s20, 0
    s_cbranch_scc1 k1_kernel_sw24
    s_and_b32 s55, s2, 7
    s_lshl_b32 s57, s55, 9
    s_add_u32 s57, s57, 9056256
    v_mov_b32 v250, 0
    v_and_b32 v248, 31, v0
    v_lshlrev_b32 v248, 2, v248
    s_waitcnt lgkmcnt(0)
    s_mov_b32 s28, s10
    s_mov_b32 s29, s11
    s_mov_b32 s30, 268435456
    s_mov_b32 s31, 0x00020000
    buffer_load_dword v251, v250, s[28:31], s57 offen sc1
    s_mov_b32 s23, 30
    s_waitcnt vmcnt(0)
    v_add_u32 v251, 1, v251
k1_kernel_sw23:
    buffer_load_dword v249, v248, s[28:31], s57 offen offset:256 sc1
    s_waitcnt vmcnt(0)
    v_cmp_eq_u32 vcc, v251, v249
    s_sub_u32 s23, s23, 1
    s_cmp_eq_u64 vcc, -1
    s_cbranch_scc1 k1_kernel_sw24
    s_sleep 16
    s_cmp_lg_u32 s23, 0
    s_cbranch_scc1 k1_kernel_sw23
k1_kernel_sw24:
    s_barrier
    s_mov_b32 s21, s61
    s_mov_b32 s24, s62
    s_mov_b32 s28, s10
    s_mov_b32 s29, s11
    s_mov_b32 s30, 268435456
    s_mov_b32 s31, 0x00020000
    buffer_load_dwordx4 v[8:11], v1, s[16:19], s21 offen offset:0
    buffer_load_dwordx4 v[12:15], v1, s[16:19], s21 offen offset:1024
    buffer_load_dwordx4 v[16:19], v1, s[16:19], s21 offen offset:2048
    buffer_load_dwordx4 v[20:23], v1, s[16:19], s21 offen offset:3072
    s_add_u32 s21, s21, 4096
    buffer_load_dwordx4 v[24:27], v1, s[16:19], s21 offen offset:0
    buffer_load_dwordx4 v[28:31], v1, s[16:19], s21 offen offset:1024
    buffer_load_dwordx4 v[32:35], v1, s[16:19], s21 offen offset:2048
    buffer_load_dwordx4 v[36:39], v1, s[16:19], s21 offen offset:3072
    s_add_u32 s21, s21, 4096
    buffer_load_dwordx4 v[40:43], v1, s[16:19], s21 offen offset:0
    buffer_load_dwordx4 v[44:47], v1, s[16:19], s21 offen offset:1024
    buffer_load_dwordx4 v[8:11], v1, s[16:19], s21 offen offset:2048
    buffer_load_dwordx4 v[12:15], v1, s[16:19], s21 offen offset:3072
    s_add_u32 s21, s21, 4096
    buffer_load_dwordx4 v[16:19], v1, s[16:19], s21 offen offset:0
    buffer_load_dwordx4 v[20:23], v1, s[16:19], s21 offen offset:1024
    buffer_load_dwordx4 v[24:27], v1, s[16:19], s21 offen offset:2048
    buffer_load_dwordx4 v[28:31], v1, s[16:19], s21 offen offset:3072
    s_add_u32 s21, s21, 4096
    buffer_load_dwordx4 v[32:35], v1, s[16:19], s21 offen offset:0
    buffer_load_dwordx4 v[36:39], v1, s[16:19], s21 offen offset:1024
    buffer_load_dwordx4 v[40:43], v1, s[16:19], s21 offen offset:2048
    buffer_load_dwordx4 v[44:47], v1, s[16:19], s21 offen offset:3072
    s_add_u32 s21, s21, 4096
    s_mul_i32 s22, s22, 1601536
    s_add_u32 s22, s22, 9060352
    s_waitcnt vmcnt(0)
    s_endpgm
.globl k2_kernel
.p2align 8
.type k2_kernel,@function
k2_kernel:
    s_cmp_ge_u32 s2, 256
    s_cbranch_scc1 k2_end
    s_load_dwordx2 s[4:5], s[0:1], 0
    s_load_dwordx2 s[6:7], s[0:1], 104
    s_load_dwordx2 s[8:9], s[0:1], 120
    s_getreg_b32 s42, hwreg(HW_REG_XCC_ID, 0, 4)
    v_lshrrev_b32 v2, 6, v0
    v_and_b32 v1, 63, v0
    v_readfirstlane_b32 s30, v2
    s_and_b32 s28, s2, 7
    s_lshr_b32 s29, s2, 3
    s_lshr_b32 s32, s29, 3
    s_and_b32 s33, s29, 7
    s_lshr_b32 s34, s29, 4
    s_and_b32 s35, s29, 15
    s_mul_i32 s36, s28, 1601536
    s_add_u32 s36, s36, 9060352
    s_lshl_b32 s37, s28, 13
    s_add_u32 s37, s37, 8990720
    s_add_u32 s42, s42, 1
    s_mov_b32 s31, 0
    v_lshlrev_b32 v2, 4, v1
    v_lshrrev_b32 v3, 4, v1
    v_and_b32 v4, 15, v1
    v_lshrrev_b32 v8, 1, v3
    v_lshl_add_u32 v8, v8, 4, v4
    v_and_b32 v9, 1, v3
    v_lshl_add_u32 v8, v8, 1, v9
    v_lshlrev_b32 v8, 3, v8
    v_lshlrev_b32 v5, 7, v1
    v_and_b32 v9, 1, v3
    v_lshlrev_b32 v9, 1, v9
    v_lshrrev_b32 v10, 1, v3
    v_or_b32 v9, v9, v10
    v_lshlrev_b32 v9, 8, v9
    v_lshl_add_u32 v254, v4, 4, v9
    s_waitcnt lgkmcnt(0)
    s_mov_b32 s12, s8
    s_mov_b32 s13, s9
    s_mov_b32 s14, 268435456
    s_mov_b32 s15, 0x00020000
    s_mov_b32 s16, s4
    s_mov_b32 s17, s5
    s_mov_b32 s18, 2621440
    s_mov_b32 s19, 0x00020000
    s_mov_b32 s24, s6
    s_mov_b32 s25, s7
    s_mov_b32 s26, 2621440
    s_mov_b32 s27, 0x00020000
    s_cmp_lg_u32 s30, 0
    s_cbranch_scc1 k2_kernel_L1
    s_lshl_b32 s41, s29, 2
    s_add_u32 s41, s41, s37
    v_mov_b32 v9, s42
    v_mov_b32 v10, 7424
    s_mov_b64 exec, 1
    buffer_store_dword v9, v10, s[12:15], s41 offen sc1
    s_mov_b64 exec, -1
k2_kernel_L1:
    s_mul_i32 s44, s33, 102400
    s_mul_i32 s45, s35, 143360
    s_add_u32 s45, s45, 4403200
    s_mul_i32 s40, s33, 286720
    s_mul_i32 s41, s30, 71680
    s_add_u32 s40, s40, s41
    s_add_u32 s40, s40, 6696960
    s_lshl_b32 s46, s32, 2
    s_add_u32 s46, s46, s30
    s_mul_i32 s47, s46, 20480
    s_mul_i32 s41, s33, 2560
    s_add_u32 s47, s47, s41
    s_add_u32 s54, s47, s36
    s_lshl_b32 s55, s46, 7
    s_add_u32 s55, s55, s37
    s_mul_i32 s22, s28, 327680
    s_add_u32 s22, s22, s47
    s_add_u32 s22, s22, 0
    s_mul_i32 s38, s30, 25600
    s_add_u32 s39, s38, s44
    s_add_u32 s39, s39, 2764800
    s_add_u32 s38, s38, 0
    s_cmp_ge_u32 s29, 18
    s_cbranch_scc1 k2_kernel_nob02
    s_lshl_b32 s46, s28, 8
    s_lshl_b32 s47, s29, 4
    s_add_u32 s46, s46, s47
    s_sub_u32 s46, s46, 16
    s_lshl_b32 s47, s30, 2
    s_add_u32 s47, s47, s46
    v_add_u32 v11, s47, v3
    s_movk_i32 s48, 1280
    v_mul_lo_u32 v6, v11, s48
    v_lshl_add_u32 v6, v4, 4, v6
    buffer_load_dwordx4 v[16:19], v6, s[16:19], 0 offen offset:0
    buffer_load_dwordx4 v[20:23], v6, s[16:19], 0 offen offset:256
    buffer_load_dwordx4 v[24:27], v6, s[16:19], 0 offen offset:512
    buffer_load_dwordx4 v[28:31], v6, s[16:19], 0 offen offset:768
    buffer_load_dwordx4 v[32:35], v6, s[16:19], 0 offen offset:1024
    s_mul_i32 s47, s29, 20480
    s_mul_i32 s48, s30, 5120
    s_add_u32 s47, s47, s48
    s_add_u32 s47, s47, s36
    s_cmp_lt_u32 s46, 2048
    s_cselect_b32 s47, s47, 0x80000000
    v_add_u32 v12, s47, v2
    s_add_u32 s48, s48, 135168
    s_mov_b32 m0, s48
    s_nop 0
    buffer_load_dwordx4 v12, s[12:15], 0 offen offset:0 lds
    buffer_load_dwordx4 v12, s[12:15], 0 offen offset:1024 lds
    buffer_load_dwordx4 v12, s[12:15], 0 offen offset:2048 lds
    buffer_load_dwordx4 v12, s[12:15], 0 offen offset:3072 lds
    s_add_u32 s48, s48, 4096
    s_mov_b32 m0, s48
    s_movk_i32 s47, 4096
    buffer_load_dwordx4 v12, s[12:15], s47 offen lds
    s_lshl_b32 s47, s30, 12
    s_add_u32 s48, s47, 118784
    s_mov_b32 m0, s48
    s_add_u32 s47, s47, 2711552
    buffer_load_dwordx4 v2, s[12:15], s47 offen offset:0 lds
    buffer_load_dwordx4 v2, s[12:15], s47 offen offset:1024 lds
    buffer_load_dwordx4 v2, s[12:15], s47 offen offset:2048 lds
    buffer_load_dwordx4 v2, s[12:15], s47 offen offset:3072 lds
    v_lshl_add_u32 v15, s30, 2, v3
    v_lshrrev_b32 v7, 1, v15
    v_and_b32 v9, 7, v4
    v_xor_b32 v7, v7, v9
    v_and_b32 v9, 1, v15
    v_lshl_add_u32 v7, v7, 1, v9
    v_lshlrev_b32 v7, 3, v7
    v_lshl_add_u32 v7, v4, 8, v7
    v_add_u32 v7, 135168, v7
    v_lshlrev_b32 v10, 5, v4
    v_add_u32 v10, 118784, v10
    v_lshrrev_b32 v12, 2, v4
    v_and_b32 v13, 3, v4
    v_lshl_add_u32 v13, v13, 4, v15
    v_lshlrev_b32 v13, 4, v13
    v_lshl_add_u32 v6, v12, 10, v13
    s_movk_i32 s48, 2048
    v_cmp_gt_u32 s[50:51], s48, v11
    v_mov_b32 v120, 0
    v_mov_b32 v121, 0
    v_mov_b32 v124, 0
    v_mov_b32 v125, 0
    v_mov_b32 v126, 0x3f803f80
    s_waitcnt vmcnt(9)
    v_dot2_f32_bf16 v120, v16, v126, v120
    v_dot2_f32_bf16 v121, v16, v16, v121
    v_lshlrev_b32 v56, 16, v16
    v_and_b32 v57, 0xffff0000, v16
    v_dot2_f32_bf16 v120, v17, v126, v120
    v_dot2_f32_bf16 v121, v17, v17, v121
    v_lshlrev_b32 v58, 16, v17
    v_and_b32 v59, 0xffff0000, v17
    v_dot2_f32_bf16 v120, v18, v126, v120
    v_dot2_f32_bf16 v121, v18, v18, v121
    v_lshlrev_b32 v60, 16, v18
    v_and_b32 v61, 0xffff0000, v18
    s_cmp_eq_u32 s30, 1
    s_cbranch_scc1 k2_kernel_sm4
    s_cmp_ge_u32 s30, 2
    s_cbranch_scc1 k2_kernel_sm5
    s_mul_i32 s41, s33, 320
    s_add_u32 s41, s41, 2748416
    s_mov_b32 m0, 155648
    s_mov_b64 exec, 0xfffff
    buffer_load_dwordx4 v2, s[12:15], s41 offen lds
    s_add_u32 s41, s41, 7168
    s_mov_b32 m0, 156160
    s_nop 0
    buffer_load_dwordx4 v2, s[12:15], s41 offen lds
    s_branch k2_kernel_sm6
k2_kernel_sm4:
    s_mul_i32 s41, s35, 448
    s_add_u32 s41, s41, 2732032
    s_mov_b32 m0, 156672
    s_mov_b64 exec, 0xfffffff
    buffer_load_dwordx4 v2, s[12:15], s41 offen lds
    s_add_u32 s41, s41, 7168
    s_mov_b32 m0, 157184
    s_nop 0
    buffer_load_dwordx4 v2, s[12:15], s41 offen lds
    s_branch k2_kernel_sm6
k2_kernel_sm5:
    s_mul_i32 s41, s33, 320
    s_add_u32 s41, s41, 2724352
    s_mov_b32 m0, 157696
    s_mov_b64 exec, 0xfffff
    buffer_load_dwordx4 v2, s[12:15], s41 offen lds
k2_kernel_sm6:
    s_mov_b64 exec, -1
    v_dot2_f32_bf16 v120, v19, v126, v120
    v_dot2_f32_bf16 v121, v19, v19, v121
    v_lshlrev_b32 v62, 16, v19
    v_and_b32 v63, 0xffff0000, v19
    v_dot2_f32_bf16 v120, v20, v126, v120
    v_dot2_f32_bf16 v121, v20, v20, v121
    v_lshlrev_b32 v64, 16, v20
    v_and_b32 v65, 0xffff0000, v20
    s_mov_b32 m0, s38
    s_nop 0
    buffer_load_dwordx4 v2, s[12:15], s39 offen offset:0 lds
    v_dot2_f32_bf16 v120, v21, v126, v120
    v_dot2_f32_bf16 v121, v21, v21, v121
    v_lshlrev_b32 v66, 16, v21
    v_and_b32 v67, 0xffff0000, v21
    v_dot2_f32_bf16 v120, v22, v126, v120
    v_dot2_f32_bf16 v121, v22, v22, v121
    v_lshlrev_b32 v68, 16, v22
    v_and_b32 v69, 0xffff0000, v22
    s_mov_b32 m0, s38
    s_nop 0
    buffer_load_dwordx4 v2, s[12:15], s39 offen offset:1024 lds
    v_dot2_f32_bf16 v120, v23, v126, v120
    v_dot2_f32_bf16 v121, v23, v23, v121
    v_lshlrev_b32 v70, 16, v23
    v_and_b32 v71, 0xffff0000, v23
    v_dot2_f32_bf16 v120, v24, v126, v120
    v_dot2_f32_bf16 v121, v24, v24, v121
    v_lshlrev_b32 v72, 16, v24
    v_and_b32 v73, 0xffff0000, v24
    s_mov_b32 m0, s38
    s_nop 0
    buffer_load_dwordx4 v2, s[12:15], s39 offen offset:2048 lds
    v_dot2_f32_bf16 v120, v25, v126, v120
    v_dot2_f32_bf16 v121, v25, v25, v121
    v_lshlrev_b32 v74, 16, v25
    v_and_b32 v75, 0xffff0000, v25
    v_dot2_f32_bf16 v120, v26, v126, v120
    v_dot2_f32_bf16 v121, v26, v26, v121
    v_lshlrev_b32 v76, 16, v26
    v_and_b32 v77, 0xffff0000, v26
    s_mov_b32 m0, s38
    s_nop 0
    buffer_load_dwordx4 v2, s[12:15], s39 offen offset:3072 lds
    s_add_u32 s38, s38, 4096
    s_add_u32 s39, s39, 4096
    v_dot2_f32_bf16 v120, v27, v126, v120
    v_dot2_f32_bf16 v121, v27, v27, v121
    v_lshlrev_b32 v78, 16, v27
    v_and_b32 v79, 0xffff0000, v27
    v_dot2_f32_bf16 v120, v28, v126, v120
    v_dot2_f32_bf16 v121, v28, v28, v121
    v_lshlrev_b32 v80, 16, v28
    v_and_b32 v81, 0xffff0000, v28
    s_mov_b32 m0, s38
    s_nop 0
    buffer_load_dwordx4 v2, s[12:15], s39 offen offset:0 lds
    v_dot2_f32_bf16 v120, v29, v126, v120
    v_dot2_f32_bf16 v121, v29, v29, v121
    v_lshlrev_b32 v82, 16, v29
    v_and_b32 v83, 0xffff0000, v29
    v_dot2_f32_bf16 v120, v30, v126, v120
    v_dot2_f32_bf16 v121, v30, v30, v121
    v_lshlrev_b32 v84, 16, v30
    v_and_b32 v85, 0xffff0000, v30
    s_mov_b32 m0, s38
    s_nop 0
    buffer_load_dwordx4 v2, s[12:15], s39 offen offset:1024 lds
    v_dot2_f32_bf16 v120, v31, v126, v120
    v_dot2_f32_bf16 v121, v31, v31, v121
    v_lshlrev_b32 v86, 16, v31
    v_and_b32 v87, 0xffff0000, v31
    v_dot2_f32_bf16 v120, v32, v126, v120
    v_dot2_f32_bf16 v121, v32, v32, v121
    v_lshlrev_b32 v88, 16, v32
    v_and_b32 v89, 0xffff0000, v32
    s_mov_b32 m0, s38
    s_nop 0
    buffer_load_dwordx4 v2, s[12:15], s39 offen offset:2048 lds
    v_dot2_f32_bf16 v120, v33, v126, v120
    v_dot2_f32_bf16 v121, v33, v33, v121
    v_lshlrev_b32 v90, 16, v33
    v_and_b32 v91, 0xffff0000, v33
    v_dot2_f32_bf16 v120, v34, v126, v120
    v_dot2_f32_bf16 v121, v34, v34, v121
    v_lshlrev_b32 v92, 16, v34
    v_and_b32 v93, 0xffff0000, v34
    s_mov_b32 m0, s38
    s_nop 0
    buffer_load_dwordx4 v2, s[12:15], s39 offen offset:3072 lds
    s_add_u32 s38, s38, 4096
    s_add_u32 s39, s39, 4096
    v_dot2_f32_bf16 v120, v35, v126, v120
    v_dot2_f32_bf16 v121, v35, v35, v121
    v_lshlrev_b32 v94, 16, v35
    v_and_b32 v95, 0xffff0000, v35
    s_nop 1
    s_nop 0
    v_add_f32_dpp v120, v120, v120 quad_perm:[1,0,3,2] row_mask:0xf bank_mask:0xf
    v_add_f32_dpp v121, v121, v121 quad_perm:[1,0,3,2] row_mask:0xf bank_mask:0xf
    s_nop 0
    v_add_f32_dpp v120, v120, v120 quad_perm:[2,3,0,1] row_mask:0xf bank_mask:0xf
    v_add_f32_dpp v121, v121, v121 quad_perm:[2,3,0,1] row_mask:0xf bank_mask:0xf
    s_nop 0
    v_add_f32_dpp v120, v120, v120 row_half_mirror row_mask:0xf bank_mask:0xf
    v_add_f32_dpp v121, v121, v121 row_half_mirror row_mask:0xf bank_mask:0xf
    s_nop 0
    v_add_f32_dpp v120, v120, v120 row_mirror row_mask:0xf bank_mask:0xf
    v_add_f32_dpp v121, v121, v121 row_mirror row_mask:0xf bank_mask:0xf
    v_mul_f32 v120, 0x3acccccd, v120
    v_mul_f32 v121, 0x3acccccd, v121
    v_fma_f32 v121, -v120, v120, v121
    v_max_f32 v121, 0, v121
    v_cvt_pk_bf16_f32 v122, v120, v121
    v_lshlrev_b32 v120, 16, v122
    v_and_b32 v121, 0xffff0000, v122
    v_add_f32 v121, 0x3727c5ac, v121
    v_cvt_pk_bf16_f32 v122, v121, v121
    v_lshlrev_b32 v121, 16, v122
    v_sqrt_f32 v121, v121
    s_nop 0
    v_cvt_pk_bf16_f32 v122, v121, v121
    v_lshlrev_b32 v121, 16, v122
    v_rcp_f32 v121, v121
    s_nop 0
    v_mul_f32 v120, v120, v121
    v_sub_f32 v120, 0, v120
    s_waitcnt vmcnt(9)
    s_barrier
    ds_read_b64 v[36:37], v7 offset:0
    ds_read_b64 v[38:39], v7 offset:128
    ds_read_b64 v[40:41], v7 offset:4096
    ds_read_b64 v[42:43], v7 offset:4224
    ds_read_b64 v[44:45], v7 offset:8192
    ds_read_b64 v[46:47], v7 offset:8320
    ds_read_b64 v[48:49], v7 offset:12288
    ds_read_b64 v[50:51], v7 offset:12416
    ds_read_b64 v[52:53], v7 offset:16384
    ds_read_b64 v[54:55], v7 offset:16512
    ds_read_b128 v[96:99], v10 offset:2560
    ds_read_b128 v[100:103], v10 offset:2576
    ds_read_b128 v[104:107], v10 offset:0
    ds_read_b128 v[108:111], v10 offset:16
    ds_read_b128 v[112:115], v10 offset:5120
    ds_read_b128 v[116:119], v10 offset:5136
    ds_read_b128 v[160:163], v10 offset:3072
    ds_read_b128 v[164:167], v10 offset:3088
    ds_read_b128 v[168:171], v10 offset:512
    ds_read_b128 v[172:175], v10 offset:528
    ds_read_b128 v[176:179], v10 offset:5632
    ds_read_b128 v[180:183], v10 offset:5648
    s_waitcnt lgkmcnt(6)
    v_lshlrev_b32 v152, 16, v36
    v_and_b32 v153, 0xffff0000, v36
    v_lshlrev_b32 v154, 16, v37
    v_and_b32 v155, 0xffff0000, v37
    v_lshlrev_b32 v156, 16, v38
    v_and_b32 v157, 0xffff0000, v38
    v_lshlrev_b32 v158, 16, v39
    v_and_b32 v159, 0xffff0000, v39
    v_pk_fma_f32 v[144:145], v[56:57], v[120:121], v[120:121] op_sel:[0,1,0] op_sel_hi:[1,1,0]
    v_pk_fma_f32 v[146:147], v[58:59], v[120:121], v[120:121] op_sel:[0,1,0] op_sel_hi:[1,1,0]
    v_pk_fma_f32 v[148:149], v[60:61], v[120:121], v[120:121] op_sel:[0,1,0] op_sel_hi:[1,1,0]
    v_pk_fma_f32 v[150:151], v[62:63], v[120:121], v[120:121] op_sel:[0,1,0] op_sel_hi:[1,1,0]
    v_pk_fma_f32 v[144:145], v[144:145], v[96:97], v[104:105]
    v_pk_fma_f32 v[146:147], v[146:147], v[98:99], v[106:107]
    v_pk_fma_f32 v[148:149], v[148:149], v[100:101], v[108:109]
    v_pk_fma_f32 v[150:151], v[150:151], v[102:103], v[110:111]
    v_pk_mul_f32 v[144:145], v[144:145], v[152:153]
    v_pk_mul_f32 v[146:147], v[146:147], v[154:155]
    v_pk_mul_f32 v[148:149], v[148:149], v[156:157]
    v_pk_mul_f32 v[150:151], v[150:151], v[158:159]
    v_pk_fma_f32 v[56:57], v[112:113], v[144:145], v[56:57]
    v_pk_fma_f32 v[58:59], v[114:115], v[146:147], v[58:59]
    v_pk_fma_f32 v[60:61], v[116:117], v[148:149], v[60:61]
    v_pk_fma_f32 v[62:63], v[118:119], v[150:151], v[62:63]
    v_cvt_pk_bf16_f32 v16, v56, v57
    v_cvt_pk_bf16_f32 v17, v58, v59
    v_cvt_pk_bf16_f32 v18, v60, v61
    v_cvt_pk_bf16_f32 v19, v62, v63
    v_dot2_f32_bf16 v124, v16, v126, v124
    v_dot2_f32_bf16 v125, v16, v16, v125
    v_dot2_f32_bf16 v124, v17, v126, v124
    v_dot2_f32_bf16 v125, v17, v17, v125
    v_dot2_f32_bf16 v124, v18, v126, v124
    v_dot2_f32_bf16 v125, v18, v18, v125
    v_dot2_f32_bf16 v124, v19, v126, v124
    v_dot2_f32_bf16 v125, v19, v19, v125
    ds_read_b128 v[96:99], v10 offset:3584
    ds_read_b128 v[100:103], v10 offset:3600
    ds_read_b128 v[104:107], v10 offset:1024
    ds_read_b128 v[108:111], v10 offset:1040
    ds_read_b128 v[112:115], v10 offset:6144
    ds_read_b128 v[116:119], v10 offset:6160
    s_waitcnt lgkmcnt(6)
    v_lshlrev_b32 v152, 16, v40
    v_and_b32 v153, 0xffff0000, v40
    v_lshlrev_b32 v154, 16, v41
    v_and_b32 v155, 0xffff0000, v41
    v_lshlrev_b32 v156, 16, v42
    v_and_b32 v157, 0xffff0000, v42
    v_lshlrev_b32 v158, 16, v43
    v_and_b32 v159, 0xffff0000, v43
    v_pk_fma_f32 v[144:145], v[64:65], v[120:121], v[120:121] op_sel:[0,1,0] op_sel_hi:[1,1,0]
    v_pk_fma_f32 v[146:147], v[66:67], v[120:121], v[120:121] op_sel:[0,1,0] op_sel_hi:[1,1,0]
    v_pk_fma_f32 v[148:149], v[68:69], v[120:121], v[120:121] op_sel:[0,1,0] op_sel_hi:[1,1,0]
    v_pk_fma_f32 v[150:151], v[70:71], v[120:121], v[120:121] op_sel:[0,1,0] op_sel_hi:[1,1,0]
    v_pk_fma_f32 v[144:145], v[144:145], v[160:161], v[168:169]
    v_pk_fma_f32 v[146:147], v[146:147], v[162:163], v[170:171]
    v_pk_fma_f32 v[148:149], v[148:149], v[164:165], v[172:173]
    v_pk_fma_f32 v[150:151], v[150:151], v[166:167], v[174:175]
    v_pk_mul_f32 v[144:145], v[144:145], v[152:153]
    v_pk_mul_f32 v[146:147], v[146:147], v[154:155]
    v_pk_mul_f32 v[148:149], v[148:149], v[156:157]
    v_pk_mul_f32 v[150:151], v[150:151], v[158:159]
    v_pk_fma_f32 v[64:65], v[176:177], v[144:145], v[64:65]
    v_pk_fma_f32 v[66:67], v[178:179], v[146:147], v[66:67]
    v_pk_fma_f32 v[68:69], v[180:181], v[148:149], v[68:69]
    v_pk_fma_f32 v[70:71], v[182:183], v[150:151], v[70:71]
    v_cvt_pk_bf16_f32 v20, v64, v65
    v_cvt_pk_bf16_f32 v21, v66, v67
    v_cvt_pk_bf16_f32 v22, v68, v69
    v_cvt_pk_bf16_f32 v23, v70, v71
    v_dot2_f32_bf16 v124, v20, v126, v124
    v_dot2_f32_bf16 v125, v20, v20, v125
    v_dot2_f32_bf16 v124, v21, v126, v124
    v_dot2_f32_bf16 v125, v21, v21, v125
    v_dot2_f32_bf16 v124, v22, v126, v124
    v_dot2_f32_bf16 v125, v22, v22, v125
    v_dot2_f32_bf16 v124, v23, v126, v124
    v_dot2_f32_bf16 v125, v23, v23, v125
    ds_read_b128 v[160:163], v10 offset:4096
    ds_read_b128 v[164:167], v10 offset:4112
    ds_read_b128 v[168:171], v10 offset:1536
    ds_read_b128 v[172:175], v10 offset:1552
    ds_read_b128 v[176:179], v10 offset:6656
    ds_read_b128 v[180:183], v10 offset:6672
    s_waitcnt lgkmcnt(6)
    v_lshlrev_b32 v152, 16, v44
    v_and_b32 v153, 0xffff0000, v44
    v_lshlrev_b32 v154, 16, v45
    v_and_b32 v155, 0xffff0000, v45
    v_lshlrev_b32 v156, 16, v46
    v_and_b32 v157, 0xffff0000, v46
    v_lshlrev_b32 v158, 16, v47
    v_and_b32 v159, 0xffff0000, v47
    v_pk_fma_f32 v[144:145], v[72:73], v[120:121], v[120:121] op_sel:[0,1,0] op_sel_hi:[1,1,0]
    v_pk_fma_f32 v[146:147], v[74:75], v[120:121], v[120:121] op_sel:[0,1,0] op_sel_hi:[1,1,0]
    v_pk_fma_f32 v[148:149], v[76:77], v[120:121], v[120:121] op_sel:[0,1,0] op_sel_hi:[1,1,0]
    v_pk_fma_f32 v[150:151], v[78:79], v[120:121], v[120:121] op_sel:[0,1,0] op_sel_hi:[1,1,0]
    v_pk_fma_f32 v[144:145], v[144:145], v[96:97], v[104:105]
    v_pk_fma_f32 v[146:147], v[146:147], v[98:99], v[106:107]
    v_pk_fma_f32 v[148:149], v[148:149], v[100:101], v[108:109]
    v_pk_fma_f32 v[150:151], v[150:151], v[102:103], v[110:111]
    v_pk_mul_f32 v[144:145], v[144:145], v[152:153]
    v_pk_mul_f32 v[146:147], v[146:147], v[154:155]
    v_pk_mul_f32 v[148:149], v[148:149], v[156:157]
    v_pk_mul_f32 v[150:151], v[150:151], v[158:159]
    v_pk_fma_f32 v[72:73], v[112:113], v[144:145], v[72:73]
    v_pk_fma_f32 v[74:75], v[114:115], v[146:147], v[74:75]
    v_pk_fma_f32 v[76:77], v[116:117], v[148:149], v[76:77]
    v_pk_fma_f32 v[78:79], v[118:119], v[150:151], v[78:79]
    v_cvt_pk_bf16_f32 v24, v72, v73
    v_cvt_pk_bf16_f32 v25, v74, v75
    v_cvt_pk_bf16_f32 v26, v76, v77
    v_cvt_pk_bf16_f32 v27, v78, v79
    v_dot2_f32_bf16 v124, v24, v126, v124
    v_dot2_f32_bf16 v125, v24, v24, v125
    v_dot2_f32_bf16 v124, v25, v126, v124
    v_dot2_f32_bf16 v125, v25, v25, v125
    v_dot2_f32_bf16 v124, v26, v126, v124
    v_dot2_f32_bf16 v125, v26, v26, v125
    v_dot2_f32_bf16 v124, v27, v126, v124
    v_dot2_f32_bf16 v125, v27, v27, v125
    ds_read_b128 v[96:99], v10 offset:4608
    ds_read_b128 v[100:103], v10 offset:4624
    ds_read_b128 v[104:107], v10 offset:2048
    ds_read_b128 v[108:111], v10 offset:2064
    ds_read_b128 v[112:115], v10 offset:7168
    ds_read_b128 v[116:119], v10 offset:7184
    s_waitcnt lgkmcnt(6)
    v_lshlrev_b32 v152, 16, v48
    v_and_b32 v153, 0xffff0000, v48
    v_lshlrev_b32 v154, 16, v49
    v_and_b32 v155, 0xffff0000, v49
    v_lshlrev_b32 v156, 16, v50
    v_and_b32 v157, 0xffff0000, v50
    v_lshlrev_b32 v158, 16, v51
    v_and_b32 v159, 0xffff0000, v51
    v_pk_fma_f32 v[144:145], v[80:81], v[120:121], v[120:121] op_sel:[0,1,0] op_sel_hi:[1,1,0]
    v_pk_fma_f32 v[146:147], v[82:83], v[120:121], v[120:121] op_sel:[0,1,0] op_sel_hi:[1,1,0]
    v_pk_fma_f32 v[148:149], v[84:85], v[120:121], v[120:121] op_sel:[0,1,0] op_sel_hi:[1,1,0]
    v_pk_fma_f32 v[150:151], v[86:87], v[120:121], v[120:121] op_sel:[0,1,0] op_sel_hi:[1,1,0]
    v_pk_fma_f32 v[144:145], v[144:145], v[160:161], v[168:169]
    v_pk_fma_f32 v[146:147], v[146:147], v[162:163], v[170:171]
    v_pk_fma_f32 v[148:149], v[148:149], v[164:165], v[172:173]
    v_pk_fma_f32 v[150:151], v[150:151], v[166:167], v[174:175]
    v_pk_mul_f32 v[144:145], v[144:145], v[152:153]
    v_pk_mul_f32 v[146:147], v[146:147], v[154:155]
    v_pk_mul_f32 v[148:149], v[148:149], v[156:157]
    v_pk_mul_f32 v[150:151], v[150:151], v[158:159]
    v_pk_fma_f32 v[80:81], v[176:177], v[144:145], v[80:81]
    v_pk_fma_f32 v[82:83], v[178:179], v[146:147], v[82:83]
    v_pk_fma_f32 v[84:85], v[180:181], v[148:149], v[84:85]
    v_pk_fma_f32 v[86:87], v[182:183], v[150:151], v[86:87]
    v_cvt_pk_bf16_f32 v28, v80, v81
    v_cvt_pk_bf16_f32 v29, v82, v83
    v_cvt_pk_bf16_f32 v30, v84, v85
    v_cvt_pk_bf16_f32 v31, v86, v87
    v_dot2_f32_bf16 v124, v28, v126, v124
    v_dot2_f32_bf16 v125, v28, v28, v125
    v_dot2_f32_bf16 v124, v29, v126, v124
    v_dot2_f32_bf16 v125, v29, v29, v125
    v_dot2_f32_bf16 v124, v30, v126, v124
    v_dot2_f32_bf16 v125, v30, v30, v125
    v_dot2_f32_bf16 v124, v31, v126, v124
    v_dot2_f32_bf16 v125, v31, v31, v125
    s_waitcnt lgkmcnt(0)
    v_lshlrev_b32 v152, 16, v52
    v_and_b32 v153, 0xffff0000, v52
    v_lshlrev_b32 v154, 16, v53
    v_and_b32 v155, 0xffff0000, v53
    v_lshlrev_b32 v156, 16, v54
    v_and_b32 v157, 0xffff0000, v54
    v_lshlrev_b32 v158, 16, v55
    v_and_b32 v159, 0xffff0000, v55
    v_pk_fma_f32 v[144:145], v[88:89], v[120:121], v[120:121] op_sel:[0,1,0] op_sel_hi:[1,1,0]
    v_pk_fma_f32 v[146:147], v[90:91], v[120:121], v[120:121] op_sel:[0,1,0] op_sel_hi:[1,1,0]
    v_pk_fma_f32 v[148:149], v[92:93], v[120:121], v[120:121] op_sel:[0,1,0] op_sel_hi:[1,1,0]
    v_pk_fma_f32 v[150:151], v[94:95], v[120:121], v[120:121] op_sel:[0,1,0] op_sel_hi:[1,1,0]
    v_pk_fma_f32 v[144:145], v[144:145], v[96:97], v[104:105]
    v_pk_fma_f32 v[146:147], v[146:147], v[98:99], v[106:107]
    v_pk_fma_f32 v[148:149], v[148:149], v[100:101], v[108:109]
    v_pk_fma_f32 v[150:151], v[150:151], v[102:103], v[110:111]
    v_pk_mul_f32 v[144:145], v[144:145], v[152:153]
    v_pk_mul_f32 v[146:147], v[146:147], v[154:155]
    v_pk_mul_f32 v[148:149], v[148:149], v[156:157]
    v_pk_mul_f32 v[150:151], v[150:151], v[158:159]
    v_pk_fma_f32 v[88:89], v[112:113], v[144:145], v[88:89]
    v_pk_fma_f32 v[90:91], v[114:115], v[146:147], v[90:91]
    v_pk_fma_f32 v[92:93], v[116:117], v[148:149], v[92:93]
    v_pk_fma_f32 v[94:95], v[118:119], v[150:151], v[94:95]
    v_cvt_pk_bf16_f32 v32, v88, v89
    v_cvt_pk_bf16_f32 v33, v90, v91
    v_cvt_pk_bf16_f32 v34, v92, v93
    v_cvt_pk_bf16_f32 v35, v94, v95
    v_dot2_f32_bf16 v124, v32, v126, v124
    v_dot2_f32_bf16 v125, v32, v32, v125
    v_dot2_f32_bf16 v124, v33, v126, v124
    v_dot2_f32_bf16 v125, v33, v33, v125
    v_dot2_f32_bf16 v124, v34, v126, v124
    v_dot2_f32_bf16 v125, v34, v34, v125
    v_dot2_f32_bf16 v124, v35, v126, v124
    v_dot2_f32_bf16 v125, v35, v35, v125
    v_and_b32 v191, 31, v1
    v_lshlrev_b32 v191, 2, v191
    s_add_u32 s41, s37, 7424
    buffer_load_dword v190, v191, s[12:15], s41 offen sc1
    ds_read_b128 v[96:99], v10 offset:10240
    ds_read_b128 v[100:103], v10 offset:10256
    ds_read_b128 v[104:107], v10 offset:7680
    ds_read_b128 v[108:111], v10 offset:7696
    s_nop 1
    s_nop 0
    v_add_f32_dpp v124, v124, v124 quad_perm:[1,0,3,2] row_mask:0xf bank_mask:0xf
    v_add_f32_dpp v125, v125, v125 quad_perm:[1,0,3,2] row_mask:0xf bank_mask:0xf
    s_nop 0
    v_add_f32_dpp v124, v124, v124 quad_perm:[2,3,0,1] row_mask:0xf bank_mask:0xf
    v_add_f32_dpp v125, v125, v125 quad_perm:[2,3,0,1] row_mask:0xf bank_mask:0xf
    s_nop 0
    v_add_f32_dpp v124, v124, v124 row_half_mirror row_mask:0xf bank_mask:0xf
    v_add_f32_dpp v125, v125, v125 row_half_mirror row_mask:0xf bank_mask:0xf
    s_nop 0
    v_add_f32_dpp v124, v124, v124 row_mirror row_mask:0xf bank_mask:0xf
    v_add_f32_dpp v125, v125, v125 row_mirror row_mask:0xf bank_mask:0xf
    v_mul_f32 v124, 0x3acccccd, v124
    v_mul_f32 v125, 0x3acccccd, v125
    v_fma_f32 v125, -v124, v124, v125
    v_max_f32 v125, 0, v125
    v_cvt_pk_bf16_f32 v122, v124, v125
    v_lshlrev_b32 v124, 16, v122
    v_and_b32 v125, 0xffff0000, v122
    v_add_f32 v125, 0x3727c5ac, v125
    v_cvt_pk_bf16_f32 v122, v125, v125
    v_lshlrev_b32 v125, 16, v122
    v_sqrt_f32 v125, v125
    s_nop 0
    v_cvt_pk_bf16_f32 v122, v125, v125
    v_lshlrev_b32 v125, 16, v122
    v_rcp_f32 v125, v125
    s_nop 0
    v_mul_f32 v124, v124, v125
    v_sub_f32 v124, 0, v124
    v_mov_b32 v120, 0
    v_mov_b32 v121, 0
    ds_read_b128 v[160:163], v10 offset:10752
    ds_read_b128 v[164:167], v10 offset:10768
    ds_read_b128 v[168:171], v10 offset:8192
    ds_read_b128 v[172:175], v10 offset:8208
    s_waitcnt lgkmcnt(4)
    v_pk_fma_f32 v[56:57], v[56:57], v[124:125], v[124:125] op_sel:[0,1,0] op_sel_hi:[1,1,0]
    v_pk_fma_f32 v[58:59], v[58:59], v[124:125], v[124:125] op_sel:[0,1,0] op_sel_hi:[1,1,0]
    v_pk_fma_f32 v[60:61], v[60:61], v[124:125], v[124:125] op_sel:[0,1,0] op_sel_hi:[1,1,0]
    v_pk_fma_f32 v[62:63], v[62:63], v[124:125], v[124:125] op_sel:[0,1,0] op_sel_hi:[1,1,0]
    v_pk_fma_f32 v[56:57], v[56:57], v[96:97], v[104:105]
    v_pk_fma_f32 v[58:59], v[58:59], v[98:99], v[106:107]
    v_pk_fma_f32 v[60:61], v[60:61], v[100:101], v[108:109]
    v_pk_fma_f32 v[62:63], v[62:63], v[102:103], v[110:111]
    v_cvt_pk_bf16_f32 v36, v56, v57
    v_cvt_pk_bf16_f32 v37, v58, v59
    v_cvt_pk_bf16_f32 v38, v60, v61
    v_cvt_pk_bf16_f32 v39, v62, v63
    v_dot2_f32_bf16 v120, v36, v126, v120
    v_dot2_f32_bf16 v121, v36, v36, v121
    v_dot2_f32_bf16 v120, v37, v126, v120
    v_dot2_f32_bf16 v121, v37, v37, v121
    v_dot2_f32_bf16 v120, v38, v126, v120
    v_dot2_f32_bf16 v121, v38, v38, v121
    v_dot2_f32_bf16 v120, v39, v126, v120
    v_dot2_f32_bf16 v121, v39, v39, v121
    ds_read_b128 v[96:99], v10 offset:11264
    ds_read_b128 v[100:103], v10 offset:11280
    ds_read_b128 v[104:107], v10 offset:8704
    ds_read_b128 v[108:111], v10 offset:8720
    s_waitcnt lgkmcnt(4)
    v_pk_fma_f32 v[64:65], v[64:65], v[124:125], v[124:125] op_sel:[0,1,0] op_sel_hi:[1,1,0]
    v_pk_fma_f32 v[66:67], v[66:67], v[124:125], v[124:125] op_sel:[0,1,0] op_sel_hi:[1,1,0]
    v_pk_fma_f32 v[68:69], v[68:69], v[124:125], v[124:125] op_sel:[0,1,0] op_sel_hi:[1,1,0]
    v_pk_fma_f32 v[70:71], v[70:71], v[124:125], v[124:125] op_sel:[0,1,0] op_sel_hi:[1,1,0]
    v_pk_fma_f32 v[64:65], v[64:65], v[160:161], v[168:169]
    v_pk_fma_f32 v[66:67], v[66:67], v[162:163], v[170:171]
    v_pk_fma_f32 v[68:69], v[68:69], v[164:165], v[172:173]
    v_pk_fma_f32 v[70:71], v[70:71], v[166:167], v[174:175]
    v_cvt_pk_bf16_f32 v40, v64, v65
    v_cvt_pk_bf16_f32 v41, v66, v67
    v_cvt_pk_bf16_f32 v42, v68, v69
    v_cvt_pk_bf16_f32 v43, v70, v71
    v_dot2_f32_bf16 v120, v40, v126, v120
    v_dot2_f32_bf16 v121, v40, v40, v121
    v_dot2_f32_bf16 v120, v41, v126, v120
    v_dot2_f32_bf16 v121, v41, v41, v121
    v_dot2_f32_bf16 v120, v42, v126, v120
    v_dot2_f32_bf16 v121, v42, v42, v121
    v_dot2_f32_bf16 v120, v43, v126, v120
    v_dot2_f32_bf16 v121, v43, v43, v121
    ds_read_b128 v[160:163], v10 offset:11776
    ds_read_b128 v[164:167], v10 offset:11792
    ds_read_b128 v[168:171], v10 offset:9216
    ds_read_b128 v[172:175], v10 offset:9232
    s_waitcnt lgkmcnt(4)
    v_pk_fma_f32 v[72:73], v[72:73], v[124:125], v[124:125] op_sel:[0,1,0] op_sel_hi:[1,1,0]
    v_pk_fma_f32 v[74:75], v[74:75], v[124:125], v[124:125] op_sel:[0,1,0] op_sel_hi:[1,1,0]
    v_pk_fma_f32 v[76:77], v[76:77], v[124:125], v[124:125] op_sel:[0,1,0] op_sel_hi:[1,1,0]
    v_pk_fma_f32 v[78:79], v[78:79], v[124:125], v[124:125] op_sel:[0,1,0] op_sel_hi:[1,1,0]
    v_pk_fma_f32 v[72:73], v[72:73], v[96:97], v[104:105]
    v_pk_fma_f32 v[74:75], v[74:75], v[98:99], v[106:107]
    v_pk_fma_f32 v[76:77], v[76:77], v[100:101], v[108:109]
    v_pk_fma_f32 v[78:79], v[78:79], v[102:103], v[110:111]
    v_cvt_pk_bf16_f32 v44, v72, v73
    v_cvt_pk_bf16_f32 v45, v74, v75
    v_cvt_pk_bf16_f32 v46, v76, v77
    v_cvt_pk_bf16_f32 v47, v78, v79
    v_dot2_f32_bf16 v120, v44, v126, v120
    v_dot2_f32_bf16 v121, v44, v44, v121
    v_dot2_f32_bf16 v120, v45, v126, v120
    v_dot2_f32_bf16 v121, v45, v45, v121
    v_dot2_f32_bf16 v120, v46, v126, v120
    v_dot2_f32_bf16 v121, v46, v46, v121
    v_dot2_f32_bf16 v120, v47, v126, v120
    v_dot2_f32_bf16 v121, v47, v47, v121
    ds_read_b128 v[96:99], v10 offset:12288
    ds_read_b128 v[100:103], v10 offset:12304
    ds_read_b128 v[104:107], v10 offset:9728
    ds_read_b128 v[108:111], v10 offset:9744
    s_waitcnt lgkmcnt(4)
    v_pk_fma_f32 v[80:81], v[80:81], v[124:125], v[124:125] op_sel:[0,1,0] op_sel_hi:[1,1,0]
    v_pk_fma_f32 v[82:83], v[82:83], v[124:125], v[124:125] op_sel:[0,1,0] op_sel_hi:[1,1,0]
    v_pk_fma_f32 v[84:85], v[84:85], v[124:125], v[124:125] op_sel:[0,1,0] op_sel_hi:[1,1,0]
    v_pk_fma_f32 v[86:87], v[86:87], v[124:125], v[124:125] op_sel:[0,1,0] op_sel_hi:[1,1,0]
    v_pk_fma_f32 v[80:81], v[80:81], v[160:161], v[168:169]
    v_pk_fma_f32 v[82:83], v[82:83], v[162:163], v[170:171]
    v_pk_fma_f32 v[84:85], v[84:85], v[164:165], v[172:173]
    v_pk_fma_f32 v[86:87], v[86:87], v[166:167], v[174:175]
    v_cvt_pk_bf16_f32 v48, v80, v81
    v_cvt_pk_bf16_f32 v49, v82, v83
    v_cvt_pk_bf16_f32 v50, v84, v85
    v_cvt_pk_bf16_f32 v51, v86, v87
    v_dot2_f32_bf16 v120, v48, v126, v120
    v_dot2_f32_bf16 v121, v48, v48, v121
    v_dot2_f32_bf16 v120, v49, v126, v120
    v_dot2_f32_bf16 v121, v49, v49, v121
    v_dot2_f32_bf16 v120, v50, v126, v120
    v_dot2_f32_bf16 v121, v50, v50, v121
    v_dot2_f32_bf16 v120, v51, v126, v120
    v_dot2_f32_bf16 v121, v51, v51, v121
    s_waitcnt lgkmcnt(0)
    v_pk_fma_f32 v[88:89], v[88:89], v[124:125], v[124:125] op_sel:[0,1,0] op_sel_hi:[1,1,0]
    v_pk_fma_f32 v[90:91], v[90:91], v[124:125], v[124:125] op_sel:[0,1,0] op_sel_hi:[1,1,0]
    v_pk_fma_f32 v[92:93], v[92:93], v[124:125], v[124:125] op_sel:[0,1,0] op_sel_hi:[1,1,0]
    v_pk_fma_f32 v[94:95], v[94:95], v[124:125], v[124:125] op_sel:[0,1,0] op_sel_hi:[1,1,0]
    v_pk_fma_f32 v[88:89], v[88:89], v[96:97], v[104:105]
    v_pk_fma_f32 v[90:91], v[90:91], v[98:99], v[106:107]
    v_pk_fma_f32 v[92:93], v[92:93], v[100:101], v[108:109]
    v_pk_fma_f32 v[94:95], v[94:95], v[102:103], v[110:111]
    v_cvt_pk_bf16_f32 v52, v88, v89
    v_cvt_pk_bf16_f32 v53, v90, v91
    v_cvt_pk_bf16_f32 v54, v92, v93
    v_cvt_pk_bf16_f32 v55, v94, v95
    v_dot2_f32_bf16 v120, v52, v126, v120
    v_dot2_f32_bf16 v121, v52, v52, v121
    v_dot2_f32_bf16 v120, v53, v126, v120
    v_dot2_f32_bf16 v121, v53, v53, v121
    v_dot2_f32_bf16 v120, v54, v126, v120
    v_dot2_f32_bf16 v121, v54, v54, v121
    v_dot2_f32_bf16 v120, v55, v126, v120
    v_dot2_f32_bf16 v121, v55, v55, v121
    s_nop 1
    s_nop 0
    v_add_f32_dpp v120, v120, v120 quad_perm:[1,0,3,2] row_mask:0xf bank_mask:0xf
    v_add_f32_dpp v121, v121, v121 quad_perm:[1,0,3,2] row_mask:0xf bank_mask:0xf
    s_nop 0
    v_add_f32_dpp v120, v120, v120 quad_perm:[2,3,0,1] row_mask:0xf bank_mask:0xf
    v_add_f32_dpp v121, v121, v121 quad_perm:[2,3,0,1] row_mask:0xf bank_mask:0xf
    s_nop 0
    v_add_f32_dpp v120, v120, v120 row_half_mirror row_mask:0xf bank_mask:0xf
    v_add_f32_dpp v121, v121, v121 row_half_mirror row_mask:0xf bank_mask:0xf
    s_nop 0
    v_add_f32_dpp v120, v120, v120 row_mirror row_mask:0xf bank_mask:0xf
    v_add_f32_dpp v121, v121, v121 row_mirror row_mask:0xf bank_mask:0xf
    v_mul_f32 v120, 0x3acccccd, v120
    v_mul_f32 v121, 0x3acccccd, v121
    v_fma_f32 v121, -v120, v120, v121
    v_max_f32 v121, 0, v121
    v_cvt_pk_bf16_f32 v122, v120, v121
    v_lshlrev_b32 v120, 16, v122
    v_and_b32 v121, 0xffff0000, v122
    v_add_f32 v121, 0x3727c5ac, v121
    v_cvt_pk_bf16_f32 v122, v121, v121
    v_lshlrev_b32 v121, 16, v122
    v_sqrt_f32 v121, v121
    s_nop 0
    v_cvt_pk_bf16_f32 v122, v121, v121
    v_lshlrev_b32 v121, 16, v122
    v_rcp_f32 v121, v121
    s_nop 0
    v_mul_f32 v120, v120, v121
    v_sub_f32 v120, 0, v120
    v_cndmask_b32 v120, 0, v120, s[50:51]
    v_cndmask_b32 v121, 0, v121, s[50:51]
    s_mul_i32 s46, s29, 20480
    s_add_u32 s46, s46, s36
    s_add_u32 s47, s46, 348160
    s_lshl_b32 s48, s29, 7
    s_add_u32 s48, s48, s36
    s_add_u32 s48, s48, 1597440
    v_lshlrev_b32 v12, 3, v15
    s_lshl_b32 s49, s29, 7
    s_add_u32 s49, s49, s37
    s_lshl_b32 s41, s30, 2
    s_add_u32 s49, s49, s41
    s_waitcnt vmcnt(0)
    s_mov_b32 s43, 200000
k2_kernel_xp7:
    v_cmp_ne_u32 vcc, 0, v190
    s_sub_u32 s43, s43, 1
    s_cmp_eq_u64 vcc, -1
    s_cbranch_scc1 k2_kernel_xd8
    s_cmp_eq_u32 s43, 0
    s_cbranch_scc1 k2_kernel_xd8
    s_add_u32 s41, s37, 7424
    buffer_load_dword v190, v191, s[12:15], s41 offen sc1
    s_waitcnt vmcnt(0)
    s_branch k2_kernel_xp7
k2_kernel_xd8:
    v_cmp_eq_u32 vcc, s42, v190
    s_nop 1
    s_cmp_eq_u64 vcc, -1
    s_cselect_b32 s31, 1, 0
    s_barrier
    v_and_b32 v9, 7, v4
    v_xor_b32 v9, v15, v9
    v_and_b32 v10, 3, v4
    v_lshl_add_u32 v9, v10, 4, v9
    v_lshrrev_b32 v10, 2, v4
    v_lshl_add_u32 v9, v10, 6, v9
    v_lshlrev_b32 v9, 4, v9
    v_add_u32 v9, 114688, v9
    ds_write_b128 v9, v[36:39] offset:0
    ds_write_b128 v9, v[16:19] offset:20480
    ds_write_b128 v9, v[40:43] offset:4096
    ds_write_b128 v9, v[20:23] offset:24576
    ds_write_b128 v9, v[44:47] offset:8192
    ds_write_b128 v9, v[24:27] offset:28672
    ds_write_b128 v9, v[48:51] offset:12288
    ds_write_b128 v9, v[28:31] offset:32768
    ds_write_b128 v9, v[52:55] offset:16384
    ds_write_b128 v9, v[32:35] offset:36864
    v_xor_b32 v9, v4, v3
    v_xor_b32 v10, 4, v9
    v_lshl_add_u32 v9, v3, 4, v9
    v_lshl_add_u32 v10, v3, 4, v10
    s_mul_i32 s41, s30, 5120
    s_add_u32 s41, s41, 114688
    v_lshl_add_u32 v9, v9, 4, s41
    v_lshl_add_u32 v10, v10, 4, s41
    s_cmp_eq_u32 s30, 1
    s_cselect_b32 s41, 1, 0
    s_cmp_eq_u32 s30, 3
    s_cselect_b32 s41, 1, s41
    s_cmp_eq_u32 s41, 1
    v_mov_b32 v11, v9
    s_cbranch_scc0 k2_noswap
    v_mov_b32 v9, v10
    v_mov_b32 v10, v11
k2_noswap:
    s_mul_i32 s41, s30, 5120
    s_add_u32 s46, s46, s41
    s_add_u32 s47, s47, s41
    s_waitcnt lgkmcnt(0)
    s_barrier
    ds_read_b128 v[36:39], v9 offset:0
    ds_read_b128 v[40:43], v10 offset:1024
    ds_read_b128 v[44:47], v9 offset:2048
    ds_read_b128 v[48:51], v10 offset:3072
    ds_read_b128 v[52:55], v9 offset:4096
    ds_read_b128 v[220:223], v9 offset:20480
    ds_read_b128 v[224:227], v10 offset:21504
    ds_read_b128 v[228:231], v9 offset:22528
    ds_read_b128 v[232:235], v10 offset:23552
    ds_read_b128 v[236:239], v9 offset:24576
    s_add_u32 s52, s46, 4096
    s_sub_u32 s41, s29, 1
    s_cmp_lt_u32 s41, 16
    s_cselect_b32 s20, s47, 0x90000000
    s_cmp_eq_u32 s31, 0
    s_cbranch_scc1 k2_kernel_slow9
    s_waitcnt lgkmcnt(9)
    buffer_store_dwordx4 v[36:39], v2, s[12:15], s46 offen offset:0
    s_waitcnt lgkmcnt(8)
    buffer_store_dwordx4 v[40:43], v2, s[12:15], s46 offen offset:1024
    s_waitcnt lgkmcnt(7)
    buffer_store_dwordx4 v[44:47], v2, s[12:15], s46 offen offset:2048
    s_waitcnt lgkmcnt(6)
    buffer_store_dwordx4 v[48:51], v2, s[12:15], s46 offen offset:3072
    s_waitcnt lgkmcnt(5)
    buffer_store_dwordx4 v[52:55], v2, s[12:15], s52 offen offset:0
    v_cmp_eq_u32 vcc, 0, v4
    s_and_saveexec_b64 s[50:51], vcc
    buffer_store_dwordx2 v[120:121], v12, s[12:15], s48 offen
    s_mov_b64 exec, -1
    s_waitcnt vmcnt(0)
    v_mov_b32 v9, 1
    v_mov_b32 v10, 0
    s_mov_b64 exec, 1
    buffer_store_dword v9, v10, s[12:15], s49 offen
    s_mov_b64 exec, -1
    s_branch k2_kernel_sent10
k2_kernel_slow9:
    s_waitcnt lgkmcnt(9)
    buffer_store_dwordx4 v[36:39], v2, s[12:15], s46 offen offset:0 sc1
    s_waitcnt lgkmcnt(8)
    buffer_store_dwordx4 v[40:43], v2, s[12:15], s46 offen offset:1024 sc1
    s_waitcnt lgkmcnt(7)
    buffer_store_dwordx4 v[44:47], v2, s[12:15], s46 offen offset:2048 sc1
    s_waitcnt lgkmcnt(6)
    buffer_store_dwordx4 v[48:51], v2, s[12:15], s46 offen offset:3072 sc1
    s_waitcnt lgkmcnt(5)
    buffer_store_dwordx4 v[52:55], v2, s[12:15], s52 offen offset:0 sc1
    v_cmp_eq_u32 vcc, 0, v4
    s_and_saveexec_b64 s[50:51], vcc
    buffer_store_dwordx2 v[120:121], v12, s[12:15], s48 offen sc1
    s_mov_b64 exec, -1
    s_waitcnt vmcnt(0)
    v_mov_b32 v9, 1
    v_mov_b32 v10, 0
    s_mov_b64 exec, 1
    buffer_store_dword v9, v10, s[12:15], s49 offen sc1
    s_mov_b64 exec, -1
k2_kernel_sent10:
    s_mov_b32 s21, s49
    s_mov_b32 m0, s38
    s_nop 0
    buffer_load_dwordx4 v2, s[12:15], s39 offen offset:0 lds
    s_mov_b32 m0, s38
    s_nop 0
    buffer_load_dwordx4 v2, s[12:15], s39 offen offset:1024 lds
    s_mov_b32 m0, s38
    s_nop 0
    buffer_load_dwordx4 v2, s[12:15], s39 offen offset:2048 lds
    s_mov_b32 m0, s38
    s_nop 0
    buffer_load_dwordx4 v2, s[12:15], s39 offen offset:3072 lds
    s_add_u32 s38, s38, 4096
    s_add_u32 s39, s39, 4096
    s_mov_b32 m0, s38
    s_nop 0
    buffer_load_dwordx4 v2, s[12:15], s39 offen offset:0 lds
    s_mov_b32 m0, s38
    s_nop 0
    buffer_load_dwordx4 v2, s[12:15], s39 offen offset:1024 lds
    s_mov_b32 m0, s38
    s_nop 0
    buffer_load_dwordx4 v2, s[12:15], s39 offen offset:2048 lds
    s_mov_b32 m0, s38
    s_nop 0
    buffer_load_dwordx4 v2, s[12:15], s39 offen offset:3072 lds
    s_add_u32 s38, s38, 4096
    s_add_u32 s39, s39, 4096
    s_mov_b32 m0, s38
    s_nop 0
    buffer_load_dwordx4 v2, s[12:15], s39 offen offset:0 lds
    s_mov_b32 m0, s38
    s_nop 0
    buffer_load_dwordx4 v2, s[12:15], s39 offen offset:1024 lds
    s_mov_b32 m0, s38
    s_nop 0
    buffer_load_dwordx4 v2, s[12:15], s39 offen offset:2048 lds
    s_mov_b32 m0, s38
    s_nop 0
    buffer_load_dwordx4 v2, s[12:15], s39 offen offset:3072 lds
    s_add_u32 s38, s38, 4096
    s_add_u32 s39, s39, 4096
    s_mov_b32 m0, s38
    s_nop 0
    buffer_load_dwordx4 v2, s[12:15], s39 offen offset:0 lds
    s_mov_b32 m0, s38
    s_nop 0
    buffer_load_dwordx4 v2, s[12:15], s39 offen offset:1024 lds
    s_mov_b32 m0, s38
    s_nop 0
    buffer_load_dwordx4 v2, s[12:15], s39 offen offset:2048 lds
    s_mov_b32 m0, s38
    s_nop 0
    buffer_load_dwordx4 v2, s[12:15], s39 offen offset:3072 lds
    s_add_u32 s38, s38, 4096
    s_add_u32 s39, s39, 4096
    s_mov_b32 m0, s38
    s_nop 0
    buffer_load_dwordx4 v2, s[12:15], s39 offen offset:0 lds
    s_branch k2_kernel_join03
k2_kernel_nob02:
    s_mov_b32 s21, 0
    s_mov_b32 s20, 0x90000000
    s_mul_i32 s38, s30, 25600
    s_add_u32 s39, s38, s44
    s_add_u32 s39, s39, 2764800
    v_and_b32 v191, 31, v1
    v_lshlrev_b32 v191, 2, v191
    s_add_u32 s41, s37, 7424
    buffer_load_dword v190, v191, s[12:15], s41 offen sc1
    s_waitcnt vmcnt(0)
    s_mov_b32 s43, 200000
k2_kernel_xp11:
    v_cmp_ne_u32 vcc, 0, v190
    s_sub_u32 s43, s43, 1
    s_cmp_eq_u64 vcc, -1
    s_cbranch_scc1 k2_kernel_xd12
    s_cmp_eq_u32 s43, 0
    s_cbranch_scc1 k2_kernel_xd12
    s_add_u32 s41, s37, 7424
    buffer_load_dword v190, v191, s[12:15], s41 offen sc1
    s_waitcnt vmcnt(0)
    s_branch k2_kernel_xp11
k2_kernel_xd12:
    v_cmp_eq_u32 vcc, s42, v190
    s_nop 1
    s_cmp_eq_u64 vcc, -1
    s_cselect_b32 s31, 1, 0
    s_cmp_eq_u32 s30, 1
    s_cbranch_scc1 k2_kernel_sm13
    s_cmp_ge_u32 s30, 2
    s_cbranch_scc1 k2_kernel_sm14
    s_mul_i32 s41, s33, 320
    s_add_u32 s41, s41, 2748416
    s_mov_b32 m0, 155648
    s_mov_b64 exec, 0xfffff
    buffer_load_dwordx4 v2, s[12:15], s41 offen lds
    s_add_u32 s41, s41, 7168
    s_mov_b32 m0, 156160
    s_nop 0
    buffer_load_dwordx4 v2, s[12:15], s41 offen lds
    s_branch k2_kernel_sm15
k2_kernel_sm13:
    s_mul_i32 s41, s35, 448
    s_add_u32 s41, s41, 2732032
    s_mov_b32 m0, 156672
    s_mov_b64 exec, 0xfffffff
    buffer_load_dwordx4 v2, s[12:15], s41 offen lds
    s_add_u32 s41, s41, 7168
    s_mov_b32 m0, 157184
    s_nop 0
    buffer_load_dwordx4 v2, s[12:15], s41 offen lds
    s_branch k2_kernel_sm15
k2_kernel_sm14:
    s_mul_i32 s41, s33, 320
    s_add_u32 s41, s41, 2724352
    s_mov_b32 m0, 157696
    s_mov_b64 exec, 0xfffff
    buffer_load_dwordx4 v2, s[12:15], s41 offen lds
k2_kernel_sm15:
    s_mov_b64 exec, -1
    s_mov_b32 m0, s38
    s_nop 0
    buffer_load_dwordx4 v2, s[12:15], s39 offen offset:0 lds
    s_mov_b32 m0, s38
    s_nop 0
    buffer_load_dwordx4 v2, s[12:15], s39 offen offset:1024 lds
    s_mov_b32 m0, s38
    s_nop 0
    buffer_load_dwordx4 v2, s[12:15], s39 offen offset:2048 lds
    s_mov_b32 m0, s38
    s_nop 0
    buffer_load_dwordx4 v2, s[12:15], s39 offen offset:3072 lds
    s_add_u32 s38, s38, 4096
    s_add_u32 s39, s39, 4096
    s_mov_b32 m0, s38
    s_nop 0
    buffer_load_dwordx4 v2, s[12:15], s39 offen offset:0 lds
    s_mov_b32 m0, s38
    s_nop 0
    buffer_load_dwordx4 v2, s[12:15], s39 offen offset:1024 lds
    s_mov_b32 m0, s38
    s_nop 0
    buffer_load_dwordx4 v2, s[12:15], s39 offen offset:2048 lds
    s_mov_b32 m0, s38
    s_nop 0
    buffer_load_dwordx4 v2, s[12:15], s39 offen offset:3072 lds
    s_add_u32 s38, s38, 4096
    s_add_u32 s39, s39, 4096
    s_mov_b32 m0, s38
    s_nop 0
    buffer_load_dwordx4 v2, s[12:15], s39 offen offset:0 lds
    s_mov_b32 m0, s38
    s_nop 0
    buffer_load_dwordx4 v2, s[12:15], s39 offen offset:1024 lds
    s_mov_b32 m0, s38
    s_nop 0
    buffer_load_dwordx4 v2, s[12:15], s39 offen offset:2048 lds
    s_mov_b32 m0, s38
    s_nop 0
    buffer_load_dwordx4 v2, s[12:15], s39 offen offset:3072 lds
    s_add_u32 s38, s38, 4096
    s_add_u32 s39, s39, 4096
    s_mov_b32 m0, s38
    s_nop 0
    buffer_load_dwordx4 v2, s[12:15], s39 offen offset:0 lds
    s_mov_b32 m0, s38
    s_nop 0
    buffer_load_dwordx4 v2, s[12:15], s39 offen offset:1024 lds
    s_mov_b32 m0, s38
    s_nop 0
    buffer_load_dwordx4 v2, s[12:15], s39 offen offset:2048 lds
    s_mov_b32 m0, s38
    s_nop 0
    buffer_load_dwordx4 v2, s[12:15], s39 offen offset:3072 lds
    s_add_u32 s38, s38, 4096
    s_add_u32 s39, s39, 4096
    s_mov_b32 m0, s38
    s_nop 0
    buffer_load_dwordx4 v2, s[12:15], s39 offen offset:0 lds
    s_mov_b32 m0, s38
    s_nop 0
    buffer_load_dwordx4 v2, s[12:15], s39 offen offset:1024 lds
    s_mov_b32 m0, s38
    s_nop 0
    buffer_load_dwordx4 v2, s[12:15], s39 offen offset:2048 lds
    s_mov_b32 m0, s38
    s_nop 0
    buffer_load_dwordx4 v2, s[12:15], s39 offen offset:3072 lds
    s_add_u32 s38, s38, 4096
    s_add_u32 s39, s39, 4096
    s_mov_b32 m0, s38
    s_nop 0
    buffer_load_dwordx4 v2, s[12:15], s39 offen offset:0 lds
    s_mov_b32 m0, s38
    s_nop 0
    buffer_load_dwordx4 v2, s[12:15], s39 offen offset:1024 lds
    s_mov_b32 m0, s38
    s_nop 0
    buffer_load_dwordx4 v2, s[12:15], s39 offen offset:2048 lds
    s_mov_b32 m0, s38
    s_nop 0
    buffer_load_dwordx4 v2, s[12:15], s39 offen offset:3072 lds
    s_add_u32 s38, s38, 4096
    s_add_u32 s39, s39, 4096
    s_mov_b32 m0, s38
    s_nop 0
    buffer_load_dwordx4 v2, s[12:15], s39 offen offset:0 lds
    s_cmp_eq_u32 s31, 0
    s_cbranch_scc1 k2_kernel_nt16
    s_sub_u32 s47, s29, 18
    s_lshl_b32 s47, s47, 2
    s_add_u32 s47, s47, s30
    s_mul_i32 s48, s47, 6144
    s_min_u32 s48, s48, 321536
    s_mul_i32 s49, s28, 327680
    s_add_u32 s48, s48, s49
    s_add_u32 s48, s48, 0
    buffer_load_dwordx4 v[64:67], v2, s[12:15], s48 offen offset:0
    buffer_load_dwordx4 v[68:71], v2, s[12:15], s48 offen offset:1024
    buffer_load_dwordx4 v[72:75], v2, s[12:15], s48 offen offset:2048
    buffer_load_dwordx4 v[76:79], v2, s[12:15], s48 offen offset:3072
    s_add_u32 s48, s48, 4096
    buffer_load_dwordx4 v[80:83], v2, s[12:15], s48 offen offset:0
    buffer_load_dwordx4 v[84:87], v2, s[12:15], s48 offen offset:1024
    s_mul_i32 s48, s47, 384
    s_min_u32 s48, s48, 20096
    s_add_u32 s48, s48, s36
    s_add_u32 s48, s48, 1581056
    s_mov_b64 exec, 7
    buffer_load_dword v100, v5, s[12:15], s48 offen
    s_mov_b64 exec, -1
k2_kernel_nt16:
k2_kernel_join03:
    s_lshl_b32 s46, s32, 2
    s_add_u32 s46, s46, s30
    s_lshr_b32 s47, s33, 1
    s_and_b32 s48, s47, 1
    s_lshr_b32 s47, s47, 1
    s_add_u32 s47, s47, 1
    s_sub_u32 s49, 0, s47
    s_cmp_eq_u32 s48, 1
    s_cselect_b32 s47, s47, s49
    s_lshl_b32 s49, s46, 4
    s_add_u32 s49, s49, 16
    s_add_u32 s49, s49, s47
    v_add_u32 v9, s49, v4
    v_lshrrev_b32 v10, 4, v9
    v_mul_u32_u24 v6, 20480, v10
    v_and_b32 v10, 15, v9
    v_lshl_add_u32 v10, v3, 4, v10
    v_lshl_add_u32 v6, v10, 4, v6
    v_lshlrev_b32 v13, 3, v9
    s_add_u32 s49, s46, s48
    s_lshl_b32 s49, s49, 7
    s_add_u32 s49, s49, s37
    v_bfe_u32 v7, v1, 2, 1
    v_lshlrev_b32 v7, 7, v7
    v_and_b32 v9, 3, v1
    v_lshl_add_u32 v7, v9, 2, v7
    s_mov_b32 s43, 200000
k2_kernel_poll17:
    buffer_load_dword v9, v7, s[12:15], s49 offen sc1
    s_waitcnt vmcnt(0)
    v_cmp_ne_u32 vcc, 0, v9
    s_sub_u32 s43, s43, 1
    s_cmp_eq_u64 vcc, -1
    s_cbranch_scc1 k2_kernel_go18
    s_cmp_lg_u32 s43, 0
    s_cbranch_scc1 k2_kernel_poll17
k2_kernel_go18:
    s_add_u32 s41, s36, 0
    buffer_load_dwordx4 v[16:19], v6, s[12:15], s41 offen offset:0 sc1
    s_add_u32 s41, s36, 0
    buffer_load_dwordx4 v[20:23], v6, s[12:15], s41 offen offset:1024 sc1
    s_add_u32 s41, s36, 0
    buffer_load_dwordx4 v[24:27], v6, s[12:15], s41 offen offset:2048 sc1
    s_add_u32 s41, s36, 0
    buffer_load_dwordx4 v[28:31], v6, s[12:15], s41 offen offset:3072 sc1
    s_add_u32 s41, s36, 1597440
    buffer_load_dwordx2 v[176:177], v13, s[12:15], s41 offen sc1
    v_mov_b32 v14, v2
    v_add_u32 v15, 0x10000, v2
    v_add_u32 v11, 0x20000, v2
    s_barrier
    s_mul_i32 s38, s30, 13312
    s_add_u32 s39, s38, s44
    s_add_u32 s39, s39, 3584000
    s_add_u32 s38, s38, 102400
    ds_read_b128 v[96:99], v14 offset:0
    ds_read_b128 v[100:103], v14 offset:1024
    ds_read_b128 v[104:107], v14 offset:2048
    ds_read_b128 v[108:111], v14 offset:3072
    ds_read_b128 v[112:115], v14 offset:4096
    ds_read_b128 v[116:119], v14 offset:5120
    ds_read_b128 v[120:123], v14 offset:6144
    ds_read_b128 v[124:127], v14 offset:7168
    ds_read_b128 v[128:131], v14 offset:8192
    ds_read_b128 v[132:135], v14 offset:9216
    s_waitcnt vmcnt(4)
    s_waitcnt lgkmcnt(5)
    v_mfma_f32_16x16x32_bf16 v[156:159], v[96:99], v[16:19], 0
    s_add_u32 s41, s36, 4096
    buffer_load_dwordx4 v[32:35], v6, s[12:15], s41 offen offset:0 sc1
    v_mfma_f32_16x16x32_bf16 v[160:163], v[100:103], v[16:19], 0
    ds_read_b128 v[136:139], v14 offset:10240
    v_mfma_f32_16x16x32_bf16 v[164:167], v[104:107], v[16:19], 0
    ds_read_b128 v[140:143], v14 offset:11264
    v_mfma_f32_16x16x32_bf16 v[168:171], v[108:111], v[16:19], 0
    ds_read_b128 v[144:147], v14 offset:12288
    s_add_u32 s41, s36, 4096
    buffer_load_dwordx4 v[36:39], v6, s[12:15], s41 offen offset:1024 sc1
    v_mfma_f32_16x16x32_bf16 v[172:175], v[112:115], v[16:19], 0
    ds_read_b128 v[148:151], v14 offset:13312
    ds_read_b128 v[152:155], v14 offset:14336
    s_waitcnt vmcnt(5)
    s_waitcnt lgkmcnt(5)
    v_mfma_f32_16x16x32_bf16 v[156:159], v[116:119], v[20:23], v[156:159]
    s_add_u32 s41, s36, 4096
    buffer_load_dwordx4 v[40:43], v6, s[12:15], s41 offen offset:2048 sc1
    v_mfma_f32_16x16x32_bf16 v[160:163], v[120:123], v[20:23], v[160:163]
    ds_read_b128 v[96:99], v14 offset:15360
    v_mfma_f32_16x16x32_bf16 v[164:167], v[124:127], v[20:23], v[164:167]
    ds_read_b128 v[100:103], v14 offset:16384
    v_mfma_f32_16x16x32_bf16 v[168:171], v[128:131], v[20:23], v[168:171]
    ds_read_b128 v[104:107], v14 offset:17408
    s_add_u32 s41, s36, 4096
    buffer_load_dwordx4 v[44:47], v6, s[12:15], s41 offen offset:3072 sc1
    v_mfma_f32_16x16x32_bf16 v[172:175], v[132:135], v[20:23], v[172:175]
    ds_read_b128 v[108:111], v14 offset:18432
    ds_read_b128 v[112:115], v14 offset:19456
    s_waitcnt vmcnt(6)
    s_waitcnt lgkmcnt(5)
    v_mfma_f32_16x16x32_bf16 v[156:159], v[136:139], v[24:27], v[156:159]
    s_add_u32 s41, s36, 8192
    buffer_load_dwordx4 v[48:51], v6, s[12:15], s41 offen offset:0 sc1
    v_mfma_f32_16x16x32_bf16 v[160:163], v[140:143], v[24:27], v[160:163]
    ds_read_b128 v[116:119], v14 offset:20480
    v_mfma_f32_16x16x32_bf16 v[164:167], v[144:147], v[24:27], v[164:167]
    ds_read_b128 v[120:123], v14 offset:21504
    v_mfma_f32_16x16x32_bf16 v[168:171], v[148:151], v[24:27], v[168:171]
    ds_read_b128 v[124:127], v14 offset:22528
    s_add_u32 s41, s36, 8192
    buffer_load_dwordx4 v[52:55], v6, s[12:15], s41 offen offset:1024 sc1
    v_mfma_f32_16x16x32_bf16 v[172:175], v[152:155], v[24:27], v[172:175]
    ds_read_b128 v[128:131], v14 offset:23552
    ds_read_b128 v[132:135], v14 offset:24576
    s_waitcnt vmcnt(7)
    s_waitcnt lgkmcnt(5)
    v_mfma_f32_16x16x32_bf16 v[156:159], v[96:99], v[28:31], v[156:159]
    s_add_u32 s41, s36, 8192
    buffer_load_dwordx4 v[56:59], v6, s[12:15], s41 offen offset:2048 sc1
    v_mfma_f32_16x16x32_bf16 v[160:163], v[100:103], v[28:31], v[160:163]
    ds_read_b128 v[136:139], v14 offset:25600
    v_mfma_f32_16x16x32_bf16 v[164:167], v[104:107], v[28:31], v[164:167]
    ds_read_b128 v[140:143], v14 offset:26624
    v_mfma_f32_16x16x32_bf16 v[168:171], v[108:111], v[28:31], v[168:171]
    ds_read_b128 v[144:147], v14 offset:27648
    s_add_u32 s41, s36, 8192
    buffer_load_dwordx4 v[60:63], v6, s[12:15], s41 offen offset:3072 sc1
    v_mfma_f32_16x16x32_bf16 v[172:175], v[112:115], v[28:31], v[172:175]
    ds_read_b128 v[148:151], v14 offset:28672
    ds_read_b128 v[152:155], v14 offset:29696
    s_waitcnt vmcnt(7)
    s_waitcnt lgkmcnt(5)
    v_mfma_f32_16x16x32_bf16 v[156:159], v[116:119], v[32:35], v[156:159]
    s_add_u32 s41, s36, 12288
    buffer_load_dwordx4 v[64:67], v6, s[12:15], s41 offen offset:0 sc1
    v_mfma_f32_16x16x32_bf16 v[160:163], v[120:123], v[32:35], v[160:163]
    ds_read_b128 v[96:99], v14 offset:30720
    v_mfma_f32_16x16x32_bf16 v[164:167], v[124:127], v[32:35], v[164:167]
    ds_read_b128 v[100:103], v14 offset:31744
    v_mfma_f32_16x16x32_bf16 v[168:171], v[128:131], v[32:35], v[168:171]
    ds_read_b128 v[104:107], v14 offset:32768
    s_add_u32 s41, s36, 12288
    buffer_load_dwordx4 v[68:71], v6, s[12:15], s41 offen offset:1024 sc1
    v_mfma_f32_16x16x32_bf16 v[172:175], v[132:135], v[32:35], v[172:175]
    ds_read_b128 v[108:111], v14 offset:33792
    ds_read_b128 v[112:115], v14 offset:34816
    s_waitcnt vmcnt(8)
    s_waitcnt lgkmcnt(5)
    v_mfma_f32_16x16x32_bf16 v[156:159], v[136:139], v[36:39], v[156:159]
    s_add_u32 s41, s36, 12288
    buffer_load_dwordx4 v[72:75], v6, s[12:15], s41 offen offset:2048 sc1
    v_mfma_f32_16x16x32_bf16 v[160:163], v[140:143], v[36:39], v[160:163]
    ds_read_b128 v[116:119], v14 offset:35840
    v_mfma_f32_16x16x32_bf16 v[164:167], v[144:147], v[36:39], v[164:167]
    ds_read_b128 v[120:123], v14 offset:36864
    v_mfma_f32_16x16x32_bf16 v[168:171], v[148:151], v[36:39], v[168:171]
    ds_read_b128 v[124:127], v14 offset:37888
    s_add_u32 s41, s36, 12288
    buffer_load_dwordx4 v[76:79], v6, s[12:15], s41 offen offset:3072 sc1
    v_mfma_f32_16x16x32_bf16 v[172:175], v[152:155], v[36:39], v[172:175]
    ds_read_b128 v[128:131], v14 offset:38912
    ds_read_b128 v[132:135], v14 offset:39936
    s_waitcnt vmcnt(9)
    s_waitcnt lgkmcnt(5)
    v_mfma_f32_16x16x32_bf16 v[156:159], v[96:99], v[40:43], v[156:159]
    s_add_u32 s41, s36, 16384
    buffer_load_dwordx4 v[80:83], v6, s[12:15], s41 offen offset:0 sc1
    v_mfma_f32_16x16x32_bf16 v[160:163], v[100:103], v[40:43], v[160:163]
    ds_read_b128 v[136:139], v14 offset:40960
    v_mfma_f32_16x16x32_bf16 v[164:167], v[104:107], v[40:43], v[164:167]
    ds_read_b128 v[140:143], v14 offset:41984
    v_mfma_f32_16x16x32_bf16 v[168:171], v[108:111], v[40:43], v[168:171]
    ds_read_b128 v[144:147], v14 offset:43008
    s_add_u32 s41, s36, 16384
    buffer_load_dwordx4 v[84:87], v6, s[12:15], s41 offen offset:1024 sc1
    v_mfma_f32_16x16x32_bf16 v[172:175], v[112:115], v[40:43], v[172:175]
    ds_read_b128 v[148:151], v14 offset:44032
    ds_read_b128 v[152:155], v14 offset:45056
    s_waitcnt vmcnt(10)
    s_waitcnt lgkmcnt(5)
    v_mfma_f32_16x16x32_bf16 v[156:159], v[116:119], v[44:47], v[156:159]
    s_add_u32 s41, s36, 16384
    buffer_load_dwordx4 v[88:91], v6, s[12:15], s41 offen offset:2048 sc1
    v_mfma_f32_16x16x32_bf16 v[160:163], v[120:123], v[44:47], v[160:163]
    ds_read_b128 v[96:99], v14 offset:46080
    v_mfma_f32_16x16x32_bf16 v[164:167], v[124:127], v[44:47], v[164:167]
    ds_read_b128 v[100:103], v14 offset:47104
    v_mfma_f32_16x16x32_bf16 v[168:171], v[128:131], v[44:47], v[168:171]
    ds_read_b128 v[104:107], v14 offset:48128
    s_add_u32 s41, s36, 16384
    buffer_load_dwordx4 v[92:95], v6, s[12:15], s41 offen offset:3072 sc1
    v_mfma_f32_16x16x32_bf16 v[172:175], v[132:135], v[44:47], v[172:175]
    ds_read_b128 v[108:111], v14 offset:49152
    ds_read_b128 v[112:115], v14 offset:50176
    s_waitcnt vmcnt(11)
    s_waitcnt lgkmcnt(5)
    v_mfma_f32_16x16x32_bf16 v[156:159], v[136:139], v[48:51], v[156:159]
    v_mfma_f32_16x16x32_bf16 v[160:163], v[140:143], v[48:51], v[160:163]
    ds_read_b128 v[116:119], v14 offset:51200
    s_mov_b32 m0, s38
    s_nop 0
    buffer_load_dwordx4 v2, s[12:15], s39 offen offset:0 lds
    v_mfma_f32_16x16x32_bf16 v[164:167], v[144:147], v[48:51], v[164:167]
    ds_read_b128 v[120:123], v14 offset:52224
    v_mfma_f32_16x16x32_bf16 v[168:171], v[148:151], v[48:51], v[168:171]
    ds_read_b128 v[124:127], v14 offset:53248
    v_mfma_f32_16x16x32_bf16 v[172:175], v[152:155], v[48:51], v[172:175]
    ds_read_b128 v[128:131], v14 offset:54272
    ds_read_b128 v[132:135], v14 offset:55296
    s_add_u32 s41, s20, 0
    buffer_store_dwordx4 v[220:223], v2, s[12:15], s41 offen sc1
    s_waitcnt vmcnt(12)
    s_waitcnt lgkmcnt(5)
    s_barrier
    v_mfma_f32_16x16x32_bf16 v[156:159], v[96:99], v[52:55], v[156:159]
    v_mfma_f32_16x16x32_bf16 v[160:163], v[100:103], v[52:55], v[160:163]
    ds_read_b128 v[136:139], v14 offset:56320
    s_mov_b32 m0, s38
    s_nop 0
    buffer_load_dwordx4 v2, s[12:15], s39 offen offset:1024 lds
    v_mfma_f32_16x16x32_bf16 v[164:167], v[104:107], v[52:55], v[164:167]
    ds_read_b128 v[140:143], v14 offset:57344
    v_mfma_f32_16x16x32_bf16 v[168:171], v[108:111], v[52:55], v[168:171]
    ds_read_b128 v[144:147], v14 offset:58368
    v_mfma_f32_16x16x32_bf16 v[172:175], v[112:115], v[52:55], v[172:175]
    ds_read_b128 v[148:151], v14 offset:59392
    ds_read_b128 v[152:155], v14 offset:60416
    s_add_u32 s41, s20, 1024
    buffer_store_dwordx4 v[224:227], v2, s[12:15], s41 offen sc1
    s_waitcnt vmcnt(13)
    s_waitcnt lgkmcnt(5)
    v_mfma_f32_16x16x32_bf16 v[156:159], v[116:119], v[56:59], v[156:159]
    v_mfma_f32_16x16x32_bf16 v[160:163], v[120:123], v[56:59], v[160:163]
    ds_read_b128 v[96:99], v14 offset:61440
    s_mov_b32 m0, s38
    s_nop 0
    buffer_load_dwordx4 v2, s[12:15], s39 offen offset:2048 lds
    v_mfma_f32_16x16x32_bf16 v[164:167], v[124:127], v[56:59], v[164:167]
    ds_read_b128 v[100:103], v14 offset:62464
    v_mfma_f32_16x16x32_bf16 v[168:171], v[128:131], v[56:59], v[168:171]
    ds_read_b128 v[104:107], v14 offset:63488
    v_mfma_f32_16x16x32_bf16 v[172:175], v[132:135], v[56:59], v[172:175]
    ds_read_b128 v[108:111], v14 offset:64512
    ds_read_b128 v[112:115], v15 offset:0
    s_add_u32 s41, s20, 2048
    buffer_store_dwordx4 v[228:231], v2, s[12:15], s41 offen sc1
    s_waitcnt vmcnt(14)
    s_waitcnt lgkmcnt(5)
    v_mfma_f32_16x16x32_bf16 v[156:159], v[136:139], v[60:63], v[156:159]
    v_mfma_f32_16x16x32_bf16 v[160:163], v[140:143], v[60:63], v[160:163]
    ds_read_b128 v[116:119], v15 offset:1024
    s_mov_b32 m0, s38
    s_nop 0
    buffer_load_dwordx4 v2, s[12:15], s39 offen offset:3072 lds
    s_add_u32 s38, s38, 4096
    s_add_u32 s39, s39, 4096
    v_mfma_f32_16x16x32_bf16 v[164:167], v[144:147], v[60:63], v[164:167]
    ds_read_b128 v[120:123], v15 offset:2048
    v_mfma_f32_16x16x32_bf16 v[168:171], v[148:151], v[60:63], v[168:171]
    ds_read_b128 v[124:127], v15 offset:3072
    v_mfma_f32_16x16x32_bf16 v[172:175], v[152:155], v[60:63], v[172:175]
    ds_read_b128 v[128:131], v15 offset:4096
    ds_read_b128 v[132:135], v15 offset:5120
    s_add_u32 s41, s20, 3072
    buffer_store_dwordx4 v[232:235], v2, s[12:15], s41 offen sc1
    s_waitcnt vmcnt(15)
    s_waitcnt lgkmcnt(5)
    v_mfma_f32_16x16x32_bf16 v[156:159], v[96:99], v[64:67], v[156:159]
    v_mfma_f32_16x16x32_bf16 v[160:163], v[100:103], v[64:67], v[160:163]
    ds_read_b128 v[136:139], v15 offset:6144
    s_mov_b32 m0, s38
    s_nop 0
    buffer_load_dwordx4 v2, s[12:15], s39 offen offset:0 lds
    v_mfma_f32_16x16x32_bf16 v[164:167], v[104:107], v[64:67], v[164:167]
    ds_read_b128 v[140:143], v15 offset:7168
    v_mfma_f32_16x16x32_bf16 v[168:171], v[108:111], v[64:67], v[168:171]
    ds_read_b128 v[144:147], v15 offset:8192
    v_mfma_f32_16x16x32_bf16 v[172:175], v[112:115], v[64:67], v[172:175]
    ds_read_b128 v[148:151], v15 offset:9216
    ds_read_b128 v[152:155], v15 offset:10240
    s_add_u32 s41, s20, 4096
    buffer_store_dwordx4 v[236:239], v2, s[12:15], s41 offen sc1
    s_waitcnt vmcnt(16)
    s_waitcnt lgkmcnt(5)
    v_mfma_f32_16x16x32_bf16 v[156:159], v[116:119], v[68:71], v[156:159]
    v_mfma_f32_16x16x32_bf16 v[160:163], v[120:123], v[68:71], v[160:163]
    ds_read_b128 v[96:99], v15 offset:11264
    s_mov_b32 m0, s38
    s_nop 0
    buffer_load_dwordx4 v2, s[12:15], s39 offen offset:1024 lds
    v_mfma_f32_16x16x32_bf16 v[164:167], v[124:127], v[68:71], v[164:167]
    ds_read_b128 v[100:103], v15 offset:12288
    v_mfma_f32_16x16x32_bf16 v[168:171], v[128:131], v[68:71], v[168:171]
    ds_read_b128 v[104:107], v15 offset:13312
    v_mfma_f32_16x16x32_bf16 v[172:175], v[132:135], v[68:71], v[172:175]
    ds_read_b128 v[108:111], v15 offset:14336
    ds_read_b128 v[112:115], v15 offset:15360
    s_mov_b32 m0, s38
    s_nop 0
    buffer_load_dwordx4 v2, s[12:15], s39 offen offset:2048 lds
    s_waitcnt vmcnt(17)
    s_waitcnt lgkmcnt(5)
    v_mfma_f32_16x16x32_bf16 v[156:159], v[136:139], v[72:75], v[156:159]
    v_mfma_f32_16x16x32_bf16 v[160:163], v[140:143], v[72:75], v[160:163]
    ds_read_b128 v[116:119], v15 offset:16384
    s_mov_b32 m0, s38
    s_nop 0
    buffer_load_dwordx4 v2, s[12:15], s39 offen offset:3072 lds
    s_add_u32 s38, s38, 4096
    s_add_u32 s39, s39, 4096
    v_mfma_f32_16x16x32_bf16 v[164:167], v[144:147], v[72:75], v[164:167]
    ds_read_b128 v[120:123], v15 offset:17408
    v_mfma_f32_16x16x32_bf16 v[168:171], v[148:151], v[72:75], v[168:171]
    ds_read_b128 v[124:127], v15 offset:18432
    v_mfma_f32_16x16x32_bf16 v[172:175], v[152:155], v[72:75], v[172:175]
    ds_read_b128 v[128:131], v15 offset:19456
    ds_read_b128 v[132:135], v15 offset:20480
    s_mov_b32 m0, s38
    s_nop 0
    buffer_load_dwordx4 v2, s[12:15], s39 offen offset:0 lds
    s_waitcnt vmcnt(18)
    s_waitcnt lgkmcnt(5)
    v_mfma_f32_16x16x32_bf16 v[156:159], v[96:99], v[76:79], v[156:159]
    v_mfma_f32_16x16x32_bf16 v[160:163], v[100:103], v[76:79], v[160:163]
    ds_read_b128 v[136:139], v15 offset:21504
    s_mov_b32 m0, s38
    s_nop 0
    buffer_load_dwordx4 v2, s[12:15], s39 offen offset:1024 lds
    v_mfma_f32_16x16x32_bf16 v[164:167], v[104:107], v[76:79], v[164:167]
    ds_read_b128 v[140:143], v15 offset:22528
    v_mfma_f32_16x16x32_bf16 v[168:171], v[108:111], v[76:79], v[168:171]
    ds_read_b128 v[144:147], v15 offset:23552
    v_mfma_f32_16x16x32_bf16 v[172:175], v[112:115], v[76:79], v[172:175]
    ds_read_b128 v[148:151], v15 offset:24576
    ds_read_b128 v[152:155], v15 offset:25600
    s_mov_b32 m0, s38
    s_nop 0
    buffer_load_dwordx4 v2, s[12:15], s39 offen offset:2048 lds
    s_waitcnt vmcnt(19)
    s_waitcnt lgkmcnt(5)
    v_mfma_f32_16x16x32_bf16 v[156:159], v[116:119], v[80:83], v[156:159]
    v_mfma_f32_16x16x32_bf16 v[160:163], v[120:123], v[80:83], v[160:163]
    ds_read_b128 v[96:99], v15 offset:26624
    s_mov_b32 m0, s38
    s_nop 0
    buffer_load_dwordx4 v2, s[12:15], s39 offen offset:3072 lds
    s_add_u32 s38, s38, 4096
    s_add_u32 s39, s39, 4096
    v_mfma_f32_16x16x32_bf16 v[164:167], v[124:127], v[80:83], v[164:167]
    ds_read_b128 v[100:103], v15 offset:27648
    v_mfma_f32_16x16x32_bf16 v[168:171], v[128:131], v[80:83], v[168:171]
    ds_read_b128 v[104:107], v15 offset:28672
    v_mfma_f32_16x16x32_bf16 v[172:175], v[132:135], v[80:83], v[172:175]
    ds_read_b128 v[108:111], v15 offset:29696
    ds_read_b128 v[112:115], v15 offset:30720
    s_mov_b32 m0, s38
    s_nop 0
    buffer_load_dwordx4 v2, s[12:15], s39 offen offset:0 lds
    s_waitcnt vmcnt(20)
    s_waitcnt lgkmcnt(5)
    v_mfma_f32_16x16x32_bf16 v[156:159], v[136:139], v[84:87], v[156:159]
    v_mfma_f32_16x16x32_bf16 v[160:163], v[140:143], v[84:87], v[160:163]
    ds_read_b128 v[116:119], v15 offset:31744
    s_mul_i32 s38, s30, 12288
    s_add_u32 s39, s38, s44
    s_add_u32 s39, s39, 3637248
    s_add_u32 s38, s38, 0
    s_mov_b32 m0, s38
    s_nop 0
    buffer_load_dwordx4 v2, s[12:15], s39 offen offset:0 lds
    v_mfma_f32_16x16x32_bf16 v[164:167], v[144:147], v[84:87], v[164:167]
    ds_read_b128 v[120:123], v15 offset:32768
    v_mfma_f32_16x16x32_bf16 v[168:171], v[148:151], v[84:87], v[168:171]
    ds_read_b128 v[124:127], v15 offset:33792
    v_mfma_f32_16x16x32_bf16 v[172:175], v[152:155], v[84:87], v[172:175]
    ds_read_b128 v[128:131], v15 offset:34816
    ds_read_b128 v[132:135], v15 offset:35840
    s_mov_b32 m0, s38
    s_nop 0
    buffer_load_dwordx4 v2, s[12:15], s39 offen offset:1024 lds
    s_waitcnt vmcnt(21)
    s_waitcnt lgkmcnt(5)
    v_mfma_f32_16x16x32_bf16 v[156:159], v[96:99], v[88:91], v[156:159]
    v_mfma_f32_16x16x32_bf16 v[160:163], v[100:103], v[88:91], v[160:163]
    s_mov_b32 m0, s38
    s_nop 0
    buffer_load_dwordx4 v2, s[12:15], s39 offen offset:2048 lds
    v_mfma_f32_16x16x32_bf16 v[164:167], v[104:107], v[88:91], v[164:167]
    v_mfma_f32_16x16x32_bf16 v[168:171], v[108:111], v[88:91], v[168:171]
    v_mfma_f32_16x16x32_bf16 v[172:175], v[112:115], v[88:91], v[172:175]
    s_mov_b32 m0, s38
    s_nop 0
    buffer_load_dwordx4 v2, s[12:15], s39 offen offset:3072 lds
    s_add_u32 s38, s38, 4096
    s_add_u32 s39, s39, 4096
    s_waitcnt vmcnt(22)
    s_waitcnt lgkmcnt(0)
    v_mfma_f32_16x16x32_bf16 v[156:159], v[116:119], v[92:95], v[156:159]
    v_mfma_f32_16x16x32_bf16 v[160:163], v[120:123], v[92:95], v[160:163]
    s_mov_b32 m0, s38
    s_nop 0
    buffer_load_dwordx4 v2, s[12:15], s39 offen offset:0 lds
    v_mfma_f32_16x16x32_bf16 v[164:167], v[124:127], v[92:95], v[164:167]
    v_mfma_f32_16x16x32_bf16 v[168:171], v[128:131], v[92:95], v[168:171]
    v_mfma_f32_16x16x32_bf16 v[172:175], v[132:135], v[92:95], v[172:175]
    s_mov_b32 m0, s38
    s_nop 0
    buffer_load_dwordx4 v2, s[12:15], s39 offen offset:1024 lds
    s_barrier
    s_mov_b32 m0, s38
    s_nop 0
    buffer_load_dwordx4 v2, s[12:15], s39 offen offset:2048 lds
    s_mov_b32 m0, s38
    s_nop 0
    buffer_load_dwordx4 v2, s[12:15], s39 offen offset:3072 lds
    s_add_u32 s38, s38, 4096
    s_add_u32 s39, s39, 4096
    s_mov_b32 m0, s38
    s_nop 0
    buffer_load_dwordx4 v2, s[12:15], s39 offen offset:0 lds
    s_mov_b32 m0, s38
    s_nop 0
    buffer_load_dwordx4 v2, s[12:15], s39 offen offset:1024 lds
    s_mov_b32 m0, s38
    s_nop 0
    buffer_load_dwordx4 v2, s[12:15], s39 offen offset:2048 lds
    s_mov_b32 m0, s38
    s_nop 0
    buffer_load_dwordx4 v2, s[12:15], s39 offen offset:3072 lds
    s_mul_i32 s38, s30, 13312
    s_add_u32 s39, s38, s45
    s_add_u32 s39, s39, 0
    s_add_u32 s38, s38, 49152
    s_mov_b32 m0, s38
    s_nop 0
    buffer_load_dwordx4 v2, s[12:15], s39 offen offset:0 lds
    s_mov_b32 m0, s38
    s_nop 0
    buffer_load_dwordx4 v2, s[12:15], s39 offen offset:1024 lds
    s_mov_b32 m0, s38
    s_nop 0
    buffer_load_dwordx4 v2, s[12:15], s39 offen offset:2048 lds
    s_mov_b32 m0, s38
    s_nop 0
    buffer_load_dwordx4 v2, s[12:15], s39 offen offset:3072 lds
    s_add_u32 s38, s38, 4096
    s_add_u32 s39, s39, 4096
    s_mov_b32 m0, s38
    s_nop 0
    buffer_load_dwordx4 v2, s[12:15], s39 offen offset:0 lds
    s_mov_b32 m0, s38
    s_nop 0
    buffer_load_dwordx4 v2, s[12:15], s39 offen offset:1024 lds
    s_mov_b32 m0, s38
    s_nop 0
    buffer_load_dwordx4 v2, s[12:15], s39 offen offset:2048 lds
    s_mov_b32 m0, s38
    s_nop 0
    buffer_load_dwordx4 v2, s[12:15], s39 offen offset:3072 lds
    s_add_u32 s38, s38, 4096
    s_add_u32 s39, s39, 4096
    s_mov_b32 m0, s38
    s_nop 0
    buffer_load_dwordx4 v2, s[12:15], s39 offen offset:0 lds
    s_mov_b32 m0, s38
    s_nop 0
    buffer_load_dwordx4 v2, s[12:15], s39 offen offset:1024 lds
    s_mov_b32 m0, s38
    s_nop 0
    buffer_load_dwordx4 v2, s[12:15], s39 offen offset:2048 lds
    s_mov_b32 m0, s38
    s_nop 0
    buffer_load_dwordx4 v2, s[12:15], s39 offen offset:3072 lds
    s_add_u32 s38, s38, 4096
    s_add_u32 s39, s39, 4096
    s_mov_b32 m0, s38
    s_nop 0
    buffer_load_dwordx4 v2, s[12:15], s39 offen offset:0 lds
    v_lshlrev_b32 v9, 4, v3
    v_add_u32 v9, 155648, v9
    v_mov_b32 v12, 0xbdd2d3e8
    v_mov_b32 v13, 0xc0135761
    ds_read_b128 v[180:183], v9 offset:0
    ds_read_b128 v[200:203], v9 offset:512
    ds_read_b128 v[184:187], v9 offset:64
    ds_read_b128 v[204:207], v9 offset:576
    ds_read_b128 v[188:191], v9 offset:128
    ds_read_b128 v[208:211], v9 offset:640
    ds_read_b128 v[192:195], v9 offset:192
    ds_read_b128 v[212:215], v9 offset:704
    ds_read_b128 v[196:199], v9 offset:256
    ds_read_b128 v[216:219], v9 offset:768
    s_waitcnt lgkmcnt(0)
    v_pk_add_f32 v[180:181], v[180:181], v[200:201]
    v_pk_add_f32 v[182:183], v[182:183], v[202:203]
    v_pk_add_f32 v[184:185], v[184:185], v[204:205]
    v_pk_add_f32 v[186:187], v[186:187], v[206:207]
    v_pk_add_f32 v[188:189], v[188:189], v[208:209]
    v_pk_add_f32 v[190:191], v[190:191], v[210:211]
    v_pk_add_f32 v[192:193], v[192:193], v[212:213]
    v_pk_add_f32 v[194:195], v[194:195], v[214:215]
    v_pk_add_f32 v[196:197], v[196:197], v[216:217]
    v_pk_add_f32 v[198:199], v[198:199], v[218:219]
    v_pk_mul_f32 v[200:201], v[180:181], v[176:177] op_sel_hi:[1,0]
    v_pk_mul_f32 v[202:203], v[182:183], v[176:177] op_sel_hi:[1,0]
    v_pk_mul_f32 v[204:205], v[184:185], v[176:177] op_sel_hi:[1,0]
    v_pk_mul_f32 v[206:207], v[186:187], v[176:177] op_sel_hi:[1,0]
    v_pk_mul_f32 v[208:209], v[188:189], v[176:177] op_sel_hi:[1,0]
    v_pk_mul_f32 v[210:211], v[190:191], v[176:177] op_sel_hi:[1,0]
    v_pk_mul_f32 v[212:213], v[192:193], v[176:177] op_sel_hi:[1,0]
    v_pk_mul_f32 v[214:215], v[194:195], v[176:177] op_sel_hi:[1,0]
    v_pk_mul_f32 v[216:217], v[196:197], v[176:177] op_sel_hi:[1,0]
    v_pk_mul_f32 v[218:219], v[198:199], v[176:177] op_sel_hi:[1,0]
    v_pk_fma_f32 v[156:157], v[156:157], v[176:177], v[200:201] op_sel:[0,1,0] op_sel_hi:[1,1,1]
    v_pk_fma_f32 v[158:159], v[158:159], v[176:177], v[202:203] op_sel:[0,1,0] op_sel_hi:[1,1,1]
    v_pk_fma_f32 v[160:161], v[160:161], v[176:177], v[204:205] op_sel:[0,1,0] op_sel_hi:[1,1,1]
    v_pk_fma_f32 v[162:163], v[162:163], v[176:177], v[206:207] op_sel:[0,1,0] op_sel_hi:[1,1,1]
    v_pk_fma_f32 v[164:165], v[164:165], v[176:177], v[208:209] op_sel:[0,1,0] op_sel_hi:[1,1,1]
    v_pk_fma_f32 v[166:167], v[166:167], v[176:177], v[210:211] op_sel:[0,1,0] op_sel_hi:[1,1,1]
    v_pk_fma_f32 v[168:169], v[168:169], v[176:177], v[212:213] op_sel:[0,1,0] op_sel_hi:[1,1,1]
    v_pk_fma_f32 v[170:171], v[170:171], v[176:177], v[214:215] op_sel:[0,1,0] op_sel_hi:[1,1,1]
    v_pk_fma_f32 v[172:173], v[172:173], v[176:177], v[216:217] op_sel:[0,1,0] op_sel_hi:[1,1,1]
    v_pk_fma_f32 v[174:175], v[174:175], v[176:177], v[218:219] op_sel:[0,1,0] op_sel_hi:[1,1,1]
    v_pk_mul_f32 v[200:201], v[156:157], v[156:157]
    v_pk_mul_f32 v[202:203], v[158:159], v[158:159]
    v_pk_mul_f32 v[204:205], v[160:161], v[160:161]
    v_pk_mul_f32 v[206:207], v[162:163], v[162:163]
    v_pk_mul_f32 v[208:209], v[164:165], v[164:165]
    v_pk_mul_f32 v[210:211], v[166:167], v[166:167]
    v_pk_mul_f32 v[212:213], v[168:169], v[168:169]
    v_pk_mul_f32 v[214:215], v[170:171], v[170:171]
    v_pk_mul_f32 v[216:217], v[172:173], v[172:173]
    v_pk_mul_f32 v[218:219], v[174:175], v[174:175]
    v_pk_fma_f32 v[200:201], v[200:201], v[12:13], v[12:13] op_sel:[0,0,1] op_sel_hi:[1,0,1]
    v_pk_fma_f32 v[202:203], v[202:203], v[12:13], v[12:13] op_sel:[0,0,1] op_sel_hi:[1,0,1]
    v_pk_fma_f32 v[204:205], v[204:205], v[12:13], v[12:13] op_sel:[0,0,1] op_sel_hi:[1,0,1]
    v_pk_fma_f32 v[206:207], v[206:207], v[12:13], v[12:13] op_sel:[0,0,1] op_sel_hi:[1,0,1]
    v_pk_fma_f32 v[208:209], v[208:209], v[12:13], v[12:13] op_sel:[0,0,1] op_sel_hi:[1,0,1]
    v_pk_fma_f32 v[210:211], v[210:211], v[12:13], v[12:13] op_sel:[0,0,1] op_sel_hi:[1,0,1]
    v_pk_fma_f32 v[212:213], v[212:213], v[12:13], v[12:13] op_sel:[0,0,1] op_sel_hi:[1,0,1]
    v_pk_fma_f32 v[214:215], v[214:215], v[12:13], v[12:13] op_sel:[0,0,1] op_sel_hi:[1,0,1]
    v_pk_fma_f32 v[216:217], v[216:217], v[12:13], v[12:13] op_sel:[0,0,1] op_sel_hi:[1,0,1]
    v_pk_fma_f32 v[218:219], v[218:219], v[12:13], v[12:13] op_sel:[0,0,1] op_sel_hi:[1,0,1]
    v_pk_mul_f32 v[200:201], v[200:201], v[156:157]
    v_pk_mul_f32 v[202:203], v[202:203], v[158:159]
    v_pk_mul_f32 v[204:205], v[204:205], v[160:161]
    v_pk_mul_f32 v[206:207], v[206:207], v[162:163]
    v_pk_mul_f32 v[208:209], v[208:209], v[164:165]
    v_pk_mul_f32 v[210:211], v[210:211], v[166:167]
    v_pk_mul_f32 v[212:213], v[212:213], v[168:169]
    v_pk_mul_f32 v[214:215], v[214:215], v[170:171]
    v_pk_mul_f32 v[216:217], v[216:217], v[172:173]
    v_pk_mul_f32 v[218:219], v[218:219], v[174:175]
    v_exp_f32 v200, v200
    v_exp_f32 v201, v201
    v_exp_f32 v202, v202
    v_exp_f32 v203, v203
    v_exp_f32 v204, v204
    v_exp_f32 v205, v205
    v_exp_f32 v206, v206
    v_exp_f32 v207, v207
    v_exp_f32 v208, v208
    v_exp_f32 v209, v209
    v_exp_f32 v210, v210
    v_exp_f32 v211, v211
    v_exp_f32 v212, v212
    v_exp_f32 v213, v213
    v_exp_f32 v214, v214
    v_exp_f32 v215, v215
    v_exp_f32 v216, v216
    v_exp_f32 v217, v217
    v_exp_f32 v218, v218
    v_exp_f32 v219, v219
    v_pk_add_f32 v[200:201], v[200:201], 1.0 op_sel_hi:[1,0]
    v_pk_add_f32 v[202:203], v[202:203], 1.0 op_sel_hi:[1,0]
    v_pk_add_f32 v[204:205], v[204:205], 1.0 op_sel_hi:[1,0]
    v_pk_add_f32 v[206:207], v[206:207], 1.0 op_sel_hi:[1,0]
    v_pk_add_f32 v[208:209], v[208:209], 1.0 op_sel_hi:[1,0]
    v_pk_add_f32 v[210:211], v[210:211], 1.0 op_sel_hi:[1,0]
    v_pk_add_f32 v[212:213], v[212:213], 1.0 op_sel_hi:[1,0]
    v_pk_add_f32 v[214:215], v[214:215], 1.0 op_sel_hi:[1,0]
    v_pk_add_f32 v[216:217], v[216:217], 1.0 op_sel_hi:[1,0]
    v_pk_add_f32 v[218:219], v[218:219], 1.0 op_sel_hi:[1,0]
    v_rcp_f32 v200, v200
    v_rcp_f32 v201, v201
    v_rcp_f32 v202, v202
    v_rcp_f32 v203, v203
    v_rcp_f32 v204, v204
    v_rcp_f32 v205, v205
    v_rcp_f32 v206, v206
    v_rcp_f32 v207, v207
    v_rcp_f32 v208, v208
    v_rcp_f32 v209, v209
    v_rcp_f32 v210, v210
    v_rcp_f32 v211, v211
    v_rcp_f32 v212, v212
    v_rcp_f32 v213, v213
    v_rcp_f32 v214, v214
    v_rcp_f32 v215, v215
    v_rcp_f32 v216, v216
    v_rcp_f32 v217, v217
    v_rcp_f32 v218, v218
    v_rcp_f32 v219, v219
    s_nop 0
    v_pk_mul_f32 v[156:157], v[156:157], v[200:201]
    v_pk_mul_f32 v[158:159], v[158:159], v[202:203]
    v_pk_mul_f32 v[160:161], v[160:161], v[204:205]
    v_pk_mul_f32 v[162:163], v[162:163], v[206:207]
    v_pk_mul_f32 v[164:165], v[164:165], v[208:209]
    v_pk_mul_f32 v[166:167], v[166:167], v[210:211]
    v_pk_mul_f32 v[168:169], v[168:169], v[212:213]
    v_pk_mul_f32 v[170:171], v[170:171], v[214:215]
    v_pk_mul_f32 v[172:173], v[172:173], v[216:217]
    v_pk_mul_f32 v[174:175], v[174:175], v[218:219]
    v_cvt_pk_bf16_f32 v156, v156, v157
    v_cvt_pk_bf16_f32 v157, v158, v159
    v_cvt_pk_bf16_f32 v158, v160, v161
    v_cvt_pk_bf16_f32 v159, v162, v163
    v_cvt_pk_bf16_f32 v164, v164, v165
    v_cvt_pk_bf16_f32 v165, v166, v167
    v_cvt_pk_bf16_f32 v166, v168, v169
    v_cvt_pk_bf16_f32 v167, v170, v171
    v_cvt_pk_bf16_f32 v172, v172, v173
    v_cvt_pk_bf16_f32 v173, v174, v175
    s_nop 1
    v_permlane16_swap_b32 v156, v158
    v_permlane16_swap_b32 v157, v159
    v_permlane16_swap_b32 v164, v166
    v_permlane16_swap_b32 v165, v167
    s_mov_b32 s46, s22
    s_lshl_b32 s41, s33, 2
    s_add_u32 s49, s55, s41
    s_cmp_eq_u32 s31, 0
    s_cbranch_scc1 k2_kernel_slow19
    buffer_store_dwordx4 v[156:159], v254, s[12:15], s46 offen offset:0
    buffer_store_dwordx4 v[164:167], v254, s[12:15], s46 offen offset:1024
    buffer_store_dwordx2 v[172:173], v8, s[12:15], s46 offen offset:2048
    s_waitcnt vmcnt(0)
    v_mov_b32 v9, 1
    v_mov_b32 v10, 2304
    s_mov_b64 exec, 1
    buffer_store_dword v9, v10, s[12:15], s49 offen
    s_mov_b64 exec, -1
    s_branch k2_kernel_sent20
k2_kernel_slow19:
    buffer_store_dwordx4 v[156:159], v254, s[12:15], s46 offen offset:0 sc1
    buffer_store_dwordx4 v[164:167], v254, s[12:15], s46 offen offset:1024 sc1
    buffer_store_dwordx2 v[172:173], v8, s[12:15], s46 offen offset:2048 sc1
    s_waitcnt vmcnt(0)
    v_mov_b32 v9, 1
    v_mov_b32 v10, 2304
    s_mov_b64 exec, 1
    buffer_store_dword v9, v10, s[12:15], s49 offen sc1
    s_mov_b64 exec, -1
k2_kernel_sent20:
    s_cmp_eq_u32 s21, 0
    s_cbranch_scc1 k2_kernel_xas23
    v_mov_b32 v9, 3
    v_mov_b32 v10, 0
    s_mov_b64 exec, 1
    s_cmp_eq_u32 s31, 0
    s_cbranch_scc1 k2_kernel_xas21
    buffer_store_dword v9, v10, s[12:15], s21 offen
    s_branch k2_kernel_xas22
k2_kernel_xas21:
    buffer_store_dword v9, v10, s[12:15], s21 offen sc1
k2_kernel_xas22:
    s_mov_b64 exec, -1
k2_kernel_xas23:
    s_sub_u32 s41, s55, s37
    s_lshr_b32 s41, s41, 7
    v_bfe_u32 v7, v1, 3, 2
    v_min_u32 v7, 2, v7
    v_add_u32 v7, s41, v7
    v_subrev_u32 v7, 1, v7
    v_max_i32 v7, 0, v7
    v_min_i32 v7, 15, v7
    v_lshlrev_b32 v7, 7, v7
    v_and_b32 v9, 7, v1
    v_lshl_add_u32 v7, v9, 2, v7
    s_add_u32 s49, s37, 2304
    s_mov_b32 s43, 200000
k2_kernel_poll24:
    buffer_load_dword v9, v7, s[12:15], s49 offen sc1
    s_waitcnt vmcnt(0)
    v_cmp_ne_u32 vcc, 0, v9
    s_sub_u32 s43, s43, 1
    s_cmp_eq_u64 vcc, -1
    s_cbranch_scc1 k2_kernel_go25
    s_cmp_lg_u32 s43, 0
    s_cbranch_scc1 k2_kernel_poll24
k2_kernel_go25:
    s_mul_i32 s41, s33, 2560
    s_sub_u32 s47, s22, s41
    s_mov_b32 s52, s47
    s_add_u32 s41, s52, 0
    buffer_load_dwordx4 v[16:19], v2, s[12:15], s41 offen offset:0 sc1
    s_add_u32 s41, s52, 0
    buffer_load_dwordx4 v[20:23], v2, s[12:15], s41 offen offset:1024 sc1
    s_add_u32 s41, s52, 0
    buffer_load_dwordx4 v[24:27], v2, s[12:15], s41 offen offset:2048 sc1
    s_add_u32 s41, s52, 0
    buffer_load_dwordx4 v[28:31], v2, s[12:15], s41 offen offset:3072 sc1
    s_add_u32 s41, s54, 20480
    s_mov_b32 s48, s41
    s_sub_u32 s41, s55, s37
    s_lshl_b32 s41, s41, 3
    s_add_u32 s46, s41, s36
    s_add_u32 s46, s46, 1581056
    s_barrier
    ds_read_b128 v[96:99], v15 offset:36864
    ds_read_b128 v[100:103], v15 offset:37888
    ds_read_b128 v[104:107], v15 offset:38912
    ds_read_b128 v[108:111], v15 offset:39936
    ds_read_b128 v[112:115], v15 offset:40960
    ds_read_b128 v[116:119], v15 offset:41984
    ds_read_b128 v[120:123], v15 offset:43008
    ds_read_b128 v[124:127], v15 offset:44032
    ds_read_b128 v[128:131], v15 offset:45056
    ds_read_b128 v[132:135], v15 offset:46080
    s_waitcnt vmcnt(3)
    s_waitcnt lgkmcnt(5)
    v_mfma_f32_16x16x32_bf16 v[156:159], v[96:99], v[16:19], 0
    s_add_u32 s41, s52, 4096
    buffer_load_dwordx4 v[32:35], v2, s[12:15], s41 offen offset:0 sc1
    v_mfma_f32_16x16x32_bf16 v[160:163], v[100:103], v[16:19], 0
    ds_read_b128 v[136:139], v15 offset:47104
    v_mfma_f32_16x16x32_bf16 v[164:167], v[104:107], v[16:19], 0
    ds_read_b128 v[140:143], v15 offset:48128
    v_mfma_f32_16x16x32_bf16 v[168:171], v[108:111], v[16:19], 0
    ds_read_b128 v[144:147], v15 offset:49152
    s_add_u32 s41, s52, 4096
    buffer_load_dwordx4 v[36:39], v2, s[12:15], s41 offen offset:1024 sc1
    v_mfma_f32_16x16x32_bf16 v[172:175], v[112:115], v[16:19], 0
    ds_read_b128 v[148:151], v15 offset:50176
    ds_read_b128 v[152:155], v15 offset:51200
    s_waitcnt vmcnt(4)
    s_waitcnt lgkmcnt(5)
    v_mfma_f32_16x16x32_bf16 v[156:159], v[116:119], v[20:23], v[156:159]
    s_add_u32 s41, s52, 4096
    buffer_load_dwordx4 v[40:43], v2, s[12:15], s41 offen offset:2048 sc1
    v_mfma_f32_16x16x32_bf16 v[160:163], v[120:123], v[20:23], v[160:163]
    ds_read_b128 v[96:99], v15 offset:52224
    v_mfma_f32_16x16x32_bf16 v[164:167], v[124:127], v[20:23], v[164:167]
    ds_read_b128 v[100:103], v15 offset:53248
    v_mfma_f32_16x16x32_bf16 v[168:171], v[128:131], v[20:23], v[168:171]
    ds_read_b128 v[104:107], v15 offset:54272
    s_add_u32 s41, s52, 4096
    buffer_load_dwordx4 v[44:47], v2, s[12:15], s41 offen offset:3072 sc1
    v_mfma_f32_16x16x32_bf16 v[172:175], v[132:135], v[20:23], v[172:175]
    ds_read_b128 v[108:111], v15 offset:55296
    ds_read_b128 v[112:115], v15 offset:56320
    s_waitcnt vmcnt(5)
    s_waitcnt lgkmcnt(5)
    v_mfma_f32_16x16x32_bf16 v[156:159], v[136:139], v[24:27], v[156:159]
    s_add_u32 s41, s52, 8192
    buffer_load_dwordx4 v[48:51], v2, s[12:15], s41 offen offset:0 sc1
    v_mfma_f32_16x16x32_bf16 v[160:163], v[140:143], v[24:27], v[160:163]
    ds_read_b128 v[116:119], v15 offset:57344
    v_mfma_f32_16x16x32_bf16 v[164:167], v[144:147], v[24:27], v[164:167]
    ds_read_b128 v[120:123], v15 offset:58368
    v_mfma_f32_16x16x32_bf16 v[168:171], v[148:151], v[24:27], v[168:171]
    ds_read_b128 v[124:127], v15 offset:59392
    s_add_u32 s41, s52, 8192
    buffer_load_dwordx4 v[52:55], v2, s[12:15], s41 offen offset:1024 sc1
    v_mfma_f32_16x16x32_bf16 v[172:175], v[152:155], v[24:27], v[172:175]
    ds_read_b128 v[128:131], v15 offset:60416
    ds_read_b128 v[132:135], v15 offset:61440
    s_waitcnt vmcnt(6)
    s_waitcnt lgkmcnt(5)
    v_mfma_f32_16x16x32_bf16 v[156:159], v[96:99], v[28:31], v[156:159]
    s_add_u32 s41, s52, 8192
    buffer_load_dwordx4 v[56:59], v2, s[12:15], s41 offen offset:2048 sc1
    v_mfma_f32_16x16x32_bf16 v[160:163], v[100:103], v[28:31], v[160:163]
    ds_read_b128 v[136:139], v15 offset:62464
    v_mfma_f32_16x16x32_bf16 v[164:167], v[104:107], v[28:31], v[164:167]
    ds_read_b128 v[140:143], v15 offset:63488
    v_mfma_f32_16x16x32_bf16 v[168:171], v[108:111], v[28:31], v[168:171]
    ds_read_b128 v[144:147], v15 offset:64512
    s_add_u32 s41, s52, 8192
    buffer_load_dwordx4 v[60:63], v2, s[12:15], s41 offen offset:3072 sc1
    v_mfma_f32_16x16x32_bf16 v[172:175], v[112:115], v[28:31], v[172:175]
    ds_read_b128 v[148:151], v11 offset:0
    ds_read_b128 v[152:155], v11 offset:1024
    s_waitcnt vmcnt(7)
    s_waitcnt lgkmcnt(5)
    v_mfma_f32_16x16x32_bf16 v[156:159], v[116:119], v[32:35], v[156:159]
    s_add_u32 s41, s52, 12288
    buffer_load_dwordx4 v[64:67], v2, s[12:15], s41 offen offset:0 sc1
    v_mfma_f32_16x16x32_bf16 v[160:163], v[120:123], v[32:35], v[160:163]
    ds_read_b128 v[96:99], v11 offset:2048
    v_mfma_f32_16x16x32_bf16 v[164:167], v[124:127], v[32:35], v[164:167]
    ds_read_b128 v[100:103], v11 offset:3072
    v_mfma_f32_16x16x32_bf16 v[168:171], v[128:131], v[32:35], v[168:171]
    ds_read_b128 v[104:107], v11 offset:4096
    s_add_u32 s41, s52, 12288
    buffer_load_dwordx4 v[68:71], v2, s[12:15], s41 offen offset:1024 sc1
    v_mfma_f32_16x16x32_bf16 v[172:175], v[132:135], v[32:35], v[172:175]
    ds_read_b128 v[108:111], v11 offset:5120
    ds_read_b128 v[112:115], v11 offset:6144
    s_waitcnt vmcnt(8)
    s_waitcnt lgkmcnt(5)
    v_mfma_f32_16x16x32_bf16 v[156:159], v[136:139], v[36:39], v[156:159]
    s_add_u32 s41, s52, 12288
    buffer_load_dwordx4 v[72:75], v2, s[12:15], s41 offen offset:2048 sc1
    v_mfma_f32_16x16x32_bf16 v[160:163], v[140:143], v[36:39], v[160:163]
    ds_read_b128 v[116:119], v11 offset:7168
    v_mfma_f32_16x16x32_bf16 v[164:167], v[144:147], v[36:39], v[164:167]
    ds_read_b128 v[120:123], v11 offset:8192
    v_mfma_f32_16x16x32_bf16 v[168:171], v[148:151], v[36:39], v[168:171]
    ds_read_b128 v[124:127], v11 offset:9216
    s_add_u32 s41, s52, 12288
    buffer_load_dwordx4 v[76:79], v2, s[12:15], s41 offen offset:3072 sc1
    v_mfma_f32_16x16x32_bf16 v[172:175], v[152:155], v[36:39], v[172:175]
    ds_read_b128 v[128:131], v11 offset:10240
    ds_read_b128 v[132:135], v11 offset:11264
    s_waitcnt vmcnt(9)
    s_waitcnt lgkmcnt(5)
    v_mfma_f32_16x16x32_bf16 v[156:159], v[96:99], v[40:43], v[156:159]
    s_add_u32 s41, s52, 16384
    buffer_load_dwordx4 v[80:83], v2, s[12:15], s41 offen offset:0 sc1
    v_mfma_f32_16x16x32_bf16 v[160:163], v[100:103], v[40:43], v[160:163]
    ds_read_b128 v[136:139], v11 offset:12288
    v_mfma_f32_16x16x32_bf16 v[164:167], v[104:107], v[40:43], v[164:167]
    ds_read_b128 v[140:143], v11 offset:13312
    v_mfma_f32_16x16x32_bf16 v[168:171], v[108:111], v[40:43], v[168:171]
    ds_read_b128 v[144:147], v11 offset:14336
    s_add_u32 s41, s52, 16384
    buffer_load_dwordx4 v[84:87], v2, s[12:15], s41 offen offset:1024 sc1
    v_mfma_f32_16x16x32_bf16 v[172:175], v[112:115], v[40:43], v[172:175]
    ds_read_b128 v[148:151], v11 offset:15360
    ds_read_b128 v[152:155], v11 offset:16384
    s_waitcnt vmcnt(10)
    s_waitcnt lgkmcnt(5)
    v_mfma_f32_16x16x32_bf16 v[156:159], v[116:119], v[44:47], v[156:159]
    s_add_u32 s41, s52, 16384
    buffer_load_dwordx4 v[88:91], v2, s[12:15], s41 offen offset:2048 sc1
    v_mfma_f32_16x16x32_bf16 v[160:163], v[120:123], v[44:47], v[160:163]
    ds_read_b128 v[96:99], v11 offset:17408
    v_mfma_f32_16x16x32_bf16 v[164:167], v[124:127], v[44:47], v[164:167]
    ds_read_b128 v[100:103], v11 offset:18432
    v_mfma_f32_16x16x32_bf16 v[168:171], v[128:131], v[44:47], v[168:171]
    ds_read_b128 v[104:107], v11 offset:19456
    s_add_u32 s41, s52, 16384
    buffer_load_dwordx4 v[92:95], v2, s[12:15], s41 offen offset:3072 sc1
    v_mfma_f32_16x16x32_bf16 v[172:175], v[132:135], v[44:47], v[172:175]
    ds_read_b128 v[108:111], v11 offset:20480
    ds_read_b128 v[112:115], v11 offset:21504
    s_waitcnt vmcnt(11)
    s_waitcnt lgkmcnt(5)
    v_mfma_f32_16x16x32_bf16 v[156:159], v[136:139], v[48:51], v[156:159]
    v_mfma_f32_16x16x32_bf16 v[160:163], v[140:143], v[48:51], v[160:163]
    ds_read_b128 v[116:119], v11 offset:22528
    buffer_load_dwordx4 v[176:179], v254, s[12:15], s48 offen sc1
    buffer_load_dwordx4 v[180:183], v254, s[12:15], s48 offen offset:1024 sc1
    buffer_load_dwordx2 v[184:185], v8, s[12:15], s48 offen offset:2048 sc1
    v_mfma_f32_16x16x32_bf16 v[164:167], v[144:147], v[48:51], v[164:167]
    ds_read_b128 v[120:123], v11 offset:23552
    v_mfma_f32_16x16x32_bf16 v[168:171], v[148:151], v[48:51], v[168:171]
    ds_read_b128 v[124:127], v14 offset:0
    v_mfma_f32_16x16x32_bf16 v[172:175], v[152:155], v[48:51], v[172:175]
    ds_read_b128 v[128:131], v14 offset:1024
    ds_read_b128 v[132:135], v14 offset:2048
    s_waitcnt vmcnt(13)
    s_waitcnt lgkmcnt(5)
    s_barrier
    v_mfma_f32_16x16x32_bf16 v[156:159], v[96:99], v[52:55], v[156:159]
    v_mfma_f32_16x16x32_bf16 v[160:163], v[100:103], v[52:55], v[160:163]
    ds_read_b128 v[136:139], v14 offset:3072
    v_mfma_f32_16x16x32_bf16 v[164:167], v[104:107], v[52:55], v[164:167]
    ds_read_b128 v[140:143], v14 offset:4096
    v_mfma_f32_16x16x32_bf16 v[168:171], v[108:111], v[52:55], v[168:171]
    ds_read_b128 v[144:147], v14 offset:5120
    v_mfma_f32_16x16x32_bf16 v[172:175], v[112:115], v[52:55], v[172:175]
    ds_read_b128 v[148:151], v14 offset:6144
    ds_read_b128 v[152:155], v14 offset:7168
    s_waitcnt vmcnt(12)
    s_waitcnt lgkmcnt(5)
    v_mfma_f32_16x16x32_bf16 v[156:159], v[116:119], v[56:59], v[156:159]
    v_mfma_f32_16x16x32_bf16 v[160:163], v[120:123], v[56:59], v[160:163]
    ds_read_b128 v[96:99], v14 offset:8192
    s_mul_i32 s38, s30, 12288
    s_add_u32 s39, s38, s45
    s_add_u32 s39, s39, 53248
    s_add_u32 s38, s38, 102400
    s_mov_b32 m0, s38
    s_nop 0
    buffer_load_dwordx4 v2, s[12:15], s39 offen offset:0 lds
    v_mfma_f32_16x16x32_bf16 v[164:167], v[124:127], v[56:59], v[164:167]
    ds_read_b128 v[100:103], v14 offset:9216
    v_mfma_f32_16x16x32_bf16 v[168:171], v[128:131], v[56:59], v[168:171]
    ds_read_b128 v[104:107], v14 offset:10240
    v_mfma_f32_16x16x32_bf16 v[172:175], v[132:135], v[56:59], v[172:175]
    ds_read_b128 v[108:111], v14 offset:11264
    ds_read_b128 v[112:115], v14 offset:12288
    s_mov_b32 m0, s38
    s_nop 0
    buffer_load_dwordx4 v2, s[12:15], s39 offen offset:1024 lds
    s_waitcnt vmcnt(13)
    s_waitcnt lgkmcnt(5)
    v_mfma_f32_16x16x32_bf16 v[156:159], v[136:139], v[60:63], v[156:159]
    v_mfma_f32_16x16x32_bf16 v[160:163], v[140:143], v[60:63], v[160:163]
    ds_read_b128 v[116:119], v14 offset:13312
    s_mov_b32 m0, s38
    s_nop 0
    buffer_load_dwordx4 v2, s[12:15], s39 offen offset:2048 lds
    v_mfma_f32_16x16x32_bf16 v[164:167], v[144:147], v[60:63], v[164:167]
    ds_read_b128 v[120:123], v14 offset:14336
    v_mfma_f32_16x16x32_bf16 v[168:171], v[148:151], v[60:63], v[168:171]
    ds_read_b128 v[124:127], v14 offset:15360
    v_mfma_f32_16x16x32_bf16 v[172:175], v[152:155], v[60:63], v[172:175]
    ds_read_b128 v[128:131], v14 offset:16384
    ds_read_b128 v[132:135], v14 offset:17408
    s_mov_b32 m0, s38
    s_nop 0
    buffer_load_dwordx4 v2, s[12:15], s39 offen offset:3072 lds
    s_add_u32 s38, s38, 4096
    s_add_u32 s39, s39, 4096
    s_waitcnt vmcnt(14)
    s_waitcnt lgkmcnt(5)
    v_mfma_f32_16x16x32_bf16 v[156:159], v[96:99], v[64:67], v[156:159]
    v_mfma_f32_16x16x32_bf16 v[160:163], v[100:103], v[64:67], v[160:163]
    ds_read_b128 v[136:139], v14 offset:18432
    s_mov_b32 m0, s38
    s_nop 0
    buffer_load_dwordx4 v2, s[12:15], s39 offen offset:0 lds
    v_mfma_f32_16x16x32_bf16 v[164:167], v[104:107], v[64:67], v[164:167]
    ds_read_b128 v[140:143], v14 offset:19456
    v_mfma_f32_16x16x32_bf16 v[168:171], v[108:111], v[64:67], v[168:171]
    ds_read_b128 v[144:147], v14 offset:20480
    v_mfma_f32_16x16x32_bf16 v[172:175], v[112:115], v[64:67], v[172:175]
    ds_read_b128 v[148:151], v14 offset:21504
    ds_read_b128 v[152:155], v14 offset:22528
    s_mov_b32 m0, s38
    s_nop 0
    buffer_load_dwordx4 v2, s[12:15], s39 offen offset:1024 lds
    s_waitcnt vmcnt(15)
    s_waitcnt lgkmcnt(5)
    v_mfma_f32_16x16x32_bf16 v[156:159], v[116:119], v[68:71], v[156:159]
    v_mfma_f32_16x16x32_bf16 v[160:163], v[120:123], v[68:71], v[160:163]
    ds_read_b128 v[96:99], v14 offset:23552
    s_mov_b32 m0, s38
    s_nop 0
    buffer_load_dwordx4 v2, s[12:15], s39 offen offset:2048 lds
    v_mfma_f32_16x16x32_bf16 v[164:167], v[124:127], v[68:71], v[164:167]
    ds_read_b128 v[100:103], v14 offset:24576
    v_mfma_f32_16x16x32_bf16 v[168:171], v[128:131], v[68:71], v[168:171]
    ds_read_b128 v[104:107], v14 offset:25600
    v_mfma_f32_16x16x32_bf16 v[172:175], v[132:135], v[68:71], v[172:175]
    ds_read_b128 v[108:111], v14 offset:26624
    ds_read_b128 v[112:115], v14 offset:27648
    s_mov_b32 m0, s38
    s_nop 0
    buffer_load_dwordx4 v2, s[12:15], s39 offen offset:3072 lds
    s_add_u32 s38, s38, 4096
    s_add_u32 s39, s39, 4096
    s_waitcnt vmcnt(16)
    s_waitcnt lgkmcnt(5)
    v_mfma_f32_16x16x32_bf16 v[156:159], v[136:139], v[72:75], v[156:159]
    v_mfma_f32_16x16x32_bf16 v[160:163], v[140:143], v[72:75], v[160:163]
    ds_read_b128 v[116:119], v14 offset:28672
    s_mov_b32 m0, s38
    s_nop 0
    buffer_load_dwordx4 v2, s[12:15], s39 offen offset:0 lds
    v_mfma_f32_16x16x32_bf16 v[164:167], v[144:147], v[72:75], v[164:167]
    ds_read_b128 v[120:123], v14 offset:29696
    v_mfma_f32_16x16x32_bf16 v[168:171], v[148:151], v[72:75], v[168:171]
    ds_read_b128 v[124:127], v14 offset:30720
    v_mfma_f32_16x16x32_bf16 v[172:175], v[152:155], v[72:75], v[172:175]
    ds_read_b128 v[128:131], v14 offset:31744
    ds_read_b128 v[132:135], v14 offset:32768
    s_mov_b32 m0, s38
    s_nop 0
    buffer_load_dwordx4 v2, s[12:15], s39 offen offset:1024 lds
    s_waitcnt vmcnt(17)
    s_waitcnt lgkmcnt(5)
    v_mfma_f32_16x16x32_bf16 v[156:159], v[96:99], v[76:79], v[156:159]
    v_mfma_f32_16x16x32_bf16 v[160:163], v[100:103], v[76:79], v[160:163]
    ds_read_b128 v[136:139], v14 offset:33792
    s_mov_b32 m0, s38
    s_nop 0
    buffer_load_dwordx4 v2, s[12:15], s39 offen offset:2048 lds
    v_mfma_f32_16x16x32_bf16 v[164:167], v[104:107], v[76:79], v[164:167]
    ds_read_b128 v[140:143], v14 offset:34816
    v_mfma_f32_16x16x32_bf16 v[168:171], v[108:111], v[76:79], v[168:171]
    ds_read_b128 v[144:147], v14 offset:35840
    v_mfma_f32_16x16x32_bf16 v[172:175], v[112:115], v[76:79], v[172:175]
    ds_read_b128 v[148:151], v14 offset:36864
    ds_read_b128 v[152:155], v14 offset:37888
    s_mov_b32 m0, s38
    s_nop 0
    buffer_load_dwordx4 v2, s[12:15], s39 offen offset:3072 lds
    s_waitcnt vmcnt(18)
    s_waitcnt lgkmcnt(5)
    v_mfma_f32_16x16x32_bf16 v[156:159], v[116:119], v[80:83], v[156:159]
    v_mfma_f32_16x16x32_bf16 v[160:163], v[120:123], v[80:83], v[160:163]
    ds_read_b128 v[96:99], v14 offset:38912
    v_mfma_f32_16x16x32_bf16 v[164:167], v[124:127], v[80:83], v[164:167]
    ds_read_b128 v[100:103], v14 offset:39936
    v_mfma_f32_16x16x32_bf16 v[168:171], v[128:131], v[80:83], v[168:171]
    ds_read_b128 v[104:107], v14 offset:40960
    v_mfma_f32_16x16x32_bf16 v[172:175], v[132:135], v[80:83], v[172:175]
    ds_read_b128 v[108:111], v14 offset:41984
    ds_read_b128 v[112:115], v14 offset:43008
    s_waitcnt vmcnt(17)
    s_waitcnt lgkmcnt(5)
    v_mfma_f32_16x16x32_bf16 v[156:159], v[136:139], v[84:87], v[156:159]
    v_mfma_f32_16x16x32_bf16 v[160:163], v[140:143], v[84:87], v[160:163]
    ds_read_b128 v[116:119], v14 offset:44032
    v_mfma_f32_16x16x32_bf16 v[164:167], v[144:147], v[84:87], v[164:167]
    ds_read_b128 v[120:123], v14 offset:45056
    v_mfma_f32_16x16x32_bf16 v[168:171], v[148:151], v[84:87], v[168:171]
    ds_read_b128 v[124:127], v14 offset:46080
    v_mfma_f32_16x16x32_bf16 v[172:175], v[152:155], v[84:87], v[172:175]
    ds_read_b128 v[128:131], v14 offset:47104
    ds_read_b128 v[132:135], v14 offset:48128
    s_waitcnt vmcnt(16)
    s_waitcnt lgkmcnt(5)
    v_mfma_f32_16x16x32_bf16 v[156:159], v[96:99], v[88:91], v[156:159]
    v_mfma_f32_16x16x32_bf16 v[160:163], v[100:103], v[88:91], v[160:163]
    v_mfma_f32_16x16x32_bf16 v[164:167], v[104:107], v[88:91], v[164:167]
    v_mfma_f32_16x16x32_bf16 v[168:171], v[108:111], v[88:91], v[168:171]
    v_mfma_f32_16x16x32_bf16 v[172:175], v[112:115], v[88:91], v[172:175]
    s_waitcnt vmcnt(15)
    s_waitcnt lgkmcnt(0)
    v_mfma_f32_16x16x32_bf16 v[156:159], v[116:119], v[92:95], v[156:159]
    v_mfma_f32_16x16x32_bf16 v[160:163], v[120:123], v[92:95], v[160:163]
    v_mfma_f32_16x16x32_bf16 v[164:167], v[124:127], v[92:95], v[164:167]
    v_mfma_f32_16x16x32_bf16 v[168:171], v[128:131], v[92:95], v[168:171]
    v_mfma_f32_16x16x32_bf16 v[172:175], v[132:135], v[92:95], v[172:175]
    s_barrier
    s_mul_i32 s38, s30, 1024
    s_add_u32 s39, s38, s45
    s_add_u32 s39, s39, 102400
    s_add_u32 s38, s38, 151552
    s_mov_b32 m0, s38
    s_nop 0
    buffer_load_dwordx4 v2, s[12:15], s39 offen offset:0 lds
    s_mul_i32 s38, s30, 9216
    s_add_u32 s39, s38, s45
    s_add_u32 s39, s39, 106496
    s_add_u32 s38, s38, 0
    s_mov_b32 m0, s38
    s_nop 0
    buffer_load_dwordx4 v2, s[12:15], s39 offen offset:0 lds
    s_mov_b32 m0, s38
    s_nop 0
    buffer_load_dwordx4 v2, s[12:15], s39 offen offset:1024 lds
    s_mov_b32 m0, s38
    s_nop 0
    buffer_load_dwordx4 v2, s[12:15], s39 offen offset:2048 lds
    s_mov_b32 m0, s38
    s_nop 0
    buffer_load_dwordx4 v2, s[12:15], s39 offen offset:3072 lds
    s_add_u32 s38, s38, 4096
    s_add_u32 s39, s39, 4096
    s_mov_b32 m0, s38
    s_nop 0
    buffer_load_dwordx4 v2, s[12:15], s39 offen offset:0 lds
    s_mov_b32 m0, s38
    s_nop 0
    buffer_load_dwordx4 v2, s[12:15], s39 offen offset:1024 lds
    s_mov_b32 m0, s38
    s_nop 0
    buffer_load_dwordx4 v2, s[12:15], s39 offen offset:2048 lds
    s_mov_b32 m0, s38
    s_nop 0
    buffer_load_dwordx4 v2, s[12:15], s39 offen offset:3072 lds
    s_add_u32 s38, s38, 4096
    s_add_u32 s39, s39, 4096
    s_mov_b32 m0, s38
    s_nop 0
    buffer_load_dwordx4 v2, s[12:15], s39 offen offset:0 lds
    v_mov_b32 v196, 0x3f803f80
    v_mov_b32 v198, 0
    v_mov_b32 v199, 0
    s_waitcnt vmcnt(22)
    s_nop 1
    v_permlane16_swap_b32 v176, v178
    v_permlane16_swap_b32 v177, v179
    v_permlane16_swap_b32 v180, v182
    v_permlane16_swap_b32 v181, v183
    s_nop 1
    v_lshlrev_b32 v200, 16, v176
    v_and_b32 v201, 0xffff0000, v176
    v_lshlrev_b32 v202, 16, v177
    v_and_b32 v203, 0xffff0000, v177
    v_lshlrev_b32 v204, 16, v178
    v_and_b32 v205, 0xffff0000, v178
    v_lshlrev_b32 v206, 16, v179
    v_and_b32 v207, 0xffff0000, v179
    v_lshlrev_b32 v208, 16, v180
    v_and_b32 v209, 0xffff0000, v180
    v_lshlrev_b32 v210, 16, v181
    v_and_b32 v211, 0xffff0000, v181
    v_lshlrev_b32 v212, 16, v182
    v_and_b32 v213, 0xffff0000, v182
    v_lshlrev_b32 v214, 16, v183
    v_and_b32 v215, 0xffff0000, v183
    v_lshlrev_b32 v216, 16, v184
    v_and_b32 v217, 0xffff0000, v184
    v_lshlrev_b32 v218, 16, v185
    v_and_b32 v219, 0xffff0000, v185
    v_pk_add_f32 v[156:157], v[156:157], v[200:201]
    v_pk_add_f32 v[158:159], v[158:159], v[202:203]
    v_pk_add_f32 v[160:161], v[160:161], v[204:205]
    v_pk_add_f32 v[162:163], v[162:163], v[206:207]
    v_pk_add_f32 v[164:165], v[164:165], v[208:209]
    v_pk_add_f32 v[166:167], v[166:167], v[210:211]
    v_pk_add_f32 v[168:169], v[168:169], v[212:213]
    v_pk_add_f32 v[170:171], v[170:171], v[214:215]
    v_pk_add_f32 v[172:173], v[172:173], v[216:217]
    v_pk_add_f32 v[174:175], v[174:175], v[218:219]
    v_cvt_pk_bf16_f32 v156, v156, v157
    v_cvt_pk_bf16_f32 v157, v158, v159
    v_cvt_pk_bf16_f32 v158, v160, v161
    v_cvt_pk_bf16_f32 v159, v162, v163
    v_cvt_pk_bf16_f32 v164, v164, v165
    v_cvt_pk_bf16_f32 v165, v166, v167
    v_cvt_pk_bf16_f32 v166, v168, v169
    v_cvt_pk_bf16_f32 v167, v170, v171
    v_cvt_pk_bf16_f32 v172, v172, v173
    v_cvt_pk_bf16_f32 v173, v174, v175
    v_dot2_f32_bf16 v198, v156, v196, v198
    v_dot2_f32_bf16 v199, v156, v156, v199
    v_dot2_f32_bf16 v198, v157, v196, v198
    v_dot2_f32_bf16 v199, v157, v157, v199
    v_dot2_f32_bf16 v198, v158, v196, v198
    v_dot2_f32_bf16 v199, v158, v158, v199
    v_dot2_f32_bf16 v198, v159, v196, v198
    v_dot2_f32_bf16 v199, v159, v159, v199
    v_dot2_f32_bf16 v198, v164, v196, v198
    v_dot2_f32_bf16 v199, v164, v164, v199
    v_dot2_f32_bf16 v198, v165, v196, v198
    v_dot2_f32_bf16 v199, v165, v165, v199
    v_dot2_f32_bf16 v198, v166, v196, v198
    v_dot2_f32_bf16 v199, v166, v166, v199
    v_dot2_f32_bf16 v198, v167, v196, v198
    v_dot2_f32_bf16 v199, v167, v167, v199
    v_dot2_f32_bf16 v198, v172, v196, v198
    v_dot2_f32_bf16 v199, v172, v172, v199
    v_dot2_f32_bf16 v198, v173, v196, v198
    v_dot2_f32_bf16 v199, v173, v173, v199
    s_nop 1
    s_nop 1
    v_permlane16_swap_b32 v156, v158
    v_permlane16_swap_b32 v157, v159
    v_permlane16_swap_b32 v164, v166
    v_permlane16_swap_b32 v165, v167
    s_nop 2
    v_mov_b32 v188, v198
    v_mov_b32 v189, v199
    s_nop 1
    v_permlane32_swap_b32 v188, v198
    v_permlane32_swap_b32 v189, v199
    s_nop 0
    v_add_f32 v198, v198, v188
    v_add_f32 v199, v199, v189
    v_mov_b32 v188, v198
    v_mov_b32 v189, v199
    s_nop 1
    v_permlane16_swap_b32 v188, v198
    v_permlane16_swap_b32 v189, v199
    s_nop 0
    v_add_f32 v198, v198, v188
    v_add_f32 v199, v199, v189
    s_add_u32 s47, s54, 20480
    v_lshlrev_b32 v9, 6, v4
    s_lshl_b32 s41, s33, 3
    s_add_u32 s46, s46, s41
    s_lshl_b32 s41, s33, 2
    s_add_u32 s49, s55, s41
    v_mov_b32 v11, v9
    s_cmp_eq_u32 s31, 0
    s_cbranch_scc1 k2_kernel_slow26
    buffer_store_dwordx4 v[156:159], v254, s[12:15], s47 offen offset:0
    buffer_store_dwordx4 v[164:167], v254, s[12:15], s47 offen offset:1024
    buffer_store_dwordx2 v[172:173], v8, s[12:15], s47 offen offset:2048
    s_mov_b64 exec, 0xffff
    buffer_store_dwordx2 v[198:199], v11, s[12:15], s46 offen
    s_mov_b64 exec, -1
    s_waitcnt vmcnt(0)
    v_mov_b32 v9, 1
    v_mov_b32 v10, 4352
    s_mov_b64 exec, 1
    buffer_store_dword v9, v10, s[12:15], s49 offen
    s_mov_b64 exec, -1
    s_branch k2_kernel_sent27
k2_kernel_slow26:
    buffer_store_dwordx4 v[156:159], v254, s[12:15], s47 offen offset:0 sc1
    buffer_store_dwordx4 v[164:167], v254, s[12:15], s47 offen offset:1024 sc1
    buffer_store_dwordx2 v[172:173], v8, s[12:15], s47 offen offset:2048 sc1
    s_mov_b64 exec, 0xffff
    buffer_store_dwordx2 v[198:199], v11, s[12:15], s46 offen sc1
    s_mov_b64 exec, -1
    s_waitcnt vmcnt(0)
    v_mov_b32 v9, 1
    v_mov_b32 v10, 4352
    s_mov_b64 exec, 1
    buffer_store_dword v9, v10, s[12:15], s49 offen sc1
    s_mov_b64 exec, -1
k2_kernel_sent27:
    s_lshl_b32 s46, s34, 3
    s_lshl_b32 s47, s30, 1
    s_add_u32 s46, s46, s47
    s_lshl_b32 s49, s46, 7
    s_add_u32 s49, s49, 4352
    v_bfe_u32 v7, v1, 3, 1
    v_lshlrev_b32 v7, 7, v7
    v_and_b32 v9, 7, v1
    v_lshl_add_u32 v7, v9, 2, v7
    v_add_u32 v7, s49, v7
    s_sub_u32 s49, s55, s37
    s_add_u32 s49, s49, 128
    v_and_b32 v9, 3, v1
    v_lshlrev_b32 v9, 2, v9
    v_add_u32 v9, s49, v9
    v_and_b32 v10, 16, v1
    v_cmp_ne_u32 vcc, 0, v10
    v_mov_b32 v11, 1
    v_mov_b32 v10, 3
    v_cndmask_b32 v7, v7, v9, vcc
    v_cndmask_b32 v10, v11, v10, vcc
    s_mov_b32 s43, 200000
k2_kernel_poll28:
    buffer_load_dword v9, v7, s[12:15], s37 offen sc1
    s_waitcnt vmcnt(0)
    v_cmp_le_u32 vcc, v10, v9
    s_sub_u32 s43, s43, 1
    s_cmp_eq_u64 vcc, -1
    s_cbranch_scc1 k2_kernel_go29
    s_cmp_lg_u32 s43, 0
    s_cbranch_scc1 k2_kernel_poll28
k2_kernel_go29:
    s_mul_i32 s47, s46, 20480
    s_add_u32 s47, s47, s36
    s_add_u32 s47, s47, 20480
    s_add_u32 s48, s47, 20480
    s_add_u32 s41, s47, 0
    buffer_load_dwordx4 v[72:75], v2, s[12:15], s41 offen offset:0 sc1
    s_add_u32 s41, s48, 0
    buffer_load_dwordx4 v[76:79], v2, s[12:15], s41 offen offset:0 sc1
    s_add_u32 s41, s47, 0
    buffer_load_dwordx4 v[80:83], v2, s[12:15], s41 offen offset:1024 sc1
    s_add_u32 s41, s48, 0
    buffer_load_dwordx4 v[84:87], v2, s[12:15], s41 offen offset:1024 sc1
    s_add_u32 s41, s47, 0
    buffer_load_dwordx4 v[88:91], v2, s[12:15], s41 offen offset:2048 sc1
    s_add_u32 s41, s48, 0
    buffer_load_dwordx4 v[92:95], v2, s[12:15], s41 offen offset:2048 sc1
    v_lshlrev_b32 v9, 6, v4
    v_lshl_add_u32 v9, v3, 4, v9
    s_lshl_b32 s41, s46, 10
    s_add_u32 s41, s41, s36
    s_add_u32 s41, s41, 1581056
    buffer_load_dwordx4 v[216:219], v9, s[12:15], s41 offen offset:0 sc1
    buffer_load_dwordx4 v[220:223], v9, s[12:15], s41 offen offset:1024 sc1
    s_mul_i32 s52, s46, 55296
    s_mul_i32 s41, s35, 3584
    s_add_u32 s52, s52, s41
    s_add_u32 s52, s52, s36
    s_add_u32 s52, s52, 696320
    s_add_u32 s53, s52, 55296
    s_barrier
    v_add_u32 v11, 0x20000, v2
    ds_read_b128 v[160:163], v14 offset:49152
    ds_read_b128 v[164:167], v14 offset:50176
    ds_read_b128 v[168:171], v14 offset:51200
    ds_read_b128 v[172:175], v14 offset:52224
    ds_read_b128 v[176:179], v14 offset:53248
    ds_read_b128 v[180:183], v14 offset:54272
    ds_read_b128 v[184:187], v14 offset:55296
    s_waitcnt vmcnt(6)
    s_waitcnt lgkmcnt(6)
    v_mfma_f32_16x16x32_bf16 v[16:19], v[160:163], v[72:75], 0
    v_mfma_f32_16x16x32_bf16 v[44:47], v[160:163], v[76:79], 0
    ds_read_b128 v[188:191], v14 offset:56320
    s_waitcnt lgkmcnt(6)
    v_mfma_f32_16x16x32_bf16 v[20:23], v[164:167], v[72:75], 0
    v_mfma_f32_16x16x32_bf16 v[48:51], v[164:167], v[76:79], 0
    ds_read_b128 v[192:195], v14 offset:57344
    s_add_u32 s41, s47, 0
    buffer_load_dwordx4 v[96:99], v2, s[12:15], s41 offen offset:3072 sc1
    s_add_u32 s41, s48, 0
    buffer_load_dwordx4 v[100:103], v2, s[12:15], s41 offen offset:3072 sc1
    s_waitcnt lgkmcnt(6)
    v_mfma_f32_16x16x32_bf16 v[24:27], v[168:171], v[72:75], 0
    v_mfma_f32_16x16x32_bf16 v[52:55], v[168:171], v[76:79], 0
    ds_read_b128 v[196:199], v14 offset:58368
    s_waitcnt lgkmcnt(6)
    v_mfma_f32_16x16x32_bf16 v[28:31], v[172:175], v[72:75], 0
    v_mfma_f32_16x16x32_bf16 v[56:59], v[172:175], v[76:79], 0
    ds_read_b128 v[200:203], v14 offset:59392
    s_waitcnt lgkmcnt(6)
    v_mfma_f32_16x16x32_bf16 v[32:35], v[176:179], v[72:75], 0
    v_mfma_f32_16x16x32_bf16 v[60:63], v[176:179], v[76:79], 0
    ds_read_b128 v[204:207], v14 offset:60416
    s_add_u32 s41, s47, 4096
    buffer_load_dwordx4 v[104:107], v2, s[12:15], s41 offen offset:0 sc1
    s_add_u32 s41, s48, 4096
    buffer_load_dwordx4 v[108:111], v2, s[12:15], s41 offen offset:0 sc1
    s_waitcnt lgkmcnt(6)
    v_mfma_f32_16x16x32_bf16 v[36:39], v[180:183], v[72:75], 0
    v_mfma_f32_16x16x32_bf16 v[64:67], v[180:183], v[76:79], 0
    ds_read_b128 v[208:211], v14 offset:61440
    s_waitcnt lgkmcnt(6)
    v_mfma_f32_16x16x32_bf16 v[40:43], v[184:187], v[72:75], 0
    v_mfma_f32_16x16x32_bf16 v[68:71], v[184:187], v[76:79], 0
    ds_read_b128 v[212:215], v14 offset:62464
    s_waitcnt vmcnt(8)
    s_waitcnt lgkmcnt(6)
    v_mfma_f32_16x16x32_bf16 v[16:19], v[188:191], v[80:83], v[16:19]
    v_mfma_f32_16x16x32_bf16 v[44:47], v[188:191], v[84:87], v[44:47]
    ds_read_b128 v[160:163], v14 offset:63488
    s_waitcnt lgkmcnt(6)
    v_mfma_f32_16x16x32_bf16 v[20:23], v[192:195], v[80:83], v[20:23]
    v_mfma_f32_16x16x32_bf16 v[48:51], v[192:195], v[84:87], v[48:51]
    ds_read_b128 v[164:167], v14 offset:64512
    s_add_u32 s41, s47, 4096
    buffer_load_dwordx4 v[112:115], v2, s[12:15], s41 offen offset:1024 sc1
    s_add_u32 s41, s48, 4096
    buffer_load_dwordx4 v[116:119], v2, s[12:15], s41 offen offset:1024 sc1
    s_waitcnt lgkmcnt(6)
    v_mfma_f32_16x16x32_bf16 v[24:27], v[196:199], v[80:83], v[24:27]
    v_mfma_f32_16x16x32_bf16 v[52:55], v[196:199], v[84:87], v[52:55]
    ds_read_b128 v[168:171], v15 offset:0
    buffer_load_dwordx4 a[0:3], v2, s[12:15], s40 offen offset:0
    s_waitcnt lgkmcnt(6)
    v_mfma_f32_16x16x32_bf16 v[28:31], v[200:203], v[80:83], v[28:31]
    v_mfma_f32_16x16x32_bf16 v[56:59], v[200:203], v[84:87], v[56:59]
    ds_read_b128 v[172:175], v15 offset:1024
    buffer_load_dwordx4 a[4:7], v2, s[12:15], s40 offen offset:1024
    s_waitcnt lgkmcnt(6)
    v_mfma_f32_16x16x32_bf16 v[32:35], v[204:207], v[80:83], v[32:35]
    v_mfma_f32_16x16x32_bf16 v[60:63], v[204:207], v[84:87], v[60:63]
    ds_read_b128 v[176:179], v15 offset:2048
    s_add_u32 s41, s47, 4096
    buffer_load_dwordx4 v[120:123], v2, s[12:15], s41 offen offset:2048 sc1
    s_add_u32 s41, s48, 4096
    buffer_load_dwordx4 v[124:127], v2, s[12:15], s41 offen offset:2048 sc1
    s_waitcnt lgkmcnt(6)
    v_mfma_f32_16x16x32_bf16 v[36:39], v[208:211], v[80:83], v[36:39]
    v_mfma_f32_16x16x32_bf16 v[64:67], v[208:211], v[84:87], v[64:67]
    ds_read_b128 v[180:183], v15 offset:3072
    buffer_load_dwordx4 a[8:11], v2, s[12:15], s40 offen offset:2048
    s_waitcnt lgkmcnt(6)
    v_mfma_f32_16x16x32_bf16 v[40:43], v[212:215], v[80:83], v[40:43]
    v_mfma_f32_16x16x32_bf16 v[68:71], v[212:215], v[84:87], v[68:71]
    ds_read_b128 v[184:187], v15 offset:4096
    s_waitcnt vmcnt(13)
    s_waitcnt lgkmcnt(6)
    v_mfma_f32_16x16x32_bf16 v[16:19], v[160:163], v[88:91], v[16:19]
    v_mfma_f32_16x16x32_bf16 v[44:47], v[160:163], v[92:95], v[44:47]
    ds_read_b128 v[188:191], v15 offset:5120
    s_waitcnt lgkmcnt(6)
    v_mfma_f32_16x16x32_bf16 v[20:23], v[164:167], v[88:91], v[20:23]
    v_mfma_f32_16x16x32_bf16 v[48:51], v[164:167], v[92:95], v[48:51]
    ds_read_b128 v[192:195], v15 offset:6144
    s_add_u32 s41, s47, 4096
    buffer_load_dwordx4 v[128:131], v2, s[12:15], s41 offen offset:3072 sc1
    s_add_u32 s41, s48, 4096
    buffer_load_dwordx4 v[132:135], v2, s[12:15], s41 offen offset:3072 sc1
    s_waitcnt lgkmcnt(6)
    v_mfma_f32_16x16x32_bf16 v[24:27], v[168:171], v[88:91], v[24:27]
    v_mfma_f32_16x16x32_bf16 v[52:55], v[168:171], v[92:95], v[52:55]
    ds_read_b128 v[196:199], v15 offset:7168
    buffer_load_dwordx4 a[12:15], v2, s[12:15], s40 offen offset:3072
    s_add_u32 s40, s40, 4096
    s_waitcnt lgkmcnt(6)
    v_mfma_f32_16x16x32_bf16 v[28:31], v[172:175], v[88:91], v[28:31]
    v_mfma_f32_16x16x32_bf16 v[56:59], v[172:175], v[92:95], v[56:59]
    ds_read_b128 v[200:203], v15 offset:8192
    buffer_load_dwordx4 a[16:19], v2, s[12:15], s40 offen offset:0
    s_waitcnt lgkmcnt(6)
    v_mfma_f32_16x16x32_bf16 v[32:35], v[176:179], v[88:91], v[32:35]
    v_mfma_f32_16x16x32_bf16 v[60:63], v[176:179], v[92:95], v[60:63]
    ds_read_b128 v[204:207], v15 offset:9216
    s_add_u32 s41, s47, 8192
    buffer_load_dwordx4 v[136:139], v2, s[12:15], s41 offen offset:0 sc1
    s_add_u32 s41, s48, 8192
    buffer_load_dwordx4 v[140:143], v2, s[12:15], s41 offen offset:0 sc1
    s_waitcnt lgkmcnt(6)
    v_mfma_f32_16x16x32_bf16 v[36:39], v[180:183], v[88:91], v[36:39]
    v_mfma_f32_16x16x32_bf16 v[64:67], v[180:183], v[92:95], v[64:67]
    ds_read_b128 v[208:211], v15 offset:10240
    buffer_load_dwordx4 a[20:23], v2, s[12:15], s40 offen offset:1024
    s_waitcnt lgkmcnt(6)
    v_mfma_f32_16x16x32_bf16 v[40:43], v[184:187], v[88:91], v[40:43]
    v_mfma_f32_16x16x32_bf16 v[68:71], v[184:187], v[92:95], v[68:71]
    ds_read_b128 v[212:215], v15 offset:11264
    s_waitcnt vmcnt(16)
    s_waitcnt lgkmcnt(6)
    v_mfma_f32_16x16x32_bf16 v[16:19], v[188:191], v[96:99], v[16:19]
    v_mfma_f32_16x16x32_bf16 v[44:47], v[188:191], v[100:103], v[44:47]
    ds_read_b128 v[160:163], v15 offset:12288
    s_waitcnt lgkmcnt(6)
    v_mfma_f32_16x16x32_bf16 v[20:23], v[192:195], v[96:99], v[20:23]
    v_mfma_f32_16x16x32_bf16 v[48:51], v[192:195], v[100:103], v[48:51]
    ds_read_b128 v[164:167], v15 offset:13312
    s_add_u32 s41, s47, 8192
    buffer_load_dwordx4 v[144:147], v2, s[12:15], s41 offen offset:1024 sc1
    s_add_u32 s41, s48, 8192
    buffer_load_dwordx4 v[148:151], v2, s[12:15], s41 offen offset:1024 sc1
    s_waitcnt lgkmcnt(6)
    v_mfma_f32_16x16x32_bf16 v[24:27], v[196:199], v[96:99], v[24:27]
    v_mfma_f32_16x16x32_bf16 v[52:55], v[196:199], v[100:103], v[52:55]
    ds_read_b128 v[168:171], v15 offset:14336
    buffer_load_dwordx4 a[24:27], v2, s[12:15], s40 offen offset:2048
    s_waitcnt lgkmcnt(6)
    v_mfma_f32_16x16x32_bf16 v[28:31], v[200:203], v[96:99], v[28:31]
    v_mfma_f32_16x16x32_bf16 v[56:59], v[200:203], v[100:103], v[56:59]
    ds_read_b128 v[172:175], v15 offset:15360
    buffer_load_dwordx4 a[28:31], v2, s[12:15], s40 offen offset:3072
    s_add_u32 s40, s40, 4096
    s_waitcnt lgkmcnt(6)
    v_mfma_f32_16x16x32_bf16 v[32:35], v[204:207], v[96:99], v[32:35]
    v_mfma_f32_16x16x32_bf16 v[60:63], v[204:207], v[100:103], v[60:63]
    ds_read_b128 v[176:179], v15 offset:16384
    s_waitcnt lgkmcnt(6)
    v_mfma_f32_16x16x32_bf16 v[36:39], v[208:211], v[96:99], v[36:39]
    v_mfma_f32_16x16x32_bf16 v[64:67], v[208:211], v[100:103], v[64:67]
    ds_read_b128 v[180:183], v15 offset:17408
    buffer_load_dwordx4 a[32:35], v2, s[12:15], s40 offen offset:0
    s_waitcnt lgkmcnt(6)
    v_mfma_f32_16x16x32_bf16 v[40:43], v[212:215], v[96:99], v[40:43]
    v_mfma_f32_16x16x32_bf16 v[68:71], v[212:215], v[100:103], v[68:71]
    ds_read_b128 v[184:187], v15 offset:18432
    s_waitcnt vmcnt(19)
    s_waitcnt lgkmcnt(6)
    v_mfma_f32_16x16x32_bf16 v[16:19], v[160:163], v[104:107], v[16:19]
    v_mfma_f32_16x16x32_bf16 v[44:47], v[160:163], v[108:111], v[44:47]
    ds_read_b128 v[188:191], v15 offset:19456
    s_waitcnt lgkmcnt(6)
    v_mfma_f32_16x16x32_bf16 v[20:23], v[164:167], v[104:107], v[20:23]
    v_mfma_f32_16x16x32_bf16 v[48:51], v[164:167], v[108:111], v[48:51]
    ds_read_b128 v[192:195], v15 offset:20480
    s_add_u32 s41, s47, 8192
    buffer_load_dwordx4 v[152:155], v2, s[12:15], s41 offen offset:2048 sc1
    s_add_u32 s41, s48, 8192
    buffer_load_dwordx4 v[156:159], v2, s[12:15], s41 offen offset:2048 sc1
    s_waitcnt lgkmcnt(6)
    v_mfma_f32_16x16x32_bf16 v[24:27], v[168:171], v[104:107], v[24:27]
    v_mfma_f32_16x16x32_bf16 v[52:55], v[168:171], v[108:111], v[52:55]
    ds_read_b128 v[196:199], v15 offset:21504
    buffer_load_dwordx4 a[36:39], v2, s[12:15], s40 offen offset:1024
    s_waitcnt lgkmcnt(6)
    v_mfma_f32_16x16x32_bf16 v[28:31], v[172:175], v[104:107], v[28:31]
    v_mfma_f32_16x16x32_bf16 v[56:59], v[172:175], v[108:111], v[56:59]
    ds_read_b128 v[200:203], v15 offset:22528
    buffer_load_dwordx4 a[40:43], v2, s[12:15], s40 offen offset:2048
    s_waitcnt lgkmcnt(6)
    v_mfma_f32_16x16x32_bf16 v[32:35], v[176:179], v[104:107], v[32:35]
    v_mfma_f32_16x16x32_bf16 v[60:63], v[176:179], v[108:111], v[60:63]
    ds_read_b128 v[204:207], v15 offset:23552
    s_waitcnt lgkmcnt(6)
    v_mfma_f32_16x16x32_bf16 v[36:39], v[180:183], v[104:107], v[36:39]
    v_mfma_f32_16x16x32_bf16 v[64:67], v[180:183], v[108:111], v[64:67]
    ds_read_b128 v[208:211], v15 offset:24576
    buffer_load_dwordx4 a[44:47], v2, s[12:15], s40 offen offset:3072
    s_add_u32 s40, s40, 4096
    s_waitcnt lgkmcnt(6)
    v_mfma_f32_16x16x32_bf16 v[40:43], v[184:187], v[104:107], v[40:43]
    v_mfma_f32_16x16x32_bf16 v[68:71], v[184:187], v[108:111], v[68:71]
    ds_read_b128 v[212:215], v15 offset:25600
    s_waitcnt vmcnt(22)
    s_waitcnt lgkmcnt(6)
    v_mfma_f32_16x16x32_bf16 v[16:19], v[188:191], v[112:115], v[16:19]
    v_mfma_f32_16x16x32_bf16 v[44:47], v[188:191], v[116:119], v[44:47]
    ds_read_b128 v[160:163], v15 offset:26624
    v_add_f32 v224, v216, v218
    v_add_f32 v225, v217, v219
    s_waitcnt lgkmcnt(6)
    v_mfma_f32_16x16x32_bf16 v[20:23], v[192:195], v[112:115], v[20:23]
    v_mfma_f32_16x16x32_bf16 v[48:51], v[192:195], v[116:119], v[48:51]
    ds_read_b128 v[164:167], v15 offset:27648
    s_add_u32 s41, s47, 8192
    buffer_load_dwordx4 v[72:75], v2, s[12:15], s41 offen offset:3072 sc1
    s_add_u32 s41, s48, 8192
    buffer_load_dwordx4 v[76:79], v2, s[12:15], s41 offen offset:3072 sc1
    v_mov_b32 v216, v224
    v_mov_b32 v217, v225
    s_waitcnt lgkmcnt(6)
    v_mfma_f32_16x16x32_bf16 v[24:27], v[196:199], v[112:115], v[24:27]
    v_mfma_f32_16x16x32_bf16 v[52:55], v[196:199], v[116:119], v[52:55]
    ds_read_b128 v[168:171], v15 offset:28672
    buffer_load_dwordx4 a[48:51], v2, s[12:15], s40 offen offset:0
    s_nop 1
    v_permlane32_swap_b32 v216, v224
    s_waitcnt lgkmcnt(6)
    v_mfma_f32_16x16x32_bf16 v[28:31], v[200:203], v[112:115], v[28:31]
    v_mfma_f32_16x16x32_bf16 v[56:59], v[200:203], v[116:119], v[56:59]
    ds_read_b128 v[172:175], v15 offset:29696
    buffer_load_dwordx4 a[52:55], v2, s[12:15], s40 offen offset:1024
    v_permlane32_swap_b32 v217, v225
    s_nop 0
    s_waitcnt lgkmcnt(6)
    v_mfma_f32_16x16x32_bf16 v[32:35], v[204:207], v[112:115], v[32:35]
    v_mfma_f32_16x16x32_bf16 v[60:63], v[204:207], v[116:119], v[60:63]
    ds_read_b128 v[176:179], v15 offset:30720
    v_add_f32 v224, v224, v216
    v_add_f32 v225, v225, v217
    s_waitcnt lgkmcnt(6)
    v_mfma_f32_16x16x32_bf16 v[36:39], v[208:211], v[112:115], v[36:39]
    v_mfma_f32_16x16x32_bf16 v[64:67], v[208:211], v[116:119], v[64:67]
    ds_read_b128 v[180:183], v15 offset:31744
    buffer_load_dwordx4 a[56:59], v2, s[12:15], s40 offen offset:2048
    v_mov_b32 v216, v224
    v_mov_b32 v217, v225
    s_waitcnt lgkmcnt(6)
    v_mfma_f32_16x16x32_bf16 v[40:43], v[212:215], v[112:115], v[40:43]
    v_mfma_f32_16x16x32_bf16 v[68:71], v[212:215], v[116:119], v[68:71]
    ds_read_b128 v[184:187], v15 offset:32768
    s_nop 1
    v_permlane16_swap_b32 v216, v224
    s_waitcnt vmcnt(23)
    s_waitcnt lgkmcnt(6)
    v_mfma_f32_16x16x32_bf16 v[16:19], v[160:163], v[120:123], v[16:19]
    v_mfma_f32_16x16x32_bf16 v[44:47], v[160:163], v[124:127], v[44:47]
    ds_read_b128 v[188:191], v15 offset:33792
    v_permlane16_swap_b32 v217, v225
    s_nop 0
    s_waitcnt lgkmcnt(6)
    v_mfma_f32_16x16x32_bf16 v[20:23], v[164:167], v[120:123], v[20:23]
    v_mfma_f32_16x16x32_bf16 v[48:51], v[164:167], v[124:127], v[48:51]
    ds_read_b128 v[192:195], v15 offset:34816
    s_add_u32 s41, s47, 12288
    buffer_load_dwordx4 v[80:83], v2, s[12:15], s41 offen offset:0 sc1
    s_add_u32 s41, s48, 12288
    buffer_load_dwordx4 v[84:87], v2, s[12:15], s41 offen offset:0 sc1
    v_add_f32 v224, v224, v216
    v_add_f32 v225, v225, v217
    s_waitcnt lgkmcnt(6)
    v_mfma_f32_16x16x32_bf16 v[24:27], v[168:171], v[120:123], v[24:27]
    v_mfma_f32_16x16x32_bf16 v[52:55], v[168:171], v[124:127], v[52:55]
    ds_read_b128 v[196:199], v15 offset:35840
    buffer_load_dwordx4 a[60:63], v2, s[12:15], s40 offen offset:3072
    s_add_u32 s40, s40, 4096
    v_mul_f32 v224, 0x3acccccd, v224
    v_mul_f32 v225, 0x3acccccd, v225
    s_waitcnt lgkmcnt(6)
    v_mfma_f32_16x16x32_bf16 v[28:31], v[172:175], v[120:123], v[28:31]
    v_mfma_f32_16x16x32_bf16 v[56:59], v[172:175], v[124:127], v[56:59]
    ds_read_b128 v[200:203], v15 offset:36864
    buffer_load_dwordx4 a[64:67], v2, s[12:15], s40 offen offset:0
    v_fma_f32 v225, -v224, v224, v225
    v_max_f32 v225, 0, v225
    s_waitcnt lgkmcnt(6)
    v_mfma_f32_16x16x32_bf16 v[32:35], v[176:179], v[120:123], v[32:35]
    v_mfma_f32_16x16x32_bf16 v[60:63], v[176:179], v[124:127], v[60:63]
    ds_read_b128 v[204:207], v15 offset:37888
    v_cvt_pk_bf16_f32 v216, v224, v225
    v_lshlrev_b32 v224, 16, v216
    s_waitcnt lgkmcnt(6)
    v_mfma_f32_16x16x32_bf16 v[36:39], v[180:183], v[120:123], v[36:39]
    v_mfma_f32_16x16x32_bf16 v[64:67], v[180:183], v[124:127], v[64:67]
    ds_read_b128 v[208:211], v15 offset:38912
    buffer_load_dwordx4 a[68:71], v2, s[12:15], s40 offen offset:1024
    v_and_b32 v225, 0xffff0000, v216
    v_add_f32 v225, 0x3727c5ac, v225
    s_waitcnt lgkmcnt(6)
    v_mfma_f32_16x16x32_bf16 v[40:43], v[184:187], v[120:123], v[40:43]
    v_mfma_f32_16x16x32_bf16 v[68:71], v[184:187], v[124:127], v[68:71]
    ds_read_b128 v[212:215], v15 offset:39936
    v_cvt_pk_bf16_f32 v216, v225, v225
    v_lshlrev_b32 v225, 16, v216
    s_waitcnt vmcnt(25)
    s_waitcnt lgkmcnt(6)
    v_mfma_f32_16x16x32_bf16 v[16:19], v[188:191], v[128:131], v[16:19]
    v_mfma_f32_16x16x32_bf16 v[44:47], v[188:191], v[132:135], v[44:47]
    ds_read_b128 v[160:163], v15 offset:40960
    v_sqrt_f32 v225, v225
    s_nop 0
    s_waitcnt lgkmcnt(6)
    v_mfma_f32_16x16x32_bf16 v[20:23], v[192:195], v[128:131], v[20:23]
    v_mfma_f32_16x16x32_bf16 v[48:51], v[192:195], v[132:135], v[48:51]
    ds_read_b128 v[164:167], v15 offset:41984
    s_add_u32 s41, s47, 12288
    buffer_load_dwordx4 v[88:91], v2, s[12:15], s41 offen offset:1024 sc1
    s_add_u32 s41, s48, 12288
    buffer_load_dwordx4 v[92:95], v2, s[12:15], s41 offen offset:1024 sc1
    v_cvt_pk_bf16_f32 v216, v225, v225
    v_lshlrev_b32 v225, 16, v216
    s_waitcnt lgkmcnt(6)
    v_mfma_f32_16x16x32_bf16 v[24:27], v[196:199], v[128:131], v[24:27]
    v_mfma_f32_16x16x32_bf16 v[52:55], v[196:199], v[132:135], v[52:55]
    ds_read_b128 v[168:171], v15 offset:43008
    buffer_load_dwordx4 a[72:75], v2, s[12:15], s40 offen offset:2048
    v_rcp_f32 v225, v225
    s_nop 0
    s_waitcnt lgkmcnt(6)
    v_mfma_f32_16x16x32_bf16 v[28:31], v[200:203], v[128:131], v[28:31]
    v_mfma_f32_16x16x32_bf16 v[56:59], v[200:203], v[132:135], v[56:59]
    ds_read_b128 v[172:175], v15 offset:44032
    buffer_load_dwordx4 a[76:79], v2, s[12:15], s40 offen offset:3072
    s_add_u32 s40, s40, 4096
    v_mul_f32 v224, v224, v225
    v_sub_f32 v224, 0, v224
    s_waitcnt lgkmcnt(6)
    v_mfma_f32_16x16x32_bf16 v[32:35], v[204:207], v[128:131], v[32:35]
    v_mfma_f32_16x16x32_bf16 v[60:63], v[204:207], v[132:135], v[60:63]
    ds_read_b128 v[176:179], v15 offset:45056
    v_add_f32 v226, v220, v222
    v_add_f32 v227, v221, v223
    s_waitcnt lgkmcnt(6)
    v_mfma_f32_16x16x32_bf16 v[36:39], v[208:211], v[128:131], v[36:39]
    v_mfma_f32_16x16x32_bf16 v[64:67], v[208:211], v[132:135], v[64:67]
    ds_read_b128 v[180:183], v15 offset:46080
    buffer_load_dwordx4 a[80:83], v2, s[12:15], s40 offen offset:0
    v_mov_b32 v216, v226
    v_mov_b32 v217, v227
    s_waitcnt lgkmcnt(6)
    v_mfma_f32_16x16x32_bf16 v[40:43], v[212:215], v[128:131], v[40:43]
    v_mfma_f32_16x16x32_bf16 v[68:71], v[212:215], v[132:135], v[68:71]
    ds_read_b128 v[184:187], v15 offset:47104
    s_nop 1
    v_permlane32_swap_b32 v216, v226
    s_waitcnt vmcnt(26)
    s_waitcnt lgkmcnt(6)
    v_mfma_f32_16x16x32_bf16 v[16:19], v[160:163], v[136:139], v[16:19]
    v_mfma_f32_16x16x32_bf16 v[44:47], v[160:163], v[140:143], v[44:47]
    ds_read_b128 v[188:191], v15 offset:48128
    v_permlane32_swap_b32 v217, v227
    s_nop 0
    s_waitcnt lgkmcnt(6)
    v_mfma_f32_16x16x32_bf16 v[20:23], v[164:167], v[136:139], v[20:23]
    v_mfma_f32_16x16x32_bf16 v[48:51], v[164:167], v[140:143], v[48:51]
    ds_read_b128 v[192:195], v15 offset:49152
    s_add_u32 s41, s47, 12288
    buffer_load_dwordx4 v[96:99], v2, s[12:15], s41 offen offset:2048 sc1
    s_add_u32 s41, s48, 12288
    buffer_load_dwordx4 v[100:103], v2, s[12:15], s41 offen offset:2048 sc1
    v_add_f32 v226, v226, v216
    v_add_f32 v227, v227, v217
    s_waitcnt lgkmcnt(6)
    v_mfma_f32_16x16x32_bf16 v[24:27], v[168:171], v[136:139], v[24:27]
    v_mfma_f32_16x16x32_bf16 v[52:55], v[168:171], v[140:143], v[52:55]
    ds_read_b128 v[196:199], v15 offset:50176
    buffer_load_dwordx4 a[84:87], v2, s[12:15], s40 offen offset:1024
    v_mov_b32 v216, v226
    v_mov_b32 v217, v227
    s_waitcnt lgkmcnt(6)
    v_mfma_f32_16x16x32_bf16 v[28:31], v[172:175], v[136:139], v[28:31]
    v_mfma_f32_16x16x32_bf16 v[56:59], v[172:175], v[140:143], v[56:59]
    ds_read_b128 v[200:203], v15 offset:51200
    buffer_load_dwordx4 a[88:91], v2, s[12:15], s40 offen offset:2048
    s_nop 1
    v_permlane16_swap_b32 v216, v226
    s_waitcnt lgkmcnt(6)
    v_mfma_f32_16x16x32_bf16 v[32:35], v[176:179], v[136:139], v[32:35]
    v_mfma_f32_16x16x32_bf16 v[60:63], v[176:179], v[140:143], v[60:63]
    ds_read_b128 v[204:207], v15 offset:52224
    v_permlane16_swap_b32 v217, v227
    s_nop 0
    s_waitcnt lgkmcnt(6)
    v_mfma_f32_16x16x32_bf16 v[36:39], v[180:183], v[136:139], v[36:39]
    v_mfma_f32_16x16x32_bf16 v[64:67], v[180:183], v[140:143], v[64:67]
    ds_read_b128 v[208:211], v15 offset:53248
    buffer_load_dwordx4 a[92:95], v2, s[12:15], s40 offen offset:3072
    s_add_u32 s40, s40, 4096
    v_add_f32 v226, v226, v216
    v_add_f32 v227, v227, v217
    s_waitcnt lgkmcnt(6)
    v_mfma_f32_16x16x32_bf16 v[40:43], v[184:187], v[136:139], v[40:43]
    v_mfma_f32_16x16x32_bf16 v[68:71], v[184:187], v[140:143], v[68:71]
    ds_read_b128 v[212:215], v15 offset:54272
    v_mul_f32 v226, 0x3acccccd, v226
    v_mul_f32 v227, 0x3acccccd, v227
    s_waitcnt vmcnt(28)
    s_waitcnt lgkmcnt(6)
    v_mfma_f32_16x16x32_bf16 v[16:19], v[188:191], v[144:147], v[16:19]
    v_mfma_f32_16x16x32_bf16 v[44:47], v[188:191], v[148:151], v[44:47]
    ds_read_b128 v[160:163], v15 offset:55296
    v_fma_f32 v227, -v226, v226, v227
    v_max_f32 v227, 0, v227
    s_waitcnt lgkmcnt(6)
    v_mfma_f32_16x16x32_bf16 v[20:23], v[192:195], v[144:147], v[20:23]
    v_mfma_f32_16x16x32_bf16 v[48:51], v[192:195], v[148:151], v[48:51]
    ds_read_b128 v[164:167], v15 offset:56320
    s_add_u32 s41, s47, 12288
    buffer_load_dwordx4 v[104:107], v2, s[12:15], s41 offen offset:3072 sc1
    s_add_u32 s41, s48, 12288
    buffer_load_dwordx4 v[108:111], v2, s[12:15], s41 offen offset:3072 sc1
    v_cvt_pk_bf16_f32 v216, v226, v227
    v_lshlrev_b32 v226, 16, v216
    s_waitcnt lgkmcnt(6)
    v_mfma_f32_16x16x32_bf16 v[24:27], v[196:199], v[144:147], v[24:27]
    v_mfma_f32_16x16x32_bf16 v[52:55], v[196:199], v[148:151], v[52:55]
    ds_read_b128 v[168:171], v15 offset:57344
    buffer_load_dwordx4 a[96:99], v2, s[12:15], s40 offen offset:0
    v_and_b32 v227, 0xffff0000, v216
    v_add_f32 v227, 0x3727c5ac, v227
    s_waitcnt lgkmcnt(6)
    v_mfma_f32_16x16x32_bf16 v[28:31], v[200:203], v[144:147], v[28:31]
    v_mfma_f32_16x16x32_bf16 v[56:59], v[200:203], v[148:151], v[56:59]
    ds_read_b128 v[172:175], v15 offset:58368
    buffer_load_dwordx4 a[100:103], v2, s[12:15], s40 offen offset:1024
    v_cvt_pk_bf16_f32 v216, v227, v227
    v_lshlrev_b32 v227, 16, v216
    s_waitcnt lgkmcnt(6)
    v_mfma_f32_16x16x32_bf16 v[32:35], v[204:207], v[144:147], v[32:35]
    v_mfma_f32_16x16x32_bf16 v[60:63], v[204:207], v[148:151], v[60:63]
    ds_read_b128 v[176:179], v15 offset:59392
    v_sqrt_f32 v227, v227
    s_nop 0
    s_waitcnt lgkmcnt(6)
    v_mfma_f32_16x16x32_bf16 v[36:39], v[208:211], v[144:147], v[36:39]
    v_mfma_f32_16x16x32_bf16 v[64:67], v[208:211], v[148:151], v[64:67]
    ds_read_b128 v[180:183], v15 offset:60416
    buffer_load_dwordx4 a[104:107], v2, s[12:15], s40 offen offset:2048
    v_cvt_pk_bf16_f32 v216, v227, v227
    v_lshlrev_b32 v227, 16, v216
    s_waitcnt lgkmcnt(6)
    v_mfma_f32_16x16x32_bf16 v[40:43], v[212:215], v[144:147], v[40:43]
    v_mfma_f32_16x16x32_bf16 v[68:71], v[212:215], v[148:151], v[68:71]
    ds_read_b128 v[184:187], v15 offset:61440
    v_rcp_f32 v227, v227
    s_nop 0
    s_waitcnt vmcnt(28)
    s_waitcnt lgkmcnt(6)
    v_mfma_f32_16x16x32_bf16 v[16:19], v[160:163], v[152:155], v[16:19]
    v_mfma_f32_16x16x32_bf16 v[44:47], v[160:163], v[156:159], v[44:47]
    ds_read_b128 v[188:191], v15 offset:62464
    v_mul_f32 v226, v226, v227
    v_sub_f32 v226, 0, v226
    s_waitcnt lgkmcnt(6)
    v_mfma_f32_16x16x32_bf16 v[20:23], v[164:167], v[152:155], v[20:23]
    v_mfma_f32_16x16x32_bf16 v[48:51], v[164:167], v[156:159], v[48:51]
    ds_read_b128 v[192:195], v15 offset:63488
    s_add_u32 s41, s47, 16384
    buffer_load_dwordx4 v[112:115], v2, s[12:15], s41 offen offset:0 sc1
    s_add_u32 s41, s48, 16384
    buffer_load_dwordx4 v[116:119], v2, s[12:15], s41 offen offset:0 sc1
    s_waitcnt lgkmcnt(6)
    v_mfma_f32_16x16x32_bf16 v[24:27], v[168:171], v[152:155], v[24:27]
    v_mfma_f32_16x16x32_bf16 v[52:55], v[168:171], v[156:159], v[52:55]
    ds_read_b128 v[196:199], v15 offset:64512
    buffer_load_dwordx4 a[108:111], v2, s[12:15], s40 offen offset:3072
    s_add_u32 s40, s40, 4096
    s_waitcnt lgkmcnt(6)
    v_mfma_f32_16x16x32_bf16 v[28:31], v[172:175], v[152:155], v[28:31]
    v_mfma_f32_16x16x32_bf16 v[56:59], v[172:175], v[156:159], v[56:59]
    ds_read_b128 v[200:203], v11 offset:0
    buffer_load_dwordx4 a[112:115], v2, s[12:15], s40 offen offset:0
    s_waitcnt lgkmcnt(6)
    v_mfma_f32_16x16x32_bf16 v[32:35], v[176:179], v[152:155], v[32:35]
    v_mfma_f32_16x16x32_bf16 v[60:63], v[176:179], v[156:159], v[60:63]
    ds_read_b128 v[204:207], v11 offset:1024
    s_waitcnt lgkmcnt(6)
    v_mfma_f32_16x16x32_bf16 v[36:39], v[180:183], v[152:155], v[36:39]
    v_mfma_f32_16x16x32_bf16 v[64:67], v[180:183], v[156:159], v[64:67]
    ds_read_b128 v[208:211], v11 offset:2048
    buffer_load_dwordx4 a[116:119], v2, s[12:15], s40 offen offset:1024
    s_waitcnt lgkmcnt(6)
    v_mfma_f32_16x16x32_bf16 v[40:43], v[184:187], v[152:155], v[40:43]
    v_mfma_f32_16x16x32_bf16 v[68:71], v[184:187], v[156:159], v[68:71]
    ds_read_b128 v[212:215], v11 offset:3072
    s_waitcnt vmcnt(28)
    s_waitcnt lgkmcnt(6)
    v_mfma_f32_16x16x32_bf16 v[16:19], v[188:191], v[72:75], v[16:19]
    v_mfma_f32_16x16x32_bf16 v[44:47], v[188:191], v[76:79], v[44:47]
    ds_read_b128 v[160:163], v11 offset:4096
    s_waitcnt lgkmcnt(6)
    v_mfma_f32_16x16x32_bf16 v[20:23], v[192:195], v[72:75], v[20:23]
    v_mfma_f32_16x16x32_bf16 v[48:51], v[192:195], v[76:79], v[48:51]
    ds_read_b128 v[164:167], v11 offset:5120
    s_add_u32 s41, s47, 16384
    buffer_load_dwordx4 v[120:123], v2, s[12:15], s41 offen offset:1024 sc1
    s_add_u32 s41, s48, 16384
    buffer_load_dwordx4 v[124:127], v2, s[12:15], s41 offen offset:1024 sc1
    s_waitcnt lgkmcnt(6)
    v_mfma_f32_16x16x32_bf16 v[24:27], v[196:199], v[72:75], v[24:27]
    v_mfma_f32_16x16x32_bf16 v[52:55], v[196:199], v[76:79], v[52:55]
    ds_read_b128 v[168:171], v11 offset:6144
    buffer_load_dwordx4 a[120:123], v2, s[12:15], s40 offen offset:2048
    s_waitcnt lgkmcnt(6)
    v_mfma_f32_16x16x32_bf16 v[28:31], v[200:203], v[72:75], v[28:31]
    v_mfma_f32_16x16x32_bf16 v[56:59], v[200:203], v[76:79], v[56:59]
    ds_read_b128 v[172:175], v11 offset:7168
    buffer_load_dwordx4 a[124:127], v2, s[12:15], s40 offen offset:3072
    s_add_u32 s40, s40, 4096
    s_waitcnt lgkmcnt(6)
    v_mfma_f32_16x16x32_bf16 v[32:35], v[204:207], v[72:75], v[32:35]
    v_mfma_f32_16x16x32_bf16 v[60:63], v[204:207], v[76:79], v[60:63]
    ds_read_b128 v[176:179], v11 offset:8192
    s_waitcnt lgkmcnt(6)
    v_mfma_f32_16x16x32_bf16 v[36:39], v[208:211], v[72:75], v[36:39]
    v_mfma_f32_16x16x32_bf16 v[64:67], v[208:211], v[76:79], v[64:67]
    ds_read_b128 v[180:183], v11 offset:9216
    buffer_load_dwordx4 a[128:131], v2, s[12:15], s40 offen offset:0
    s_waitcnt lgkmcnt(6)
    v_mfma_f32_16x16x32_bf16 v[40:43], v[212:215], v[72:75], v[40:43]
    v_mfma_f32_16x16x32_bf16 v[68:71], v[212:215], v[76:79], v[68:71]
    ds_read_b128 v[184:187], v11 offset:10240
    s_waitcnt vmcnt(28)
    s_waitcnt lgkmcnt(6)
    v_mfma_f32_16x16x32_bf16 v[16:19], v[160:163], v[80:83], v[16:19]
    v_mfma_f32_16x16x32_bf16 v[44:47], v[160:163], v[84:87], v[44:47]
    ds_read_b128 v[188:191], v11 offset:11264
    s_waitcnt lgkmcnt(6)
    v_mfma_f32_16x16x32_bf16 v[20:23], v[164:167], v[80:83], v[20:23]
    v_mfma_f32_16x16x32_bf16 v[48:51], v[164:167], v[84:87], v[48:51]
    ds_read_b128 v[192:195], v11 offset:12288
    s_add_u32 s41, s47, 16384
    buffer_load_dwordx4 v[128:131], v2, s[12:15], s41 offen offset:2048 sc1
    s_add_u32 s41, s48, 16384
    buffer_load_dwordx4 v[132:135], v2, s[12:15], s41 offen offset:2048 sc1
    s_waitcnt lgkmcnt(6)
    v_mfma_f32_16x16x32_bf16 v[24:27], v[168:171], v[80:83], v[24:27]
    v_mfma_f32_16x16x32_bf16 v[52:55], v[168:171], v[84:87], v[52:55]
    ds_read_b128 v[196:199], v11 offset:13312
    buffer_load_dwordx4 a[132:135], v2, s[12:15], s40 offen offset:1024
    s_waitcnt lgkmcnt(6)
    v_mfma_f32_16x16x32_bf16 v[28:31], v[172:175], v[80:83], v[28:31]
    v_mfma_f32_16x16x32_bf16 v[56:59], v[172:175], v[84:87], v[56:59]
    ds_read_b128 v[200:203], v11 offset:14336
    buffer_load_dwordx4 a[136:139], v2, s[12:15], s40 offen offset:2048
    s_waitcnt lgkmcnt(6)
    v_mfma_f32_16x16x32_bf16 v[32:35], v[176:179], v[80:83], v[32:35]
    v_mfma_f32_16x16x32_bf16 v[60:63], v[176:179], v[84:87], v[60:63]
    ds_read_b128 v[204:207], v11 offset:15360
    s_waitcnt lgkmcnt(6)
    v_mfma_f32_16x16x32_bf16 v[36:39], v[180:183], v[80:83], v[36:39]
    v_mfma_f32_16x16x32_bf16 v[64:67], v[180:183], v[84:87], v[64:67]
    ds_read_b128 v[208:211], v11 offset:16384
    buffer_load_dwordx4 a[140:143], v2, s[12:15], s40 offen offset:3072
    s_add_u32 s40, s40, 4096
    s_waitcnt lgkmcnt(6)
    v_mfma_f32_16x16x32_bf16 v[40:43], v[184:187], v[80:83], v[40:43]
    v_mfma_f32_16x16x32_bf16 v[68:71], v[184:187], v[84:87], v[68:71]
    ds_read_b128 v[212:215], v11 offset:17408
    buffer_load_dwordx4 a[144:147], v2, s[12:15], s40 offen offset:0
    s_waitcnt vmcnt(29)
    s_waitcnt lgkmcnt(6)
    v_mfma_f32_16x16x32_bf16 v[16:19], v[188:191], v[88:91], v[16:19]
    v_mfma_f32_16x16x32_bf16 v[44:47], v[188:191], v[92:95], v[44:47]
    ds_read_b128 v[160:163], v11 offset:18432
    s_waitcnt lgkmcnt(6)
    v_mfma_f32_16x16x32_bf16 v[20:23], v[192:195], v[88:91], v[20:23]
    v_mfma_f32_16x16x32_bf16 v[48:51], v[192:195], v[92:95], v[48:51]
    ds_read_b128 v[164:167], v11 offset:19456
    s_add_u32 s41, s47, 16384
    buffer_load_dwordx4 v[136:139], v2, s[12:15], s41 offen offset:3072 sc1
    s_add_u32 s41, s48, 16384
    buffer_load_dwordx4 v[140:143], v2, s[12:15], s41 offen offset:3072 sc1
    s_waitcnt lgkmcnt(6)
    v_mfma_f32_16x16x32_bf16 v[24:27], v[196:199], v[88:91], v[24:27]
    v_mfma_f32_16x16x32_bf16 v[52:55], v[196:199], v[92:95], v[52:55]
    ds_read_b128 v[168:171], v11 offset:20480
    buffer_load_dwordx4 a[148:151], v2, s[12:15], s40 offen offset:1024
    s_waitcnt lgkmcnt(6)
    v_mfma_f32_16x16x32_bf16 v[28:31], v[200:203], v[88:91], v[28:31]
    v_mfma_f32_16x16x32_bf16 v[56:59], v[200:203], v[92:95], v[56:59]
    ds_read_b128 v[172:175], v11 offset:21504
    buffer_load_dwordx4 a[152:155], v2, s[12:15], s40 offen offset:2048
    s_waitcnt lgkmcnt(6)
    v_mfma_f32_16x16x32_bf16 v[32:35], v[204:207], v[88:91], v[32:35]
    v_mfma_f32_16x16x32_bf16 v[60:63], v[204:207], v[92:95], v[60:63]
    ds_read_b128 v[176:179], v11 offset:22528
    s_waitcnt lgkmcnt(6)
    v_mfma_f32_16x16x32_bf16 v[36:39], v[208:211], v[88:91], v[36:39]
    v_mfma_f32_16x16x32_bf16 v[64:67], v[208:211], v[92:95], v[64:67]
    ds_read_b128 v[180:183], v11 offset:23552
    buffer_load_dwordx4 a[156:159], v2, s[12:15], s40 offen offset:3072
    s_add_u32 s40, s40, 4096
    s_waitcnt lgkmcnt(6)
    v_mfma_f32_16x16x32_bf16 v[40:43], v[212:215], v[88:91], v[40:43]
    v_mfma_f32_16x16x32_bf16 v[68:71], v[212:215], v[92:95], v[68:71]
    ds_read_b128 v[184:187], v14 offset:0
    buffer_load_dwordx4 a[160:163], v2, s[12:15], s40 offen offset:0
    s_add_u32 s48, s54, 368640
    buffer_load_dwordx4 v[228:231], v254, s[12:15], s48 offen sc1
    buffer_load_dwordx4 v[232:235], v254, s[12:15], s48 offen offset:1024 sc1
    buffer_load_dwordx2 v[236:237], v8, s[12:15], s48 offen offset:2048 sc1
    s_waitcnt vmcnt(33)
    s_waitcnt lgkmcnt(6)
    v_mfma_f32_16x16x32_bf16 v[16:19], v[160:163], v[96:99], v[16:19]
    v_mfma_f32_16x16x32_bf16 v[44:47], v[160:163], v[100:103], v[44:47]
    ds_read_b128 v[188:191], v14 offset:1024
    s_waitcnt lgkmcnt(6)
    v_mfma_f32_16x16x32_bf16 v[20:23], v[164:167], v[96:99], v[20:23]
    v_mfma_f32_16x16x32_bf16 v[48:51], v[164:167], v[100:103], v[48:51]
    ds_read_b128 v[192:195], v14 offset:2048
    s_waitcnt lgkmcnt(6)
    v_mfma_f32_16x16x32_bf16 v[24:27], v[168:171], v[96:99], v[24:27]
    v_mfma_f32_16x16x32_bf16 v[52:55], v[168:171], v[100:103], v[52:55]
    ds_read_b128 v[196:199], v14 offset:3072
    buffer_load_dwordx4 a[164:167], v2, s[12:15], s40 offen offset:1024
    s_waitcnt lgkmcnt(6)
    v_mfma_f32_16x16x32_bf16 v[28:31], v[172:175], v[96:99], v[28:31]
    v_mfma_f32_16x16x32_bf16 v[56:59], v[172:175], v[100:103], v[56:59]
    ds_read_b128 v[200:203], v14 offset:4096
    buffer_load_dwordx4 a[168:171], v2, s[12:15], s40 offen offset:2048
    s_waitcnt lgkmcnt(6)
    v_mfma_f32_16x16x32_bf16 v[32:35], v[176:179], v[96:99], v[32:35]
    v_mfma_f32_16x16x32_bf16 v[60:63], v[176:179], v[100:103], v[60:63]
    ds_read_b128 v[204:207], v14 offset:5120
    s_waitcnt lgkmcnt(6)
    v_mfma_f32_16x16x32_bf16 v[36:39], v[180:183], v[96:99], v[36:39]
    v_mfma_f32_16x16x32_bf16 v[64:67], v[180:183], v[100:103], v[64:67]
    ds_read_b128 v[208:211], v14 offset:6144
    buffer_load_dwordx4 a[172:175], v2, s[12:15], s40 offen offset:3072
    s_add_u32 s40, s40, 4096
    s_waitcnt lgkmcnt(6)
    v_mfma_f32_16x16x32_bf16 v[40:43], v[184:187], v[96:99], v[40:43]
    v_mfma_f32_16x16x32_bf16 v[68:71], v[184:187], v[100:103], v[68:71]
    ds_read_b128 v[212:215], v14 offset:7168
    buffer_load_dwordx4 a[176:179], v2, s[12:15], s40 offen offset:0
    s_add_u32 s48, s54, 20480
    buffer_load_dwordx4 v[238:241], v254, s[12:15], s48 offen sc1
    buffer_load_dwordx4 v[242:245], v254, s[12:15], s48 offen offset:1024 sc1
    buffer_load_dwordx2 v[246:247], v8, s[12:15], s48 offen offset:2048 sc1
    s_waitcnt vmcnt(35)
    s_waitcnt lgkmcnt(6)
    v_mfma_f32_16x16x32_bf16 v[16:19], v[188:191], v[104:107], v[16:19]
    v_mfma_f32_16x16x32_bf16 v[44:47], v[188:191], v[108:111], v[44:47]
    ds_read_b128 v[160:163], v14 offset:8192
    s_waitcnt lgkmcnt(6)
    v_mfma_f32_16x16x32_bf16 v[20:23], v[192:195], v[104:107], v[20:23]
    v_mfma_f32_16x16x32_bf16 v[48:51], v[192:195], v[108:111], v[48:51]
    ds_read_b128 v[164:167], v14 offset:9216
    s_waitcnt lgkmcnt(6)
    v_mfma_f32_16x16x32_bf16 v[24:27], v[196:199], v[104:107], v[24:27]
    v_mfma_f32_16x16x32_bf16 v[52:55], v[196:199], v[108:111], v[52:55]
    ds_read_b128 v[168:171], v14 offset:10240
    buffer_load_dwordx4 a[180:183], v2, s[12:15], s40 offen offset:1024
    s_waitcnt lgkmcnt(6)
    v_mfma_f32_16x16x32_bf16 v[28:31], v[200:203], v[104:107], v[28:31]
    v_mfma_f32_16x16x32_bf16 v[56:59], v[200:203], v[108:111], v[56:59]
    ds_read_b128 v[172:175], v14 offset:11264
    buffer_load_dwordx4 a[184:187], v2, s[12:15], s40 offen offset:2048
    s_waitcnt lgkmcnt(6)
    v_mfma_f32_16x16x32_bf16 v[32:35], v[204:207], v[104:107], v[32:35]
    v_mfma_f32_16x16x32_bf16 v[60:63], v[204:207], v[108:111], v[60:63]
    ds_read_b128 v[176:179], v14 offset:12288
    s_waitcnt lgkmcnt(6)
    v_mfma_f32_16x16x32_bf16 v[36:39], v[208:211], v[104:107], v[36:39]
    v_mfma_f32_16x16x32_bf16 v[64:67], v[208:211], v[108:111], v[64:67]
    ds_read_b128 v[180:183], v14 offset:13312
    buffer_load_dwordx4 a[188:191], v2, s[12:15], s40 offen offset:3072
    s_add_u32 s40, s40, 4096
    s_waitcnt lgkmcnt(6)
    v_mfma_f32_16x16x32_bf16 v[40:43], v[212:215], v[104:107], v[40:43]
    v_mfma_f32_16x16x32_bf16 v[68:71], v[212:215], v[108:111], v[68:71]
    ds_read_b128 v[184:187], v14 offset:14336
    buffer_load_dwordx4 a[192:195], v2, s[12:15], s40 offen offset:0
    s_waitcnt vmcnt(34)
    s_waitcnt lgkmcnt(6)
    v_mfma_f32_16x16x32_bf16 v[16:19], v[160:163], v[112:115], v[16:19]
    v_mfma_f32_16x16x32_bf16 v[44:47], v[160:163], v[116:119], v[44:47]
    ds_read_b128 v[188:191], v14 offset:15360
    s_waitcnt lgkmcnt(6)
    v_mfma_f32_16x16x32_bf16 v[20:23], v[164:167], v[112:115], v[20:23]
    v_mfma_f32_16x16x32_bf16 v[48:51], v[164:167], v[116:119], v[48:51]
    ds_read_b128 v[192:195], v14 offset:16384
    s_waitcnt lgkmcnt(6)
    v_mfma_f32_16x16x32_bf16 v[24:27], v[168:171], v[112:115], v[24:27]
    v_mfma_f32_16x16x32_bf16 v[52:55], v[168:171], v[116:119], v[52:55]
    ds_read_b128 v[196:199], v14 offset:17408
    buffer_load_dwordx4 a[196:199], v2, s[12:15], s40 offen offset:1024
    s_waitcnt lgkmcnt(6)
    v_mfma_f32_16x16x32_bf16 v[28:31], v[172:175], v[112:115], v[28:31]
    v_mfma_f32_16x16x32_bf16 v[56:59], v[172:175], v[116:119], v[56:59]
    ds_read_b128 v[200:203], v14 offset:18432
    buffer_load_dwordx4 a[200:203], v2, s[12:15], s40 offen offset:2048
    s_waitcnt lgkmcnt(6)
    v_mfma_f32_16x16x32_bf16 v[32:35], v[176:179], v[112:115], v[32:35]
    v_mfma_f32_16x16x32_bf16 v[60:63], v[176:179], v[116:119], v[60:63]
    ds_read_b128 v[204:207], v14 offset:19456
    s_waitcnt lgkmcnt(6)
    v_mfma_f32_16x16x32_bf16 v[36:39], v[180:183], v[112:115], v[36:39]
    v_mfma_f32_16x16x32_bf16 v[64:67], v[180:183], v[116:119], v[64:67]
    ds_read_b128 v[208:211], v14 offset:20480
    buffer_load_dwordx4 a[204:207], v2, s[12:15], s40 offen offset:3072
    s_add_u32 s40, s40, 4096
    s_waitcnt lgkmcnt(6)
    v_mfma_f32_16x16x32_bf16 v[40:43], v[184:187], v[112:115], v[40:43]
    v_mfma_f32_16x16x32_bf16 v[68:71], v[184:187], v[116:119], v[68:71]
    ds_read_b128 v[212:215], v14 offset:21504
    buffer_load_dwordx4 a[208:211], v2, s[12:15], s40 offen offset:0
    s_waitcnt vmcnt(33)
    s_waitcnt lgkmcnt(6)
    v_mfma_f32_16x16x32_bf16 v[16:19], v[188:191], v[120:123], v[16:19]
    v_mfma_f32_16x16x32_bf16 v[44:47], v[188:191], v[124:127], v[44:47]
    ds_read_b128 v[160:163], v14 offset:22528
    s_waitcnt lgkmcnt(6)
    v_mfma_f32_16x16x32_bf16 v[20:23], v[192:195], v[120:123], v[20:23]
    v_mfma_f32_16x16x32_bf16 v[48:51], v[192:195], v[124:127], v[48:51]
    ds_read_b128 v[164:167], v14 offset:23552
    s_waitcnt lgkmcnt(6)
    v_mfma_f32_16x16x32_bf16 v[24:27], v[196:199], v[120:123], v[24:27]
    v_mfma_f32_16x16x32_bf16 v[52:55], v[196:199], v[124:127], v[52:55]
    ds_read_b128 v[168:171], v14 offset:24576
    buffer_load_dwordx4 a[212:215], v2, s[12:15], s40 offen offset:1024
    s_waitcnt lgkmcnt(6)
    v_mfma_f32_16x16x32_bf16 v[28:31], v[200:203], v[120:123], v[28:31]
    v_mfma_f32_16x16x32_bf16 v[56:59], v[200:203], v[124:127], v[56:59]
    ds_read_b128 v[172:175], v14 offset:25600
    buffer_load_dwordx4 a[216:219], v2, s[12:15], s40 offen offset:2048
    s_waitcnt lgkmcnt(6)
    v_mfma_f32_16x16x32_bf16 v[32:35], v[204:207], v[120:123], v[32:35]
    v_mfma_f32_16x16x32_bf16 v[60:63], v[204:207], v[124:127], v[60:63]
    ds_read_b128 v[176:179], v14 offset:26624
    s_waitcnt lgkmcnt(6)
    v_mfma_f32_16x16x32_bf16 v[36:39], v[208:211], v[120:123], v[36:39]
    v_mfma_f32_16x16x32_bf16 v[64:67], v[208:211], v[124:127], v[64:67]
    ds_read_b128 v[180:183], v14 offset:27648
    buffer_load_dwordx4 a[220:223], v2, s[12:15], s40 offen offset:3072
    s_add_u32 s40, s40, 4096
    s_waitcnt lgkmcnt(6)
    v_mfma_f32_16x16x32_bf16 v[40:43], v[212:215], v[120:123], v[40:43]
    v_mfma_f32_16x16x32_bf16 v[68:71], v[212:215], v[124:127], v[68:71]
    ds_read_b128 v[184:187], v14 offset:28672
    buffer_load_dwordx4 a[224:227], v2, s[12:15], s40 offen offset:0
    s_waitcnt vmcnt(32)
    s_waitcnt lgkmcnt(6)
    v_mfma_f32_16x16x32_bf16 v[16:19], v[160:163], v[128:131], v[16:19]
    v_mfma_f32_16x16x32_bf16 v[44:47], v[160:163], v[132:135], v[44:47]
    ds_read_b128 v[188:191], v14 offset:29696
    s_waitcnt lgkmcnt(6)
    v_mfma_f32_16x16x32_bf16 v[20:23], v[164:167], v[128:131], v[20:23]
    v_mfma_f32_16x16x32_bf16 v[48:51], v[164:167], v[132:135], v[48:51]
    ds_read_b128 v[192:195], v14 offset:30720
    s_waitcnt lgkmcnt(6)
    v_mfma_f32_16x16x32_bf16 v[24:27], v[168:171], v[128:131], v[24:27]
    v_mfma_f32_16x16x32_bf16 v[52:55], v[168:171], v[132:135], v[52:55]
    ds_read_b128 v[196:199], v14 offset:31744
    buffer_load_dwordx4 a[228:231], v2, s[12:15], s40 offen offset:1024
    s_waitcnt lgkmcnt(6)
    v_mfma_f32_16x16x32_bf16 v[28:31], v[172:175], v[128:131], v[28:31]
    v_mfma_f32_16x16x32_bf16 v[56:59], v[172:175], v[132:135], v[56:59]
    ds_read_b128 v[200:203], v14 offset:32768
    buffer_load_dwordx4 a[232:235], v2, s[12:15], s40 offen offset:2048
    s_waitcnt lgkmcnt(6)
    v_mfma_f32_16x16x32_bf16 v[32:35], v[176:179], v[128:131], v[32:35]
    v_mfma_f32_16x16x32_bf16 v[60:63], v[176:179], v[132:135], v[60:63]
    ds_read_b128 v[204:207], v14 offset:33792
    s_waitcnt lgkmcnt(6)
    v_mfma_f32_16x16x32_bf16 v[36:39], v[180:183], v[128:131], v[36:39]
    v_mfma_f32_16x16x32_bf16 v[64:67], v[180:183], v[132:135], v[64:67]
    ds_read_b128 v[208:211], v14 offset:34816
    buffer_load_dwordx4 a[236:239], v2, s[12:15], s40 offen offset:3072
    s_add_u32 s40, s40, 4096
    s_waitcnt lgkmcnt(6)
    v_mfma_f32_16x16x32_bf16 v[40:43], v[184:187], v[128:131], v[40:43]
    v_mfma_f32_16x16x32_bf16 v[68:71], v[184:187], v[132:135], v[68:71]
    ds_read_b128 v[212:215], v14 offset:35840
    buffer_load_dwordx4 a[240:243], v2, s[12:15], s40 offen offset:0
    s_waitcnt vmcnt(30)
    s_waitcnt lgkmcnt(6)
    v_mfma_f32_16x16x32_bf16 v[16:19], v[188:191], v[136:139], v[16:19]
    v_mfma_f32_16x16x32_bf16 v[44:47], v[188:191], v[140:143], v[44:47]
    s_waitcnt lgkmcnt(5)
    v_mfma_f32_16x16x32_bf16 v[20:23], v[192:195], v[136:139], v[20:23]
    v_mfma_f32_16x16x32_bf16 v[48:51], v[192:195], v[140:143], v[48:51]
    s_waitcnt lgkmcnt(4)
    v_mfma_f32_16x16x32_bf16 v[24:27], v[196:199], v[136:139], v[24:27]
    v_mfma_f32_16x16x32_bf16 v[52:55], v[196:199], v[140:143], v[52:55]
    buffer_load_dwordx4 a[244:247], v2, s[12:15], s40 offen offset:1024
    s_waitcnt lgkmcnt(3)
    v_mfma_f32_16x16x32_bf16 v[28:31], v[200:203], v[136:139], v[28:31]
    v_mfma_f32_16x16x32_bf16 v[56:59], v[200:203], v[140:143], v[56:59]
    buffer_load_dwordx4 a[248:251], v2, s[12:15], s40 offen offset:2048
    s_waitcnt lgkmcnt(2)
    v_mfma_f32_16x16x32_bf16 v[32:35], v[204:207], v[136:139], v[32:35]
    v_mfma_f32_16x16x32_bf16 v[60:63], v[204:207], v[140:143], v[60:63]
    s_waitcnt lgkmcnt(1)
    v_mfma_f32_16x16x32_bf16 v[36:39], v[208:211], v[136:139], v[36:39]
    v_mfma_f32_16x16x32_bf16 v[64:67], v[208:211], v[140:143], v[64:67]
    buffer_load_dwordx4 a[252:255], v2, s[12:15], s40 offen offset:3072
    s_add_u32 s40, s40, 4096
    s_waitcnt lgkmcnt(0)
    v_mfma_f32_16x16x32_bf16 v[40:43], v[212:215], v[136:139], v[40:43]
    v_mfma_f32_16x16x32_bf16 v[68:71], v[212:215], v[140:143], v[68:71]
    v_lshlrev_b32 v9, 4, v3
    v_add_u32 v9, 156672, v9
    v_mov_b32 v12, 0xbdd2d3e8
    v_mov_b32 v13, 0xc0135761
    ds_read_b128 v[72:75], v9 offset:0
    ds_read_b128 v[100:103], v9 offset:512
    ds_read_b128 v[76:79], v9 offset:64
    ds_read_b128 v[104:107], v9 offset:576
    ds_read_b128 v[80:83], v9 offset:128
    ds_read_b128 v[108:111], v9 offset:640
    ds_read_b128 v[84:87], v9 offset:192
    ds_read_b128 v[112:115], v9 offset:704
    ds_read_b128 v[88:91], v9 offset:256
    ds_read_b128 v[116:119], v9 offset:768
    ds_read_b128 v[92:95], v9 offset:320
    ds_read_b128 v[120:123], v9 offset:832
    ds_read_b128 v[96:99], v9 offset:384
    ds_read_b128 v[124:127], v9 offset:896
    s_waitcnt lgkmcnt(0)
    v_pk_add_f32 v[72:73], v[72:73], v[100:101]
    v_pk_add_f32 v[74:75], v[74:75], v[102:103]
    v_pk_add_f32 v[76:77], v[76:77], v[104:105]
    v_pk_add_f32 v[78:79], v[78:79], v[106:107]
    v_pk_add_f32 v[80:81], v[80:81], v[108:109]
    v_pk_add_f32 v[82:83], v[82:83], v[110:111]
    v_pk_add_f32 v[84:85], v[84:85], v[112:113]
    v_pk_add_f32 v[86:87], v[86:87], v[114:115]
    v_pk_add_f32 v[88:89], v[88:89], v[116:117]
    v_pk_add_f32 v[90:91], v[90:91], v[118:119]
    v_pk_add_f32 v[92:93], v[92:93], v[120:121]
    v_pk_add_f32 v[94:95], v[94:95], v[122:123]
    v_pk_add_f32 v[96:97], v[96:97], v[124:125]
    v_pk_add_f32 v[98:99], v[98:99], v[126:127]
    s_lshl_b32 s49, s34, 2
    s_add_u32 s49, s49, s30
    s_lshl_b32 s49, s49, 7
    s_add_u32 s49, s49, s37
    s_lshl_b32 s41, s35, 2
    s_add_u32 s49, s49, s41
    v_pk_mul_f32 v[160:161], v[72:73], v[224:225] op_sel_hi:[1,0]
    v_pk_mul_f32 v[162:163], v[74:75], v[224:225] op_sel_hi:[1,0]
    v_pk_mul_f32 v[164:165], v[72:73], v[226:227] op_sel_hi:[1,0]
    v_pk_mul_f32 v[166:167], v[74:75], v[226:227] op_sel_hi:[1,0]
    v_pk_mul_f32 v[168:169], v[76:77], v[224:225] op_sel_hi:[1,0]
    v_pk_mul_f32 v[170:171], v[78:79], v[224:225] op_sel_hi:[1,0]
    v_pk_mul_f32 v[172:173], v[76:77], v[226:227] op_sel_hi:[1,0]
    v_pk_mul_f32 v[174:175], v[78:79], v[226:227] op_sel_hi:[1,0]
    v_pk_fma_f32 v[16:17], v[16:17], v[224:225], v[160:161] op_sel:[0,1,0] op_sel_hi:[1,1,1]
    v_pk_fma_f32 v[18:19], v[18:19], v[224:225], v[162:163] op_sel:[0,1,0] op_sel_hi:[1,1,1]
    v_pk_fma_f32 v[44:45], v[44:45], v[226:227], v[164:165] op_sel:[0,1,0] op_sel_hi:[1,1,1]
    v_pk_fma_f32 v[46:47], v[46:47], v[226:227], v[166:167] op_sel:[0,1,0] op_sel_hi:[1,1,1]
    v_pk_fma_f32 v[20:21], v[20:21], v[224:225], v[168:169] op_sel:[0,1,0] op_sel_hi:[1,1,1]
    v_pk_fma_f32 v[22:23], v[22:23], v[224:225], v[170:171] op_sel:[0,1,0] op_sel_hi:[1,1,1]
    v_pk_fma_f32 v[48:49], v[48:49], v[226:227], v[172:173] op_sel:[0,1,0] op_sel_hi:[1,1,1]
    v_pk_fma_f32 v[50:51], v[50:51], v[226:227], v[174:175] op_sel:[0,1,0] op_sel_hi:[1,1,1]
    v_pk_mul_f32 v[160:161], v[16:17], v[16:17]
    v_pk_mul_f32 v[162:163], v[18:19], v[18:19]
    v_pk_mul_f32 v[164:165], v[44:45], v[44:45]
    v_pk_mul_f32 v[166:167], v[46:47], v[46:47]
    v_pk_mul_f32 v[168:169], v[20:21], v[20:21]
    v_pk_mul_f32 v[170:171], v[22:23], v[22:23]
    v_pk_mul_f32 v[172:173], v[48:49], v[48:49]
    v_pk_mul_f32 v[174:175], v[50:51], v[50:51]
    v_pk_fma_f32 v[160:161], v[160:161], v[12:13], v[12:13] op_sel:[0,0,1] op_sel_hi:[1,0,1]
    v_pk_fma_f32 v[162:163], v[162:163], v[12:13], v[12:13] op_sel:[0,0,1] op_sel_hi:[1,0,1]
    v_pk_fma_f32 v[164:165], v[164:165], v[12:13], v[12:13] op_sel:[0,0,1] op_sel_hi:[1,0,1]
    v_pk_fma_f32 v[166:167], v[166:167], v[12:13], v[12:13] op_sel:[0,0,1] op_sel_hi:[1,0,1]
    v_pk_fma_f32 v[168:169], v[168:169], v[12:13], v[12:13] op_sel:[0,0,1] op_sel_hi:[1,0,1]
    v_pk_fma_f32 v[170:171], v[170:171], v[12:13], v[12:13] op_sel:[0,0,1] op_sel_hi:[1,0,1]
    v_pk_fma_f32 v[172:173], v[172:173], v[12:13], v[12:13] op_sel:[0,0,1] op_sel_hi:[1,0,1]
    v_pk_fma_f32 v[174:175], v[174:175], v[12:13], v[12:13] op_sel:[0,0,1] op_sel_hi:[1,0,1]
    v_pk_mul_f32 v[160:161], v[160:161], v[16:17]
    v_pk_mul_f32 v[162:163], v[162:163], v[18:19]
    v_pk_mul_f32 v[164:165], v[164:165], v[44:45]
    v_pk_mul_f32 v[166:167], v[166:167], v[46:47]
    v_pk_mul_f32 v[168:169], v[168:169], v[20:21]
    v_pk_mul_f32 v[170:171], v[170:171], v[22:23]
    v_pk_mul_f32 v[172:173], v[172:173], v[48:49]
    v_pk_mul_f32 v[174:175], v[174:175], v[50:51]
    v_exp_f32 v160, v160
    v_exp_f32 v161, v161
    v_exp_f32 v162, v162
    v_exp_f32 v163, v163
    v_exp_f32 v164, v164
    v_exp_f32 v165, v165
    v_exp_f32 v166, v166
    v_exp_f32 v167, v167
    v_exp_f32 v168, v168
    v_exp_f32 v169, v169
    v_exp_f32 v170, v170
    v_exp_f32 v171, v171
    v_exp_f32 v172, v172
    v_exp_f32 v173, v173
    v_exp_f32 v174, v174
    v_exp_f32 v175, v175
    v_pk_add_f32 v[160:161], v[160:161], 1.0 op_sel_hi:[1,0]
    v_pk_add_f32 v[162:163], v[162:163], 1.0 op_sel_hi:[1,0]
    v_pk_add_f32 v[164:165], v[164:165], 1.0 op_sel_hi:[1,0]
    v_pk_add_f32 v[166:167], v[166:167], 1.0 op_sel_hi:[1,0]
    v_pk_add_f32 v[168:169], v[168:169], 1.0 op_sel_hi:[1,0]
    v_pk_add_f32 v[170:171], v[170:171], 1.0 op_sel_hi:[1,0]
    v_pk_add_f32 v[172:173], v[172:173], 1.0 op_sel_hi:[1,0]
    v_pk_add_f32 v[174:175], v[174:175], 1.0 op_sel_hi:[1,0]
    v_rcp_f32 v160, v160
    v_rcp_f32 v161, v161
    v_rcp_f32 v162, v162
    v_rcp_f32 v163, v163
    v_rcp_f32 v164, v164
    v_rcp_f32 v165, v165
    v_rcp_f32 v166, v166
    v_rcp_f32 v167, v167
    v_rcp_f32 v168, v168
    v_rcp_f32 v169, v169
    v_rcp_f32 v170, v170
    v_rcp_f32 v171, v171
    v_rcp_f32 v172, v172
    v_rcp_f32 v173, v173
    v_rcp_f32 v174, v174
    v_rcp_f32 v175, v175
    s_nop 0
    v_pk_mul_f32 v[16:17], v[16:17], v[160:161]
    v_pk_mul_f32 v[18:19], v[18:19], v[162:163]
    v_pk_mul_f32 v[44:45], v[44:45], v[164:165]
    v_pk_mul_f32 v[46:47], v[46:47], v[166:167]
    v_pk_mul_f32 v[20:21], v[20:21], v[168:169]
    v_pk_mul_f32 v[22:23], v[22:23], v[170:171]
    v_pk_mul_f32 v[48:49], v[48:49], v[172:173]
    v_pk_mul_f32 v[50:51], v[50:51], v[174:175]
    v_cvt_pk_bf16_f32 v16, v16, v17
    v_cvt_pk_bf16_f32 v17, v18, v19
    v_cvt_pk_bf16_f32 v18, v20, v21
    v_cvt_pk_bf16_f32 v19, v22, v23
    v_cvt_pk_bf16_f32 v44, v44, v45
    v_cvt_pk_bf16_f32 v45, v46, v47
    v_cvt_pk_bf16_f32 v46, v48, v49
    v_cvt_pk_bf16_f32 v47, v50, v51
    s_nop 1
    v_permlane16_swap_b32 v16, v18
    v_permlane16_swap_b32 v17, v19
    v_permlane16_swap_b32 v44, v46
    v_permlane16_swap_b32 v45, v47
    buffer_store_dwordx4 v[16:19], v254, s[12:15], s52 offen offset:0 sc1
    buffer_store_dwordx4 v[44:47], v254, s[12:15], s53 offen offset:0 sc1
k2_kernel_gs30:
    v_pk_mul_f32 v[160:161], v[80:81], v[224:225] op_sel_hi:[1,0]
    v_pk_mul_f32 v[162:163], v[82:83], v[224:225] op_sel_hi:[1,0]
    v_pk_mul_f32 v[164:165], v[80:81], v[226:227] op_sel_hi:[1,0]
    v_pk_mul_f32 v[166:167], v[82:83], v[226:227] op_sel_hi:[1,0]
    v_pk_mul_f32 v[168:169], v[84:85], v[224:225] op_sel_hi:[1,0]
    v_pk_mul_f32 v[170:171], v[86:87], v[224:225] op_sel_hi:[1,0]
    v_pk_mul_f32 v[172:173], v[84:85], v[226:227] op_sel_hi:[1,0]
    v_pk_mul_f32 v[174:175], v[86:87], v[226:227] op_sel_hi:[1,0]
    v_pk_fma_f32 v[24:25], v[24:25], v[224:225], v[160:161] op_sel:[0,1,0] op_sel_hi:[1,1,1]
    v_pk_fma_f32 v[26:27], v[26:27], v[224:225], v[162:163] op_sel:[0,1,0] op_sel_hi:[1,1,1]
    v_pk_fma_f32 v[52:53], v[52:53], v[226:227], v[164:165] op_sel:[0,1,0] op_sel_hi:[1,1,1]
    v_pk_fma_f32 v[54:55], v[54:55], v[226:227], v[166:167] op_sel:[0,1,0] op_sel_hi:[1,1,1]
    v_pk_fma_f32 v[28:29], v[28:29], v[224:225], v[168:169] op_sel:[0,1,0] op_sel_hi:[1,1,1]
    v_pk_fma_f32 v[30:31], v[30:31], v[224:225], v[170:171] op_sel:[0,1,0] op_sel_hi:[1,1,1]
    v_pk_fma_f32 v[56:57], v[56:57], v[226:227], v[172:173] op_sel:[0,1,0] op_sel_hi:[1,1,1]
    v_pk_fma_f32 v[58:59], v[58:59], v[226:227], v[174:175] op_sel:[0,1,0] op_sel_hi:[1,1,1]
    v_pk_mul_f32 v[160:161], v[24:25], v[24:25]
    v_pk_mul_f32 v[162:163], v[26:27], v[26:27]
    v_pk_mul_f32 v[164:165], v[52:53], v[52:53]
    v_pk_mul_f32 v[166:167], v[54:55], v[54:55]
    v_pk_mul_f32 v[168:169], v[28:29], v[28:29]
    v_pk_mul_f32 v[170:171], v[30:31], v[30:31]
    v_pk_mul_f32 v[172:173], v[56:57], v[56:57]
    v_pk_mul_f32 v[174:175], v[58:59], v[58:59]
    v_pk_fma_f32 v[160:161], v[160:161], v[12:13], v[12:13] op_sel:[0,0,1] op_sel_hi:[1,0,1]
    v_pk_fma_f32 v[162:163], v[162:163], v[12:13], v[12:13] op_sel:[0,0,1] op_sel_hi:[1,0,1]
    v_pk_fma_f32 v[164:165], v[164:165], v[12:13], v[12:13] op_sel:[0,0,1] op_sel_hi:[1,0,1]
    v_pk_fma_f32 v[166:167], v[166:167], v[12:13], v[12:13] op_sel:[0,0,1] op_sel_hi:[1,0,1]
    v_pk_fma_f32 v[168:169], v[168:169], v[12:13], v[12:13] op_sel:[0,0,1] op_sel_hi:[1,0,1]
    v_pk_fma_f32 v[170:171], v[170:171], v[12:13], v[12:13] op_sel:[0,0,1] op_sel_hi:[1,0,1]
    v_pk_fma_f32 v[172:173], v[172:173], v[12:13], v[12:13] op_sel:[0,0,1] op_sel_hi:[1,0,1]
    v_pk_fma_f32 v[174:175], v[174:175], v[12:13], v[12:13] op_sel:[0,0,1] op_sel_hi:[1,0,1]
    v_pk_mul_f32 v[160:161], v[160:161], v[24:25]
    v_pk_mul_f32 v[162:163], v[162:163], v[26:27]
    v_pk_mul_f32 v[164:165], v[164:165], v[52:53]
    v_pk_mul_f32 v[166:167], v[166:167], v[54:55]
    v_pk_mul_f32 v[168:169], v[168:169], v[28:29]
    v_pk_mul_f32 v[170:171], v[170:171], v[30:31]
    v_pk_mul_f32 v[172:173], v[172:173], v[56:57]
    v_pk_mul_f32 v[174:175], v[174:175], v[58:59]
    v_exp_f32 v160, v160
    v_exp_f32 v161, v161
    v_exp_f32 v162, v162
    v_exp_f32 v163, v163
    v_exp_f32 v164, v164
    v_exp_f32 v165, v165
    v_exp_f32 v166, v166
    v_exp_f32 v167, v167
    v_exp_f32 v168, v168
    v_exp_f32 v169, v169
    v_exp_f32 v170, v170
    v_exp_f32 v171, v171
    v_exp_f32 v172, v172
    v_exp_f32 v173, v173
    v_exp_f32 v174, v174
    v_exp_f32 v175, v175
    v_pk_add_f32 v[160:161], v[160:161], 1.0 op_sel_hi:[1,0]
    v_pk_add_f32 v[162:163], v[162:163], 1.0 op_sel_hi:[1,0]
    v_pk_add_f32 v[164:165], v[164:165], 1.0 op_sel_hi:[1,0]
    v_pk_add_f32 v[166:167], v[166:167], 1.0 op_sel_hi:[1,0]
    v_pk_add_f32 v[168:169], v[168:169], 1.0 op_sel_hi:[1,0]
    v_pk_add_f32 v[170:171], v[170:171], 1.0 op_sel_hi:[1,0]
    v_pk_add_f32 v[172:173], v[172:173], 1.0 op_sel_hi:[1,0]
    v_pk_add_f32 v[174:175], v[174:175], 1.0 op_sel_hi:[1,0]
    v_rcp_f32 v160, v160
    v_rcp_f32 v161, v161
    v_rcp_f32 v162, v162
    v_rcp_f32 v163, v163
    v_rcp_f32 v164, v164
    v_rcp_f32 v165, v165
    v_rcp_f32 v166, v166
    v_rcp_f32 v167, v167
    v_rcp_f32 v168, v168
    v_rcp_f32 v169, v169
    v_rcp_f32 v170, v170
    v_rcp_f32 v171, v171
    v_rcp_f32 v172, v172
    v_rcp_f32 v173, v173
    v_rcp_f32 v174, v174
    v_rcp_f32 v175, v175
    s_nop 0
    v_pk_mul_f32 v[24:25], v[24:25], v[160:161]
    v_pk_mul_f32 v[26:27], v[26:27], v[162:163]
    v_pk_mul_f32 v[52:53], v[52:53], v[164:165]
    v_pk_mul_f32 v[54:55], v[54:55], v[166:167]
    v_pk_mul_f32 v[28:29], v[28:29], v[168:169]
    v_pk_mul_f32 v[30:31], v[30:31], v[170:171]
    v_pk_mul_f32 v[56:57], v[56:57], v[172:173]
    v_pk_mul_f32 v[58:59], v[58:59], v[174:175]
    v_cvt_pk_bf16_f32 v24, v24, v25
    v_cvt_pk_bf16_f32 v25, v26, v27
    v_cvt_pk_bf16_f32 v26, v28, v29
    v_cvt_pk_bf16_f32 v27, v30, v31
    v_cvt_pk_bf16_f32 v52, v52, v53
    v_cvt_pk_bf16_f32 v53, v54, v55
    v_cvt_pk_bf16_f32 v54, v56, v57
    v_cvt_pk_bf16_f32 v55, v58, v59
    s_nop 1
    v_permlane16_swap_b32 v24, v26
    v_permlane16_swap_b32 v25, v27
    v_permlane16_swap_b32 v52, v54
    v_permlane16_swap_b32 v53, v55
    s_cmp_eq_u32 s35, 15
    s_cselect_b32 s46, 0xffff, -1
    s_mov_b32 exec_lo, s46
    s_mov_b32 exec_hi, s46
    buffer_store_dwordx4 v[24:27], v254, s[12:15], s52 offen offset:1024 sc1
    buffer_store_dwordx4 v[52:55], v254, s[12:15], s53 offen offset:1024 sc1
    s_mov_b64 exec, -1
k2_kernel_gs31:
    v_pk_mul_f32 v[160:161], v[88:89], v[224:225] op_sel_hi:[1,0]
    v_pk_mul_f32 v[162:163], v[90:91], v[224:225] op_sel_hi:[1,0]
    v_pk_mul_f32 v[164:165], v[88:89], v[226:227] op_sel_hi:[1,0]
    v_pk_mul_f32 v[166:167], v[90:91], v[226:227] op_sel_hi:[1,0]
    v_pk_mul_f32 v[168:169], v[92:93], v[224:225] op_sel_hi:[1,0]
    v_pk_mul_f32 v[170:171], v[94:95], v[224:225] op_sel_hi:[1,0]
    v_pk_mul_f32 v[172:173], v[92:93], v[226:227] op_sel_hi:[1,0]
    v_pk_mul_f32 v[174:175], v[94:95], v[226:227] op_sel_hi:[1,0]
    v_pk_fma_f32 v[32:33], v[32:33], v[224:225], v[160:161] op_sel:[0,1,0] op_sel_hi:[1,1,1]
    v_pk_fma_f32 v[34:35], v[34:35], v[224:225], v[162:163] op_sel:[0,1,0] op_sel_hi:[1,1,1]
    v_pk_fma_f32 v[60:61], v[60:61], v[226:227], v[164:165] op_sel:[0,1,0] op_sel_hi:[1,1,1]
    v_pk_fma_f32 v[62:63], v[62:63], v[226:227], v[166:167] op_sel:[0,1,0] op_sel_hi:[1,1,1]
    v_pk_fma_f32 v[36:37], v[36:37], v[224:225], v[168:169] op_sel:[0,1,0] op_sel_hi:[1,1,1]
    v_pk_fma_f32 v[38:39], v[38:39], v[224:225], v[170:171] op_sel:[0,1,0] op_sel_hi:[1,1,1]
    v_pk_fma_f32 v[64:65], v[64:65], v[226:227], v[172:173] op_sel:[0,1,0] op_sel_hi:[1,1,1]
    v_pk_fma_f32 v[66:67], v[66:67], v[226:227], v[174:175] op_sel:[0,1,0] op_sel_hi:[1,1,1]
    v_pk_mul_f32 v[160:161], v[32:33], v[32:33]
    v_pk_mul_f32 v[162:163], v[34:35], v[34:35]
    v_pk_mul_f32 v[164:165], v[60:61], v[60:61]
    v_pk_mul_f32 v[166:167], v[62:63], v[62:63]
    v_pk_mul_f32 v[168:169], v[36:37], v[36:37]
    v_pk_mul_f32 v[170:171], v[38:39], v[38:39]
    v_pk_mul_f32 v[172:173], v[64:65], v[64:65]
    v_pk_mul_f32 v[174:175], v[66:67], v[66:67]
    v_pk_fma_f32 v[160:161], v[160:161], v[12:13], v[12:13] op_sel:[0,0,1] op_sel_hi:[1,0,1]
    v_pk_fma_f32 v[162:163], v[162:163], v[12:13], v[12:13] op_sel:[0,0,1] op_sel_hi:[1,0,1]
    v_pk_fma_f32 v[164:165], v[164:165], v[12:13], v[12:13] op_sel:[0,0,1] op_sel_hi:[1,0,1]
    v_pk_fma_f32 v[166:167], v[166:167], v[12:13], v[12:13] op_sel:[0,0,1] op_sel_hi:[1,0,1]
    v_pk_fma_f32 v[168:169], v[168:169], v[12:13], v[12:13] op_sel:[0,0,1] op_sel_hi:[1,0,1]
    v_pk_fma_f32 v[170:171], v[170:171], v[12:13], v[12:13] op_sel:[0,0,1] op_sel_hi:[1,0,1]
    v_pk_fma_f32 v[172:173], v[172:173], v[12:13], v[12:13] op_sel:[0,0,1] op_sel_hi:[1,0,1]
    v_pk_fma_f32 v[174:175], v[174:175], v[12:13], v[12:13] op_sel:[0,0,1] op_sel_hi:[1,0,1]
    v_pk_mul_f32 v[160:161], v[160:161], v[32:33]
    v_pk_mul_f32 v[162:163], v[162:163], v[34:35]
    v_pk_mul_f32 v[164:165], v[164:165], v[60:61]
    v_pk_mul_f32 v[166:167], v[166:167], v[62:63]
    v_pk_mul_f32 v[168:169], v[168:169], v[36:37]
    v_pk_mul_f32 v[170:171], v[170:171], v[38:39]
    v_pk_mul_f32 v[172:173], v[172:173], v[64:65]
    v_pk_mul_f32 v[174:175], v[174:175], v[66:67]
    v_exp_f32 v160, v160
    v_exp_f32 v161, v161
    v_exp_f32 v162, v162
    v_exp_f32 v163, v163
    v_exp_f32 v164, v164
    v_exp_f32 v165, v165
    v_exp_f32 v166, v166
    v_exp_f32 v167, v167
    v_exp_f32 v168, v168
    v_exp_f32 v169, v169
    v_exp_f32 v170, v170
    v_exp_f32 v171, v171
    v_exp_f32 v172, v172
    v_exp_f32 v173, v173
    v_exp_f32 v174, v174
    v_exp_f32 v175, v175
    v_pk_add_f32 v[160:161], v[160:161], 1.0 op_sel_hi:[1,0]
    v_pk_add_f32 v[162:163], v[162:163], 1.0 op_sel_hi:[1,0]
    v_pk_add_f32 v[164:165], v[164:165], 1.0 op_sel_hi:[1,0]
    v_pk_add_f32 v[166:167], v[166:167], 1.0 op_sel_hi:[1,0]
    v_pk_add_f32 v[168:169], v[168:169], 1.0 op_sel_hi:[1,0]
    v_pk_add_f32 v[170:171], v[170:171], 1.0 op_sel_hi:[1,0]
    v_pk_add_f32 v[172:173], v[172:173], 1.0 op_sel_hi:[1,0]
    v_pk_add_f32 v[174:175], v[174:175], 1.0 op_sel_hi:[1,0]
    v_rcp_f32 v160, v160
    v_rcp_f32 v161, v161
    v_rcp_f32 v162, v162
    v_rcp_f32 v163, v163
    v_rcp_f32 v164, v164
    v_rcp_f32 v165, v165
    v_rcp_f32 v166, v166
    v_rcp_f32 v167, v167
    v_rcp_f32 v168, v168
    v_rcp_f32 v169, v169
    v_rcp_f32 v170, v170
    v_rcp_f32 v171, v171
    v_rcp_f32 v172, v172
    v_rcp_f32 v173, v173
    v_rcp_f32 v174, v174
    v_rcp_f32 v175, v175
    s_nop 0
    v_pk_mul_f32 v[32:33], v[32:33], v[160:161]
    v_pk_mul_f32 v[34:35], v[34:35], v[162:163]
    v_pk_mul_f32 v[60:61], v[60:61], v[164:165]
    v_pk_mul_f32 v[62:63], v[62:63], v[166:167]
    v_pk_mul_f32 v[36:37], v[36:37], v[168:169]
    v_pk_mul_f32 v[38:39], v[38:39], v[170:171]
    v_pk_mul_f32 v[64:65], v[64:65], v[172:173]
    v_pk_mul_f32 v[66:67], v[66:67], v[174:175]
    v_cvt_pk_bf16_f32 v32, v32, v33
    v_cvt_pk_bf16_f32 v33, v34, v35
    v_cvt_pk_bf16_f32 v34, v36, v37
    v_cvt_pk_bf16_f32 v35, v38, v39
    v_cvt_pk_bf16_f32 v60, v60, v61
    v_cvt_pk_bf16_f32 v61, v62, v63
    v_cvt_pk_bf16_f32 v62, v64, v65
    v_cvt_pk_bf16_f32 v63, v66, v67
    s_nop 1
    v_permlane16_swap_b32 v32, v34
    v_permlane16_swap_b32 v33, v35
    v_permlane16_swap_b32 v60, v62
    v_permlane16_swap_b32 v61, v63
    s_cmp_eq_u32 s35, 15
    s_cbranch_scc1 k2_kernel_gs32
    buffer_store_dwordx4 v[32:35], v254, s[12:15], s52 offen offset:2048 sc1
    buffer_store_dwordx4 v[60:63], v254, s[12:15], s53 offen offset:2048 sc1
k2_kernel_gs32:
    v_pk_mul_f32 v[160:161], v[96:97], v[224:225] op_sel_hi:[1,0]
    v_pk_mul_f32 v[162:163], v[98:99], v[224:225] op_sel_hi:[1,0]
    v_pk_mul_f32 v[164:165], v[96:97], v[226:227] op_sel_hi:[1,0]
    v_pk_mul_f32 v[166:167], v[98:99], v[226:227] op_sel_hi:[1,0]
    v_pk_fma_f32 v[40:41], v[40:41], v[224:225], v[160:161] op_sel:[0,1,0] op_sel_hi:[1,1,1]
    v_pk_fma_f32 v[42:43], v[42:43], v[224:225], v[162:163] op_sel:[0,1,0] op_sel_hi:[1,1,1]
    v_pk_fma_f32 v[68:69], v[68:69], v[226:227], v[164:165] op_sel:[0,1,0] op_sel_hi:[1,1,1]
    v_pk_fma_f32 v[70:71], v[70:71], v[226:227], v[166:167] op_sel:[0,1,0] op_sel_hi:[1,1,1]
    v_pk_mul_f32 v[160:161], v[40:41], v[40:41]
    v_pk_mul_f32 v[162:163], v[42:43], v[42:43]
    v_pk_mul_f32 v[164:165], v[68:69], v[68:69]
    v_pk_mul_f32 v[166:167], v[70:71], v[70:71]
    v_pk_fma_f32 v[160:161], v[160:161], v[12:13], v[12:13] op_sel:[0,0,1] op_sel_hi:[1,0,1]
    v_pk_fma_f32 v[162:163], v[162:163], v[12:13], v[12:13] op_sel:[0,0,1] op_sel_hi:[1,0,1]
    v_pk_fma_f32 v[164:165], v[164:165], v[12:13], v[12:13] op_sel:[0,0,1] op_sel_hi:[1,0,1]
    v_pk_fma_f32 v[166:167], v[166:167], v[12:13], v[12:13] op_sel:[0,0,1] op_sel_hi:[1,0,1]
    v_pk_mul_f32 v[160:161], v[160:161], v[40:41]
    v_pk_mul_f32 v[162:163], v[162:163], v[42:43]
    v_pk_mul_f32 v[164:165], v[164:165], v[68:69]
    v_pk_mul_f32 v[166:167], v[166:167], v[70:71]
    v_exp_f32 v160, v160
    v_exp_f32 v161, v161
    v_exp_f32 v162, v162
    v_exp_f32 v163, v163
    v_exp_f32 v164, v164
    v_exp_f32 v165, v165
    v_exp_f32 v166, v166
    v_exp_f32 v167, v167
    v_pk_add_f32 v[160:161], v[160:161], 1.0 op_sel_hi:[1,0]
    v_pk_add_f32 v[162:163], v[162:163], 1.0 op_sel_hi:[1,0]
    v_pk_add_f32 v[164:165], v[164:165], 1.0 op_sel_hi:[1,0]
    v_pk_add_f32 v[166:167], v[166:167], 1.0 op_sel_hi:[1,0]
    v_rcp_f32 v160, v160
    v_rcp_f32 v161, v161
    v_rcp_f32 v162, v162
    v_rcp_f32 v163, v163
    v_rcp_f32 v164, v164
    v_rcp_f32 v165, v165
    v_rcp_f32 v166, v166
    v_rcp_f32 v167, v167
    s_nop 0
    v_pk_mul_f32 v[40:41], v[40:41], v[160:161]
    v_pk_mul_f32 v[42:43], v[42:43], v[162:163]
    v_pk_mul_f32 v[68:69], v[68:69], v[164:165]
    v_pk_mul_f32 v[70:71], v[70:71], v[166:167]
    v_cvt_pk_bf16_f32 v40, v40, v41
    v_cvt_pk_bf16_f32 v41, v42, v43
    v_cvt_pk_bf16_f32 v68, v68, v69
    v_cvt_pk_bf16_f32 v69, v70, v71
    s_cmp_eq_u32 s35, 15
    s_cbranch_scc1 k2_kernel_gs33
    buffer_store_dwordx2 v[40:41], v8, s[12:15], s52 offen offset:3072 sc1
    buffer_store_dwordx2 v[68:69], v8, s[12:15], s53 offen offset:3072 sc1
k2_kernel_gs33:
    s_waitcnt vmcnt(0)
    v_mov_b32 v9, 1
    v_mov_b32 v10, 6400
    s_mov_b64 exec, 1
    s_cmp_eq_u32 s31, 0
    s_cbranch_scc1 k2_kernel_slow34
    buffer_store_dword v9, v10, s[12:15], s49 offen
    s_branch k2_kernel_sent35
k2_kernel_slow34:
    buffer_store_dword v9, v10, s[12:15], s49 offen sc1
k2_kernel_sent35:
    s_mov_b64 exec, -1
    buffer_load_dwordx4 v[192:195], v2, s[12:15], s40 offen offset:0
    buffer_load_dwordx4 v[196:199], v2, s[12:15], s40 offen offset:1024
    buffer_load_dwordx4 v[200:203], v2, s[12:15], s40 offen offset:2048
    buffer_load_dwordx4 v[204:207], v2, s[12:15], s40 offen offset:3072
    s_add_u32 s40, s40, 4096
    buffer_load_dwordx4 v[208:211], v2, s[12:15], s40 offen offset:0
    buffer_load_dwordx4 v[212:215], v2, s[12:15], s40 offen offset:1024
    s_and_b32 s41, s32, 1
    s_lshl_b32 s41, s41, 1
    s_lshl_b32 s49, s34, 2
    s_add_u32 s49, s49, s41
    s_lshl_b32 s49, s49, 7
    s_add_u32 s49, s49, s37
    s_lshl_b32 s41, s30, 4
    s_add_u32 s49, s49, s41
    s_add_u32 s49, s49, 6400
    v_bfe_u32 v7, v1, 2, 1
    v_lshlrev_b32 v7, 7, v7
    v_and_b32 v9, 3, v1
    v_lshl_add_u32 v7, v9, 2, v7
    s_add_u32 s41, s30, 0
    s_and_b32 s41, s41, 3
    s_lshl_b32 s46, s32, 2
    s_add_u32 s41, s41, s46
    s_mul_i32 s41, s41, 55296
    s_mul_i32 s46, s30, 14336
    s_add_u32 s41, s41, s46
    s_add_u32 s41, s41, s36
    s_add_u32 s50, s41, 696320
    s_add_u32 s41, s30, 1
    s_and_b32 s41, s41, 3
    s_lshl_b32 s46, s32, 2
    s_add_u32 s41, s41, s46
    s_mul_i32 s41, s41, 55296
    s_mul_i32 s46, s30, 14336
    s_add_u32 s41, s41, s46
    s_add_u32 s41, s41, s36
    s_add_u32 s51, s41, 696320
    s_add_u32 s41, s30, 2
    s_and_b32 s41, s41, 3
    s_lshl_b32 s46, s32, 2
    s_add_u32 s41, s41, s46
    s_mul_i32 s41, s41, 55296
    s_mul_i32 s46, s30, 14336
    s_add_u32 s41, s41, s46
    s_add_u32 s41, s41, s36
    s_add_u32 s52, s41, 696320
    s_add_u32 s41, s30, 3
    s_and_b32 s41, s41, 3
    s_lshl_b32 s46, s32, 2
    s_add_u32 s41, s41, s46
    s_mul_i32 s41, s41, 55296
    s_mul_i32 s46, s30, 14336
    s_add_u32 s41, s41, s46
    s_add_u32 s41, s41, s36
    s_add_u32 s53, s41, 696320
    s_mov_b32 s43, 200000
k2_kernel_poll36:
    buffer_load_dword v9, v7, s[12:15], s49 offen sc1
    s_waitcnt vmcnt(0)
    v_cmp_ne_u32 vcc, 0, v9
    s_sub_u32 s43, s43, 1
    s_cmp_eq_u64 vcc, -1
    s_cbranch_scc1 k2_kernel_go37
    s_cmp_lg_u32 s43, 0
    s_cbranch_scc1 k2_kernel_poll36
k2_kernel_go37:
    s_add_u32 s41, s50, 0
    buffer_load_dwordx4 v[96:99], v2, s[12:15], s41 offen offset:0 sc1
    s_add_u32 s41, s51, 0
    buffer_load_dwordx4 v[100:103], v2, s[12:15], s41 offen offset:0 sc1
    s_add_u32 s41, s52, 0
    buffer_load_dwordx4 v[104:107], v2, s[12:15], s41 offen offset:0 sc1
    s_add_u32 s41, s53, 0
    buffer_load_dwordx4 v[108:111], v2, s[12:15], s41 offen offset:0 sc1
    s_add_u32 s41, s50, 0
    buffer_load_dwordx4 v[112:115], v2, s[12:15], s41 offen offset:1024 sc1
    s_add_u32 s41, s51, 0
    buffer_load_dwordx4 v[116:119], v2, s[12:15], s41 offen offset:1024 sc1
    s_add_u32 s41, s52, 0
    buffer_load_dwordx4 v[120:123], v2, s[12:15], s41 offen offset:1024 sc1
    s_add_u32 s41, s53, 0
    buffer_load_dwordx4 v[124:127], v2, s[12:15], s41 offen offset:1024 sc1
    s_waitcnt vmcnt(4)
    v_mfma_f32_16x16x32_bf16 v[16:19], a[0:3], v[96:99], 0
    v_mfma_f32_16x16x32_bf16 v[36:39], a[0:3], v[100:103], 0
    v_mfma_f32_16x16x32_bf16 v[56:59], a[0:3], v[104:107], 0
    v_mfma_f32_16x16x32_bf16 v[76:79], a[0:3], v[108:111], 0
    s_add_u32 s41, s50, 0
    buffer_load_dwordx4 v[128:131], v2, s[12:15], s41 offen offset:2048 sc1
    v_mfma_f32_16x16x32_bf16 v[20:23], a[4:7], v[96:99], 0
    v_mfma_f32_16x16x32_bf16 v[40:43], a[4:7], v[100:103], 0
    v_mfma_f32_16x16x32_bf16 v[60:63], a[4:7], v[104:107], 0
    v_mfma_f32_16x16x32_bf16 v[80:83], a[4:7], v[108:111], 0
    s_add_u32 s41, s51, 0
    buffer_load_dwordx4 v[132:135], v2, s[12:15], s41 offen offset:2048 sc1
    s_add_u32 s41, s52, 0
    buffer_load_dwordx4 v[136:139], v2, s[12:15], s41 offen offset:2048 sc1
    v_mfma_f32_16x16x32_bf16 v[24:27], a[8:11], v[96:99], 0
    v_mfma_f32_16x16x32_bf16 v[44:47], a[8:11], v[100:103], 0
    v_mfma_f32_16x16x32_bf16 v[64:67], a[8:11], v[104:107], 0
    v_mfma_f32_16x16x32_bf16 v[84:87], a[8:11], v[108:111], 0
    s_add_u32 s41, s53, 0
    buffer_load_dwordx4 v[140:143], v2, s[12:15], s41 offen offset:2048 sc1
    v_mfma_f32_16x16x32_bf16 v[28:31], a[12:15], v[96:99], 0
    v_mfma_f32_16x16x32_bf16 v[48:51], a[12:15], v[100:103], 0
    v_mfma_f32_16x16x32_bf16 v[68:71], a[12:15], v[104:107], 0
    v_mfma_f32_16x16x32_bf16 v[88:91], a[12:15], v[108:111], 0
    s_add_u32 s41, s50, 0
    buffer_load_dwordx4 v[144:147], v2, s[12:15], s41 offen offset:3072 sc1
    s_add_u32 s41, s51, 0
    buffer_load_dwordx4 v[148:151], v2, s[12:15], s41 offen offset:3072 sc1
    v_mfma_f32_16x16x32_bf16 v[32:35], a[16:19], v[96:99], 0
    v_mfma_f32_16x16x32_bf16 v[52:55], a[16:19], v[100:103], 0
    v_mfma_f32_16x16x32_bf16 v[72:75], a[16:19], v[104:107], 0
    v_mfma_f32_16x16x32_bf16 v[92:95], a[16:19], v[108:111], 0
    s_add_u32 s41, s52, 0
    buffer_load_dwordx4 v[152:155], v2, s[12:15], s41 offen offset:3072 sc1
    s_waitcnt vmcnt(7)
    v_mfma_f32_16x16x32_bf16 v[16:19], a[20:23], v[112:115], v[16:19]
    v_mfma_f32_16x16x32_bf16 v[36:39], a[20:23], v[116:119], v[36:39]
    v_mfma_f32_16x16x32_bf16 v[56:59], a[20:23], v[120:123], v[56:59]
    v_mfma_f32_16x16x32_bf16 v[76:79], a[20:23], v[124:127], v[76:79]
    s_add_u32 s41, s53, 0
    buffer_load_dwordx4 v[156:159], v2, s[12:15], s41 offen offset:3072 sc1
    v_mfma_f32_16x16x32_bf16 v[20:23], a[24:27], v[112:115], v[20:23]
    v_mfma_f32_16x16x32_bf16 v[40:43], a[24:27], v[116:119], v[40:43]
    v_mfma_f32_16x16x32_bf16 v[60:63], a[24:27], v[120:123], v[60:63]
    v_mfma_f32_16x16x32_bf16 v[80:83], a[24:27], v[124:127], v[80:83]
    s_add_u32 s41, s50, 4096
    buffer_load_dwordx4 v[160:163], v2, s[12:15], s41 offen offset:0 sc1
    s_add_u32 s41, s51, 4096
    buffer_load_dwordx4 v[164:167], v2, s[12:15], s41 offen offset:0 sc1
    v_mfma_f32_16x16x32_bf16 v[24:27], a[28:31], v[112:115], v[24:27]
    v_mfma_f32_16x16x32_bf16 v[44:47], a[28:31], v[116:119], v[44:47]
    v_mfma_f32_16x16x32_bf16 v[64:67], a[28:31], v[120:123], v[64:67]
    v_mfma_f32_16x16x32_bf16 v[84:87], a[28:31], v[124:127], v[84:87]
    s_add_u32 s41, s52, 4096
    buffer_load_dwordx4 v[168:171], v2, s[12:15], s41 offen offset:0 sc1
    v_mfma_f32_16x16x32_bf16 v[28:31], a[32:35], v[112:115], v[28:31]
    v_mfma_f32_16x16x32_bf16 v[48:51], a[32:35], v[116:119], v[48:51]
    v_mfma_f32_16x16x32_bf16 v[68:71], a[32:35], v[120:123], v[68:71]
    v_mfma_f32_16x16x32_bf16 v[88:91], a[32:35], v[124:127], v[88:91]
    s_add_u32 s41, s53, 4096
    buffer_load_dwordx4 v[172:175], v2, s[12:15], s41 offen offset:0 sc1
    s_add_u32 s41, s50, 4096
    buffer_load_dwordx4 v[176:179], v2, s[12:15], s41 offen offset:1024 sc1
    v_mfma_f32_16x16x32_bf16 v[32:35], a[36:39], v[112:115], v[32:35]
    v_mfma_f32_16x16x32_bf16 v[52:55], a[36:39], v[116:119], v[52:55]
    v_mfma_f32_16x16x32_bf16 v[72:75], a[36:39], v[120:123], v[72:75]
    v_mfma_f32_16x16x32_bf16 v[92:95], a[36:39], v[124:127], v[92:95]
    s_add_u32 s41, s51, 4096
    buffer_load_dwordx4 v[180:183], v2, s[12:15], s41 offen offset:1024 sc1
    s_waitcnt vmcnt(10)
    v_mfma_f32_16x16x32_bf16 v[16:19], a[40:43], v[128:131], v[16:19]
    v_mfma_f32_16x16x32_bf16 v[36:39], a[40:43], v[132:135], v[36:39]
    v_mfma_f32_16x16x32_bf16 v[56:59], a[40:43], v[136:139], v[56:59]
    v_mfma_f32_16x16x32_bf16 v[76:79], a[40:43], v[140:143], v[76:79]
    s_add_u32 s41, s52, 4096
    buffer_load_dwordx4 v[184:187], v2, s[12:15], s41 offen offset:1024 sc1
    v_mfma_f32_16x16x32_bf16 v[20:23], a[44:47], v[128:131], v[20:23]
    v_mfma_f32_16x16x32_bf16 v[40:43], a[44:47], v[132:135], v[40:43]
    v_mfma_f32_16x16x32_bf16 v[60:63], a[44:47], v[136:139], v[60:63]
    v_mfma_f32_16x16x32_bf16 v[80:83], a[44:47], v[140:143], v[80:83]
    s_add_u32 s41, s53, 4096
    buffer_load_dwordx4 v[188:191], v2, s[12:15], s41 offen offset:1024 sc1
    s_add_u32 s41, s50, 4096
    buffer_load_dwordx4 v[96:99], v2, s[12:15], s41 offen offset:2048 sc1
    v_mfma_f32_16x16x32_bf16 v[24:27], a[48:51], v[128:131], v[24:27]
    v_mfma_f32_16x16x32_bf16 v[44:47], a[48:51], v[132:135], v[44:47]
    v_mfma_f32_16x16x32_bf16 v[64:67], a[48:51], v[136:139], v[64:67]
    v_mfma_f32_16x16x32_bf16 v[84:87], a[48:51], v[140:143], v[84:87]
    s_add_u32 s41, s51, 4096
    buffer_load_dwordx4 v[100:103], v2, s[12:15], s41 offen offset:2048 sc1
    v_mfma_f32_16x16x32_bf16 v[28:31], a[52:55], v[128:131], v[28:31]
    v_mfma_f32_16x16x32_bf16 v[48:51], a[52:55], v[132:135], v[48:51]
    v_mfma_f32_16x16x32_bf16 v[68:71], a[52:55], v[136:139], v[68:71]
    v_mfma_f32_16x16x32_bf16 v[88:91], a[52:55], v[140:143], v[88:91]
    s_add_u32 s41, s52, 4096
    buffer_load_dwordx4 v[104:107], v2, s[12:15], s41 offen offset:2048 sc1
    v_mfma_f32_16x16x32_bf16 v[32:35], a[56:59], v[128:131], v[32:35]
    v_mfma_f32_16x16x32_bf16 v[52:55], a[56:59], v[132:135], v[52:55]
    v_mfma_f32_16x16x32_bf16 v[72:75], a[56:59], v[136:139], v[72:75]
    v_mfma_f32_16x16x32_bf16 v[92:95], a[56:59], v[140:143], v[92:95]
    s_add_u32 s41, s53, 4096
    buffer_load_dwordx4 v[108:111], v2, s[12:15], s41 offen offset:2048 sc1
    s_waitcnt vmcnt(12)
    v_mfma_f32_16x16x32_bf16 v[16:19], a[60:63], v[144:147], v[16:19]
    v_mfma_f32_16x16x32_bf16 v[36:39], a[60:63], v[148:151], v[36:39]
    v_mfma_f32_16x16x32_bf16 v[56:59], a[60:63], v[152:155], v[56:59]
    v_mfma_f32_16x16x32_bf16 v[76:79], a[60:63], v[156:159], v[76:79]
    s_add_u32 s41, s50, 4096
    buffer_load_dwordx4 v[112:115], v2, s[12:15], s41 offen offset:3072 sc1
    v_mfma_f32_16x16x32_bf16 v[20:23], a[64:67], v[144:147], v[20:23]
    v_mfma_f32_16x16x32_bf16 v[40:43], a[64:67], v[148:151], v[40:43]
    v_mfma_f32_16x16x32_bf16 v[60:63], a[64:67], v[152:155], v[60:63]
    v_mfma_f32_16x16x32_bf16 v[80:83], a[64:67], v[156:159], v[80:83]
    s_add_u32 s41, s51, 4096
    buffer_load_dwordx4 v[116:119], v2, s[12:15], s41 offen offset:3072 sc1
    v_mfma_f32_16x16x32_bf16 v[24:27], a[68:71], v[144:147], v[24:27]
    v_mfma_f32_16x16x32_bf16 v[44:47], a[68:71], v[148:151], v[44:47]
    v_mfma_f32_16x16x32_bf16 v[64:67], a[68:71], v[152:155], v[64:67]
    v_mfma_f32_16x16x32_bf16 v[84:87], a[68:71], v[156:159], v[84:87]
    s_add_u32 s41, s52, 4096
    buffer_load_dwordx4 v[120:123], v2, s[12:15], s41 offen offset:3072 sc1
    v_mfma_f32_16x16x32_bf16 v[28:31], a[72:75], v[144:147], v[28:31]
    v_mfma_f32_16x16x32_bf16 v[48:51], a[72:75], v[148:151], v[48:51]
    v_mfma_f32_16x16x32_bf16 v[68:71], a[72:75], v[152:155], v[68:71]
    v_mfma_f32_16x16x32_bf16 v[88:91], a[72:75], v[156:159], v[88:91]
    s_add_u32 s41, s53, 4096
    buffer_load_dwordx4 v[124:127], v2, s[12:15], s41 offen offset:3072 sc1
    v_mfma_f32_16x16x32_bf16 v[32:35], a[76:79], v[144:147], v[32:35]
    v_mfma_f32_16x16x32_bf16 v[52:55], a[76:79], v[148:151], v[52:55]
    v_mfma_f32_16x16x32_bf16 v[72:75], a[76:79], v[152:155], v[72:75]
    v_mfma_f32_16x16x32_bf16 v[92:95], a[76:79], v[156:159], v[92:95]
    s_add_u32 s41, s50, 8192
    buffer_load_dwordx4 v[128:131], v2, s[12:15], s41 offen offset:0 sc1
    s_waitcnt vmcnt(13)
    v_mfma_f32_16x16x32_bf16 v[16:19], a[80:83], v[160:163], v[16:19]
    v_mfma_f32_16x16x32_bf16 v[36:39], a[80:83], v[164:167], v[36:39]
    v_mfma_f32_16x16x32_bf16 v[56:59], a[80:83], v[168:171], v[56:59]
    v_mfma_f32_16x16x32_bf16 v[76:79], a[80:83], v[172:175], v[76:79]
    s_add_u32 s41, s51, 8192
    buffer_load_dwordx4 v[132:135], v2, s[12:15], s41 offen offset:0 sc1
    v_mfma_f32_16x16x32_bf16 v[20:23], a[84:87], v[160:163], v[20:23]
    v_mfma_f32_16x16x32_bf16 v[40:43], a[84:87], v[164:167], v[40:43]
    v_mfma_f32_16x16x32_bf16 v[60:63], a[84:87], v[168:171], v[60:63]
    v_mfma_f32_16x16x32_bf16 v[80:83], a[84:87], v[172:175], v[80:83]
    s_add_u32 s41, s52, 8192
    buffer_load_dwordx4 v[136:139], v2, s[12:15], s41 offen offset:0 sc1
    v_mfma_f32_16x16x32_bf16 v[24:27], a[88:91], v[160:163], v[24:27]
    v_mfma_f32_16x16x32_bf16 v[44:47], a[88:91], v[164:167], v[44:47]
    v_mfma_f32_16x16x32_bf16 v[64:67], a[88:91], v[168:171], v[64:67]
    v_mfma_f32_16x16x32_bf16 v[84:87], a[88:91], v[172:175], v[84:87]
    s_add_u32 s41, s53, 8192
    buffer_load_dwordx4 v[140:143], v2, s[12:15], s41 offen offset:0 sc1
    v_mfma_f32_16x16x32_bf16 v[28:31], a[92:95], v[160:163], v[28:31]
    v_mfma_f32_16x16x32_bf16 v[48:51], a[92:95], v[164:167], v[48:51]
    v_mfma_f32_16x16x32_bf16 v[68:71], a[92:95], v[168:171], v[68:71]
    v_mfma_f32_16x16x32_bf16 v[88:91], a[92:95], v[172:175], v[88:91]
    s_add_u32 s41, s50, 8192
    buffer_load_dwordx4 v[144:147], v2, s[12:15], s41 offen offset:1024 sc1
    v_mfma_f32_16x16x32_bf16 v[32:35], a[96:99], v[160:163], v[32:35]
    v_mfma_f32_16x16x32_bf16 v[52:55], a[96:99], v[164:167], v[52:55]
    v_mfma_f32_16x16x32_bf16 v[72:75], a[96:99], v[168:171], v[72:75]
    v_mfma_f32_16x16x32_bf16 v[92:95], a[96:99], v[172:175], v[92:95]
    s_add_u32 s41, s51, 8192
    buffer_load_dwordx4 v[148:151], v2, s[12:15], s41 offen offset:1024 sc1
    s_waitcnt vmcnt(14)
    v_mfma_f32_16x16x32_bf16 v[16:19], a[100:103], v[176:179], v[16:19]
    v_mfma_f32_16x16x32_bf16 v[36:39], a[100:103], v[180:183], v[36:39]
    v_mfma_f32_16x16x32_bf16 v[56:59], a[100:103], v[184:187], v[56:59]
    v_mfma_f32_16x16x32_bf16 v[76:79], a[100:103], v[188:191], v[76:79]
    s_add_u32 s41, s52, 8192
    buffer_load_dwordx4 v[152:155], v2, s[12:15], s41 offen offset:1024 sc1
    v_mfma_f32_16x16x32_bf16 v[20:23], a[104:107], v[176:179], v[20:23]
    v_mfma_f32_16x16x32_bf16 v[40:43], a[104:107], v[180:183], v[40:43]
    v_mfma_f32_16x16x32_bf16 v[60:63], a[104:107], v[184:187], v[60:63]
    v_mfma_f32_16x16x32_bf16 v[80:83], a[104:107], v[188:191], v[80:83]
    s_add_u32 s41, s53, 8192
    buffer_load_dwordx4 v[156:159], v2, s[12:15], s41 offen offset:1024 sc1
    v_mfma_f32_16x16x32_bf16 v[24:27], a[108:111], v[176:179], v[24:27]
    v_mfma_f32_16x16x32_bf16 v[44:47], a[108:111], v[180:183], v[44:47]
    v_mfma_f32_16x16x32_bf16 v[64:67], a[108:111], v[184:187], v[64:67]
    v_mfma_f32_16x16x32_bf16 v[84:87], a[108:111], v[188:191], v[84:87]
    s_add_u32 s41, s50, 8192
    buffer_load_dwordx4 v[160:163], v2, s[12:15], s41 offen offset:2048 sc1
    v_mfma_f32_16x16x32_bf16 v[28:31], a[112:115], v[176:179], v[28:31]
    v_mfma_f32_16x16x32_bf16 v[48:51], a[112:115], v[180:183], v[48:51]
    v_mfma_f32_16x16x32_bf16 v[68:71], a[112:115], v[184:187], v[68:71]
    v_mfma_f32_16x16x32_bf16 v[88:91], a[112:115], v[188:191], v[88:91]
    s_add_u32 s41, s51, 8192
    buffer_load_dwordx4 v[164:167], v2, s[12:15], s41 offen offset:2048 sc1
    v_mfma_f32_16x16x32_bf16 v[32:35], a[116:119], v[176:179], v[32:35]
    v_mfma_f32_16x16x32_bf16 v[52:55], a[116:119], v[180:183], v[52:55]
    v_mfma_f32_16x16x32_bf16 v[72:75], a[116:119], v[184:187], v[72:75]
    v_mfma_f32_16x16x32_bf16 v[92:95], a[116:119], v[188:191], v[92:95]
    s_add_u32 s41, s52, 8192
    buffer_load_dwordx4 v[168:171], v2, s[12:15], s41 offen offset:2048 sc1
    s_waitcnt vmcnt(15)
    v_mfma_f32_16x16x32_bf16 v[16:19], a[120:123], v[96:99], v[16:19]
    v_mfma_f32_16x16x32_bf16 v[36:39], a[120:123], v[100:103], v[36:39]
    v_mfma_f32_16x16x32_bf16 v[56:59], a[120:123], v[104:107], v[56:59]
    v_mfma_f32_16x16x32_bf16 v[76:79], a[120:123], v[108:111], v[76:79]
    s_add_u32 s41, s53, 8192
    buffer_load_dwordx4 v[172:175], v2, s[12:15], s41 offen offset:2048 sc1
    v_mfma_f32_16x16x32_bf16 v[20:23], a[124:127], v[96:99], v[20:23]
    v_mfma_f32_16x16x32_bf16 v[40:43], a[124:127], v[100:103], v[40:43]
    v_mfma_f32_16x16x32_bf16 v[60:63], a[124:127], v[104:107], v[60:63]
    v_mfma_f32_16x16x32_bf16 v[80:83], a[124:127], v[108:111], v[80:83]
    s_add_u32 s41, s50, 8192
    buffer_load_dwordx4 v[176:179], v2, s[12:15], s41 offen offset:3072 sc1
    v_mfma_f32_16x16x32_bf16 v[24:27], a[128:131], v[96:99], v[24:27]
    v_mfma_f32_16x16x32_bf16 v[44:47], a[128:131], v[100:103], v[44:47]
    v_mfma_f32_16x16x32_bf16 v[64:67], a[128:131], v[104:107], v[64:67]
    v_mfma_f32_16x16x32_bf16 v[84:87], a[128:131], v[108:111], v[84:87]
    s_add_u32 s41, s51, 8192
    buffer_load_dwordx4 v[180:183], v2, s[12:15], s41 offen offset:3072 sc1
    v_mfma_f32_16x16x32_bf16 v[28:31], a[132:135], v[96:99], v[28:31]
    v_mfma_f32_16x16x32_bf16 v[48:51], a[132:135], v[100:103], v[48:51]
    v_mfma_f32_16x16x32_bf16 v[68:71], a[132:135], v[104:107], v[68:71]
    v_mfma_f32_16x16x32_bf16 v[88:91], a[132:135], v[108:111], v[88:91]
    s_add_u32 s41, s52, 8192
    buffer_load_dwordx4 v[184:187], v2, s[12:15], s41 offen offset:3072 sc1
    v_mfma_f32_16x16x32_bf16 v[32:35], a[136:139], v[96:99], v[32:35]
    v_mfma_f32_16x16x32_bf16 v[52:55], a[136:139], v[100:103], v[52:55]
    v_mfma_f32_16x16x32_bf16 v[72:75], a[136:139], v[104:107], v[72:75]
    v_mfma_f32_16x16x32_bf16 v[92:95], a[136:139], v[108:111], v[92:95]
    s_add_u32 s41, s53, 8192
    buffer_load_dwordx4 v[188:191], v2, s[12:15], s41 offen offset:3072 sc1
    s_waitcnt vmcnt(16)
    v_mfma_f32_16x16x32_bf16 v[16:19], a[140:143], v[112:115], v[16:19]
    v_mfma_f32_16x16x32_bf16 v[36:39], a[140:143], v[116:119], v[36:39]
    v_mfma_f32_16x16x32_bf16 v[56:59], a[140:143], v[120:123], v[56:59]
    v_mfma_f32_16x16x32_bf16 v[76:79], a[140:143], v[124:127], v[76:79]
    v_mfma_f32_16x16x32_bf16 v[20:23], a[144:147], v[112:115], v[20:23]
    v_mfma_f32_16x16x32_bf16 v[40:43], a[144:147], v[116:119], v[40:43]
    v_mfma_f32_16x16x32_bf16 v[60:63], a[144:147], v[120:123], v[60:63]
    v_mfma_f32_16x16x32_bf16 v[80:83], a[144:147], v[124:127], v[80:83]
    s_add_u32 s41, s50, 12288
    buffer_load_dwordx4 v[96:99], v2, s[12:15], s41 offen offset:0 sc1
    v_mfma_f32_16x16x32_bf16 v[24:27], a[148:151], v[112:115], v[24:27]
    v_mfma_f32_16x16x32_bf16 v[44:47], a[148:151], v[116:119], v[44:47]
    v_mfma_f32_16x16x32_bf16 v[64:67], a[148:151], v[120:123], v[64:67]
    v_mfma_f32_16x16x32_bf16 v[84:87], a[148:151], v[124:127], v[84:87]
    s_add_u32 s41, s51, 12288
    buffer_load_dwordx4 v[100:103], v2, s[12:15], s41 offen offset:0 sc1
    v_mfma_f32_16x16x32_bf16 v[28:31], a[152:155], v[112:115], v[28:31]
    v_mfma_f32_16x16x32_bf16 v[48:51], a[152:155], v[116:119], v[48:51]
    v_mfma_f32_16x16x32_bf16 v[68:71], a[152:155], v[120:123], v[68:71]
    v_mfma_f32_16x16x32_bf16 v[88:91], a[152:155], v[124:127], v[88:91]
    s_add_u32 s41, s52, 12288
    buffer_load_dwordx4 v[104:107], v2, s[12:15], s41 offen offset:0 sc1
    v_mfma_f32_16x16x32_bf16 v[32:35], a[156:159], v[112:115], v[32:35]
    v_mfma_f32_16x16x32_bf16 v[52:55], a[156:159], v[116:119], v[52:55]
    v_mfma_f32_16x16x32_bf16 v[72:75], a[156:159], v[120:123], v[72:75]
    v_mfma_f32_16x16x32_bf16 v[92:95], a[156:159], v[124:127], v[92:95]
    s_add_u32 s41, s53, 12288
    buffer_load_dwordx4 v[108:111], v2, s[12:15], s41 offen offset:0 sc1
    s_waitcnt vmcnt(16)
    v_mfma_f32_16x16x32_bf16 v[16:19], a[160:163], v[128:131], v[16:19]
    v_mfma_f32_16x16x32_bf16 v[36:39], a[160:163], v[132:135], v[36:39]
    v_mfma_f32_16x16x32_bf16 v[56:59], a[160:163], v[136:139], v[56:59]
    v_mfma_f32_16x16x32_bf16 v[76:79], a[160:163], v[140:143], v[76:79]
    v_mfma_f32_16x16x32_bf16 v[20:23], a[164:167], v[128:131], v[20:23]
    v_mfma_f32_16x16x32_bf16 v[40:43], a[164:167], v[132:135], v[40:43]
    v_mfma_f32_16x16x32_bf16 v[60:63], a[164:167], v[136:139], v[60:63]
    v_mfma_f32_16x16x32_bf16 v[80:83], a[164:167], v[140:143], v[80:83]
    s_add_u32 s41, s50, 12288
    buffer_load_dwordx4 v[112:115], v2, s[12:15], s41 offen offset:1024 sc1
    v_mfma_f32_16x16x32_bf16 v[24:27], a[168:171], v[128:131], v[24:27]
    v_mfma_f32_16x16x32_bf16 v[44:47], a[168:171], v[132:135], v[44:47]
    v_mfma_f32_16x16x32_bf16 v[64:67], a[168:171], v[136:139], v[64:67]
    v_mfma_f32_16x16x32_bf16 v[84:87], a[168:171], v[140:143], v[84:87]
    s_add_u32 s41, s51, 12288
    buffer_load_dwordx4 v[116:119], v2, s[12:15], s41 offen offset:1024 sc1
    v_mfma_f32_16x16x32_bf16 v[28:31], a[172:175], v[128:131], v[28:31]
    v_mfma_f32_16x16x32_bf16 v[48:51], a[172:175], v[132:135], v[48:51]
    v_mfma_f32_16x16x32_bf16 v[68:71], a[172:175], v[136:139], v[68:71]
    v_mfma_f32_16x16x32_bf16 v[88:91], a[172:175], v[140:143], v[88:91]
    s_add_u32 s41, s52, 12288
    buffer_load_dwordx4 v[120:123], v2, s[12:15], s41 offen offset:1024 sc1
    v_mfma_f32_16x16x32_bf16 v[32:35], a[176:179], v[128:131], v[32:35]
    v_mfma_f32_16x16x32_bf16 v[52:55], a[176:179], v[132:135], v[52:55]
    v_mfma_f32_16x16x32_bf16 v[72:75], a[176:179], v[136:139], v[72:75]
    v_mfma_f32_16x16x32_bf16 v[92:95], a[176:179], v[140:143], v[92:95]
    s_add_u32 s41, s53, 12288
    buffer_load_dwordx4 v[124:127], v2, s[12:15], s41 offen offset:1024 sc1
    s_waitcnt vmcnt(16)
    v_mfma_f32_16x16x32_bf16 v[16:19], a[180:183], v[144:147], v[16:19]
    v_mfma_f32_16x16x32_bf16 v[36:39], a[180:183], v[148:151], v[36:39]
    v_mfma_f32_16x16x32_bf16 v[56:59], a[180:183], v[152:155], v[56:59]
    v_mfma_f32_16x16x32_bf16 v[76:79], a[180:183], v[156:159], v[76:79]
    v_mfma_f32_16x16x32_bf16 v[20:23], a[184:187], v[144:147], v[20:23]
    v_mfma_f32_16x16x32_bf16 v[40:43], a[184:187], v[148:151], v[40:43]
    v_mfma_f32_16x16x32_bf16 v[60:63], a[184:187], v[152:155], v[60:63]
    v_mfma_f32_16x16x32_bf16 v[80:83], a[184:187], v[156:159], v[80:83]
    v_mfma_f32_16x16x32_bf16 v[24:27], a[188:191], v[144:147], v[24:27]
    v_mfma_f32_16x16x32_bf16 v[44:47], a[188:191], v[148:151], v[44:47]
    v_mfma_f32_16x16x32_bf16 v[64:67], a[188:191], v[152:155], v[64:67]
    v_mfma_f32_16x16x32_bf16 v[84:87], a[188:191], v[156:159], v[84:87]
    v_mfma_f32_16x16x32_bf16 v[28:31], a[192:195], v[144:147], v[28:31]
    v_mfma_f32_16x16x32_bf16 v[48:51], a[192:195], v[148:151], v[48:51]
    v_mfma_f32_16x16x32_bf16 v[68:71], a[192:195], v[152:155], v[68:71]
    v_mfma_f32_16x16x32_bf16 v[88:91], a[192:195], v[156:159], v[88:91]
    v_mfma_f32_16x16x32_bf16 v[32:35], a[196:199], v[144:147], v[32:35]
    v_mfma_f32_16x16x32_bf16 v[52:55], a[196:199], v[148:151], v[52:55]
    v_mfma_f32_16x16x32_bf16 v[72:75], a[196:199], v[152:155], v[72:75]
    v_mfma_f32_16x16x32_bf16 v[92:95], a[196:199], v[156:159], v[92:95]
    s_waitcnt vmcnt(12)
    v_mfma_f32_16x16x32_bf16 v[16:19], a[200:203], v[160:163], v[16:19]
    v_mfma_f32_16x16x32_bf16 v[36:39], a[200:203], v[164:167], v[36:39]
    v_mfma_f32_16x16x32_bf16 v[56:59], a[200:203], v[168:171], v[56:59]
    v_mfma_f32_16x16x32_bf16 v[76:79], a[200:203], v[172:175], v[76:79]
    v_mfma_f32_16x16x32_bf16 v[20:23], a[204:207], v[160:163], v[20:23]
    v_mfma_f32_16x16x32_bf16 v[40:43], a[204:207], v[164:167], v[40:43]
    v_mfma_f32_16x16x32_bf16 v[60:63], a[204:207], v[168:171], v[60:63]
    v_mfma_f32_16x16x32_bf16 v[80:83], a[204:207], v[172:175], v[80:83]
    v_mfma_f32_16x16x32_bf16 v[24:27], a[208:211], v[160:163], v[24:27]
    v_mfma_f32_16x16x32_bf16 v[44:47], a[208:211], v[164:167], v[44:47]
    v_mfma_f32_16x16x32_bf16 v[64:67], a[208:211], v[168:171], v[64:67]
    v_mfma_f32_16x16x32_bf16 v[84:87], a[208:211], v[172:175], v[84:87]
    v_mfma_f32_16x16x32_bf16 v[28:31], a[212:215], v[160:163], v[28:31]
    v_mfma_f32_16x16x32_bf16 v[48:51], a[212:215], v[164:167], v[48:51]
    v_mfma_f32_16x16x32_bf16 v[68:71], a[212:215], v[168:171], v[68:71]
    v_mfma_f32_16x16x32_bf16 v[88:91], a[212:215], v[172:175], v[88:91]
    v_mfma_f32_16x16x32_bf16 v[32:35], a[216:219], v[160:163], v[32:35]
    v_mfma_f32_16x16x32_bf16 v[52:55], a[216:219], v[164:167], v[52:55]
    v_mfma_f32_16x16x32_bf16 v[72:75], a[216:219], v[168:171], v[72:75]
    v_mfma_f32_16x16x32_bf16 v[92:95], a[216:219], v[172:175], v[92:95]
    s_waitcnt vmcnt(8)
    v_mfma_f32_16x16x32_bf16 v[16:19], a[220:223], v[176:179], v[16:19]
    v_mfma_f32_16x16x32_bf16 v[36:39], a[220:223], v[180:183], v[36:39]
    v_mfma_f32_16x16x32_bf16 v[56:59], a[220:223], v[184:187], v[56:59]
    v_mfma_f32_16x16x32_bf16 v[76:79], a[220:223], v[188:191], v[76:79]
    v_mfma_f32_16x16x32_bf16 v[20:23], a[224:227], v[176:179], v[20:23]
    v_mfma_f32_16x16x32_bf16 v[40:43], a[224:227], v[180:183], v[40:43]
    v_mfma_f32_16x16x32_bf16 v[60:63], a[224:227], v[184:187], v[60:63]
    v_mfma_f32_16x16x32_bf16 v[80:83], a[224:227], v[188:191], v[80:83]
    v_mfma_f32_16x16x32_bf16 v[24:27], a[228:231], v[176:179], v[24:27]
    v_mfma_f32_16x16x32_bf16 v[44:47], a[228:231], v[180:183], v[44:47]
    v_mfma_f32_16x16x32_bf16 v[64:67], a[228:231], v[184:187], v[64:67]
    v_mfma_f32_16x16x32_bf16 v[84:87], a[228:231], v[188:191], v[84:87]
    v_mfma_f32_16x16x32_bf16 v[28:31], a[232:235], v[176:179], v[28:31]
    v_mfma_f32_16x16x32_bf16 v[48:51], a[232:235], v[180:183], v[48:51]
    v_mfma_f32_16x16x32_bf16 v[68:71], a[232:235], v[184:187], v[68:71]
    v_mfma_f32_16x16x32_bf16 v[88:91], a[232:235], v[188:191], v[88:91]
    v_mfma_f32_16x16x32_bf16 v[32:35], a[236:239], v[176:179], v[32:35]
    v_mfma_f32_16x16x32_bf16 v[52:55], a[236:239], v[180:183], v[52:55]
    v_mfma_f32_16x16x32_bf16 v[72:75], a[236:239], v[184:187], v[72:75]
    v_mfma_f32_16x16x32_bf16 v[92:95], a[236:239], v[188:191], v[92:95]
    s_cmp_eq_u32 s30, 3
    s_cbranch_scc1 k2_kernel_k4skip38
    s_waitcnt vmcnt(4)
    v_mfma_f32_16x16x32_bf16 v[16:19], a[240:243], v[96:99], v[16:19]
    v_mfma_f32_16x16x32_bf16 v[36:39], a[240:243], v[100:103], v[36:39]
    v_mfma_f32_16x16x32_bf16 v[56:59], a[240:243], v[104:107], v[56:59]
    v_mfma_f32_16x16x32_bf16 v[76:79], a[240:243], v[108:111], v[76:79]
    v_mfma_f32_16x16x32_bf16 v[20:23], a[244:247], v[96:99], v[20:23]
    v_mfma_f32_16x16x32_bf16 v[40:43], a[244:247], v[100:103], v[40:43]
    v_mfma_f32_16x16x32_bf16 v[60:63], a[244:247], v[104:107], v[60:63]
    v_mfma_f32_16x16x32_bf16 v[80:83], a[244:247], v[108:111], v[80:83]
    v_mfma_f32_16x16x32_bf16 v[24:27], a[248:251], v[96:99], v[24:27]
    v_mfma_f32_16x16x32_bf16 v[44:47], a[248:251], v[100:103], v[44:47]
    v_mfma_f32_16x16x32_bf16 v[64:67], a[248:251], v[104:107], v[64:67]
    v_mfma_f32_16x16x32_bf16 v[84:87], a[248:251], v[108:111], v[84:87]
    v_mfma_f32_16x16x32_bf16 v[28:31], a[252:255], v[96:99], v[28:31]
    v_mfma_f32_16x16x32_bf16 v[48:51], a[252:255], v[100:103], v[48:51]
    v_mfma_f32_16x16x32_bf16 v[68:71], a[252:255], v[104:107], v[68:71]
    v_mfma_f32_16x16x32_bf16 v[88:91], a[252:255], v[108:111], v[88:91]
    v_mfma_f32_16x16x32_bf16 v[32:35], v[192:195], v[96:99], v[32:35]
    v_mfma_f32_16x16x32_bf16 v[52:55], v[192:195], v[100:103], v[52:55]
    v_mfma_f32_16x16x32_bf16 v[72:75], v[192:195], v[104:107], v[72:75]
    v_mfma_f32_16x16x32_bf16 v[92:95], v[192:195], v[108:111], v[92:95]
    s_waitcnt vmcnt(0)
    v_mfma_f32_16x16x32_bf16 v[16:19], v[196:199], v[112:115], v[16:19]
    v_mfma_f32_16x16x32_bf16 v[36:39], v[196:199], v[116:119], v[36:39]
    v_mfma_f32_16x16x32_bf16 v[56:59], v[196:199], v[120:123], v[56:59]
    v_mfma_f32_16x16x32_bf16 v[76:79], v[196:199], v[124:127], v[76:79]
    v_mfma_f32_16x16x32_bf16 v[20:23], v[200:203], v[112:115], v[20:23]
    v_mfma_f32_16x16x32_bf16 v[40:43], v[200:203], v[116:119], v[40:43]
    v_mfma_f32_16x16x32_bf16 v[60:63], v[200:203], v[120:123], v[60:63]
    v_mfma_f32_16x16x32_bf16 v[80:83], v[200:203], v[124:127], v[80:83]
    v_mfma_f32_16x16x32_bf16 v[24:27], v[204:207], v[112:115], v[24:27]
    v_mfma_f32_16x16x32_bf16 v[44:47], v[204:207], v[116:119], v[44:47]
    v_mfma_f32_16x16x32_bf16 v[64:67], v[204:207], v[120:123], v[64:67]
    v_mfma_f32_16x16x32_bf16 v[84:87], v[204:207], v[124:127], v[84:87]
    v_mfma_f32_16x16x32_bf16 v[28:31], v[208:211], v[112:115], v[28:31]
    v_mfma_f32_16x16x32_bf16 v[48:51], v[208:211], v[116:119], v[48:51]
    v_mfma_f32_16x16x32_bf16 v[68:71], v[208:211], v[120:123], v[68:71]
    v_mfma_f32_16x16x32_bf16 v[88:91], v[208:211], v[124:127], v[88:91]
    v_mfma_f32_16x16x32_bf16 v[32:35], v[212:215], v[112:115], v[32:35]
    v_mfma_f32_16x16x32_bf16 v[52:55], v[212:215], v[116:119], v[52:55]
    v_mfma_f32_16x16x32_bf16 v[72:75], v[212:215], v[120:123], v[72:75]
    v_mfma_f32_16x16x32_bf16 v[92:95], v[212:215], v[124:127], v[92:95]
k2_kernel_k4skip38:
    s_waitcnt vmcnt(0)
    s_barrier
    s_add_u32 s41, s30, 1
    s_and_b32 s41, s41, 3
    s_mul_i32 s41, s41, 15360
    s_add_u32 s41, s41, 0
    v_add_u32 v9, s41, v2
    ds_write_b128 v9, v[36:39] offset:0
    ds_write_b128 v9, v[40:43] offset:1024
    ds_write_b128 v9, v[44:47] offset:2048
    ds_write_b128 v9, v[48:51] offset:3072
    ds_write_b128 v9, v[52:55] offset:4096
    s_add_u32 s41, s30, 2
    s_and_b32 s41, s41, 3
    s_mul_i32 s41, s41, 15360
    s_add_u32 s41, s41, 5120
    v_add_u32 v9, s41, v2
    ds_write_b128 v9, v[56:59] offset:0
    ds_write_b128 v9, v[60:63] offset:1024
    ds_write_b128 v9, v[64:67] offset:2048
    ds_write_b128 v9, v[68:71] offset:3072
    ds_write_b128 v9, v[72:75] offset:4096
    s_add_u32 s41, s30, 3
    s_and_b32 s41, s41, 3
    s_mul_i32 s41, s41, 15360
    s_add_u32 s41, s41, 10240
    v_add_u32 v9, s41, v2
    ds_write_b128 v9, v[76:79] offset:0
    ds_write_b128 v9, v[80:83] offset:1024
    ds_write_b128 v9, v[84:87] offset:2048
    ds_write_b128 v9, v[88:91] offset:3072
    ds_write_b128 v9, v[92:95] offset:4096
    v_lshlrev_b32 v10, 4, v3
    v_add_u32 v10, 157696, v10
    ds_read_b128 v[96:99], v10 offset:0
    ds_read_b128 v[100:103], v10 offset:64
    ds_read_b128 v[104:107], v10 offset:128
    ds_read_b128 v[108:111], v10 offset:192
    ds_read_b128 v[112:115], v10 offset:256
    s_mul_i32 s41, s30, 15360
    v_add_u32 v9, s41, v2
    s_waitcnt lgkmcnt(0)
    s_barrier
    ds_read_b128 v[116:119], v9 offset:0
    ds_read_b128 v[120:123], v9 offset:1024
    ds_read_b128 v[124:127], v9 offset:2048
    ds_read_b128 v[128:131], v9 offset:3072
    ds_read_b128 v[132:135], v9 offset:4096
    ds_read_b128 v[136:139], v9 offset:5120
    ds_read_b128 v[140:143], v9 offset:6144
    ds_read_b128 v[144:147], v9 offset:7168
    ds_read_b128 v[148:151], v9 offset:8192
    ds_read_b128 v[152:155], v9 offset:9216
    ds_read_b128 v[156:159], v9 offset:10240
    ds_read_b128 v[160:163], v9 offset:11264
    ds_read_b128 v[164:167], v9 offset:12288
    ds_read_b128 v[168:171], v9 offset:13312
    ds_read_b128 v[172:175], v9 offset:14336
    s_lshl_b32 s46, s32, 2
    s_add_u32 s46, s46, s30
    s_lshl_b32 s46, s46, 4
    s_lshl_b32 s47, s28, 8
    s_add_u32 s46, s46, s47
    v_add_u32 v10, s46, v4
    v_mul_u32_u24 v10, 1280, v10
    v_lshl_add_u32 v10, v3, 3, v10
    s_mul_i32 s47, s33, 160
    s_nop 1
    v_permlane16_swap_b32 v228, v230
    v_permlane16_swap_b32 v229, v231
    v_permlane16_swap_b32 v232, v234
    v_permlane16_swap_b32 v233, v235
    v_permlane16_swap_b32 v238, v240
    v_permlane16_swap_b32 v239, v241
    v_permlane16_swap_b32 v242, v244
    v_permlane16_swap_b32 v243, v245
    s_waitcnt lgkmcnt(0)
    v_pk_add_f32 v[16:17], v[16:17], v[116:117]
    v_pk_add_f32 v[18:19], v[18:19], v[118:119]
    v_pk_add_f32 v[20:21], v[20:21], v[120:121]
    v_pk_add_f32 v[22:23], v[22:23], v[122:123]
    v_pk_add_f32 v[24:25], v[24:25], v[124:125]
    v_pk_add_f32 v[26:27], v[26:27], v[126:127]
    v_pk_add_f32 v[28:29], v[28:29], v[128:129]
    v_pk_add_f32 v[30:31], v[30:31], v[130:131]
    v_pk_add_f32 v[32:33], v[32:33], v[132:133]
    v_pk_add_f32 v[34:35], v[34:35], v[134:135]
    v_pk_add_f32 v[16:17], v[16:17], v[136:137]
    v_pk_add_f32 v[18:19], v[18:19], v[138:139]
    v_pk_add_f32 v[20:21], v[20:21], v[140:141]
    v_pk_add_f32 v[22:23], v[22:23], v[142:143]
    v_pk_add_f32 v[24:25], v[24:25], v[144:145]
    v_pk_add_f32 v[26:27], v[26:27], v[146:147]
    v_pk_add_f32 v[28:29], v[28:29], v[148:149]
    v_pk_add_f32 v[30:31], v[30:31], v[150:151]
    v_pk_add_f32 v[32:33], v[32:33], v[152:153]
    v_pk_add_f32 v[34:35], v[34:35], v[154:155]
    v_pk_add_f32 v[16:17], v[16:17], v[156:157]
    v_pk_add_f32 v[18:19], v[18:19], v[158:159]
    v_pk_add_f32 v[20:21], v[20:21], v[160:161]
    v_pk_add_f32 v[22:23], v[22:23], v[162:163]
    v_pk_add_f32 v[24:25], v[24:25], v[164:165]
    v_pk_add_f32 v[26:27], v[26:27], v[166:167]
    v_pk_add_f32 v[28:29], v[28:29], v[168:169]
    v_pk_add_f32 v[30:31], v[30:31], v[170:171]
    v_pk_add_f32 v[32:33], v[32:33], v[172:173]
    v_pk_add_f32 v[34:35], v[34:35], v[174:175]
    v_lshlrev_b32 v116, 16, v238
    v_and_b32 v117, 0xffff0000, v238
    v_lshlrev_b32 v118, 16, v239
    v_and_b32 v119, 0xffff0000, v239
    v_lshlrev_b32 v136, 16, v228
    v_and_b32 v137, 0xffff0000, v228
    v_lshlrev_b32 v138, 16, v229
    v_and_b32 v139, 0xffff0000, v229
    v_lshlrev_b32 v120, 16, v240
    v_and_b32 v121, 0xffff0000, v240
    v_lshlrev_b32 v122, 16, v241
    v_and_b32 v123, 0xffff0000, v241
    v_lshlrev_b32 v140, 16, v230
    v_and_b32 v141, 0xffff0000, v230
    v_lshlrev_b32 v142, 16, v231
    v_and_b32 v143, 0xffff0000, v231
    v_lshlrev_b32 v124, 16, v242
    v_and_b32 v125, 0xffff0000, v242
    v_lshlrev_b32 v126, 16, v243
    v_and_b32 v127, 0xffff0000, v243
    v_lshlrev_b32 v144, 16, v232
    v_and_b32 v145, 0xffff0000, v232
    v_lshlrev_b32 v146, 16, v233
    v_and_b32 v147, 0xffff0000, v233
    v_lshlrev_b32 v128, 16, v244
    v_and_b32 v129, 0xffff0000, v244
    v_lshlrev_b32 v130, 16, v245
    v_and_b32 v131, 0xffff0000, v245
    v_lshlrev_b32 v148, 16, v234
    v_and_b32 v149, 0xffff0000, v234
    v_lshlrev_b32 v150, 16, v235
    v_and_b32 v151, 0xffff0000, v235
    v_lshlrev_b32 v132, 16, v246
    v_and_b32 v133, 0xffff0000, v246
    v_lshlrev_b32 v134, 16, v247
    v_and_b32 v135, 0xffff0000, v247
    v_lshlrev_b32 v152, 16, v236
    v_and_b32 v153, 0xffff0000, v236
    v_lshlrev_b32 v154, 16, v237
    v_and_b32 v155, 0xffff0000, v237
    v_pk_add_f32 v[16:17], v[16:17], v[116:117]
    v_pk_add_f32 v[18:19], v[18:19], v[118:119]
    v_pk_add_f32 v[20:21], v[20:21], v[120:121]
    v_pk_add_f32 v[22:23], v[22:23], v[122:123]
    v_pk_add_f32 v[24:25], v[24:25], v[124:125]
    v_pk_add_f32 v[26:27], v[26:27], v[126:127]
    v_pk_add_f32 v[28:29], v[28:29], v[128:129]
    v_pk_add_f32 v[30:31], v[30:31], v[130:131]
    v_pk_add_f32 v[32:33], v[32:33], v[132:133]
    v_pk_add_f32 v[34:35], v[34:35], v[134:135]
    v_pk_fma_f32 v[16:17], v[16:17], v[96:97], v[136:137]
    v_pk_fma_f32 v[18:19], v[18:19], v[98:99], v[138:139]
    v_pk_fma_f32 v[20:21], v[20:21], v[100:101], v[140:141]
    v_pk_fma_f32 v[22:23], v[22:23], v[102:103], v[142:143]
    v_pk_fma_f32 v[24:25], v[24:25], v[104:105], v[144:145]
    v_pk_fma_f32 v[26:27], v[26:27], v[106:107], v[146:147]
    v_pk_fma_f32 v[28:29], v[28:29], v[108:109], v[148:149]
    v_pk_fma_f32 v[30:31], v[30:31], v[110:111], v[150:151]
    v_pk_fma_f32 v[32:33], v[32:33], v[112:113], v[152:153]
    v_pk_fma_f32 v[34:35], v[34:35], v[114:115], v[154:155]
    v_cvt_pk_bf16_f32 v16, v16, v17
    v_cvt_pk_bf16_f32 v17, v18, v19
    v_cvt_pk_bf16_f32 v18, v20, v21
    v_cvt_pk_bf16_f32 v19, v22, v23
    v_cvt_pk_bf16_f32 v24, v24, v25
    v_cvt_pk_bf16_f32 v25, v26, v27
    v_cvt_pk_bf16_f32 v26, v28, v29
    v_cvt_pk_bf16_f32 v27, v30, v31
    v_cvt_pk_bf16_f32 v32, v32, v33
    v_cvt_pk_bf16_f32 v33, v34, v35
    s_nop 1
    v_permlane16_swap_b32 v16, v18
    v_permlane16_swap_b32 v17, v19
    v_permlane16_swap_b32 v24, v26
    v_permlane16_swap_b32 v25, v27
    v_and_b32 v9, 1, v3
    v_lshlrev_b32 v9, 5, v9
    v_lshrrev_b32 v11, 1, v3
    v_lshl_add_u32 v9, v11, 4, v9
    v_lshlrev_b32 v11, 3, v3
    v_sub_u32 v11, v10, v11
    v_add_u32 v11, v11, v9
    buffer_store_dwordx4 v[16:19], v11, s[24:27], s47 offen offset:0
    buffer_store_dwordx4 v[24:27], v11, s[24:27], s47 offen offset:64
    buffer_store_dwordx2 v[32:33], v10, s[24:27], s47 offen offset:128
    s_waitcnt vmcnt(0) lgkmcnt(0)
    s_endpgm
k2_end:
    s_endpgm
CODE_END:
    s_endpgm
.section .rodata,"a"
.p2align 6
.amdhsa_kernel k1_kernel
  .amdhsa_next_free_vgpr 256
  .amdhsa_next_free_sgpr 72
  .amdhsa_accum_offset 256
  .amdhsa_group_segment_fixed_size 0
  .amdhsa_kernarg_size 128
  .amdhsa_user_sgpr_count 2
  .amdhsa_user_sgpr_kernarg_segment_ptr 1
  .amdhsa_system_sgpr_workgroup_id_x 1
  .amdhsa_float_denorm_mode_32 3
.end_amdhsa_kernel
.p2align 6
.amdhsa_kernel k2_kernel
  .amdhsa_next_free_vgpr 512
  .amdhsa_next_free_sgpr 102
  .amdhsa_accum_offset 256
  .amdhsa_group_segment_fixed_size 0
  .amdhsa_kernarg_size 128
  .amdhsa_user_sgpr_count 2
  .amdhsa_user_sgpr_kernarg_segment_ptr 1
  .amdhsa_system_sgpr_workgroup_id_x 1
  .amdhsa_float_denorm_mode_32 3
.end_amdhsa_kernel
```

```asm
; @launch kernel=k1_kernel grid=(352,1,1) block=(256,1,1) lds=48128
; @launch kernel=k2_kernel grid=(256,1,1) block=(256,1,1) lds=163840
.amdgcn_target "amdgcn-amd-amdhsa--gfx950"
.text
.globl k1_kernel
.p2align 8
.type k1_kernel,@function
k1_kernel:
    s_cmp_ge_u32 s2, 352
    s_cbranch_scc1 k1_end
    s_load_dwordx4 s[4:7], s[0:1], 32
    s_load_dwordx2 s[10:11], s[0:1], 120
    s_load_dwordx4 s[12:15], s[0:1], 8
    s_load_dwordx2 s[8:9], s[0:1], 24
    v_lshrrev_b32 v2, 6, v0
    v_and_b32 v1, 63, v0
    v_readfirstlane_b32 s20, v2
    s_sub_u32 s54, s2, 160
    s_cmp_ge_u32 s2, 256
    s_cbranch_scc1 k1_side
    s_and_b32 s55, s2, 7
    s_lshr_b32 s56, s2, 3
    s_lshl_b32 s57, s55, 9
    s_add_u32 s57, s57, 9056256
    v_mov_b32 v250, 0
    s_waitcnt lgkmcnt(0)
    s_mov_b32 s28, s10
    s_mov_b32 s29, s11
    s_mov_b32 s30, 268435456
    s_mov_b32 s31, 0x00020000
    buffer_load_dword v251, v250, s[28:31], s57 offen sc1
    s_mov_b32 s16, s12
    s_mov_b32 s17, s13
    s_mov_b32 s18, 2621440
    s_mov_b32 s19, 0x00020000
    s_mov_b32 s40, s14
    s_mov_b32 s41, s15
    s_mov_b32 s42, 2621440
    s_mov_b32 s43, 0x00020000
    s_mov_b32 s44, s8
    s_mov_b32 s45, s9
    s_mov_b32 s46, 5120
    s_mov_b32 s47, 0x00020000
    v_mul_u32_u24 v4, 3277, v0
    v_lshrrev_b32 v4, 16, v4
    v_mul_u32_u24 v5, 20, v4
    v_sub_u32 v5, v0, v5
    s_lshl_b32 s21, s56, 6
    v_lshl_add_u32 v6, v4, 3, s21
    v_mul_u32_u24 v6, 1280, v6
    s_mul_i32 s22, s55, 160
    v_lshl_add_u32 v7, v5, 3, s22
    v_add_u32 v6, v6, v7
    v_subrev_u32 v8, 3840, v6
    v_add_u32 v9, 5120, v6
    s_movk_i32 s23, 160
    v_cmp_gt_u32 vcc, s23, v0
    s_and_saveexec_b64 s[60:61], vcc
    s_cbranch_execz k1_kvld
    buffer_load_dwordx2 v[10:11], v8, s[16:19], 0 offen offset:0
    buffer_load_dwordx2 v[12:13], v8, s[16:19], 0 offen offset:1280
    buffer_load_dwordx2 v[14:15], v8, s[16:19], 0 offen offset:2560
    buffer_load_dwordx2 v[16:17], v6, s[16:19], 0 offen offset:0
    buffer_load_dwordx2 v[18:19], v6, s[16:19], 0 offen offset:1280
    buffer_load_dwordx2 v[20:21], v6, s[16:19], 0 offen offset:2560
    buffer_load_dwordx2 v[22:23], v6, s[16:19], 0 offen offset:3840
    buffer_load_dwordx2 v[24:25], v9, s[16:19], 0 offen offset:0
    buffer_load_dwordx2 v[26:27], v9, s[16:19], 0 offen offset:1280
    buffer_load_dwordx2 v[28:29], v9, s[16:19], 0 offen offset:2560
    buffer_load_dwordx2 v[30:31], v9, s[16:19], 0 offen offset:3840
    v_lshlrev_b32 v150, 2, v7
    buffer_load_dwordx4 v[48:51], v150, s[44:47], 0 offen
    buffer_load_dwordx4 v[52:55], v150, s[44:47], 0 offen offset:16
    buffer_load_dwordx2 v[32:33], v6, s[40:43], 0 offen offset:0
    buffer_load_dwordx2 v[34:35], v6, s[40:43], 0 offen offset:1280
    buffer_load_dwordx2 v[36:37], v6, s[40:43], 0 offen offset:2560
    buffer_load_dwordx2 v[38:39], v6, s[40:43], 0 offen offset:3840
    buffer_load_dwordx2 v[40:41], v9, s[40:43], 0 offen offset:0
    buffer_load_dwordx2 v[42:43], v9, s[40:43], 0 offen offset:1280
    buffer_load_dwordx2 v[44:45], v9, s[40:43], 0 offen offset:2560
    buffer_load_dwordx2 v[46:47], v9, s[40:43], 0 offen offset:3840
k1_kvld:
    s_mov_b64 exec, -1
    s_mov_b32 s24, s4
    s_mov_b32 s25, s5
    s_mov_b32 s26, 2621440
    s_mov_b32 s27, 0x00020000
    s_cmp_lt_u32 s56, 12
    s_cbranch_scc1 k1_kernel_nc1
    s_mul_i32 s58, s55, 20
    s_add_u32 s58, s58, s56
    s_sub_u32 s58, s58, 12
    s_lshl_b32 s21, s58, 2
    s_add_u32 s21, s21, s20
    s_mul_i32 s34, s20, 9472
    v_lshlrev_b32 v3, 4, v1
    s_lshl_b32 s35, s21, 12
    s_add_u32 s36, s34, 256
    s_mov_b32 m0, s36
    s_nop 0
    buffer_load_dwordx4 v3, s[24:27], s35 offen offset:0 lds
    buffer_load_dwordx4 v3, s[24:27], s35 offen offset:1024 lds
    buffer_load_dwordx4 v3, s[24:27], s35 offen offset:2048 lds
    buffer_load_dwordx4 v3, s[24:27], s35 offen offset:3072 lds
k1_kernel_nc1:
    s_mov_b64 exec, s[60:61]
    s_movk_i32 s23, 160
    v_cmp_gt_u32 vcc, s23, v0
    s_and_b64 exec, exec, vcc
    s_cbranch_execz k1_kvskip
    v_sub_u32 v150, 7, v4
    v_and_b32 v151, 7, v5
    v_xor_b32 v150, v150, v151
    v_lshlrev_b32 v150, 4, v150
    v_lshl_add_u32 v150, v5, 9, v150
    v_add_u32 v150, 37888, v150
    s_cmp_lt_u32 s56, 12
    s_cbranch_scc1 k1_w8
    s_waitcnt vmcnt(12)
    s_branch k1_w9
k1_w8:
    s_waitcnt vmcnt(8)
k1_w9:
    v_lshlrev_b32 v56, 16, v48
    v_and_b32 v60, 0xffff0000, v48
    v_lshlrev_b32 v64, 16, v49
    v_and_b32 v68, 0xffff0000, v49
    v_lshlrev_b32 v57, 16, v50
    v_and_b32 v61, 0xffff0000, v50
    v_lshlrev_b32 v65, 16, v51
    v_and_b32 v69, 0xffff0000, v51
    v_lshlrev_b32 v58, 16, v52
    v_and_b32 v62, 0xffff0000, v52
    v_lshlrev_b32 v66, 16, v53
    v_and_b32 v70, 0xffff0000, v53
    v_lshlrev_b32 v59, 16, v54
    v_and_b32 v63, 0xffff0000, v54
    v_lshlrev_b32 v67, 16, v55
    v_and_b32 v71, 0xffff0000, v55
    v_lshlrev_b32 v72, 16, v10
    v_and_b32 v73, 0xffff0000, v10
    v_lshlrev_b32 v74, 16, v11
    v_and_b32 v75, 0xffff0000, v11
    v_lshlrev_b32 v76, 16, v12
    v_and_b32 v77, 0xffff0000, v12
    v_lshlrev_b32 v78, 16, v13
    v_and_b32 v79, 0xffff0000, v13
    v_lshlrev_b32 v80, 16, v14
    v_and_b32 v81, 0xffff0000, v14
    v_lshlrev_b32 v82, 16, v15
    v_and_b32 v83, 0xffff0000, v15
    v_lshlrev_b32 v84, 16, v16
    v_and_b32 v85, 0xffff0000, v16
    v_lshlrev_b32 v86, 16, v17
    v_and_b32 v87, 0xffff0000, v17
    v_lshlrev_b32 v88, 16, v18
    v_and_b32 v89, 0xffff0000, v18
    v_lshlrev_b32 v90, 16, v19
    v_and_b32 v91, 0xffff0000, v19
    v_lshlrev_b32 v92, 16, v20
    v_and_b32 v93, 0xffff0000, v20
    v_lshlrev_b32 v94, 16, v21
    v_and_b32 v95, 0xffff0000, v21
    v_lshlrev_b32 v96, 16, v22
    v_and_b32 v97, 0xffff0000, v22
    v_lshlrev_b32 v98, 16, v23
    v_and_b32 v99, 0xffff0000, v23
    v_lshlrev_b32 v100, 16, v24
    v_and_b32 v101, 0xffff0000, v24
    v_lshlrev_b32 v102, 16, v25
    v_and_b32 v103, 0xffff0000, v25
    v_lshlrev_b32 v104, 16, v26
    v_and_b32 v105, 0xffff0000, v26
    v_lshlrev_b32 v106, 16, v27
    v_and_b32 v107, 0xffff0000, v27
    v_lshlrev_b32 v108, 16, v28
    v_and_b32 v109, 0xffff0000, v28
    v_lshlrev_b32 v110, 16, v29
    v_and_b32 v111, 0xffff0000, v29
    v_lshlrev_b32 v112, 16, v30
    v_and_b32 v113, 0xffff0000, v30
    v_lshlrev_b32 v114, 16, v31
    v_and_b32 v115, 0xffff0000, v31
    v_pk_mul_f32 v[116:117], v[72:73], v[68:69]
    v_pk_mul_f32 v[120:121], v[76:77], v[68:69]
    v_pk_mul_f32 v[124:125], v[80:81], v[68:69]
    v_pk_mul_f32 v[128:129], v[84:85], v[68:69]
    v_pk_mul_f32 v[132:133], v[88:89], v[68:69]
    v_pk_mul_f32 v[136:137], v[92:93], v[68:69]
    v_pk_mul_f32 v[140:141], v[96:97], v[68:69]
    v_pk_mul_f32 v[144:145], v[100:101], v[68:69]
    v_pk_fma_f32 v[116:117], v[76:77], v[64:65], v[116:117]
    v_pk_fma_f32 v[120:121], v[80:81], v[64:65], v[120:121]
    v_pk_fma_f32 v[124:125], v[84:85], v[64:65], v[124:125]
    v_pk_fma_f32 v[128:129], v[88:89], v[64:65], v[128:129]
    v_pk_fma_f32 v[132:133], v[92:93], v[64:65], v[132:133]
    v_pk_fma_f32 v[136:137], v[96:97], v[64:65], v[136:137]
    v_pk_fma_f32 v[140:141], v[100:101], v[64:65], v[140:141]
    v_pk_fma_f32 v[144:145], v[104:105], v[64:65], v[144:145]
    v_pk_fma_f32 v[116:117], v[80:81], v[60:61], v[116:117]
    v_pk_fma_f32 v[120:121], v[84:85], v[60:61], v[120:121]
    v_pk_fma_f32 v[124:125], v[88:89], v[60:61], v[124:125]
    v_pk_fma_f32 v[128:129], v[92:93], v[60:61], v[128:129]
    v_pk_fma_f32 v[132:133], v[96:97], v[60:61], v[132:133]
    v_pk_fma_f32 v[136:137], v[100:101], v[60:61], v[136:137]
    v_pk_fma_f32 v[140:141], v[104:105], v[60:61], v[140:141]
    v_pk_fma_f32 v[144:145], v[108:109], v[60:61], v[144:145]
    v_pk_fma_f32 v[116:117], v[84:85], v[56:57], v[116:117]
    v_pk_fma_f32 v[120:121], v[88:89], v[56:57], v[120:121]
    v_pk_fma_f32 v[124:125], v[92:93], v[56:57], v[124:125]
    v_pk_fma_f32 v[128:129], v[96:97], v[56:57], v[128:129]
    v_pk_fma_f32 v[132:133], v[100:101], v[56:57], v[132:133]
    v_pk_fma_f32 v[136:137], v[104:105], v[56:57], v[136:137]
    v_pk_fma_f32 v[140:141], v[108:109], v[56:57], v[140:141]
    v_pk_fma_f32 v[144:145], v[112:113], v[56:57], v[144:145]
    v_pk_mul_f32 v[118:119], v[74:75], v[70:71]
    v_pk_mul_f32 v[122:123], v[78:79], v[70:71]
    v_pk_mul_f32 v[126:127], v[82:83], v[70:71]
    v_pk_mul_f32 v[130:131], v[86:87], v[70:71]
    v_pk_mul_f32 v[134:135], v[90:91], v[70:71]
    v_pk_mul_f32 v[138:139], v[94:95], v[70:71]
    v_pk_mul_f32 v[142:143], v[98:99], v[70:71]
    v_pk_mul_f32 v[146:147], v[102:103], v[70:71]
    v_pk_fma_f32 v[118:119], v[78:79], v[66:67], v[118:119]
    v_pk_fma_f32 v[122:123], v[82:83], v[66:67], v[122:123]
    v_pk_fma_f32 v[126:127], v[86:87], v[66:67], v[126:127]
    v_pk_fma_f32 v[130:131], v[90:91], v[66:67], v[130:131]
    v_pk_fma_f32 v[134:135], v[94:95], v[66:67], v[134:135]
    v_pk_fma_f32 v[138:139], v[98:99], v[66:67], v[138:139]
    v_pk_fma_f32 v[142:143], v[102:103], v[66:67], v[142:143]
    v_pk_fma_f32 v[146:147], v[106:107], v[66:67], v[146:147]
    v_pk_fma_f32 v[118:119], v[82:83], v[62:63], v[118:119]
    v_pk_fma_f32 v[122:123], v[86:87], v[62:63], v[122:123]
    v_pk_fma_f32 v[126:127], v[90:91], v[62:63], v[126:127]
    v_pk_fma_f32 v[130:131], v[94:95], v[62:63], v[130:131]
    v_pk_fma_f32 v[134:135], v[98:99], v[62:63], v[134:135]
    v_pk_fma_f32 v[138:139], v[102:103], v[62:63], v[138:139]
    v_pk_fma_f32 v[142:143], v[106:107], v[62:63], v[142:143]
    v_pk_fma_f32 v[146:147], v[110:111], v[62:63], v[146:147]
    v_pk_fma_f32 v[118:119], v[86:87], v[58:59], v[118:119]
    v_pk_fma_f32 v[122:123], v[90:91], v[58:59], v[122:123]
    v_pk_fma_f32 v[126:127], v[94:95], v[58:59], v[126:127]
    v_pk_fma_f32 v[130:131], v[98:99], v[58:59], v[130:131]
    v_pk_fma_f32 v[134:135], v[102:103], v[58:59], v[134:135]
    v_pk_fma_f32 v[138:139], v[106:107], v[58:59], v[138:139]
    v_pk_fma_f32 v[142:143], v[110:111], v[58:59], v[142:143]
    v_pk_fma_f32 v[146:147], v[114:115], v[58:59], v[146:147]
    v_cvt_pk_bf16_f32 v154, v116, v117
    v_lshlrev_b32 v116, 16, v154
    v_and_b32 v117, 0xffff0000, v154
    v_cvt_pk_bf16_f32 v155, v118, v119
    v_lshlrev_b32 v118, 16, v155
    v_and_b32 v119, 0xffff0000, v155
    v_cvt_pk_bf16_f32 v156, v120, v121
    v_lshlrev_b32 v120, 16, v156
    v_and_b32 v121, 0xffff0000, v156
    v_cvt_pk_bf16_f32 v157, v122, v123
    v_lshlrev_b32 v122, 16, v157
    v_and_b32 v123, 0xffff0000, v157
    v_cvt_pk_bf16_f32 v158, v124, v125
    v_lshlrev_b32 v124, 16, v158
    v_and_b32 v125, 0xffff0000, v158
    v_cvt_pk_bf16_f32 v159, v126, v127
    v_lshlrev_b32 v126, 16, v159
    v_and_b32 v127, 0xffff0000, v159
    v_cvt_pk_bf16_f32 v160, v128, v129
    v_lshlrev_b32 v128, 16, v160
    v_and_b32 v129, 0xffff0000, v160
    v_cvt_pk_bf16_f32 v161, v130, v131
    v_lshlrev_b32 v130, 16, v161
    v_and_b32 v131, 0xffff0000, v161
    v_cvt_pk_bf16_f32 v154, v132, v133
    v_lshlrev_b32 v132, 16, v154
    v_and_b32 v133, 0xffff0000, v154
    v_cvt_pk_bf16_f32 v155, v134, v135
    v_lshlrev_b32 v134, 16, v155
    v_and_b32 v135, 0xffff0000, v155
    v_cvt_pk_bf16_f32 v156, v136, v137
    v_lshlrev_b32 v136, 16, v156
    v_and_b32 v137, 0xffff0000, v156
    v_cvt_pk_bf16_f32 v157, v138, v139
    v_lshlrev_b32 v138, 16, v157
    v_and_b32 v139, 0xffff0000, v157
    v_cvt_pk_bf16_f32 v158, v140, v141
    v_lshlrev_b32 v140, 16, v158
    v_and_b32 v141, 0xffff0000, v158
    v_cvt_pk_bf16_f32 v159, v142, v143
    v_lshlrev_b32 v142, 16, v159
    v_and_b32 v143, 0xffff0000, v159
    v_cvt_pk_bf16_f32 v160, v144, v145
    v_lshlrev_b32 v144, 16, v160
    v_and_b32 v145, 0xffff0000, v160
    v_cvt_pk_bf16_f32 v161, v146, v147
    v_lshlrev_b32 v146, 16, v161
    v_and_b32 v147, 0xffff0000, v161
    s_cmp_lt_u32 s56, 12
    s_cbranch_scc1 k1_w0
    s_waitcnt vmcnt(4)
    s_branch k1_w1
k1_w0:
    s_waitcnt vmcnt(0)
k1_w1:
    v_lshlrev_b32 v72, 16, v32
    v_and_b32 v73, 0xffff0000, v32
    v_lshlrev_b32 v74, 16, v33
    v_and_b32 v75, 0xffff0000, v33
    v_lshlrev_b32 v76, 16, v34
    v_and_b32 v77, 0xffff0000, v34
    v_lshlrev_b32 v78, 16, v35
    v_and_b32 v79, 0xffff0000, v35
    v_lshlrev_b32 v80, 16, v36
    v_and_b32 v81, 0xffff0000, v36
    v_lshlrev_b32 v82, 16, v37
    v_and_b32 v83, 0xffff0000, v37
    v_lshlrev_b32 v84, 16, v38
    v_and_b32 v85, 0xffff0000, v38
    v_lshlrev_b32 v86, 16, v39
    v_and_b32 v87, 0xffff0000, v39
    v_lshlrev_b32 v88, 16, v40
    v_and_b32 v89, 0xffff0000, v40
    v_lshlrev_b32 v90, 16, v41
    v_and_b32 v91, 0xffff0000, v41
    v_lshlrev_b32 v92, 16, v42
    v_and_b32 v93, 0xffff0000, v42
    v_lshlrev_b32 v94, 16, v43
    v_and_b32 v95, 0xffff0000, v43
    v_lshlrev_b32 v96, 16, v44
    v_and_b32 v97, 0xffff0000, v44
    v_lshlrev_b32 v98, 16, v45
    v_and_b32 v99, 0xffff0000, v45
    v_lshlrev_b32 v100, 16, v46
    v_and_b32 v101, 0xffff0000, v46
    v_lshlrev_b32 v102, 16, v47
    v_and_b32 v103, 0xffff0000, v47
    v_pk_mul_f32 v[116:117], v[116:117], v[72:73]
    v_pk_mul_f32 v[118:119], v[118:119], v[74:75]
    v_pk_mul_f32 v[120:121], v[120:121], v[76:77]
    v_pk_mul_f32 v[122:123], v[122:123], v[78:79]
    v_pk_mul_f32 v[124:125], v[124:125], v[80:81]
    v_pk_mul_f32 v[126:127], v[126:127], v[82:83]
    v_pk_mul_f32 v[128:129], v[128:129], v[84:85]
    v_pk_mul_f32 v[130:131], v[130:131], v[86:87]
    v_pk_mul_f32 v[132:133], v[132:133], v[88:89]
    v_pk_mul_f32 v[134:135], v[134:135], v[90:91]
    v_pk_mul_f32 v[136:137], v[136:137], v[92:93]
    v_pk_mul_f32 v[138:139], v[138:139], v[94:95]
    v_pk_mul_f32 v[140:141], v[140:141], v[96:97]
    v_pk_mul_f32 v[142:143], v[142:143], v[98:99]
    v_pk_mul_f32 v[144:145], v[144:145], v[100:101]
    v_pk_mul_f32 v[146:147], v[146:147], v[102:103]
    v_cvt_pk_bf16_f32 v10, v144, v140
    v_cvt_pk_bf16_f32 v11, v136, v132
    v_cvt_pk_bf16_f32 v12, v128, v124
    v_cvt_pk_bf16_f32 v13, v120, v116
    v_cvt_pk_bf16_f32 v14, v145, v141
    v_cvt_pk_bf16_f32 v15, v137, v133
    v_cvt_pk_bf16_f32 v16, v129, v125
    v_cvt_pk_bf16_f32 v17, v121, v117
    v_cvt_pk_bf16_f32 v18, v146, v142
    v_cvt_pk_bf16_f32 v19, v138, v134
    v_cvt_pk_bf16_f32 v20, v130, v126
    v_cvt_pk_bf16_f32 v21, v122, v118
    v_cvt_pk_bf16_f32 v22, v147, v143
    v_cvt_pk_bf16_f32 v23, v139, v135
    v_cvt_pk_bf16_f32 v24, v131, v127
    v_cvt_pk_bf16_f32 v25, v123, v119
    ds_write_b128 v150, v[10:13] offset:0
    ds_write_b128 v150, v[14:17] offset:128
    ds_write_b128 v150, v[18:21] offset:256
    ds_write_b128 v150, v[22:25] offset:384
k1_kvskip:
    s_mov_b64 exec, -1
    v_lshrrev_b32 v151, 3, v0
    v_and_b32 v152, 7, v0
    v_lshrrev_b32 v153, 2, v151
    v_and_b32 v153, 7, v153
    v_xor_b32 v153, v153, v152
    v_lshlrev_b32 v153, 4, v153
    v_lshl_add_u32 v153, v151, 7, v153
    v_add_u32 v153, 37888, v153
    v_mul_u32_u24 v151, 4224, v151
    v_lshl_add_u32 v154, v152, 4, v151
    s_mul_i32 s36, s55, 337920
    s_add_u32 s36, s36, 0
    s_lshl_b32 s37, s56, 7
    s_sub_u32 s38, 3968, s37
    s_add_u32 s38, s38, s36
    s_waitcnt lgkmcnt(0)
    s_barrier
    ds_read_b128 v[32:35], v153 offset:0
    ds_read_b128 v[36:39], v153 offset:4096
    ds_read_b128 v[40:43], v153 offset:8192
    s_waitcnt lgkmcnt(2)
    buffer_store_dwordx4 v[32:35], v154, s[28:31], s38 offen sc1
    s_add_u32 s38, s38, 135168
    s_waitcnt lgkmcnt(1)
    buffer_store_dwordx4 v[36:39], v154, s[28:31], s38 offen sc1
    s_add_u32 s38, s38, 135168
    s_movk_i32 s23, 128
    v_cmp_gt_u32 vcc, s23, v0
    s_and_saveexec_b64 s[60:61], vcc
    s_cbranch_execz k1_st2skip
    s_waitcnt lgkmcnt(0)
    buffer_store_dwordx4 v[40:43], v154, s[28:31], s38 offen sc1
    s_add_u32 s38, s38, 135168
k1_st2skip:
    s_mov_b64 exec, -1
    s_cmp_lg_u32 s56, 0
    s_cbranch_scc1 k1_kernel_L2
    v_mov_b32 v44, 0
    v_mov_b32 v45, 0
    v_mov_b32 v46, 0
    v_mov_b32 v47, 0
    s_add_u32 s36, s36, 4096
    buffer_store_dwordx4 v[44:47], v154, s[28:31], s36 offen sc1
    s_add_u32 s36, s36, 135168
    buffer_store_dwordx4 v[44:47], v154, s[28:31], s36 offen sc1
    s_add_u32 s36, s36, 135168
    s_movk_i32 s23, 128
    v_cmp_gt_u32 vcc, s23, v0
    s_and_b64 exec, exec, vcc
    s_cbranch_execz k1_kernel_L2
    buffer_store_dwordx4 v[44:47], v154, s[28:31], s36 offen sc1
    s_add_u32 s36, s36, 135168
k1_kernel_L2:
    s_mov_b64 exec, -1
    s_waitcnt vmcnt(0)
    v_add_u32 v251, 1, v251
    s_barrier
    s_cmp_lg_u32 s20, 0
    s_cbranch_scc1 k1_kernel_kf3
    s_lshl_b32 s23, s56, 2
    s_add_u32 s23, s23, s57
    s_mov_b64 exec, 1
    buffer_store_dword v251, v250, s[28:31], s23 offen offset:256
    buffer_store_dword v251, v250, s[28:31], s23 offen offset:128 sc1
    s_mov_b64 exec, -1
k1_kernel_kf3:
    s_lshl_b32 s54, s56, 3
    s_add_u32 s54, s54, s55
    s_cmp_lt_u32 s56, 12
    s_cbranch_scc1 k1_side2
    s_mov_b32 s2, s58
    s_setprio 3
    s_lshl_b32 s21, s2, 3
    s_add_u32 s22, s6, s21
    s_addc_u32 s23, s7, 0
    s_load_dwordx2 s[32:33], s[22:23], 0
    s_lshl_b32 s21, s2, 2
    s_add_u32 s21, s21, s20
    s_mul_i32 s34, s20, 9472
    v_lshlrev_b32 v3, 4, v1
    s_mul_i32 s37, s21, 4224
    s_add_u32 s37, s37, 0
    v_lshrrev_b32 v4, 3, v0
    v_mul_u32_u24 v4, 20480, v4
    s_lshr_b32 s38, s2, 1
    s_and_b32 s38, s38, 7
    v_and_b32 v5, 7, v0
    v_xor_b32 v5, s38, v5
    v_lshl_add_u32 v4, v5, 4, v4
    s_lshl_b32 s38, s2, 7
    v_add_u32 v20, 0, v1
    v_mul_u32_u24 v21, 3856, v20
    v_lshrrev_b32 v21, 16, v21
    v_mul_u32_u24 v22, 17, v21
    v_sub_u32 v22, v20, v22
    v_lshlrev_b32 v22, 4, v22
    v_lshlrev_b32 v21, 8, v21
    v_sub_u32 v22, v22, v21
    v_add_u32 v23, 3840, v22
    v_add_u32 v20, 64, v1
    v_mul_u32_u24 v21, 3856, v20
    v_lshrrev_b32 v21, 16, v21
    v_mul_u32_u24 v22, 17, v21
    v_sub_u32 v22, v20, v22
    v_lshlrev_b32 v22, 4, v22
    v_lshlrev_b32 v21, 8, v21
    v_sub_u32 v22, v22, v21
    v_add_u32 v24, 3840, v22
    v_add_u32 v20, 128, v1
    v_mul_u32_u24 v21, 3856, v20
    v_lshrrev_b32 v21, 16, v21
    v_mul_u32_u24 v22, 17, v21
    v_sub_u32 v22, v20, v22
    v_lshlrev_b32 v22, 4, v22
    v_lshlrev_b32 v21, 8, v21
    v_sub_u32 v22, v22, v21
    v_add_u32 v25, 3840, v22
    v_add_u32 v20, 192, v1
    v_mul_u32_u24 v21, 3856, v20
    v_lshrrev_b32 v21, 16, v21
    v_mul_u32_u24 v22, 17, v21
    v_sub_u32 v22, v20, v22
    v_lshlrev_b32 v22, 4, v22
    v_lshlrev_b32 v21, 8, v21
    v_sub_u32 v22, v22, v21
    v_add_u32 v26, 3840, v22
    v_add_u32 v20, 256, v1
    v_mul_u32_u24 v21, 3856, v20
    v_lshrrev_b32 v21, 16, v21
    v_mul_u32_u24 v22, 17, v21
    v_sub_u32 v22, v20, v22
    v_lshlrev_b32 v22, 4, v22
    v_lshlrev_b32 v21, 8, v21
    v_sub_u32 v22, v22, v21
    v_add_u32 v27, 3840, v22
    v_lshl_add_u32 v5, v1, 2, s34
    v_mov_b32 v6, 0
    ds_write_b32 v5, v6
    v_and_b32 v7, 15, v1
    v_bfe_u32 v8, v1, 4, 1
    v_lshrrev_b32 v9, 5, v1
    v_mul_u32_u24 v10, 272, v7
    v_lshl_add_u32 v10, v9, 4, v10
    v_add_u32 v10, s34, v10
    v_add_u32 v10, 4356, v10
    v_lshlrev_b32 v11, 2, v8
    v_sub_u32 v10, v10, v11
    v_and_b32 v12, 7, v1
    v_mul_u32_u24 v13, 272, v12
    v_lshl_add_u32 v13, v9, 4, v13
    v_add_u32 v13, s34, v13
    v_add_u32 v13, 4356, v13
    v_sub_u32 v13, v13, v11
    v_bfe_u32 v11, v1, 3, 1
    v_lshlrev_b32 v11, 4, v11
    v_sub_u32 v11, 16, v11
    v_and_b32 v14, 31, v1
    v_lshlrev_b32 v14, 3, v14
    v_lshl_add_u32 v14, v9, 4, v14
    v_add_u32 v14, s34, v14
    v_add_u32 v14, 8, v14
    v_cmp_ne_u32 vcc, 0, v12
    v_mov_b32 v16, 0
    s_nop 1
    v_cndmask_b32 v15, v16, -1, vcc
    s_waitcnt lgkmcnt(0)
    ds_read_b64 v[176:177], v14 offset:1792
    ds_read_b64 v[178:179], v14 offset:1800
    ds_read_b64 v[180:181], v14 offset:1824
    ds_read_b64 v[182:183], v14 offset:1832
    ds_read_b64 v[184:185], v14 offset:1856
    ds_read_b64 v[186:187], v14 offset:1864
    ds_read_b64 v[188:189], v14 offset:1888
    ds_read_b64 v[190:191], v14 offset:1896
    ds_read_b64 v[192:193], v14 offset:1920
    ds_read_b64 v[194:195], v14 offset:1928
    ds_read_b64 v[196:197], v14 offset:1952
    ds_read_b64 v[198:199], v14 offset:1960
    ds_read_b64 v[200:201], v14 offset:1984
    ds_read_b64 v[202:203], v14 offset:1992
    ds_read_b64 v[204:205], v14 offset:2016
    ds_read_b64 v[206:207], v14 offset:2024
    s_cmp_lg_u32 s20, 0
    s_cbranch_scc1 k1_kernel_kw4
    v_and_b32 v40, 31, v1
    v_lshlrev_b32 v40, 2, v40
    s_mov_b32 s23, 200000
    s_mov_b64 s[60:61], 0
k1_kernel_kp5:
    buffer_load_dword v41, v40, s[28:31], s57 offen offset:256 sc1
    s_waitcnt vmcnt(0)
    v_cmp_eq_u32 vcc, v251, v41
    s_sub_u32 s23, s23, 1
    s_or_b64 s[60:61], s[60:61], vcc
    s_cmp_eq_u64 s[60:61], -1
    s_cbranch_scc1 k1_kernel_kd6
    s_and_b32 s21, s23, 3
    s_cmp_lg_u32 s21, 0
    s_cbranch_scc1 k1_kernel_kq8
    buffer_load_dword v41, v40, s[28:31], s57 offen offset:128 sc1
    s_waitcnt vmcnt(0)
    v_cmp_eq_u32 vcc, v251, v41
    s_nop 1
    s_or_b64 s[60:61], s[60:61], vcc
    s_cmp_eq_u64 s[60:61], -1
    s_cbranch_scc1 k1_kernel_kd6
k1_kernel_kq8:
    s_sleep 2
    s_cmp_lg_u32 s23, 0
    s_cbranch_scc1 k1_kernel_kp5
k1_kernel_kd6:
    s_cmp_lg_u32 s56, 12
    s_cbranch_scc1 k1_kernel_kw4
    s_mov_b64 exec, 1
    buffer_store_dword v251, v250, s[28:31], s57 offen sc1
    s_mov_b64 exec, -1
k1_kernel_kw4:
    s_barrier
    s_add_u32 s36, s34, 4352
    s_mov_b32 m0, s36
    s_nop 0
    buffer_load_dwordx4 v23, s[28:31], s37 offen sc1 lds
    s_add_u32 s36, s34, 5376
    s_mov_b32 m0, s36
    s_nop 0
    buffer_load_dwordx4 v24, s[28:31], s37 offen sc1 lds
    s_add_u32 s36, s34, 6400
    s_mov_b32 m0, s36
    s_nop 0
    buffer_load_dwordx4 v25, s[28:31], s37 offen sc1 lds
    s_add_u32 s36, s34, 7424
    s_mov_b32 m0, s36
    s_nop 0
    buffer_load_dwordx4 v26, s[28:31], s37 offen sc1 lds
    s_add_u32 s36, s34, 8448
    s_mov_b32 m0, s36
    s_mov_b64 exec, 0xffff
    buffer_load_dwordx4 v27, s[28:31], s37 offen sc1 lds
    s_mov_b64 exec, -1
    s_waitcnt vmcnt(0) lgkmcnt(0)
    ds_read2_b32 v[64:65], v10 offset0:0 offset1:1
    ds_read2_b32 v[66:67], v10 offset0:2 offset1:3
    ds_read2_b32 v[68:69], v10 offset0:8 offset1:9
    ds_read2_b32 v[70:71], v10 offset0:10 offset1:11
    ds_read2_b32 v[72:73], v10 offset0:16 offset1:17
    ds_read2_b32 v[74:75], v10 offset0:18 offset1:19
    ds_read2_b32 v[76:77], v10 offset0:24 offset1:25
    ds_read2_b32 v[78:79], v10 offset0:26 offset1:27
    ds_read2_b32 v[80:81], v10 offset0:32 offset1:33
    ds_read2_b32 v[82:83], v10 offset0:34 offset1:35
    ds_read2_b32 v[84:85], v10 offset0:40 offset1:41
    ds_read2_b32 v[86:87], v10 offset0:42 offset1:43
    ds_read2_b32 v[88:89], v10 offset0:48 offset1:49
    ds_read2_b32 v[90:91], v10 offset0:50 offset1:51
    ds_read2_b32 v[92:93], v10 offset0:56 offset1:57
    ds_read2_b32 v[94:95], v10 offset0:58 offset1:59
    s_waitcnt lgkmcnt(0)
    v_mfma_f32_32x32x16_bf16 v[144:159], v[176:179], v[64:67], 0
    ds_read_b32 v16, v10 offset:16
    ds_read_b32 v17, v10 offset:48
    ds_read_b32 v18, v10 offset:80
    ds_read_b32 v19, v10 offset:112
    ds_read_b32 v20, v10 offset:144
    ds_read_b32 v21, v10 offset:176
    ds_read_b32 v22, v10 offset:208
    ds_read_b32 v23, v10 offset:240
    ds_read2_b32 v[96:97], v13 offset0:0 offset1:1
    ds_read2_b32 v[98:99], v13 offset0:2 offset1:3
    ds_read_b32 v24, v13 offset:16
    ds_read2_b32 v[100:101], v13 offset0:8 offset1:9
    ds_read2_b32 v[102:103], v13 offset0:10 offset1:11
    ds_read_b32 v25, v13 offset:48
    ds_read2_b32 v[104:105], v13 offset0:16 offset1:17
    ds_read2_b32 v[106:107], v13 offset0:18 offset1:19
    v_mfma_f32_32x32x16_bf16 v[144:159], v[180:183], v[68:71], v[144:159]
    ds_read_b32 v26, v13 offset:80
    ds_read2_b32 v[108:109], v13 offset0:24 offset1:25
    ds_read2_b32 v[110:111], v13 offset0:26 offset1:27
    ds_read_b32 v27, v13 offset:112
    ds_read2_b32 v[112:113], v13 offset0:32 offset1:33
    ds_read2_b32 v[114:115], v13 offset0:34 offset1:35
    ds_read_b32 v28, v13 offset:144
    ds_read2_b32 v[116:117], v13 offset0:40 offset1:41
    ds_read2_b32 v[118:119], v13 offset0:42 offset1:43
    ds_read_b32 v29, v13 offset:176
    ds_read2_b32 v[120:121], v13 offset0:48 offset1:49
    ds_read2_b32 v[122:123], v13 offset0:50 offset1:51
    ds_read_b32 v30, v13 offset:208
    ds_read2_b32 v[124:125], v13 offset0:56 offset1:57
    ds_read2_b32 v[126:127], v13 offset0:58 offset1:59
    ds_read_b32 v31, v13 offset:240
    v_mfma_f32_32x32x16_bf16 v[144:159], v[184:187], v[72:75], v[144:159]
    s_waitcnt lgkmcnt(15)
    s_waitcnt lgkmcnt(0)
    v_alignbit_b32 v32, v65, v64, 16
    v_alignbit_b32 v33, v66, v65, 16
    v_alignbit_b32 v34, v67, v66, 16
    v_alignbit_b32 v35, v16, v67, 16
    v_mfma_f32_32x32x16_bf16 v[144:159], v[188:191], v[76:79], v[144:159]
    v_alignbit_b32 v36, v69, v68, 16
    v_alignbit_b32 v37, v70, v69, 16
    v_alignbit_b32 v38, v71, v70, 16
    v_alignbit_b32 v39, v17, v71, 16
    v_alignbit_b32 v40, v73, v72, 16
    v_alignbit_b32 v41, v74, v73, 16
    v_mfma_f32_32x32x16_bf16 v[144:159], v[192:195], v[80:83], v[144:159]
    v_alignbit_b32 v42, v75, v74, 16
    v_alignbit_b32 v43, v18, v75, 16
    v_alignbit_b32 v44, v77, v76, 16
    v_alignbit_b32 v45, v78, v77, 16
    v_alignbit_b32 v46, v79, v78, 16
    v_alignbit_b32 v47, v19, v79, 16
    v_mfma_f32_32x32x16_bf16 v[144:159], v[196:199], v[84:87], v[144:159]
    v_alignbit_b32 v48, v81, v80, 16
    v_alignbit_b32 v49, v82, v81, 16
    v_alignbit_b32 v50, v83, v82, 16
    v_alignbit_b32 v51, v20, v83, 16
    v_alignbit_b32 v52, v85, v84, 16
    v_alignbit_b32 v53, v86, v85, 16
    v_mfma_f32_32x32x16_bf16 v[144:159], v[200:203], v[88:91], v[144:159]
    v_alignbit_b32 v54, v87, v86, 16
    v_alignbit_b32 v55, v21, v87, 16
    v_alignbit_b32 v56, v89, v88, 16
    v_alignbit_b32 v57, v90, v89, 16
    v_alignbit_b32 v58, v91, v90, 16
    v_alignbit_b32 v59, v22, v91, 16
    v_mfma_f32_32x32x16_bf16 v[144:159], v[204:207], v[92:95], v[144:159]
    v_alignbit_b32 v60, v93, v92, 16
    v_alignbit_b32 v61, v94, v93, 16
    v_alignbit_b32 v62, v95, v94, 16
    v_alignbit_b32 v63, v23, v95, 16
    s_nop 0
    v_mfma_f32_32x32x16_bf16 v[128:143], v[176:179], v[32:35], 0
    ds_read_b64 v[208:209], v14 offset:3840
    ds_read_b64 v[210:211], v14 offset:3848
    s_nop 2
    v_mfma_f32_32x32x16_bf16 v[128:143], v[180:183], v[36:39], v[128:143]
    ds_read_b64 v[212:213], v14 offset:3872
    ds_read_b64 v[214:215], v14 offset:3880
    s_nop 2
    v_mfma_f32_32x32x16_bf16 v[128:143], v[184:187], v[40:43], v[128:143]
    ds_read_b64 v[216:217], v14 offset:3904
    ds_read_b64 v[218:219], v14 offset:3912
    v_alignbit_b32 v96, v97, v96, v11
    v_alignbit_b32 v97, v98, v97, v11
    v_alignbit_b32 v98, v99, v98, v11
    v_alignbit_b32 v99, v24, v99, v11
    v_alignbit_b32 v100, v101, v100, v11
    v_alignbit_b32 v101, v102, v101, v11
    v_alignbit_b32 v102, v103, v102, v11
    v_alignbit_b32 v103, v25, v103, v11
    v_alignbit_b32 v104, v105, v104, v11
    v_mfma_f32_32x32x16_bf16 v[128:143], v[188:191], v[44:47], v[128:143]
    ds_read_b64 v[220:221], v14 offset:3936
    ds_read_b64 v[222:223], v14 offset:3944
    v_alignbit_b32 v105, v106, v105, v11
    v_alignbit_b32 v106, v107, v106, v11
    v_alignbit_b32 v107, v26, v107, v11
    v_alignbit_b32 v108, v109, v108, v11
    v_alignbit_b32 v109, v110, v109, v11
    v_alignbit_b32 v110, v111, v110, v11
    v_alignbit_b32 v111, v27, v111, v11
    v_mov_b32_dpp v144, v144 row_shr:1 row_mask:0xf bank_mask:0xf bound_ctrl:0
    v_mfma_f32_32x32x16_bf16 v[128:143], v[192:195], v[48:51], v[128:143]
    ds_read_b64 v[224:225], v14 offset:3968
    ds_read_b64 v[226:227], v14 offset:3976
    v_mov_b32_dpp v145, v145 row_shr:1 row_mask:0xf bank_mask:0xf bound_ctrl:0
    v_mov_b32_dpp v146, v146 row_shr:1 row_mask:0xf bank_mask:0xf bound_ctrl:0
    v_mov_b32_dpp v147, v147 row_shr:1 row_mask:0xf bank_mask:0xf bound_ctrl:0
    v_mov_b32_dpp v148, v148 row_shr:1 row_mask:0xf bank_mask:0xf bound_ctrl:0
    v_mov_b32_dpp v149, v149 row_shr:1 row_mask:0xf bank_mask:0xf bound_ctrl:0
    v_mov_b32_dpp v150, v150 row_shr:1 row_mask:0xf bank_mask:0xf bound_ctrl:0
    v_mov_b32_dpp v151, v151 row_shr:1 row_mask:0xf bank_mask:0xf bound_ctrl:0
    v_mov_b32_dpp v152, v152 row_shr:1 row_mask:0xf bank_mask:0xf bound_ctrl:0
    v_mfma_f32_32x32x16_bf16 v[128:143], v[196:199], v[52:55], v[128:143]
    ds_read_b64 v[228:229], v14 offset:4000
    ds_read_b64 v[230:231], v14 offset:4008
    v_mov_b32_dpp v153, v153 row_shr:1 row_mask:0xf bank_mask:0xf bound_ctrl:0
    v_mov_b32_dpp v154, v154 row_shr:1 row_mask:0xf bank_mask:0xf bound_ctrl:0
    v_mov_b32_dpp v155, v155 row_shr:1 row_mask:0xf bank_mask:0xf bound_ctrl:0
    v_mov_b32_dpp v156, v156 row_shr:1 row_mask:0xf bank_mask:0xf bound_ctrl:0
    v_mov_b32_dpp v157, v157 row_shr:1 row_mask:0xf bank_mask:0xf bound_ctrl:0
    v_mov_b32_dpp v158, v158 row_shr:1 row_mask:0xf bank_mask:0xf bound_ctrl:0
    v_mov_b32_dpp v159, v159 row_shr:1 row_mask:0xf bank_mask:0xf bound_ctrl:0
    v_alignbit_b32 v112, v113, v112, v11
    v_mfma_f32_32x32x16_bf16 v[128:143], v[200:203], v[56:59], v[128:143]
    ds_read_b64 v[232:233], v14 offset:4032
    ds_read_b64 v[234:235], v14 offset:4040
    v_alignbit_b32 v113, v114, v113, v11
    v_alignbit_b32 v114, v115, v114, v11
    v_alignbit_b32 v115, v28, v115, v11
    v_alignbit_b32 v116, v117, v116, v11
    v_alignbit_b32 v117, v118, v117, v11
    v_alignbit_b32 v118, v119, v118, v11
    v_alignbit_b32 v119, v29, v119, v11
    v_alignbit_b32 v120, v121, v120, v11
    v_mfma_f32_32x32x16_bf16 v[128:143], v[204:207], v[60:63], v[128:143]
    ds_read_b64 v[236:237], v14 offset:4064
    ds_read_b64 v[238:239], v14 offset:4072
    v_alignbit_b32 v121, v122, v121, v11
    v_alignbit_b32 v122, v123, v122, v11
    v_alignbit_b32 v123, v30, v123, v11
    v_alignbit_b32 v124, v125, v124, v11
    v_alignbit_b32 v125, v126, v125, v11
    v_alignbit_b32 v126, v127, v126, v11
    v_alignbit_b32 v127, v31, v127, v11
    s_nop 0
    s_waitcnt lgkmcnt(0)
    v_mfma_f32_32x32x16_bf16 v[160:175], v[208:211], v[96:99], 0
    ds_read_b64 v[176:177], v14 offset:1536
    ds_read_b64 v[178:179], v14 offset:1544
    ds_read_b64 v[180:181], v14 offset:1568
    ds_read_b64 v[182:183], v14 offset:1576
    s_nop 0
    v_mfma_f32_32x32x16_bf16 v[160:175], v[212:215], v[100:103], v[160:175]
    ds_read_b64 v[184:185], v14 offset:1600
    ds_read_b64 v[186:187], v14 offset:1608
    ds_read_b64 v[188:189], v14 offset:1632
    s_nop 1
    v_mfma_f32_32x32x16_bf16 v[160:175], v[216:219], v[104:107], v[160:175]
    ds_read_b64 v[190:191], v14 offset:1640
    ds_read_b64 v[192:193], v14 offset:1664
    ds_read_b64 v[194:195], v14 offset:1672
    v_mov_b32_dpp v128, v128 row_shr:1 row_mask:0xf bank_mask:0xf bound_ctrl:0
    v_mov_b32_dpp v129, v129 row_shr:1 row_mask:0xf bank_mask:0xf bound_ctrl:0
    v_mov_b32_dpp v130, v130 row_shr:1 row_mask:0xf bank_mask:0xf bound_ctrl:0
    v_mfma_f32_32x32x16_bf16 v[160:175], v[220:223], v[108:111], v[160:175]
    ds_read_b64 v[196:197], v14 offset:1696
    ds_read_b64 v[198:199], v14 offset:1704
    ds_read_b64 v[200:201], v14 offset:1728
    v_mov_b32_dpp v131, v131 row_shr:1 row_mask:0xf bank_mask:0xf bound_ctrl:0
    v_mov_b32_dpp v132, v132 row_shr:1 row_mask:0xf bank_mask:0xf bound_ctrl:0
    v_mov_b32_dpp v133, v133 row_shr:1 row_mask:0xf bank_mask:0xf bound_ctrl:0
    v_mfma_f32_32x32x16_bf16 v[160:175], v[224:227], v[112:115], v[160:175]
    ds_read_b64 v[202:203], v14 offset:1736
    ds_read_b64 v[204:205], v14 offset:1760
    ds_read_b64 v[206:207], v14 offset:1768
    v_mov_b32_dpp v134, v134 row_shr:1 row_mask:0xf bank_mask:0xf bound_ctrl:0
    v_mov_b32_dpp v135, v135 row_shr:1 row_mask:0xf bank_mask:0xf bound_ctrl:0
    v_mov_b32_dpp v136, v136 row_shr:1 row_mask:0xf bank_mask:0xf bound_ctrl:0
    v_mfma_f32_32x32x16_bf16 v[160:175], v[228:231], v[116:119], v[160:175]
    v_mov_b32_dpp v137, v137 row_shr:1 row_mask:0xf bank_mask:0xf bound_ctrl:0
    v_mov_b32_dpp v138, v138 row_shr:1 row_mask:0xf bank_mask:0xf bound_ctrl:0
    v_mov_b32_dpp v139, v139 row_shr:1 row_mask:0xf bank_mask:0xf bound_ctrl:0
    v_mfma_f32_32x32x16_bf16 v[160:175], v[232:235], v[120:123], v[160:175]
    v_mov_b32_dpp v140, v140 row_shr:1 row_mask:0xf bank_mask:0xf bound_ctrl:0
    v_mov_b32_dpp v141, v141 row_shr:1 row_mask:0xf bank_mask:0xf bound_ctrl:0
    v_mfma_f32_32x32x16_bf16 v[160:175], v[236:239], v[124:127], v[160:175]
    v_mov_b32_dpp v142, v142 row_shr:1 row_mask:0xf bank_mask:0xf bound_ctrl:0
    v_mov_b32_dpp v143, v143 row_shr:1 row_mask:0xf bank_mask:0xf bound_ctrl:0
    s_waitcnt lgkmcnt(0)
    v_mfma_f32_32x32x16_bf16 v[144:159], v[176:179], v[64:67], v[144:159]
    ds_read_b64 v[208:209], v14 offset:3584
    ds_read_b64 v[210:211], v14 offset:3592
    s_nop 2
    v_mfma_f32_32x32x16_bf16 v[144:159], v[180:183], v[68:71], v[144:159]
    ds_read_b64 v[212:213], v14 offset:3616
    ds_read_b64 v[214:215], v14 offset:3624
    s_nop 2
    v_mfma_f32_32x32x16_bf16 v[144:159], v[184:187], v[72:75], v[144:159]
    ds_read_b64 v[216:217], v14 offset:3648
    ds_read_b64 v[218:219], v14 offset:3656
    v_and_b32_dpp v160, v160, v15 row_shr:1 row_mask:0xf bank_mask:0xf bound_ctrl:0
    v_and_b32_dpp v161, v161, v15 row_shr:1 row_mask:0xf bank_mask:0xf bound_ctrl:0
    v_and_b32_dpp v162, v162, v15 row_shr:1 row_mask:0xf bank_mask:0xf bound_ctrl:0
    v_mfma_f32_32x32x16_bf16 v[144:159], v[188:191], v[76:79], v[144:159]
    ds_read_b64 v[220:221], v14 offset:3680
    ds_read_b64 v[222:223], v14 offset:3688
    v_and_b32_dpp v163, v163, v15 row_shr:1 row_mask:0xf bank_mask:0xf bound_ctrl:0
    v_and_b32_dpp v164, v164, v15 row_shr:1 row_mask:0xf bank_mask:0xf bound_ctrl:0
    v_and_b32_dpp v165, v165, v15 row_shr:1 row_mask:0xf bank_mask:0xf bound_ctrl:0
    v_mfma_f32_32x32x16_bf16 v[144:159], v[192:195], v[80:83], v[144:159]
    ds_read_b64 v[224:225], v14 offset:3712
    ds_read_b64 v[226:227], v14 offset:3720
    v_and_b32_dpp v166, v166, v15 row_shr:1 row_mask:0xf bank_mask:0xf bound_ctrl:0
    v_and_b32_dpp v167, v167, v15 row_shr:1 row_mask:0xf bank_mask:0xf bound_ctrl:0
    v_and_b32_dpp v168, v168, v15 row_shr:1 row_mask:0xf bank_mask:0xf bound_ctrl:0
    v_mfma_f32_32x32x16_bf16 v[144:159], v[196:199], v[84:87], v[144:159]
    ds_read_b64 v[228:229], v14 offset:3744
    ds_read_b64 v[230:231], v14 offset:3752
    v_and_b32_dpp v169, v169, v15 row_shr:1 row_mask:0xf bank_mask:0xf bound_ctrl:0
    v_and_b32_dpp v170, v170, v15 row_shr:1 row_mask:0xf bank_mask:0xf bound_ctrl:0
    v_and_b32_dpp v171, v171, v15 row_shr:1 row_mask:0xf bank_mask:0xf bound_ctrl:0
    v_mfma_f32_32x32x16_bf16 v[144:159], v[200:203], v[88:91], v[144:159]
    ds_read_b64 v[232:233], v14 offset:3776
    ds_read_b64 v[234:235], v14 offset:3784
    v_and_b32_dpp v172, v172, v15 row_shr:1 row_mask:0xf bank_mask:0xf bound_ctrl:0
    v_and_b32_dpp v173, v173, v15 row_shr:1 row_mask:0xf bank_mask:0xf bound_ctrl:0
    v_mfma_f32_32x32x16_bf16 v[144:159], v[204:207], v[92:95], v[144:159]
    ds_read_b64 v[236:237], v14 offset:3808
    ds_read_b64 v[238:239], v14 offset:3816
    v_and_b32_dpp v174, v174, v15 row_shr:1 row_mask:0xf bank_mask:0xf bound_ctrl:0
    v_and_b32_dpp v175, v175, v15 row_shr:1 row_mask:0xf bank_mask:0xf bound_ctrl:0
    v_mfma_f32_32x32x16_bf16 v[128:143], v[176:179], v[32:35], v[128:143]
    s_nop 4
    v_mfma_f32_32x32x16_bf16 v[128:143], v[180:183], v[36:39], v[128:143]
    s_nop 4
    v_mfma_f32_32x32x16_bf16 v[128:143], v[184:187], v[40:43], v[128:143]
    v_mov_b32_dpp v144, v144 row_shr:1 row_mask:0xf bank_mask:0xf bound_ctrl:0
    v_mov_b32_dpp v145, v145 row_shr:1 row_mask:0xf bank_mask:0xf bound_ctrl:0
    v_mov_b32_dpp v146, v146 row_shr:1 row_mask:0xf bank_mask:0xf bound_ctrl:0
    v_mfma_f32_32x32x16_bf16 v[128:143], v[188:191], v[44:47], v[128:143]
    v_mov_b32_dpp v147, v147 row_shr:1 row_mask:0xf bank_mask:0xf bound_ctrl:0
    v_mov_b32_dpp v148, v148 row_shr:1 row_mask:0xf bank_mask:0xf bound_ctrl:0
    v_mov_b32_dpp v149, v149 row_shr:1 row_mask:0xf bank_mask:0xf bound_ctrl:0
    v_mfma_f32_32x32x16_bf16 v[128:143], v[192:195], v[48:51], v[128:143]
    v_mov_b32_dpp v150, v150 row_shr:1 row_mask:0xf bank_mask:0xf bound_ctrl:0
    v_mov_b32_dpp v151, v151 row_shr:1 row_mask:0xf bank_mask:0xf bound_ctrl:0
    v_mov_b32_dpp v152, v152 row_shr:1 row_mask:0xf bank_mask:0xf bound_ctrl:0
    v_mfma_f32_32x32x16_bf16 v[128:143], v[196:199], v[52:55], v[128:143]
    v_mov_b32_dpp v153, v153 row_shr:1 row_mask:0xf bank_mask:0xf bound_ctrl:0
    v_mov_b32_dpp v154, v154 row_shr:1 row_mask:0xf bank_mask:0xf bound_ctrl:0
    v_mov_b32_dpp v155, v155 row_shr:1 row_mask:0xf bank_mask:0xf bound_ctrl:0
    v_mfma_f32_32x32x16_bf16 v[128:143], v[200:203], v[56:59], v[128:143]
    v_mov_b32_dpp v156, v156 row_shr:1 row_mask:0xf bank_mask:0xf bound_ctrl:0
    v_mov_b32_dpp v157, v157 row_shr:1 row_mask:0xf bank_mask:0xf bound_ctrl:0
    v_mfma_f32_32x32x16_bf16 v[128:143], v[204:207], v[60:63], v[128:143]
    v_mov_b32_dpp v158, v158 row_shr:1 row_mask:0xf bank_mask:0xf bound_ctrl:0
    v_mov_b32_dpp v159, v159 row_shr:1 row_mask:0xf bank_mask:0xf bound_ctrl:0
    s_waitcnt lgkmcnt(0)
    v_mfma_f32_32x32x16_bf16 v[160:175], v[208:211], v[96:99], v[160:175]
    ds_read_b64 v[176:177], v14 offset:1280
    ds_read_b64 v[178:179], v14 offset:1288
    ds_read_b64 v[180:181], v14 offset:1312
    ds_read_b64 v[182:183], v14 offset:1320
    s_nop 0
    v_mfma_f32_32x32x16_bf16 v[160:175], v[212:215], v[100:103], v[160:175]
    ds_read_b64 v[184:185], v14 offset:1344
    ds_read_b64 v[186:187], v14 offset:1352
    ds_read_b64 v[188:189], v14 offset:1376
    s_nop 1
    v_mfma_f32_32x32x16_bf16 v[160:175], v[216:219], v[104:107], v[160:175]
    ds_read_b64 v[190:191], v14 offset:1384
    ds_read_b64 v[192:193], v14 offset:1408
    ds_read_b64 v[194:195], v14 offset:1416
    v_mov_b32_dpp v128, v128 row_shr:1 row_mask:0xf bank_mask:0xf bound_ctrl:0
    v_mov_b32_dpp v129, v129 row_shr:1 row_mask:0xf bank_mask:0xf bound_ctrl:0
    v_mov_b32_dpp v130, v130 row_shr:1 row_mask:0xf bank_mask:0xf bound_ctrl:0
    v_mfma_f32_32x32x16_bf16 v[160:175], v[220:223], v[108:111], v[160:175]
    ds_read_b64 v[196:197], v14 offset:1440
    ds_read_b64 v[198:199], v14 offset:1448
    ds_read_b64 v[200:201], v14 offset:1472
    v_mov_b32_dpp v131, v131 row_shr:1 row_mask:0xf bank_mask:0xf bound_ctrl:0
    v_mov_b32_dpp v132, v132 row_shr:1 row_mask:0xf bank_mask:0xf bound_ctrl:0
    v_mov_b32_dpp v133, v133 row_shr:1 row_mask:0xf bank_mask:0xf bound_ctrl:0
    v_mfma_f32_32x32x16_bf16 v[160:175], v[224:227], v[112:115], v[160:175]
    ds_read_b64 v[202:203], v14 offset:1480
    ds_read_b64 v[204:205], v14 offset:1504
    ds_read_b64 v[206:207], v14 offset:1512
    v_mov_b32_dpp v134, v134 row_shr:1 row_mask:0xf bank_mask:0xf bound_ctrl:0
    v_mov_b32_dpp v135, v135 row_shr:1 row_mask:0xf bank_mask:0xf bound_ctrl:0
    v_mov_b32_dpp v136, v136 row_shr:1 row_mask:0xf bank_mask:0xf bound_ctrl:0
    v_mfma_f32_32x32x16_bf16 v[160:175], v[228:231], v[116:119], v[160:175]
    v_mov_b32_dpp v137, v137 row_shr:1 row_mask:0xf bank_mask:0xf bound_ctrl:0
    v_mov_b32_dpp v138, v138 row_shr:1 row_mask:0xf bank_mask:0xf bound_ctrl:0
    v_mov_b32_dpp v139, v139 row_shr:1 row_mask:0xf bank_mask:0xf bound_ctrl:0
    v_mfma_f32_32x32x16_bf16 v[160:175], v[232:235], v[120:123], v[160:175]
    v_mov_b32_dpp v140, v140 row_shr:1 row_mask:0xf bank_mask:0xf bound_ctrl:0
    v_mov_b32_dpp v141, v141 row_shr:1 row_mask:0xf bank_mask:0xf bound_ctrl:0
    v_mfma_f32_32x32x16_bf16 v[160:175], v[236:239], v[124:127], v[160:175]
    v_mov_b32_dpp v142, v142 row_shr:1 row_mask:0xf bank_mask:0xf bound_ctrl:0
    v_mov_b32_dpp v143, v143 row_shr:1 row_mask:0xf bank_mask:0xf bound_ctrl:0
    s_waitcnt lgkmcnt(0)
    v_mfma_f32_32x32x16_bf16 v[144:159], v[176:179], v[64:67], v[144:159]
    ds_read_b64 v[208:209], v14 offset:3328
    ds_read_b64 v[210:211], v14 offset:3336
    s_nop 2
    v_mfma_f32_32x32x16_bf16 v[144:159], v[180:183], v[68:71], v[144:159]
    ds_read_b64 v[212:213], v14 offset:3360
    ds_read_b64 v[214:215], v14 offset:3368
    s_nop 2
    v_mfma_f32_32x32x16_bf16 v[144:159], v[184:187], v[72:75], v[144:159]
    ds_read_b64 v[216:217], v14 offset:3392
    ds_read_b64 v[218:219], v14 offset:3400
    v_and_b32_dpp v160, v160, v15 row_shr:1 row_mask:0xf bank_mask:0xf bound_ctrl:0
    v_and_b32_dpp v161, v161, v15 row_shr:1 row_mask:0xf bank_mask:0xf bound_ctrl:0
    v_and_b32_dpp v162, v162, v15 row_shr:1 row_mask:0xf bank_mask:0xf bound_ctrl:0
    v_mfma_f32_32x32x16_bf16 v[144:159], v[188:191], v[76:79], v[144:159]
    ds_read_b64 v[220:221], v14 offset:3424
    ds_read_b64 v[222:223], v14 offset:3432
    v_and_b32_dpp v163, v163, v15 row_shr:1 row_mask:0xf bank_mask:0xf bound_ctrl:0
    v_and_b32_dpp v164, v164, v15 row_shr:1 row_mask:0xf bank_mask:0xf bound_ctrl:0
    v_and_b32_dpp v165, v165, v15 row_shr:1 row_mask:0xf bank_mask:0xf bound_ctrl:0
    v_mfma_f32_32x32x16_bf16 v[144:159], v[192:195], v[80:83], v[144:159]
    ds_read_b64 v[224:225], v14 offset:3456
    ds_read_b64 v[226:227], v14 offset:3464
    v_and_b32_dpp v166, v166, v15 row_shr:1 row_mask:0xf bank_mask:0xf bound_ctrl:0
    v_and_b32_dpp v167, v167, v15 row_shr:1 row_mask:0xf bank_mask:0xf bound_ctrl:0
    v_and_b32_dpp v168, v168, v15 row_shr:1 row_mask:0xf bank_mask:0xf bound_ctrl:0
    v_mfma_f32_32x32x16_bf16 v[144:159], v[196:199], v[84:87], v[144:159]
    ds_read_b64 v[228:229], v14 offset:3488
    ds_read_b64 v[230:231], v14 offset:3496
    v_and_b32_dpp v169, v169, v15 row_shr:1 row_mask:0xf bank_mask:0xf bound_ctrl:0
    v_and_b32_dpp v170, v170, v15 row_shr:1 row_mask:0xf bank_mask:0xf bound_ctrl:0
    v_and_b32_dpp v171, v171, v15 row_shr:1 row_mask:0xf bank_mask:0xf bound_ctrl:0
    v_mfma_f32_32x32x16_bf16 v[144:159], v[200:203], v[88:91], v[144:159]
    ds_read_b64 v[232:233], v14 offset:3520
    ds_read_b64 v[234:235], v14 offset:3528
    v_and_b32_dpp v172, v172, v15 row_shr:1 row_mask:0xf bank_mask:0xf bound_ctrl:0
    v_and_b32_dpp v173, v173, v15 row_shr:1 row_mask:0xf bank_mask:0xf bound_ctrl:0
    v_mfma_f32_32x32x16_bf16 v[144:159], v[204:207], v[92:95], v[144:159]
    ds_read_b64 v[236:237], v14 offset:3552
    ds_read_b64 v[238:239], v14 offset:3560
    v_and_b32_dpp v174, v174, v15 row_shr:1 row_mask:0xf bank_mask:0xf bound_ctrl:0
    v_and_b32_dpp v175, v175, v15 row_shr:1 row_mask:0xf bank_mask:0xf bound_ctrl:0
    v_mfma_f32_32x32x16_bf16 v[128:143], v[176:179], v[32:35], v[128:143]
    s_nop 4
    v_mfma_f32_32x32x16_bf16 v[128:143], v[180:183], v[36:39], v[128:143]
    s_nop 4
    v_mfma_f32_32x32x16_bf16 v[128:143], v[184:187], v[40:43], v[128:143]
    v_mov_b32_dpp v144, v144 row_shr:1 row_mask:0xf bank_mask:0xf bound_ctrl:0
    v_mov_b32_dpp v145, v145 row_shr:1 row_mask:0xf bank_mask:0xf bound_ctrl:0
    v_mov_b32_dpp v146, v146 row_shr:1 row_mask:0xf bank_mask:0xf bound_ctrl:0
    v_mfma_f32_32x32x16_bf16 v[128:143], v[188:191], v[44:47], v[128:143]
    v_mov_b32_dpp v147, v147 row_shr:1 row_mask:0xf bank_mask:0xf bound_ctrl:0
    v_mov_b32_dpp v148, v148 row_shr:1 row_mask:0xf bank_mask:0xf bound_ctrl:0
    v_mov_b32_dpp v149, v149 row_shr:1 row_mask:0xf bank_mask:0xf bound_ctrl:0
    v_mfma_f32_32x32x16_bf16 v[128:143], v[192:195], v[48:51], v[128:143]
    v_mov_b32_dpp v150, v150 row_shr:1 row_mask:0xf bank_mask:0xf bound_ctrl:0
    v_mov_b32_dpp v151, v151 row_shr:1 row_mask:0xf bank_mask:0xf bound_ctrl:0
    v_mov_b32_dpp v152, v152 row_shr:1 row_mask:0xf bank_mask:0xf bound_ctrl:0
    v_mfma_f32_32x32x16_bf16 v[128:143], v[196:199], v[52:55], v[128:143]
    v_mov_b32_dpp v153, v153 row_shr:1 row_mask:0xf bank_mask:0xf bound_ctrl:0
    v_mov_b32_dpp v154, v154 row_shr:1 row_mask:0xf bank_mask:0xf bound_ctrl:0
    v_mov_b32_dpp v155, v155 row_shr:1 row_mask:0xf bank_mask:0xf bound_ctrl:0
    v_mfma_f32_32x32x16_bf16 v[128:143], v[200:203], v[56:59], v[128:143]
    v_mov_b32_dpp v156, v156 row_shr:1 row_mask:0xf bank_mask:0xf bound_ctrl:0
    v_mov_b32_dpp v157, v157 row_shr:1 row_mask:0xf bank_mask:0xf bound_ctrl:0
    v_mfma_f32_32x32x16_bf16 v[128:143], v[204:207], v[60:63], v[128:143]
    v_mov_b32_dpp v158, v158 row_shr:1 row_mask:0xf bank_mask:0xf bound_ctrl:0
    v_mov_b32_dpp v159, v159 row_shr:1 row_mask:0xf bank_mask:0xf bound_ctrl:0
    s_waitcnt lgkmcnt(0)
    v_mfma_f32_32x32x16_bf16 v[160:175], v[208:211], v[96:99], v[160:175]
    ds_read_b64 v[176:177], v14 offset:1024
    ds_read_b64 v[178:179], v14 offset:1032
    ds_read_b64 v[180:181], v14 offset:1056
    ds_read_b64 v[182:183], v14 offset:1064
    s_nop 0
    v_mfma_f32_32x32x16_bf16 v[160:175], v[212:215], v[100:103], v[160:175]
    ds_read_b64 v[184:185], v14 offset:1088
    ds_read_b64 v[186:187], v14 offset:1096
    ds_read_b64 v[188:189], v14 offset:1120
    s_nop 1
    v_mfma_f32_32x32x16_bf16 v[160:175], v[216:219], v[104:107], v[160:175]
    ds_read_b64 v[190:191], v14 offset:1128
    ds_read_b64 v[192:193], v14 offset:1152
    ds_read_b64 v[194:195], v14 offset:1160
    v_mov_b32_dpp v128, v128 row_shr:1 row_mask:0xf bank_mask:0xf bound_ctrl:0
    v_mov_b32_dpp v129, v129 row_shr:1 row_mask:0xf bank_mask:0xf bound_ctrl:0
    v_mov_b32_dpp v130, v130 row_shr:1 row_mask:0xf bank_mask:0xf bound_ctrl:0
    v_mfma_f32_32x32x16_bf16 v[160:175], v[220:223], v[108:111], v[160:175]
    ds_read_b64 v[196:197], v14 offset:1184
    ds_read_b64 v[198:199], v14 offset:1192
    ds_read_b64 v[200:201], v14 offset:1216
    v_mov_b32_dpp v131, v131 row_shr:1 row_mask:0xf bank_mask:0xf bound_ctrl:0
    v_mov_b32_dpp v132, v132 row_shr:1 row_mask:0xf bank_mask:0xf bound_ctrl:0
    v_mov_b32_dpp v133, v133 row_shr:1 row_mask:0xf bank_mask:0xf bound_ctrl:0
    v_mfma_f32_32x32x16_bf16 v[160:175], v[224:227], v[112:115], v[160:175]
    ds_read_b64 v[202:203], v14 offset:1224
    ds_read_b64 v[204:205], v14 offset:1248
    ds_read_b64 v[206:207], v14 offset:1256
    v_mov_b32_dpp v134, v134 row_shr:1 row_mask:0xf bank_mask:0xf bound_ctrl:0
    v_mov_b32_dpp v135, v135 row_shr:1 row_mask:0xf bank_mask:0xf bound_ctrl:0
    v_mov_b32_dpp v136, v136 row_shr:1 row_mask:0xf bank_mask:0xf bound_ctrl:0
    v_mfma_f32_32x32x16_bf16 v[160:175], v[228:231], v[116:119], v[160:175]
    v_mov_b32_dpp v137, v137 row_shr:1 row_mask:0xf bank_mask:0xf bound_ctrl:0
    v_mov_b32_dpp v138, v138 row_shr:1 row_mask:0xf bank_mask:0xf bound_ctrl:0
    v_mov_b32_dpp v139, v139 row_shr:1 row_mask:0xf bank_mask:0xf bound_ctrl:0
    v_mfma_f32_32x32x16_bf16 v[160:175], v[232:235], v[120:123], v[160:175]
    v_mov_b32_dpp v140, v140 row_shr:1 row_mask:0xf bank_mask:0xf bound_ctrl:0
    v_mov_b32_dpp v141, v141 row_shr:1 row_mask:0xf bank_mask:0xf bound_ctrl:0
    v_mfma_f32_32x32x16_bf16 v[160:175], v[236:239], v[124:127], v[160:175]
    v_mov_b32_dpp v142, v142 row_shr:1 row_mask:0xf bank_mask:0xf bound_ctrl:0
    v_mov_b32_dpp v143, v143 row_shr:1 row_mask:0xf bank_mask:0xf bound_ctrl:0
    s_waitcnt lgkmcnt(0)
    v_mfma_f32_32x32x16_bf16 v[144:159], v[176:179], v[64:67], v[144:159]
    ds_read_b64 v[208:209], v14 offset:3072
    ds_read_b64 v[210:211], v14 offset:3080
    s_nop 2
    v_mfma_f32_32x32x16_bf16 v[144:159], v[180:183], v[68:71], v[144:159]
    ds_read_b64 v[212:213], v14 offset:3104
    ds_read_b64 v[214:215], v14 offset:3112
    s_nop 2
    v_mfma_f32_32x32x16_bf16 v[144:159], v[184:187], v[72:75], v[144:159]
    ds_read_b64 v[216:217], v14 offset:3136
    ds_read_b64 v[218:219], v14 offset:3144
    v_and_b32_dpp v160, v160, v15 row_shr:1 row_mask:0xf bank_mask:0xf bound_ctrl:0
    v_and_b32_dpp v161, v161, v15 row_shr:1 row_mask:0xf bank_mask:0xf bound_ctrl:0
    v_and_b32_dpp v162, v162, v15 row_shr:1 row_mask:0xf bank_mask:0xf bound_ctrl:0
    v_mfma_f32_32x32x16_bf16 v[144:159], v[188:191], v[76:79], v[144:159]
    ds_read_b64 v[220:221], v14 offset:3168
    ds_read_b64 v[222:223], v14 offset:3176
    v_and_b32_dpp v163, v163, v15 row_shr:1 row_mask:0xf bank_mask:0xf bound_ctrl:0
    v_and_b32_dpp v164, v164, v15 row_shr:1 row_mask:0xf bank_mask:0xf bound_ctrl:0
    v_and_b32_dpp v165, v165, v15 row_shr:1 row_mask:0xf bank_mask:0xf bound_ctrl:0
    v_mfma_f32_32x32x16_bf16 v[144:159], v[192:195], v[80:83], v[144:159]
    ds_read_b64 v[224:225], v14 offset:3200
    ds_read_b64 v[226:227], v14 offset:3208
    v_and_b32_dpp v166, v166, v15 row_shr:1 row_mask:0xf bank_mask:0xf bound_ctrl:0
    v_and_b32_dpp v167, v167, v15 row_shr:1 row_mask:0xf bank_mask:0xf bound_ctrl:0
    v_and_b32_dpp v168, v168, v15 row_shr:1 row_mask:0xf bank_mask:0xf bound_ctrl:0
    v_mfma_f32_32x32x16_bf16 v[144:159], v[196:199], v[84:87], v[144:159]
    ds_read_b64 v[228:229], v14 offset:3232
    ds_read_b64 v[230:231], v14 offset:3240
    v_and_b32_dpp v169, v169, v15 row_shr:1 row_mask:0xf bank_mask:0xf bound_ctrl:0
    v_and_b32_dpp v170, v170, v15 row_shr:1 row_mask:0xf bank_mask:0xf bound_ctrl:0
    v_and_b32_dpp v171, v171, v15 row_shr:1 row_mask:0xf bank_mask:0xf bound_ctrl:0
    v_mfma_f32_32x32x16_bf16 v[144:159], v[200:203], v[88:91], v[144:159]
    ds_read_b64 v[232:233], v14 offset:3264
    ds_read_b64 v[234:235], v14 offset:3272
    v_and_b32_dpp v172, v172, v15 row_shr:1 row_mask:0xf bank_mask:0xf bound_ctrl:0
    v_and_b32_dpp v173, v173, v15 row_shr:1 row_mask:0xf bank_mask:0xf bound_ctrl:0
    v_mfma_f32_32x32x16_bf16 v[144:159], v[204:207], v[92:95], v[144:159]
    ds_read_b64 v[236:237], v14 offset:3296
    ds_read_b64 v[238:239], v14 offset:3304
    v_and_b32_dpp v174, v174, v15 row_shr:1 row_mask:0xf bank_mask:0xf bound_ctrl:0
    v_and_b32_dpp v175, v175, v15 row_shr:1 row_mask:0xf bank_mask:0xf bound_ctrl:0
    v_mfma_f32_32x32x16_bf16 v[128:143], v[176:179], v[32:35], v[128:143]
    s_nop 4
    v_mfma_f32_32x32x16_bf16 v[128:143], v[180:183], v[36:39], v[128:143]
    s_nop 4
    v_mfma_f32_32x32x16_bf16 v[128:143], v[184:187], v[40:43], v[128:143]
    v_mov_b32_dpp v144, v144 row_shr:1 row_mask:0xf bank_mask:0xf bound_ctrl:0
    v_mov_b32_dpp v145, v145 row_shr:1 row_mask:0xf bank_mask:0xf bound_ctrl:0
    v_mov_b32_dpp v146, v146 row_shr:1 row_mask:0xf bank_mask:0xf bound_ctrl:0
    v_mfma_f32_32x32x16_bf16 v[128:143], v[188:191], v[44:47], v[128:143]
    v_mov_b32_dpp v147, v147 row_shr:1 row_mask:0xf bank_mask:0xf bound_ctrl:0
    v_mov_b32_dpp v148, v148 row_shr:1 row_mask:0xf bank_mask:0xf bound_ctrl:0
    v_mov_b32_dpp v149, v149 row_shr:1 row_mask:0xf bank_mask:0xf bound_ctrl:0
    v_mfma_f32_32x32x16_bf16 v[128:143], v[192:195], v[48:51], v[128:143]
    v_mov_b32_dpp v150, v150 row_shr:1 row_mask:0xf bank_mask:0xf bound_ctrl:0
    v_mov_b32_dpp v151, v151 row_shr:1 row_mask:0xf bank_mask:0xf bound_ctrl:0
    v_mov_b32_dpp v152, v152 row_shr:1 row_mask:0xf bank_mask:0xf bound_ctrl:0
    v_mfma_f32_32x32x16_bf16 v[128:143], v[196:199], v[52:55], v[128:143]
    v_mov_b32_dpp v153, v153 row_shr:1 row_mask:0xf bank_mask:0xf bound_ctrl:0
    v_mov_b32_dpp v154, v154 row_shr:1 row_mask:0xf bank_mask:0xf bound_ctrl:0
    v_mov_b32_dpp v155, v155 row_shr:1 row_mask:0xf bank_mask:0xf bound_ctrl:0
    v_mfma_f32_32x32x16_bf16 v[128:143], v[200:203], v[56:59], v[128:143]
    v_mov_b32_dpp v156, v156 row_shr:1 row_mask:0xf bank_mask:0xf bound_ctrl:0
    v_mov_b32_dpp v157, v157 row_shr:1 row_mask:0xf bank_mask:0xf bound_ctrl:0
    v_mfma_f32_32x32x16_bf16 v[128:143], v[204:207], v[60:63], v[128:143]
    v_mov_b32_dpp v158, v158 row_shr:1 row_mask:0xf bank_mask:0xf bound_ctrl:0
    v_mov_b32_dpp v159, v159 row_shr:1 row_mask:0xf bank_mask:0xf bound_ctrl:0
    s_waitcnt lgkmcnt(0)
    v_mfma_f32_32x32x16_bf16 v[160:175], v[208:211], v[96:99], v[160:175]
    ds_read_b64 v[176:177], v14 offset:768
    ds_read_b64 v[178:179], v14 offset:776
    ds_read_b64 v[180:181], v14 offset:800
    ds_read_b64 v[182:183], v14 offset:808
    s_nop 0
    v_mfma_f32_32x32x16_bf16 v[160:175], v[212:215], v[100:103], v[160:175]
    ds_read_b64 v[184:185], v14 offset:832
    ds_read_b64 v[186:187], v14 offset:840
    ds_read_b64 v[188:189], v14 offset:864
    s_nop 1
    v_mfma_f32_32x32x16_bf16 v[160:175], v[216:219], v[104:107], v[160:175]
    ds_read_b64 v[190:191], v14 offset:872
    ds_read_b64 v[192:193], v14 offset:896
    ds_read_b64 v[194:195], v14 offset:904
    v_mov_b32_dpp v128, v128 row_shr:1 row_mask:0xf bank_mask:0xf bound_ctrl:0
    v_mov_b32_dpp v129, v129 row_shr:1 row_mask:0xf bank_mask:0xf bound_ctrl:0
    v_mov_b32_dpp v130, v130 row_shr:1 row_mask:0xf bank_mask:0xf bound_ctrl:0
    v_mfma_f32_32x32x16_bf16 v[160:175], v[220:223], v[108:111], v[160:175]
    ds_read_b64 v[196:197], v14 offset:928
    ds_read_b64 v[198:199], v14 offset:936
    ds_read_b64 v[200:201], v14 offset:960
    v_mov_b32_dpp v131, v131 row_shr:1 row_mask:0xf bank_mask:0xf bound_ctrl:0
    v_mov_b32_dpp v132, v132 row_shr:1 row_mask:0xf bank_mask:0xf bound_ctrl:0
    v_mov_b32_dpp v133, v133 row_shr:1 row_mask:0xf bank_mask:0xf bound_ctrl:0
    v_mfma_f32_32x32x16_bf16 v[160:175], v[224:227], v[112:115], v[160:175]
    ds_read_b64 v[202:203], v14 offset:968
    ds_read_b64 v[204:205], v14 offset:992
    ds_read_b64 v[206:207], v14 offset:1000
    v_mov_b32_dpp v134, v134 row_shr:1 row_mask:0xf bank_mask:0xf bound_ctrl:0
    v_mov_b32_dpp v135, v135 row_shr:1 row_mask:0xf bank_mask:0xf bound_ctrl:0
    v_mov_b32_dpp v136, v136 row_shr:1 row_mask:0xf bank_mask:0xf bound_ctrl:0
    v_mfma_f32_32x32x16_bf16 v[160:175], v[228:231], v[116:119], v[160:175]
    v_mov_b32_dpp v137, v137 row_shr:1 row_mask:0xf bank_mask:0xf bound_ctrl:0
    v_mov_b32_dpp v138, v138 row_shr:1 row_mask:0xf bank_mask:0xf bound_ctrl:0
    v_mov_b32_dpp v139, v139 row_shr:1 row_mask:0xf bank_mask:0xf bound_ctrl:0
    v_mfma_f32_32x32x16_bf16 v[160:175], v[232:235], v[120:123], v[160:175]
    v_mov_b32_dpp v140, v140 row_shr:1 row_mask:0xf bank_mask:0xf bound_ctrl:0
    v_mov_b32_dpp v141, v141 row_shr:1 row_mask:0xf bank_mask:0xf bound_ctrl:0
    v_mfma_f32_32x32x16_bf16 v[160:175], v[236:239], v[124:127], v[160:175]
    v_mov_b32_dpp v142, v142 row_shr:1 row_mask:0xf bank_mask:0xf bound_ctrl:0
    v_mov_b32_dpp v143, v143 row_shr:1 row_mask:0xf bank_mask:0xf bound_ctrl:0
    s_waitcnt lgkmcnt(0)
    v_mfma_f32_32x32x16_bf16 v[144:159], v[176:179], v[64:67], v[144:159]
    ds_read_b64 v[208:209], v14 offset:2816
    ds_read_b64 v[210:211], v14 offset:2824
    s_nop 2
    v_mfma_f32_32x32x16_bf16 v[144:159], v[180:183], v[68:71], v[144:159]
    ds_read_b64 v[212:213], v14 offset:2848
    ds_read_b64 v[214:215], v14 offset:2856
    s_nop 2
    v_mfma_f32_32x32x16_bf16 v[144:159], v[184:187], v[72:75], v[144:159]
    ds_read_b64 v[216:217], v14 offset:2880
    ds_read_b64 v[218:219], v14 offset:2888
    v_and_b32_dpp v160, v160, v15 row_shr:1 row_mask:0xf bank_mask:0xf bound_ctrl:0
    v_and_b32_dpp v161, v161, v15 row_shr:1 row_mask:0xf bank_mask:0xf bound_ctrl:0
    v_and_b32_dpp v162, v162, v15 row_shr:1 row_mask:0xf bank_mask:0xf bound_ctrl:0
    v_mfma_f32_32x32x16_bf16 v[144:159], v[188:191], v[76:79], v[144:159]
    ds_read_b64 v[220:221], v14 offset:2912
    ds_read_b64 v[222:223], v14 offset:2920
    v_and_b32_dpp v163, v163, v15 row_shr:1 row_mask:0xf bank_mask:0xf bound_ctrl:0
    v_and_b32_dpp v164, v164, v15 row_shr:1 row_mask:0xf bank_mask:0xf bound_ctrl:0
    v_and_b32_dpp v165, v165, v15 row_shr:1 row_mask:0xf bank_mask:0xf bound_ctrl:0
    v_mfma_f32_32x32x16_bf16 v[144:159], v[192:195], v[80:83], v[144:159]
    ds_read_b64 v[224:225], v14 offset:2944
    ds_read_b64 v[226:227], v14 offset:2952
    v_and_b32_dpp v166, v166, v15 row_shr:1 row_mask:0xf bank_mask:0xf bound_ctrl:0
    v_and_b32_dpp v167, v167, v15 row_shr:1 row_mask:0xf bank_mask:0xf bound_ctrl:0
    v_and_b32_dpp v168, v168, v15 row_shr:1 row_mask:0xf bank_mask:0xf bound_ctrl:0
    v_mfma_f32_32x32x16_bf16 v[144:159], v[196:199], v[84:87], v[144:159]
    ds_read_b64 v[228:229], v14 offset:2976
    ds_read_b64 v[230:231], v14 offset:2984
    v_and_b32_dpp v169, v169, v15 row_shr:1 row_mask:0xf bank_mask:0xf bound_ctrl:0
    v_and_b32_dpp v170, v170, v15 row_shr:1 row_mask:0xf bank_mask:0xf bound_ctrl:0
    v_and_b32_dpp v171, v171, v15 row_shr:1 row_mask:0xf bank_mask:0xf bound_ctrl:0
    v_mfma_f32_32x32x16_bf16 v[144:159], v[200:203], v[88:91], v[144:159]
    ds_read_b64 v[232:233], v14 offset:3008
    ds_read_b64 v[234:235], v14 offset:3016
    v_and_b32_dpp v172, v172, v15 row_shr:1 row_mask:0xf bank_mask:0xf bound_ctrl:0
    v_and_b32_dpp v173, v173, v15 row_shr:1 row_mask:0xf bank_mask:0xf bound_ctrl:0
    v_mfma_f32_32x32x16_bf16 v[144:159], v[204:207], v[92:95], v[144:159]
    ds_read_b64 v[236:237], v14 offset:3040
    ds_read_b64 v[238:239], v14 offset:3048
    v_and_b32_dpp v174, v174, v15 row_shr:1 row_mask:0xf bank_mask:0xf bound_ctrl:0
    v_and_b32_dpp v175, v175, v15 row_shr:1 row_mask:0xf bank_mask:0xf bound_ctrl:0
    v_mfma_f32_32x32x16_bf16 v[128:143], v[176:179], v[32:35], v[128:143]
    s_nop 4
    v_mfma_f32_32x32x16_bf16 v[128:143], v[180:183], v[36:39], v[128:143]
    s_nop 4
    v_mfma_f32_32x32x16_bf16 v[128:143], v[184:187], v[40:43], v[128:143]
    v_mov_b32_dpp v144, v144 row_shr:1 row_mask:0xf bank_mask:0xf bound_ctrl:0
    v_mov_b32_dpp v145, v145 row_shr:1 row_mask:0xf bank_mask:0xf bound_ctrl:0
    v_mov_b32_dpp v146, v146 row_shr:1 row_mask:0xf bank_mask:0xf bound_ctrl:0
    v_mfma_f32_32x32x16_bf16 v[128:143], v[188:191], v[44:47], v[128:143]
    v_mov_b32_dpp v147, v147 row_shr:1 row_mask:0xf bank_mask:0xf bound_ctrl:0
    v_mov_b32_dpp v148, v148 row_shr:1 row_mask:0xf bank_mask:0xf bound_ctrl:0
    v_mov_b32_dpp v149, v149 row_shr:1 row_mask:0xf bank_mask:0xf bound_ctrl:0
    v_mfma_f32_32x32x16_bf16 v[128:143], v[192:195], v[48:51], v[128:143]
    v_mov_b32_dpp v150, v150 row_shr:1 row_mask:0xf bank_mask:0xf bound_ctrl:0
    v_mov_b32_dpp v151, v151 row_shr:1 row_mask:0xf bank_mask:0xf bound_ctrl:0
    v_mov_b32_dpp v152, v152 row_shr:1 row_mask:0xf bank_mask:0xf bound_ctrl:0
    v_mfma_f32_32x32x16_bf16 v[128:143], v[196:199], v[52:55], v[128:143]
    v_mov_b32_dpp v153, v153 row_shr:1 row_mask:0xf bank_mask:0xf bound_ctrl:0
    v_mov_b32_dpp v154, v154 row_shr:1 row_mask:0xf bank_mask:0xf bound_ctrl:0
    v_mov_b32_dpp v155, v155 row_shr:1 row_mask:0xf bank_mask:0xf bound_ctrl:0
    v_mfma_f32_32x32x16_bf16 v[128:143], v[200:203], v[56:59], v[128:143]
    v_mov_b32_dpp v156, v156 row_shr:1 row_mask:0xf bank_mask:0xf bound_ctrl:0
    v_mov_b32_dpp v157, v157 row_shr:1 row_mask:0xf bank_mask:0xf bound_ctrl:0
    v_mfma_f32_32x32x16_bf16 v[128:143], v[204:207], v[60:63], v[128:143]
    v_mov_b32_dpp v158, v158 row_shr:1 row_mask:0xf bank_mask:0xf bound_ctrl:0
    v_mov_b32_dpp v159, v159 row_shr:1 row_mask:0xf bank_mask:0xf bound_ctrl:0
    s_waitcnt lgkmcnt(0)
    v_mfma_f32_32x32x16_bf16 v[160:175], v[208:211], v[96:99], v[160:175]
    ds_read_b64 v[176:177], v14 offset:512
    ds_read_b64 v[178:179], v14 offset:520
    ds_read_b64 v[180:181], v14 offset:544
    ds_read_b64 v[182:183], v14 offset:552
    s_nop 0
    v_mfma_f32_32x32x16_bf16 v[160:175], v[212:215], v[100:103], v[160:175]
    ds_read_b64 v[184:185], v14 offset:576
    ds_read_b64 v[186:187], v14 offset:584
    ds_read_b64 v[188:189], v14 offset:608
    s_nop 1
    v_mfma_f32_32x32x16_bf16 v[160:175], v[216:219], v[104:107], v[160:175]
    ds_read_b64 v[190:191], v14 offset:616
    ds_read_b64 v[192:193], v14 offset:640
    ds_read_b64 v[194:195], v14 offset:648
    v_mov_b32_dpp v128, v128 row_shr:1 row_mask:0xf bank_mask:0xf bound_ctrl:0
    v_mov_b32_dpp v129, v129 row_shr:1 row_mask:0xf bank_mask:0xf bound_ctrl:0
    v_mov_b32_dpp v130, v130 row_shr:1 row_mask:0xf bank_mask:0xf bound_ctrl:0
    v_mfma_f32_32x32x16_bf16 v[160:175], v[220:223], v[108:111], v[160:175]
    ds_read_b64 v[196:197], v14 offset:672
    ds_read_b64 v[198:199], v14 offset:680
    ds_read_b64 v[200:201], v14 offset:704
    v_mov_b32_dpp v131, v131 row_shr:1 row_mask:0xf bank_mask:0xf bound_ctrl:0
    v_mov_b32_dpp v132, v132 row_shr:1 row_mask:0xf bank_mask:0xf bound_ctrl:0
    v_mov_b32_dpp v133, v133 row_shr:1 row_mask:0xf bank_mask:0xf bound_ctrl:0
    v_mfma_f32_32x32x16_bf16 v[160:175], v[224:227], v[112:115], v[160:175]
    ds_read_b64 v[202:203], v14 offset:712
    ds_read_b64 v[204:205], v14 offset:736
    ds_read_b64 v[206:207], v14 offset:744
    v_mov_b32_dpp v134, v134 row_shr:1 row_mask:0xf bank_mask:0xf bound_ctrl:0
    v_mov_b32_dpp v135, v135 row_shr:1 row_mask:0xf bank_mask:0xf bound_ctrl:0
    v_mov_b32_dpp v136, v136 row_shr:1 row_mask:0xf bank_mask:0xf bound_ctrl:0
    v_mfma_f32_32x32x16_bf16 v[160:175], v[228:231], v[116:119], v[160:175]
    v_mov_b32_dpp v137, v137 row_shr:1 row_mask:0xf bank_mask:0xf bound_ctrl:0
    v_mov_b32_dpp v138, v138 row_shr:1 row_mask:0xf bank_mask:0xf bound_ctrl:0
    v_mov_b32_dpp v139, v139 row_shr:1 row_mask:0xf bank_mask:0xf bound_ctrl:0
    v_mfma_f32_32x32x16_bf16 v[160:175], v[232:235], v[120:123], v[160:175]
    v_mov_b32_dpp v140, v140 row_shr:1 row_mask:0xf bank_mask:0xf bound_ctrl:0
    v_mov_b32_dpp v141, v141 row_shr:1 row_mask:0xf bank_mask:0xf bound_ctrl:0
    v_mfma_f32_32x32x16_bf16 v[160:175], v[236:239], v[124:127], v[160:175]
    v_mov_b32_dpp v142, v142 row_shr:1 row_mask:0xf bank_mask:0xf bound_ctrl:0
    v_mov_b32_dpp v143, v143 row_shr:1 row_mask:0xf bank_mask:0xf bound_ctrl:0
    s_waitcnt lgkmcnt(0)
    v_mfma_f32_32x32x16_bf16 v[144:159], v[176:179], v[64:67], v[144:159]
    ds_read_b64 v[208:209], v14 offset:2560
    ds_read_b64 v[210:211], v14 offset:2568
    s_nop 2
    v_mfma_f32_32x32x16_bf16 v[144:159], v[180:183], v[68:71], v[144:159]
    ds_read_b64 v[212:213], v14 offset:2592
    ds_read_b64 v[214:215], v14 offset:2600
    s_nop 2
    v_mfma_f32_32x32x16_bf16 v[144:159], v[184:187], v[72:75], v[144:159]
    ds_read_b64 v[216:217], v14 offset:2624
    ds_read_b64 v[218:219], v14 offset:2632
    v_and_b32_dpp v160, v160, v15 row_shr:1 row_mask:0xf bank_mask:0xf bound_ctrl:0
    v_and_b32_dpp v161, v161, v15 row_shr:1 row_mask:0xf bank_mask:0xf bound_ctrl:0
    v_and_b32_dpp v162, v162, v15 row_shr:1 row_mask:0xf bank_mask:0xf bound_ctrl:0
    v_mfma_f32_32x32x16_bf16 v[144:159], v[188:191], v[76:79], v[144:159]
    ds_read_b64 v[220:221], v14 offset:2656
    ds_read_b64 v[222:223], v14 offset:2664
    v_and_b32_dpp v163, v163, v15 row_shr:1 row_mask:0xf bank_mask:0xf bound_ctrl:0
    v_and_b32_dpp v164, v164, v15 row_shr:1 row_mask:0xf bank_mask:0xf bound_ctrl:0
    v_and_b32_dpp v165, v165, v15 row_shr:1 row_mask:0xf bank_mask:0xf bound_ctrl:0
    v_mfma_f32_32x32x16_bf16 v[144:159], v[192:195], v[80:83], v[144:159]
    ds_read_b64 v[224:225], v14 offset:2688
    ds_read_b64 v[226:227], v14 offset:2696
    v_and_b32_dpp v166, v166, v15 row_shr:1 row_mask:0xf bank_mask:0xf bound_ctrl:0
    v_and_b32_dpp v167, v167, v15 row_shr:1 row_mask:0xf bank_mask:0xf bound_ctrl:0
    v_and_b32_dpp v168, v168, v15 row_shr:1 row_mask:0xf bank_mask:0xf bound_ctrl:0
    v_mfma_f32_32x32x16_bf16 v[144:159], v[196:199], v[84:87], v[144:159]
    ds_read_b64 v[228:229], v14 offset:2720
    ds_read_b64 v[230:231], v14 offset:2728
    v_and_b32_dpp v169, v169, v15 row_shr:1 row_mask:0xf bank_mask:0xf bound_ctrl:0
    v_and_b32_dpp v170, v170, v15 row_shr:1 row_mask:0xf bank_mask:0xf bound_ctrl:0
    v_and_b32_dpp v171, v171, v15 row_shr:1 row_mask:0xf bank_mask:0xf bound_ctrl:0
    v_mfma_f32_32x32x16_bf16 v[144:159], v[200:203], v[88:91], v[144:159]
    ds_read_b64 v[232:233], v14 offset:2752
    ds_read_b64 v[234:235], v14 offset:2760
    v_and_b32_dpp v172, v172, v15 row_shr:1 row_mask:0xf bank_mask:0xf bound_ctrl:0
    v_and_b32_dpp v173, v173, v15 row_shr:1 row_mask:0xf bank_mask:0xf bound_ctrl:0
    v_mfma_f32_32x32x16_bf16 v[144:159], v[204:207], v[92:95], v[144:159]
    ds_read_b64 v[236:237], v14 offset:2784
    ds_read_b64 v[238:239], v14 offset:2792
    v_and_b32_dpp v174, v174, v15 row_shr:1 row_mask:0xf bank_mask:0xf bound_ctrl:0
    v_and_b32_dpp v175, v175, v15 row_shr:1 row_mask:0xf bank_mask:0xf bound_ctrl:0
    v_mfma_f32_32x32x16_bf16 v[128:143], v[176:179], v[32:35], v[128:143]
    s_nop 4
    v_mfma_f32_32x32x16_bf16 v[128:143], v[180:183], v[36:39], v[128:143]
    s_nop 4
    v_mfma_f32_32x32x16_bf16 v[128:143], v[184:187], v[40:43], v[128:143]
    v_mov_b32_dpp v144, v144 row_shr:1 row_mask:0xf bank_mask:0xf bound_ctrl:0
    v_mov_b32_dpp v145, v145 row_shr:1 row_mask:0xf bank_mask:0xf bound_ctrl:0
    v_mov_b32_dpp v146, v146 row_shr:1 row_mask:0xf bank_mask:0xf bound_ctrl:0
    v_mfma_f32_32x32x16_bf16 v[128:143], v[188:191], v[44:47], v[128:143]
    v_mov_b32_dpp v147, v147 row_shr:1 row_mask:0xf bank_mask:0xf bound_ctrl:0
    v_mov_b32_dpp v148, v148 row_shr:1 row_mask:0xf bank_mask:0xf bound_ctrl:0
    v_mov_b32_dpp v149, v149 row_shr:1 row_mask:0xf bank_mask:0xf bound_ctrl:0
    v_mfma_f32_32x32x16_bf16 v[128:143], v[192:195], v[48:51], v[128:143]
    v_mov_b32_dpp v150, v150 row_shr:1 row_mask:0xf bank_mask:0xf bound_ctrl:0
    v_mov_b32_dpp v151, v151 row_shr:1 row_mask:0xf bank_mask:0xf bound_ctrl:0
    v_mov_b32_dpp v152, v152 row_shr:1 row_mask:0xf bank_mask:0xf bound_ctrl:0
    v_mfma_f32_32x32x16_bf16 v[128:143], v[196:199], v[52:55], v[128:143]
    v_mov_b32_dpp v153, v153 row_shr:1 row_mask:0xf bank_mask:0xf bound_ctrl:0
    v_mov_b32_dpp v154, v154 row_shr:1 row_mask:0xf bank_mask:0xf bound_ctrl:0
    v_mov_b32_dpp v155, v155 row_shr:1 row_mask:0xf bank_mask:0xf bound_ctrl:0
    v_mfma_f32_32x32x16_bf16 v[128:143], v[200:203], v[56:59], v[128:143]
    v_mov_b32_dpp v156, v156 row_shr:1 row_mask:0xf bank_mask:0xf bound_ctrl:0
    v_mov_b32_dpp v157, v157 row_shr:1 row_mask:0xf bank_mask:0xf bound_ctrl:0
    v_mfma_f32_32x32x16_bf16 v[128:143], v[204:207], v[60:63], v[128:143]
    v_mov_b32_dpp v158, v158 row_shr:1 row_mask:0xf bank_mask:0xf bound_ctrl:0
    v_mov_b32_dpp v159, v159 row_shr:1 row_mask:0xf bank_mask:0xf bound_ctrl:0
    s_waitcnt lgkmcnt(0)
    v_mfma_f32_32x32x16_bf16 v[160:175], v[208:211], v[96:99], v[160:175]
    ds_read_b64 v[176:177], v14 offset:256
    ds_read_b64 v[178:179], v14 offset:264
    ds_read_b64 v[180:181], v14 offset:288
    ds_read_b64 v[182:183], v14 offset:296
    s_nop 0
    v_mfma_f32_32x32x16_bf16 v[160:175], v[212:215], v[100:103], v[160:175]
    ds_read_b64 v[184:185], v14 offset:320
    ds_read_b64 v[186:187], v14 offset:328
    ds_read_b64 v[188:189], v14 offset:352
    s_nop 1
    v_mfma_f32_32x32x16_bf16 v[160:175], v[216:219], v[104:107], v[160:175]
    ds_read_b64 v[190:191], v14 offset:360
    ds_read_b64 v[192:193], v14 offset:384
    ds_read_b64 v[194:195], v14 offset:392
    v_mov_b32_dpp v128, v128 row_shr:1 row_mask:0xf bank_mask:0xf bound_ctrl:0
    v_mov_b32_dpp v129, v129 row_shr:1 row_mask:0xf bank_mask:0xf bound_ctrl:0
    v_mov_b32_dpp v130, v130 row_shr:1 row_mask:0xf bank_mask:0xf bound_ctrl:0
    v_mfma_f32_32x32x16_bf16 v[160:175], v[220:223], v[108:111], v[160:175]
    ds_read_b64 v[196:197], v14 offset:416
    ds_read_b64 v[198:199], v14 offset:424
    ds_read_b64 v[200:201], v14 offset:448
    v_mov_b32_dpp v131, v131 row_shr:1 row_mask:0xf bank_mask:0xf bound_ctrl:0
    v_mov_b32_dpp v132, v132 row_shr:1 row_mask:0xf bank_mask:0xf bound_ctrl:0
    v_mov_b32_dpp v133, v133 row_shr:1 row_mask:0xf bank_mask:0xf bound_ctrl:0
    v_mfma_f32_32x32x16_bf16 v[160:175], v[224:227], v[112:115], v[160:175]
    ds_read_b64 v[202:203], v14 offset:456
    ds_read_b64 v[204:205], v14 offset:480
    ds_read_b64 v[206:207], v14 offset:488
    v_mov_b32_dpp v134, v134 row_shr:1 row_mask:0xf bank_mask:0xf bound_ctrl:0
    v_mov_b32_dpp v135, v135 row_shr:1 row_mask:0xf bank_mask:0xf bound_ctrl:0
    v_mov_b32_dpp v136, v136 row_shr:1 row_mask:0xf bank_mask:0xf bound_ctrl:0
    v_mfma_f32_32x32x16_bf16 v[160:175], v[228:231], v[116:119], v[160:175]
    v_mov_b32_dpp v137, v137 row_shr:1 row_mask:0xf bank_mask:0xf bound_ctrl:0
    v_mov_b32_dpp v138, v138 row_shr:1 row_mask:0xf bank_mask:0xf bound_ctrl:0
    v_mov_b32_dpp v139, v139 row_shr:1 row_mask:0xf bank_mask:0xf bound_ctrl:0
    v_mfma_f32_32x32x16_bf16 v[160:175], v[232:235], v[120:123], v[160:175]
    v_mov_b32_dpp v140, v140 row_shr:1 row_mask:0xf bank_mask:0xf bound_ctrl:0
    v_mov_b32_dpp v141, v141 row_shr:1 row_mask:0xf bank_mask:0xf bound_ctrl:0
    v_mfma_f32_32x32x16_bf16 v[160:175], v[236:239], v[124:127], v[160:175]
    v_mov_b32_dpp v142, v142 row_shr:1 row_mask:0xf bank_mask:0xf bound_ctrl:0
    v_mov_b32_dpp v143, v143 row_shr:1 row_mask:0xf bank_mask:0xf bound_ctrl:0
    s_waitcnt lgkmcnt(0)
    v_mfma_f32_32x32x16_bf16 v[144:159], v[176:179], v[64:67], v[144:159]
    ds_read_b64 v[208:209], v14 offset:2304
    ds_read_b64 v[210:211], v14 offset:2312
    s_nop 2
    v_mfma_f32_32x32x16_bf16 v[144:159], v[180:183], v[68:71], v[144:159]
    ds_read_b64 v[212:213], v14 offset:2336
    ds_read_b64 v[214:215], v14 offset:2344
    s_nop 2
    v_mfma_f32_32x32x16_bf16 v[144:159], v[184:187], v[72:75], v[144:159]
    ds_read_b64 v[216:217], v14 offset:2368
    ds_read_b64 v[218:219], v14 offset:2376
    v_and_b32_dpp v160, v160, v15 row_shr:1 row_mask:0xf bank_mask:0xf bound_ctrl:0
    v_and_b32_dpp v161, v161, v15 row_shr:1 row_mask:0xf bank_mask:0xf bound_ctrl:0
    v_and_b32_dpp v162, v162, v15 row_shr:1 row_mask:0xf bank_mask:0xf bound_ctrl:0
    v_mfma_f32_32x32x16_bf16 v[144:159], v[188:191], v[76:79], v[144:159]
    ds_read_b64 v[220:221], v14 offset:2400
    ds_read_b64 v[222:223], v14 offset:2408
    v_and_b32_dpp v163, v163, v15 row_shr:1 row_mask:0xf bank_mask:0xf bound_ctrl:0
    v_and_b32_dpp v164, v164, v15 row_shr:1 row_mask:0xf bank_mask:0xf bound_ctrl:0
    v_and_b32_dpp v165, v165, v15 row_shr:1 row_mask:0xf bank_mask:0xf bound_ctrl:0
    v_mfma_f32_32x32x16_bf16 v[144:159], v[192:195], v[80:83], v[144:159]
    ds_read_b64 v[224:225], v14 offset:2432
    ds_read_b64 v[226:227], v14 offset:2440
    v_and_b32_dpp v166, v166, v15 row_shr:1 row_mask:0xf bank_mask:0xf bound_ctrl:0
    v_and_b32_dpp v167, v167, v15 row_shr:1 row_mask:0xf bank_mask:0xf bound_ctrl:0
    v_and_b32_dpp v168, v168, v15 row_shr:1 row_mask:0xf bank_mask:0xf bound_ctrl:0
    v_mfma_f32_32x32x16_bf16 v[144:159], v[196:199], v[84:87], v[144:159]
    ds_read_b64 v[228:229], v14 offset:2464
    ds_read_b64 v[230:231], v14 offset:2472
    v_and_b32_dpp v169, v169, v15 row_shr:1 row_mask:0xf bank_mask:0xf bound_ctrl:0
    v_and_b32_dpp v170, v170, v15 row_shr:1 row_mask:0xf bank_mask:0xf bound_ctrl:0
    v_and_b32_dpp v171, v171, v15 row_shr:1 row_mask:0xf bank_mask:0xf bound_ctrl:0
    v_mfma_f32_32x32x16_bf16 v[144:159], v[200:203], v[88:91], v[144:159]
    ds_read_b64 v[232:233], v14 offset:2496
    ds_read_b64 v[234:235], v14 offset:2504
    v_and_b32_dpp v172, v172, v15 row_shr:1 row_mask:0xf bank_mask:0xf bound_ctrl:0
    v_and_b32_dpp v173, v173, v15 row_shr:1 row_mask:0xf bank_mask:0xf bound_ctrl:0
    v_mfma_f32_32x32x16_bf16 v[144:159], v[204:207], v[92:95], v[144:159]
    ds_read_b64 v[236:237], v14 offset:2528
    ds_read_b64 v[238:239], v14 offset:2536
    v_and_b32_dpp v174, v174, v15 row_shr:1 row_mask:0xf bank_mask:0xf bound_ctrl:0
    v_and_b32_dpp v175, v175, v15 row_shr:1 row_mask:0xf bank_mask:0xf bound_ctrl:0
    v_mfma_f32_32x32x16_bf16 v[128:143], v[176:179], v[32:35], v[128:143]
    s_nop 4
    v_mfma_f32_32x32x16_bf16 v[128:143], v[180:183], v[36:39], v[128:143]
    s_nop 4
    v_mfma_f32_32x32x16_bf16 v[128:143], v[184:187], v[40:43], v[128:143]
    v_mov_b32_dpp v144, v144 row_shr:1 row_mask:0xf bank_mask:0xf bound_ctrl:0
    v_mov_b32_dpp v145, v145 row_shr:1 row_mask:0xf bank_mask:0xf bound_ctrl:0
    v_mov_b32_dpp v146, v146 row_shr:1 row_mask:0xf bank_mask:0xf bound_ctrl:0
    v_mfma_f32_32x32x16_bf16 v[128:143], v[188:191], v[44:47], v[128:143]
    v_mov_b32_dpp v147, v147 row_shr:1 row_mask:0xf bank_mask:0xf bound_ctrl:0
    v_mov_b32_dpp v148, v148 row_shr:1 row_mask:0xf bank_mask:0xf bound_ctrl:0
    v_mov_b32_dpp v149, v149 row_shr:1 row_mask:0xf bank_mask:0xf bound_ctrl:0
    v_mfma_f32_32x32x16_bf16 v[128:143], v[192:195], v[48:51], v[128:143]
    v_mov_b32_dpp v150, v150 row_shr:1 row_mask:0xf bank_mask:0xf bound_ctrl:0
    v_mov_b32_dpp v151, v151 row_shr:1 row_mask:0xf bank_mask:0xf bound_ctrl:0
    v_mov_b32_dpp v152, v152 row_shr:1 row_mask:0xf bank_mask:0xf bound_ctrl:0
    v_mfma_f32_32x32x16_bf16 v[128:143], v[196:199], v[52:55], v[128:143]
    v_mov_b32_dpp v153, v153 row_shr:1 row_mask:0xf bank_mask:0xf bound_ctrl:0
    v_mov_b32_dpp v154, v154 row_shr:1 row_mask:0xf bank_mask:0xf bound_ctrl:0
    v_mov_b32_dpp v155, v155 row_shr:1 row_mask:0xf bank_mask:0xf bound_ctrl:0
    v_mfma_f32_32x32x16_bf16 v[128:143], v[200:203], v[56:59], v[128:143]
    v_mov_b32_dpp v156, v156 row_shr:1 row_mask:0xf bank_mask:0xf bound_ctrl:0
    v_mov_b32_dpp v157, v157 row_shr:1 row_mask:0xf bank_mask:0xf bound_ctrl:0
    v_mfma_f32_32x32x16_bf16 v[128:143], v[204:207], v[60:63], v[128:143]
    v_mov_b32_dpp v158, v158 row_shr:1 row_mask:0xf bank_mask:0xf bound_ctrl:0
    v_mov_b32_dpp v159, v159 row_shr:1 row_mask:0xf bank_mask:0xf bound_ctrl:0
    s_waitcnt lgkmcnt(0)
    v_mfma_f32_32x32x16_bf16 v[160:175], v[208:211], v[96:99], v[160:175]
    ds_read_b64 v[176:177], v14 offset:0
    ds_read_b64 v[178:179], v14 offset:8
    ds_read_b64 v[180:181], v14 offset:32
    ds_read_b64 v[182:183], v14 offset:40
    s_nop 0
    v_mfma_f32_32x32x16_bf16 v[160:175], v[212:215], v[100:103], v[160:175]
    ds_read_b64 v[184:185], v14 offset:64
    ds_read_b64 v[186:187], v14 offset:72
    ds_read_b64 v[188:189], v14 offset:96
    s_nop 1
    v_mfma_f32_32x32x16_bf16 v[160:175], v[216:219], v[104:107], v[160:175]
    ds_read_b64 v[190:191], v14 offset:104
    ds_read_b64 v[192:193], v14 offset:128
    ds_read_b64 v[194:195], v14 offset:136
    v_mov_b32_dpp v128, v128 row_shr:1 row_mask:0xf bank_mask:0xf bound_ctrl:0
    v_mov_b32_dpp v129, v129 row_shr:1 row_mask:0xf bank_mask:0xf bound_ctrl:0
    v_mov_b32_dpp v130, v130 row_shr:1 row_mask:0xf bank_mask:0xf bound_ctrl:0
    v_mfma_f32_32x32x16_bf16 v[160:175], v[220:223], v[108:111], v[160:175]
    ds_read_b64 v[196:197], v14 offset:160
    ds_read_b64 v[198:199], v14 offset:168
    ds_read_b64 v[200:201], v14 offset:192
    v_mov_b32_dpp v131, v131 row_shr:1 row_mask:0xf bank_mask:0xf bound_ctrl:0
    v_mov_b32_dpp v132, v132 row_shr:1 row_mask:0xf bank_mask:0xf bound_ctrl:0
    v_mov_b32_dpp v133, v133 row_shr:1 row_mask:0xf bank_mask:0xf bound_ctrl:0
    v_mfma_f32_32x32x16_bf16 v[160:175], v[224:227], v[112:115], v[160:175]
    ds_read_b64 v[202:203], v14 offset:200
    ds_read_b64 v[204:205], v14 offset:224
    ds_read_b64 v[206:207], v14 offset:232
    v_mov_b32_dpp v134, v134 row_shr:1 row_mask:0xf bank_mask:0xf bound_ctrl:0
    v_mov_b32_dpp v135, v135 row_shr:1 row_mask:0xf bank_mask:0xf bound_ctrl:0
    v_mov_b32_dpp v136, v136 row_shr:1 row_mask:0xf bank_mask:0xf bound_ctrl:0
    v_mfma_f32_32x32x16_bf16 v[160:175], v[228:231], v[116:119], v[160:175]
    v_mov_b32_dpp v137, v137 row_shr:1 row_mask:0xf bank_mask:0xf bound_ctrl:0
    v_mov_b32_dpp v138, v138 row_shr:1 row_mask:0xf bank_mask:0xf bound_ctrl:0
    v_mov_b32_dpp v139, v139 row_shr:1 row_mask:0xf bank_mask:0xf bound_ctrl:0
    v_mfma_f32_32x32x16_bf16 v[160:175], v[232:235], v[120:123], v[160:175]
    v_mov_b32_dpp v140, v140 row_shr:1 row_mask:0xf bank_mask:0xf bound_ctrl:0
    v_mov_b32_dpp v141, v141 row_shr:1 row_mask:0xf bank_mask:0xf bound_ctrl:0
    v_mfma_f32_32x32x16_bf16 v[160:175], v[236:239], v[124:127], v[160:175]
    v_mov_b32_dpp v142, v142 row_shr:1 row_mask:0xf bank_mask:0xf bound_ctrl:0
    v_mov_b32_dpp v143, v143 row_shr:1 row_mask:0xf bank_mask:0xf bound_ctrl:0
    s_waitcnt lgkmcnt(0)
    v_mfma_f32_32x32x16_bf16 v[144:159], v[176:179], v[64:67], v[144:159]
    ds_read_b64 v[208:209], v14 offset:2048
    ds_read_b64 v[210:211], v14 offset:2056
    s_nop 2
    v_mfma_f32_32x32x16_bf16 v[144:159], v[180:183], v[68:71], v[144:159]
    ds_read_b64 v[212:213], v14 offset:2080
    ds_read_b64 v[214:215], v14 offset:2088
    s_nop 2
    v_mfma_f32_32x32x16_bf16 v[144:159], v[184:187], v[72:75], v[144:159]
    ds_read_b64 v[216:217], v14 offset:2112
    ds_read_b64 v[218:219], v14 offset:2120
    v_and_b32_dpp v160, v160, v15 row_shr:1 row_mask:0xf bank_mask:0xf bound_ctrl:0
    v_and_b32_dpp v161, v161, v15 row_shr:1 row_mask:0xf bank_mask:0xf bound_ctrl:0
    v_and_b32_dpp v162, v162, v15 row_shr:1 row_mask:0xf bank_mask:0xf bound_ctrl:0
    v_mfma_f32_32x32x16_bf16 v[144:159], v[188:191], v[76:79], v[144:159]
    ds_read_b64 v[220:221], v14 offset:2144
    ds_read_b64 v[222:223], v14 offset:2152
    v_and_b32_dpp v163, v163, v15 row_shr:1 row_mask:0xf bank_mask:0xf bound_ctrl:0
    v_and_b32_dpp v164, v164, v15 row_shr:1 row_mask:0xf bank_mask:0xf bound_ctrl:0
    v_and_b32_dpp v165, v165, v15 row_shr:1 row_mask:0xf bank_mask:0xf bound_ctrl:0
    v_mfma_f32_32x32x16_bf16 v[144:159], v[192:195], v[80:83], v[144:159]
    ds_read_b64 v[224:225], v14 offset:2176
    ds_read_b64 v[226:227], v14 offset:2184
    v_and_b32_dpp v166, v166, v15 row_shr:1 row_mask:0xf bank_mask:0xf bound_ctrl:0
    v_and_b32_dpp v167, v167, v15 row_shr:1 row_mask:0xf bank_mask:0xf bound_ctrl:0
    v_and_b32_dpp v168, v168, v15 row_shr:1 row_mask:0xf bank_mask:0xf bound_ctrl:0
    v_mfma_f32_32x32x16_bf16 v[144:159], v[196:199], v[84:87], v[144:159]
    ds_read_b64 v[228:229], v14 offset:2208
    ds_read_b64 v[230:231], v14 offset:2216
    v_and_b32_dpp v169, v169, v15 row_shr:1 row_mask:0xf bank_mask:0xf bound_ctrl:0
    v_and_b32_dpp v170, v170, v15 row_shr:1 row_mask:0xf bank_mask:0xf bound_ctrl:0
    v_and_b32_dpp v171, v171, v15 row_shr:1 row_mask:0xf bank_mask:0xf bound_ctrl:0
    v_mfma_f32_32x32x16_bf16 v[144:159], v[200:203], v[88:91], v[144:159]
    ds_read_b64 v[232:233], v14 offset:2240
    ds_read_b64 v[234:235], v14 offset:2248
    v_and_b32_dpp v172, v172, v15 row_shr:1 row_mask:0xf bank_mask:0xf bound_ctrl:0
    v_and_b32_dpp v173, v173, v15 row_shr:1 row_mask:0xf bank_mask:0xf bound_ctrl:0
    v_mfma_f32_32x32x16_bf16 v[144:159], v[204:207], v[92:95], v[144:159]
    ds_read_b64 v[236:237], v14 offset:2272
    ds_read_b64 v[238:239], v14 offset:2280
    v_and_b32_dpp v174, v174, v15 row_shr:1 row_mask:0xf bank_mask:0xf bound_ctrl:0
    v_and_b32_dpp v175, v175, v15 row_shr:1 row_mask:0xf bank_mask:0xf bound_ctrl:0
    v_mfma_f32_32x32x16_bf16 v[128:143], v[176:179], v[32:35], v[128:143]
    v_mfma_f32_32x32x16_bf16 v[128:143], v[180:183], v[36:39], v[128:143]
    v_mfma_f32_32x32x16_bf16 v[128:143], v[184:187], v[40:43], v[128:143]
    v_mul_u32_u24 v16, 272, v7
    v_add_u32 v16, s34, v16
    v_add_u32 v16, 4388, v16
    v_lshlrev_b32 v17, 2, v8
    v_sub_u32 v16, v16, v17
    v_lshlrev_b32 v17, 5, v9
    v_sub_u32 v16, v16, v17
    v_mfma_f32_32x32x16_bf16 v[128:143], v[188:191], v[44:47], v[128:143]
    ds_read_b32 v64, v16 offset:216
    ds_read_b32 v65, v16 offset:208
    ds_read_b32 v66, v16 offset:200
    ds_read_b32 v67, v16 offset:192
    ds_read_b32 v68, v16 offset:152
    ds_read_b32 v69, v16 offset:144
    v_mfma_f32_32x32x16_bf16 v[128:143], v[192:195], v[48:51], v[128:143]
    ds_read_b32 v70, v16 offset:136
    ds_read_b32 v71, v16 offset:128
    ds_read_b32 v72, v16 offset:88
    ds_read_b32 v73, v16 offset:80
    ds_read_b32 v74, v16 offset:72
    ds_read_b32 v75, v16 offset:64
    v_mfma_f32_32x32x16_bf16 v[128:143], v[196:199], v[52:55], v[128:143]
    ds_read_b32 v76, v16 offset:24
    ds_read_b32 v77, v16 offset:16
    ds_read_b32 v78, v16 offset:8
    ds_read_b32 v79, v16 offset:0
    s_lshr_b32 s44, s20, 1
    s_and_b32 s45, s20, 1
    v_mfma_f32_32x32x16_bf16 v[128:143], v[200:203], v[56:59], v[128:143]
    s_cmp_eq_u32 s44, 1
    s_cselect_b32 s44, s33, s32
    s_lshl_b32 s46, s44, 16
    s_and_b32 s47, s44, 0xffff0000
    s_cmp_eq_u32 s45, 1
    s_cselect_b32 s44, s47, s46
    v_mfma_f32_32x32x16_bf16 v[128:143], v[204:207], v[60:63], v[128:143]
    v_mul_u32_u24 v18, 264, v7
    v_lshl_add_u32 v18, v9, 5, v18
    v_lshl_add_u32 v18, v8, 2, v18
    v_add_u32 v18, s34, v18
    v_mul_u32_u24 v17, 264, v2
    v_lshl_add_u32 v17, v1, 2, v17
    s_waitcnt lgkmcnt(0)
    v_mfma_f32_32x32x16_bf16 v[160:175], v[208:211], v[96:99], v[160:175]
    v_mfma_f32_32x32x16_bf16 v[160:175], v[212:215], v[100:103], v[160:175]
    v_mfma_f32_32x32x16_bf16 v[160:175], v[216:219], v[104:107], v[160:175]
    v_and_b32 v80, 0xffff0000, v64
    v_lshlrev_b32 v64, 16, v64
    v_and_b32 v81, 0xffff0000, v65
    v_lshlrev_b32 v65, 16, v65
    v_and_b32 v82, 0xffff0000, v66
    v_lshlrev_b32 v66, 16, v66
    v_mfma_f32_32x32x16_bf16 v[160:175], v[220:223], v[108:111], v[160:175]
    v_and_b32 v83, 0xffff0000, v67
    v_lshlrev_b32 v67, 16, v67
    v_and_b32 v84, 0xffff0000, v68
    v_lshlrev_b32 v68, 16, v68
    v_and_b32 v85, 0xffff0000, v69
    v_lshlrev_b32 v69, 16, v69
    v_mfma_f32_32x32x16_bf16 v[160:175], v[224:227], v[112:115], v[160:175]
    v_and_b32 v86, 0xffff0000, v70
    v_lshlrev_b32 v70, 16, v70
    v_and_b32 v87, 0xffff0000, v71
    v_lshlrev_b32 v71, 16, v71
    v_and_b32 v88, 0xffff0000, v72
    v_mfma_f32_32x32x16_bf16 v[160:175], v[228:231], v[116:119], v[160:175]
    v_lshlrev_b32 v72, 16, v72
    v_and_b32 v89, 0xffff0000, v73
    v_lshlrev_b32 v73, 16, v73
    v_and_b32 v90, 0xffff0000, v74
    v_lshlrev_b32 v74, 16, v74
    v_mfma_f32_32x32x16_bf16 v[160:175], v[232:235], v[120:123], v[160:175]
    v_and_b32 v91, 0xffff0000, v75
    v_lshlrev_b32 v75, 16, v75
    v_and_b32 v92, 0xffff0000, v76
    v_lshlrev_b32 v76, 16, v76
    v_and_b32 v93, 0xffff0000, v77
    v_mfma_f32_32x32x16_bf16 v[160:175], v[236:239], v[124:127], v[160:175]
    v_lshlrev_b32 v77, 16, v77
    v_and_b32 v94, 0xffff0000, v78
    v_lshlrev_b32 v78, 16, v78
    v_and_b32 v95, 0xffff0000, v79
    v_lshlrev_b32 v79, 16, v79
    s_mov_b32 s48, 0x05040100
    s_mov_b32 s49, 0x07060302
    s_nop 11
    v_add_f32_dpp v128, v160, v128 row_shr:8 row_mask:0xf bank_mask:0xf bound_ctrl:0
    v_add_f32_dpp v129, v161, v129 row_shr:8 row_mask:0xf bank_mask:0xf bound_ctrl:0
    v_add_f32_dpp v130, v162, v130 row_shr:8 row_mask:0xf bank_mask:0xf bound_ctrl:0
    v_add_f32_dpp v131, v163, v131 row_shr:8 row_mask:0xf bank_mask:0xf bound_ctrl:0
    v_add_f32_dpp v132, v164, v132 row_shr:8 row_mask:0xf bank_mask:0xf bound_ctrl:0
    v_add_f32_dpp v133, v165, v133 row_shr:8 row_mask:0xf bank_mask:0xf bound_ctrl:0
    v_add_f32_dpp v134, v166, v134 row_shr:8 row_mask:0xf bank_mask:0xf bound_ctrl:0
    v_add_f32_dpp v135, v167, v135 row_shr:8 row_mask:0xf bank_mask:0xf bound_ctrl:0
    v_add_f32_dpp v136, v168, v136 row_shr:8 row_mask:0xf bank_mask:0xf bound_ctrl:0
    v_add_f32_dpp v137, v169, v137 row_shr:8 row_mask:0xf bank_mask:0xf bound_ctrl:0
    v_add_f32_dpp v138, v170, v138 row_shr:8 row_mask:0xf bank_mask:0xf bound_ctrl:0
    v_add_f32_dpp v139, v171, v139 row_shr:8 row_mask:0xf bank_mask:0xf bound_ctrl:0
    v_add_f32_dpp v140, v172, v140 row_shr:8 row_mask:0xf bank_mask:0xf bound_ctrl:0
    v_add_f32_dpp v141, v173, v141 row_shr:8 row_mask:0xf bank_mask:0xf bound_ctrl:0
    v_add_f32_dpp v142, v174, v142 row_shr:8 row_mask:0xf bank_mask:0xf bound_ctrl:0
    v_add_f32_dpp v143, v175, v143 row_shr:8 row_mask:0xf bank_mask:0xf bound_ctrl:0
    s_mov_b32 s42, 0xff00ff00
    s_mov_b32 s43, 0xff00ff00
    s_mov_b64 exec, s[42:43]
    v_add_f32 v144, v160, v144
    v_add_f32 v145, v161, v145
    v_add_f32 v146, v162, v146
    v_add_f32 v147, v163, v147
    v_add_f32 v148, v164, v148
    v_add_f32 v149, v165, v149
    v_add_f32 v150, v166, v150
    v_add_f32 v151, v167, v151
    v_add_f32 v152, v168, v152
    v_add_f32 v153, v169, v153
    v_add_f32 v154, v170, v154
    v_add_f32 v155, v171, v155
    v_add_f32 v156, v172, v156
    v_add_f32 v157, v173, v157
    v_add_f32 v158, v174, v158
    v_add_f32 v159, v175, v159
    s_mov_b64 exec, -1
    v_fma_f32 v128, v80, s44, v128
    v_fma_f32 v144, v64, s44, v144
    v_fma_f32 v129, v81, s44, v129
    v_fma_f32 v145, v65, s44, v145
    v_fma_f32 v130, v82, s44, v130
    v_fma_f32 v146, v66, s44, v146
    v_fma_f32 v131, v83, s44, v131
    v_fma_f32 v147, v67, s44, v147
    v_fma_f32 v132, v84, s44, v132
    v_fma_f32 v148, v68, s44, v148
    v_fma_f32 v133, v85, s44, v133
    v_fma_f32 v149, v69, s44, v149
    v_fma_f32 v134, v86, s44, v134
    v_fma_f32 v150, v70, s44, v150
    v_fma_f32 v135, v87, s44, v135
    v_fma_f32 v151, v71, s44, v151
    v_fma_f32 v136, v88, s44, v136
    v_fma_f32 v152, v72, s44, v152
    v_fma_f32 v137, v89, s44, v137
    v_fma_f32 v153, v73, s44, v153
    v_fma_f32 v138, v90, s44, v138
    v_fma_f32 v154, v74, s44, v154
    v_fma_f32 v139, v91, s44, v139
    v_fma_f32 v155, v75, s44, v155
    v_fma_f32 v140, v92, s44, v140
    v_fma_f32 v156, v76, s44, v156
    v_fma_f32 v141, v93, s44, v141
    v_fma_f32 v157, v77, s44, v157
    v_fma_f32 v142, v94, s44, v142
    v_fma_f32 v158, v78, s44, v158
    v_fma_f32 v143, v95, s44, v143
    v_fma_f32 v159, v79, s44, v159
    v_cvt_pk_bf16_f32 v32, v128, v144
    v_cvt_pk_bf16_f32 v33, v129, v145
    v_cvt_pk_bf16_f32 v34, v130, v146
    v_cvt_pk_bf16_f32 v35, v131, v147
    v_cvt_pk_bf16_f32 v36, v132, v148
    v_cvt_pk_bf16_f32 v37, v133, v149
    v_cvt_pk_bf16_f32 v38, v134, v150
    v_cvt_pk_bf16_f32 v39, v135, v151
    v_cvt_pk_bf16_f32 v40, v136, v152
    v_cvt_pk_bf16_f32 v41, v137, v153
    v_cvt_pk_bf16_f32 v42, v138, v154
    v_cvt_pk_bf16_f32 v43, v139, v155
    v_cvt_pk_bf16_f32 v44, v140, v156
    v_cvt_pk_bf16_f32 v45, v141, v157
    v_cvt_pk_bf16_f32 v46, v142, v158
    v_cvt_pk_bf16_f32 v47, v143, v159
    ds_write_b32 v18, v32 offset:0
    ds_write_b32 v18, v33 offset:8
    ds_write_b32 v18, v34 offset:16
    ds_write_b32 v18, v35 offset:24
    ds_write_b32 v18, v36 offset:64
    ds_write_b32 v18, v37 offset:72
    ds_write_b32 v18, v38 offset:80
    ds_write_b32 v18, v39 offset:88
    ds_write_b32 v18, v40 offset:128
    ds_write_b32 v18, v41 offset:136
    ds_write_b32 v18, v42 offset:144
    ds_write_b32 v18, v43 offset:152
    ds_write_b32 v18, v44 offset:192
    ds_write_b32 v18, v45 offset:200
    ds_write_b32 v18, v46 offset:208
    ds_write_b32 v18, v47 offset:216
    s_waitcnt lgkmcnt(0)
    s_barrier
    ds_read_b32 v48, v17 offset:0
    ds_read_b32 v49, v17 offset:9472
    ds_read_b32 v50, v17 offset:18944
    ds_read_b32 v51, v17 offset:28416
    ds_read_b32 v52, v17 offset:1056
    ds_read_b32 v53, v17 offset:10528
    ds_read_b32 v54, v17 offset:20000
    ds_read_b32 v55, v17 offset:29472
    ds_read_b32 v56, v17 offset:2112
    ds_read_b32 v57, v17 offset:11584
    ds_read_b32 v58, v17 offset:21056
    ds_read_b32 v59, v17 offset:30528
    ds_read_b32 v60, v17 offset:3168
    ds_read_b32 v61, v17 offset:12640
    ds_read_b32 v62, v17 offset:22112
    ds_read_b32 v63, v17 offset:31584
    s_waitcnt lgkmcnt(0)
    v_perm_b32 v96, v49, v48, s48
    v_perm_b32 v98, v49, v48, s49
    v_perm_b32 v97, v51, v50, s48
    v_perm_b32 v99, v51, v50, s49
    v_perm_b32 v100, v53, v52, s48
    v_perm_b32 v102, v53, v52, s49
    v_perm_b32 v101, v55, v54, s48
    v_perm_b32 v103, v55, v54, s49
    v_perm_b32 v104, v57, v56, s48
    v_perm_b32 v106, v57, v56, s49
    v_perm_b32 v105, v59, v58, s48
    v_perm_b32 v107, v59, v58, s49
    v_perm_b32 v108, v61, v60, s48
    v_perm_b32 v110, v61, v60, s49
    v_perm_b32 v109, v63, v62, s48
    v_perm_b32 v111, v63, v62, s49
    v_lshrrev_b32 v20, 3, v0
    v_lshrrev_b32 v21, 4, v20
    v_and_b32 v22, 15, v20
    v_mul_u32_u24 v23, 20480, v20
    v_sub_u32 v23, v4, v23
    s_mov_b32 s40, 1601536
    v_mul_lo_u32 v24, v21, s40
    v_add_u32 v24, v24, v23
    v_add_u32 v25, 1, v22
    v_mul_u32_u24 v25, 20480, v25
    v_add_u32 v25, v25, v24
    v_cmp_eq_u32 s[42:43], 15, v22
    v_cmp_eq_u32 s[44:45], 0, v22
    v_add_u32 v26, 3203072, v24
    v_add_u32 v27, 348160, v24
    v_cndmask_b32 v26, v27, v26, s[42:43]
    v_cmp_ne_u32 vcc, 0, v20
    s_and_b64 s[46:47], s[44:45], vcc
    s_or_b64 s[46:47], s[46:47], s[42:43]
    v_cmp_ne_u32 vcc, 31, v20
    s_and_b64 s[52:53], s[42:43], vcc
    s_or_b64 s[52:53], s[52:53], s[44:45]
    s_or_b64 s[44:45], s[44:45], s[42:43]
    s_add_u32 s39, s38, 9060352
    buffer_store_dwordx4 v[96:99], v25, s[28:31], s39 offen sc1
    s_mov_b64 exec, s[46:47]
    s_cbranch_execz k1_kernel_halo9
    s_sub_u32 s41, s39, 1601536
    buffer_store_dwordx4 v[96:99], v26, s[28:31], s41 offen sc1
k1_kernel_halo9:
    s_mov_b64 exec, -1
    s_add_u32 s39, s39, 3203072
    buffer_store_dwordx4 v[100:103], v25, s[28:31], s39 offen sc1
    s_mov_b64 exec, s[44:45]
    s_cbranch_execz k1_kernel_halo10
    s_sub_u32 s41, s39, 1601536
    buffer_store_dwordx4 v[100:103], v26, s[28:31], s41 offen sc1
k1_kernel_halo10:
    s_mov_b64 exec, -1
    s_add_u32 s39, s39, 3203072
    buffer_store_dwordx4 v[104:107], v25, s[28:31], s39 offen sc1
    s_mov_b64 exec, s[44:45]
    s_cbranch_execz k1_kernel_halo11
    s_sub_u32 s41, s39, 1601536
    buffer_store_dwordx4 v[104:107], v26, s[28:31], s41 offen sc1
k1_kernel_halo11:
    s_mov_b64 exec, -1
    s_add_u32 s39, s39, 3203072
    buffer_store_dwordx4 v[108:111], v25, s[28:31], s39 offen sc1
    s_mov_b64 exec, s[52:53]
    s_cbranch_execz k1_kernel_halo12
    s_sub_u32 s41, s39, 1601536
    buffer_store_dwordx4 v[108:111], v26, s[28:31], s41 offen sc1
k1_kernel_halo12:
    s_mov_b64 exec, -1
    s_add_u32 s39, s39, 3203072
    s_waitcnt vmcnt(0)
    s_endpgm
k1_side:
    s_cmp_ge_u32 s54, 188
    s_cbranch_scc1 k1_end
    s_cmp_lt_u32 s54, 128
    s_cbranch_scc1 k1_kernel_sx13
    s_mov_b32 s61, s54
    s_cmp_lg_u32 s20, 0
    s_cbranch_scc1 k1_kernel_sw15
    s_and_b32 s55, s2, 7
    s_lshl_b32 s57, s55, 9
    s_add_u32 s57, s57, 9056256
    v_mov_b32 v250, 0
    v_and_b32 v248, 31, v0
    v_lshlrev_b32 v248, 2, v248
    s_waitcnt lgkmcnt(0)
    s_mov_b32 s28, s10
    s_mov_b32 s29, s11
    s_mov_b32 s30, 268435456
    s_mov_b32 s31, 0x00020000
    buffer_load_dword v251, v250, s[28:31], s57 offen sc1
    s_mov_b32 s23, 30
    s_waitcnt vmcnt(0)
    v_add_u32 v251, 1, v251
k1_kernel_sw14:
    buffer_load_dword v249, v248, s[28:31], s57 offen offset:256 sc1
    s_waitcnt vmcnt(0)
    v_cmp_eq_u32 vcc, v251, v249
    s_sub_u32 s23, s23, 1
    s_cmp_eq_u64 vcc, -1
    s_cbranch_scc1 k1_kernel_sw15
    s_sleep 16
    s_cmp_lg_u32 s23, 0
    s_cbranch_scc1 k1_kernel_sw14
k1_kernel_sw15:
    s_barrier
    s_mov_b32 s54, s61
k1_kernel_sx13:
    s_cmp_lt_u32 s54, 128
    s_cbranch_scc1 k1_pf
    s_branch k1_mod0
k1_side2:
    s_load_dwordx2 s[10:11], s[0:1], 120
    s_load_dwordx8 s[12:19], s[0:1], 56
    v_lshrrev_b32 v2, 6, v0
    v_and_b32 v1, 63, v0
    v_readfirstlane_b32 s20, v2
    s_waitcnt lgkmcnt(0)
    s_mov_b32 s28, s10
    s_mov_b32 s29, s11
    s_mov_b32 s30, 268435456
    s_mov_b32 s31, 0x00020000
    s_sub_u32 s21, s54, 0
    v_lshrrev_b32 v3, 3, v0
    v_and_b32 v4, 7, v0
    v_mul_u32_u24 v5, 144, v3
    v_lshl_add_u32 v5, v4, 4, v5
    v_and_b32 v6, 15, v1
    v_lshrrev_b32 v7, 4, v1
    v_lshrrev_b32 v8, 2, v6
    v_lshl_add_u32 v8, v7, 3, v8
    v_mul_u32_u24 v8, 144, v8
    v_and_b32 v9, 3, v6
    v_lshl_add_u32 v8, v9, 3, v8
    s_lshl_b32 s22, s20, 5
    v_add_u32 v8, s22, v8
    v_lshlrev_b32 v9, 4, v1
    s_cmp_lt_u32 s21, 10
    s_cbranch_scc1 k1_kernel_pk16
    s_cmp_lt_u32 s21, 20
    s_cbranch_scc1 k1_kernel_pk17
    s_cmp_lt_u32 s21, 48
    s_cbranch_scc1 k1_kernel_pk18
    s_cmp_lt_u32 s21, 78
    s_cbranch_scc1 k1_kernel_pk19
    s_branch k1_kernel_pke20
k1_kernel_pk16:
    s_mov_b32 s24, s12
    s_mov_b32 s25, s13
    s_mov_b32 s26, 819200
    s_mov_b32 s27, 0x00020000
    s_sub_u32 s32, s21, 0
    s_mul_i32 s33, s32, 52429
    s_lshr_b32 s33, s33, 18
    s_mul_i32 s34, s33, 5
    s_sub_u32 s34, s32, s34
    s_lshl_b32 s34, s34, 1
    v_mul_u32_u24 v10, 1280, v3
    v_lshl_add_u32 v10, v4, 4, v10
    s_mul_i32 s35, s33, 409600
    s_lshl_b32 s36, s34, 7
    s_add_u32 s35, s35, s36
    buffer_load_dwordx4 v[32:35], v10, s[24:27], s35 offen offset:0
    s_add_u32 s35, s35, 40960
    buffer_load_dwordx4 v[36:39], v10, s[24:27], s35 offen offset:0
    s_add_u32 s35, s35, 40960
    buffer_load_dwordx4 v[40:43], v10, s[24:27], s35 offen offset:0
    s_add_u32 s35, s35, 40960
    buffer_load_dwordx4 v[44:47], v10, s[24:27], s35 offen offset:0
    s_add_u32 s35, s35, 40960
    buffer_load_dwordx4 v[48:51], v10, s[24:27], s35 offen offset:0
    s_add_u32 s35, s35, 40960
    buffer_load_dwordx4 v[52:55], v10, s[24:27], s35 offen offset:0
    s_add_u32 s35, s35, 40960
    buffer_load_dwordx4 v[56:59], v10, s[24:27], s35 offen offset:0
    s_add_u32 s35, s35, 40960
    buffer_load_dwordx4 v[60:63], v10, s[24:27], s35 offen offset:0
    s_add_u32 s35, s35, 40960
    buffer_load_dwordx4 v[64:67], v10, s[24:27], s35 offen offset:0
    s_add_u32 s35, s35, 40960
    buffer_load_dwordx4 v[68:71], v10, s[24:27], s35 offen offset:0
    s_sub_u32 s35, s35, 368640
    buffer_load_dwordx4 v[72:75], v10, s[24:27], s35 offen offset:128
    s_add_u32 s35, s35, 40960
    buffer_load_dwordx4 v[76:79], v10, s[24:27], s35 offen offset:128
    s_add_u32 s35, s35, 40960
    buffer_load_dwordx4 v[80:83], v10, s[24:27], s35 offen offset:128
    s_add_u32 s35, s35, 40960
    buffer_load_dwordx4 v[84:87], v10, s[24:27], s35 offen offset:128
    s_add_u32 s35, s35, 40960
    buffer_load_dwordx4 v[88:91], v10, s[24:27], s35 offen offset:128
    s_add_u32 s35, s35, 40960
    buffer_load_dwordx4 v[92:95], v10, s[24:27], s35 offen offset:128
    s_add_u32 s35, s35, 40960
    buffer_load_dwordx4 v[96:99], v10, s[24:27], s35 offen offset:128
    s_add_u32 s35, s35, 40960
    buffer_load_dwordx4 v[100:103], v10, s[24:27], s35 offen offset:128
    s_add_u32 s35, s35, 40960
    buffer_load_dwordx4 v[104:107], v10, s[24:27], s35 offen offset:128
    s_add_u32 s35, s35, 40960
    buffer_load_dwordx4 v[108:111], v10, s[24:27], s35 offen offset:128
    s_lshl_b32 s36, s34, 2
    s_add_u32 s36, s36, s20
    s_mul_i32 s38, s36, 52429
    s_lshr_b32 s38, s38, 18
    s_mul_i32 s39, s38, 5
    s_sub_u32 s39, s36, s39
    s_mul_i32 s37, s38, 100
    s_mul_i32 s40, s33, 50
    s_add_u32 s37, s37, s40
    s_add_u32 s37, s37, s39
    s_lshl_b32 s37, s37, 10
    s_add_u32 s37, s37, 2764800
    s_waitcnt vmcnt(19)
    ds_write_b128 v5, v[32:35] offset:0
    s_waitcnt vmcnt(18)
    ds_write_b128 v5, v[36:39] offset:4608
    s_waitcnt vmcnt(17)
    ds_write_b128 v5, v[40:43] offset:9216
    s_waitcnt vmcnt(16)
    ds_write_b128 v5, v[44:47] offset:13824
    s_waitcnt vmcnt(15)
    ds_write_b128 v5, v[48:51] offset:18432
    s_waitcnt vmcnt(14)
    ds_write_b128 v5, v[52:55] offset:23040
    s_waitcnt vmcnt(13)
    ds_write_b128 v5, v[56:59] offset:27648
    s_waitcnt vmcnt(12)
    ds_write_b128 v5, v[60:63] offset:32256
    s_waitcnt vmcnt(11)
    ds_write_b128 v5, v[64:67] offset:36864
    s_waitcnt vmcnt(10)
    ds_write_b128 v5, v[68:71] offset:41472
    s_waitcnt lgkmcnt(0)
    s_barrier
    ds_read_b64_tr_b16 v[32:33], v8 offset:0
    ds_read_b64_tr_b16 v[34:35], v8 offset:576
    ds_read_b64_tr_b16 v[36:37], v8 offset:4608
    ds_read_b64_tr_b16 v[38:39], v8 offset:5184
    ds_read_b64_tr_b16 v[40:41], v8 offset:9216
    ds_read_b64_tr_b16 v[42:43], v8 offset:9792
    ds_read_b64_tr_b16 v[44:45], v8 offset:13824
    ds_read_b64_tr_b16 v[46:47], v8 offset:14400
    ds_read_b64_tr_b16 v[48:49], v8 offset:18432
    ds_read_b64_tr_b16 v[50:51], v8 offset:19008
    ds_read_b64_tr_b16 v[52:53], v8 offset:23040
    ds_read_b64_tr_b16 v[54:55], v8 offset:23616
    ds_read_b64_tr_b16 v[56:57], v8 offset:27648
    ds_read_b64_tr_b16 v[58:59], v8 offset:28224
    ds_read_b64_tr_b16 v[60:61], v8 offset:32256
    ds_read_b64_tr_b16 v[62:63], v8 offset:32832
    ds_read_b64_tr_b16 v[64:65], v8 offset:36864
    ds_read_b64_tr_b16 v[66:67], v8 offset:37440
    ds_read_b64_tr_b16 v[68:69], v8 offset:41472
    ds_read_b64_tr_b16 v[70:71], v8 offset:42048
    v_mov_b32 v12, 0
    v_mov_b32 v13, 0x3f803f80
    s_waitcnt lgkmcnt(15)
    s_add_u32 s38, s37, 0
    buffer_store_dwordx4 v[32:35], v9, s[28:31], s38 offen sc1
    v_dot2_f32_bf16 v12, v32, v13, v12
    v_dot2_f32_bf16 v12, v33, v13, v12
    v_dot2_f32_bf16 v12, v34, v13, v12
    v_dot2_f32_bf16 v12, v35, v13, v12
    s_waitcnt lgkmcnt(15)
    s_add_u32 s38, s37, 5120
    buffer_store_dwordx4 v[36:39], v9, s[28:31], s38 offen sc1
    v_dot2_f32_bf16 v12, v36, v13, v12
    v_dot2_f32_bf16 v12, v37, v13, v12
    v_dot2_f32_bf16 v12, v38, v13, v12
    v_dot2_f32_bf16 v12, v39, v13, v12
    s_waitcnt lgkmcnt(14)
    s_add_u32 s38, s37, 10240
    buffer_store_dwordx4 v[40:43], v9, s[28:31], s38 offen sc1
    v_dot2_f32_bf16 v12, v40, v13, v12
    v_dot2_f32_bf16 v12, v41, v13, v12
    v_dot2_f32_bf16 v12, v42, v13, v12
    v_dot2_f32_bf16 v12, v43, v13, v12
    s_waitcnt lgkmcnt(12)
    s_add_u32 s38, s37, 15360
    buffer_store_dwordx4 v[44:47], v9, s[28:31], s38 offen sc1
    v_dot2_f32_bf16 v12, v44, v13, v12
    v_dot2_f32_bf16 v12, v45, v13, v12
    v_dot2_f32_bf16 v12, v46, v13, v12
    v_dot2_f32_bf16 v12, v47, v13, v12
    s_waitcnt lgkmcnt(10)
    s_add_u32 s38, s37, 20480
    buffer_store_dwordx4 v[48:51], v9, s[28:31], s38 offen sc1
    v_dot2_f32_bf16 v12, v48, v13, v12
    v_dot2_f32_bf16 v12, v49, v13, v12
    v_dot2_f32_bf16 v12, v50, v13, v12
    v_dot2_f32_bf16 v12, v51, v13, v12
    s_waitcnt lgkmcnt(8)
    s_add_u32 s38, s37, 25600
    buffer_store_dwordx4 v[52:55], v9, s[28:31], s38 offen sc1
    v_dot2_f32_bf16 v12, v52, v13, v12
    v_dot2_f32_bf16 v12, v53, v13, v12
    v_dot2_f32_bf16 v12, v54, v13, v12
    v_dot2_f32_bf16 v12, v55, v13, v12
    s_waitcnt lgkmcnt(6)
    s_add_u32 s38, s37, 30720
    buffer_store_dwordx4 v[56:59], v9, s[28:31], s38 offen sc1
    v_dot2_f32_bf16 v12, v56, v13, v12
    v_dot2_f32_bf16 v12, v57, v13, v12
    v_dot2_f32_bf16 v12, v58, v13, v12
    v_dot2_f32_bf16 v12, v59, v13, v12
    s_waitcnt lgkmcnt(4)
    s_add_u32 s38, s37, 35840
    buffer_store_dwordx4 v[60:63], v9, s[28:31], s38 offen sc1
    v_dot2_f32_bf16 v12, v60, v13, v12
    v_dot2_f32_bf16 v12, v61, v13, v12
    v_dot2_f32_bf16 v12, v62, v13, v12
    v_dot2_f32_bf16 v12, v63, v13, v12
    s_waitcnt lgkmcnt(2)
    s_add_u32 s38, s37, 40960
    buffer_store_dwordx4 v[64:67], v9, s[28:31], s38 offen sc1
    v_dot2_f32_bf16 v12, v64, v13, v12
    v_dot2_f32_bf16 v12, v65, v13, v12
    v_dot2_f32_bf16 v12, v66, v13, v12
    v_dot2_f32_bf16 v12, v67, v13, v12
    s_waitcnt lgkmcnt(0)
    s_add_u32 s38, s37, 46080
    buffer_store_dwordx4 v[68:71], v9, s[28:31], s38 offen sc1
    v_dot2_f32_bf16 v12, v68, v13, v12
    v_dot2_f32_bf16 v12, v69, v13, v12
    v_dot2_f32_bf16 v12, v70, v13, v12
    v_dot2_f32_bf16 v12, v71, v13, v12
    s_nop 2
    v_mov_b32 v13, v12
    s_nop 1
    v_permlane32_swap_b32 v13, v12
    v_add_f32 v12, v12, v13
    v_mov_b32 v13, v12
    s_nop 1
    v_permlane16_swap_b32 v13, v12
    v_add_f32 v12, v12, v13
    s_mul_i32 s38, s33, 7168
    s_lshl_b32 s39, s36, 6
    s_add_u32 s38, s38, s39
    s_add_u32 s38, s38, 2748416
    v_lshlrev_b32 v14, 2, v1
    v_cmp_gt_u32 vcc, 16, v1
    s_and_saveexec_b64 s[40:41], vcc
    buffer_store_dword v12, v14, s[28:31], s38 offen sc1
    s_mov_b64 exec, -1
    s_add_u32 s34, s34, 1
    s_barrier
    s_lshl_b32 s36, s34, 2
    s_add_u32 s36, s36, s20
    s_mul_i32 s38, s36, 52429
    s_lshr_b32 s38, s38, 18
    s_mul_i32 s39, s38, 5
    s_sub_u32 s39, s36, s39
    s_mul_i32 s37, s38, 100
    s_mul_i32 s40, s33, 50
    s_add_u32 s37, s37, s40
    s_add_u32 s37, s37, s39
    s_lshl_b32 s37, s37, 10
    s_add_u32 s37, s37, 2764800
    s_waitcnt vmcnt(20)
    ds_write_b128 v5, v[72:75] offset:0
    s_waitcnt vmcnt(19)
    ds_write_b128 v5, v[76:79] offset:4608
    s_waitcnt vmcnt(18)
    ds_write_b128 v5, v[80:83] offset:9216
    s_waitcnt vmcnt(17)
    ds_write_b128 v5, v[84:87] offset:13824
    s_waitcnt vmcnt(16)
    ds_write_b128 v5, v[88:91] offset:18432
    s_waitcnt vmcnt(15)
    ds_write_b128 v5, v[92:95] offset:23040
    s_waitcnt vmcnt(14)
    ds_write_b128 v5, v[96:99] offset:27648
    s_waitcnt vmcnt(13)
    ds_write_b128 v5, v[100:103] offset:32256
    s_waitcnt vmcnt(12)
    ds_write_b128 v5, v[104:107] offset:36864
    s_waitcnt vmcnt(11)
    ds_write_b128 v5, v[108:111] offset:41472
    s_waitcnt lgkmcnt(0)
    s_barrier
    ds_read_b64_tr_b16 v[72:73], v8 offset:0
    ds_read_b64_tr_b16 v[74:75], v8 offset:576
    ds_read_b64_tr_b16 v[76:77], v8 offset:4608
    ds_read_b64_tr_b16 v[78:79], v8 offset:5184
    ds_read_b64_tr_b16 v[80:81], v8 offset:9216
    ds_read_b64_tr_b16 v[82:83], v8 offset:9792
    ds_read_b64_tr_b16 v[84:85], v8 offset:13824
    ds_read_b64_tr_b16 v[86:87], v8 offset:14400
    ds_read_b64_tr_b16 v[88:89], v8 offset:18432
    ds_read_b64_tr_b16 v[90:91], v8 offset:19008
    ds_read_b64_tr_b16 v[92:93], v8 offset:23040
    ds_read_b64_tr_b16 v[94:95], v8 offset:23616
    ds_read_b64_tr_b16 v[96:97], v8 offset:27648
    ds_read_b64_tr_b16 v[98:99], v8 offset:28224
    ds_read_b64_tr_b16 v[100:101], v8 offset:32256
    ds_read_b64_tr_b16 v[102:103], v8 offset:32832
    ds_read_b64_tr_b16 v[104:105], v8 offset:36864
    ds_read_b64_tr_b16 v[106:107], v8 offset:37440
    ds_read_b64_tr_b16 v[108:109], v8 offset:41472
    ds_read_b64_tr_b16 v[110:111], v8 offset:42048
    v_mov_b32 v12, 0
    v_mov_b32 v13, 0x3f803f80
    s_waitcnt lgkmcnt(15)
    s_add_u32 s38, s37, 0
    buffer_store_dwordx4 v[72:75], v9, s[28:31], s38 offen sc1
    v_dot2_f32_bf16 v12, v72, v13, v12
    v_dot2_f32_bf16 v12, v73, v13, v12
    v_dot2_f32_bf16 v12, v74, v13, v12
    v_dot2_f32_bf16 v12, v75, v13, v12
    s_waitcnt lgkmcnt(15)
    s_add_u32 s38, s37, 5120
    buffer_store_dwordx4 v[76:79], v9, s[28:31], s38 offen sc1
    v_dot2_f32_bf16 v12, v76, v13, v12
    v_dot2_f32_bf16 v12, v77, v13, v12
    v_dot2_f32_bf16 v12, v78, v13, v12
    v_dot2_f32_bf16 v12, v79, v13, v12
    s_waitcnt lgkmcnt(14)
    s_add_u32 s38, s37, 10240
    buffer_store_dwordx4 v[80:83], v9, s[28:31], s38 offen sc1
    v_dot2_f32_bf16 v12, v80, v13, v12
    v_dot2_f32_bf16 v12, v81, v13, v12
    v_dot2_f32_bf16 v12, v82, v13, v12
    v_dot2_f32_bf16 v12, v83, v13, v12
    s_waitcnt lgkmcnt(12)
    s_add_u32 s38, s37, 15360
    buffer_store_dwordx4 v[84:87], v9, s[28:31], s38 offen sc1
    v_dot2_f32_bf16 v12, v84, v13, v12
    v_dot2_f32_bf16 v12, v85, v13, v12
    v_dot2_f32_bf16 v12, v86, v13, v12
    v_dot2_f32_bf16 v12, v87, v13, v12
    s_waitcnt lgkmcnt(10)
    s_add_u32 s38, s37, 20480
    buffer_store_dwordx4 v[88:91], v9, s[28:31], s38 offen sc1
    v_dot2_f32_bf16 v12, v88, v13, v12
    v_dot2_f32_bf16 v12, v89, v13, v12
    v_dot2_f32_bf16 v12, v90, v13, v12
    v_dot2_f32_bf16 v12, v91, v13, v12
    s_waitcnt lgkmcnt(8)
    s_add_u32 s38, s37, 25600
    buffer_store_dwordx4 v[92:95], v9, s[28:31], s38 offen sc1
    v_dot2_f32_bf16 v12, v92, v13, v12
    v_dot2_f32_bf16 v12, v93, v13, v12
    v_dot2_f32_bf16 v12, v94, v13, v12
    v_dot2_f32_bf16 v12, v95, v13, v12
    s_waitcnt lgkmcnt(6)
    s_add_u32 s38, s37, 30720
    buffer_store_dwordx4 v[96:99], v9, s[28:31], s38 offen sc1
    v_dot2_f32_bf16 v12, v96, v13, v12
    v_dot2_f32_bf16 v12, v97, v13, v12
    v_dot2_f32_bf16 v12, v98, v13, v12
    v_dot2_f32_bf16 v12, v99, v13, v12
    s_waitcnt lgkmcnt(4)
    s_add_u32 s38, s37, 35840
    buffer_store_dwordx4 v[100:103], v9, s[28:31], s38 offen sc1
    v_dot2_f32_bf16 v12, v100, v13, v12
    v_dot2_f32_bf16 v12, v101, v13, v12
    v_dot2_f32_bf16 v12, v102, v13, v12
    v_dot2_f32_bf16 v12, v103, v13, v12
    s_waitcnt lgkmcnt(2)
    s_add_u32 s38, s37, 40960
    buffer_store_dwordx4 v[104:107], v9, s[28:31], s38 offen sc1
    v_dot2_f32_bf16 v12, v104, v13, v12
    v_dot2_f32_bf16 v12, v105, v13, v12
    v_dot2_f32_bf16 v12, v106, v13, v12
    v_dot2_f32_bf16 v12, v107, v13, v12
    s_waitcnt lgkmcnt(0)
    s_add_u32 s38, s37, 46080
    buffer_store_dwordx4 v[108:111], v9, s[28:31], s38 offen sc1
    v_dot2_f32_bf16 v12, v108, v13, v12
    v_dot2_f32_bf16 v12, v109, v13, v12
    v_dot2_f32_bf16 v12, v110, v13, v12
    v_dot2_f32_bf16 v12, v111, v13, v12
    s_nop 2
    v_mov_b32 v13, v12
    s_nop 1
    v_permlane32_swap_b32 v13, v12
    v_add_f32 v12, v12, v13
    v_mov_b32 v13, v12
    s_nop 1
    v_permlane16_swap_b32 v13, v12
    v_add_f32 v12, v12, v13
    s_mul_i32 s38, s33, 7168
    s_lshl_b32 s39, s36, 6
    s_add_u32 s38, s38, s39
    s_add_u32 s38, s38, 2748416
    v_lshlrev_b32 v14, 2, v1
    v_cmp_gt_u32 vcc, 16, v1
    s_and_saveexec_b64 s[40:41], vcc
    buffer_store_dword v12, v14, s[28:31], s38 offen sc1
    s_mov_b64 exec, -1
    s_endpgm
k1_kernel_pk17:
    s_mov_b32 s24, s14
    s_mov_b32 s25, s15
    s_mov_b32 s26, 819200
    s_mov_b32 s27, 0x00020000
    s_sub_u32 s32, s21, 10
    s_mul_i32 s33, s32, 52429
    s_lshr_b32 s33, s33, 18
    s_mul_i32 s34, s33, 5
    s_sub_u32 s34, s32, s34
    s_lshl_b32 s34, s34, 1
    v_mul_u32_u24 v10, 1280, v3
    v_lshl_add_u32 v10, v4, 4, v10
    s_mul_i32 s35, s33, 409600
    s_lshl_b32 s36, s34, 7
    s_add_u32 s35, s35, s36
    buffer_load_dwordx4 v[32:35], v10, s[24:27], s35 offen offset:0
    s_add_u32 s35, s35, 40960
    buffer_load_dwordx4 v[36:39], v10, s[24:27], s35 offen offset:0
    s_add_u32 s35, s35, 40960
    buffer_load_dwordx4 v[40:43], v10, s[24:27], s35 offen offset:0
    s_add_u32 s35, s35, 40960
    buffer_load_dwordx4 v[44:47], v10, s[24:27], s35 offen offset:0
    s_add_u32 s35, s35, 40960
    buffer_load_dwordx4 v[48:51], v10, s[24:27], s35 offen offset:0
    s_add_u32 s35, s35, 40960
    buffer_load_dwordx4 v[52:55], v10, s[24:27], s35 offen offset:0
    s_add_u32 s35, s35, 40960
    buffer_load_dwordx4 v[56:59], v10, s[24:27], s35 offen offset:0
    s_add_u32 s35, s35, 40960
    buffer_load_dwordx4 v[60:63], v10, s[24:27], s35 offen offset:0
    s_add_u32 s35, s35, 40960
    buffer_load_dwordx4 v[64:67], v10, s[24:27], s35 offen offset:0
    s_add_u32 s35, s35, 40960
    buffer_load_dwordx4 v[68:71], v10, s[24:27], s35 offen offset:0
    s_sub_u32 s35, s35, 368640
    buffer_load_dwordx4 v[72:75], v10, s[24:27], s35 offen offset:128
    s_add_u32 s35, s35, 40960
    buffer_load_dwordx4 v[76:79], v10, s[24:27], s35 offen offset:128
    s_add_u32 s35, s35, 40960
    buffer_load_dwordx4 v[80:83], v10, s[24:27], s35 offen offset:128
    s_add_u32 s35, s35, 40960
    buffer_load_dwordx4 v[84:87], v10, s[24:27], s35 offen offset:128
    s_add_u32 s35, s35, 40960
    buffer_load_dwordx4 v[88:91], v10, s[24:27], s35 offen offset:128
    s_add_u32 s35, s35, 40960
    buffer_load_dwordx4 v[92:95], v10, s[24:27], s35 offen offset:128
    s_add_u32 s35, s35, 40960
    buffer_load_dwordx4 v[96:99], v10, s[24:27], s35 offen offset:128
    s_add_u32 s35, s35, 40960
    buffer_load_dwordx4 v[100:103], v10, s[24:27], s35 offen offset:128
    s_add_u32 s35, s35, 40960
    buffer_load_dwordx4 v[104:107], v10, s[24:27], s35 offen offset:128
    s_add_u32 s35, s35, 40960
    buffer_load_dwordx4 v[108:111], v10, s[24:27], s35 offen offset:128
    s_lshl_b32 s36, s34, 2
    s_add_u32 s36, s36, s20
    s_mul_i32 s38, s36, 52429
    s_lshr_b32 s38, s38, 18
    s_mul_i32 s39, s38, 5
    s_sub_u32 s39, s36, s39
    s_mul_i32 s37, s38, 100
    s_mul_i32 s40, s33, 50
    s_add_u32 s37, s37, s40
    s_add_u32 s37, s37, s39
    s_lshl_b32 s37, s37, 10
    s_add_u32 s37, s37, 3584000
    s_waitcnt vmcnt(19)
    ds_write_b128 v5, v[32:35] offset:0
    s_waitcnt vmcnt(18)
    ds_write_b128 v5, v[36:39] offset:4608
    s_waitcnt vmcnt(17)
    ds_write_b128 v5, v[40:43] offset:9216
    s_waitcnt vmcnt(16)
    ds_write_b128 v5, v[44:47] offset:13824
    s_waitcnt vmcnt(15)
    ds_write_b128 v5, v[48:51] offset:18432
    s_waitcnt vmcnt(14)
    ds_write_b128 v5, v[52:55] offset:23040
    s_waitcnt vmcnt(13)
    ds_write_b128 v5, v[56:59] offset:27648
    s_waitcnt vmcnt(12)
    ds_write_b128 v5, v[60:63] offset:32256
    s_waitcnt vmcnt(11)
    ds_write_b128 v5, v[64:67] offset:36864
    s_waitcnt vmcnt(10)
    ds_write_b128 v5, v[68:71] offset:41472
    s_waitcnt lgkmcnt(0)
    s_barrier
    ds_read_b64_tr_b16 v[32:33], v8 offset:0
    ds_read_b64_tr_b16 v[34:35], v8 offset:576
    ds_read_b64_tr_b16 v[36:37], v8 offset:4608
    ds_read_b64_tr_b16 v[38:39], v8 offset:5184
    ds_read_b64_tr_b16 v[40:41], v8 offset:9216
    ds_read_b64_tr_b16 v[42:43], v8 offset:9792
    ds_read_b64_tr_b16 v[44:45], v8 offset:13824
    ds_read_b64_tr_b16 v[46:47], v8 offset:14400
    ds_read_b64_tr_b16 v[48:49], v8 offset:18432
    ds_read_b64_tr_b16 v[50:51], v8 offset:19008
    ds_read_b64_tr_b16 v[52:53], v8 offset:23040
    ds_read_b64_tr_b16 v[54:55], v8 offset:23616
    ds_read_b64_tr_b16 v[56:57], v8 offset:27648
    ds_read_b64_tr_b16 v[58:59], v8 offset:28224
    ds_read_b64_tr_b16 v[60:61], v8 offset:32256
    ds_read_b64_tr_b16 v[62:63], v8 offset:32832
    ds_read_b64_tr_b16 v[64:65], v8 offset:36864
    ds_read_b64_tr_b16 v[66:67], v8 offset:37440
    ds_read_b64_tr_b16 v[68:69], v8 offset:41472
    ds_read_b64_tr_b16 v[70:71], v8 offset:42048
    s_waitcnt lgkmcnt(15)
    s_add_u32 s38, s37, 0
    buffer_store_dwordx4 v[32:35], v9, s[28:31], s38 offen sc1
    s_waitcnt lgkmcnt(15)
    s_add_u32 s38, s37, 5120
    buffer_store_dwordx4 v[36:39], v9, s[28:31], s38 offen sc1
    s_waitcnt lgkmcnt(14)
    s_add_u32 s38, s37, 10240
    buffer_store_dwordx4 v[40:43], v9, s[28:31], s38 offen sc1
    s_waitcnt lgkmcnt(12)
    s_add_u32 s38, s37, 15360
    buffer_store_dwordx4 v[44:47], v9, s[28:31], s38 offen sc1
    s_waitcnt lgkmcnt(10)
    s_add_u32 s38, s37, 20480
    buffer_store_dwordx4 v[48:51], v9, s[28:31], s38 offen sc1
    s_waitcnt lgkmcnt(8)
    s_add_u32 s38, s37, 25600
    buffer_store_dwordx4 v[52:55], v9, s[28:31], s38 offen sc1
    s_waitcnt lgkmcnt(6)
    s_add_u32 s38, s37, 30720
    buffer_store_dwordx4 v[56:59], v9, s[28:31], s38 offen sc1
    s_waitcnt lgkmcnt(4)
    s_add_u32 s38, s37, 35840
    buffer_store_dwordx4 v[60:63], v9, s[28:31], s38 offen sc1
    s_waitcnt lgkmcnt(2)
    s_add_u32 s38, s37, 40960
    buffer_store_dwordx4 v[64:67], v9, s[28:31], s38 offen sc1
    s_waitcnt lgkmcnt(0)
    s_add_u32 s38, s37, 46080
    buffer_store_dwordx4 v[68:71], v9, s[28:31], s38 offen sc1
    s_add_u32 s34, s34, 1
    s_barrier
    s_lshl_b32 s36, s34, 2
    s_add_u32 s36, s36, s20
    s_mul_i32 s38, s36, 52429
    s_lshr_b32 s38, s38, 18
    s_mul_i32 s39, s38, 5
    s_sub_u32 s39, s36, s39
    s_mul_i32 s37, s38, 100
    s_mul_i32 s40, s33, 50
    s_add_u32 s37, s37, s40
    s_add_u32 s37, s37, s39
    s_lshl_b32 s37, s37, 10
    s_add_u32 s37, s37, 3584000
    s_waitcnt vmcnt(19)
    ds_write_b128 v5, v[72:75] offset:0
    s_waitcnt vmcnt(18)
    ds_write_b128 v5, v[76:79] offset:4608
    s_waitcnt vmcnt(17)
    ds_write_b128 v5, v[80:83] offset:9216
    s_waitcnt vmcnt(16)
    ds_write_b128 v5, v[84:87] offset:13824
    s_waitcnt vmcnt(15)
    ds_write_b128 v5, v[88:91] offset:18432
    s_waitcnt vmcnt(14)
    ds_write_b128 v5, v[92:95] offset:23040
    s_waitcnt vmcnt(13)
    ds_write_b128 v5, v[96:99] offset:27648
    s_waitcnt vmcnt(12)
    ds_write_b128 v5, v[100:103] offset:32256
    s_waitcnt vmcnt(11)
    ds_write_b128 v5, v[104:107] offset:36864
    s_waitcnt vmcnt(10)
    ds_write_b128 v5, v[108:111] offset:41472
    s_waitcnt lgkmcnt(0)
    s_barrier
    ds_read_b64_tr_b16 v[72:73], v8 offset:0
    ds_read_b64_tr_b16 v[74:75], v8 offset:576
    ds_read_b64_tr_b16 v[76:77], v8 offset:4608
    ds_read_b64_tr_b16 v[78:79], v8 offset:5184
    ds_read_b64_tr_b16 v[80:81], v8 offset:9216
    ds_read_b64_tr_b16 v[82:83], v8 offset:9792
    ds_read_b64_tr_b16 v[84:85], v8 offset:13824
    ds_read_b64_tr_b16 v[86:87], v8 offset:14400
    ds_read_b64_tr_b16 v[88:89], v8 offset:18432
    ds_read_b64_tr_b16 v[90:91], v8 offset:19008
    ds_read_b64_tr_b16 v[92:93], v8 offset:23040
    ds_read_b64_tr_b16 v[94:95], v8 offset:23616
    ds_read_b64_tr_b16 v[96:97], v8 offset:27648
    ds_read_b64_tr_b16 v[98:99], v8 offset:28224
    ds_read_b64_tr_b16 v[100:101], v8 offset:32256
    ds_read_b64_tr_b16 v[102:103], v8 offset:32832
    ds_read_b64_tr_b16 v[104:105], v8 offset:36864
    ds_read_b64_tr_b16 v[106:107], v8 offset:37440
    ds_read_b64_tr_b16 v[108:109], v8 offset:41472
    ds_read_b64_tr_b16 v[110:111], v8 offset:42048
    s_waitcnt lgkmcnt(15)
    s_add_u32 s38, s37, 0
    buffer_store_dwordx4 v[72:75], v9, s[28:31], s38 offen sc1
    s_waitcnt lgkmcnt(15)
    s_add_u32 s38, s37, 5120
    buffer_store_dwordx4 v[76:79], v9, s[28:31], s38 offen sc1
    s_waitcnt lgkmcnt(14)
    s_add_u32 s38, s37, 10240
    buffer_store_dwordx4 v[80:83], v9, s[28:31], s38 offen sc1
    s_waitcnt lgkmcnt(12)
    s_add_u32 s38, s37, 15360
    buffer_store_dwordx4 v[84:87], v9, s[28:31], s38 offen sc1
    s_waitcnt lgkmcnt(10)
    s_add_u32 s38, s37, 20480
    buffer_store_dwordx4 v[88:91], v9, s[28:31], s38 offen sc1
    s_waitcnt lgkmcnt(8)
    s_add_u32 s38, s37, 25600
    buffer_store_dwordx4 v[92:95], v9, s[28:31], s38 offen sc1
    s_waitcnt lgkmcnt(6)
    s_add_u32 s38, s37, 30720
    buffer_store_dwordx4 v[96:99], v9, s[28:31], s38 offen sc1
    s_waitcnt lgkmcnt(4)
    s_add_u32 s38, s37, 35840
    buffer_store_dwordx4 v[100:103], v9, s[28:31], s38 offen sc1
    s_waitcnt lgkmcnt(2)
    s_add_u32 s38, s37, 40960
    buffer_store_dwordx4 v[104:107], v9, s[28:31], s38 offen sc1
    s_waitcnt lgkmcnt(0)
    s_add_u32 s38, s37, 46080
    buffer_store_dwordx4 v[108:111], v9, s[28:31], s38 offen sc1
    s_endpgm
k1_kernel_pk18:
    s_mov_b32 s24, s16
    s_mov_b32 s25, s17
    s_mov_b32 s26, 2211840
    s_mov_b32 s27, 0x00020000
    s_sub_u32 s32, s21, 20
    s_mul_i32 s33, s32, 4682
    s_lshr_b32 s33, s33, 16
    s_mul_i32 s34, s33, 14
    s_sub_u32 s34, s32, s34
    s_lshl_b32 s34, s34, 1
    v_mul_u32_u24 v10, 3456, v3
    v_lshl_add_u32 v10, v4, 4, v10
    s_mul_i32 s35, s33, 1105920
    s_lshl_b32 s36, s34, 7
    s_add_u32 s35, s35, s36
    buffer_load_dwordx4 v[32:35], v10, s[24:27], s35 offen offset:0
    s_add_u32 s35, s35, 110592
    buffer_load_dwordx4 v[36:39], v10, s[24:27], s35 offen offset:0
    s_add_u32 s35, s35, 110592
    buffer_load_dwordx4 v[40:43], v10, s[24:27], s35 offen offset:0
    s_add_u32 s35, s35, 110592
    buffer_load_dwordx4 v[44:47], v10, s[24:27], s35 offen offset:0
    s_add_u32 s35, s35, 110592
    buffer_load_dwordx4 v[48:51], v10, s[24:27], s35 offen offset:0
    s_add_u32 s35, s35, 110592
    buffer_load_dwordx4 v[52:55], v10, s[24:27], s35 offen offset:0
    s_add_u32 s35, s35, 110592
    buffer_load_dwordx4 v[56:59], v10, s[24:27], s35 offen offset:0
    s_add_u32 s35, s35, 110592
    buffer_load_dwordx4 v[60:63], v10, s[24:27], s35 offen offset:0
    s_add_u32 s35, s35, 110592
    buffer_load_dwordx4 v[64:67], v10, s[24:27], s35 offen offset:0
    s_add_u32 s35, s35, 110592
    buffer_load_dwordx4 v[68:71], v10, s[24:27], s35 offen offset:0
    s_sub_u32 s35, s35, 995328
    buffer_load_dwordx4 v[72:75], v10, s[24:27], s35 offen offset:128
    s_add_u32 s35, s35, 110592
    buffer_load_dwordx4 v[76:79], v10, s[24:27], s35 offen offset:128
    s_add_u32 s35, s35, 110592
    buffer_load_dwordx4 v[80:83], v10, s[24:27], s35 offen offset:128
    s_add_u32 s35, s35, 110592
    buffer_load_dwordx4 v[84:87], v10, s[24:27], s35 offen offset:128
    s_add_u32 s35, s35, 110592
    buffer_load_dwordx4 v[88:91], v10, s[24:27], s35 offen offset:128
    s_add_u32 s35, s35, 110592
    buffer_load_dwordx4 v[92:95], v10, s[24:27], s35 offen offset:128
    s_add_u32 s35, s35, 110592
    buffer_load_dwordx4 v[96:99], v10, s[24:27], s35 offen offset:128
    s_add_u32 s35, s35, 110592
    buffer_load_dwordx4 v[100:103], v10, s[24:27], s35 offen offset:128
    s_add_u32 s35, s35, 110592
    buffer_load_dwordx4 v[104:107], v10, s[24:27], s35 offen offset:128
    s_add_u32 s35, s35, 110592
    buffer_load_dwordx4 v[108:111], v10, s[24:27], s35 offen offset:128
    s_lshl_b32 s36, s34, 2
    s_add_u32 s36, s36, s20
    s_mul_i32 s38, s36, 9363
    s_lshr_b32 s38, s38, 16
    s_mul_i32 s39, s38, 7
    s_sub_u32 s39, s36, s39
    s_mul_i32 s37, s38, 140
    s_mul_i32 s40, s33, 70
    s_add_u32 s37, s37, s40
    s_add_u32 s37, s37, s39
    s_lshl_b32 s37, s37, 10
    s_add_u32 s37, s37, 4403200
    s_waitcnt vmcnt(19)
    ds_write_b128 v5, v[32:35] offset:0
    s_waitcnt vmcnt(18)
    ds_write_b128 v5, v[36:39] offset:4608
    s_waitcnt vmcnt(17)
    ds_write_b128 v5, v[40:43] offset:9216
    s_waitcnt vmcnt(16)
    ds_write_b128 v5, v[44:47] offset:13824
    s_waitcnt vmcnt(15)
    ds_write_b128 v5, v[48:51] offset:18432
    s_waitcnt vmcnt(14)
    ds_write_b128 v5, v[52:55] offset:23040
    s_waitcnt vmcnt(13)
    ds_write_b128 v5, v[56:59] offset:27648
    s_waitcnt vmcnt(12)
    ds_write_b128 v5, v[60:63] offset:32256
    s_waitcnt vmcnt(11)
    ds_write_b128 v5, v[64:67] offset:36864
    s_waitcnt vmcnt(10)
    ds_write_b128 v5, v[68:71] offset:41472
    s_waitcnt lgkmcnt(0)
    s_barrier
    ds_read_b64_tr_b16 v[32:33], v8 offset:0
    ds_read_b64_tr_b16 v[34:35], v8 offset:576
    ds_read_b64_tr_b16 v[36:37], v8 offset:4608
    ds_read_b64_tr_b16 v[38:39], v8 offset:5184
    ds_read_b64_tr_b16 v[40:41], v8 offset:9216
    ds_read_b64_tr_b16 v[42:43], v8 offset:9792
    ds_read_b64_tr_b16 v[44:45], v8 offset:13824
    ds_read_b64_tr_b16 v[46:47], v8 offset:14400
    ds_read_b64_tr_b16 v[48:49], v8 offset:18432
    ds_read_b64_tr_b16 v[50:51], v8 offset:19008
    ds_read_b64_tr_b16 v[52:53], v8 offset:23040
    ds_read_b64_tr_b16 v[54:55], v8 offset:23616
    ds_read_b64_tr_b16 v[56:57], v8 offset:27648
    ds_read_b64_tr_b16 v[58:59], v8 offset:28224
    ds_read_b64_tr_b16 v[60:61], v8 offset:32256
    ds_read_b64_tr_b16 v[62:63], v8 offset:32832
    ds_read_b64_tr_b16 v[64:65], v8 offset:36864
    ds_read_b64_tr_b16 v[66:67], v8 offset:37440
    ds_read_b64_tr_b16 v[68:69], v8 offset:41472
    ds_read_b64_tr_b16 v[70:71], v8 offset:42048
    v_mov_b32 v12, 0
    v_mov_b32 v13, 0x3f803f80
    s_waitcnt lgkmcnt(15)
    s_add_u32 s38, s37, 0
    buffer_store_dwordx4 v[32:35], v9, s[28:31], s38 offen sc1
    v_dot2_f32_bf16 v12, v32, v13, v12
    v_dot2_f32_bf16 v12, v33, v13, v12
    v_dot2_f32_bf16 v12, v34, v13, v12
    v_dot2_f32_bf16 v12, v35, v13, v12
    s_waitcnt lgkmcnt(15)
    s_add_u32 s38, s37, 7168
    buffer_store_dwordx4 v[36:39], v9, s[28:31], s38 offen sc1
    v_dot2_f32_bf16 v12, v36, v13, v12
    v_dot2_f32_bf16 v12, v37, v13, v12
    v_dot2_f32_bf16 v12, v38, v13, v12
    v_dot2_f32_bf16 v12, v39, v13, v12
    s_waitcnt lgkmcnt(14)
    s_add_u32 s38, s37, 14336
    buffer_store_dwordx4 v[40:43], v9, s[28:31], s38 offen sc1
    v_dot2_f32_bf16 v12, v40, v13, v12
    v_dot2_f32_bf16 v12, v41, v13, v12
    v_dot2_f32_bf16 v12, v42, v13, v12
    v_dot2_f32_bf16 v12, v43, v13, v12
    s_waitcnt lgkmcnt(12)
    s_add_u32 s38, s37, 21504
    buffer_store_dwordx4 v[44:47], v9, s[28:31], s38 offen sc1
    v_dot2_f32_bf16 v12, v44, v13, v12
    v_dot2_f32_bf16 v12, v45, v13, v12
    v_dot2_f32_bf16 v12, v46, v13, v12
    v_dot2_f32_bf16 v12, v47, v13, v12
    s_waitcnt lgkmcnt(10)
    s_add_u32 s38, s37, 28672
    buffer_store_dwordx4 v[48:51], v9, s[28:31], s38 offen sc1
    v_dot2_f32_bf16 v12, v48, v13, v12
    v_dot2_f32_bf16 v12, v49, v13, v12
    v_dot2_f32_bf16 v12, v50, v13, v12
    v_dot2_f32_bf16 v12, v51, v13, v12
    s_waitcnt lgkmcnt(8)
    s_add_u32 s38, s37, 35840
    buffer_store_dwordx4 v[52:55], v9, s[28:31], s38 offen sc1
    v_dot2_f32_bf16 v12, v52, v13, v12
    v_dot2_f32_bf16 v12, v53, v13, v12
    v_dot2_f32_bf16 v12, v54, v13, v12
    v_dot2_f32_bf16 v12, v55, v13, v12
    s_waitcnt lgkmcnt(6)
    s_add_u32 s38, s37, 43008
    buffer_store_dwordx4 v[56:59], v9, s[28:31], s38 offen sc1
    v_dot2_f32_bf16 v12, v56, v13, v12
    v_dot2_f32_bf16 v12, v57, v13, v12
    v_dot2_f32_bf16 v12, v58, v13, v12
    v_dot2_f32_bf16 v12, v59, v13, v12
    s_waitcnt lgkmcnt(4)
    s_add_u32 s38, s37, 50176
    buffer_store_dwordx4 v[60:63], v9, s[28:31], s38 offen sc1
    v_dot2_f32_bf16 v12, v60, v13, v12
    v_dot2_f32_bf16 v12, v61, v13, v12
    v_dot2_f32_bf16 v12, v62, v13, v12
    v_dot2_f32_bf16 v12, v63, v13, v12
    s_waitcnt lgkmcnt(2)
    s_add_u32 s38, s37, 57344
    buffer_store_dwordx4 v[64:67], v9, s[28:31], s38 offen sc1
    v_dot2_f32_bf16 v12, v64, v13, v12
    v_dot2_f32_bf16 v12, v65, v13, v12
    v_dot2_f32_bf16 v12, v66, v13, v12
    v_dot2_f32_bf16 v12, v67, v13, v12
    s_waitcnt lgkmcnt(0)
    s_add_u32 s38, s37, 64512
    buffer_store_dwordx4 v[68:71], v9, s[28:31], s38 offen sc1
    v_dot2_f32_bf16 v12, v68, v13, v12
    v_dot2_f32_bf16 v12, v69, v13, v12
    v_dot2_f32_bf16 v12, v70, v13, v12
    v_dot2_f32_bf16 v12, v71, v13, v12
    s_nop 2
    v_mov_b32 v13, v12
    s_nop 1
    v_permlane32_swap_b32 v13, v12
    v_add_f32 v12, v12, v13
    v_mov_b32 v13, v12
    s_nop 1
    v_permlane16_swap_b32 v13, v12
    v_add_f32 v12, v12, v13
    s_mul_i32 s38, s33, 7168
    s_lshl_b32 s39, s36, 6
    s_add_u32 s38, s38, s39
    s_add_u32 s38, s38, 2732032
    v_lshlrev_b32 v14, 2, v1
    v_cmp_gt_u32 vcc, 16, v1
    s_and_saveexec_b64 s[40:41], vcc
    buffer_store_dword v12, v14, s[28:31], s38 offen sc1
    s_mov_b64 exec, -1
    s_add_u32 s34, s34, 1
    s_barrier
    s_lshl_b32 s36, s34, 2
    s_add_u32 s36, s36, s20
    s_mul_i32 s38, s36, 9363
    s_lshr_b32 s38, s38, 16
    s_mul_i32 s39, s38, 7
    s_sub_u32 s39, s36, s39
    s_mul_i32 s37, s38, 140
    s_mul_i32 s40, s33, 70
    s_add_u32 s37, s37, s40
    s_add_u32 s37, s37, s39
    s_lshl_b32 s37, s37, 10
    s_add_u32 s37, s37, 4403200
    s_waitcnt vmcnt(20)
    ds_write_b128 v5, v[72:75] offset:0
    s_waitcnt vmcnt(19)
    ds_write_b128 v5, v[76:79] offset:4608
    s_waitcnt vmcnt(18)
    ds_write_b128 v5, v[80:83] offset:9216
    s_waitcnt vmcnt(17)
    ds_write_b128 v5, v[84:87] offset:13824
    s_waitcnt vmcnt(16)
    ds_write_b128 v5, v[88:91] offset:18432
    s_waitcnt vmcnt(15)
    ds_write_b128 v5, v[92:95] offset:23040
    s_waitcnt vmcnt(14)
    ds_write_b128 v5, v[96:99] offset:27648
    s_waitcnt vmcnt(13)
    ds_write_b128 v5, v[100:103] offset:32256
    s_waitcnt vmcnt(12)
    ds_write_b128 v5, v[104:107] offset:36864
    s_waitcnt vmcnt(11)
    ds_write_b128 v5, v[108:111] offset:41472
    s_waitcnt lgkmcnt(0)
    s_barrier
    ds_read_b64_tr_b16 v[72:73], v8 offset:0
    ds_read_b64_tr_b16 v[74:75], v8 offset:576
    ds_read_b64_tr_b16 v[76:77], v8 offset:4608
    ds_read_b64_tr_b16 v[78:79], v8 offset:5184
    ds_read_b64_tr_b16 v[80:81], v8 offset:9216
    ds_read_b64_tr_b16 v[82:83], v8 offset:9792
    ds_read_b64_tr_b16 v[84:85], v8 offset:13824
    ds_read_b64_tr_b16 v[86:87], v8 offset:14400
    ds_read_b64_tr_b16 v[88:89], v8 offset:18432
    ds_read_b64_tr_b16 v[90:91], v8 offset:19008
    ds_read_b64_tr_b16 v[92:93], v8 offset:23040
    ds_read_b64_tr_b16 v[94:95], v8 offset:23616
    ds_read_b64_tr_b16 v[96:97], v8 offset:27648
    ds_read_b64_tr_b16 v[98:99], v8 offset:28224
    ds_read_b64_tr_b16 v[100:101], v8 offset:32256
    ds_read_b64_tr_b16 v[102:103], v8 offset:32832
    ds_read_b64_tr_b16 v[104:105], v8 offset:36864
    ds_read_b64_tr_b16 v[106:107], v8 offset:37440
    ds_read_b64_tr_b16 v[108:109], v8 offset:41472
    ds_read_b64_tr_b16 v[110:111], v8 offset:42048
    v_mov_b32 v12, 0
    v_mov_b32 v13, 0x3f803f80
    s_waitcnt lgkmcnt(15)
    s_add_u32 s38, s37, 0
    buffer_store_dwordx4 v[72:75], v9, s[28:31], s38 offen sc1
    v_dot2_f32_bf16 v12, v72, v13, v12
    v_dot2_f32_bf16 v12, v73, v13, v12
    v_dot2_f32_bf16 v12, v74, v13, v12
    v_dot2_f32_bf16 v12, v75, v13, v12
    s_waitcnt lgkmcnt(15)
    s_add_u32 s38, s37, 7168
    buffer_store_dwordx4 v[76:79], v9, s[28:31], s38 offen sc1
    v_dot2_f32_bf16 v12, v76, v13, v12
    v_dot2_f32_bf16 v12, v77, v13, v12
    v_dot2_f32_bf16 v12, v78, v13, v12
    v_dot2_f32_bf16 v12, v79, v13, v12
    s_waitcnt lgkmcnt(14)
    s_add_u32 s38, s37, 14336
    buffer_store_dwordx4 v[80:83], v9, s[28:31], s38 offen sc1
    v_dot2_f32_bf16 v12, v80, v13, v12
    v_dot2_f32_bf16 v12, v81, v13, v12
    v_dot2_f32_bf16 v12, v82, v13, v12
    v_dot2_f32_bf16 v12, v83, v13, v12
    s_waitcnt lgkmcnt(12)
    s_add_u32 s38, s37, 21504
    buffer_store_dwordx4 v[84:87], v9, s[28:31], s38 offen sc1
    v_dot2_f32_bf16 v12, v84, v13, v12
    v_dot2_f32_bf16 v12, v85, v13, v12
    v_dot2_f32_bf16 v12, v86, v13, v12
    v_dot2_f32_bf16 v12, v87, v13, v12
    s_waitcnt lgkmcnt(10)
    s_add_u32 s38, s37, 28672
    buffer_store_dwordx4 v[88:91], v9, s[28:31], s38 offen sc1
    v_dot2_f32_bf16 v12, v88, v13, v12
    v_dot2_f32_bf16 v12, v89, v13, v12
    v_dot2_f32_bf16 v12, v90, v13, v12
    v_dot2_f32_bf16 v12, v91, v13, v12
    s_waitcnt lgkmcnt(8)
    s_add_u32 s38, s37, 35840
    buffer_store_dwordx4 v[92:95], v9, s[28:31], s38 offen sc1
    v_dot2_f32_bf16 v12, v92, v13, v12
    v_dot2_f32_bf16 v12, v93, v13, v12
    v_dot2_f32_bf16 v12, v94, v13, v12
    v_dot2_f32_bf16 v12, v95, v13, v12
    s_waitcnt lgkmcnt(6)
    s_add_u32 s38, s37, 43008
    buffer_store_dwordx4 v[96:99], v9, s[28:31], s38 offen sc1
    v_dot2_f32_bf16 v12, v96, v13, v12
    v_dot2_f32_bf16 v12, v97, v13, v12
    v_dot2_f32_bf16 v12, v98, v13, v12
    v_dot2_f32_bf16 v12, v99, v13, v12
    s_waitcnt lgkmcnt(4)
    s_add_u32 s38, s37, 50176
    buffer_store_dwordx4 v[100:103], v9, s[28:31], s38 offen sc1
    v_dot2_f32_bf16 v12, v100, v13, v12
    v_dot2_f32_bf16 v12, v101, v13, v12
    v_dot2_f32_bf16 v12, v102, v13, v12
    v_dot2_f32_bf16 v12, v103, v13, v12
    s_waitcnt lgkmcnt(2)
    s_add_u32 s38, s37, 57344
    buffer_store_dwordx4 v[104:107], v9, s[28:31], s38 offen sc1
    v_dot2_f32_bf16 v12, v104, v13, v12
    v_dot2_f32_bf16 v12, v105, v13, v12
    v_dot2_f32_bf16 v12, v106, v13, v12
    v_dot2_f32_bf16 v12, v107, v13, v12
    s_waitcnt lgkmcnt(0)
    s_add_u32 s38, s37, 64512
    buffer_store_dwordx4 v[108:111], v9, s[28:31], s38 offen sc1
    v_dot2_f32_bf16 v12, v108, v13, v12
    v_dot2_f32_bf16 v12, v109, v13, v12
    v_dot2_f32_bf16 v12, v110, v13, v12
    v_dot2_f32_bf16 v12, v111, v13, v12
    s_nop 2
    v_mov_b32 v13, v12
    s_nop 1
    v_permlane32_swap_b32 v13, v12
    v_add_f32 v12, v12, v13
    v_mov_b32 v13, v12
    s_nop 1
    v_permlane16_swap_b32 v13, v12
    v_add_f32 v12, v12, v13
    s_mul_i32 s38, s33, 7168
    s_lshl_b32 s39, s36, 6
    s_add_u32 s38, s38, s39
    s_add_u32 s38, s38, 2732032
    v_lshlrev_b32 v14, 2, v1
    v_cmp_gt_u32 vcc, 16, v1
    s_and_saveexec_b64 s[40:41], vcc
    buffer_store_dword v12, v14, s[28:31], s38 offen sc1
    s_mov_b64 exec, -1
    s_endpgm
k1_kernel_pk19:
    s_mov_b32 s24, s18
    s_mov_b32 s25, s19
    s_mov_b32 s26, 2211840
    s_mov_b32 s27, 0x00020000
    s_sub_u32 s32, s21, 48
    s_mul_i32 s33, s32, 52429
    s_lshr_b32 s33, s33, 18
    s_mul_i32 s34, s33, 5
    s_sub_u32 s34, s32, s34
    s_lshl_b32 s34, s34, 1
    v_mul_u32_u24 v10, 1280, v3
    v_lshl_add_u32 v10, v4, 4, v10
    s_mul_i32 s35, s33, 368640
    s_lshl_b32 s36, s34, 7
    s_add_u32 s35, s35, s36
    buffer_load_dwordx4 v[32:35], v10, s[24:27], s35 offen offset:0
    s_add_u32 s35, s35, 40960
    buffer_load_dwordx4 v[36:39], v10, s[24:27], s35 offen offset:0
    s_add_u32 s35, s35, 40960
    buffer_load_dwordx4 v[40:43], v10, s[24:27], s35 offen offset:0
    s_add_u32 s35, s35, 40960
    buffer_load_dwordx4 v[44:47], v10, s[24:27], s35 offen offset:0
    s_add_u32 s35, s35, 40960
    buffer_load_dwordx4 v[48:51], v10, s[24:27], s35 offen offset:0
    s_add_u32 s35, s35, 40960
    buffer_load_dwordx4 v[52:55], v10, s[24:27], s35 offen offset:0
    s_add_u32 s35, s35, 40960
    buffer_load_dwordx4 v[56:59], v10, s[24:27], s35 offen offset:0
    s_add_u32 s35, s35, 40960
    buffer_load_dwordx4 v[60:63], v10, s[24:27], s35 offen offset:0
    s_add_u32 s35, s35, 40960
    buffer_load_dwordx4 v[64:67], v10, s[24:27], s35 offen offset:0
    s_sub_u32 s35, s35, 327680
    buffer_load_dwordx4 v[72:75], v10, s[24:27], s35 offen offset:128
    s_add_u32 s35, s35, 40960
    buffer_load_dwordx4 v[76:79], v10, s[24:27], s35 offen offset:128
    s_add_u32 s35, s35, 40960
    buffer_load_dwordx4 v[80:83], v10, s[24:27], s35 offen offset:128
    s_add_u32 s35, s35, 40960
    buffer_load_dwordx4 v[84:87], v10, s[24:27], s35 offen offset:128
    s_add_u32 s35, s35, 40960
    buffer_load_dwordx4 v[88:91], v10, s[24:27], s35 offen offset:128
    s_add_u32 s35, s35, 40960
    buffer_load_dwordx4 v[92:95], v10, s[24:27], s35 offen offset:128
    s_add_u32 s35, s35, 40960
    buffer_load_dwordx4 v[96:99], v10, s[24:27], s35 offen offset:128
    s_add_u32 s35, s35, 40960
    buffer_load_dwordx4 v[100:103], v10, s[24:27], s35 offen offset:128
    s_add_u32 s35, s35, 40960
    buffer_load_dwordx4 v[104:107], v10, s[24:27], s35 offen offset:128
    s_lshl_b32 s36, s34, 2
    s_add_u32 s36, s36, s20
    s_mul_i32 s38, s36, 52429
    s_lshr_b32 s38, s38, 18
    s_mul_i32 s39, s38, 5
    s_sub_u32 s39, s36, s39
    s_mul_i32 s37, s38, 280
    s_mul_i32 s40, s33, 45
    s_add_u32 s37, s37, s40
    s_add_u32 s37, s37, s39
    s_lshl_b32 s37, s37, 10
    s_add_u32 s37, s37, 6696960
    s_waitcnt vmcnt(17)
    ds_write_b128 v5, v[32:35] offset:0
    s_waitcnt vmcnt(16)
    ds_write_b128 v5, v[36:39] offset:4608
    s_waitcnt vmcnt(15)
    ds_write_b128 v5, v[40:43] offset:9216
    s_waitcnt vmcnt(14)
    ds_write_b128 v5, v[44:47] offset:13824
    s_waitcnt vmcnt(13)
    ds_write_b128 v5, v[48:51] offset:18432
    s_waitcnt vmcnt(12)
    ds_write_b128 v5, v[52:55] offset:23040
    s_waitcnt vmcnt(11)
    ds_write_b128 v5, v[56:59] offset:27648
    s_waitcnt vmcnt(10)
    ds_write_b128 v5, v[60:63] offset:32256
    s_waitcnt vmcnt(9)
    ds_write_b128 v5, v[64:67] offset:36864
    s_waitcnt lgkmcnt(0)
    s_barrier
    ds_read_b64_tr_b16 v[32:33], v8 offset:0
    ds_read_b64_tr_b16 v[34:35], v8 offset:576
    ds_read_b64_tr_b16 v[36:37], v8 offset:4608
    ds_read_b64_tr_b16 v[38:39], v8 offset:5184
    ds_read_b64_tr_b16 v[40:41], v8 offset:9216
    ds_read_b64_tr_b16 v[42:43], v8 offset:9792
    ds_read_b64_tr_b16 v[44:45], v8 offset:13824
    ds_read_b64_tr_b16 v[46:47], v8 offset:14400
    ds_read_b64_tr_b16 v[48:49], v8 offset:18432
    ds_read_b64_tr_b16 v[50:51], v8 offset:19008
    ds_read_b64_tr_b16 v[52:53], v8 offset:23040
    ds_read_b64_tr_b16 v[54:55], v8 offset:23616
    ds_read_b64_tr_b16 v[56:57], v8 offset:27648
    ds_read_b64_tr_b16 v[58:59], v8 offset:28224
    ds_read_b64_tr_b16 v[60:61], v8 offset:32256
    ds_read_b64_tr_b16 v[62:63], v8 offset:32832
    ds_read_b64_tr_b16 v[64:65], v8 offset:36864
    ds_read_b64_tr_b16 v[66:67], v8 offset:37440
    s_waitcnt lgkmcnt(15)
    s_add_u32 s38, s37, 0
    buffer_store_dwordx4 v[32:35], v9, s[28:31], s38 offen sc1
    s_waitcnt lgkmcnt(14)
    s_add_u32 s38, s37, 5120
    buffer_store_dwordx4 v[36:39], v9, s[28:31], s38 offen sc1
    s_waitcnt lgkmcnt(12)
    s_add_u32 s38, s37, 10240
    buffer_store_dwordx4 v[40:43], v9, s[28:31], s38 offen sc1
    s_waitcnt lgkmcnt(10)
    s_add_u32 s38, s37, 15360
    buffer_store_dwordx4 v[44:47], v9, s[28:31], s38 offen sc1
    s_waitcnt lgkmcnt(8)
    s_add_u32 s38, s37, 20480
    buffer_store_dwordx4 v[48:51], v9, s[28:31], s38 offen sc1
    s_waitcnt lgkmcnt(6)
    s_add_u32 s38, s37, 25600
    buffer_store_dwordx4 v[52:55], v9, s[28:31], s38 offen sc1
    s_waitcnt lgkmcnt(4)
    s_add_u32 s38, s37, 30720
    buffer_store_dwordx4 v[56:59], v9, s[28:31], s38 offen sc1
    s_waitcnt lgkmcnt(2)
    s_add_u32 s38, s37, 35840
    buffer_store_dwordx4 v[60:63], v9, s[28:31], s38 offen sc1
    s_waitcnt lgkmcnt(0)
    s_add_u32 s38, s37, 40960
    buffer_store_dwordx4 v[64:67], v9, s[28:31], s38 offen sc1
    s_add_u32 s34, s34, 1
    s_barrier
    s_lshl_b32 s36, s34, 2
    s_add_u32 s36, s36, s20
    s_mul_i32 s38, s36, 52429
    s_lshr_b32 s38, s38, 18
    s_mul_i32 s39, s38, 5
    s_sub_u32 s39, s36, s39
    s_mul_i32 s37, s38, 280
    s_mul_i32 s40, s33, 45
    s_add_u32 s37, s37, s40
    s_add_u32 s37, s37, s39
    s_lshl_b32 s37, s37, 10
    s_add_u32 s37, s37, 6696960
    s_waitcnt vmcnt(17)
    ds_write_b128 v5, v[72:75] offset:0
    s_waitcnt vmcnt(16)
    ds_write_b128 v5, v[76:79] offset:4608
    s_waitcnt vmcnt(15)
    ds_write_b128 v5, v[80:83] offset:9216
    s_waitcnt vmcnt(14)
    ds_write_b128 v5, v[84:87] offset:13824
    s_waitcnt vmcnt(13)
    ds_write_b128 v5, v[88:91] offset:18432
    s_waitcnt vmcnt(12)
    ds_write_b128 v5, v[92:95] offset:23040
    s_waitcnt vmcnt(11)
    ds_write_b128 v5, v[96:99] offset:27648
    s_waitcnt vmcnt(10)
    ds_write_b128 v5, v[100:103] offset:32256
    s_waitcnt vmcnt(9)
    ds_write_b128 v5, v[104:107] offset:36864
    s_waitcnt lgkmcnt(0)
    s_barrier
    ds_read_b64_tr_b16 v[72:73], v8 offset:0
    ds_read_b64_tr_b16 v[74:75], v8 offset:576
    ds_read_b64_tr_b16 v[76:77], v8 offset:4608
    ds_read_b64_tr_b16 v[78:79], v8 offset:5184
    ds_read_b64_tr_b16 v[80:81], v8 offset:9216
    ds_read_b64_tr_b16 v[82:83], v8 offset:9792
    ds_read_b64_tr_b16 v[84:85], v8 offset:13824
    ds_read_b64_tr_b16 v[86:87], v8 offset:14400
    ds_read_b64_tr_b16 v[88:89], v8 offset:18432
    ds_read_b64_tr_b16 v[90:91], v8 offset:19008
    ds_read_b64_tr_b16 v[92:93], v8 offset:23040
    ds_read_b64_tr_b16 v[94:95], v8 offset:23616
    ds_read_b64_tr_b16 v[96:97], v8 offset:27648
    ds_read_b64_tr_b16 v[98:99], v8 offset:28224
    ds_read_b64_tr_b16 v[100:101], v8 offset:32256
    ds_read_b64_tr_b16 v[102:103], v8 offset:32832
    ds_read_b64_tr_b16 v[104:105], v8 offset:36864
    ds_read_b64_tr_b16 v[106:107], v8 offset:37440
    s_waitcnt lgkmcnt(15)
    s_add_u32 s38, s37, 0
    buffer_store_dwordx4 v[72:75], v9, s[28:31], s38 offen sc1
    s_waitcnt lgkmcnt(14)
    s_add_u32 s38, s37, 5120
    buffer_store_dwordx4 v[76:79], v9, s[28:31], s38 offen sc1
    s_waitcnt lgkmcnt(12)
    s_add_u32 s38, s37, 10240
    buffer_store_dwordx4 v[80:83], v9, s[28:31], s38 offen sc1
    s_waitcnt lgkmcnt(10)
    s_add_u32 s38, s37, 15360
    buffer_store_dwordx4 v[84:87], v9, s[28:31], s38 offen sc1
    s_waitcnt lgkmcnt(8)
    s_add_u32 s38, s37, 20480
    buffer_store_dwordx4 v[88:91], v9, s[28:31], s38 offen sc1
    s_waitcnt lgkmcnt(6)
    s_add_u32 s38, s37, 25600
    buffer_store_dwordx4 v[92:95], v9, s[28:31], s38 offen sc1
    s_waitcnt lgkmcnt(4)
    s_add_u32 s38, s37, 30720
    buffer_store_dwordx4 v[96:99], v9, s[28:31], s38 offen sc1
    s_waitcnt lgkmcnt(2)
    s_add_u32 s38, s37, 35840
    buffer_store_dwordx4 v[100:103], v9, s[28:31], s38 offen sc1
    s_waitcnt lgkmcnt(0)
    s_add_u32 s38, s37, 40960
    buffer_store_dwordx4 v[104:107], v9, s[28:31], s38 offen sc1
    s_endpgm
k1_kernel_pke20:
    s_endpgm
k1_mod0:
    s_sub_u32 s54, s54, 128
    s_waitcnt lgkmcnt(0)
    s_mov_b32 s28, s10
    s_mov_b32 s29, s11
    s_mov_b32 s30, 268435456
    s_mov_b32 s31, 0x00020000
k1_modf:
    s_load_dwordx4 s[12:15], s[0:1], 88
    s_mov_b32 s32, s54
    v_and_b32 v3, 7, v0
    v_lshrrev_b32 v4, 3, v0
    v_lshlrev_b32 v5, 1, v4
    v_mul_u32_u24 v6, 7680, v4
    s_lshl_b32 s36, s32, 7
    v_lshl_add_u32 v7, v3, 4, s36
    v_add_u32 v6, v6, v7
    s_waitcnt lgkmcnt(0)
    s_mov_b32 s16, s12
    s_mov_b32 s17, s13
    s_mov_b32 s18, 1280
    s_mov_b32 s19, 0x00020000
    s_mov_b32 s20, s14
    s_mov_b32 s21, s15
    s_mov_b32 s22, 4915200
    s_mov_b32 s23, 0x00020000
    buffer_load_ushort v10, v5, s[16:19], 0 offen offset:0
    buffer_load_ushort v11, v5, s[16:19], 0 offen offset:64
    buffer_load_ushort v12, v5, s[16:19], 0 offen offset:128
    buffer_load_ushort v13, v5, s[16:19], 0 offen offset:192
    buffer_load_ushort v14, v5, s[16:19], 0 offen offset:256
    buffer_load_ushort v15, v5, s[16:19], 0 offen offset:320
    buffer_load_ushort v16, v5, s[16:19], 0 offen offset:384
    buffer_load_ushort v17, v5, s[16:19], 0 offen offset:448
    buffer_load_ushort v18, v5, s[16:19], 0 offen offset:512
    buffer_load_ushort v19, v5, s[16:19], 0 offen offset:576
    buffer_load_ushort v20, v5, s[16:19], 0 offen offset:640
    buffer_load_ushort v21, v5, s[16:19], 0 offen offset:704
    buffer_load_ushort v22, v5, s[16:19], 0 offen offset:768
    buffer_load_ushort v23, v5, s[16:19], 0 offen offset:832
    buffer_load_ushort v24, v5, s[16:19], 0 offen offset:896
    buffer_load_ushort v25, v5, s[16:19], 0 offen offset:960
    buffer_load_ushort v26, v5, s[16:19], 0 offen offset:1024
    buffer_load_ushort v27, v5, s[16:19], 0 offen offset:1088
    buffer_load_ushort v28, v5, s[16:19], 0 offen offset:1152
    buffer_load_ushort v29, v5, s[16:19], 0 offen offset:1216
    s_mov_b32 s37, 0
    buffer_load_dwordx4 v[32:35], v6, s[20:23], s37 offen
    s_mov_b32 s37, 245760
    buffer_load_dwordx4 v[36:39], v6, s[20:23], s37 offen
    s_mov_b32 s37, 491520
    buffer_load_dwordx4 v[40:43], v6, s[20:23], s37 offen
    s_mov_b32 s37, 737280
    buffer_load_dwordx4 v[44:47], v6, s[20:23], s37 offen
    s_mov_b32 s37, 983040
    buffer_load_dwordx4 v[48:51], v6, s[20:23], s37 offen
    s_mov_b32 s37, 1228800
    buffer_load_dwordx4 v[52:55], v6, s[20:23], s37 offen
    s_mov_b32 s37, 1474560
    buffer_load_dwordx4 v[56:59], v6, s[20:23], s37 offen
    s_mov_b32 s37, 1720320
    buffer_load_dwordx4 v[60:63], v6, s[20:23], s37 offen
    s_mov_b32 s37, 1966080
    buffer_load_dwordx4 v[64:67], v6, s[20:23], s37 offen
    s_mov_b32 s37, 2211840
    buffer_load_dwordx4 v[68:71], v6, s[20:23], s37 offen
    s_mov_b32 s37, 2457600
    buffer_load_dwordx4 v[72:75], v6, s[20:23], s37 offen
    s_mov_b32 s37, 2703360
    buffer_load_dwordx4 v[76:79], v6, s[20:23], s37 offen
    s_mov_b32 s37, 2949120
    buffer_load_dwordx4 v[80:83], v6, s[20:23], s37 offen
    s_mov_b32 s37, 3194880
    buffer_load_dwordx4 v[84:87], v6, s[20:23], s37 offen
    s_mov_b32 s37, 3440640
    buffer_load_dwordx4 v[88:91], v6, s[20:23], s37 offen
    s_mov_b32 s37, 3686400
    buffer_load_dwordx4 v[92:95], v6, s[20:23], s37 offen
    s_mov_b32 s37, 3932160
    buffer_load_dwordx4 v[96:99], v6, s[20:23], s37 offen
    s_mov_b32 s37, 4177920
    buffer_load_dwordx4 v[100:103], v6, s[20:23], s37 offen
    s_mov_b32 s37, 4423680
    buffer_load_dwordx4 v[104:107], v6, s[20:23], s37 offen
    s_mov_b32 s37, 4669440
    buffer_load_dwordx4 v[108:111], v6, s[20:23], s37 offen
    s_waitcnt vmcnt(20)
    v_lshlrev_b32 v10, 16, v10
    v_mul_f32 v120, 0xbfb8aa3b, v10
    v_exp_f32 v120, v120
    v_lshlrev_b32 v11, 16, v11
    v_mul_f32 v121, 0xbfb8aa3b, v11
    v_exp_f32 v121, v121
    v_lshlrev_b32 v12, 16, v12
    v_mul_f32 v122, 0xbfb8aa3b, v12
    v_exp_f32 v122, v122
    v_lshlrev_b32 v13, 16, v13
    v_mul_f32 v123, 0xbfb8aa3b, v13
    v_exp_f32 v123, v123
    v_lshlrev_b32 v14, 16, v14
    v_mul_f32 v124, 0xbfb8aa3b, v14
    v_exp_f32 v124, v124
    v_lshlrev_b32 v15, 16, v15
    v_mul_f32 v125, 0xbfb8aa3b, v15
    v_exp_f32 v125, v125
    v_lshlrev_b32 v16, 16, v16
    v_mul_f32 v126, 0xbfb8aa3b, v16
    v_exp_f32 v126, v126
    v_lshlrev_b32 v17, 16, v17
    v_mul_f32 v127, 0xbfb8aa3b, v17
    v_exp_f32 v127, v127
    v_lshlrev_b32 v18, 16, v18
    v_mul_f32 v128, 0xbfb8aa3b, v18
    v_exp_f32 v128, v128
    v_lshlrev_b32 v19, 16, v19
    v_mul_f32 v129, 0xbfb8aa3b, v19
    v_exp_f32 v129, v129
    v_lshlrev_b32 v20, 16, v20
    v_mul_f32 v130, 0xbfb8aa3b, v20
    v_exp_f32 v130, v130
    v_lshlrev_b32 v21, 16, v21
    v_mul_f32 v131, 0xbfb8aa3b, v21
    v_exp_f32 v131, v131
    v_lshlrev_b32 v22, 16, v22
    v_mul_f32 v132, 0xbfb8aa3b, v22
    v_exp_f32 v132, v132
    v_lshlrev_b32 v23, 16, v23
    v_mul_f32 v133, 0xbfb8aa3b, v23
    v_exp_f32 v133, v133
    v_lshlrev_b32 v24, 16, v24
    v_mul_f32 v134, 0xbfb8aa3b, v24
    v_exp_f32 v134, v134
    v_lshlrev_b32 v25, 16, v25
    v_mul_f32 v135, 0xbfb8aa3b, v25
    v_exp_f32 v135, v135
    v_lshlrev_b32 v26, 16, v26
    v_mul_f32 v136, 0xbfb8aa3b, v26
    v_exp_f32 v136, v136
    v_lshlrev_b32 v27, 16, v27
    v_mul_f32 v137, 0xbfb8aa3b, v27
    v_exp_f32 v137, v137
    v_lshlrev_b32 v28, 16, v28
    v_mul_f32 v138, 0xbfb8aa3b, v28
    v_exp_f32 v138, v138
    v_lshlrev_b32 v29, 16, v29
    v_mul_f32 v139, 0xbfb8aa3b, v29
    v_exp_f32 v139, v139
    v_add_f32 v120, 1.0, v120
    v_rcp_f32 v120, v120
    v_add_f32 v121, 1.0, v121
    v_rcp_f32 v121, v121
    v_add_f32 v122, 1.0, v122
    v_rcp_f32 v122, v122
    v_add_f32 v123, 1.0, v123
    v_rcp_f32 v123, v123
    v_add_f32 v124, 1.0, v124
    v_rcp_f32 v124, v124
    v_add_f32 v125, 1.0, v125
    v_rcp_f32 v125, v125
    v_add_f32 v126, 1.0, v126
    v_rcp_f32 v126, v126
    v_add_f32 v127, 1.0, v127
    v_rcp_f32 v127, v127
    v_add_f32 v128, 1.0, v128
    v_rcp_f32 v128, v128
    v_add_f32 v129, 1.0, v129
    v_rcp_f32 v129, v129
    v_add_f32 v130, 1.0, v130
    v_rcp_f32 v130, v130
    v_add_f32 v131, 1.0, v131
    v_rcp_f32 v131, v131
    v_add_f32 v132, 1.0, v132
    v_rcp_f32 v132, v132
    v_add_f32 v133, 1.0, v133
    v_rcp_f32 v133, v133
    v_add_f32 v134, 1.0, v134
    v_rcp_f32 v134, v134
    v_add_f32 v135, 1.0, v135
    v_rcp_f32 v135, v135
    v_add_f32 v136, 1.0, v136
    v_rcp_f32 v136, v136
    v_add_f32 v137, 1.0, v137
    v_rcp_f32 v137, v137
    v_add_f32 v138, 1.0, v138
    v_rcp_f32 v138, v138
    v_add_f32 v139, 1.0, v139
    v_rcp_f32 v139, v139
    s_nop 0
    v_mul_f32 v10, v10, v120
    v_mul_f32 v11, v11, v121
    v_mul_f32 v12, v12, v122
    v_mul_f32 v13, v13, v123
    v_mul_f32 v14, v14, v124
    v_mul_f32 v15, v15, v125
    v_mul_f32 v16, v16, v126
    v_mul_f32 v17, v17, v127
    v_mul_f32 v18, v18, v128
    v_mul_f32 v19, v19, v129
    v_mul_f32 v20, v20, v130
    v_mul_f32 v21, v21, v131
    v_mul_f32 v22, v22, v132
    v_mul_f32 v23, v23, v133
    v_mul_f32 v24, v24, v134
    v_mul_f32 v25, v25, v135
    v_mul_f32 v26, v26, v136
    v_mul_f32 v27, v27, v137
    v_mul_f32 v28, v28, v138
    v_mul_f32 v29, v29, v139
    v_cvt_pk_bf16_f32 v120, v10, v11
    v_lshlrev_b32 v10, 16, v120
    v_and_b32 v11, 0xffff0000, v120
    v_cvt_pk_bf16_f32 v120, v12, v13
    v_lshlrev_b32 v12, 16, v120
    v_and_b32 v13, 0xffff0000, v120
    v_cvt_pk_bf16_f32 v120, v14, v15
    v_lshlrev_b32 v14, 16, v120
    v_and_b32 v15, 0xffff0000, v120
    v_cvt_pk_bf16_f32 v120, v16, v17
    v_lshlrev_b32 v16, 16, v120
    v_and_b32 v17, 0xffff0000, v120
    v_cvt_pk_bf16_f32 v120, v18, v19
    v_lshlrev_b32 v18, 16, v120
    v_and_b32 v19, 0xffff0000, v120
    v_cvt_pk_bf16_f32 v120, v20, v21
    v_lshlrev_b32 v20, 16, v120
    v_and_b32 v21, 0xffff0000, v120
    v_cvt_pk_bf16_f32 v120, v22, v23
    v_lshlrev_b32 v22, 16, v120
    v_and_b32 v23, 0xffff0000, v120
    v_cvt_pk_bf16_f32 v120, v24, v25
    v_lshlrev_b32 v24, 16, v120
    v_and_b32 v25, 0xffff0000, v120
    v_cvt_pk_bf16_f32 v120, v26, v27
    v_lshlrev_b32 v26, 16, v120
    v_and_b32 v27, 0xffff0000, v120
    v_cvt_pk_bf16_f32 v120, v28, v29
    v_lshlrev_b32 v28, 16, v120
    v_and_b32 v29, 0xffff0000, v120
    v_mov_b32 v112, 0
    v_mov_b32 v113, 0
    v_mov_b32 v114, 0
    v_mov_b32 v115, 0
    v_mov_b32 v116, 0
    v_mov_b32 v117, 0
    v_mov_b32 v118, 0
    v_mov_b32 v119, 0
    s_waitcnt vmcnt(19)
    v_lshlrev_b32 v120, 16, v32
    v_and_b32 v121, 0xffff0000, v32
    v_lshlrev_b32 v122, 16, v33
    v_and_b32 v123, 0xffff0000, v33
    v_lshlrev_b32 v124, 16, v34
    v_and_b32 v125, 0xffff0000, v34
    v_lshlrev_b32 v126, 16, v35
    v_and_b32 v127, 0xffff0000, v35
    v_pk_fma_f32 v[112:113], v[120:121], v[10:11], v[112:113] op_sel:[0,0,0] op_sel_hi:[1,0,1]
    v_pk_fma_f32 v[114:115], v[122:123], v[10:11], v[114:115] op_sel:[0,0,0] op_sel_hi:[1,0,1]
    v_pk_fma_f32 v[116:117], v[124:125], v[10:11], v[116:117] op_sel:[0,0,0] op_sel_hi:[1,0,1]
    v_pk_fma_f32 v[118:119], v[126:127], v[10:11], v[118:119] op_sel:[0,0,0] op_sel_hi:[1,0,1]
    s_waitcnt vmcnt(18)
    v_lshlrev_b32 v120, 16, v36
    v_and_b32 v121, 0xffff0000, v36
    v_lshlrev_b32 v122, 16, v37
    v_and_b32 v123, 0xffff0000, v37
    v_lshlrev_b32 v124, 16, v38
    v_and_b32 v125, 0xffff0000, v38
    v_lshlrev_b32 v126, 16, v39
    v_and_b32 v127, 0xffff0000, v39
    v_pk_fma_f32 v[112:113], v[120:121], v[10:11], v[112:113] op_sel:[0,1,0] op_sel_hi:[1,1,1]
    v_pk_fma_f32 v[114:115], v[122:123], v[10:11], v[114:115] op_sel:[0,1,0] op_sel_hi:[1,1,1]
    v_pk_fma_f32 v[116:117], v[124:125], v[10:11], v[116:117] op_sel:[0,1,0] op_sel_hi:[1,1,1]
    v_pk_fma_f32 v[118:119], v[126:127], v[10:11], v[118:119] op_sel:[0,1,0] op_sel_hi:[1,1,1]
    s_waitcnt vmcnt(17)
    v_lshlrev_b32 v120, 16, v40
    v_and_b32 v121, 0xffff0000, v40
    v_lshlrev_b32 v122, 16, v41
    v_and_b32 v123, 0xffff0000, v41
    v_lshlrev_b32 v124, 16, v42
    v_and_b32 v125, 0xffff0000, v42
    v_lshlrev_b32 v126, 16, v43
    v_and_b32 v127, 0xffff0000, v43
    v_pk_fma_f32 v[112:113], v[120:121], v[12:13], v[112:113] op_sel:[0,0,0] op_sel_hi:[1,0,1]
    v_pk_fma_f32 v[114:115], v[122:123], v[12:13], v[114:115] op_sel:[0,0,0] op_sel_hi:[1,0,1]
    v_pk_fma_f32 v[116:117], v[124:125], v[12:13], v[116:117] op_sel:[0,0,0] op_sel_hi:[1,0,1]
    v_pk_fma_f32 v[118:119], v[126:127], v[12:13], v[118:119] op_sel:[0,0,0] op_sel_hi:[1,0,1]
    s_waitcnt vmcnt(16)
    v_lshlrev_b32 v120, 16, v44
    v_and_b32 v121, 0xffff0000, v44
    v_lshlrev_b32 v122, 16, v45
    v_and_b32 v123, 0xffff0000, v45
    v_lshlrev_b32 v124, 16, v46
    v_and_b32 v125, 0xffff0000, v46
    v_lshlrev_b32 v126, 16, v47
    v_and_b32 v127, 0xffff0000, v47
    v_pk_fma_f32 v[112:113], v[120:121], v[12:13], v[112:113] op_sel:[0,1,0] op_sel_hi:[1,1,1]
    v_pk_fma_f32 v[114:115], v[122:123], v[12:13], v[114:115] op_sel:[0,1,0] op_sel_hi:[1,1,1]
    v_pk_fma_f32 v[116:117], v[124:125], v[12:13], v[116:117] op_sel:[0,1,0] op_sel_hi:[1,1,1]
    v_pk_fma_f32 v[118:119], v[126:127], v[12:13], v[118:119] op_sel:[0,1,0] op_sel_hi:[1,1,1]
    s_waitcnt vmcnt(15)
    v_lshlrev_b32 v120, 16, v48
    v_and_b32 v121, 0xffff0000, v48
    v_lshlrev_b32 v122, 16, v49
    v_and_b32 v123, 0xffff0000, v49
    v_lshlrev_b32 v124, 16, v50
    v_and_b32 v125, 0xffff0000, v50
    v_lshlrev_b32 v126, 16, v51
    v_and_b32 v127, 0xffff0000, v51
    v_pk_fma_f32 v[112:113], v[120:121], v[14:15], v[112:113] op_sel:[0,0,0] op_sel_hi:[1,0,1]
    v_pk_fma_f32 v[114:115], v[122:123], v[14:15], v[114:115] op_sel:[0,0,0] op_sel_hi:[1,0,1]
    v_pk_fma_f32 v[116:117], v[124:125], v[14:15], v[116:117] op_sel:[0,0,0] op_sel_hi:[1,0,1]
    v_pk_fma_f32 v[118:119], v[126:127], v[14:15], v[118:119] op_sel:[0,0,0] op_sel_hi:[1,0,1]
    s_waitcnt vmcnt(14)
    v_lshlrev_b32 v120, 16, v52
    v_and_b32 v121, 0xffff0000, v52
    v_lshlrev_b32 v122, 16, v53
    v_and_b32 v123, 0xffff0000, v53
    v_lshlrev_b32 v124, 16, v54
    v_and_b32 v125, 0xffff0000, v54
    v_lshlrev_b32 v126, 16, v55
    v_and_b32 v127, 0xffff0000, v55
    v_pk_fma_f32 v[112:113], v[120:121], v[14:15], v[112:113] op_sel:[0,1,0] op_sel_hi:[1,1,1]
    v_pk_fma_f32 v[114:115], v[122:123], v[14:15], v[114:115] op_sel:[0,1,0] op_sel_hi:[1,1,1]
    v_pk_fma_f32 v[116:117], v[124:125], v[14:15], v[116:117] op_sel:[0,1,0] op_sel_hi:[1,1,1]
    v_pk_fma_f32 v[118:119], v[126:127], v[14:15], v[118:119] op_sel:[0,1,0] op_sel_hi:[1,1,1]
    s_waitcnt vmcnt(13)
    v_lshlrev_b32 v120, 16, v56
    v_and_b32 v121, 0xffff0000, v56
    v_lshlrev_b32 v122, 16, v57
    v_and_b32 v123, 0xffff0000, v57
    v_lshlrev_b32 v124, 16, v58
    v_and_b32 v125, 0xffff0000, v58
    v_lshlrev_b32 v126, 16, v59
    v_and_b32 v127, 0xffff0000, v59
    v_pk_fma_f32 v[112:113], v[120:121], v[16:17], v[112:113] op_sel:[0,0,0] op_sel_hi:[1,0,1]
    v_pk_fma_f32 v[114:115], v[122:123], v[16:17], v[114:115] op_sel:[0,0,0] op_sel_hi:[1,0,1]
    v_pk_fma_f32 v[116:117], v[124:125], v[16:17], v[116:117] op_sel:[0,0,0] op_sel_hi:[1,0,1]
    v_pk_fma_f32 v[118:119], v[126:127], v[16:17], v[118:119] op_sel:[0,0,0] op_sel_hi:[1,0,1]
    s_waitcnt vmcnt(12)
    v_lshlrev_b32 v120, 16, v60
    v_and_b32 v121, 0xffff0000, v60
    v_lshlrev_b32 v122, 16, v61
    v_and_b32 v123, 0xffff0000, v61
    v_lshlrev_b32 v124, 16, v62
    v_and_b32 v125, 0xffff0000, v62
    v_lshlrev_b32 v126, 16, v63
    v_and_b32 v127, 0xffff0000, v63
    v_pk_fma_f32 v[112:113], v[120:121], v[16:17], v[112:113] op_sel:[0,1,0] op_sel_hi:[1,1,1]
    v_pk_fma_f32 v[114:115], v[122:123], v[16:17], v[114:115] op_sel:[0,1,0] op_sel_hi:[1,1,1]
    v_pk_fma_f32 v[116:117], v[124:125], v[16:17], v[116:117] op_sel:[0,1,0] op_sel_hi:[1,1,1]
    v_pk_fma_f32 v[118:119], v[126:127], v[16:17], v[118:119] op_sel:[0,1,0] op_sel_hi:[1,1,1]
    s_waitcnt vmcnt(11)
    v_lshlrev_b32 v120, 16, v64
    v_and_b32 v121, 0xffff0000, v64
    v_lshlrev_b32 v122, 16, v65
    v_and_b32 v123, 0xffff0000, v65
    v_lshlrev_b32 v124, 16, v66
    v_and_b32 v125, 0xffff0000, v66
    v_lshlrev_b32 v126, 16, v67
    v_and_b32 v127, 0xffff0000, v67
    v_pk_fma_f32 v[112:113], v[120:121], v[18:19], v[112:113] op_sel:[0,0,0] op_sel_hi:[1,0,1]
    v_pk_fma_f32 v[114:115], v[122:123], v[18:19], v[114:115] op_sel:[0,0,0] op_sel_hi:[1,0,1]
    v_pk_fma_f32 v[116:117], v[124:125], v[18:19], v[116:117] op_sel:[0,0,0] op_sel_hi:[1,0,1]
    v_pk_fma_f32 v[118:119], v[126:127], v[18:19], v[118:119] op_sel:[0,0,0] op_sel_hi:[1,0,1]
    s_waitcnt vmcnt(10)
    v_lshlrev_b32 v120, 16, v68
    v_and_b32 v121, 0xffff0000, v68
    v_lshlrev_b32 v122, 16, v69
    v_and_b32 v123, 0xffff0000, v69
    v_lshlrev_b32 v124, 16, v70
    v_and_b32 v125, 0xffff0000, v70
    v_lshlrev_b32 v126, 16, v71
    v_and_b32 v127, 0xffff0000, v71
    v_pk_fma_f32 v[112:113], v[120:121], v[18:19], v[112:113] op_sel:[0,1,0] op_sel_hi:[1,1,1]
    v_pk_fma_f32 v[114:115], v[122:123], v[18:19], v[114:115] op_sel:[0,1,0] op_sel_hi:[1,1,1]
    v_pk_fma_f32 v[116:117], v[124:125], v[18:19], v[116:117] op_sel:[0,1,0] op_sel_hi:[1,1,1]
    v_pk_fma_f32 v[118:119], v[126:127], v[18:19], v[118:119] op_sel:[0,1,0] op_sel_hi:[1,1,1]
    s_waitcnt vmcnt(9)
    v_lshlrev_b32 v120, 16, v72
    v_and_b32 v121, 0xffff0000, v72
    v_lshlrev_b32 v122, 16, v73
    v_and_b32 v123, 0xffff0000, v73
    v_lshlrev_b32 v124, 16, v74
    v_and_b32 v125, 0xffff0000, v74
    v_lshlrev_b32 v126, 16, v75
    v_and_b32 v127, 0xffff0000, v75
    v_pk_fma_f32 v[112:113], v[120:121], v[20:21], v[112:113] op_sel:[0,0,0] op_sel_hi:[1,0,1]
    v_pk_fma_f32 v[114:115], v[122:123], v[20:21], v[114:115] op_sel:[0,0,0] op_sel_hi:[1,0,1]
    v_pk_fma_f32 v[116:117], v[124:125], v[20:21], v[116:117] op_sel:[0,0,0] op_sel_hi:[1,0,1]
    v_pk_fma_f32 v[118:119], v[126:127], v[20:21], v[118:119] op_sel:[0,0,0] op_sel_hi:[1,0,1]
    s_waitcnt vmcnt(8)
    v_lshlrev_b32 v120, 16, v76
    v_and_b32 v121, 0xffff0000, v76
    v_lshlrev_b32 v122, 16, v77
    v_and_b32 v123, 0xffff0000, v77
    v_lshlrev_b32 v124, 16, v78
    v_and_b32 v125, 0xffff0000, v78
    v_lshlrev_b32 v126, 16, v79
    v_and_b32 v127, 0xffff0000, v79
    v_pk_fma_f32 v[112:113], v[120:121], v[20:21], v[112:113] op_sel:[0,1,0] op_sel_hi:[1,1,1]
    v_pk_fma_f32 v[114:115], v[122:123], v[20:21], v[114:115] op_sel:[0,1,0] op_sel_hi:[1,1,1]
    v_pk_fma_f32 v[116:117], v[124:125], v[20:21], v[116:117] op_sel:[0,1,0] op_sel_hi:[1,1,1]
    v_pk_fma_f32 v[118:119], v[126:127], v[20:21], v[118:119] op_sel:[0,1,0] op_sel_hi:[1,1,1]
    s_waitcnt vmcnt(7)
    v_lshlrev_b32 v120, 16, v80
    v_and_b32 v121, 0xffff0000, v80
    v_lshlrev_b32 v122, 16, v81
    v_and_b32 v123, 0xffff0000, v81
    v_lshlrev_b32 v124, 16, v82
    v_and_b32 v125, 0xffff0000, v82
    v_lshlrev_b32 v126, 16, v83
    v_and_b32 v127, 0xffff0000, v83
    v_pk_fma_f32 v[112:113], v[120:121], v[22:23], v[112:113] op_sel:[0,0,0] op_sel_hi:[1,0,1]
    v_pk_fma_f32 v[114:115], v[122:123], v[22:23], v[114:115] op_sel:[0,0,0] op_sel_hi:[1,0,1]
    v_pk_fma_f32 v[116:117], v[124:125], v[22:23], v[116:117] op_sel:[0,0,0] op_sel_hi:[1,0,1]
    v_pk_fma_f32 v[118:119], v[126:127], v[22:23], v[118:119] op_sel:[0,0,0] op_sel_hi:[1,0,1]
    s_waitcnt vmcnt(6)
    v_lshlrev_b32 v120, 16, v84
    v_and_b32 v121, 0xffff0000, v84
    v_lshlrev_b32 v122, 16, v85
    v_and_b32 v123, 0xffff0000, v85
    v_lshlrev_b32 v124, 16, v86
    v_and_b32 v125, 0xffff0000, v86
    v_lshlrev_b32 v126, 16, v87
    v_and_b32 v127, 0xffff0000, v87
    v_pk_fma_f32 v[112:113], v[120:121], v[22:23], v[112:113] op_sel:[0,1,0] op_sel_hi:[1,1,1]
    v_pk_fma_f32 v[114:115], v[122:123], v[22:23], v[114:115] op_sel:[0,1,0] op_sel_hi:[1,1,1]
    v_pk_fma_f32 v[116:117], v[124:125], v[22:23], v[116:117] op_sel:[0,1,0] op_sel_hi:[1,1,1]
    v_pk_fma_f32 v[118:119], v[126:127], v[22:23], v[118:119] op_sel:[0,1,0] op_sel_hi:[1,1,1]
    s_waitcnt vmcnt(5)
    v_lshlrev_b32 v120, 16, v88
    v_and_b32 v121, 0xffff0000, v88
    v_lshlrev_b32 v122, 16, v89
    v_and_b32 v123, 0xffff0000, v89
    v_lshlrev_b32 v124, 16, v90
    v_and_b32 v125, 0xffff0000, v90
    v_lshlrev_b32 v126, 16, v91
    v_and_b32 v127, 0xffff0000, v91
    v_pk_fma_f32 v[112:113], v[120:121], v[24:25], v[112:113] op_sel:[0,0,0] op_sel_hi:[1,0,1]
    v_pk_fma_f32 v[114:115], v[122:123], v[24:25], v[114:115] op_sel:[0,0,0] op_sel_hi:[1,0,1]
    v_pk_fma_f32 v[116:117], v[124:125], v[24:25], v[116:117] op_sel:[0,0,0] op_sel_hi:[1,0,1]
    v_pk_fma_f32 v[118:119], v[126:127], v[24:25], v[118:119] op_sel:[0,0,0] op_sel_hi:[1,0,1]
    s_waitcnt vmcnt(4)
    v_lshlrev_b32 v120, 16, v92
    v_and_b32 v121, 0xffff0000, v92
    v_lshlrev_b32 v122, 16, v93
    v_and_b32 v123, 0xffff0000, v93
    v_lshlrev_b32 v124, 16, v94
    v_and_b32 v125, 0xffff0000, v94
    v_lshlrev_b32 v126, 16, v95
    v_and_b32 v127, 0xffff0000, v95
    v_pk_fma_f32 v[112:113], v[120:121], v[24:25], v[112:113] op_sel:[0,1,0] op_sel_hi:[1,1,1]
    v_pk_fma_f32 v[114:115], v[122:123], v[24:25], v[114:115] op_sel:[0,1,0] op_sel_hi:[1,1,1]
    v_pk_fma_f32 v[116:117], v[124:125], v[24:25], v[116:117] op_sel:[0,1,0] op_sel_hi:[1,1,1]
    v_pk_fma_f32 v[118:119], v[126:127], v[24:25], v[118:119] op_sel:[0,1,0] op_sel_hi:[1,1,1]
    s_waitcnt vmcnt(3)
    v_lshlrev_b32 v120, 16, v96
    v_and_b32 v121, 0xffff0000, v96
    v_lshlrev_b32 v122, 16, v97
    v_and_b32 v123, 0xffff0000, v97
    v_lshlrev_b32 v124, 16, v98
    v_and_b32 v125, 0xffff0000, v98
    v_lshlrev_b32 v126, 16, v99
    v_and_b32 v127, 0xffff0000, v99
    v_pk_fma_f32 v[112:113], v[120:121], v[26:27], v[112:113] op_sel:[0,0,0] op_sel_hi:[1,0,1]
    v_pk_fma_f32 v[114:115], v[122:123], v[26:27], v[114:115] op_sel:[0,0,0] op_sel_hi:[1,0,1]
    v_pk_fma_f32 v[116:117], v[124:125], v[26:27], v[116:117] op_sel:[0,0,0] op_sel_hi:[1,0,1]
    v_pk_fma_f32 v[118:119], v[126:127], v[26:27], v[118:119] op_sel:[0,0,0] op_sel_hi:[1,0,1]
    s_waitcnt vmcnt(2)
    v_lshlrev_b32 v120, 16, v100
    v_and_b32 v121, 0xffff0000, v100
    v_lshlrev_b32 v122, 16, v101
    v_and_b32 v123, 0xffff0000, v101
    v_lshlrev_b32 v124, 16, v102
    v_and_b32 v125, 0xffff0000, v102
    v_lshlrev_b32 v126, 16, v103
    v_and_b32 v127, 0xffff0000, v103
    v_pk_fma_f32 v[112:113], v[120:121], v[26:27], v[112:113] op_sel:[0,1,0] op_sel_hi:[1,1,1]
    v_pk_fma_f32 v[114:115], v[122:123], v[26:27], v[114:115] op_sel:[0,1,0] op_sel_hi:[1,1,1]
    v_pk_fma_f32 v[116:117], v[124:125], v[26:27], v[116:117] op_sel:[0,1,0] op_sel_hi:[1,1,1]
    v_pk_fma_f32 v[118:119], v[126:127], v[26:27], v[118:119] op_sel:[0,1,0] op_sel_hi:[1,1,1]
    s_waitcnt vmcnt(1)
    v_lshlrev_b32 v120, 16, v104
    v_and_b32 v121, 0xffff0000, v104
    v_lshlrev_b32 v122, 16, v105
    v_and_b32 v123, 0xffff0000, v105
    v_lshlrev_b32 v124, 16, v106
    v_and_b32 v125, 0xffff0000, v106
    v_lshlrev_b32 v126, 16, v107
    v_and_b32 v127, 0xffff0000, v107
    v_pk_fma_f32 v[112:113], v[120:121], v[28:29], v[112:113] op_sel:[0,0,0] op_sel_hi:[1,0,1]
    v_pk_fma_f32 v[114:115], v[122:123], v[28:29], v[114:115] op_sel:[0,0,0] op_sel_hi:[1,0,1]
    v_pk_fma_f32 v[116:117], v[124:125], v[28:29], v[116:117] op_sel:[0,0,0] op_sel_hi:[1,0,1]
    v_pk_fma_f32 v[118:119], v[126:127], v[28:29], v[118:119] op_sel:[0,0,0] op_sel_hi:[1,0,1]
    s_waitcnt vmcnt(0)
    v_lshlrev_b32 v120, 16, v108
    v_and_b32 v121, 0xffff0000, v108
    v_lshlrev_b32 v122, 16, v109
    v_and_b32 v123, 0xffff0000, v109
    v_lshlrev_b32 v124, 16, v110
    v_and_b32 v125, 0xffff0000, v110
    v_lshlrev_b32 v126, 16, v111
    v_and_b32 v127, 0xffff0000, v111
    v_pk_fma_f32 v[112:113], v[120:121], v[28:29], v[112:113] op_sel:[0,1,0] op_sel_hi:[1,1,1]
    v_pk_fma_f32 v[114:115], v[122:123], v[28:29], v[114:115] op_sel:[0,1,0] op_sel_hi:[1,1,1]
    v_pk_fma_f32 v[116:117], v[124:125], v[28:29], v[116:117] op_sel:[0,1,0] op_sel_hi:[1,1,1]
    v_pk_fma_f32 v[118:119], v[126:127], v[28:29], v[118:119] op_sel:[0,1,0] op_sel_hi:[1,1,1]
    v_lshlrev_b32 v7, 5, v0
    ds_write_b128 v7, v[112:115]
    ds_write_b128 v7, v[116:119] offset:16
    s_waitcnt lgkmcnt(0)
    s_barrier
    v_cmp_gt_u32 vcc, 64, v0
    s_and_saveexec_b64 s[42:43], vcc
    s_cbranch_execz k1_end
    v_lshlrev_b32 v7, 2, v0
    ds_read_b32 v32, v7 offset:0
    ds_read_b32 v33, v7 offset:256
    ds_read_b32 v34, v7 offset:512
    ds_read_b32 v35, v7 offset:768
    ds_read_b32 v36, v7 offset:1024
    ds_read_b32 v37, v7 offset:1280
    ds_read_b32 v38, v7 offset:1536
    ds_read_b32 v39, v7 offset:1792
    ds_read_b32 v40, v7 offset:2048
    ds_read_b32 v41, v7 offset:2304
    ds_read_b32 v42, v7 offset:2560
    ds_read_b32 v43, v7 offset:2816
    ds_read_b32 v44, v7 offset:3072
    ds_read_b32 v45, v7 offset:3328
    ds_read_b32 v46, v7 offset:3584
    ds_read_b32 v47, v7 offset:3840
    ds_read_b32 v48, v7 offset:4096
    ds_read_b32 v49, v7 offset:4352
    ds_read_b32 v50, v7 offset:4608
    ds_read_b32 v51, v7 offset:4864
    ds_read_b32 v52, v7 offset:5120
    ds_read_b32 v53, v7 offset:5376
    ds_read_b32 v54, v7 offset:5632
    ds_read_b32 v55, v7 offset:5888
    ds_read_b32 v56, v7 offset:6144
    ds_read_b32 v57, v7 offset:6400
    ds_read_b32 v58, v7 offset:6656
    ds_read_b32 v59, v7 offset:6912
    ds_read_b32 v60, v7 offset:7168
    ds_read_b32 v61, v7 offset:7424
    ds_read_b32 v62, v7 offset:7680
    ds_read_b32 v63, v7 offset:7936
    s_waitcnt lgkmcnt(0)
    v_add_f32 v32, v32, v48
    v_add_f32 v33, v33, v49
    v_add_f32 v34, v34, v50
    v_add_f32 v35, v35, v51
    v_add_f32 v36, v36, v52
    v_add_f32 v37, v37, v53
    v_add_f32 v38, v38, v54
    v_add_f32 v39, v39, v55
    v_add_f32 v40, v40, v56
    v_add_f32 v41, v41, v57
    v_add_f32 v42, v42, v58
    v_add_f32 v43, v43, v59
    v_add_f32 v44, v44, v60
    v_add_f32 v45, v45, v61
    v_add_f32 v46, v46, v62
    v_add_f32 v47, v47, v63
    v_add_f32 v32, v32, v40
    v_add_f32 v33, v33, v41
    v_add_f32 v34, v34, v42
    v_add_f32 v35, v35, v43
    v_add_f32 v36, v36, v44
    v_add_f32 v37, v37, v45
    v_add_f32 v38, v38, v46
    v_add_f32 v39, v39, v47
    v_add_f32 v32, v32, v36
    v_add_f32 v33, v33, v37
    v_add_f32 v34, v34, v38
    v_add_f32 v35, v35, v39
    v_add_f32 v32, v32, v34
    v_add_f32 v33, v33, v35
    v_add_f32 v32, v32, v33
    s_movk_i32 s22, 640
    v_cvt_pk_bf16_f32 v32, v32, v32
    v_lshlrev_b32 v32, 16, v32
    v_add_f32 v33, 1.0, v32
    v_cvt_pk_bf16_f32 v33, v33, v33
    v_lshlrev_b32 v33, 16, v33
    s_lshl_b32 s33, s32, 6
    v_add_u32 v34, s33, v0
    v_subrev_u32 v35, 640, v34
    v_cmp_gt_u32 vcc, 640, v35
    v_subrev_u32 v35, 2560, v34
    v_cmp_gt_u32 s[40:41], s22, v35
    s_or_b64 vcc, vcc, s[40:41]
    v_cndmask_b32 v32, v32, v33, vcc
    s_lshl_b32 s21, s32, 8
    s_add_u32 s21, s21, 2711552
    buffer_store_dword v32, v7, s[28:31], s21 offen sc1
k1_end:
    s_endpgm
k1_pf:
    s_waitcnt lgkmcnt(0)
    s_load_dwordx2 s[4:5], s[0:1], 0
    v_lshlrev_b32 v3, 7, v1
    v_lshlrev_b32 v1, 4, v1
    s_sub_u32 s24, s54, 96
    s_lshr_b32 s24, s24, 3
    s_lshl_b32 s24, s24, 2
    s_add_u32 s24, s24, s20
    s_and_b32 s22, s2, 7
    s_mul_i32 s21, s24, 20480
    s_mul_i32 s23, s22, 327680
    s_add_u32 s21, s21, s23
    s_waitcnt lgkmcnt(0)
    s_mov_b32 s16, s4
    s_mov_b32 s17, s5
    s_mov_b32 s18, 2621440
    s_mov_b32 s19, 0x00020000
    s_mov_b32 s28, s10
    s_mov_b32 s29, s11
    s_mov_b32 s30, 268435456
    s_mov_b32 s31, 0x00020000
    s_sub_u32 s36, s54, 96
    s_cmp_ge_u32 s36, 16
    s_cbranch_scc1 k1_kernel_zf21
    s_lshl_b32 s36, s36, 12
    s_add_u32 s36, s36, 8990720
    v_lshlrev_b32 v5, 4, v0
    v_mov_b32 v60, 0
    v_mov_b32 v61, 0
    v_mov_b32 v62, 0
    v_mov_b32 v63, 0
    buffer_store_dwordx4 v[60:63], v5, s[28:31], s36 offen sc1
k1_kernel_zf21:
    s_sub_u32 s36, s54, 96
    s_lshr_b32 s36, s36, 3
    s_mul_i32 s36, s36, 5120
    s_and_b32 s37, s2, 7
    s_mul_i32 s37, s37, 1601536
    s_add_u32 s36, s36, s37
    s_add_u32 s36, s36, 10641408
    v_lshlrev_b32 v5, 4, v0
    v_mov_b32 v60, 0
    v_mov_b32 v61, 0
    v_mov_b32 v62, 0
    v_mov_b32 v63, 0
    buffer_store_dwordx4 v[60:63], v5, s[28:31], s36 offen sc1
    s_add_u32 s36, s36, 4096
    s_cmp_lg_u32 s20, 0
    s_cbranch_scc1 k1_zst
    buffer_store_dwordx4 v[60:63], v5, s[28:31], s36 offen sc1
k1_zst:
    s_and_b32 s37, s2, 7
    s_cmp_eq_u32 s37, 0
    s_cselect_b32 s38, 9060352, 0
    s_cmp_eq_u32 s37, 7
    s_cselect_b32 s38, 20619264, s38
    s_cmp_eq_u32 s38, 0
    s_cbranch_scc1 k1_zht
    s_sub_u32 s36, s54, 96
    s_lshr_b32 s36, s36, 3
    s_mul_i32 s36, s36, 5120
    s_add_u32 s36, s36, s38
    buffer_store_dwordx4 v[60:63], v5, s[28:31], s36 offen sc1
    s_add_u32 s36, s36, 4096
    s_cmp_lg_u32 s20, 0
    s_cbranch_scc1 k1_zht
    buffer_store_dwordx4 v[60:63], v5, s[28:31], s36 offen sc1
k1_zht:
    s_getpc_b64 s[40:41]
k1_pcref:
    s_sub_u32 s40, s40, k1_pcref-k1_kernel
    s_subb_u32 s41, s41, 0
    s_lshl_b32 s42, s24, 12
    s_add_u32 s43, s42, 0
    s_min_u32 s43, s43, (CODE_END-k1_kernel-1020)&0xfffffff0
    v_add_u32 v6, s43, v1
    global_load_dwordx4 v[64:67], v6, s[40:41]
    s_add_u32 s43, s42, 1024
    s_min_u32 s43, s43, (CODE_END-k1_kernel-1020)&0xfffffff0
    v_add_u32 v6, s43, v1
    global_load_dwordx4 v[68:71], v6, s[40:41]
    s_add_u32 s43, s42, 2048
    s_min_u32 s43, s43, (CODE_END-k1_kernel-1020)&0xfffffff0
    v_add_u32 v6, s43, v1
    global_load_dwordx4 v[72:75], v6, s[40:41]
    s_add_u32 s43, s42, 3072
    s_min_u32 s43, s43, (CODE_END-k1_kernel-1020)&0xfffffff0
    v_add_u32 v6, s43, v1
    global_load_dwordx4 v[76:79], v6, s[40:41]
    s_mov_b32 s61, s21
    s_mov_b32 s62, s24
    s_waitcnt vmcnt(0)
    s_cmp_lg_u32 s20, 0
    s_cbranch_scc1 k1_kernel_sw23
    s_and_b32 s55, s2, 7
    s_lshl_b32 s57, s55, 9
    s_add_u32 s57, s57, 9056256
    v_mov_b32 v250, 0
    v_and_b32 v248, 31, v0
    v_lshlrev_b32 v248, 2, v248
    s_waitcnt lgkmcnt(0)
    s_mov_b32 s28, s10
    s_mov_b32 s29, s11
    s_mov_b32 s30, 268435456
    s_mov_b32 s31, 0x00020000
    buffer_load_dword v251, v250, s[28:31], s57 offen sc1
    s_mov_b32 s23, 30
    s_waitcnt vmcnt(0)
    v_add_u32 v251, 1, v251
k1_kernel_sw22:
    buffer_load_dword v249, v248, s[28:31], s57 offen offset:256 sc1
    s_waitcnt vmcnt(0)
    v_cmp_eq_u32 vcc, v251, v249
    s_sub_u32 s23, s23, 1
    s_cmp_eq_u64 vcc, -1
    s_cbranch_scc1 k1_kernel_sw23
    s_sleep 16
    s_cmp_lg_u32 s23, 0
    s_cbranch_scc1 k1_kernel_sw22
k1_kernel_sw23:
    s_barrier
    s_mov_b32 s21, s61
    s_mov_b32 s24, s62
    s_mov_b32 s28, s10
    s_mov_b32 s29, s11
    s_mov_b32 s30, 268435456
    s_mov_b32 s31, 0x00020000
    buffer_load_dwordx4 v[8:11], v1, s[16:19], s21 offen offset:0
    buffer_load_dwordx4 v[12:15], v1, s[16:19], s21 offen offset:1024
    buffer_load_dwordx4 v[16:19], v1, s[16:19], s21 offen offset:2048
    buffer_load_dwordx4 v[20:23], v1, s[16:19], s21 offen offset:3072
    s_add_u32 s21, s21, 4096
    buffer_load_dwordx4 v[24:27], v1, s[16:19], s21 offen offset:0
    buffer_load_dwordx4 v[28:31], v1, s[16:19], s21 offen offset:1024
    buffer_load_dwordx4 v[32:35], v1, s[16:19], s21 offen offset:2048
    buffer_load_dwordx4 v[36:39], v1, s[16:19], s21 offen offset:3072
    s_add_u32 s21, s21, 4096
    buffer_load_dwordx4 v[40:43], v1, s[16:19], s21 offen offset:0
    buffer_load_dwordx4 v[44:47], v1, s[16:19], s21 offen offset:1024
    buffer_load_dwordx4 v[8:11], v1, s[16:19], s21 offen offset:2048
    buffer_load_dwordx4 v[12:15], v1, s[16:19], s21 offen offset:3072
    s_add_u32 s21, s21, 4096
    buffer_load_dwordx4 v[16:19], v1, s[16:19], s21 offen offset:0
    buffer_load_dwordx4 v[20:23], v1, s[16:19], s21 offen offset:1024
    buffer_load_dwordx4 v[24:27], v1, s[16:19], s21 offen offset:2048
    buffer_load_dwordx4 v[28:31], v1, s[16:19], s21 offen offset:3072
    s_add_u32 s21, s21, 4096
    buffer_load_dwordx4 v[32:35], v1, s[16:19], s21 offen offset:0
    buffer_load_dwordx4 v[36:39], v1, s[16:19], s21 offen offset:1024
    buffer_load_dwordx4 v[40:43], v1, s[16:19], s21 offen offset:2048
    buffer_load_dwordx4 v[44:47], v1, s[16:19], s21 offen offset:3072
    s_add_u32 s21, s21, 4096
    s_mul_i32 s22, s22, 1601536
    s_add_u32 s22, s22, 9060352
    s_waitcnt vmcnt(0)
    s_endpgm
.globl k2_kernel
.p2align 8
.type k2_kernel,@function
k2_kernel:
    s_cmp_ge_u32 s2, 256
    s_cbranch_scc1 k2_end
    s_load_dwordx2 s[4:5], s[0:1], 0
    s_load_dwordx2 s[6:7], s[0:1], 104
    s_load_dwordx2 s[8:9], s[0:1], 120
    s_getreg_b32 s42, hwreg(HW_REG_XCC_ID, 0, 4)
    v_lshrrev_b32 v2, 6, v0
    v_and_b32 v1, 63, v0
    v_readfirstlane_b32 s30, v2
    s_and_b32 s28, s2, 7
    s_lshr_b32 s29, s2, 3
    s_lshr_b32 s32, s29, 3
    s_and_b32 s33, s29, 7
    s_lshr_b32 s34, s29, 4
    s_and_b32 s35, s29, 15
    s_mul_i32 s36, s28, 1601536
    s_add_u32 s36, s36, 9060352
    s_lshl_b32 s37, s28, 13
    s_add_u32 s37, s37, 8990720
    s_add_u32 s42, s42, 1
    s_mov_b32 s31, 0
    v_lshlrev_b32 v2, 4, v1
    v_lshrrev_b32 v3, 4, v1
    v_and_b32 v4, 15, v1
    v_lshrrev_b32 v8, 1, v3
    v_lshl_add_u32 v8, v8, 4, v4
    v_and_b32 v9, 1, v3
    v_lshl_add_u32 v8, v8, 1, v9
    v_lshlrev_b32 v8, 3, v8
    v_lshlrev_b32 v5, 7, v1
    v_and_b32 v9, 1, v3
    v_lshlrev_b32 v9, 1, v9
    v_lshrrev_b32 v10, 1, v3
    v_or_b32 v9, v9, v10
    v_lshlrev_b32 v9, 8, v9
    v_lshl_add_u32 v254, v4, 4, v9
    s_waitcnt lgkmcnt(0)
    s_mov_b32 s12, s8
    s_mov_b32 s13, s9
    s_mov_b32 s14, 268435456
    s_mov_b32 s15, 0x00020000
    s_mov_b32 s16, s4
    s_mov_b32 s17, s5
    s_mov_b32 s18, 2621440
    s_mov_b32 s19, 0x00020000
    s_mov_b32 s24, s6
    s_mov_b32 s25, s7
    s_mov_b32 s26, 2621440
    s_mov_b32 s27, 0x00020000
    s_cmp_lg_u32 s30, 0
    s_cbranch_scc1 k2_kernel_L1
    s_lshl_b32 s41, s29, 2
    s_add_u32 s41, s41, s37
    v_mov_b32 v9, s42
    v_mov_b32 v10, 7424
    s_mov_b64 exec, 1
    buffer_store_dword v9, v10, s[12:15], s41 offen sc1
    s_mov_b64 exec, -1
k2_kernel_L1:
    s_mul_i32 s44, s33, 102400
    s_mul_i32 s45, s35, 143360
    s_add_u32 s45, s45, 4403200
    s_mul_i32 s40, s33, 286720
    s_mul_i32 s41, s30, 71680
    s_add_u32 s40, s40, s41
    s_add_u32 s40, s40, 6696960
    s_lshl_b32 s46, s32, 2
    s_add_u32 s46, s46, s30
    s_mul_i32 s47, s46, 20480
    s_mul_i32 s41, s33, 2560
    s_add_u32 s47, s47, s41
    s_add_u32 s54, s47, s36
    s_lshl_b32 s55, s46, 7
    s_add_u32 s55, s55, s37
    s_mul_i32 s22, s28, 327680
    s_add_u32 s22, s22, s47
    s_add_u32 s22, s22, 0
    s_mul_i32 s38, s30, 25600
    s_add_u32 s39, s38, s44
    s_add_u32 s39, s39, 2764800
    s_add_u32 s38, s38, 0
    s_cmp_ge_u32 s29, 18
    s_cbranch_scc1 k2_kernel_nob02
    s_lshl_b32 s46, s28, 8
    s_lshl_b32 s47, s29, 4
    s_add_u32 s46, s46, s47
    s_sub_u32 s46, s46, 16
    s_lshl_b32 s47, s30, 2
    s_add_u32 s47, s47, s46
    v_add_u32 v11, s47, v3
    s_movk_i32 s48, 1280
    v_mul_lo_u32 v6, v11, s48
    v_lshl_add_u32 v6, v4, 4, v6
    buffer_load_dwordx4 v[16:19], v6, s[16:19], 0 offen offset:0
    buffer_load_dwordx4 v[20:23], v6, s[16:19], 0 offen offset:256
    buffer_load_dwordx4 v[24:27], v6, s[16:19], 0 offen offset:512
    buffer_load_dwordx4 v[28:31], v6, s[16:19], 0 offen offset:768
    buffer_load_dwordx4 v[32:35], v6, s[16:19], 0 offen offset:1024
    s_mul_i32 s47, s29, 20480
    s_mul_i32 s48, s30, 5120
    s_add_u32 s47, s47, s48
    s_add_u32 s47, s47, s36
    v_add_u32 v12, s47, v2
    s_add_u32 s48, s48, 135168
    s_mov_b32 m0, s48
    s_nop 0
    buffer_load_dwordx4 v12, s[12:15], 0 offen offset:0 lds
    buffer_load_dwordx4 v12, s[12:15], 0 offen offset:1024 lds
    buffer_load_dwordx4 v12, s[12:15], 0 offen offset:2048 lds
    buffer_load_dwordx4 v12, s[12:15], 0 offen offset:3072 lds
    s_add_u32 s48, s48, 4096
    s_mov_b32 m0, s48
    s_movk_i32 s47, 4096
    buffer_load_dwordx4 v12, s[12:15], s47 offen lds
    s_lshl_b32 s47, s30, 12
    s_add_u32 s48, s47, 118784
    s_add_u32 s41, s47, 0
    s_min_u32 s41, s41, 14336
    s_add_u32 s41, s41, 2711552
    s_add_u32 m0, s48, 0
    s_nop 0
    buffer_load_dwordx4 v2, s[12:15], s41 offen lds
    s_add_u32 s41, s47, 1024
    s_min_u32 s41, s41, 14336
    s_add_u32 s41, s41, 2711552
    s_add_u32 m0, s48, 1024
    s_nop 0
    buffer_load_dwordx4 v2, s[12:15], s41 offen lds
    s_add_u32 s41, s47, 2048
    s_min_u32 s41, s41, 14336
    s_add_u32 s41, s41, 2711552
    s_add_u32 m0, s48, 2048
    s_nop 0
    buffer_load_dwordx4 v2, s[12:15], s41 offen lds
    s_add_u32 s41, s47, 3072
    s_min_u32 s41, s41, 14336
    s_add_u32 s41, s41, 2711552
    s_add_u32 m0, s48, 3072
    s_nop 0
    buffer_load_dwordx4 v2, s[12:15], s41 offen lds
    v_lshl_add_u32 v15, s30, 2, v3
    v_lshrrev_b32 v7, 1, v15
    v_and_b32 v9, 7, v4
    v_xor_b32 v7, v7, v9
    v_and_b32 v9, 1, v15
    v_lshl_add_u32 v7, v7, 1, v9
    v_lshlrev_b32 v7, 3, v7
    v_lshl_add_u32 v7, v4, 8, v7
    v_add_u32 v7, 135168, v7
    v_lshlrev_b32 v10, 5, v4
    v_add_u32 v10, 118784, v10
    v_lshrrev_b32 v12, 2, v4
    v_and_b32 v13, 3, v4
    v_lshl_add_u32 v13, v13, 4, v15
    v_lshlrev_b32 v13, 4, v13
    v_lshl_add_u32 v6, v12, 10, v13
    s_movk_i32 s48, 2048
    v_cmp_gt_u32 s[50:51], s48, v11
    v_mov_b32 v120, 0
    v_mov_b32 v121, 0
    v_mov_b32 v124, 0
    v_mov_b32 v125, 0
    v_mov_b32 v126, 0x3f803f80
    s_waitcnt vmcnt(9)
    v_dot2_f32_bf16 v120, v16, v126, v120
    v_dot2_f32_bf16 v121, v16, v16, v121
    v_lshlrev_b32 v56, 16, v16
    v_and_b32 v57, 0xffff0000, v16
    v_dot2_f32_bf16 v120, v17, v126, v120
    v_dot2_f32_bf16 v121, v17, v17, v121
    v_lshlrev_b32 v58, 16, v17
    v_and_b32 v59, 0xffff0000, v17
    v_dot2_f32_bf16 v120, v18, v126, v120
    v_dot2_f32_bf16 v121, v18, v18, v121
    v_lshlrev_b32 v60, 16, v18
    v_and_b32 v61, 0xffff0000, v18
    s_cmp_eq_u32 s30, 1
    s_cbranch_scc1 k2_kernel_sm4
    s_cmp_ge_u32 s30, 2
    s_cbranch_scc1 k2_kernel_sm5
    s_mul_i32 s41, s33, 320
    s_add_u32 s41, s41, 2748416
    s_mov_b32 m0, 155648
    s_mov_b64 exec, 0xfffff
    buffer_load_dwordx4 v2, s[12:15], s41 offen lds
    s_add_u32 s41, s41, 7168
    s_mov_b32 m0, 156160
    s_nop 0
    buffer_load_dwordx4 v2, s[12:15], s41 offen lds
    s_branch k2_kernel_sm6
k2_kernel_sm4:
    s_mul_i32 s41, s35, 448
    s_add_u32 s41, s41, 2732032
    s_mov_b32 m0, 156672
    s_mov_b64 exec, 0xfffffff
    buffer_load_dwordx4 v2, s[12:15], s41 offen lds
    s_add_u32 s41, s41, 7168
    s_mov_b32 m0, 157184
    s_nop 0
    buffer_load_dwordx4 v2, s[12:15], s41 offen lds
    s_branch k2_kernel_sm6
k2_kernel_sm5:
    s_mul_i32 s41, s33, 320
    s_add_u32 s41, s41, 2724352
    s_mov_b32 m0, 157696
    s_mov_b64 exec, 0xfffff
    buffer_load_dwordx4 v2, s[12:15], s41 offen lds
k2_kernel_sm6:
    s_mov_b64 exec, -1
    v_dot2_f32_bf16 v120, v19, v126, v120
    v_dot2_f32_bf16 v121, v19, v19, v121
    v_lshlrev_b32 v62, 16, v19
    v_and_b32 v63, 0xffff0000, v19
    v_dot2_f32_bf16 v120, v20, v126, v120
    v_dot2_f32_bf16 v121, v20, v20, v121
    v_lshlrev_b32 v64, 16, v20
    v_and_b32 v65, 0xffff0000, v20
    s_mov_b32 m0, s38
    s_nop 0
    buffer_load_dwordx4 v2, s[12:15], s39 offen offset:0 lds
    v_dot2_f32_bf16 v120, v21, v126, v120
    v_dot2_f32_bf16 v121, v21, v21, v121
    v_lshlrev_b32 v66, 16, v21
    v_and_b32 v67, 0xffff0000, v21
    v_dot2_f32_bf16 v120, v22, v126, v120
    v_dot2_f32_bf16 v121, v22, v22, v121
    v_lshlrev_b32 v68, 16, v22
    v_and_b32 v69, 0xffff0000, v22
    s_mov_b32 m0, s38
    s_nop 0
    buffer_load_dwordx4 v2, s[12:15], s39 offen offset:1024 lds
    v_dot2_f32_bf16 v120, v23, v126, v120
    v_dot2_f32_bf16 v121, v23, v23, v121
    v_lshlrev_b32 v70, 16, v23
    v_and_b32 v71, 0xffff0000, v23
    v_dot2_f32_bf16 v120, v24, v126, v120
    v_dot2_f32_bf16 v121, v24, v24, v121
    v_lshlrev_b32 v72, 16, v24
    v_and_b32 v73, 0xffff0000, v24
    s_mov_b32 m0, s38
    s_nop 0
    buffer_load_dwordx4 v2, s[12:15], s39 offen offset:2048 lds
    v_dot2_f32_bf16 v120, v25, v126, v120
    v_dot2_f32_bf16 v121, v25, v25, v121
    v_lshlrev_b32 v74, 16, v25
    v_and_b32 v75, 0xffff0000, v25
    v_dot2_f32_bf16 v120, v26, v126, v120
    v_dot2_f32_bf16 v121, v26, v26, v121
    v_lshlrev_b32 v76, 16, v26
    v_and_b32 v77, 0xffff0000, v26
    s_mov_b32 m0, s38
    s_nop 0
    buffer_load_dwordx4 v2, s[12:15], s39 offen offset:3072 lds
    s_add_u32 s38, s38, 4096
    s_add_u32 s39, s39, 4096
    v_dot2_f32_bf16 v120, v27, v126, v120
    v_dot2_f32_bf16 v121, v27, v27, v121
    v_lshlrev_b32 v78, 16, v27
    v_and_b32 v79, 0xffff0000, v27
    v_dot2_f32_bf16 v120, v28, v126, v120
    v_dot2_f32_bf16 v121, v28, v28, v121
    v_lshlrev_b32 v80, 16, v28
    v_and_b32 v81, 0xffff0000, v28
    s_mov_b32 m0, s38
    s_nop 0
    buffer_load_dwordx4 v2, s[12:15], s39 offen offset:0 lds
    v_dot2_f32_bf16 v120, v29, v126, v120
    v_dot2_f32_bf16 v121, v29, v29, v121
    v_lshlrev_b32 v82, 16, v29
    v_and_b32 v83, 0xffff0000, v29
    v_dot2_f32_bf16 v120, v30, v126, v120
    v_dot2_f32_bf16 v121, v30, v30, v121
    v_lshlrev_b32 v84, 16, v30
    v_and_b32 v85, 0xffff0000, v30
    s_mov_b32 m0, s38
    s_nop 0
    buffer_load_dwordx4 v2, s[12:15], s39 offen offset:1024 lds
    v_dot2_f32_bf16 v120, v31, v126, v120
    v_dot2_f32_bf16 v121, v31, v31, v121
    v_lshlrev_b32 v86, 16, v31
    v_and_b32 v87, 0xffff0000, v31
    v_dot2_f32_bf16 v120, v32, v126, v120
    v_dot2_f32_bf16 v121, v32, v32, v121
    v_lshlrev_b32 v88, 16, v32
    v_and_b32 v89, 0xffff0000, v32
    s_mov_b32 m0, s38
    s_nop 0
    buffer_load_dwordx4 v2, s[12:15], s39 offen offset:2048 lds
    v_dot2_f32_bf16 v120, v33, v126, v120
    v_dot2_f32_bf16 v121, v33, v33, v121
    v_lshlrev_b32 v90, 16, v33
    v_and_b32 v91, 0xffff0000, v33
    v_dot2_f32_bf16 v120, v34, v126, v120
    v_dot2_f32_bf16 v121, v34, v34, v121
    v_lshlrev_b32 v92, 16, v34
    v_and_b32 v93, 0xffff0000, v34
    s_mov_b32 m0, s38
    s_nop 0
    buffer_load_dwordx4 v2, s[12:15], s39 offen offset:3072 lds
    s_add_u32 s38, s38, 4096
    s_add_u32 s39, s39, 4096
    v_dot2_f32_bf16 v120, v35, v126, v120
    v_dot2_f32_bf16 v121, v35, v35, v121
    v_lshlrev_b32 v94, 16, v35
    v_and_b32 v95, 0xffff0000, v35
    s_nop 1
    s_nop 0
    v_add_f32_dpp v120, v120, v120 quad_perm:[1,0,3,2] row_mask:0xf bank_mask:0xf
    v_add_f32_dpp v121, v121, v121 quad_perm:[1,0,3,2] row_mask:0xf bank_mask:0xf
    s_nop 0
    v_add_f32_dpp v120, v120, v120 quad_perm:[2,3,0,1] row_mask:0xf bank_mask:0xf
    v_add_f32_dpp v121, v121, v121 quad_perm:[2,3,0,1] row_mask:0xf bank_mask:0xf
    s_nop 0
    v_add_f32_dpp v120, v120, v120 row_half_mirror row_mask:0xf bank_mask:0xf
    v_add_f32_dpp v121, v121, v121 row_half_mirror row_mask:0xf bank_mask:0xf
    s_nop 0
    v_add_f32_dpp v120, v120, v120 row_mirror row_mask:0xf bank_mask:0xf
    v_add_f32_dpp v121, v121, v121 row_mirror row_mask:0xf bank_mask:0xf
    v_mul_f32 v120, 0x3acccccd, v120
    v_mul_f32 v121, 0x3acccccd, v121
    v_fma_f32 v121, -v120, v120, v121
    v_max_f32 v121, 0, v121
    v_cvt_pk_bf16_f32 v122, v120, v121
    v_lshlrev_b32 v120, 16, v122
    v_and_b32 v121, 0xffff0000, v122
    v_add_f32 v121, 0x3727c5ac, v121
    v_cvt_pk_bf16_f32 v122, v121, v121
    v_lshlrev_b32 v121, 16, v122
    v_sqrt_f32 v121, v121
    s_nop 0
    v_cvt_pk_bf16_f32 v122, v121, v121
    v_lshlrev_b32 v121, 16, v122
    v_rcp_f32 v121, v121
    s_nop 0
    v_mul_f32 v120, v120, v121
    v_sub_f32 v120, 0, v120
    s_waitcnt vmcnt(9)
    s_barrier
    ds_read_b64 v[36:37], v7 offset:0
    ds_read_b64 v[38:39], v7 offset:128
    ds_read_b64 v[40:41], v7 offset:4096
    ds_read_b64 v[42:43], v7 offset:4224
    ds_read_b64 v[44:45], v7 offset:8192
    ds_read_b64 v[46:47], v7 offset:8320
    ds_read_b64 v[48:49], v7 offset:12288
    ds_read_b64 v[50:51], v7 offset:12416
    ds_read_b64 v[52:53], v7 offset:16384
    ds_read_b64 v[54:55], v7 offset:16512
    ds_read_b128 v[96:99], v10 offset:2560
    ds_read_b128 v[100:103], v10 offset:2576
    ds_read_b128 v[104:107], v10 offset:0
    ds_read_b128 v[108:111], v10 offset:16
    ds_read_b128 v[112:115], v10 offset:5120
    ds_read_b128 v[116:119], v10 offset:5136
    ds_read_b128 v[160:163], v10 offset:3072
    ds_read_b128 v[164:167], v10 offset:3088
    ds_read_b128 v[168:171], v10 offset:512
    ds_read_b128 v[172:175], v10 offset:528
    ds_read_b128 v[176:179], v10 offset:5632
    ds_read_b128 v[180:183], v10 offset:5648
    s_waitcnt lgkmcnt(6)
    v_lshlrev_b32 v152, 16, v36
    v_and_b32 v153, 0xffff0000, v36
    v_lshlrev_b32 v154, 16, v37
    v_and_b32 v155, 0xffff0000, v37
    v_lshlrev_b32 v156, 16, v38
    v_and_b32 v157, 0xffff0000, v38
    v_lshlrev_b32 v158, 16, v39
    v_and_b32 v159, 0xffff0000, v39
    v_pk_fma_f32 v[144:145], v[56:57], v[120:121], v[120:121] op_sel:[0,1,0] op_sel_hi:[1,1,0]
    v_pk_fma_f32 v[146:147], v[58:59], v[120:121], v[120:121] op_sel:[0,1,0] op_sel_hi:[1,1,0]
    v_pk_fma_f32 v[148:149], v[60:61], v[120:121], v[120:121] op_sel:[0,1,0] op_sel_hi:[1,1,0]
    v_pk_fma_f32 v[150:151], v[62:63], v[120:121], v[120:121] op_sel:[0,1,0] op_sel_hi:[1,1,0]
    v_pk_fma_f32 v[144:145], v[144:145], v[96:97], v[104:105]
    v_pk_fma_f32 v[146:147], v[146:147], v[98:99], v[106:107]
    v_pk_fma_f32 v[148:149], v[148:149], v[100:101], v[108:109]
    v_pk_fma_f32 v[150:151], v[150:151], v[102:103], v[110:111]
    v_pk_mul_f32 v[144:145], v[144:145], v[152:153]
    v_pk_mul_f32 v[146:147], v[146:147], v[154:155]
    v_pk_mul_f32 v[148:149], v[148:149], v[156:157]
    v_pk_mul_f32 v[150:151], v[150:151], v[158:159]
    v_pk_fma_f32 v[56:57], v[112:113], v[144:145], v[56:57]
    v_pk_fma_f32 v[58:59], v[114:115], v[146:147], v[58:59]
    v_pk_fma_f32 v[60:61], v[116:117], v[148:149], v[60:61]
    v_pk_fma_f32 v[62:63], v[118:119], v[150:151], v[62:63]
    v_cvt_pk_bf16_f32 v16, v56, v57
    v_cvt_pk_bf16_f32 v17, v58, v59
    v_cvt_pk_bf16_f32 v18, v60, v61
    v_cvt_pk_bf16_f32 v19, v62, v63
    v_dot2_f32_bf16 v124, v16, v126, v124
    v_dot2_f32_bf16 v125, v16, v16, v125
    v_dot2_f32_bf16 v124, v17, v126, v124
    v_dot2_f32_bf16 v125, v17, v17, v125
    v_dot2_f32_bf16 v124, v18, v126, v124
    v_dot2_f32_bf16 v125, v18, v18, v125
    v_dot2_f32_bf16 v124, v19, v126, v124
    v_dot2_f32_bf16 v125, v19, v19, v125
    ds_read_b128 v[96:99], v10 offset:3584
    ds_read_b128 v[100:103], v10 offset:3600
    ds_read_b128 v[104:107], v10 offset:1024
    ds_read_b128 v[108:111], v10 offset:1040
    ds_read_b128 v[112:115], v10 offset:6144
    ds_read_b128 v[116:119], v10 offset:6160
    s_waitcnt lgkmcnt(6)
    v_lshlrev_b32 v152, 16, v40
    v_and_b32 v153, 0xffff0000, v40
    v_lshlrev_b32 v154, 16, v41
    v_and_b32 v155, 0xffff0000, v41
    v_lshlrev_b32 v156, 16, v42
    v_and_b32 v157, 0xffff0000, v42
    v_lshlrev_b32 v158, 16, v43
    v_and_b32 v159, 0xffff0000, v43
    v_pk_fma_f32 v[144:145], v[64:65], v[120:121], v[120:121] op_sel:[0,1,0] op_sel_hi:[1,1,0]
    v_pk_fma_f32 v[146:147], v[66:67], v[120:121], v[120:121] op_sel:[0,1,0] op_sel_hi:[1,1,0]
    v_pk_fma_f32 v[148:149], v[68:69], v[120:121], v[120:121] op_sel:[0,1,0] op_sel_hi:[1,1,0]
    v_pk_fma_f32 v[150:151], v[70:71], v[120:121], v[120:121] op_sel:[0,1,0] op_sel_hi:[1,1,0]
    v_pk_fma_f32 v[144:145], v[144:145], v[160:161], v[168:169]
    v_pk_fma_f32 v[146:147], v[146:147], v[162:163], v[170:171]
    v_pk_fma_f32 v[148:149], v[148:149], v[164:165], v[172:173]
    v_pk_fma_f32 v[150:151], v[150:151], v[166:167], v[174:175]
    v_pk_mul_f32 v[144:145], v[144:145], v[152:153]
    v_pk_mul_f32 v[146:147], v[146:147], v[154:155]
    v_pk_mul_f32 v[148:149], v[148:149], v[156:157]
    v_pk_mul_f32 v[150:151], v[150:151], v[158:159]
    v_pk_fma_f32 v[64:65], v[176:177], v[144:145], v[64:65]
    v_pk_fma_f32 v[66:67], v[178:179], v[146:147], v[66:67]
    v_pk_fma_f32 v[68:69], v[180:181], v[148:149], v[68:69]
    v_pk_fma_f32 v[70:71], v[182:183], v[150:151], v[70:71]
    v_cvt_pk_bf16_f32 v20, v64, v65
    v_cvt_pk_bf16_f32 v21, v66, v67
    v_cvt_pk_bf16_f32 v22, v68, v69
    v_cvt_pk_bf16_f32 v23, v70, v71
    v_dot2_f32_bf16 v124, v20, v126, v124
    v_dot2_f32_bf16 v125, v20, v20, v125
    v_dot2_f32_bf16 v124, v21, v126, v124
    v_dot2_f32_bf16 v125, v21, v21, v125
    v_dot2_f32_bf16 v124, v22, v126, v124
    v_dot2_f32_bf16 v125, v22, v22, v125
    v_dot2_f32_bf16 v124, v23, v126, v124
    v_dot2_f32_bf16 v125, v23, v23, v125
    ds_read_b128 v[160:163], v10 offset:4096
    ds_read_b128 v[164:167], v10 offset:4112
    ds_read_b128 v[168:171], v10 offset:1536
    ds_read_b128 v[172:175], v10 offset:1552
    ds_read_b128 v[176:179], v10 offset:6656
    ds_read_b128 v[180:183], v10 offset:6672
    s_waitcnt lgkmcnt(6)
    v_lshlrev_b32 v152, 16, v44
    v_and_b32 v153, 0xffff0000, v44
    v_lshlrev_b32 v154, 16, v45
    v_and_b32 v155, 0xffff0000, v45
    v_lshlrev_b32 v156, 16, v46
    v_and_b32 v157, 0xffff0000, v46
    v_lshlrev_b32 v158, 16, v47
    v_and_b32 v159, 0xffff0000, v47
    v_pk_fma_f32 v[144:145], v[72:73], v[120:121], v[120:121] op_sel:[0,1,0] op_sel_hi:[1,1,0]
    v_pk_fma_f32 v[146:147], v[74:75], v[120:121], v[120:121] op_sel:[0,1,0] op_sel_hi:[1,1,0]
    v_pk_fma_f32 v[148:149], v[76:77], v[120:121], v[120:121] op_sel:[0,1,0] op_sel_hi:[1,1,0]
    v_pk_fma_f32 v[150:151], v[78:79], v[120:121], v[120:121] op_sel:[0,1,0] op_sel_hi:[1,1,0]
    v_pk_fma_f32 v[144:145], v[144:145], v[96:97], v[104:105]
    v_pk_fma_f32 v[146:147], v[146:147], v[98:99], v[106:107]
    v_pk_fma_f32 v[148:149], v[148:149], v[100:101], v[108:109]
    v_pk_fma_f32 v[150:151], v[150:151], v[102:103], v[110:111]
    v_pk_mul_f32 v[144:145], v[144:145], v[152:153]
    v_pk_mul_f32 v[146:147], v[146:147], v[154:155]
    v_pk_mul_f32 v[148:149], v[148:149], v[156:157]
    v_pk_mul_f32 v[150:151], v[150:151], v[158:159]
    v_pk_fma_f32 v[72:73], v[112:113], v[144:145], v[72:73]
    v_pk_fma_f32 v[74:75], v[114:115], v[146:147], v[74:75]
    v_pk_fma_f32 v[76:77], v[116:117], v[148:149], v[76:77]
    v_pk_fma_f32 v[78:79], v[118:119], v[150:151], v[78:79]
    v_cvt_pk_bf16_f32 v24, v72, v73
    v_cvt_pk_bf16_f32 v25, v74, v75
    v_cvt_pk_bf16_f32 v26, v76, v77
    v_cvt_pk_bf16_f32 v27, v78, v79
    v_dot2_f32_bf16 v124, v24, v126, v124
    v_dot2_f32_bf16 v125, v24, v24, v125
    v_dot2_f32_bf16 v124, v25, v126, v124
    v_dot2_f32_bf16 v125, v25, v25, v125
    v_dot2_f32_bf16 v124, v26, v126, v124
    v_dot2_f32_bf16 v125, v26, v26, v125
    v_dot2_f32_bf16 v124, v27, v126, v124
    v_dot2_f32_bf16 v125, v27, v27, v125
    ds_read_b128 v[96:99], v10 offset:4608
    ds_read_b128 v[100:103], v10 offset:4624
    ds_read_b128 v[104:107], v10 offset:2048
    ds_read_b128 v[108:111], v10 offset:2064
    ds_read_b128 v[112:115], v10 offset:7168
    ds_read_b128 v[116:119], v10 offset:7184
    s_waitcnt lgkmcnt(6)
    v_lshlrev_b32 v152, 16, v48
    v_and_b32 v153, 0xffff0000, v48
    v_lshlrev_b32 v154, 16, v49
    v_and_b32 v155, 0xffff0000, v49
    v_lshlrev_b32 v156, 16, v50
    v_and_b32 v157, 0xffff0000, v50
    v_lshlrev_b32 v158, 16, v51
    v_and_b32 v159, 0xffff0000, v51
    v_pk_fma_f32 v[144:145], v[80:81], v[120:121], v[120:121] op_sel:[0,1,0] op_sel_hi:[1,1,0]
    v_pk_fma_f32 v[146:147], v[82:83], v[120:121], v[120:121] op_sel:[0,1,0] op_sel_hi:[1,1,0]
    v_pk_fma_f32 v[148:149], v[84:85], v[120:121], v[120:121] op_sel:[0,1,0] op_sel_hi:[1,1,0]
    v_pk_fma_f32 v[150:151], v[86:87], v[120:121], v[120:121] op_sel:[0,1,0] op_sel_hi:[1,1,0]
    v_pk_fma_f32 v[144:145], v[144:145], v[160:161], v[168:169]
    v_pk_fma_f32 v[146:147], v[146:147], v[162:163], v[170:171]
    v_pk_fma_f32 v[148:149], v[148:149], v[164:165], v[172:173]
    v_pk_fma_f32 v[150:151], v[150:151], v[166:167], v[174:175]
    v_pk_mul_f32 v[144:145], v[144:145], v[152:153]
    v_pk_mul_f32 v[146:147], v[146:147], v[154:155]
    v_pk_mul_f32 v[148:149], v[148:149], v[156:157]
    v_pk_mul_f32 v[150:151], v[150:151], v[158:159]
    v_pk_fma_f32 v[80:81], v[176:177], v[144:145], v[80:81]
    v_pk_fma_f32 v[82:83], v[178:179], v[146:147], v[82:83]
    v_pk_fma_f32 v[84:85], v[180:181], v[148:149], v[84:85]
    v_pk_fma_f32 v[86:87], v[182:183], v[150:151], v[86:87]
    v_cvt_pk_bf16_f32 v28, v80, v81
    v_cvt_pk_bf16_f32 v29, v82, v83
    v_cvt_pk_bf16_f32 v30, v84, v85
    v_cvt_pk_bf16_f32 v31, v86, v87
    v_dot2_f32_bf16 v124, v28, v126, v124
    v_dot2_f32_bf16 v125, v28, v28, v125
    v_dot2_f32_bf16 v124, v29, v126, v124
    v_dot2_f32_bf16 v125, v29, v29, v125
    v_dot2_f32_bf16 v124, v30, v126, v124
    v_dot2_f32_bf16 v125, v30, v30, v125
    v_dot2_f32_bf16 v124, v31, v126, v124
    v_dot2_f32_bf16 v125, v31, v31, v125
    s_waitcnt lgkmcnt(0)
    v_lshlrev_b32 v152, 16, v52
    v_and_b32 v153, 0xffff0000, v52
    v_lshlrev_b32 v154, 16, v53
    v_and_b32 v155, 0xffff0000, v53
    v_lshlrev_b32 v156, 16, v54
    v_and_b32 v157, 0xffff0000, v54
    v_lshlrev_b32 v158, 16, v55
    v_and_b32 v159, 0xffff0000, v55
    v_pk_fma_f32 v[144:145], v[88:89], v[120:121], v[120:121] op_sel:[0,1,0] op_sel_hi:[1,1,0]
    v_pk_fma_f32 v[146:147], v[90:91], v[120:121], v[120:121] op_sel:[0,1,0] op_sel_hi:[1,1,0]
    v_pk_fma_f32 v[148:149], v[92:93], v[120:121], v[120:121] op_sel:[0,1,0] op_sel_hi:[1,1,0]
    v_pk_fma_f32 v[150:151], v[94:95], v[120:121], v[120:121] op_sel:[0,1,0] op_sel_hi:[1,1,0]
    v_pk_fma_f32 v[144:145], v[144:145], v[96:97], v[104:105]
    v_pk_fma_f32 v[146:147], v[146:147], v[98:99], v[106:107]
    v_pk_fma_f32 v[148:149], v[148:149], v[100:101], v[108:109]
    v_pk_fma_f32 v[150:151], v[150:151], v[102:103], v[110:111]
    v_pk_mul_f32 v[144:145], v[144:145], v[152:153]
    v_pk_mul_f32 v[146:147], v[146:147], v[154:155]
    v_pk_mul_f32 v[148:149], v[148:149], v[156:157]
    v_pk_mul_f32 v[150:151], v[150:151], v[158:159]
    v_pk_fma_f32 v[88:89], v[112:113], v[144:145], v[88:89]
    v_pk_fma_f32 v[90:91], v[114:115], v[146:147], v[90:91]
    v_pk_fma_f32 v[92:93], v[116:117], v[148:149], v[92:93]
    v_pk_fma_f32 v[94:95], v[118:119], v[150:151], v[94:95]
    v_cvt_pk_bf16_f32 v32, v88, v89
    v_cvt_pk_bf16_f32 v33, v90, v91
    v_cvt_pk_bf16_f32 v34, v92, v93
    v_cvt_pk_bf16_f32 v35, v94, v95
    v_dot2_f32_bf16 v124, v32, v126, v124
    v_dot2_f32_bf16 v125, v32, v32, v125
    v_dot2_f32_bf16 v124, v33, v126, v124
    v_dot2_f32_bf16 v125, v33, v33, v125
    v_dot2_f32_bf16 v124, v34, v126, v124
    v_dot2_f32_bf16 v125, v34, v34, v125
    v_dot2_f32_bf16 v124, v35, v126, v124
    v_dot2_f32_bf16 v125, v35, v35, v125
    v_and_b32 v191, 31, v1
    v_lshlrev_b32 v191, 2, v191
    s_add_u32 s41, s37, 7424
    buffer_load_dword v190, v191, s[12:15], s41 offen sc1
    ds_read_b128 v[96:99], v10 offset:10240
    ds_read_b128 v[100:103], v10 offset:10256
    ds_read_b128 v[104:107], v10 offset:7680
    ds_read_b128 v[108:111], v10 offset:7696
    s_nop 1
    s_nop 0
    v_add_f32_dpp v124, v124, v124 quad_perm:[1,0,3,2] row_mask:0xf bank_mask:0xf
    v_add_f32_dpp v125, v125, v125 quad_perm:[1,0,3,2] row_mask:0xf bank_mask:0xf
    s_nop 0
    v_add_f32_dpp v124, v124, v124 quad_perm:[2,3,0,1] row_mask:0xf bank_mask:0xf
    v_add_f32_dpp v125, v125, v125 quad_perm:[2,3,0,1] row_mask:0xf bank_mask:0xf
    s_nop 0
    v_add_f32_dpp v124, v124, v124 row_half_mirror row_mask:0xf bank_mask:0xf
    v_add_f32_dpp v125, v125, v125 row_half_mirror row_mask:0xf bank_mask:0xf
    s_nop 0
    v_add_f32_dpp v124, v124, v124 row_mirror row_mask:0xf bank_mask:0xf
    v_add_f32_dpp v125, v125, v125 row_mirror row_mask:0xf bank_mask:0xf
    v_mul_f32 v124, 0x3acccccd, v124
    v_mul_f32 v125, 0x3acccccd, v125
    v_fma_f32 v125, -v124, v124, v125
    v_max_f32 v125, 0, v125
    v_cvt_pk_bf16_f32 v122, v124, v125
    v_lshlrev_b32 v124, 16, v122
    v_and_b32 v125, 0xffff0000, v122
    v_add_f32 v125, 0x3727c5ac, v125
    v_cvt_pk_bf16_f32 v122, v125, v125
    v_lshlrev_b32 v125, 16, v122
    v_sqrt_f32 v125, v125
    s_nop 0
    v_cvt_pk_bf16_f32 v122, v125, v125
    v_lshlrev_b32 v125, 16, v122
    v_rcp_f32 v125, v125
    s_nop 0
    v_mul_f32 v124, v124, v125
    v_sub_f32 v124, 0, v124
    v_mov_b32 v120, 0
    v_mov_b32 v121, 0
    ds_read_b128 v[160:163], v10 offset:10752
    ds_read_b128 v[164:167], v10 offset:10768
    ds_read_b128 v[168:171], v10 offset:8192
    ds_read_b128 v[172:175], v10 offset:8208
    s_waitcnt lgkmcnt(4)
    v_pk_fma_f32 v[56:57], v[56:57], v[124:125], v[124:125] op_sel:[0,1,0] op_sel_hi:[1,1,0]
    v_pk_fma_f32 v[58:59], v[58:59], v[124:125], v[124:125] op_sel:[0,1,0] op_sel_hi:[1,1,0]
    v_pk_fma_f32 v[60:61], v[60:61], v[124:125], v[124:125] op_sel:[0,1,0] op_sel_hi:[1,1,0]
    v_pk_fma_f32 v[62:63], v[62:63], v[124:125], v[124:125] op_sel:[0,1,0] op_sel_hi:[1,1,0]
    v_pk_fma_f32 v[56:57], v[56:57], v[96:97], v[104:105]
    v_pk_fma_f32 v[58:59], v[58:59], v[98:99], v[106:107]
    v_pk_fma_f32 v[60:61], v[60:61], v[100:101], v[108:109]
    v_pk_fma_f32 v[62:63], v[62:63], v[102:103], v[110:111]
    v_cvt_pk_bf16_f32 v36, v56, v57
    v_cvt_pk_bf16_f32 v37, v58, v59
    v_cvt_pk_bf16_f32 v38, v60, v61
    v_cvt_pk_bf16_f32 v39, v62, v63
    v_dot2_f32_bf16 v120, v36, v126, v120
    v_dot2_f32_bf16 v121, v36, v36, v121
    v_dot2_f32_bf16 v120, v37, v126, v120
    v_dot2_f32_bf16 v121, v37, v37, v121
    v_dot2_f32_bf16 v120, v38, v126, v120
    v_dot2_f32_bf16 v121, v38, v38, v121
    v_dot2_f32_bf16 v120, v39, v126, v120
    v_dot2_f32_bf16 v121, v39, v39, v121
    ds_read_b128 v[96:99], v10 offset:11264
    ds_read_b128 v[100:103], v10 offset:11280
    ds_read_b128 v[104:107], v10 offset:8704
    ds_read_b128 v[108:111], v10 offset:8720
    s_waitcnt lgkmcnt(4)
    v_pk_fma_f32 v[64:65], v[64:65], v[124:125], v[124:125] op_sel:[0,1,0] op_sel_hi:[1,1,0]
    v_pk_fma_f32 v[66:67], v[66:67], v[124:125], v[124:125] op_sel:[0,1,0] op_sel_hi:[1,1,0]
    v_pk_fma_f32 v[68:69], v[68:69], v[124:125], v[124:125] op_sel:[0,1,0] op_sel_hi:[1,1,0]
    v_pk_fma_f32 v[70:71], v[70:71], v[124:125], v[124:125] op_sel:[0,1,0] op_sel_hi:[1,1,0]
    v_pk_fma_f32 v[64:65], v[64:65], v[160:161], v[168:169]
    v_pk_fma_f32 v[66:67], v[66:67], v[162:163], v[170:171]
    v_pk_fma_f32 v[68:69], v[68:69], v[164:165], v[172:173]
    v_pk_fma_f32 v[70:71], v[70:71], v[166:167], v[174:175]
    v_cvt_pk_bf16_f32 v40, v64, v65
    v_cvt_pk_bf16_f32 v41, v66, v67
    v_cvt_pk_bf16_f32 v42, v68, v69
    v_cvt_pk_bf16_f32 v43, v70, v71
    v_dot2_f32_bf16 v120, v40, v126, v120
    v_dot2_f32_bf16 v121, v40, v40, v121
    v_dot2_f32_bf16 v120, v41, v126, v120
    v_dot2_f32_bf16 v121, v41, v41, v121
    v_dot2_f32_bf16 v120, v42, v126, v120
    v_dot2_f32_bf16 v121, v42, v42, v121
    v_dot2_f32_bf16 v120, v43, v126, v120
    v_dot2_f32_bf16 v121, v43, v43, v121
    ds_read_b128 v[160:163], v10 offset:11776
    ds_read_b128 v[164:167], v10 offset:11792
    ds_read_b128 v[168:171], v10 offset:9216
    ds_read_b128 v[172:175], v10 offset:9232
    s_waitcnt lgkmcnt(4)
    v_pk_fma_f32 v[72:73], v[72:73], v[124:125], v[124:125] op_sel:[0,1,0] op_sel_hi:[1,1,0]
    v_pk_fma_f32 v[74:75], v[74:75], v[124:125], v[124:125] op_sel:[0,1,0] op_sel_hi:[1,1,0]
    v_pk_fma_f32 v[76:77], v[76:77], v[124:125], v[124:125] op_sel:[0,1,0] op_sel_hi:[1,1,0]
    v_pk_fma_f32 v[78:79], v[78:79], v[124:125], v[124:125] op_sel:[0,1,0] op_sel_hi:[1,1,0]
    v_pk_fma_f32 v[72:73], v[72:73], v[96:97], v[104:105]
    v_pk_fma_f32 v[74:75], v[74:75], v[98:99], v[106:107]
    v_pk_fma_f32 v[76:77], v[76:77], v[100:101], v[108:109]
    v_pk_fma_f32 v[78:79], v[78:79], v[102:103], v[110:111]
    v_cvt_pk_bf16_f32 v44, v72, v73
    v_cvt_pk_bf16_f32 v45, v74, v75
    v_cvt_pk_bf16_f32 v46, v76, v77
    v_cvt_pk_bf16_f32 v47, v78, v79
    v_dot2_f32_bf16 v120, v44, v126, v120
    v_dot2_f32_bf16 v121, v44, v44, v121
    v_dot2_f32_bf16 v120, v45, v126, v120
    v_dot2_f32_bf16 v121, v45, v45, v121
    v_dot2_f32_bf16 v120, v46, v126, v120
    v_dot2_f32_bf16 v121, v46, v46, v121
    v_dot2_f32_bf16 v120, v47, v126, v120
    v_dot2_f32_bf16 v121, v47, v47, v121
    ds_read_b128 v[96:99], v10 offset:12288
    ds_read_b128 v[100:103], v10 offset:12304
    ds_read_b128 v[104:107], v10 offset:9728
    ds_read_b128 v[108:111], v10 offset:9744
    s_waitcnt lgkmcnt(4)
    v_pk_fma_f32 v[80:81], v[80:81], v[124:125], v[124:125] op_sel:[0,1,0] op_sel_hi:[1,1,0]
    v_pk_fma_f32 v[82:83], v[82:83], v[124:125], v[124:125] op_sel:[0,1,0] op_sel_hi:[1,1,0]
    v_pk_fma_f32 v[84:85], v[84:85], v[124:125], v[124:125] op_sel:[0,1,0] op_sel_hi:[1,1,0]
    v_pk_fma_f32 v[86:87], v[86:87], v[124:125], v[124:125] op_sel:[0,1,0] op_sel_hi:[1,1,0]
    v_pk_fma_f32 v[80:81], v[80:81], v[160:161], v[168:169]
    v_pk_fma_f32 v[82:83], v[82:83], v[162:163], v[170:171]
    v_pk_fma_f32 v[84:85], v[84:85], v[164:165], v[172:173]
    v_pk_fma_f32 v[86:87], v[86:87], v[166:167], v[174:175]
    v_cvt_pk_bf16_f32 v48, v80, v81
    v_cvt_pk_bf16_f32 v49, v82, v83
    v_cvt_pk_bf16_f32 v50, v84, v85
    v_cvt_pk_bf16_f32 v51, v86, v87
    v_dot2_f32_bf16 v120, v48, v126, v120
    v_dot2_f32_bf16 v121, v48, v48, v121
    v_dot2_f32_bf16 v120, v49, v126, v120
    v_dot2_f32_bf16 v121, v49, v49, v121
    v_dot2_f32_bf16 v120, v50, v126, v120
    v_dot2_f32_bf16 v121, v50, v50, v121
    v_dot2_f32_bf16 v120, v51, v126, v120
    v_dot2_f32_bf16 v121, v51, v51, v121
    s_waitcnt lgkmcnt(0)
    v_pk_fma_f32 v[88:89], v[88:89], v[124:125], v[124:125] op_sel:[0,1,0] op_sel_hi:[1,1,0]
    v_pk_fma_f32 v[90:91], v[90:91], v[124:125], v[124:125] op_sel:[0,1,0] op_sel_hi:[1,1,0]
    v_pk_fma_f32 v[92:93], v[92:93], v[124:125], v[124:125] op_sel:[0,1,0] op_sel_hi:[1,1,0]
    v_pk_fma_f32 v[94:95], v[94:95], v[124:125], v[124:125] op_sel:[0,1,0] op_sel_hi:[1,1,0]
    v_pk_fma_f32 v[88:89], v[88:89], v[96:97], v[104:105]
    v_pk_fma_f32 v[90:91], v[90:91], v[98:99], v[106:107]
    v_pk_fma_f32 v[92:93], v[92:93], v[100:101], v[108:109]
    v_pk_fma_f32 v[94:95], v[94:95], v[102:103], v[110:111]
    v_cvt_pk_bf16_f32 v52, v88, v89
    v_cvt_pk_bf16_f32 v53, v90, v91
    v_cvt_pk_bf16_f32 v54, v92, v93
    v_cvt_pk_bf16_f32 v55, v94, v95
    v_dot2_f32_bf16 v120, v52, v126, v120
    v_dot2_f32_bf16 v121, v52, v52, v121
    v_dot2_f32_bf16 v120, v53, v126, v120
    v_dot2_f32_bf16 v121, v53, v53, v121
    v_dot2_f32_bf16 v120, v54, v126, v120
    v_dot2_f32_bf16 v121, v54, v54, v121
    v_dot2_f32_bf16 v120, v55, v126, v120
    v_dot2_f32_bf16 v121, v55, v55, v121
    s_nop 1
    s_nop 0
    v_add_f32_dpp v120, v120, v120 quad_perm:[1,0,3,2] row_mask:0xf bank_mask:0xf
    v_add_f32_dpp v121, v121, v121 quad_perm:[1,0,3,2] row_mask:0xf bank_mask:0xf
    s_nop 0
    v_add_f32_dpp v120, v120, v120 quad_perm:[2,3,0,1] row_mask:0xf bank_mask:0xf
    v_add_f32_dpp v121, v121, v121 quad_perm:[2,3,0,1] row_mask:0xf bank_mask:0xf
    s_nop 0
    v_add_f32_dpp v120, v120, v120 row_half_mirror row_mask:0xf bank_mask:0xf
    v_add_f32_dpp v121, v121, v121 row_half_mirror row_mask:0xf bank_mask:0xf
    s_nop 0
    v_add_f32_dpp v120, v120, v120 row_mirror row_mask:0xf bank_mask:0xf
    v_add_f32_dpp v121, v121, v121 row_mirror row_mask:0xf bank_mask:0xf
    v_mul_f32 v120, 0x3acccccd, v120
    v_mul_f32 v121, 0x3acccccd, v121
    v_fma_f32 v121, -v120, v120, v121
    v_max_f32 v121, 0, v121
    v_cvt_pk_bf16_f32 v122, v120, v121
    v_lshlrev_b32 v120, 16, v122
    v_and_b32 v121, 0xffff0000, v122
    v_add_f32 v121, 0x3727c5ac, v121
    v_cvt_pk_bf16_f32 v122, v121, v121
    v_lshlrev_b32 v121, 16, v122
    v_sqrt_f32 v121, v121
    s_nop 0
    v_cvt_pk_bf16_f32 v122, v121, v121
    v_lshlrev_b32 v121, 16, v122
    v_rcp_f32 v121, v121
    s_nop 0
    v_mul_f32 v120, v120, v121
    v_sub_f32 v120, 0, v120
    v_cndmask_b32 v120, 0, v120, s[50:51]
    v_cndmask_b32 v121, 0, v121, s[50:51]
    s_mul_i32 s46, s29, 20480
    s_add_u32 s46, s46, s36
    s_add_u32 s47, s46, 348160
    s_lshl_b32 s48, s29, 7
    s_add_u32 s48, s48, s36
    s_add_u32 s48, s48, 1597440
    v_lshlrev_b32 v12, 3, v15
    s_lshl_b32 s49, s29, 7
    s_add_u32 s49, s49, s37
    s_lshl_b32 s41, s30, 2
    s_add_u32 s49, s49, s41
    s_waitcnt vmcnt(0)
    s_mov_b32 s43, 200000
k2_kernel_xp7:
    v_cmp_ne_u32 vcc, 0, v190
    s_sub_u32 s43, s43, 1
    s_cmp_eq_u64 vcc, -1
    s_cbranch_scc1 k2_kernel_xd8
    s_cmp_eq_u32 s43, 0
    s_cbranch_scc1 k2_kernel_xd8
    s_add_u32 s41, s37, 7424
    buffer_load_dword v190, v191, s[12:15], s41 offen sc1
    s_waitcnt vmcnt(0)
    s_branch k2_kernel_xp7
k2_kernel_xd8:
    v_cmp_eq_u32 vcc, s42, v190
    s_nop 1
    s_cmp_eq_u64 vcc, -1
    s_cselect_b32 s31, 1, 0
    s_barrier
    v_and_b32 v9, 7, v4
    v_xor_b32 v9, v15, v9
    v_and_b32 v10, 3, v4
    v_lshl_add_u32 v9, v10, 4, v9
    v_lshrrev_b32 v10, 2, v4
    v_lshl_add_u32 v9, v10, 6, v9
    v_lshlrev_b32 v9, 4, v9
    v_add_u32 v9, 114688, v9
    ds_write_b128 v9, v[36:39] offset:0
    ds_write_b128 v9, v[16:19] offset:20480
    ds_write_b128 v9, v[40:43] offset:4096
    ds_write_b128 v9, v[20:23] offset:24576
    ds_write_b128 v9, v[44:47] offset:8192
    ds_write_b128 v9, v[24:27] offset:28672
    ds_write_b128 v9, v[48:51] offset:12288
    ds_write_b128 v9, v[28:31] offset:32768
    ds_write_b128 v9, v[52:55] offset:16384
    ds_write_b128 v9, v[32:35] offset:36864
    v_xor_b32 v9, v4, v3
    v_xor_b32 v10, 4, v9
    v_lshl_add_u32 v9, v3, 4, v9
    v_lshl_add_u32 v10, v3, 4, v10
    s_mul_i32 s41, s30, 5120
    s_add_u32 s41, s41, 114688
    v_lshl_add_u32 v9, v9, 4, s41
    v_lshl_add_u32 v10, v10, 4, s41
    s_cmp_eq_u32 s30, 1
    s_cselect_b32 s41, 1, 0
    s_cmp_eq_u32 s30, 3
    s_cselect_b32 s41, 1, s41
    s_cmp_eq_u32 s41, 1
    v_mov_b32 v11, v9
    s_cbranch_scc0 k2_noswap
    v_mov_b32 v9, v10
    v_mov_b32 v10, v11
k2_noswap:
    s_mul_i32 s41, s30, 5120
    s_add_u32 s46, s46, s41
    s_add_u32 s47, s47, s41
    s_waitcnt lgkmcnt(0)
    s_barrier
    ds_read_b128 v[36:39], v9 offset:0
    ds_read_b128 v[40:43], v10 offset:1024
    ds_read_b128 v[44:47], v9 offset:2048
    ds_read_b128 v[48:51], v10 offset:3072
    ds_read_b128 v[52:55], v9 offset:4096
    ds_read_b128 v[220:223], v9 offset:20480
    ds_read_b128 v[224:227], v10 offset:21504
    ds_read_b128 v[228:231], v9 offset:22528
    ds_read_b128 v[232:235], v10 offset:23552
    ds_read_b128 v[236:239], v9 offset:24576
    s_add_u32 s52, s46, 4096
    s_sub_u32 s41, s29, 1
    s_cmp_lt_u32 s41, 16
    s_cselect_b32 s20, s47, 0x90000000
    s_cmp_eq_u32 s31, 0
    s_cbranch_scc1 k2_kernel_slow9
    s_waitcnt lgkmcnt(9)
    buffer_store_dwordx4 v[36:39], v2, s[12:15], s46 offen offset:0
    s_waitcnt lgkmcnt(8)
    buffer_store_dwordx4 v[40:43], v2, s[12:15], s46 offen offset:1024
    s_waitcnt lgkmcnt(7)
    buffer_store_dwordx4 v[44:47], v2, s[12:15], s46 offen offset:2048
    s_waitcnt lgkmcnt(6)
    buffer_store_dwordx4 v[48:51], v2, s[12:15], s46 offen offset:3072
    s_waitcnt lgkmcnt(5)
    buffer_store_dwordx4 v[52:55], v2, s[12:15], s52 offen offset:0
    v_cmp_eq_u32 vcc, 0, v4
    s_and_saveexec_b64 s[50:51], vcc
    buffer_store_dwordx2 v[120:121], v12, s[12:15], s48 offen
    s_mov_b64 exec, -1
    s_waitcnt vmcnt(0)
    v_mov_b32 v9, 1
    v_mov_b32 v10, 0
    s_mov_b64 exec, 1
    buffer_store_dword v9, v10, s[12:15], s49 offen
    s_mov_b64 exec, -1
    s_branch k2_kernel_sent10
k2_kernel_slow9:
    s_waitcnt lgkmcnt(9)
    buffer_store_dwordx4 v[36:39], v2, s[12:15], s46 offen offset:0 sc1
    s_waitcnt lgkmcnt(8)
    buffer_store_dwordx4 v[40:43], v2, s[12:15], s46 offen offset:1024 sc1
    s_waitcnt lgkmcnt(7)
    buffer_store_dwordx4 v[44:47], v2, s[12:15], s46 offen offset:2048 sc1
    s_waitcnt lgkmcnt(6)
    buffer_store_dwordx4 v[48:51], v2, s[12:15], s46 offen offset:3072 sc1
    s_waitcnt lgkmcnt(5)
    buffer_store_dwordx4 v[52:55], v2, s[12:15], s52 offen offset:0 sc1
    v_cmp_eq_u32 vcc, 0, v4
    s_and_saveexec_b64 s[50:51], vcc
    buffer_store_dwordx2 v[120:121], v12, s[12:15], s48 offen sc1
    s_mov_b64 exec, -1
    s_waitcnt vmcnt(0)
    v_mov_b32 v9, 1
    v_mov_b32 v10, 0
    s_mov_b64 exec, 1
    buffer_store_dword v9, v10, s[12:15], s49 offen sc1
    s_mov_b64 exec, -1
k2_kernel_sent10:
    s_mov_b32 s21, s49
    s_mov_b32 m0, s38
    s_nop 0
    buffer_load_dwordx4 v2, s[12:15], s39 offen offset:0 lds
    s_mov_b32 m0, s38
    s_nop 0
    buffer_load_dwordx4 v2, s[12:15], s39 offen offset:1024 lds
    s_mov_b32 m0, s38
    s_nop 0
    buffer_load_dwordx4 v2, s[12:15], s39 offen offset:2048 lds
    s_mov_b32 m0, s38
    s_nop 0
    buffer_load_dwordx4 v2, s[12:15], s39 offen offset:3072 lds
    s_add_u32 s38, s38, 4096
    s_add_u32 s39, s39, 4096
    s_mov_b32 m0, s38
    s_nop 0
    buffer_load_dwordx4 v2, s[12:15], s39 offen offset:0 lds
    s_mov_b32 m0, s38
    s_nop 0
    buffer_load_dwordx4 v2, s[12:15], s39 offen offset:1024 lds
    s_mov_b32 m0, s38
    s_nop 0
    buffer_load_dwordx4 v2, s[12:15], s39 offen offset:2048 lds
    s_mov_b32 m0, s38
    s_nop 0
    buffer_load_dwordx4 v2, s[12:15], s39 offen offset:3072 lds
    s_add_u32 s38, s38, 4096
    s_add_u32 s39, s39, 4096
    s_mov_b32 m0, s38
    s_nop 0
    buffer_load_dwordx4 v2, s[12:15], s39 offen offset:0 lds
    s_mov_b32 m0, s38
    s_nop 0
    buffer_load_dwordx4 v2, s[12:15], s39 offen offset:1024 lds
    s_mov_b32 m0, s38
    s_nop 0
    buffer_load_dwordx4 v2, s[12:15], s39 offen offset:2048 lds
    s_mov_b32 m0, s38
    s_nop 0
    buffer_load_dwordx4 v2, s[12:15], s39 offen offset:3072 lds
    s_add_u32 s38, s38, 4096
    s_add_u32 s39, s39, 4096
    s_mov_b32 m0, s38
    s_nop 0
    buffer_load_dwordx4 v2, s[12:15], s39 offen offset:0 lds
    s_mov_b32 m0, s38
    s_nop 0
    buffer_load_dwordx4 v2, s[12:15], s39 offen offset:1024 lds
    s_mov_b32 m0, s38
    s_nop 0
    buffer_load_dwordx4 v2, s[12:15], s39 offen offset:2048 lds
    s_mov_b32 m0, s38
    s_nop 0
    buffer_load_dwordx4 v2, s[12:15], s39 offen offset:3072 lds
    s_add_u32 s38, s38, 4096
    s_add_u32 s39, s39, 4096
    s_mov_b32 m0, s38
    s_nop 0
    buffer_load_dwordx4 v2, s[12:15], s39 offen offset:0 lds
    s_branch k2_kernel_join03
k2_kernel_nob02:
    s_mov_b32 s21, 0
    s_mov_b32 s20, 0x90000000
    s_mul_i32 s38, s30, 25600
    s_add_u32 s39, s38, s44
    s_add_u32 s39, s39, 2764800
    v_and_b32 v191, 31, v1
    v_lshlrev_b32 v191, 2, v191
    s_add_u32 s41, s37, 7424
    buffer_load_dword v190, v191, s[12:15], s41 offen sc1
    s_waitcnt vmcnt(0)
    s_mov_b32 s43, 200000
k2_kernel_xp11:
    v_cmp_ne_u32 vcc, 0, v190
    s_sub_u32 s43, s43, 1
    s_cmp_eq_u64 vcc, -1
    s_cbranch_scc1 k2_kernel_xd12
    s_cmp_eq_u32 s43, 0
    s_cbranch_scc1 k2_kernel_xd12
    s_add_u32 s41, s37, 7424
    buffer_load_dword v190, v191, s[12:15], s41 offen sc1
    s_waitcnt vmcnt(0)
    s_branch k2_kernel_xp11
k2_kernel_xd12:
    v_cmp_eq_u32 vcc, s42, v190
    s_nop 1
    s_cmp_eq_u64 vcc, -1
    s_cselect_b32 s31, 1, 0
    s_cmp_eq_u32 s30, 1
    s_cbranch_scc1 k2_kernel_sm13
    s_cmp_ge_u32 s30, 2
    s_cbranch_scc1 k2_kernel_sm14
    s_mul_i32 s41, s33, 320
    s_add_u32 s41, s41, 2748416
    s_mov_b32 m0, 155648
    s_mov_b64 exec, 0xfffff
    buffer_load_dwordx4 v2, s[12:15], s41 offen lds
    s_add_u32 s41, s41, 7168
    s_mov_b32 m0, 156160
    s_nop 0
    buffer_load_dwordx4 v2, s[12:15], s41 offen lds
    s_branch k2_kernel_sm15
k2_kernel_sm13:
    s_mul_i32 s41, s35, 448
    s_add_u32 s41, s41, 2732032
    s_mov_b32 m0, 156672
    s_mov_b64 exec, 0xfffffff
    buffer_load_dwordx4 v2, s[12:15], s41 offen lds
    s_add_u32 s41, s41, 7168
    s_mov_b32 m0, 157184
    s_nop 0
    buffer_load_dwordx4 v2, s[12:15], s41 offen lds
    s_branch k2_kernel_sm15
k2_kernel_sm14:
    s_mul_i32 s41, s33, 320
    s_add_u32 s41, s41, 2724352
    s_mov_b32 m0, 157696
    s_mov_b64 exec, 0xfffff
    buffer_load_dwordx4 v2, s[12:15], s41 offen lds
k2_kernel_sm15:
    s_mov_b64 exec, -1
    s_mov_b32 m0, s38
    s_nop 0
    buffer_load_dwordx4 v2, s[12:15], s39 offen offset:0 lds
    s_mov_b32 m0, s38
    s_nop 0
    buffer_load_dwordx4 v2, s[12:15], s39 offen offset:1024 lds
    s_mov_b32 m0, s38
    s_nop 0
    buffer_load_dwordx4 v2, s[12:15], s39 offen offset:2048 lds
    s_mov_b32 m0, s38
    s_nop 0
    buffer_load_dwordx4 v2, s[12:15], s39 offen offset:3072 lds
    s_add_u32 s38, s38, 4096
    s_add_u32 s39, s39, 4096
    s_mov_b32 m0, s38
    s_nop 0
    buffer_load_dwordx4 v2, s[12:15], s39 offen offset:0 lds
    s_mov_b32 m0, s38
    s_nop 0
    buffer_load_dwordx4 v2, s[12:15], s39 offen offset:1024 lds
    s_mov_b32 m0, s38
    s_nop 0
    buffer_load_dwordx4 v2, s[12:15], s39 offen offset:2048 lds
    s_mov_b32 m0, s38
    s_nop 0
    buffer_load_dwordx4 v2, s[12:15], s39 offen offset:3072 lds
    s_add_u32 s38, s38, 4096
    s_add_u32 s39, s39, 4096
    s_mov_b32 m0, s38
    s_nop 0
    buffer_load_dwordx4 v2, s[12:15], s39 offen offset:0 lds
    s_mov_b32 m0, s38
    s_nop 0
    buffer_load_dwordx4 v2, s[12:15], s39 offen offset:1024 lds
    s_mov_b32 m0, s38
    s_nop 0
    buffer_load_dwordx4 v2, s[12:15], s39 offen offset:2048 lds
    s_mov_b32 m0, s38
    s_nop 0
    buffer_load_dwordx4 v2, s[12:15], s39 offen offset:3072 lds
    s_add_u32 s38, s38, 4096
    s_add_u32 s39, s39, 4096
    s_mov_b32 m0, s38
    s_nop 0
    buffer_load_dwordx4 v2, s[12:15], s39 offen offset:0 lds
    s_mov_b32 m0, s38
    s_nop 0
    buffer_load_dwordx4 v2, s[12:15], s39 offen offset:1024 lds
    s_mov_b32 m0, s38
    s_nop 0
    buffer_load_dwordx4 v2, s[12:15], s39 offen offset:2048 lds
    s_mov_b32 m0, s38
    s_nop 0
    buffer_load_dwordx4 v2, s[12:15], s39 offen offset:3072 lds
    s_add_u32 s38, s38, 4096
    s_add_u32 s39, s39, 4096
    s_mov_b32 m0, s38
    s_nop 0
    buffer_load_dwordx4 v2, s[12:15], s39 offen offset:0 lds
    s_mov_b32 m0, s38
    s_nop 0
    buffer_load_dwordx4 v2, s[12:15], s39 offen offset:1024 lds
    s_mov_b32 m0, s38
    s_nop 0
    buffer_load_dwordx4 v2, s[12:15], s39 offen offset:2048 lds
    s_mov_b32 m0, s38
    s_nop 0
    buffer_load_dwordx4 v2, s[12:15], s39 offen offset:3072 lds
    s_add_u32 s38, s38, 4096
    s_add_u32 s39, s39, 4096
    s_mov_b32 m0, s38
    s_nop 0
    buffer_load_dwordx4 v2, s[12:15], s39 offen offset:0 lds
    s_mov_b32 m0, s38
    s_nop 0
    buffer_load_dwordx4 v2, s[12:15], s39 offen offset:1024 lds
    s_mov_b32 m0, s38
    s_nop 0
    buffer_load_dwordx4 v2, s[12:15], s39 offen offset:2048 lds
    s_mov_b32 m0, s38
    s_nop 0
    buffer_load_dwordx4 v2, s[12:15], s39 offen offset:3072 lds
    s_add_u32 s38, s38, 4096
    s_add_u32 s39, s39, 4096
    s_mov_b32 m0, s38
    s_nop 0
    buffer_load_dwordx4 v2, s[12:15], s39 offen offset:0 lds
    s_cmp_eq_u32 s31, 0
    s_cbranch_scc1 k2_kernel_nt16
    s_sub_u32 s47, s29, 18
    s_lshl_b32 s47, s47, 2
    s_add_u32 s47, s47, s30
    s_mul_i32 s48, s47, 6144
    s_min_u32 s48, s48, 321536
    s_mul_i32 s49, s28, 327680
    s_add_u32 s48, s48, s49
    s_add_u32 s48, s48, 0
    buffer_load_dwordx4 v[64:67], v2, s[12:15], s48 offen offset:0
    buffer_load_dwordx4 v[68:71], v2, s[12:15], s48 offen offset:1024
    buffer_load_dwordx4 v[72:75], v2, s[12:15], s48 offen offset:2048
    buffer_load_dwordx4 v[76:79], v2, s[12:15], s48 offen offset:3072
    s_add_u32 s48, s48, 4096
    buffer_load_dwordx4 v[80:83], v2, s[12:15], s48 offen offset:0
    buffer_load_dwordx4 v[84:87], v2, s[12:15], s48 offen offset:1024
    s_mul_i32 s48, s47, 384
    s_min_u32 s48, s48, 20096
    s_add_u32 s48, s48, s36
    s_add_u32 s48, s48, 1581056
    s_mov_b64 exec, 7
    buffer_load_dword v100, v5, s[12:15], s48 offen
    s_mov_b64 exec, -1
k2_kernel_nt16:
k2_kernel_join03:
    s_lshl_b32 s46, s32, 2
    s_add_u32 s46, s46, s30
    s_lshr_b32 s47, s33, 1
    s_and_b32 s48, s47, 1
    s_lshr_b32 s47, s47, 1
    s_add_u32 s47, s47, 1
    s_sub_u32 s49, 0, s47
    s_cmp_eq_u32 s48, 1
    s_cselect_b32 s47, s47, s49
    s_lshl_b32 s49, s46, 4
    s_add_u32 s49, s49, 16
    s_add_u32 s49, s49, s47
    v_add_u32 v9, s49, v4
    v_lshrrev_b32 v10, 4, v9
    v_mul_u32_u24 v6, 20480, v10
    v_and_b32 v10, 15, v9
    v_lshl_add_u32 v10, v3, 4, v10
    v_lshl_add_u32 v6, v10, 4, v6
    v_lshlrev_b32 v13, 3, v9
    s_add_u32 s49, s46, s48
    s_lshl_b32 s49, s49, 7
    s_add_u32 s49, s49, s37
    v_bfe_u32 v7, v1, 2, 1
    v_lshlrev_b32 v7, 7, v7
    v_and_b32 v9, 3, v1
    v_lshl_add_u32 v7, v9, 2, v7
    s_mov_b32 s43, 200000
k2_kernel_poll17:
    buffer_load_dword v9, v7, s[12:15], s49 offen sc1
    s_waitcnt vmcnt(0)
    v_cmp_ne_u32 vcc, 0, v9
    s_sub_u32 s43, s43, 1
    s_cmp_eq_u64 vcc, -1
    s_cbranch_scc1 k2_kernel_go18
    s_cmp_lg_u32 s43, 0
    s_cbranch_scc1 k2_kernel_poll17
k2_kernel_go18:
    s_add_u32 s41, s36, 0
    buffer_load_dwordx4 v[16:19], v6, s[12:15], s41 offen offset:0 sc1
    s_add_u32 s41, s36, 0
    buffer_load_dwordx4 v[20:23], v6, s[12:15], s41 offen offset:1024 sc1
    s_add_u32 s41, s36, 0
    buffer_load_dwordx4 v[24:27], v6, s[12:15], s41 offen offset:2048 sc1
    s_add_u32 s41, s36, 0
    buffer_load_dwordx4 v[28:31], v6, s[12:15], s41 offen offset:3072 sc1
    s_add_u32 s41, s36, 1597440
    buffer_load_dwordx2 v[176:177], v13, s[12:15], s41 offen sc1
    v_mov_b32 v14, v2
    v_add_u32 v15, 0x10000, v2
    v_add_u32 v11, 0x20000, v2
    s_barrier
    s_mul_i32 s38, s30, 13312
    s_add_u32 s39, s38, s44
    s_add_u32 s39, s39, 3584000
    s_add_u32 s38, s38, 102400
    ds_read_b128 v[96:99], v14 offset:0
    ds_read_b128 v[100:103], v14 offset:1024
    ds_read_b128 v[104:107], v14 offset:2048
    ds_read_b128 v[108:111], v14 offset:3072
    ds_read_b128 v[112:115], v14 offset:4096
    ds_read_b128 v[116:119], v14 offset:5120
    ds_read_b128 v[120:123], v14 offset:6144
    ds_read_b128 v[124:127], v14 offset:7168
    ds_read_b128 v[128:131], v14 offset:8192
    ds_read_b128 v[132:135], v14 offset:9216
    s_waitcnt vmcnt(4)
    s_waitcnt lgkmcnt(5)
    v_mfma_f32_16x16x32_bf16 v[156:159], v[96:99], v[16:19], 0
    s_add_u32 s41, s36, 4096
    buffer_load_dwordx4 v[32:35], v6, s[12:15], s41 offen offset:0 sc1
    v_mfma_f32_16x16x32_bf16 v[160:163], v[100:103], v[16:19], 0
    ds_read_b128 v[136:139], v14 offset:10240
    v_mfma_f32_16x16x32_bf16 v[164:167], v[104:107], v[16:19], 0
    ds_read_b128 v[140:143], v14 offset:11264
    v_mfma_f32_16x16x32_bf16 v[168:171], v[108:111], v[16:19], 0
    ds_read_b128 v[144:147], v14 offset:12288
    s_add_u32 s41, s36, 4096
    buffer_load_dwordx4 v[36:39], v6, s[12:15], s41 offen offset:1024 sc1
    v_mfma_f32_16x16x32_bf16 v[172:175], v[112:115], v[16:19], 0
    ds_read_b128 v[148:151], v14 offset:13312
    ds_read_b128 v[152:155], v14 offset:14336
    s_waitcnt vmcnt(5)
    s_waitcnt lgkmcnt(5)
    v_mfma_f32_16x16x32_bf16 v[156:159], v[116:119], v[20:23], v[156:159]
    s_add_u32 s41, s36, 4096
    buffer_load_dwordx4 v[40:43], v6, s[12:15], s41 offen offset:2048 sc1
    v_mfma_f32_16x16x32_bf16 v[160:163], v[120:123], v[20:23], v[160:163]
    ds_read_b128 v[96:99], v14 offset:15360
    v_mfma_f32_16x16x32_bf16 v[164:167], v[124:127], v[20:23], v[164:167]
    ds_read_b128 v[100:103], v14 offset:16384
    v_mfma_f32_16x16x32_bf16 v[168:171], v[128:131], v[20:23], v[168:171]
    ds_read_b128 v[104:107], v14 offset:17408
    s_add_u32 s41, s36, 4096
    buffer_load_dwordx4 v[44:47], v6, s[12:15], s41 offen offset:3072 sc1
    v_mfma_f32_16x16x32_bf16 v[172:175], v[132:135], v[20:23], v[172:175]
    ds_read_b128 v[108:111], v14 offset:18432
    ds_read_b128 v[112:115], v14 offset:19456
    s_waitcnt vmcnt(6)
    s_waitcnt lgkmcnt(5)
    v_mfma_f32_16x16x32_bf16 v[156:159], v[136:139], v[24:27], v[156:159]
    s_add_u32 s41, s36, 8192
    buffer_load_dwordx4 v[48:51], v6, s[12:15], s41 offen offset:0 sc1
    v_mfma_f32_16x16x32_bf16 v[160:163], v[140:143], v[24:27], v[160:163]
    ds_read_b128 v[116:119], v14 offset:20480
    v_mfma_f32_16x16x32_bf16 v[164:167], v[144:147], v[24:27], v[164:167]
    ds_read_b128 v[120:123], v14 offset:21504
    v_mfma_f32_16x16x32_bf16 v[168:171], v[148:151], v[24:27], v[168:171]
    ds_read_b128 v[124:127], v14 offset:22528
    s_add_u32 s41, s36, 8192
    buffer_load_dwordx4 v[52:55], v6, s[12:15], s41 offen offset:1024 sc1
    v_mfma_f32_16x16x32_bf16 v[172:175], v[152:155], v[24:27], v[172:175]
    ds_read_b128 v[128:131], v14 offset:23552
    ds_read_b128 v[132:135], v14 offset:24576
    s_waitcnt vmcnt(7)
    s_waitcnt lgkmcnt(5)
    v_mfma_f32_16x16x32_bf16 v[156:159], v[96:99], v[28:31], v[156:159]
    s_add_u32 s41, s36, 8192
    buffer_load_dwordx4 v[56:59], v6, s[12:15], s41 offen offset:2048 sc1
    v_mfma_f32_16x16x32_bf16 v[160:163], v[100:103], v[28:31], v[160:163]
    ds_read_b128 v[136:139], v14 offset:25600
    v_mfma_f32_16x16x32_bf16 v[164:167], v[104:107], v[28:31], v[164:167]
    ds_read_b128 v[140:143], v14 offset:26624
    v_mfma_f32_16x16x32_bf16 v[168:171], v[108:111], v[28:31], v[168:171]
    ds_read_b128 v[144:147], v14 offset:27648
    s_add_u32 s41, s36, 8192
    buffer_load_dwordx4 v[60:63], v6, s[12:15], s41 offen offset:3072 sc1
    v_mfma_f32_16x16x32_bf16 v[172:175], v[112:115], v[28:31], v[172:175]
    ds_read_b128 v[148:151], v14 offset:28672
    ds_read_b128 v[152:155], v14 offset:29696
    s_waitcnt vmcnt(7)
    s_waitcnt lgkmcnt(5)
    v_mfma_f32_16x16x32_bf16 v[156:159], v[116:119], v[32:35], v[156:159]
    s_add_u32 s41, s36, 12288
    buffer_load_dwordx4 v[64:67], v6, s[12:15], s41 offen offset:0 sc1
    v_mfma_f32_16x16x32_bf16 v[160:163], v[120:123], v[32:35], v[160:163]
    ds_read_b128 v[96:99], v14 offset:30720
    v_mfma_f32_16x16x32_bf16 v[164:167], v[124:127], v[32:35], v[164:167]
    ds_read_b128 v[100:103], v14 offset:31744
    v_mfma_f32_16x16x32_bf16 v[168:171], v[128:131], v[32:35], v[168:171]
    ds_read_b128 v[104:107], v14 offset:32768
    s_add_u32 s41, s36, 12288
    buffer_load_dwordx4 v[68:71], v6, s[12:15], s41 offen offset:1024 sc1
    v_mfma_f32_16x16x32_bf16 v[172:175], v[132:135], v[32:35], v[172:175]
    ds_read_b128 v[108:111], v14 offset:33792
    ds_read_b128 v[112:115], v14 offset:34816
    s_waitcnt vmcnt(8)
    s_waitcnt lgkmcnt(5)
    v_mfma_f32_16x16x32_bf16 v[156:159], v[136:139], v[36:39], v[156:159]
    s_add_u32 s41, s36, 12288
    buffer_load_dwordx4 v[72:75], v6, s[12:15], s41 offen offset:2048 sc1
    v_mfma_f32_16x16x32_bf16 v[160:163], v[140:143], v[36:39], v[160:163]
    ds_read_b128 v[116:119], v14 offset:35840
    v_mfma_f32_16x16x32_bf16 v[164:167], v[144:147], v[36:39], v[164:167]
    ds_read_b128 v[120:123], v14 offset:36864
    v_mfma_f32_16x16x32_bf16 v[168:171], v[148:151], v[36:39], v[168:171]
    ds_read_b128 v[124:127], v14 offset:37888
    s_add_u32 s41, s36, 12288
    buffer_load_dwordx4 v[76:79], v6, s[12:15], s41 offen offset:3072 sc1
    v_mfma_f32_16x16x32_bf16 v[172:175], v[152:155], v[36:39], v[172:175]
    ds_read_b128 v[128:131], v14 offset:38912
    ds_read_b128 v[132:135], v14 offset:39936
    s_waitcnt vmcnt(9)
    s_waitcnt lgkmcnt(5)
    v_mfma_f32_16x16x32_bf16 v[156:159], v[96:99], v[40:43], v[156:159]
    s_add_u32 s41, s36, 16384
    buffer_load_dwordx4 v[80:83], v6, s[12:15], s41 offen offset:0 sc1
    v_mfma_f32_16x16x32_bf16 v[160:163], v[100:103], v[40:43], v[160:163]
    ds_read_b128 v[136:139], v14 offset:40960
    v_mfma_f32_16x16x32_bf16 v[164:167], v[104:107], v[40:43], v[164:167]
    ds_read_b128 v[140:143], v14 offset:41984
    v_mfma_f32_16x16x32_bf16 v[168:171], v[108:111], v[40:43], v[168:171]
    ds_read_b128 v[144:147], v14 offset:43008
    s_add_u32 s41, s36, 16384
    buffer_load_dwordx4 v[84:87], v6, s[12:15], s41 offen offset:1024 sc1
    v_mfma_f32_16x16x32_bf16 v[172:175], v[112:115], v[40:43], v[172:175]
    ds_read_b128 v[148:151], v14 offset:44032
    ds_read_b128 v[152:155], v14 offset:45056
    s_waitcnt vmcnt(10)
    s_waitcnt lgkmcnt(5)
    v_mfma_f32_16x16x32_bf16 v[156:159], v[116:119], v[44:47], v[156:159]
    s_add_u32 s41, s36, 16384
    buffer_load_dwordx4 v[88:91], v6, s[12:15], s41 offen offset:2048 sc1
    v_mfma_f32_16x16x32_bf16 v[160:163], v[120:123], v[44:47], v[160:163]
    ds_read_b128 v[96:99], v14 offset:46080
    v_mfma_f32_16x16x32_bf16 v[164:167], v[124:127], v[44:47], v[164:167]
    ds_read_b128 v[100:103], v14 offset:47104
    v_mfma_f32_16x16x32_bf16 v[168:171], v[128:131], v[44:47], v[168:171]
    ds_read_b128 v[104:107], v14 offset:48128
    s_add_u32 s41, s36, 16384
    buffer_load_dwordx4 v[92:95], v6, s[12:15], s41 offen offset:3072 sc1
    v_mfma_f32_16x16x32_bf16 v[172:175], v[132:135], v[44:47], v[172:175]
    ds_read_b128 v[108:111], v14 offset:49152
    ds_read_b128 v[112:115], v14 offset:50176
    s_waitcnt vmcnt(11)
    s_waitcnt lgkmcnt(5)
    v_mfma_f32_16x16x32_bf16 v[156:159], v[136:139], v[48:51], v[156:159]
    v_mfma_f32_16x16x32_bf16 v[160:163], v[140:143], v[48:51], v[160:163]
    ds_read_b128 v[116:119], v14 offset:51200
    s_mov_b32 m0, s38
    s_nop 0
    buffer_load_dwordx4 v2, s[12:15], s39 offen offset:0 lds
    v_mfma_f32_16x16x32_bf16 v[164:167], v[144:147], v[48:51], v[164:167]
    ds_read_b128 v[120:123], v14 offset:52224
    v_mfma_f32_16x16x32_bf16 v[168:171], v[148:151], v[48:51], v[168:171]
    ds_read_b128 v[124:127], v14 offset:53248
    v_mfma_f32_16x16x32_bf16 v[172:175], v[152:155], v[48:51], v[172:175]
    ds_read_b128 v[128:131], v14 offset:54272
    ds_read_b128 v[132:135], v14 offset:55296
    s_add_u32 s41, s20, 0
    buffer_store_dwordx4 v[220:223], v2, s[12:15], s41 offen sc1
    s_waitcnt vmcnt(12)
    s_waitcnt lgkmcnt(5)
    s_barrier
    v_mfma_f32_16x16x32_bf16 v[156:159], v[96:99], v[52:55], v[156:159]
    v_mfma_f32_16x16x32_bf16 v[160:163], v[100:103], v[52:55], v[160:163]
    ds_read_b128 v[136:139], v14 offset:56320
    s_mov_b32 m0, s38
    s_nop 0
    buffer_load_dwordx4 v2, s[12:15], s39 offen offset:1024 lds
    v_mfma_f32_16x16x32_bf16 v[164:167], v[104:107], v[52:55], v[164:167]
    ds_read_b128 v[140:143], v14 offset:57344
    v_mfma_f32_16x16x32_bf16 v[168:171], v[108:111], v[52:55], v[168:171]
    ds_read_b128 v[144:147], v14 offset:58368
    v_mfma_f32_16x16x32_bf16 v[172:175], v[112:115], v[52:55], v[172:175]
    ds_read_b128 v[148:151], v14 offset:59392
    ds_read_b128 v[152:155], v14 offset:60416
    s_add_u32 s41, s20, 1024
    buffer_store_dwordx4 v[224:227], v2, s[12:15], s41 offen sc1
    s_waitcnt vmcnt(13)
    s_waitcnt lgkmcnt(5)
    v_mfma_f32_16x16x32_bf16 v[156:159], v[116:119], v[56:59], v[156:159]
    v_mfma_f32_16x16x32_bf16 v[160:163], v[120:123], v[56:59], v[160:163]
    ds_read_b128 v[96:99], v14 offset:61440
    s_mov_b32 m0, s38
    s_nop 0
    buffer_load_dwordx4 v2, s[12:15], s39 offen offset:2048 lds
    v_mfma_f32_16x16x32_bf16 v[164:167], v[124:127], v[56:59], v[164:167]
    ds_read_b128 v[100:103], v14 offset:62464
    v_mfma_f32_16x16x32_bf16 v[168:171], v[128:131], v[56:59], v[168:171]
    ds_read_b128 v[104:107], v14 offset:63488
    v_mfma_f32_16x16x32_bf16 v[172:175], v[132:135], v[56:59], v[172:175]
    ds_read_b128 v[108:111], v14 offset:64512
    ds_read_b128 v[112:115], v15 offset:0
    s_add_u32 s41, s20, 2048
    buffer_store_dwordx4 v[228:231], v2, s[12:15], s41 offen sc1
    s_waitcnt vmcnt(14)
    s_waitcnt lgkmcnt(5)
    v_mfma_f32_16x16x32_bf16 v[156:159], v[136:139], v[60:63], v[156:159]
    v_mfma_f32_16x16x32_bf16 v[160:163], v[140:143], v[60:63], v[160:163]
    ds_read_b128 v[116:119], v15 offset:1024
    s_mov_b32 m0, s38
    s_nop 0
    buffer_load_dwordx4 v2, s[12:15], s39 offen offset:3072 lds
    s_add_u32 s38, s38, 4096
    s_add_u32 s39, s39, 4096
    v_mfma_f32_16x16x32_bf16 v[164:167], v[144:147], v[60:63], v[164:167]
    ds_read_b128 v[120:123], v15 offset:2048
    v_mfma_f32_16x16x32_bf16 v[168:171], v[148:151], v[60:63], v[168:171]
    ds_read_b128 v[124:127], v15 offset:3072
    v_mfma_f32_16x16x32_bf16 v[172:175], v[152:155], v[60:63], v[172:175]
    ds_read_b128 v[128:131], v15 offset:4096
    ds_read_b128 v[132:135], v15 offset:5120
    s_add_u32 s41, s20, 3072
    buffer_store_dwordx4 v[232:235], v2, s[12:15], s41 offen sc1
    s_waitcnt vmcnt(15)
    s_waitcnt lgkmcnt(5)
    v_mfma_f32_16x16x32_bf16 v[156:159], v[96:99], v[64:67], v[156:159]
    v_mfma_f32_16x16x32_bf16 v[160:163], v[100:103], v[64:67], v[160:163]
    ds_read_b128 v[136:139], v15 offset:6144
    s_mov_b32 m0, s38
    s_nop 0
    buffer_load_dwordx4 v2, s[12:15], s39 offen offset:0 lds
    v_mfma_f32_16x16x32_bf16 v[164:167], v[104:107], v[64:67], v[164:167]
    ds_read_b128 v[140:143], v15 offset:7168
    v_mfma_f32_16x16x32_bf16 v[168:171], v[108:111], v[64:67], v[168:171]
    ds_read_b128 v[144:147], v15 offset:8192
    v_mfma_f32_16x16x32_bf16 v[172:175], v[112:115], v[64:67], v[172:175]
    ds_read_b128 v[148:151], v15 offset:9216
    ds_read_b128 v[152:155], v15 offset:10240
    s_add_u32 s41, s20, 4096
    buffer_store_dwordx4 v[236:239], v2, s[12:15], s41 offen sc1
    s_waitcnt vmcnt(16)
    s_waitcnt lgkmcnt(5)
    v_mfma_f32_16x16x32_bf16 v[156:159], v[116:119], v[68:71], v[156:159]
    v_mfma_f32_16x16x32_bf16 v[160:163], v[120:123], v[68:71], v[160:163]
    ds_read_b128 v[96:99], v15 offset:11264
    s_mov_b32 m0, s38
    s_nop 0
    buffer_load_dwordx4 v2, s[12:15], s39 offen offset:1024 lds
    v_mfma_f32_16x16x32_bf16 v[164:167], v[124:127], v[68:71], v[164:167]
    ds_read_b128 v[100:103], v15 offset:12288
    v_mfma_f32_16x16x32_bf16 v[168:171], v[128:131], v[68:71], v[168:171]
    ds_read_b128 v[104:107], v15 offset:13312
    v_mfma_f32_16x16x32_bf16 v[172:175], v[132:135], v[68:71], v[172:175]
    ds_read_b128 v[108:111], v15 offset:14336
    ds_read_b128 v[112:115], v15 offset:15360
    s_mov_b32 m0, s38
    s_nop 0
    buffer_load_dwordx4 v2, s[12:15], s39 offen offset:2048 lds
    s_waitcnt vmcnt(17)
    s_waitcnt lgkmcnt(5)
    v_mfma_f32_16x16x32_bf16 v[156:159], v[136:139], v[72:75], v[156:159]
    v_mfma_f32_16x16x32_bf16 v[160:163], v[140:143], v[72:75], v[160:163]
    ds_read_b128 v[116:119], v15 offset:16384
    s_mov_b32 m0, s38
    s_nop 0
    buffer_load_dwordx4 v2, s[12:15], s39 offen offset:3072 lds
    s_add_u32 s38, s38, 4096
    s_add_u32 s39, s39, 4096
    v_mfma_f32_16x16x32_bf16 v[164:167], v[144:147], v[72:75], v[164:167]
    ds_read_b128 v[120:123], v15 offset:17408
    v_mfma_f32_16x16x32_bf16 v[168:171], v[148:151], v[72:75], v[168:171]
    ds_read_b128 v[124:127], v15 offset:18432
    v_mfma_f32_16x16x32_bf16 v[172:175], v[152:155], v[72:75], v[172:175]
    ds_read_b128 v[128:131], v15 offset:19456
    ds_read_b128 v[132:135], v15 offset:20480
    s_mov_b32 m0, s38
    s_nop 0
    buffer_load_dwordx4 v2, s[12:15], s39 offen offset:0 lds
    s_waitcnt vmcnt(18)
    s_waitcnt lgkmcnt(5)
    v_mfma_f32_16x16x32_bf16 v[156:159], v[96:99], v[76:79], v[156:159]
    v_mfma_f32_16x16x32_bf16 v[160:163], v[100:103], v[76:79], v[160:163]
    ds_read_b128 v[136:139], v15 offset:21504
    s_mov_b32 m0, s38
    s_nop 0
    buffer_load_dwordx4 v2, s[12:15], s39 offen offset:1024 lds
    v_mfma_f32_16x16x32_bf16 v[164:167], v[104:107], v[76:79], v[164:167]
    ds_read_b128 v[140:143], v15 offset:22528
    v_mfma_f32_16x16x32_bf16 v[168:171], v[108:111], v[76:79], v[168:171]
    ds_read_b128 v[144:147], v15 offset:23552
    v_mfma_f32_16x16x32_bf16 v[172:175], v[112:115], v[76:79], v[172:175]
    ds_read_b128 v[148:151], v15 offset:24576
    ds_read_b128 v[152:155], v15 offset:25600
    s_mov_b32 m0, s38
    s_nop 0
    buffer_load_dwordx4 v2, s[12:15], s39 offen offset:2048 lds
    s_waitcnt vmcnt(19)
    s_waitcnt lgkmcnt(5)
    v_mfma_f32_16x16x32_bf16 v[156:159], v[116:119], v[80:83], v[156:159]
    v_mfma_f32_16x16x32_bf16 v[160:163], v[120:123], v[80:83], v[160:163]
    ds_read_b128 v[96:99], v15 offset:26624
    s_mov_b32 m0, s38
    s_nop 0
    buffer_load_dwordx4 v2, s[12:15], s39 offen offset:3072 lds
    s_add_u32 s38, s38, 4096
    s_add_u32 s39, s39, 4096
    v_mfma_f32_16x16x32_bf16 v[164:167], v[124:127], v[80:83], v[164:167]
    ds_read_b128 v[100:103], v15 offset:27648
    v_mfma_f32_16x16x32_bf16 v[168:171], v[128:131], v[80:83], v[168:171]
    ds_read_b128 v[104:107], v15 offset:28672
    v_mfma_f32_16x16x32_bf16 v[172:175], v[132:135], v[80:83], v[172:175]
    ds_read_b128 v[108:111], v15 offset:29696
    ds_read_b128 v[112:115], v15 offset:30720
    s_mov_b32 m0, s38
    s_nop 0
    buffer_load_dwordx4 v2, s[12:15], s39 offen offset:0 lds
    s_waitcnt vmcnt(20)
    s_waitcnt lgkmcnt(5)
    v_mfma_f32_16x16x32_bf16 v[156:159], v[136:139], v[84:87], v[156:159]
    v_mfma_f32_16x16x32_bf16 v[160:163], v[140:143], v[84:87], v[160:163]
    ds_read_b128 v[116:119], v15 offset:31744
    s_mul_i32 s38, s30, 12288
    s_add_u32 s39, s38, s44
    s_add_u32 s39, s39, 3637248
    s_add_u32 s38, s38, 0
    s_mov_b32 m0, s38
    s_nop 0
    buffer_load_dwordx4 v2, s[12:15], s39 offen offset:0 lds
    v_mfma_f32_16x16x32_bf16 v[164:167], v[144:147], v[84:87], v[164:167]
    ds_read_b128 v[120:123], v15 offset:32768
    v_mfma_f32_16x16x32_bf16 v[168:171], v[148:151], v[84:87], v[168:171]
    ds_read_b128 v[124:127], v15 offset:33792
    v_mfma_f32_16x16x32_bf16 v[172:175], v[152:155], v[84:87], v[172:175]
    ds_read_b128 v[128:131], v15 offset:34816
    ds_read_b128 v[132:135], v15 offset:35840
    s_mov_b32 m0, s38
    s_nop 0
    buffer_load_dwordx4 v2, s[12:15], s39 offen offset:1024 lds
    s_waitcnt vmcnt(21)
    s_waitcnt lgkmcnt(5)
    v_mfma_f32_16x16x32_bf16 v[156:159], v[96:99], v[88:91], v[156:159]
    v_mfma_f32_16x16x32_bf16 v[160:163], v[100:103], v[88:91], v[160:163]
    s_mov_b32 m0, s38
    s_nop 0
    buffer_load_dwordx4 v2, s[12:15], s39 offen offset:2048 lds
    v_mfma_f32_16x16x32_bf16 v[164:167], v[104:107], v[88:91], v[164:167]
    v_mfma_f32_16x16x32_bf16 v[168:171], v[108:111], v[88:91], v[168:171]
    v_mfma_f32_16x16x32_bf16 v[172:175], v[112:115], v[88:91], v[172:175]
    s_mov_b32 m0, s38
    s_nop 0
    buffer_load_dwordx4 v2, s[12:15], s39 offen offset:3072 lds
    s_add_u32 s38, s38, 4096
    s_add_u32 s39, s39, 4096
    s_waitcnt vmcnt(22)
    s_waitcnt lgkmcnt(0)
    v_mfma_f32_16x16x32_bf16 v[156:159], v[116:119], v[92:95], v[156:159]
    v_mfma_f32_16x16x32_bf16 v[160:163], v[120:123], v[92:95], v[160:163]
    s_mov_b32 m0, s38
    s_nop 0
    buffer_load_dwordx4 v2, s[12:15], s39 offen offset:0 lds
    v_mfma_f32_16x16x32_bf16 v[164:167], v[124:127], v[92:95], v[164:167]
    v_mfma_f32_16x16x32_bf16 v[168:171], v[128:131], v[92:95], v[168:171]
    v_mfma_f32_16x16x32_bf16 v[172:175], v[132:135], v[92:95], v[172:175]
    s_mov_b32 m0, s38
    s_nop 0
    buffer_load_dwordx4 v2, s[12:15], s39 offen offset:1024 lds
    s_barrier
    s_mov_b32 m0, s38
    s_nop 0
    buffer_load_dwordx4 v2, s[12:15], s39 offen offset:2048 lds
    s_mov_b32 m0, s38
    s_nop 0
    buffer_load_dwordx4 v2, s[12:15], s39 offen offset:3072 lds
    s_add_u32 s38, s38, 4096
    s_add_u32 s39, s39, 4096
    s_mov_b32 m0, s38
    s_nop 0
    buffer_load_dwordx4 v2, s[12:15], s39 offen offset:0 lds
    s_mov_b32 m0, s38
    s_nop 0
    buffer_load_dwordx4 v2, s[12:15], s39 offen offset:1024 lds
    s_mov_b32 m0, s38
    s_nop 0
    buffer_load_dwordx4 v2, s[12:15], s39 offen offset:2048 lds
    s_mov_b32 m0, s38
    s_nop 0
    buffer_load_dwordx4 v2, s[12:15], s39 offen offset:3072 lds
    s_mul_i32 s38, s30, 13312
    s_add_u32 s39, s38, s45
    s_add_u32 s39, s39, 0
    s_add_u32 s38, s38, 49152
    s_mov_b32 m0, s38
    s_nop 0
    buffer_load_dwordx4 v2, s[12:15], s39 offen offset:0 lds
    s_mov_b32 m0, s38
    s_nop 0
    buffer_load_dwordx4 v2, s[12:15], s39 offen offset:1024 lds
    s_mov_b32 m0, s38
    s_nop 0
    buffer_load_dwordx4 v2, s[12:15], s39 offen offset:2048 lds
    s_mov_b32 m0, s38
    s_nop 0
    buffer_load_dwordx4 v2, s[12:15], s39 offen offset:3072 lds
    s_add_u32 s38, s38, 4096
    s_add_u32 s39, s39, 4096
    s_mov_b32 m0, s38
    s_nop 0
    buffer_load_dwordx4 v2, s[12:15], s39 offen offset:0 lds
    s_mov_b32 m0, s38
    s_nop 0
    buffer_load_dwordx4 v2, s[12:15], s39 offen offset:1024 lds
    s_mov_b32 m0, s38
    s_nop 0
    buffer_load_dwordx4 v2, s[12:15], s39 offen offset:2048 lds
    s_mov_b32 m0, s38
    s_nop 0
    buffer_load_dwordx4 v2, s[12:15], s39 offen offset:3072 lds
    s_add_u32 s38, s38, 4096
    s_add_u32 s39, s39, 4096
    s_mov_b32 m0, s38
    s_nop 0
    buffer_load_dwordx4 v2, s[12:15], s39 offen offset:0 lds
    s_mov_b32 m0, s38
    s_nop 0
    buffer_load_dwordx4 v2, s[12:15], s39 offen offset:1024 lds
    s_mov_b32 m0, s38
    s_nop 0
    buffer_load_dwordx4 v2, s[12:15], s39 offen offset:2048 lds
    s_mov_b32 m0, s38
    s_nop 0
    buffer_load_dwordx4 v2, s[12:15], s39 offen offset:3072 lds
    s_add_u32 s38, s38, 4096
    s_add_u32 s39, s39, 4096
    s_mov_b32 m0, s38
    s_nop 0
    buffer_load_dwordx4 v2, s[12:15], s39 offen offset:0 lds
    v_lshlrev_b32 v9, 4, v3
    v_add_u32 v9, 155648, v9
    v_mov_b32 v12, 0xbdd2d3e8
    v_mov_b32 v13, 0xc0135761
    ds_read_b128 v[180:183], v9 offset:0
    ds_read_b128 v[200:203], v9 offset:512
    ds_read_b128 v[184:187], v9 offset:64
    ds_read_b128 v[204:207], v9 offset:576
    ds_read_b128 v[188:191], v9 offset:128
    ds_read_b128 v[208:211], v9 offset:640
    ds_read_b128 v[192:195], v9 offset:192
    ds_read_b128 v[212:215], v9 offset:704
    ds_read_b128 v[196:199], v9 offset:256
    ds_read_b128 v[216:219], v9 offset:768
    s_waitcnt lgkmcnt(0)
    v_pk_add_f32 v[180:181], v[180:181], v[200:201]
    v_pk_add_f32 v[182:183], v[182:183], v[202:203]
    v_pk_add_f32 v[184:185], v[184:185], v[204:205]
    v_pk_add_f32 v[186:187], v[186:187], v[206:207]
    v_pk_add_f32 v[188:189], v[188:189], v[208:209]
    v_pk_add_f32 v[190:191], v[190:191], v[210:211]
    v_pk_add_f32 v[192:193], v[192:193], v[212:213]
    v_pk_add_f32 v[194:195], v[194:195], v[214:215]
    v_pk_add_f32 v[196:197], v[196:197], v[216:217]
    v_pk_add_f32 v[198:199], v[198:199], v[218:219]
    v_pk_mul_f32 v[200:201], v[180:181], v[176:177] op_sel_hi:[1,0]
    v_pk_mul_f32 v[202:203], v[182:183], v[176:177] op_sel_hi:[1,0]
    v_pk_mul_f32 v[204:205], v[184:185], v[176:177] op_sel_hi:[1,0]
    v_pk_mul_f32 v[206:207], v[186:187], v[176:177] op_sel_hi:[1,0]
    v_pk_mul_f32 v[208:209], v[188:189], v[176:177] op_sel_hi:[1,0]
    v_pk_mul_f32 v[210:211], v[190:191], v[176:177] op_sel_hi:[1,0]
    v_pk_mul_f32 v[212:213], v[192:193], v[176:177] op_sel_hi:[1,0]
    v_pk_mul_f32 v[214:215], v[194:195], v[176:177] op_sel_hi:[1,0]
    v_pk_mul_f32 v[216:217], v[196:197], v[176:177] op_sel_hi:[1,0]
    v_pk_mul_f32 v[218:219], v[198:199], v[176:177] op_sel_hi:[1,0]
    v_pk_fma_f32 v[156:157], v[156:157], v[176:177], v[200:201] op_sel:[0,1,0] op_sel_hi:[1,1,1]
    v_pk_fma_f32 v[158:159], v[158:159], v[176:177], v[202:203] op_sel:[0,1,0] op_sel_hi:[1,1,1]
    v_pk_fma_f32 v[160:161], v[160:161], v[176:177], v[204:205] op_sel:[0,1,0] op_sel_hi:[1,1,1]
    v_pk_fma_f32 v[162:163], v[162:163], v[176:177], v[206:207] op_sel:[0,1,0] op_sel_hi:[1,1,1]
    v_pk_fma_f32 v[164:165], v[164:165], v[176:177], v[208:209] op_sel:[0,1,0] op_sel_hi:[1,1,1]
    v_pk_fma_f32 v[166:167], v[166:167], v[176:177], v[210:211] op_sel:[0,1,0] op_sel_hi:[1,1,1]
    v_pk_fma_f32 v[168:169], v[168:169], v[176:177], v[212:213] op_sel:[0,1,0] op_sel_hi:[1,1,1]
    v_pk_fma_f32 v[170:171], v[170:171], v[176:177], v[214:215] op_sel:[0,1,0] op_sel_hi:[1,1,1]
    v_pk_fma_f32 v[172:173], v[172:173], v[176:177], v[216:217] op_sel:[0,1,0] op_sel_hi:[1,1,1]
    v_pk_fma_f32 v[174:175], v[174:175], v[176:177], v[218:219] op_sel:[0,1,0] op_sel_hi:[1,1,1]
    v_pk_mul_f32 v[200:201], v[156:157], v[156:157]
    v_pk_mul_f32 v[202:203], v[158:159], v[158:159]
    v_pk_mul_f32 v[204:205], v[160:161], v[160:161]
    v_pk_mul_f32 v[206:207], v[162:163], v[162:163]
    v_pk_mul_f32 v[208:209], v[164:165], v[164:165]
    v_pk_mul_f32 v[210:211], v[166:167], v[166:167]
    v_pk_mul_f32 v[212:213], v[168:169], v[168:169]
    v_pk_mul_f32 v[214:215], v[170:171], v[170:171]
    v_pk_mul_f32 v[216:217], v[172:173], v[172:173]
    v_pk_mul_f32 v[218:219], v[174:175], v[174:175]
    v_pk_fma_f32 v[200:201], v[200:201], v[12:13], v[12:13] op_sel:[0,0,1] op_sel_hi:[1,0,1]
    v_pk_fma_f32 v[202:203], v[202:203], v[12:13], v[12:13] op_sel:[0,0,1] op_sel_hi:[1,0,1]
    v_pk_fma_f32 v[204:205], v[204:205], v[12:13], v[12:13] op_sel:[0,0,1] op_sel_hi:[1,0,1]
    v_pk_fma_f32 v[206:207], v[206:207], v[12:13], v[12:13] op_sel:[0,0,1] op_sel_hi:[1,0,1]
    v_pk_fma_f32 v[208:209], v[208:209], v[12:13], v[12:13] op_sel:[0,0,1] op_sel_hi:[1,0,1]
    v_pk_fma_f32 v[210:211], v[210:211], v[12:13], v[12:13] op_sel:[0,0,1] op_sel_hi:[1,0,1]
    v_pk_fma_f32 v[212:213], v[212:213], v[12:13], v[12:13] op_sel:[0,0,1] op_sel_hi:[1,0,1]
    v_pk_fma_f32 v[214:215], v[214:215], v[12:13], v[12:13] op_sel:[0,0,1] op_sel_hi:[1,0,1]
    v_pk_fma_f32 v[216:217], v[216:217], v[12:13], v[12:13] op_sel:[0,0,1] op_sel_hi:[1,0,1]
    v_pk_fma_f32 v[218:219], v[218:219], v[12:13], v[12:13] op_sel:[0,0,1] op_sel_hi:[1,0,1]
    v_pk_mul_f32 v[200:201], v[200:201], v[156:157]
    v_pk_mul_f32 v[202:203], v[202:203], v[158:159]
    v_pk_mul_f32 v[204:205], v[204:205], v[160:161]
    v_pk_mul_f32 v[206:207], v[206:207], v[162:163]
    v_pk_mul_f32 v[208:209], v[208:209], v[164:165]
    v_pk_mul_f32 v[210:211], v[210:211], v[166:167]
    v_pk_mul_f32 v[212:213], v[212:213], v[168:169]
    v_pk_mul_f32 v[214:215], v[214:215], v[170:171]
    v_pk_mul_f32 v[216:217], v[216:217], v[172:173]
    v_pk_mul_f32 v[218:219], v[218:219], v[174:175]
    v_exp_f32 v200, v200
    v_exp_f32 v201, v201
    v_exp_f32 v202, v202
    v_exp_f32 v203, v203
    v_exp_f32 v204, v204
    v_exp_f32 v205, v205
    v_exp_f32 v206, v206
    v_exp_f32 v207, v207
    v_exp_f32 v208, v208
    v_exp_f32 v209, v209
    v_exp_f32 v210, v210
    v_exp_f32 v211, v211
    v_exp_f32 v212, v212
    v_exp_f32 v213, v213
    v_exp_f32 v214, v214
    v_exp_f32 v215, v215
    v_exp_f32 v216, v216
    v_exp_f32 v217, v217
    v_exp_f32 v218, v218
    v_exp_f32 v219, v219
    v_pk_add_f32 v[200:201], v[200:201], 1.0 op_sel_hi:[1,0]
    v_pk_add_f32 v[202:203], v[202:203], 1.0 op_sel_hi:[1,0]
    v_pk_add_f32 v[204:205], v[204:205], 1.0 op_sel_hi:[1,0]
    v_pk_add_f32 v[206:207], v[206:207], 1.0 op_sel_hi:[1,0]
    v_pk_add_f32 v[208:209], v[208:209], 1.0 op_sel_hi:[1,0]
    v_pk_add_f32 v[210:211], v[210:211], 1.0 op_sel_hi:[1,0]
    v_pk_add_f32 v[212:213], v[212:213], 1.0 op_sel_hi:[1,0]
    v_pk_add_f32 v[214:215], v[214:215], 1.0 op_sel_hi:[1,0]
    v_pk_add_f32 v[216:217], v[216:217], 1.0 op_sel_hi:[1,0]
    v_pk_add_f32 v[218:219], v[218:219], 1.0 op_sel_hi:[1,0]
    v_rcp_f32 v200, v200
    v_rcp_f32 v201, v201
    v_rcp_f32 v202, v202
    v_rcp_f32 v203, v203
    v_rcp_f32 v204, v204
    v_rcp_f32 v205, v205
    v_rcp_f32 v206, v206
    v_rcp_f32 v207, v207
    v_rcp_f32 v208, v208
    v_rcp_f32 v209, v209
    v_rcp_f32 v210, v210
    v_rcp_f32 v211, v211
    v_rcp_f32 v212, v212
    v_rcp_f32 v213, v213
    v_rcp_f32 v214, v214
    v_rcp_f32 v215, v215
    v_rcp_f32 v216, v216
    v_rcp_f32 v217, v217
    v_rcp_f32 v218, v218
    v_rcp_f32 v219, v219
    s_nop 0
    v_pk_mul_f32 v[156:157], v[156:157], v[200:201]
    v_pk_mul_f32 v[158:159], v[158:159], v[202:203]
    v_pk_mul_f32 v[160:161], v[160:161], v[204:205]
    v_pk_mul_f32 v[162:163], v[162:163], v[206:207]
    v_pk_mul_f32 v[164:165], v[164:165], v[208:209]
    v_pk_mul_f32 v[166:167], v[166:167], v[210:211]
    v_pk_mul_f32 v[168:169], v[168:169], v[212:213]
    v_pk_mul_f32 v[170:171], v[170:171], v[214:215]
    v_pk_mul_f32 v[172:173], v[172:173], v[216:217]
    v_pk_mul_f32 v[174:175], v[174:175], v[218:219]
    v_cvt_pk_bf16_f32 v156, v156, v157
    v_cvt_pk_bf16_f32 v157, v158, v159
    v_cvt_pk_bf16_f32 v158, v160, v161
    v_cvt_pk_bf16_f32 v159, v162, v163
    v_cvt_pk_bf16_f32 v164, v164, v165
    v_cvt_pk_bf16_f32 v165, v166, v167
    v_cvt_pk_bf16_f32 v166, v168, v169
    v_cvt_pk_bf16_f32 v167, v170, v171
    v_cvt_pk_bf16_f32 v172, v172, v173
    v_cvt_pk_bf16_f32 v173, v174, v175
    s_nop 1
    v_permlane16_swap_b32 v156, v158
    v_permlane16_swap_b32 v157, v159
    v_permlane16_swap_b32 v164, v166
    v_permlane16_swap_b32 v165, v167
    s_mov_b32 s46, s22
    s_lshl_b32 s41, s33, 2
    s_add_u32 s49, s55, s41
    s_cmp_eq_u32 s31, 0
    s_cbranch_scc1 k2_kernel_slow19
    buffer_store_dwordx4 v[156:159], v254, s[12:15], s46 offen offset:0
    buffer_store_dwordx4 v[164:167], v254, s[12:15], s46 offen offset:1024
    buffer_store_dwordx2 v[172:173], v8, s[12:15], s46 offen offset:2048
    s_waitcnt vmcnt(0)
    v_mov_b32 v9, 1
    v_mov_b32 v10, 2304
    s_mov_b64 exec, 1
    buffer_store_dword v9, v10, s[12:15], s49 offen
    s_mov_b64 exec, -1
    s_branch k2_kernel_sent20
k2_kernel_slow19:
    buffer_store_dwordx4 v[156:159], v254, s[12:15], s46 offen offset:0 sc1
    buffer_store_dwordx4 v[164:167], v254, s[12:15], s46 offen offset:1024 sc1
    buffer_store_dwordx2 v[172:173], v8, s[12:15], s46 offen offset:2048 sc1
    s_waitcnt vmcnt(0)
    v_mov_b32 v9, 1
    v_mov_b32 v10, 2304
    s_mov_b64 exec, 1
    buffer_store_dword v9, v10, s[12:15], s49 offen sc1
    s_mov_b64 exec, -1
k2_kernel_sent20:
    s_cmp_eq_u32 s21, 0
    s_cbranch_scc1 k2_kernel_xas23
    v_mov_b32 v9, 3
    v_mov_b32 v10, 0
    s_mov_b64 exec, 1
    s_cmp_eq_u32 s31, 0
    s_cbranch_scc1 k2_kernel_xas21
    buffer_store_dword v9, v10, s[12:15], s21 offen
    s_branch k2_kernel_xas22
k2_kernel_xas21:
    buffer_store_dword v9, v10, s[12:15], s21 offen sc1
k2_kernel_xas22:
    s_mov_b64 exec, -1
k2_kernel_xas23:
    s_sub_u32 s41, s55, s37
    s_lshr_b32 s41, s41, 7
    v_bfe_u32 v7, v1, 3, 2
    v_min_u32 v7, 2, v7
    v_add_u32 v7, s41, v7
    v_subrev_u32 v7, 1, v7
    v_max_i32 v7, 0, v7
    v_min_i32 v7, 15, v7
    v_lshlrev_b32 v7, 7, v7
    v_and_b32 v9, 7, v1
    v_lshl_add_u32 v7, v9, 2, v7
    s_add_u32 s49, s37, 2304
    s_mov_b32 s43, 200000
k2_kernel_poll24:
    buffer_load_dword v9, v7, s[12:15], s49 offen sc1
    s_waitcnt vmcnt(0)
    v_cmp_ne_u32 vcc, 0, v9
    s_sub_u32 s43, s43, 1
    s_cmp_eq_u64 vcc, -1
    s_cbranch_scc1 k2_kernel_go25
    s_cmp_lg_u32 s43, 0
    s_cbranch_scc1 k2_kernel_poll24
k2_kernel_go25:
    s_mul_i32 s41, s33, 2560
    s_sub_u32 s47, s22, s41
    s_mov_b32 s52, s47
    s_add_u32 s41, s52, 0
    buffer_load_dwordx4 v[16:19], v2, s[12:15], s41 offen offset:0 sc1
    s_add_u32 s41, s52, 0
    buffer_load_dwordx4 v[20:23], v2, s[12:15], s41 offen offset:1024 sc1
    s_add_u32 s41, s52, 0
    buffer_load_dwordx4 v[24:27], v2, s[12:15], s41 offen offset:2048 sc1
    s_add_u32 s41, s52, 0
    buffer_load_dwordx4 v[28:31], v2, s[12:15], s41 offen offset:3072 sc1
    s_add_u32 s41, s54, 20480
    s_mov_b32 s48, s41
    s_sub_u32 s41, s55, s37
    s_lshl_b32 s41, s41, 3
    s_add_u32 s46, s41, s36
    s_add_u32 s46, s46, 1581056
    s_barrier
    ds_read_b128 v[96:99], v15 offset:36864
    ds_read_b128 v[100:103], v15 offset:37888
    ds_read_b128 v[104:107], v15 offset:38912
    ds_read_b128 v[108:111], v15 offset:39936
    ds_read_b128 v[112:115], v15 offset:40960
    ds_read_b128 v[116:119], v15 offset:41984
    ds_read_b128 v[120:123], v15 offset:43008
    ds_read_b128 v[124:127], v15 offset:44032
    ds_read_b128 v[128:131], v15 offset:45056
    ds_read_b128 v[132:135], v15 offset:46080
    s_waitcnt vmcnt(3)
    s_waitcnt lgkmcnt(5)
    v_mfma_f32_16x16x32_bf16 v[156:159], v[96:99], v[16:19], 0
    s_add_u32 s41, s52, 4096
    buffer_load_dwordx4 v[32:35], v2, s[12:15], s41 offen offset:0 sc1
    v_mfma_f32_16x16x32_bf16 v[160:163], v[100:103], v[16:19], 0
    ds_read_b128 v[136:139], v15 offset:47104
    v_mfma_f32_16x16x32_bf16 v[164:167], v[104:107], v[16:19], 0
    ds_read_b128 v[140:143], v15 offset:48128
    v_mfma_f32_16x16x32_bf16 v[168:171], v[108:111], v[16:19], 0
    ds_read_b128 v[144:147], v15 offset:49152
    s_add_u32 s41, s52, 4096
    buffer_load_dwordx4 v[36:39], v2, s[12:15], s41 offen offset:1024 sc1
    v_mfma_f32_16x16x32_bf16 v[172:175], v[112:115], v[16:19], 0
    ds_read_b128 v[148:151], v15 offset:50176
    ds_read_b128 v[152:155], v15 offset:51200
    s_waitcnt vmcnt(4)
    s_waitcnt lgkmcnt(5)
    v_mfma_f32_16x16x32_bf16 v[156:159], v[116:119], v[20:23], v[156:159]
    s_add_u32 s41, s52, 4096
    buffer_load_dwordx4 v[40:43], v2, s[12:15], s41 offen offset:2048 sc1
    v_mfma_f32_16x16x32_bf16 v[160:163], v[120:123], v[20:23], v[160:163]
    ds_read_b128 v[96:99], v15 offset:52224
    v_mfma_f32_16x16x32_bf16 v[164:167], v[124:127], v[20:23], v[164:167]
    ds_read_b128 v[100:103], v15 offset:53248
    v_mfma_f32_16x16x32_bf16 v[168:171], v[128:131], v[20:23], v[168:171]
    ds_read_b128 v[104:107], v15 offset:54272
    s_add_u32 s41, s52, 4096
    buffer_load_dwordx4 v[44:47], v2, s[12:15], s41 offen offset:3072 sc1
    v_mfma_f32_16x16x32_bf16 v[172:175], v[132:135], v[20:23], v[172:175]
    ds_read_b128 v[108:111], v15 offset:55296
    ds_read_b128 v[112:115], v15 offset:56320
    s_waitcnt vmcnt(5)
    s_waitcnt lgkmcnt(5)
    v_mfma_f32_16x16x32_bf16 v[156:159], v[136:139], v[24:27], v[156:159]
    s_add_u32 s41, s52, 8192
    buffer_load_dwordx4 v[48:51], v2, s[12:15], s41 offen offset:0 sc1
    v_mfma_f32_16x16x32_bf16 v[160:163], v[140:143], v[24:27], v[160:163]
    ds_read_b128 v[116:119], v15 offset:57344
    v_mfma_f32_16x16x32_bf16 v[164:167], v[144:147], v[24:27], v[164:167]
    ds_read_b128 v[120:123], v15 offset:58368
    v_mfma_f32_16x16x32_bf16 v[168:171], v[148:151], v[24:27], v[168:171]
    ds_read_b128 v[124:127], v15 offset:59392
    s_add_u32 s41, s52, 8192
    buffer_load_dwordx4 v[52:55], v2, s[12:15], s41 offen offset:1024 sc1
    v_mfma_f32_16x16x32_bf16 v[172:175], v[152:155], v[24:27], v[172:175]
    ds_read_b128 v[128:131], v15 offset:60416
    ds_read_b128 v[132:135], v15 offset:61440
    s_waitcnt vmcnt(6)
    s_waitcnt lgkmcnt(5)
    v_mfma_f32_16x16x32_bf16 v[156:159], v[96:99], v[28:31], v[156:159]
    s_add_u32 s41, s52, 8192
    buffer_load_dwordx4 v[56:59], v2, s[12:15], s41 offen offset:2048 sc1
    v_mfma_f32_16x16x32_bf16 v[160:163], v[100:103], v[28:31], v[160:163]
    ds_read_b128 v[136:139], v15 offset:62464
    v_mfma_f32_16x16x32_bf16 v[164:167], v[104:107], v[28:31], v[164:167]
    ds_read_b128 v[140:143], v15 offset:63488
    v_mfma_f32_16x16x32_bf16 v[168:171], v[108:111], v[28:31], v[168:171]
    ds_read_b128 v[144:147], v15 offset:64512
    s_add_u32 s41, s52, 8192
    buffer_load_dwordx4 v[60:63], v2, s[12:15], s41 offen offset:3072 sc1
    v_mfma_f32_16x16x32_bf16 v[172:175], v[112:115], v[28:31], v[172:175]
    ds_read_b128 v[148:151], v11 offset:0
    ds_read_b128 v[152:155], v11 offset:1024
    s_waitcnt vmcnt(7)
    s_waitcnt lgkmcnt(5)
    v_mfma_f32_16x16x32_bf16 v[156:159], v[116:119], v[32:35], v[156:159]
    s_add_u32 s41, s52, 12288
    buffer_load_dwordx4 v[64:67], v2, s[12:15], s41 offen offset:0 sc1
    v_mfma_f32_16x16x32_bf16 v[160:163], v[120:123], v[32:35], v[160:163]
    ds_read_b128 v[96:99], v11 offset:2048
    v_mfma_f32_16x16x32_bf16 v[164:167], v[124:127], v[32:35], v[164:167]
    ds_read_b128 v[100:103], v11 offset:3072
    v_mfma_f32_16x16x32_bf16 v[168:171], v[128:131], v[32:35], v[168:171]
    ds_read_b128 v[104:107], v11 offset:4096
    s_add_u32 s41, s52, 12288
    buffer_load_dwordx4 v[68:71], v2, s[12:15], s41 offen offset:1024 sc1
    v_mfma_f32_16x16x32_bf16 v[172:175], v[132:135], v[32:35], v[172:175]
    ds_read_b128 v[108:111], v11 offset:5120
    ds_read_b128 v[112:115], v11 offset:6144
    s_waitcnt vmcnt(8)
    s_waitcnt lgkmcnt(5)
    v_mfma_f32_16x16x32_bf16 v[156:159], v[136:139], v[36:39], v[156:159]
    s_add_u32 s41, s52, 12288
    buffer_load_dwordx4 v[72:75], v2, s[12:15], s41 offen offset:2048 sc1
    v_mfma_f32_16x16x32_bf16 v[160:163], v[140:143], v[36:39], v[160:163]
    ds_read_b128 v[116:119], v11 offset:7168
    v_mfma_f32_16x16x32_bf16 v[164:167], v[144:147], v[36:39], v[164:167]
    ds_read_b128 v[120:123], v11 offset:8192
    v_mfma_f32_16x16x32_bf16 v[168:171], v[148:151], v[36:39], v[168:171]
    ds_read_b128 v[124:127], v11 offset:9216
    s_add_u32 s41, s52, 12288
    buffer_load_dwordx4 v[76:79], v2, s[12:15], s41 offen offset:3072 sc1
    v_mfma_f32_16x16x32_bf16 v[172:175], v[152:155], v[36:39], v[172:175]
    ds_read_b128 v[128:131], v11 offset:10240
    ds_read_b128 v[132:135], v11 offset:11264
    s_waitcnt vmcnt(9)
    s_waitcnt lgkmcnt(5)
    v_mfma_f32_16x16x32_bf16 v[156:159], v[96:99], v[40:43], v[156:159]
    s_add_u32 s41, s52, 16384
    buffer_load_dwordx4 v[80:83], v2, s[12:15], s41 offen offset:0 sc1
    v_mfma_f32_16x16x32_bf16 v[160:163], v[100:103], v[40:43], v[160:163]
    ds_read_b128 v[136:139], v11 offset:12288
    v_mfma_f32_16x16x32_bf16 v[164:167], v[104:107], v[40:43], v[164:167]
    ds_read_b128 v[140:143], v11 offset:13312
    v_mfma_f32_16x16x32_bf16 v[168:171], v[108:111], v[40:43], v[168:171]
    ds_read_b128 v[144:147], v11 offset:14336
    s_add_u32 s41, s52, 16384
    buffer_load_dwordx4 v[84:87], v2, s[12:15], s41 offen offset:1024 sc1
    v_mfma_f32_16x16x32_bf16 v[172:175], v[112:115], v[40:43], v[172:175]
    ds_read_b128 v[148:151], v11 offset:15360
    ds_read_b128 v[152:155], v11 offset:16384
    s_waitcnt vmcnt(10)
    s_waitcnt lgkmcnt(5)
    v_mfma_f32_16x16x32_bf16 v[156:159], v[116:119], v[44:47], v[156:159]
    s_add_u32 s41, s52, 16384
    buffer_load_dwordx4 v[88:91], v2, s[12:15], s41 offen offset:2048 sc1
    v_mfma_f32_16x16x32_bf16 v[160:163], v[120:123], v[44:47], v[160:163]
    ds_read_b128 v[96:99], v11 offset:17408
    v_mfma_f32_16x16x32_bf16 v[164:167], v[124:127], v[44:47], v[164:167]
    ds_read_b128 v[100:103], v11 offset:18432
    v_mfma_f32_16x16x32_bf16 v[168:171], v[128:131], v[44:47], v[168:171]
    ds_read_b128 v[104:107], v11 offset:19456
    s_add_u32 s41, s52, 16384
    buffer_load_dwordx4 v[92:95], v2, s[12:15], s41 offen offset:3072 sc1
    v_mfma_f32_16x16x32_bf16 v[172:175], v[132:135], v[44:47], v[172:175]
    ds_read_b128 v[108:111], v11 offset:20480
    ds_read_b128 v[112:115], v11 offset:21504
    s_waitcnt vmcnt(11)
    s_waitcnt lgkmcnt(5)
    v_mfma_f32_16x16x32_bf16 v[156:159], v[136:139], v[48:51], v[156:159]
    v_mfma_f32_16x16x32_bf16 v[160:163], v[140:143], v[48:51], v[160:163]
    ds_read_b128 v[116:119], v11 offset:22528
    buffer_load_dwordx4 v[176:179], v254, s[12:15], s48 offen sc1
    buffer_load_dwordx4 v[180:183], v254, s[12:15], s48 offen offset:1024 sc1
    buffer_load_dwordx2 v[184:185], v8, s[12:15], s48 offen offset:2048 sc1
    v_mfma_f32_16x16x32_bf16 v[164:167], v[144:147], v[48:51], v[164:167]
    ds_read_b128 v[120:123], v11 offset:23552
    v_mfma_f32_16x16x32_bf16 v[168:171], v[148:151], v[48:51], v[168:171]
    ds_read_b128 v[124:127], v14 offset:0
    v_mfma_f32_16x16x32_bf16 v[172:175], v[152:155], v[48:51], v[172:175]
    ds_read_b128 v[128:131], v14 offset:1024
    ds_read_b128 v[132:135], v14 offset:2048
    s_waitcnt vmcnt(13)
    s_waitcnt lgkmcnt(5)
    s_barrier
    v_mfma_f32_16x16x32_bf16 v[156:159], v[96:99], v[52:55], v[156:159]
    v_mfma_f32_16x16x32_bf16 v[160:163], v[100:103], v[52:55], v[160:163]
    ds_read_b128 v[136:139], v14 offset:3072
    v_mfma_f32_16x16x32_bf16 v[164:167], v[104:107], v[52:55], v[164:167]
    ds_read_b128 v[140:143], v14 offset:4096
    v_mfma_f32_16x16x32_bf16 v[168:171], v[108:111], v[52:55], v[168:171]
    ds_read_b128 v[144:147], v14 offset:5120
    v_mfma_f32_16x16x32_bf16 v[172:175], v[112:115], v[52:55], v[172:175]
    ds_read_b128 v[148:151], v14 offset:6144
    ds_read_b128 v[152:155], v14 offset:7168
    s_waitcnt vmcnt(12)
    s_waitcnt lgkmcnt(5)
    v_mfma_f32_16x16x32_bf16 v[156:159], v[116:119], v[56:59], v[156:159]
    v_mfma_f32_16x16x32_bf16 v[160:163], v[120:123], v[56:59], v[160:163]
    ds_read_b128 v[96:99], v14 offset:8192
    s_mul_i32 s38, s30, 12288
    s_add_u32 s39, s38, s45
    s_add_u32 s39, s39, 53248
    s_add_u32 s38, s38, 102400
    s_mov_b32 m0, s38
    s_nop 0
    buffer_load_dwordx4 v2, s[12:15], s39 offen offset:0 lds
    v_mfma_f32_16x16x32_bf16 v[164:167], v[124:127], v[56:59], v[164:167]
    ds_read_b128 v[100:103], v14 offset:9216
    v_mfma_f32_16x16x32_bf16 v[168:171], v[128:131], v[56:59], v[168:171]
    ds_read_b128 v[104:107], v14 offset:10240
    v_mfma_f32_16x16x32_bf16 v[172:175], v[132:135], v[56:59], v[172:175]
    ds_read_b128 v[108:111], v14 offset:11264
    ds_read_b128 v[112:115], v14 offset:12288
    s_mov_b32 m0, s38
    s_nop 0
    buffer_load_dwordx4 v2, s[12:15], s39 offen offset:1024 lds
    s_waitcnt vmcnt(13)
    s_waitcnt lgkmcnt(5)
    v_mfma_f32_16x16x32_bf16 v[156:159], v[136:139], v[60:63], v[156:159]
    v_mfma_f32_16x16x32_bf16 v[160:163], v[140:143], v[60:63], v[160:163]
    ds_read_b128 v[116:119], v14 offset:13312
    s_mov_b32 m0, s38
    s_nop 0
    buffer_load_dwordx4 v2, s[12:15], s39 offen offset:2048 lds
    v_mfma_f32_16x16x32_bf16 v[164:167], v[144:147], v[60:63], v[164:167]
    ds_read_b128 v[120:123], v14 offset:14336
    v_mfma_f32_16x16x32_bf16 v[168:171], v[148:151], v[60:63], v[168:171]
    ds_read_b128 v[124:127], v14 offset:15360
    v_mfma_f32_16x16x32_bf16 v[172:175], v[152:155], v[60:63], v[172:175]
    ds_read_b128 v[128:131], v14 offset:16384
    ds_read_b128 v[132:135], v14 offset:17408
    s_mov_b32 m0, s38
    s_nop 0
    buffer_load_dwordx4 v2, s[12:15], s39 offen offset:3072 lds
    s_add_u32 s38, s38, 4096
    s_add_u32 s39, s39, 4096
    s_waitcnt vmcnt(14)
    s_waitcnt lgkmcnt(5)
    v_mfma_f32_16x16x32_bf16 v[156:159], v[96:99], v[64:67], v[156:159]
    v_mfma_f32_16x16x32_bf16 v[160:163], v[100:103], v[64:67], v[160:163]
    ds_read_b128 v[136:139], v14 offset:18432
    s_mov_b32 m0, s38
    s_nop 0
    buffer_load_dwordx4 v2, s[12:15], s39 offen offset:0 lds
    v_mfma_f32_16x16x32_bf16 v[164:167], v[104:107], v[64:67], v[164:167]
    ds_read_b128 v[140:143], v14 offset:19456
    v_mfma_f32_16x16x32_bf16 v[168:171], v[108:111], v[64:67], v[168:171]
    ds_read_b128 v[144:147], v14 offset:20480
    v_mfma_f32_16x16x32_bf16 v[172:175], v[112:115], v[64:67], v[172:175]
    ds_read_b128 v[148:151], v14 offset:21504
    ds_read_b128 v[152:155], v14 offset:22528
    s_mov_b32 m0, s38
    s_nop 0
    buffer_load_dwordx4 v2, s[12:15], s39 offen offset:1024 lds
    s_waitcnt vmcnt(15)
    s_waitcnt lgkmcnt(5)
    v_mfma_f32_16x16x32_bf16 v[156:159], v[116:119], v[68:71], v[156:159]
    v_mfma_f32_16x16x32_bf16 v[160:163], v[120:123], v[68:71], v[160:163]
    ds_read_b128 v[96:99], v14 offset:23552
    s_mov_b32 m0, s38
    s_nop 0
    buffer_load_dwordx4 v2, s[12:15], s39 offen offset:2048 lds
    v_mfma_f32_16x16x32_bf16 v[164:167], v[124:127], v[68:71], v[164:167]
    ds_read_b128 v[100:103], v14 offset:24576
    v_mfma_f32_16x16x32_bf16 v[168:171], v[128:131], v[68:71], v[168:171]
    ds_read_b128 v[104:107], v14 offset:25600
    v_mfma_f32_16x16x32_bf16 v[172:175], v[132:135], v[68:71], v[172:175]
    ds_read_b128 v[108:111], v14 offset:26624
    ds_read_b128 v[112:115], v14 offset:27648
    s_mov_b32 m0, s38
    s_nop 0
    buffer_load_dwordx4 v2, s[12:15], s39 offen offset:3072 lds
    s_add_u32 s38, s38, 4096
    s_add_u32 s39, s39, 4096
    s_waitcnt vmcnt(16)
    s_waitcnt lgkmcnt(5)
    v_mfma_f32_16x16x32_bf16 v[156:159], v[136:139], v[72:75], v[156:159]
    v_mfma_f32_16x16x32_bf16 v[160:163], v[140:143], v[72:75], v[160:163]
    ds_read_b128 v[116:119], v14 offset:28672
    s_mov_b32 m0, s38
    s_nop 0
    buffer_load_dwordx4 v2, s[12:15], s39 offen offset:0 lds
    v_mfma_f32_16x16x32_bf16 v[164:167], v[144:147], v[72:75], v[164:167]
    ds_read_b128 v[120:123], v14 offset:29696
    v_mfma_f32_16x16x32_bf16 v[168:171], v[148:151], v[72:75], v[168:171]
    ds_read_b128 v[124:127], v14 offset:30720
    v_mfma_f32_16x16x32_bf16 v[172:175], v[152:155], v[72:75], v[172:175]
    ds_read_b128 v[128:131], v14 offset:31744
    ds_read_b128 v[132:135], v14 offset:32768
    s_mov_b32 m0, s38
    s_nop 0
    buffer_load_dwordx4 v2, s[12:15], s39 offen offset:1024 lds
    s_waitcnt vmcnt(17)
    s_waitcnt lgkmcnt(5)
    v_mfma_f32_16x16x32_bf16 v[156:159], v[96:99], v[76:79], v[156:159]
    v_mfma_f32_16x16x32_bf16 v[160:163], v[100:103], v[76:79], v[160:163]
    ds_read_b128 v[136:139], v14 offset:33792
    s_mov_b32 m0, s38
    s_nop 0
    buffer_load_dwordx4 v2, s[12:15], s39 offen offset:2048 lds
    v_mfma_f32_16x16x32_bf16 v[164:167], v[104:107], v[76:79], v[164:167]
    ds_read_b128 v[140:143], v14 offset:34816
    v_mfma_f32_16x16x32_bf16 v[168:171], v[108:111], v[76:79], v[168:171]
    ds_read_b128 v[144:147], v14 offset:35840
    v_mfma_f32_16x16x32_bf16 v[172:175], v[112:115], v[76:79], v[172:175]
    ds_read_b128 v[148:151], v14 offset:36864
    ds_read_b128 v[152:155], v14 offset:37888
    s_mov_b32 m0, s38
    s_nop 0
    buffer_load_dwordx4 v2, s[12:15], s39 offen offset:3072 lds
    s_waitcnt vmcnt(18)
    s_waitcnt lgkmcnt(5)
    v_mfma_f32_16x16x32_bf16 v[156:159], v[116:119], v[80:83], v[156:159]
    v_mfma_f32_16x16x32_bf16 v[160:163], v[120:123], v[80:83], v[160:163]
    ds_read_b128 v[96:99], v14 offset:38912
    v_mfma_f32_16x16x32_bf16 v[164:167], v[124:127], v[80:83], v[164:167]
    ds_read_b128 v[100:103], v14 offset:39936
    v_mfma_f32_16x16x32_bf16 v[168:171], v[128:131], v[80:83], v[168:171]
    ds_read_b128 v[104:107], v14 offset:40960
    v_mfma_f32_16x16x32_bf16 v[172:175], v[132:135], v[80:83], v[172:175]
    ds_read_b128 v[108:111], v14 offset:41984
    ds_read_b128 v[112:115], v14 offset:43008
    s_waitcnt vmcnt(17)
    s_waitcnt lgkmcnt(5)
    v_mfma_f32_16x16x32_bf16 v[156:159], v[136:139], v[84:87], v[156:159]
    v_mfma_f32_16x16x32_bf16 v[160:163], v[140:143], v[84:87], v[160:163]
    ds_read_b128 v[116:119], v14 offset:44032
    v_mfma_f32_16x16x32_bf16 v[164:167], v[144:147], v[84:87], v[164:167]
    ds_read_b128 v[120:123], v14 offset:45056
    v_mfma_f32_16x16x32_bf16 v[168:171], v[148:151], v[84:87], v[168:171]
    ds_read_b128 v[124:127], v14 offset:46080
    v_mfma_f32_16x16x32_bf16 v[172:175], v[152:155], v[84:87], v[172:175]
    ds_read_b128 v[128:131], v14 offset:47104
    ds_read_b128 v[132:135], v14 offset:48128
    s_waitcnt vmcnt(16)
    s_waitcnt lgkmcnt(5)
    v_mfma_f32_16x16x32_bf16 v[156:159], v[96:99], v[88:91], v[156:159]
    v_mfma_f32_16x16x32_bf16 v[160:163], v[100:103], v[88:91], v[160:163]
    v_mfma_f32_16x16x32_bf16 v[164:167], v[104:107], v[88:91], v[164:167]
    v_mfma_f32_16x16x32_bf16 v[168:171], v[108:111], v[88:91], v[168:171]
    v_mfma_f32_16x16x32_bf16 v[172:175], v[112:115], v[88:91], v[172:175]
    s_waitcnt vmcnt(15)
    s_waitcnt lgkmcnt(0)
    v_mfma_f32_16x16x32_bf16 v[156:159], v[116:119], v[92:95], v[156:159]
    v_mfma_f32_16x16x32_bf16 v[160:163], v[120:123], v[92:95], v[160:163]
    v_mfma_f32_16x16x32_bf16 v[164:167], v[124:127], v[92:95], v[164:167]
    v_mfma_f32_16x16x32_bf16 v[168:171], v[128:131], v[92:95], v[168:171]
    v_mfma_f32_16x16x32_bf16 v[172:175], v[132:135], v[92:95], v[172:175]
    s_barrier
    s_mul_i32 s38, s30, 1024
    s_add_u32 s39, s38, s45
    s_add_u32 s39, s39, 102400
    s_add_u32 s38, s38, 151552
    s_mov_b32 m0, s38
    s_nop 0
    buffer_load_dwordx4 v2, s[12:15], s39 offen offset:0 lds
    s_mul_i32 s38, s30, 9216
    s_add_u32 s39, s38, s45
    s_add_u32 s39, s39, 106496
    s_add_u32 s38, s38, 0
    s_mov_b32 m0, s38
    s_nop 0
    buffer_load_dwordx4 v2, s[12:15], s39 offen offset:0 lds
    s_mov_b32 m0, s38
    s_nop 0
    buffer_load_dwordx4 v2, s[12:15], s39 offen offset:1024 lds
    s_mov_b32 m0, s38
    s_nop 0
    buffer_load_dwordx4 v2, s[12:15], s39 offen offset:2048 lds
    s_mov_b32 m0, s38
    s_nop 0
    buffer_load_dwordx4 v2, s[12:15], s39 offen offset:3072 lds
    s_add_u32 s38, s38, 4096
    s_add_u32 s39, s39, 4096
    s_mov_b32 m0, s38
    s_nop 0
    buffer_load_dwordx4 v2, s[12:15], s39 offen offset:0 lds
    s_mov_b32 m0, s38
    s_nop 0
    buffer_load_dwordx4 v2, s[12:15], s39 offen offset:1024 lds
    s_mov_b32 m0, s38
    s_nop 0
    buffer_load_dwordx4 v2, s[12:15], s39 offen offset:2048 lds
    s_mov_b32 m0, s38
    s_nop 0
    buffer_load_dwordx4 v2, s[12:15], s39 offen offset:3072 lds
    s_add_u32 s38, s38, 4096
    s_add_u32 s39, s39, 4096
    s_mov_b32 m0, s38
    s_nop 0
    buffer_load_dwordx4 v2, s[12:15], s39 offen offset:0 lds
    v_mov_b32 v196, 0x3f803f80
    v_mov_b32 v198, 0
    v_mov_b32 v199, 0
    s_waitcnt vmcnt(22)
    s_nop 1
    v_permlane16_swap_b32 v176, v178
    v_permlane16_swap_b32 v177, v179
    v_permlane16_swap_b32 v180, v182
    v_permlane16_swap_b32 v181, v183
    s_nop 1
    v_lshlrev_b32 v200, 16, v176
    v_and_b32 v201, 0xffff0000, v176
    v_lshlrev_b32 v202, 16, v177
    v_and_b32 v203, 0xffff0000, v177
    v_lshlrev_b32 v204, 16, v178
    v_and_b32 v205, 0xffff0000, v178
    v_lshlrev_b32 v206, 16, v179
    v_and_b32 v207, 0xffff0000, v179
    v_lshlrev_b32 v208, 16, v180
    v_and_b32 v209, 0xffff0000, v180
    v_lshlrev_b32 v210, 16, v181
    v_and_b32 v211, 0xffff0000, v181
    v_lshlrev_b32 v212, 16, v182
    v_and_b32 v213, 0xffff0000, v182
    v_lshlrev_b32 v214, 16, v183
    v_and_b32 v215, 0xffff0000, v183
    v_lshlrev_b32 v216, 16, v184
    v_and_b32 v217, 0xffff0000, v184
    v_lshlrev_b32 v218, 16, v185
    v_and_b32 v219, 0xffff0000, v185
    v_pk_add_f32 v[156:157], v[156:157], v[200:201]
    v_pk_add_f32 v[158:159], v[158:159], v[202:203]
    v_pk_add_f32 v[160:161], v[160:161], v[204:205]
    v_pk_add_f32 v[162:163], v[162:163], v[206:207]
    v_pk_add_f32 v[164:165], v[164:165], v[208:209]
    v_pk_add_f32 v[166:167], v[166:167], v[210:211]
    v_pk_add_f32 v[168:169], v[168:169], v[212:213]
    v_pk_add_f32 v[170:171], v[170:171], v[214:215]
    v_pk_add_f32 v[172:173], v[172:173], v[216:217]
    v_pk_add_f32 v[174:175], v[174:175], v[218:219]
    v_cvt_pk_bf16_f32 v156, v156, v157
    v_cvt_pk_bf16_f32 v157, v158, v159
    v_cvt_pk_bf16_f32 v158, v160, v161
    v_cvt_pk_bf16_f32 v159, v162, v163
    v_cvt_pk_bf16_f32 v164, v164, v165
    v_cvt_pk_bf16_f32 v165, v166, v167
    v_cvt_pk_bf16_f32 v166, v168, v169
    v_cvt_pk_bf16_f32 v167, v170, v171
    v_cvt_pk_bf16_f32 v172, v172, v173
    v_cvt_pk_bf16_f32 v173, v174, v175
    v_dot2_f32_bf16 v198, v156, v196, v198
    v_dot2_f32_bf16 v199, v156, v156, v199
    v_dot2_f32_bf16 v198, v157, v196, v198
    v_dot2_f32_bf16 v199, v157, v157, v199
    v_dot2_f32_bf16 v198, v158, v196, v198
    v_dot2_f32_bf16 v199, v158, v158, v199
    v_dot2_f32_bf16 v198, v159, v196, v198
    v_dot2_f32_bf16 v199, v159, v159, v199
    v_dot2_f32_bf16 v198, v164, v196, v198
    v_dot2_f32_bf16 v199, v164, v164, v199
    v_dot2_f32_bf16 v198, v165, v196, v198
    v_dot2_f32_bf16 v199, v165, v165, v199
    v_dot2_f32_bf16 v198, v166, v196, v198
    v_dot2_f32_bf16 v199, v166, v166, v199
    v_dot2_f32_bf16 v198, v167, v196, v198
    v_dot2_f32_bf16 v199, v167, v167, v199
    v_dot2_f32_bf16 v198, v172, v196, v198
    v_dot2_f32_bf16 v199, v172, v172, v199
    v_dot2_f32_bf16 v198, v173, v196, v198
    v_dot2_f32_bf16 v199, v173, v173, v199
    s_nop 1
    s_nop 1
    v_permlane16_swap_b32 v156, v158
    v_permlane16_swap_b32 v157, v159
    v_permlane16_swap_b32 v164, v166
    v_permlane16_swap_b32 v165, v167
    s_nop 2
    v_mov_b32 v188, v198
    v_mov_b32 v189, v199
    s_nop 1
    v_permlane32_swap_b32 v188, v198
    v_permlane32_swap_b32 v189, v199
    s_nop 0
    v_add_f32 v198, v198, v188
    v_add_f32 v199, v199, v189
    v_mov_b32 v188, v198
    v_mov_b32 v189, v199
    s_nop 1
    v_permlane16_swap_b32 v188, v198
    v_permlane16_swap_b32 v189, v199
    s_nop 0
    v_add_f32 v198, v198, v188
    v_add_f32 v199, v199, v189
    s_add_u32 s47, s54, 20480
    v_lshlrev_b32 v9, 6, v4
    s_lshl_b32 s41, s33, 3
    s_add_u32 s46, s46, s41
    s_lshl_b32 s41, s33, 2
    s_add_u32 s49, s55, s41
    v_mov_b32 v11, v9
    s_cmp_eq_u32 s31, 0
    s_cbranch_scc1 k2_kernel_slow26
    buffer_store_dwordx4 v[156:159], v254, s[12:15], s47 offen offset:0
    buffer_store_dwordx4 v[164:167], v254, s[12:15], s47 offen offset:1024
    buffer_store_dwordx2 v[172:173], v8, s[12:15], s47 offen offset:2048
    s_mov_b64 exec, 0xffff
    buffer_store_dwordx2 v[198:199], v11, s[12:15], s46 offen
    s_mov_b64 exec, -1
    s_waitcnt vmcnt(0)
    v_mov_b32 v9, 1
    v_mov_b32 v10, 4352
    s_mov_b64 exec, 1
    buffer_store_dword v9, v10, s[12:15], s49 offen
    s_mov_b64 exec, -1
    s_branch k2_kernel_sent27
k2_kernel_slow26:
    buffer_store_dwordx4 v[156:159], v254, s[12:15], s47 offen offset:0 sc1
    buffer_store_dwordx4 v[164:167], v254, s[12:15], s47 offen offset:1024 sc1
    buffer_store_dwordx2 v[172:173], v8, s[12:15], s47 offen offset:2048 sc1
    s_mov_b64 exec, 0xffff
    buffer_store_dwordx2 v[198:199], v11, s[12:15], s46 offen sc1
    s_mov_b64 exec, -1
    s_waitcnt vmcnt(0)
    v_mov_b32 v9, 1
    v_mov_b32 v10, 4352
    s_mov_b64 exec, 1
    buffer_store_dword v9, v10, s[12:15], s49 offen sc1
    s_mov_b64 exec, -1
k2_kernel_sent27:
    s_lshl_b32 s46, s34, 3
    s_lshl_b32 s47, s30, 1
    s_add_u32 s46, s46, s47
    s_lshl_b32 s49, s46, 7
    s_add_u32 s49, s49, 4352
    v_bfe_u32 v7, v1, 3, 1
    v_lshlrev_b32 v7, 7, v7
    v_and_b32 v9, 7, v1
    v_lshl_add_u32 v7, v9, 2, v7
    v_add_u32 v7, s49, v7
    s_sub_u32 s49, s55, s37
    s_add_u32 s49, s49, 128
    v_and_b32 v9, 3, v1
    v_lshlrev_b32 v9, 2, v9
    v_add_u32 v9, s49, v9
    v_and_b32 v10, 16, v1
    v_cmp_ne_u32 vcc, 0, v10
    v_mov_b32 v11, 1
    v_mov_b32 v10, 3
    v_cndmask_b32 v7, v7, v9, vcc
    v_cndmask_b32 v10, v11, v10, vcc
    s_mov_b32 s43, 200000
k2_kernel_poll28:
    buffer_load_dword v9, v7, s[12:15], s37 offen sc1
    s_waitcnt vmcnt(0)
    v_cmp_le_u32 vcc, v10, v9
    s_sub_u32 s43, s43, 1
    s_cmp_eq_u64 vcc, -1
    s_cbranch_scc1 k2_kernel_go29
    s_cmp_lg_u32 s43, 0
    s_cbranch_scc1 k2_kernel_poll28
k2_kernel_go29:
    s_mul_i32 s47, s46, 20480
    s_add_u32 s47, s47, s36
    s_add_u32 s47, s47, 20480
    s_add_u32 s48, s47, 20480
    s_add_u32 s41, s47, 0
    buffer_load_dwordx4 v[72:75], v2, s[12:15], s41 offen offset:0 sc1
    s_add_u32 s41, s48, 0
    buffer_load_dwordx4 v[76:79], v2, s[12:15], s41 offen offset:0 sc1
    s_add_u32 s41, s47, 0
    buffer_load_dwordx4 v[80:83], v2, s[12:15], s41 offen offset:1024 sc1
    s_add_u32 s41, s48, 0
    buffer_load_dwordx4 v[84:87], v2, s[12:15], s41 offen offset:1024 sc1
    s_add_u32 s41, s47, 0
    buffer_load_dwordx4 v[88:91], v2, s[12:15], s41 offen offset:2048 sc1
    s_add_u32 s41, s48, 0
    buffer_load_dwordx4 v[92:95], v2, s[12:15], s41 offen offset:2048 sc1
    v_lshlrev_b32 v9, 6, v4
    v_lshl_add_u32 v9, v3, 4, v9
    s_lshl_b32 s41, s46, 10
    s_add_u32 s41, s41, s36
    s_add_u32 s41, s41, 1581056
    buffer_load_dwordx4 v[216:219], v9, s[12:15], s41 offen offset:0 sc1
    buffer_load_dwordx4 v[220:223], v9, s[12:15], s41 offen offset:1024 sc1
    s_mul_i32 s52, s46, 55296
    s_mul_i32 s41, s35, 3584
    s_add_u32 s52, s52, s41
    s_add_u32 s52, s52, s36
    s_add_u32 s52, s52, 696320
    s_add_u32 s53, s52, 55296
    s_barrier
    v_add_u32 v11, 0x20000, v2
    ds_read_b128 v[160:163], v14 offset:49152
    ds_read_b128 v[164:167], v14 offset:50176
    ds_read_b128 v[168:171], v14 offset:51200
    ds_read_b128 v[172:175], v14 offset:52224
    ds_read_b128 v[176:179], v14 offset:53248
    ds_read_b128 v[180:183], v14 offset:54272
    ds_read_b128 v[184:187], v14 offset:55296
    s_waitcnt vmcnt(6)
    s_waitcnt lgkmcnt(6)
    v_mfma_f32_16x16x32_bf16 v[16:19], v[160:163], v[72:75], 0
    v_mfma_f32_16x16x32_bf16 v[44:47], v[160:163], v[76:79], 0
    ds_read_b128 v[188:191], v14 offset:56320
    s_waitcnt lgkmcnt(6)
    v_mfma_f32_16x16x32_bf16 v[20:23], v[164:167], v[72:75], 0
    v_mfma_f32_16x16x32_bf16 v[48:51], v[164:167], v[76:79], 0
    ds_read_b128 v[192:195], v14 offset:57344
    s_add_u32 s41, s47, 0
    buffer_load_dwordx4 v[96:99], v2, s[12:15], s41 offen offset:3072 sc1
    s_add_u32 s41, s48, 0
    buffer_load_dwordx4 v[100:103], v2, s[12:15], s41 offen offset:3072 sc1
    s_waitcnt lgkmcnt(6)
    v_mfma_f32_16x16x32_bf16 v[24:27], v[168:171], v[72:75], 0
    v_mfma_f32_16x16x32_bf16 v[52:55], v[168:171], v[76:79], 0
    ds_read_b128 v[196:199], v14 offset:58368
    s_waitcnt lgkmcnt(6)
    v_mfma_f32_16x16x32_bf16 v[28:31], v[172:175], v[72:75], 0
    v_mfma_f32_16x16x32_bf16 v[56:59], v[172:175], v[76:79], 0
    ds_read_b128 v[200:203], v14 offset:59392
    s_waitcnt lgkmcnt(6)
    v_mfma_f32_16x16x32_bf16 v[32:35], v[176:179], v[72:75], 0
    v_mfma_f32_16x16x32_bf16 v[60:63], v[176:179], v[76:79], 0
    ds_read_b128 v[204:207], v14 offset:60416
    s_add_u32 s41, s47, 4096
    buffer_load_dwordx4 v[104:107], v2, s[12:15], s41 offen offset:0 sc1
    s_add_u32 s41, s48, 4096
    buffer_load_dwordx4 v[108:111], v2, s[12:15], s41 offen offset:0 sc1
    s_waitcnt lgkmcnt(6)
    v_mfma_f32_16x16x32_bf16 v[36:39], v[180:183], v[72:75], 0
    v_mfma_f32_16x16x32_bf16 v[64:67], v[180:183], v[76:79], 0
    ds_read_b128 v[208:211], v14 offset:61440
    s_waitcnt lgkmcnt(6)
    v_mfma_f32_16x16x32_bf16 v[40:43], v[184:187], v[72:75], 0
    v_mfma_f32_16x16x32_bf16 v[68:71], v[184:187], v[76:79], 0
    ds_read_b128 v[212:215], v14 offset:62464
    s_waitcnt vmcnt(8)
    s_waitcnt lgkmcnt(6)
    v_mfma_f32_16x16x32_bf16 v[16:19], v[188:191], v[80:83], v[16:19]
    v_mfma_f32_16x16x32_bf16 v[44:47], v[188:191], v[84:87], v[44:47]
    ds_read_b128 v[160:163], v14 offset:63488
    s_waitcnt lgkmcnt(6)
    v_mfma_f32_16x16x32_bf16 v[20:23], v[192:195], v[80:83], v[20:23]
    v_mfma_f32_16x16x32_bf16 v[48:51], v[192:195], v[84:87], v[48:51]
    ds_read_b128 v[164:167], v14 offset:64512
    s_add_u32 s41, s47, 4096
    buffer_load_dwordx4 v[112:115], v2, s[12:15], s41 offen offset:1024 sc1
    s_add_u32 s41, s48, 4096
    buffer_load_dwordx4 v[116:119], v2, s[12:15], s41 offen offset:1024 sc1
    s_waitcnt lgkmcnt(6)
    v_mfma_f32_16x16x32_bf16 v[24:27], v[196:199], v[80:83], v[24:27]
    v_mfma_f32_16x16x32_bf16 v[52:55], v[196:199], v[84:87], v[52:55]
    ds_read_b128 v[168:171], v15 offset:0
    buffer_load_dwordx4 a[0:3], v2, s[12:15], s40 offen offset:0
    s_waitcnt lgkmcnt(6)
    v_mfma_f32_16x16x32_bf16 v[28:31], v[200:203], v[80:83], v[28:31]
    v_mfma_f32_16x16x32_bf16 v[56:59], v[200:203], v[84:87], v[56:59]
    ds_read_b128 v[172:175], v15 offset:1024
    buffer_load_dwordx4 a[4:7], v2, s[12:15], s40 offen offset:1024
    s_waitcnt lgkmcnt(6)
    v_mfma_f32_16x16x32_bf16 v[32:35], v[204:207], v[80:83], v[32:35]
    v_mfma_f32_16x16x32_bf16 v[60:63], v[204:207], v[84:87], v[60:63]
    ds_read_b128 v[176:179], v15 offset:2048
    s_add_u32 s41, s47, 4096
    buffer_load_dwordx4 v[120:123], v2, s[12:15], s41 offen offset:2048 sc1
    s_add_u32 s41, s48, 4096
    buffer_load_dwordx4 v[124:127], v2, s[12:15], s41 offen offset:2048 sc1
    s_waitcnt lgkmcnt(6)
    v_mfma_f32_16x16x32_bf16 v[36:39], v[208:211], v[80:83], v[36:39]
    v_mfma_f32_16x16x32_bf16 v[64:67], v[208:211], v[84:87], v[64:67]
    ds_read_b128 v[180:183], v15 offset:3072
    buffer_load_dwordx4 a[8:11], v2, s[12:15], s40 offen offset:2048
    s_waitcnt lgkmcnt(6)
    v_mfma_f32_16x16x32_bf16 v[40:43], v[212:215], v[80:83], v[40:43]
    v_mfma_f32_16x16x32_bf16 v[68:71], v[212:215], v[84:87], v[68:71]
    ds_read_b128 v[184:187], v15 offset:4096
    s_waitcnt vmcnt(13)
    s_waitcnt lgkmcnt(6)
    v_mfma_f32_16x16x32_bf16 v[16:19], v[160:163], v[88:91], v[16:19]
    v_mfma_f32_16x16x32_bf16 v[44:47], v[160:163], v[92:95], v[44:47]
    ds_read_b128 v[188:191], v15 offset:5120
    s_waitcnt lgkmcnt(6)
    v_mfma_f32_16x16x32_bf16 v[20:23], v[164:167], v[88:91], v[20:23]
    v_mfma_f32_16x16x32_bf16 v[48:51], v[164:167], v[92:95], v[48:51]
    ds_read_b128 v[192:195], v15 offset:6144
    s_add_u32 s41, s47, 4096
    buffer_load_dwordx4 v[128:131], v2, s[12:15], s41 offen offset:3072 sc1
    s_add_u32 s41, s48, 4096
    buffer_load_dwordx4 v[132:135], v2, s[12:15], s41 offen offset:3072 sc1
    s_waitcnt lgkmcnt(6)
    v_mfma_f32_16x16x32_bf16 v[24:27], v[168:171], v[88:91], v[24:27]
    v_mfma_f32_16x16x32_bf16 v[52:55], v[168:171], v[92:95], v[52:55]
    ds_read_b128 v[196:199], v15 offset:7168
    buffer_load_dwordx4 a[12:15], v2, s[12:15], s40 offen offset:3072
    s_add_u32 s40, s40, 4096
    s_waitcnt lgkmcnt(6)
    v_mfma_f32_16x16x32_bf16 v[28:31], v[172:175], v[88:91], v[28:31]
    v_mfma_f32_16x16x32_bf16 v[56:59], v[172:175], v[92:95], v[56:59]
    ds_read_b128 v[200:203], v15 offset:8192
    buffer_load_dwordx4 a[16:19], v2, s[12:15], s40 offen offset:0
    s_waitcnt lgkmcnt(6)
    v_mfma_f32_16x16x32_bf16 v[32:35], v[176:179], v[88:91], v[32:35]
    v_mfma_f32_16x16x32_bf16 v[60:63], v[176:179], v[92:95], v[60:63]
    ds_read_b128 v[204:207], v15 offset:9216
    s_add_u32 s41, s47, 8192
    buffer_load_dwordx4 v[136:139], v2, s[12:15], s41 offen offset:0 sc1
    s_add_u32 s41, s48, 8192
    buffer_load_dwordx4 v[140:143], v2, s[12:15], s41 offen offset:0 sc1
    s_waitcnt lgkmcnt(6)
    v_mfma_f32_16x16x32_bf16 v[36:39], v[180:183], v[88:91], v[36:39]
    v_mfma_f32_16x16x32_bf16 v[64:67], v[180:183], v[92:95], v[64:67]
    ds_read_b128 v[208:211], v15 offset:10240
    buffer_load_dwordx4 a[20:23], v2, s[12:15], s40 offen offset:1024
    s_waitcnt lgkmcnt(6)
    v_mfma_f32_16x16x32_bf16 v[40:43], v[184:187], v[88:91], v[40:43]
    v_mfma_f32_16x16x32_bf16 v[68:71], v[184:187], v[92:95], v[68:71]
    ds_read_b128 v[212:215], v15 offset:11264
    s_waitcnt vmcnt(16)
    s_waitcnt lgkmcnt(6)
    v_mfma_f32_16x16x32_bf16 v[16:19], v[188:191], v[96:99], v[16:19]
    v_mfma_f32_16x16x32_bf16 v[44:47], v[188:191], v[100:103], v[44:47]
    ds_read_b128 v[160:163], v15 offset:12288
    s_waitcnt lgkmcnt(6)
    v_mfma_f32_16x16x32_bf16 v[20:23], v[192:195], v[96:99], v[20:23]
    v_mfma_f32_16x16x32_bf16 v[48:51], v[192:195], v[100:103], v[48:51]
    ds_read_b128 v[164:167], v15 offset:13312
    s_add_u32 s41, s47, 8192
    buffer_load_dwordx4 v[144:147], v2, s[12:15], s41 offen offset:1024 sc1
    s_add_u32 s41, s48, 8192
    buffer_load_dwordx4 v[148:151], v2, s[12:15], s41 offen offset:1024 sc1
    s_waitcnt lgkmcnt(6)
    v_mfma_f32_16x16x32_bf16 v[24:27], v[196:199], v[96:99], v[24:27]
    v_mfma_f32_16x16x32_bf16 v[52:55], v[196:199], v[100:103], v[52:55]
    ds_read_b128 v[168:171], v15 offset:14336
    buffer_load_dwordx4 a[24:27], v2, s[12:15], s40 offen offset:2048
    s_waitcnt lgkmcnt(6)
    v_mfma_f32_16x16x32_bf16 v[28:31], v[200:203], v[96:99], v[28:31]
    v_mfma_f32_16x16x32_bf16 v[56:59], v[200:203], v[100:103], v[56:59]
    ds_read_b128 v[172:175], v15 offset:15360
    buffer_load_dwordx4 a[28:31], v2, s[12:15], s40 offen offset:3072
    s_add_u32 s40, s40, 4096
    s_waitcnt lgkmcnt(6)
    v_mfma_f32_16x16x32_bf16 v[32:35], v[204:207], v[96:99], v[32:35]
    v_mfma_f32_16x16x32_bf16 v[60:63], v[204:207], v[100:103], v[60:63]
    ds_read_b128 v[176:179], v15 offset:16384
    s_waitcnt lgkmcnt(6)
    v_mfma_f32_16x16x32_bf16 v[36:39], v[208:211], v[96:99], v[36:39]
    v_mfma_f32_16x16x32_bf16 v[64:67], v[208:211], v[100:103], v[64:67]
    ds_read_b128 v[180:183], v15 offset:17408
    buffer_load_dwordx4 a[32:35], v2, s[12:15], s40 offen offset:0
    s_waitcnt lgkmcnt(6)
    v_mfma_f32_16x16x32_bf16 v[40:43], v[212:215], v[96:99], v[40:43]
    v_mfma_f32_16x16x32_bf16 v[68:71], v[212:215], v[100:103], v[68:71]
    ds_read_b128 v[184:187], v15 offset:18432
    s_waitcnt vmcnt(19)
    s_waitcnt lgkmcnt(6)
    v_mfma_f32_16x16x32_bf16 v[16:19], v[160:163], v[104:107], v[16:19]
    v_mfma_f32_16x16x32_bf16 v[44:47], v[160:163], v[108:111], v[44:47]
    ds_read_b128 v[188:191], v15 offset:19456
    s_waitcnt lgkmcnt(6)
    v_mfma_f32_16x16x32_bf16 v[20:23], v[164:167], v[104:107], v[20:23]
    v_mfma_f32_16x16x32_bf16 v[48:51], v[164:167], v[108:111], v[48:51]
    ds_read_b128 v[192:195], v15 offset:20480
    s_add_u32 s41, s47, 8192
    buffer_load_dwordx4 v[152:155], v2, s[12:15], s41 offen offset:2048 sc1
    s_add_u32 s41, s48, 8192
    buffer_load_dwordx4 v[156:159], v2, s[12:15], s41 offen offset:2048 sc1
    s_waitcnt lgkmcnt(6)
    v_mfma_f32_16x16x32_bf16 v[24:27], v[168:171], v[104:107], v[24:27]
    v_mfma_f32_16x16x32_bf16 v[52:55], v[168:171], v[108:111], v[52:55]
    ds_read_b128 v[196:199], v15 offset:21504
    buffer_load_dwordx4 a[36:39], v2, s[12:15], s40 offen offset:1024
    s_waitcnt lgkmcnt(6)
    v_mfma_f32_16x16x32_bf16 v[28:31], v[172:175], v[104:107], v[28:31]
    v_mfma_f32_16x16x32_bf16 v[56:59], v[172:175], v[108:111], v[56:59]
    ds_read_b128 v[200:203], v15 offset:22528
    buffer_load_dwordx4 a[40:43], v2, s[12:15], s40 offen offset:2048
    s_waitcnt lgkmcnt(6)
    v_mfma_f32_16x16x32_bf16 v[32:35], v[176:179], v[104:107], v[32:35]
    v_mfma_f32_16x16x32_bf16 v[60:63], v[176:179], v[108:111], v[60:63]
    ds_read_b128 v[204:207], v15 offset:23552
    s_waitcnt lgkmcnt(6)
    v_mfma_f32_16x16x32_bf16 v[36:39], v[180:183], v[104:107], v[36:39]
    v_mfma_f32_16x16x32_bf16 v[64:67], v[180:183], v[108:111], v[64:67]
    ds_read_b128 v[208:211], v15 offset:24576
    buffer_load_dwordx4 a[44:47], v2, s[12:15], s40 offen offset:3072
    s_add_u32 s40, s40, 4096
    s_waitcnt lgkmcnt(6)
    v_mfma_f32_16x16x32_bf16 v[40:43], v[184:187], v[104:107], v[40:43]
    v_mfma_f32_16x16x32_bf16 v[68:71], v[184:187], v[108:111], v[68:71]
    ds_read_b128 v[212:215], v15 offset:25600
    s_waitcnt vmcnt(22)
    s_waitcnt lgkmcnt(6)
    v_mfma_f32_16x16x32_bf16 v[16:19], v[188:191], v[112:115], v[16:19]
    v_mfma_f32_16x16x32_bf16 v[44:47], v[188:191], v[116:119], v[44:47]
    ds_read_b128 v[160:163], v15 offset:26624
    v_add_f32 v224, v216, v218
    v_add_f32 v225, v217, v219
    s_waitcnt lgkmcnt(6)
    v_mfma_f32_16x16x32_bf16 v[20:23], v[192:195], v[112:115], v[20:23]
    v_mfma_f32_16x16x32_bf16 v[48:51], v[192:195], v[116:119], v[48:51]
    ds_read_b128 v[164:167], v15 offset:27648
    s_add_u32 s41, s47, 8192
    buffer_load_dwordx4 v[72:75], v2, s[12:15], s41 offen offset:3072 sc1
    s_add_u32 s41, s48, 8192
    buffer_load_dwordx4 v[76:79], v2, s[12:15], s41 offen offset:3072 sc1
    v_mov_b32 v216, v224
    v_mov_b32 v217, v225
    s_waitcnt lgkmcnt(6)
    v_mfma_f32_16x16x32_bf16 v[24:27], v[196:199], v[112:115], v[24:27]
    v_mfma_f32_16x16x32_bf16 v[52:55], v[196:199], v[116:119], v[52:55]
    ds_read_b128 v[168:171], v15 offset:28672
    buffer_load_dwordx4 a[48:51], v2, s[12:15], s40 offen offset:0
    s_nop 1
    v_permlane32_swap_b32 v216, v224
    s_waitcnt lgkmcnt(6)
    v_mfma_f32_16x16x32_bf16 v[28:31], v[200:203], v[112:115], v[28:31]
    v_mfma_f32_16x16x32_bf16 v[56:59], v[200:203], v[116:119], v[56:59]
    ds_read_b128 v[172:175], v15 offset:29696
    buffer_load_dwordx4 a[52:55], v2, s[12:15], s40 offen offset:1024
    v_permlane32_swap_b32 v217, v225
    s_nop 0
    s_waitcnt lgkmcnt(6)
    v_mfma_f32_16x16x32_bf16 v[32:35], v[204:207], v[112:115], v[32:35]
    v_mfma_f32_16x16x32_bf16 v[60:63], v[204:207], v[116:119], v[60:63]
    ds_read_b128 v[176:179], v15 offset:30720
    v_add_f32 v224, v224, v216
    v_add_f32 v225, v225, v217
    s_waitcnt lgkmcnt(6)
    v_mfma_f32_16x16x32_bf16 v[36:39], v[208:211], v[112:115], v[36:39]
    v_mfma_f32_16x16x32_bf16 v[64:67], v[208:211], v[116:119], v[64:67]
    ds_read_b128 v[180:183], v15 offset:31744
    buffer_load_dwordx4 a[56:59], v2, s[12:15], s40 offen offset:2048
    v_mov_b32 v216, v224
    v_mov_b32 v217, v225
    s_waitcnt lgkmcnt(6)
    v_mfma_f32_16x16x32_bf16 v[40:43], v[212:215], v[112:115], v[40:43]
    v_mfma_f32_16x16x32_bf16 v[68:71], v[212:215], v[116:119], v[68:71]
    ds_read_b128 v[184:187], v15 offset:32768
    s_nop 1
    v_permlane16_swap_b32 v216, v224
    s_waitcnt vmcnt(23)
    s_waitcnt lgkmcnt(6)
    v_mfma_f32_16x16x32_bf16 v[16:19], v[160:163], v[120:123], v[16:19]
    v_mfma_f32_16x16x32_bf16 v[44:47], v[160:163], v[124:127], v[44:47]
    ds_read_b128 v[188:191], v15 offset:33792
    v_permlane16_swap_b32 v217, v225
    s_nop 0
    s_waitcnt lgkmcnt(6)
    v_mfma_f32_16x16x32_bf16 v[20:23], v[164:167], v[120:123], v[20:23]
    v_mfma_f32_16x16x32_bf16 v[48:51], v[164:167], v[124:127], v[48:51]
    ds_read_b128 v[192:195], v15 offset:34816
    s_add_u32 s41, s47, 12288
    buffer_load_dwordx4 v[80:83], v2, s[12:15], s41 offen offset:0 sc1
    s_add_u32 s41, s48, 12288
    buffer_load_dwordx4 v[84:87], v2, s[12:15], s41 offen offset:0 sc1
    v_add_f32 v224, v224, v216
    v_add_f32 v225, v225, v217
    s_waitcnt lgkmcnt(6)
    v_mfma_f32_16x16x32_bf16 v[24:27], v[168:171], v[120:123], v[24:27]
    v_mfma_f32_16x16x32_bf16 v[52:55], v[168:171], v[124:127], v[52:55]
    ds_read_b128 v[196:199], v15 offset:35840
    buffer_load_dwordx4 a[60:63], v2, s[12:15], s40 offen offset:3072
    s_add_u32 s40, s40, 4096
    v_mul_f32 v224, 0x3acccccd, v224
    v_mul_f32 v225, 0x3acccccd, v225
    s_waitcnt lgkmcnt(6)
    v_mfma_f32_16x16x32_bf16 v[28:31], v[172:175], v[120:123], v[28:31]
    v_mfma_f32_16x16x32_bf16 v[56:59], v[172:175], v[124:127], v[56:59]
    ds_read_b128 v[200:203], v15 offset:36864
    buffer_load_dwordx4 a[64:67], v2, s[12:15], s40 offen offset:0
    v_fma_f32 v225, -v224, v224, v225
    v_max_f32 v225, 0, v225
    s_waitcnt lgkmcnt(6)
    v_mfma_f32_16x16x32_bf16 v[32:35], v[176:179], v[120:123], v[32:35]
    v_mfma_f32_16x16x32_bf16 v[60:63], v[176:179], v[124:127], v[60:63]
    ds_read_b128 v[204:207], v15 offset:37888
    v_cvt_pk_bf16_f32 v216, v224, v225
    v_lshlrev_b32 v224, 16, v216
    s_waitcnt lgkmcnt(6)
    v_mfma_f32_16x16x32_bf16 v[36:39], v[180:183], v[120:123], v[36:39]
    v_mfma_f32_16x16x32_bf16 v[64:67], v[180:183], v[124:127], v[64:67]
    ds_read_b128 v[208:211], v15 offset:38912
    buffer_load_dwordx4 a[68:71], v2, s[12:15], s40 offen offset:1024
    v_and_b32 v225, 0xffff0000, v216
    v_add_f32 v225, 0x3727c5ac, v225
    s_waitcnt lgkmcnt(6)
    v_mfma_f32_16x16x32_bf16 v[40:43], v[184:187], v[120:123], v[40:43]
    v_mfma_f32_16x16x32_bf16 v[68:71], v[184:187], v[124:127], v[68:71]
    ds_read_b128 v[212:215], v15 offset:39936
    v_cvt_pk_bf16_f32 v216, v225, v225
    v_lshlrev_b32 v225, 16, v216
    s_waitcnt vmcnt(25)
    s_waitcnt lgkmcnt(6)
    v_mfma_f32_16x16x32_bf16 v[16:19], v[188:191], v[128:131], v[16:19]
    v_mfma_f32_16x16x32_bf16 v[44:47], v[188:191], v[132:135], v[44:47]
    ds_read_b128 v[160:163], v15 offset:40960
    v_sqrt_f32 v225, v225
    s_nop 0
    s_waitcnt lgkmcnt(6)
    v_mfma_f32_16x16x32_bf16 v[20:23], v[192:195], v[128:131], v[20:23]
    v_mfma_f32_16x16x32_bf16 v[48:51], v[192:195], v[132:135], v[48:51]
    ds_read_b128 v[164:167], v15 offset:41984
    s_add_u32 s41, s47, 12288
    buffer_load_dwordx4 v[88:91], v2, s[12:15], s41 offen offset:1024 sc1
    s_add_u32 s41, s48, 12288
    buffer_load_dwordx4 v[92:95], v2, s[12:15], s41 offen offset:1024 sc1
    v_cvt_pk_bf16_f32 v216, v225, v225
    v_lshlrev_b32 v225, 16, v216
    s_waitcnt lgkmcnt(6)
    v_mfma_f32_16x16x32_bf16 v[24:27], v[196:199], v[128:131], v[24:27]
    v_mfma_f32_16x16x32_bf16 v[52:55], v[196:199], v[132:135], v[52:55]
    ds_read_b128 v[168:171], v15 offset:43008
    buffer_load_dwordx4 a[72:75], v2, s[12:15], s40 offen offset:2048
    v_rcp_f32 v225, v225
    s_nop 0
    s_waitcnt lgkmcnt(6)
    v_mfma_f32_16x16x32_bf16 v[28:31], v[200:203], v[128:131], v[28:31]
    v_mfma_f32_16x16x32_bf16 v[56:59], v[200:203], v[132:135], v[56:59]
    ds_read_b128 v[172:175], v15 offset:44032
    buffer_load_dwordx4 a[76:79], v2, s[12:15], s40 offen offset:3072
    s_add_u32 s40, s40, 4096
    v_mul_f32 v224, v224, v225
    v_sub_f32 v224, 0, v224
    s_waitcnt lgkmcnt(6)
    v_mfma_f32_16x16x32_bf16 v[32:35], v[204:207], v[128:131], v[32:35]
    v_mfma_f32_16x16x32_bf16 v[60:63], v[204:207], v[132:135], v[60:63]
    ds_read_b128 v[176:179], v15 offset:45056
    v_add_f32 v226, v220, v222
    v_add_f32 v227, v221, v223
    s_waitcnt lgkmcnt(6)
    v_mfma_f32_16x16x32_bf16 v[36:39], v[208:211], v[128:131], v[36:39]
    v_mfma_f32_16x16x32_bf16 v[64:67], v[208:211], v[132:135], v[64:67]
    ds_read_b128 v[180:183], v15 offset:46080
    buffer_load_dwordx4 a[80:83], v2, s[12:15], s40 offen offset:0
    v_mov_b32 v216, v226
    v_mov_b32 v217, v227
    s_waitcnt lgkmcnt(6)
    v_mfma_f32_16x16x32_bf16 v[40:43], v[212:215], v[128:131], v[40:43]
    v_mfma_f32_16x16x32_bf16 v[68:71], v[212:215], v[132:135], v[68:71]
    ds_read_b128 v[184:187], v15 offset:47104
    s_nop 1
    v_permlane32_swap_b32 v216, v226
    s_waitcnt vmcnt(26)
    s_waitcnt lgkmcnt(6)
    v_mfma_f32_16x16x32_bf16 v[16:19], v[160:163], v[136:139], v[16:19]
    v_mfma_f32_16x16x32_bf16 v[44:47], v[160:163], v[140:143], v[44:47]
    ds_read_b128 v[188:191], v15 offset:48128
    v_permlane32_swap_b32 v217, v227
    s_nop 0
    s_waitcnt lgkmcnt(6)
    v_mfma_f32_16x16x32_bf16 v[20:23], v[164:167], v[136:139], v[20:23]
    v_mfma_f32_16x16x32_bf16 v[48:51], v[164:167], v[140:143], v[48:51]
    ds_read_b128 v[192:195], v15 offset:49152
    s_add_u32 s41, s47, 12288
    buffer_load_dwordx4 v[96:99], v2, s[12:15], s41 offen offset:2048 sc1
    s_add_u32 s41, s48, 12288
    buffer_load_dwordx4 v[100:103], v2, s[12:15], s41 offen offset:2048 sc1
    v_add_f32 v226, v226, v216
    v_add_f32 v227, v227, v217
    s_waitcnt lgkmcnt(6)
    v_mfma_f32_16x16x32_bf16 v[24:27], v[168:171], v[136:139], v[24:27]
    v_mfma_f32_16x16x32_bf16 v[52:55], v[168:171], v[140:143], v[52:55]
    ds_read_b128 v[196:199], v15 offset:50176
    buffer_load_dwordx4 a[84:87], v2, s[12:15], s40 offen offset:1024
    v_mov_b32 v216, v226
    v_mov_b32 v217, v227
    s_waitcnt lgkmcnt(6)
    v_mfma_f32_16x16x32_bf16 v[28:31], v[172:175], v[136:139], v[28:31]
    v_mfma_f32_16x16x32_bf16 v[56:59], v[172:175], v[140:143], v[56:59]
    ds_read_b128 v[200:203], v15 offset:51200
    buffer_load_dwordx4 a[88:91], v2, s[12:15], s40 offen offset:2048
    s_nop 1
    v_permlane16_swap_b32 v216, v226
    s_waitcnt lgkmcnt(6)
    v_mfma_f32_16x16x32_bf16 v[32:35], v[176:179], v[136:139], v[32:35]
    v_mfma_f32_16x16x32_bf16 v[60:63], v[176:179], v[140:143], v[60:63]
    ds_read_b128 v[204:207], v15 offset:52224
    v_permlane16_swap_b32 v217, v227
    s_nop 0
    s_waitcnt lgkmcnt(6)
    v_mfma_f32_16x16x32_bf16 v[36:39], v[180:183], v[136:139], v[36:39]
    v_mfma_f32_16x16x32_bf16 v[64:67], v[180:183], v[140:143], v[64:67]
    ds_read_b128 v[208:211], v15 offset:53248
    buffer_load_dwordx4 a[92:95], v2, s[12:15], s40 offen offset:3072
    s_add_u32 s40, s40, 4096
    v_add_f32 v226, v226, v216
    v_add_f32 v227, v227, v217
    s_waitcnt lgkmcnt(6)
    v_mfma_f32_16x16x32_bf16 v[40:43], v[184:187], v[136:139], v[40:43]
    v_mfma_f32_16x16x32_bf16 v[68:71], v[184:187], v[140:143], v[68:71]
    ds_read_b128 v[212:215], v15 offset:54272
    v_mul_f32 v226, 0x3acccccd, v226
    v_mul_f32 v227, 0x3acccccd, v227
    s_waitcnt vmcnt(28)
    s_waitcnt lgkmcnt(6)
    v_mfma_f32_16x16x32_bf16 v[16:19], v[188:191], v[144:147], v[16:19]
    v_mfma_f32_16x16x32_bf16 v[44:47], v[188:191], v[148:151], v[44:47]
    ds_read_b128 v[160:163], v15 offset:55296
    v_fma_f32 v227, -v226, v226, v227
    v_max_f32 v227, 0, v227
    s_waitcnt lgkmcnt(6)
    v_mfma_f32_16x16x32_bf16 v[20:23], v[192:195], v[144:147], v[20:23]
    v_mfma_f32_16x16x32_bf16 v[48:51], v[192:195], v[148:151], v[48:51]
    ds_read_b128 v[164:167], v15 offset:56320
    s_add_u32 s41, s47, 12288
    buffer_load_dwordx4 v[104:107], v2, s[12:15], s41 offen offset:3072 sc1
    s_add_u32 s41, s48, 12288
    buffer_load_dwordx4 v[108:111], v2, s[12:15], s41 offen offset:3072 sc1
    v_cvt_pk_bf16_f32 v216, v226, v227
    v_lshlrev_b32 v226, 16, v216
    s_waitcnt lgkmcnt(6)
    v_mfma_f32_16x16x32_bf16 v[24:27], v[196:199], v[144:147], v[24:27]
    v_mfma_f32_16x16x32_bf16 v[52:55], v[196:199], v[148:151], v[52:55]
    ds_read_b128 v[168:171], v15 offset:57344
    buffer_load_dwordx4 a[96:99], v2, s[12:15], s40 offen offset:0
    v_and_b32 v227, 0xffff0000, v216
    v_add_f32 v227, 0x3727c5ac, v227
    s_waitcnt lgkmcnt(6)
    v_mfma_f32_16x16x32_bf16 v[28:31], v[200:203], v[144:147], v[28:31]
    v_mfma_f32_16x16x32_bf16 v[56:59], v[200:203], v[148:151], v[56:59]
    ds_read_b128 v[172:175], v15 offset:58368
    buffer_load_dwordx4 a[100:103], v2, s[12:15], s40 offen offset:1024
    v_cvt_pk_bf16_f32 v216, v227, v227
    v_lshlrev_b32 v227, 16, v216
    s_waitcnt lgkmcnt(6)
    v_mfma_f32_16x16x32_bf16 v[32:35], v[204:207], v[144:147], v[32:35]
    v_mfma_f32_16x16x32_bf16 v[60:63], v[204:207], v[148:151], v[60:63]
    ds_read_b128 v[176:179], v15 offset:59392
    v_sqrt_f32 v227, v227
    s_nop 0
    s_waitcnt lgkmcnt(6)
    v_mfma_f32_16x16x32_bf16 v[36:39], v[208:211], v[144:147], v[36:39]
    v_mfma_f32_16x16x32_bf16 v[64:67], v[208:211], v[148:151], v[64:67]
    ds_read_b128 v[180:183], v15 offset:60416
    buffer_load_dwordx4 a[104:107], v2, s[12:15], s40 offen offset:2048
    v_cvt_pk_bf16_f32 v216, v227, v227
    v_lshlrev_b32 v227, 16, v216
    s_waitcnt lgkmcnt(6)
    v_mfma_f32_16x16x32_bf16 v[40:43], v[212:215], v[144:147], v[40:43]
    v_mfma_f32_16x16x32_bf16 v[68:71], v[212:215], v[148:151], v[68:71]
    ds_read_b128 v[184:187], v15 offset:61440
    v_rcp_f32 v227, v227
    s_nop 0
    s_waitcnt vmcnt(28)
    s_waitcnt lgkmcnt(6)
    v_mfma_f32_16x16x32_bf16 v[16:19], v[160:163], v[152:155], v[16:19]
    v_mfma_f32_16x16x32_bf16 v[44:47], v[160:163], v[156:159], v[44:47]
    ds_read_b128 v[188:191], v15 offset:62464
    v_mul_f32 v226, v226, v227
    v_sub_f32 v226, 0, v226
    s_waitcnt lgkmcnt(6)
    v_mfma_f32_16x16x32_bf16 v[20:23], v[164:167], v[152:155], v[20:23]
    v_mfma_f32_16x16x32_bf16 v[48:51], v[164:167], v[156:159], v[48:51]
    ds_read_b128 v[192:195], v15 offset:63488
    s_add_u32 s41, s47, 16384
    buffer_load_dwordx4 v[112:115], v2, s[12:15], s41 offen offset:0 sc1
    s_add_u32 s41, s48, 16384
    buffer_load_dwordx4 v[116:119], v2, s[12:15], s41 offen offset:0 sc1
    s_waitcnt lgkmcnt(6)
    v_mfma_f32_16x16x32_bf16 v[24:27], v[168:171], v[152:155], v[24:27]
    v_mfma_f32_16x16x32_bf16 v[52:55], v[168:171], v[156:159], v[52:55]
    ds_read_b128 v[196:199], v15 offset:64512
    buffer_load_dwordx4 a[108:111], v2, s[12:15], s40 offen offset:3072
    s_add_u32 s40, s40, 4096
    s_waitcnt lgkmcnt(6)
    v_mfma_f32_16x16x32_bf16 v[28:31], v[172:175], v[152:155], v[28:31]
    v_mfma_f32_16x16x32_bf16 v[56:59], v[172:175], v[156:159], v[56:59]
    ds_read_b128 v[200:203], v11 offset:0
    buffer_load_dwordx4 a[112:115], v2, s[12:15], s40 offen offset:0
    s_waitcnt lgkmcnt(6)
    v_mfma_f32_16x16x32_bf16 v[32:35], v[176:179], v[152:155], v[32:35]
    v_mfma_f32_16x16x32_bf16 v[60:63], v[176:179], v[156:159], v[60:63]
    ds_read_b128 v[204:207], v11 offset:1024
    s_waitcnt lgkmcnt(6)
    v_mfma_f32_16x16x32_bf16 v[36:39], v[180:183], v[152:155], v[36:39]
    v_mfma_f32_16x16x32_bf16 v[64:67], v[180:183], v[156:159], v[64:67]
    ds_read_b128 v[208:211], v11 offset:2048
    buffer_load_dwordx4 a[116:119], v2, s[12:15], s40 offen offset:1024
    s_waitcnt lgkmcnt(6)
    v_mfma_f32_16x16x32_bf16 v[40:43], v[184:187], v[152:155], v[40:43]
    v_mfma_f32_16x16x32_bf16 v[68:71], v[184:187], v[156:159], v[68:71]
    ds_read_b128 v[212:215], v11 offset:3072
    s_waitcnt vmcnt(28)
    s_waitcnt lgkmcnt(6)
    v_mfma_f32_16x16x32_bf16 v[16:19], v[188:191], v[72:75], v[16:19]
    v_mfma_f32_16x16x32_bf16 v[44:47], v[188:191], v[76:79], v[44:47]
    ds_read_b128 v[160:163], v11 offset:4096
    s_waitcnt lgkmcnt(6)
    v_mfma_f32_16x16x32_bf16 v[20:23], v[192:195], v[72:75], v[20:23]
    v_mfma_f32_16x16x32_bf16 v[48:51], v[192:195], v[76:79], v[48:51]
    ds_read_b128 v[164:167], v11 offset:5120
    s_add_u32 s41, s47, 16384
    buffer_load_dwordx4 v[120:123], v2, s[12:15], s41 offen offset:1024 sc1
    s_add_u32 s41, s48, 16384
    buffer_load_dwordx4 v[124:127], v2, s[12:15], s41 offen offset:1024 sc1
    s_waitcnt lgkmcnt(6)
    v_mfma_f32_16x16x32_bf16 v[24:27], v[196:199], v[72:75], v[24:27]
    v_mfma_f32_16x16x32_bf16 v[52:55], v[196:199], v[76:79], v[52:55]
    ds_read_b128 v[168:171], v11 offset:6144
    buffer_load_dwordx4 a[120:123], v2, s[12:15], s40 offen offset:2048
    s_waitcnt lgkmcnt(6)
    v_mfma_f32_16x16x32_bf16 v[28:31], v[200:203], v[72:75], v[28:31]
    v_mfma_f32_16x16x32_bf16 v[56:59], v[200:203], v[76:79], v[56:59]
    ds_read_b128 v[172:175], v11 offset:7168
    buffer_load_dwordx4 a[124:127], v2, s[12:15], s40 offen offset:3072
    s_add_u32 s40, s40, 4096
    s_waitcnt lgkmcnt(6)
    v_mfma_f32_16x16x32_bf16 v[32:35], v[204:207], v[72:75], v[32:35]
    v_mfma_f32_16x16x32_bf16 v[60:63], v[204:207], v[76:79], v[60:63]
    ds_read_b128 v[176:179], v11 offset:8192
    s_waitcnt lgkmcnt(6)
    v_mfma_f32_16x16x32_bf16 v[36:39], v[208:211], v[72:75], v[36:39]
    v_mfma_f32_16x16x32_bf16 v[64:67], v[208:211], v[76:79], v[64:67]
    ds_read_b128 v[180:183], v11 offset:9216
    buffer_load_dwordx4 a[128:131], v2, s[12:15], s40 offen offset:0
    s_waitcnt lgkmcnt(6)
    v_mfma_f32_16x16x32_bf16 v[40:43], v[212:215], v[72:75], v[40:43]
    v_mfma_f32_16x16x32_bf16 v[68:71], v[212:215], v[76:79], v[68:71]
    ds_read_b128 v[184:187], v11 offset:10240
    s_waitcnt vmcnt(28)
    s_waitcnt lgkmcnt(6)
    v_mfma_f32_16x16x32_bf16 v[16:19], v[160:163], v[80:83], v[16:19]
    v_mfma_f32_16x16x32_bf16 v[44:47], v[160:163], v[84:87], v[44:47]
    ds_read_b128 v[188:191], v11 offset:11264
    s_waitcnt lgkmcnt(6)
    v_mfma_f32_16x16x32_bf16 v[20:23], v[164:167], v[80:83], v[20:23]
    v_mfma_f32_16x16x32_bf16 v[48:51], v[164:167], v[84:87], v[48:51]
    ds_read_b128 v[192:195], v11 offset:12288
    s_add_u32 s41, s47, 16384
    buffer_load_dwordx4 v[128:131], v2, s[12:15], s41 offen offset:2048 sc1
    s_add_u32 s41, s48, 16384
    buffer_load_dwordx4 v[132:135], v2, s[12:15], s41 offen offset:2048 sc1
    s_waitcnt lgkmcnt(6)
    v_mfma_f32_16x16x32_bf16 v[24:27], v[168:171], v[80:83], v[24:27]
    v_mfma_f32_16x16x32_bf16 v[52:55], v[168:171], v[84:87], v[52:55]
    ds_read_b128 v[196:199], v11 offset:13312
    buffer_load_dwordx4 a[132:135], v2, s[12:15], s40 offen offset:1024
    s_waitcnt lgkmcnt(6)
    v_mfma_f32_16x16x32_bf16 v[28:31], v[172:175], v[80:83], v[28:31]
    v_mfma_f32_16x16x32_bf16 v[56:59], v[172:175], v[84:87], v[56:59]
    ds_read_b128 v[200:203], v11 offset:14336
    buffer_load_dwordx4 a[136:139], v2, s[12:15], s40 offen offset:2048
    s_waitcnt lgkmcnt(6)
    v_mfma_f32_16x16x32_bf16 v[32:35], v[176:179], v[80:83], v[32:35]
    v_mfma_f32_16x16x32_bf16 v[60:63], v[176:179], v[84:87], v[60:63]
    ds_read_b128 v[204:207], v11 offset:15360
    s_waitcnt lgkmcnt(6)
    v_mfma_f32_16x16x32_bf16 v[36:39], v[180:183], v[80:83], v[36:39]
    v_mfma_f32_16x16x32_bf16 v[64:67], v[180:183], v[84:87], v[64:67]
    ds_read_b128 v[208:211], v11 offset:16384
    buffer_load_dwordx4 a[140:143], v2, s[12:15], s40 offen offset:3072
    s_add_u32 s40, s40, 4096
    s_waitcnt lgkmcnt(6)
    v_mfma_f32_16x16x32_bf16 v[40:43], v[184:187], v[80:83], v[40:43]
    v_mfma_f32_16x16x32_bf16 v[68:71], v[184:187], v[84:87], v[68:71]
    ds_read_b128 v[212:215], v11 offset:17408
    buffer_load_dwordx4 a[144:147], v2, s[12:15], s40 offen offset:0
    s_waitcnt vmcnt(29)
    s_waitcnt lgkmcnt(6)
    v_mfma_f32_16x16x32_bf16 v[16:19], v[188:191], v[88:91], v[16:19]
    v_mfma_f32_16x16x32_bf16 v[44:47], v[188:191], v[92:95], v[44:47]
    ds_read_b128 v[160:163], v11 offset:18432
    s_waitcnt lgkmcnt(6)
    v_mfma_f32_16x16x32_bf16 v[20:23], v[192:195], v[88:91], v[20:23]
    v_mfma_f32_16x16x32_bf16 v[48:51], v[192:195], v[92:95], v[48:51]
    ds_read_b128 v[164:167], v11 offset:19456
    s_add_u32 s41, s47, 16384
    buffer_load_dwordx4 v[136:139], v2, s[12:15], s41 offen offset:3072 sc1
    s_add_u32 s41, s48, 16384
    buffer_load_dwordx4 v[140:143], v2, s[12:15], s41 offen offset:3072 sc1
    s_waitcnt lgkmcnt(6)
    v_mfma_f32_16x16x32_bf16 v[24:27], v[196:199], v[88:91], v[24:27]
    v_mfma_f32_16x16x32_bf16 v[52:55], v[196:199], v[92:95], v[52:55]
    ds_read_b128 v[168:171], v11 offset:20480
    buffer_load_dwordx4 a[148:151], v2, s[12:15], s40 offen offset:1024
    s_waitcnt lgkmcnt(6)
    v_mfma_f32_16x16x32_bf16 v[28:31], v[200:203], v[88:91], v[28:31]
    v_mfma_f32_16x16x32_bf16 v[56:59], v[200:203], v[92:95], v[56:59]
    ds_read_b128 v[172:175], v11 offset:21504
    buffer_load_dwordx4 a[152:155], v2, s[12:15], s40 offen offset:2048
    s_waitcnt lgkmcnt(6)
    v_mfma_f32_16x16x32_bf16 v[32:35], v[204:207], v[88:91], v[32:35]
    v_mfma_f32_16x16x32_bf16 v[60:63], v[204:207], v[92:95], v[60:63]
    ds_read_b128 v[176:179], v11 offset:22528
    s_waitcnt lgkmcnt(6)
    v_mfma_f32_16x16x32_bf16 v[36:39], v[208:211], v[88:91], v[36:39]
    v_mfma_f32_16x16x32_bf16 v[64:67], v[208:211], v[92:95], v[64:67]
    ds_read_b128 v[180:183], v11 offset:23552
    buffer_load_dwordx4 a[156:159], v2, s[12:15], s40 offen offset:3072
    s_add_u32 s40, s40, 4096
    s_waitcnt lgkmcnt(6)
    v_mfma_f32_16x16x32_bf16 v[40:43], v[212:215], v[88:91], v[40:43]
    v_mfma_f32_16x16x32_bf16 v[68:71], v[212:215], v[92:95], v[68:71]
    ds_read_b128 v[184:187], v14 offset:0
    buffer_load_dwordx4 a[160:163], v2, s[12:15], s40 offen offset:0
    s_add_u32 s48, s54, 368640
    buffer_load_dwordx4 v[228:231], v254, s[12:15], s48 offen sc1
    buffer_load_dwordx4 v[232:235], v254, s[12:15], s48 offen offset:1024 sc1
    buffer_load_dwordx2 v[236:237], v8, s[12:15], s48 offen offset:2048 sc1
    s_waitcnt vmcnt(33)
    s_waitcnt lgkmcnt(6)
    v_mfma_f32_16x16x32_bf16 v[16:19], v[160:163], v[96:99], v[16:19]
    v_mfma_f32_16x16x32_bf16 v[44:47], v[160:163], v[100:103], v[44:47]
    ds_read_b128 v[188:191], v14 offset:1024
    s_waitcnt lgkmcnt(6)
    v_mfma_f32_16x16x32_bf16 v[20:23], v[164:167], v[96:99], v[20:23]
    v_mfma_f32_16x16x32_bf16 v[48:51], v[164:167], v[100:103], v[48:51]
    ds_read_b128 v[192:195], v14 offset:2048
    s_waitcnt lgkmcnt(6)
    v_mfma_f32_16x16x32_bf16 v[24:27], v[168:171], v[96:99], v[24:27]
    v_mfma_f32_16x16x32_bf16 v[52:55], v[168:171], v[100:103], v[52:55]
    ds_read_b128 v[196:199], v14 offset:3072
    buffer_load_dwordx4 a[164:167], v2, s[12:15], s40 offen offset:1024
    s_waitcnt lgkmcnt(6)
    v_mfma_f32_16x16x32_bf16 v[28:31], v[172:175], v[96:99], v[28:31]
    v_mfma_f32_16x16x32_bf16 v[56:59], v[172:175], v[100:103], v[56:59]
    ds_read_b128 v[200:203], v14 offset:4096
    buffer_load_dwordx4 a[168:171], v2, s[12:15], s40 offen offset:2048
    s_waitcnt lgkmcnt(6)
    v_mfma_f32_16x16x32_bf16 v[32:35], v[176:179], v[96:99], v[32:35]
    v_mfma_f32_16x16x32_bf16 v[60:63], v[176:179], v[100:103], v[60:63]
    ds_read_b128 v[204:207], v14 offset:5120
    s_waitcnt lgkmcnt(6)
    v_mfma_f32_16x16x32_bf16 v[36:39], v[180:183], v[96:99], v[36:39]
    v_mfma_f32_16x16x32_bf16 v[64:67], v[180:183], v[100:103], v[64:67]
    ds_read_b128 v[208:211], v14 offset:6144
    buffer_load_dwordx4 a[172:175], v2, s[12:15], s40 offen offset:3072
    s_add_u32 s40, s40, 4096
    s_waitcnt lgkmcnt(6)
    v_mfma_f32_16x16x32_bf16 v[40:43], v[184:187], v[96:99], v[40:43]
    v_mfma_f32_16x16x32_bf16 v[68:71], v[184:187], v[100:103], v[68:71]
    ds_read_b128 v[212:215], v14 offset:7168
    buffer_load_dwordx4 a[176:179], v2, s[12:15], s40 offen offset:0
    s_add_u32 s48, s54, 20480
    buffer_load_dwordx4 v[238:241], v254, s[12:15], s48 offen sc1
    buffer_load_dwordx4 v[242:245], v254, s[12:15], s48 offen offset:1024 sc1
    buffer_load_dwordx2 v[246:247], v8, s[12:15], s48 offen offset:2048 sc1
    s_waitcnt vmcnt(35)
    s_waitcnt lgkmcnt(6)
    v_mfma_f32_16x16x32_bf16 v[16:19], v[188:191], v[104:107], v[16:19]
    v_mfma_f32_16x16x32_bf16 v[44:47], v[188:191], v[108:111], v[44:47]
    ds_read_b128 v[160:163], v14 offset:8192
    s_waitcnt lgkmcnt(6)
    v_mfma_f32_16x16x32_bf16 v[20:23], v[192:195], v[104:107], v[20:23]
    v_mfma_f32_16x16x32_bf16 v[48:51], v[192:195], v[108:111], v[48:51]
    ds_read_b128 v[164:167], v14 offset:9216
    s_waitcnt lgkmcnt(6)
    v_mfma_f32_16x16x32_bf16 v[24:27], v[196:199], v[104:107], v[24:27]
    v_mfma_f32_16x16x32_bf16 v[52:55], v[196:199], v[108:111], v[52:55]
    ds_read_b128 v[168:171], v14 offset:10240
    buffer_load_dwordx4 a[180:183], v2, s[12:15], s40 offen offset:1024
    s_waitcnt lgkmcnt(6)
    v_mfma_f32_16x16x32_bf16 v[28:31], v[200:203], v[104:107], v[28:31]
    v_mfma_f32_16x16x32_bf16 v[56:59], v[200:203], v[108:111], v[56:59]
    ds_read_b128 v[172:175], v14 offset:11264
    buffer_load_dwordx4 a[184:187], v2, s[12:15], s40 offen offset:2048
    s_waitcnt lgkmcnt(6)
    v_mfma_f32_16x16x32_bf16 v[32:35], v[204:207], v[104:107], v[32:35]
    v_mfma_f32_16x16x32_bf16 v[60:63], v[204:207], v[108:111], v[60:63]
    ds_read_b128 v[176:179], v14 offset:12288
    s_waitcnt lgkmcnt(6)
    v_mfma_f32_16x16x32_bf16 v[36:39], v[208:211], v[104:107], v[36:39]
    v_mfma_f32_16x16x32_bf16 v[64:67], v[208:211], v[108:111], v[64:67]
    ds_read_b128 v[180:183], v14 offset:13312
    buffer_load_dwordx4 a[188:191], v2, s[12:15], s40 offen offset:3072
    s_add_u32 s40, s40, 4096
    s_waitcnt lgkmcnt(6)
    v_mfma_f32_16x16x32_bf16 v[40:43], v[212:215], v[104:107], v[40:43]
    v_mfma_f32_16x16x32_bf16 v[68:71], v[212:215], v[108:111], v[68:71]
    ds_read_b128 v[184:187], v14 offset:14336
    buffer_load_dwordx4 a[192:195], v2, s[12:15], s40 offen offset:0
    s_waitcnt vmcnt(34)
    s_waitcnt lgkmcnt(6)
    v_mfma_f32_16x16x32_bf16 v[16:19], v[160:163], v[112:115], v[16:19]
    v_mfma_f32_16x16x32_bf16 v[44:47], v[160:163], v[116:119], v[44:47]
    ds_read_b128 v[188:191], v14 offset:15360
    s_waitcnt lgkmcnt(6)
    v_mfma_f32_16x16x32_bf16 v[20:23], v[164:167], v[112:115], v[20:23]
    v_mfma_f32_16x16x32_bf16 v[48:51], v[164:167], v[116:119], v[48:51]
    ds_read_b128 v[192:195], v14 offset:16384
    s_waitcnt lgkmcnt(6)
    v_mfma_f32_16x16x32_bf16 v[24:27], v[168:171], v[112:115], v[24:27]
    v_mfma_f32_16x16x32_bf16 v[52:55], v[168:171], v[116:119], v[52:55]
    ds_read_b128 v[196:199], v14 offset:17408
    buffer_load_dwordx4 a[196:199], v2, s[12:15], s40 offen offset:1024
    s_waitcnt lgkmcnt(6)
    v_mfma_f32_16x16x32_bf16 v[28:31], v[172:175], v[112:115], v[28:31]
    v_mfma_f32_16x16x32_bf16 v[56:59], v[172:175], v[116:119], v[56:59]
    ds_read_b128 v[200:203], v14 offset:18432
    buffer_load_dwordx4 a[200:203], v2, s[12:15], s40 offen offset:2048
    s_waitcnt lgkmcnt(6)
    v_mfma_f32_16x16x32_bf16 v[32:35], v[176:179], v[112:115], v[32:35]
    v_mfma_f32_16x16x32_bf16 v[60:63], v[176:179], v[116:119], v[60:63]
    ds_read_b128 v[204:207], v14 offset:19456
    s_waitcnt lgkmcnt(6)
    v_mfma_f32_16x16x32_bf16 v[36:39], v[180:183], v[112:115], v[36:39]
    v_mfma_f32_16x16x32_bf16 v[64:67], v[180:183], v[116:119], v[64:67]
    ds_read_b128 v[208:211], v14 offset:20480
    buffer_load_dwordx4 a[204:207], v2, s[12:15], s40 offen offset:3072
    s_add_u32 s40, s40, 4096
    s_waitcnt lgkmcnt(6)
    v_mfma_f32_16x16x32_bf16 v[40:43], v[184:187], v[112:115], v[40:43]
    v_mfma_f32_16x16x32_bf16 v[68:71], v[184:187], v[116:119], v[68:71]
    ds_read_b128 v[212:215], v14 offset:21504
    buffer_load_dwordx4 a[208:211], v2, s[12:15], s40 offen offset:0
    s_waitcnt vmcnt(33)
    s_waitcnt lgkmcnt(6)
    v_mfma_f32_16x16x32_bf16 v[16:19], v[188:191], v[120:123], v[16:19]
    v_mfma_f32_16x16x32_bf16 v[44:47], v[188:191], v[124:127], v[44:47]
    ds_read_b128 v[160:163], v14 offset:22528
    s_waitcnt lgkmcnt(6)
    v_mfma_f32_16x16x32_bf16 v[20:23], v[192:195], v[120:123], v[20:23]
    v_mfma_f32_16x16x32_bf16 v[48:51], v[192:195], v[124:127], v[48:51]
    ds_read_b128 v[164:167], v14 offset:23552
    s_waitcnt lgkmcnt(6)
    v_mfma_f32_16x16x32_bf16 v[24:27], v[196:199], v[120:123], v[24:27]
    v_mfma_f32_16x16x32_bf16 v[52:55], v[196:199], v[124:127], v[52:55]
    ds_read_b128 v[168:171], v14 offset:24576
    buffer_load_dwordx4 a[212:215], v2, s[12:15], s40 offen offset:1024
    s_waitcnt lgkmcnt(6)
    v_mfma_f32_16x16x32_bf16 v[28:31], v[200:203], v[120:123], v[28:31]
    v_mfma_f32_16x16x32_bf16 v[56:59], v[200:203], v[124:127], v[56:59]
    ds_read_b128 v[172:175], v14 offset:25600
    buffer_load_dwordx4 a[216:219], v2, s[12:15], s40 offen offset:2048
    s_waitcnt lgkmcnt(6)
    v_mfma_f32_16x16x32_bf16 v[32:35], v[204:207], v[120:123], v[32:35]
    v_mfma_f32_16x16x32_bf16 v[60:63], v[204:207], v[124:127], v[60:63]
    ds_read_b128 v[176:179], v14 offset:26624
    s_waitcnt lgkmcnt(6)
    v_mfma_f32_16x16x32_bf16 v[36:39], v[208:211], v[120:123], v[36:39]
    v_mfma_f32_16x16x32_bf16 v[64:67], v[208:211], v[124:127], v[64:67]
    ds_read_b128 v[180:183], v14 offset:27648
    buffer_load_dwordx4 a[220:223], v2, s[12:15], s40 offen offset:3072
    s_add_u32 s40, s40, 4096
    s_waitcnt lgkmcnt(6)
    v_mfma_f32_16x16x32_bf16 v[40:43], v[212:215], v[120:123], v[40:43]
    v_mfma_f32_16x16x32_bf16 v[68:71], v[212:215], v[124:127], v[68:71]
    ds_read_b128 v[184:187], v14 offset:28672
    buffer_load_dwordx4 a[224:227], v2, s[12:15], s40 offen offset:0
    s_waitcnt vmcnt(32)
    s_waitcnt lgkmcnt(6)
    v_mfma_f32_16x16x32_bf16 v[16:19], v[160:163], v[128:131], v[16:19]
    v_mfma_f32_16x16x32_bf16 v[44:47], v[160:163], v[132:135], v[44:47]
    ds_read_b128 v[188:191], v14 offset:29696
    s_waitcnt lgkmcnt(6)
    v_mfma_f32_16x16x32_bf16 v[20:23], v[164:167], v[128:131], v[20:23]
    v_mfma_f32_16x16x32_bf16 v[48:51], v[164:167], v[132:135], v[48:51]
    ds_read_b128 v[192:195], v14 offset:30720
    s_waitcnt lgkmcnt(6)
    v_mfma_f32_16x16x32_bf16 v[24:27], v[168:171], v[128:131], v[24:27]
    v_mfma_f32_16x16x32_bf16 v[52:55], v[168:171], v[132:135], v[52:55]
    ds_read_b128 v[196:199], v14 offset:31744
    buffer_load_dwordx4 a[228:231], v2, s[12:15], s40 offen offset:1024
    s_waitcnt lgkmcnt(6)
    v_mfma_f32_16x16x32_bf16 v[28:31], v[172:175], v[128:131], v[28:31]
    v_mfma_f32_16x16x32_bf16 v[56:59], v[172:175], v[132:135], v[56:59]
    ds_read_b128 v[200:203], v14 offset:32768
    buffer_load_dwordx4 a[232:235], v2, s[12:15], s40 offen offset:2048
    s_waitcnt lgkmcnt(6)
    v_mfma_f32_16x16x32_bf16 v[32:35], v[176:179], v[128:131], v[32:35]
    v_mfma_f32_16x16x32_bf16 v[60:63], v[176:179], v[132:135], v[60:63]
    ds_read_b128 v[204:207], v14 offset:33792
    s_waitcnt lgkmcnt(6)
    v_mfma_f32_16x16x32_bf16 v[36:39], v[180:183], v[128:131], v[36:39]
    v_mfma_f32_16x16x32_bf16 v[64:67], v[180:183], v[132:135], v[64:67]
    ds_read_b128 v[208:211], v14 offset:34816
    buffer_load_dwordx4 a[236:239], v2, s[12:15], s40 offen offset:3072
    s_add_u32 s40, s40, 4096
    s_cmp_eq_u32 s30, 3
    s_cselect_b32 s41, 61440, 0
    s_sub_u32 s40, s40, s41
    s_waitcnt lgkmcnt(6)
    v_mfma_f32_16x16x32_bf16 v[40:43], v[184:187], v[128:131], v[40:43]
    v_mfma_f32_16x16x32_bf16 v[68:71], v[184:187], v[132:135], v[68:71]
    ds_read_b128 v[212:215], v14 offset:35840
    buffer_load_dwordx4 a[240:243], v2, s[12:15], s40 offen offset:0
    s_waitcnt vmcnt(30)
    s_waitcnt lgkmcnt(6)
    v_mfma_f32_16x16x32_bf16 v[16:19], v[188:191], v[136:139], v[16:19]
    v_mfma_f32_16x16x32_bf16 v[44:47], v[188:191], v[140:143], v[44:47]
    s_waitcnt lgkmcnt(5)
    v_mfma_f32_16x16x32_bf16 v[20:23], v[192:195], v[136:139], v[20:23]
    v_mfma_f32_16x16x32_bf16 v[48:51], v[192:195], v[140:143], v[48:51]
    s_waitcnt lgkmcnt(4)
    v_mfma_f32_16x16x32_bf16 v[24:27], v[196:199], v[136:139], v[24:27]
    v_mfma_f32_16x16x32_bf16 v[52:55], v[196:199], v[140:143], v[52:55]
    buffer_load_dwordx4 a[244:247], v2, s[12:15], s40 offen offset:1024
    s_waitcnt lgkmcnt(3)
    v_mfma_f32_16x16x32_bf16 v[28:31], v[200:203], v[136:139], v[28:31]
    v_mfma_f32_16x16x32_bf16 v[56:59], v[200:203], v[140:143], v[56:59]
    buffer_load_dwordx4 a[248:251], v2, s[12:15], s40 offen offset:2048
    s_waitcnt lgkmcnt(2)
    v_mfma_f32_16x16x32_bf16 v[32:35], v[204:207], v[136:139], v[32:35]
    v_mfma_f32_16x16x32_bf16 v[60:63], v[204:207], v[140:143], v[60:63]
    s_waitcnt lgkmcnt(1)
    v_mfma_f32_16x16x32_bf16 v[36:39], v[208:211], v[136:139], v[36:39]
    v_mfma_f32_16x16x32_bf16 v[64:67], v[208:211], v[140:143], v[64:67]
    buffer_load_dwordx4 a[252:255], v2, s[12:15], s40 offen offset:3072
    s_add_u32 s40, s40, 4096
    s_waitcnt lgkmcnt(0)
    v_mfma_f32_16x16x32_bf16 v[40:43], v[212:215], v[136:139], v[40:43]
    v_mfma_f32_16x16x32_bf16 v[68:71], v[212:215], v[140:143], v[68:71]
    v_lshlrev_b32 v9, 4, v3
    v_add_u32 v9, 156672, v9
    v_mov_b32 v12, 0xbdd2d3e8
    v_mov_b32 v13, 0xc0135761
    ds_read_b128 v[72:75], v9 offset:0
    ds_read_b128 v[100:103], v9 offset:512
    ds_read_b128 v[76:79], v9 offset:64
    ds_read_b128 v[104:107], v9 offset:576
    ds_read_b128 v[80:83], v9 offset:128
    ds_read_b128 v[108:111], v9 offset:640
    ds_read_b128 v[84:87], v9 offset:192
    ds_read_b128 v[112:115], v9 offset:704
    ds_read_b128 v[88:91], v9 offset:256
    ds_read_b128 v[116:119], v9 offset:768
    ds_read_b128 v[92:95], v9 offset:320
    ds_read_b128 v[120:123], v9 offset:832
    ds_read_b128 v[96:99], v9 offset:384
    ds_read_b128 v[124:127], v9 offset:896
    s_waitcnt lgkmcnt(0)
    v_pk_add_f32 v[72:73], v[72:73], v[100:101]
    v_pk_add_f32 v[74:75], v[74:75], v[102:103]
    v_pk_add_f32 v[76:77], v[76:77], v[104:105]
    v_pk_add_f32 v[78:79], v[78:79], v[106:107]
    v_pk_add_f32 v[80:81], v[80:81], v[108:109]
    v_pk_add_f32 v[82:83], v[82:83], v[110:111]
    v_pk_add_f32 v[84:85], v[84:85], v[112:113]
    v_pk_add_f32 v[86:87], v[86:87], v[114:115]
    v_pk_add_f32 v[88:89], v[88:89], v[116:117]
    v_pk_add_f32 v[90:91], v[90:91], v[118:119]
    v_pk_add_f32 v[92:93], v[92:93], v[120:121]
    v_pk_add_f32 v[94:95], v[94:95], v[122:123]
    v_pk_add_f32 v[96:97], v[96:97], v[124:125]
    v_pk_add_f32 v[98:99], v[98:99], v[126:127]
    s_lshl_b32 s49, s34, 2
    s_add_u32 s49, s49, s30
    s_lshl_b32 s49, s49, 7
    s_add_u32 s49, s49, s37
    s_lshl_b32 s41, s35, 2
    s_add_u32 s49, s49, s41
    v_pk_mul_f32 v[160:161], v[72:73], v[224:225] op_sel_hi:[1,0]
    v_pk_mul_f32 v[162:163], v[74:75], v[224:225] op_sel_hi:[1,0]
    v_pk_mul_f32 v[164:165], v[72:73], v[226:227] op_sel_hi:[1,0]
    v_pk_mul_f32 v[166:167], v[74:75], v[226:227] op_sel_hi:[1,0]
    v_pk_mul_f32 v[168:169], v[76:77], v[224:225] op_sel_hi:[1,0]
    v_pk_mul_f32 v[170:171], v[78:79], v[224:225] op_sel_hi:[1,0]
    v_pk_mul_f32 v[172:173], v[76:77], v[226:227] op_sel_hi:[1,0]
    v_pk_mul_f32 v[174:175], v[78:79], v[226:227] op_sel_hi:[1,0]
    v_pk_fma_f32 v[16:17], v[16:17], v[224:225], v[160:161] op_sel:[0,1,0] op_sel_hi:[1,1,1]
    v_pk_fma_f32 v[18:19], v[18:19], v[224:225], v[162:163] op_sel:[0,1,0] op_sel_hi:[1,1,1]
    v_pk_fma_f32 v[44:45], v[44:45], v[226:227], v[164:165] op_sel:[0,1,0] op_sel_hi:[1,1,1]
    v_pk_fma_f32 v[46:47], v[46:47], v[226:227], v[166:167] op_sel:[0,1,0] op_sel_hi:[1,1,1]
    v_pk_fma_f32 v[20:21], v[20:21], v[224:225], v[168:169] op_sel:[0,1,0] op_sel_hi:[1,1,1]
    v_pk_fma_f32 v[22:23], v[22:23], v[224:225], v[170:171] op_sel:[0,1,0] op_sel_hi:[1,1,1]
    v_pk_fma_f32 v[48:49], v[48:49], v[226:227], v[172:173] op_sel:[0,1,0] op_sel_hi:[1,1,1]
    v_pk_fma_f32 v[50:51], v[50:51], v[226:227], v[174:175] op_sel:[0,1,0] op_sel_hi:[1,1,1]
    v_pk_mul_f32 v[160:161], v[16:17], v[16:17]
    v_pk_mul_f32 v[162:163], v[18:19], v[18:19]
    v_pk_mul_f32 v[164:165], v[44:45], v[44:45]
    v_pk_mul_f32 v[166:167], v[46:47], v[46:47]
    v_pk_mul_f32 v[168:169], v[20:21], v[20:21]
    v_pk_mul_f32 v[170:171], v[22:23], v[22:23]
    v_pk_mul_f32 v[172:173], v[48:49], v[48:49]
    v_pk_mul_f32 v[174:175], v[50:51], v[50:51]
    v_pk_fma_f32 v[160:161], v[160:161], v[12:13], v[12:13] op_sel:[0,0,1] op_sel_hi:[1,0,1]
    v_pk_fma_f32 v[162:163], v[162:163], v[12:13], v[12:13] op_sel:[0,0,1] op_sel_hi:[1,0,1]
    v_pk_fma_f32 v[164:165], v[164:165], v[12:13], v[12:13] op_sel:[0,0,1] op_sel_hi:[1,0,1]
    v_pk_fma_f32 v[166:167], v[166:167], v[12:13], v[12:13] op_sel:[0,0,1] op_sel_hi:[1,0,1]
    v_pk_fma_f32 v[168:169], v[168:169], v[12:13], v[12:13] op_sel:[0,0,1] op_sel_hi:[1,0,1]
    v_pk_fma_f32 v[170:171], v[170:171], v[12:13], v[12:13] op_sel:[0,0,1] op_sel_hi:[1,0,1]
    v_pk_fma_f32 v[172:173], v[172:173], v[12:13], v[12:13] op_sel:[0,0,1] op_sel_hi:[1,0,1]
    v_pk_fma_f32 v[174:175], v[174:175], v[12:13], v[12:13] op_sel:[0,0,1] op_sel_hi:[1,0,1]
    v_pk_mul_f32 v[160:161], v[160:161], v[16:17]
    v_pk_mul_f32 v[162:163], v[162:163], v[18:19]
    v_pk_mul_f32 v[164:165], v[164:165], v[44:45]
    v_pk_mul_f32 v[166:167], v[166:167], v[46:47]
    v_pk_mul_f32 v[168:169], v[168:169], v[20:21]
    v_pk_mul_f32 v[170:171], v[170:171], v[22:23]
    v_pk_mul_f32 v[172:173], v[172:173], v[48:49]
    v_pk_mul_f32 v[174:175], v[174:175], v[50:51]
    v_exp_f32 v160, v160
    v_exp_f32 v161, v161
    v_exp_f32 v162, v162
    v_exp_f32 v163, v163
    v_exp_f32 v164, v164
    v_exp_f32 v165, v165
    v_exp_f32 v166, v166
    v_exp_f32 v167, v167
    v_exp_f32 v168, v168
    v_exp_f32 v169, v169
    v_exp_f32 v170, v170
    v_exp_f32 v171, v171
    v_exp_f32 v172, v172
    v_exp_f32 v173, v173
    v_exp_f32 v174, v174
    v_exp_f32 v175, v175
    v_pk_add_f32 v[160:161], v[160:161], 1.0 op_sel_hi:[1,0]
    v_pk_add_f32 v[162:163], v[162:163], 1.0 op_sel_hi:[1,0]
    v_pk_add_f32 v[164:165], v[164:165], 1.0 op_sel_hi:[1,0]
    v_pk_add_f32 v[166:167], v[166:167], 1.0 op_sel_hi:[1,0]
    v_pk_add_f32 v[168:169], v[168:169], 1.0 op_sel_hi:[1,0]
    v_pk_add_f32 v[170:171], v[170:171], 1.0 op_sel_hi:[1,0]
    v_pk_add_f32 v[172:173], v[172:173], 1.0 op_sel_hi:[1,0]
    v_pk_add_f32 v[174:175], v[174:175], 1.0 op_sel_hi:[1,0]
    v_rcp_f32 v160, v160
    v_rcp_f32 v161, v161
    v_rcp_f32 v162, v162
    v_rcp_f32 v163, v163
    v_rcp_f32 v164, v164
    v_rcp_f32 v165, v165
    v_rcp_f32 v166, v166
    v_rcp_f32 v167, v167
    v_rcp_f32 v168, v168
    v_rcp_f32 v169, v169
    v_rcp_f32 v170, v170
    v_rcp_f32 v171, v171
    v_rcp_f32 v172, v172
    v_rcp_f32 v173, v173
    v_rcp_f32 v174, v174
    v_rcp_f32 v175, v175
    s_nop 0
    v_pk_mul_f32 v[16:17], v[16:17], v[160:161]
    v_pk_mul_f32 v[18:19], v[18:19], v[162:163]
    v_pk_mul_f32 v[44:45], v[44:45], v[164:165]
    v_pk_mul_f32 v[46:47], v[46:47], v[166:167]
    v_pk_mul_f32 v[20:21], v[20:21], v[168:169]
    v_pk_mul_f32 v[22:23], v[22:23], v[170:171]
    v_pk_mul_f32 v[48:49], v[48:49], v[172:173]
    v_pk_mul_f32 v[50:51], v[50:51], v[174:175]
    v_cvt_pk_bf16_f32 v16, v16, v17
    v_cvt_pk_bf16_f32 v17, v18, v19
    v_cvt_pk_bf16_f32 v18, v20, v21
    v_cvt_pk_bf16_f32 v19, v22, v23
    v_cvt_pk_bf16_f32 v44, v44, v45
    v_cvt_pk_bf16_f32 v45, v46, v47
    v_cvt_pk_bf16_f32 v46, v48, v49
    v_cvt_pk_bf16_f32 v47, v50, v51
    s_nop 1
    v_permlane16_swap_b32 v16, v18
    v_permlane16_swap_b32 v17, v19
    v_permlane16_swap_b32 v44, v46
    v_permlane16_swap_b32 v45, v47
    buffer_store_dwordx4 v[16:19], v254, s[12:15], s52 offen offset:0 sc1
    buffer_store_dwordx4 v[44:47], v254, s[12:15], s53 offen offset:0 sc1
k2_kernel_gs30:
    v_pk_mul_f32 v[160:161], v[80:81], v[224:225] op_sel_hi:[1,0]
    v_pk_mul_f32 v[162:163], v[82:83], v[224:225] op_sel_hi:[1,0]
    v_pk_mul_f32 v[164:165], v[80:81], v[226:227] op_sel_hi:[1,0]
    v_pk_mul_f32 v[166:167], v[82:83], v[226:227] op_sel_hi:[1,0]
    v_pk_mul_f32 v[168:169], v[84:85], v[224:225] op_sel_hi:[1,0]
    v_pk_mul_f32 v[170:171], v[86:87], v[224:225] op_sel_hi:[1,0]
    v_pk_mul_f32 v[172:173], v[84:85], v[226:227] op_sel_hi:[1,0]
    v_pk_mul_f32 v[174:175], v[86:87], v[226:227] op_sel_hi:[1,0]
    v_pk_fma_f32 v[24:25], v[24:25], v[224:225], v[160:161] op_sel:[0,1,0] op_sel_hi:[1,1,1]
    v_pk_fma_f32 v[26:27], v[26:27], v[224:225], v[162:163] op_sel:[0,1,0] op_sel_hi:[1,1,1]
    v_pk_fma_f32 v[52:53], v[52:53], v[226:227], v[164:165] op_sel:[0,1,0] op_sel_hi:[1,1,1]
    v_pk_fma_f32 v[54:55], v[54:55], v[226:227], v[166:167] op_sel:[0,1,0] op_sel_hi:[1,1,1]
    v_pk_fma_f32 v[28:29], v[28:29], v[224:225], v[168:169] op_sel:[0,1,0] op_sel_hi:[1,1,1]
    v_pk_fma_f32 v[30:31], v[30:31], v[224:225], v[170:171] op_sel:[0,1,0] op_sel_hi:[1,1,1]
    v_pk_fma_f32 v[56:57], v[56:57], v[226:227], v[172:173] op_sel:[0,1,0] op_sel_hi:[1,1,1]
    v_pk_fma_f32 v[58:59], v[58:59], v[226:227], v[174:175] op_sel:[0,1,0] op_sel_hi:[1,1,1]
    v_pk_mul_f32 v[160:161], v[24:25], v[24:25]
    v_pk_mul_f32 v[162:163], v[26:27], v[26:27]
    v_pk_mul_f32 v[164:165], v[52:53], v[52:53]
    v_pk_mul_f32 v[166:167], v[54:55], v[54:55]
    v_pk_mul_f32 v[168:169], v[28:29], v[28:29]
    v_pk_mul_f32 v[170:171], v[30:31], v[30:31]
    v_pk_mul_f32 v[172:173], v[56:57], v[56:57]
    v_pk_mul_f32 v[174:175], v[58:59], v[58:59]
    v_pk_fma_f32 v[160:161], v[160:161], v[12:13], v[12:13] op_sel:[0,0,1] op_sel_hi:[1,0,1]
    v_pk_fma_f32 v[162:163], v[162:163], v[12:13], v[12:13] op_sel:[0,0,1] op_sel_hi:[1,0,1]
    v_pk_fma_f32 v[164:165], v[164:165], v[12:13], v[12:13] op_sel:[0,0,1] op_sel_hi:[1,0,1]
    v_pk_fma_f32 v[166:167], v[166:167], v[12:13], v[12:13] op_sel:[0,0,1] op_sel_hi:[1,0,1]
    v_pk_fma_f32 v[168:169], v[168:169], v[12:13], v[12:13] op_sel:[0,0,1] op_sel_hi:[1,0,1]
    v_pk_fma_f32 v[170:171], v[170:171], v[12:13], v[12:13] op_sel:[0,0,1] op_sel_hi:[1,0,1]
    v_pk_fma_f32 v[172:173], v[172:173], v[12:13], v[12:13] op_sel:[0,0,1] op_sel_hi:[1,0,1]
    v_pk_fma_f32 v[174:175], v[174:175], v[12:13], v[12:13] op_sel:[0,0,1] op_sel_hi:[1,0,1]
    v_pk_mul_f32 v[160:161], v[160:161], v[24:25]
    v_pk_mul_f32 v[162:163], v[162:163], v[26:27]
    v_pk_mul_f32 v[164:165], v[164:165], v[52:53]
    v_pk_mul_f32 v[166:167], v[166:167], v[54:55]
    v_pk_mul_f32 v[168:169], v[168:169], v[28:29]
    v_pk_mul_f32 v[170:171], v[170:171], v[30:31]
    v_pk_mul_f32 v[172:173], v[172:173], v[56:57]
    v_pk_mul_f32 v[174:175], v[174:175], v[58:59]
    v_exp_f32 v160, v160
    v_exp_f32 v161, v161
    v_exp_f32 v162, v162
    v_exp_f32 v163, v163
    v_exp_f32 v164, v164
    v_exp_f32 v165, v165
    v_exp_f32 v166, v166
    v_exp_f32 v167, v167
    v_exp_f32 v168, v168
    v_exp_f32 v169, v169
    v_exp_f32 v170, v170
    v_exp_f32 v171, v171
    v_exp_f32 v172, v172
    v_exp_f32 v173, v173
    v_exp_f32 v174, v174
    v_exp_f32 v175, v175
    v_pk_add_f32 v[160:161], v[160:161], 1.0 op_sel_hi:[1,0]
    v_pk_add_f32 v[162:163], v[162:163], 1.0 op_sel_hi:[1,0]
    v_pk_add_f32 v[164:165], v[164:165], 1.0 op_sel_hi:[1,0]
    v_pk_add_f32 v[166:167], v[166:167], 1.0 op_sel_hi:[1,0]
    v_pk_add_f32 v[168:169], v[168:169], 1.0 op_sel_hi:[1,0]
    v_pk_add_f32 v[170:171], v[170:171], 1.0 op_sel_hi:[1,0]
    v_pk_add_f32 v[172:173], v[172:173], 1.0 op_sel_hi:[1,0]
    v_pk_add_f32 v[174:175], v[174:175], 1.0 op_sel_hi:[1,0]
    v_rcp_f32 v160, v160
    v_rcp_f32 v161, v161
    v_rcp_f32 v162, v162
    v_rcp_f32 v163, v163
    v_rcp_f32 v164, v164
    v_rcp_f32 v165, v165
    v_rcp_f32 v166, v166
    v_rcp_f32 v167, v167
    v_rcp_f32 v168, v168
    v_rcp_f32 v169, v169
    v_rcp_f32 v170, v170
    v_rcp_f32 v171, v171
    v_rcp_f32 v172, v172
    v_rcp_f32 v173, v173
    v_rcp_f32 v174, v174
    v_rcp_f32 v175, v175
    s_nop 0
    v_pk_mul_f32 v[24:25], v[24:25], v[160:161]
    v_pk_mul_f32 v[26:27], v[26:27], v[162:163]
    v_pk_mul_f32 v[52:53], v[52:53], v[164:165]
    v_pk_mul_f32 v[54:55], v[54:55], v[166:167]
    v_pk_mul_f32 v[28:29], v[28:29], v[168:169]
    v_pk_mul_f32 v[30:31], v[30:31], v[170:171]
    v_pk_mul_f32 v[56:57], v[56:57], v[172:173]
    v_pk_mul_f32 v[58:59], v[58:59], v[174:175]
    v_cvt_pk_bf16_f32 v24, v24, v25
    v_cvt_pk_bf16_f32 v25, v26, v27
    v_cvt_pk_bf16_f32 v26, v28, v29
    v_cvt_pk_bf16_f32 v27, v30, v31
    v_cvt_pk_bf16_f32 v52, v52, v53
    v_cvt_pk_bf16_f32 v53, v54, v55
    v_cvt_pk_bf16_f32 v54, v56, v57
    v_cvt_pk_bf16_f32 v55, v58, v59
    s_nop 1
    v_permlane16_swap_b32 v24, v26
    v_permlane16_swap_b32 v25, v27
    v_permlane16_swap_b32 v52, v54
    v_permlane16_swap_b32 v53, v55
    s_cmp_eq_u32 s35, 15
    s_cselect_b32 s46, 0xffff, -1
    s_mov_b32 exec_lo, s46
    s_mov_b32 exec_hi, s46
    buffer_store_dwordx4 v[24:27], v254, s[12:15], s52 offen offset:1024 sc1
    buffer_store_dwordx4 v[52:55], v254, s[12:15], s53 offen offset:1024 sc1
    s_mov_b64 exec, -1
k2_kernel_gs31:
    v_pk_mul_f32 v[160:161], v[88:89], v[224:225] op_sel_hi:[1,0]
    v_pk_mul_f32 v[162:163], v[90:91], v[224:225] op_sel_hi:[1,0]
    v_pk_mul_f32 v[164:165], v[88:89], v[226:227] op_sel_hi:[1,0]
    v_pk_mul_f32 v[166:167], v[90:91], v[226:227] op_sel_hi:[1,0]
    v_pk_mul_f32 v[168:169], v[92:93], v[224:225] op_sel_hi:[1,0]
    v_pk_mul_f32 v[170:171], v[94:95], v[224:225] op_sel_hi:[1,0]
    v_pk_mul_f32 v[172:173], v[92:93], v[226:227] op_sel_hi:[1,0]
    v_pk_mul_f32 v[174:175], v[94:95], v[226:227] op_sel_hi:[1,0]
    v_pk_fma_f32 v[32:33], v[32:33], v[224:225], v[160:161] op_sel:[0,1,0] op_sel_hi:[1,1,1]
    v_pk_fma_f32 v[34:35], v[34:35], v[224:225], v[162:163] op_sel:[0,1,0] op_sel_hi:[1,1,1]
    v_pk_fma_f32 v[60:61], v[60:61], v[226:227], v[164:165] op_sel:[0,1,0] op_sel_hi:[1,1,1]
    v_pk_fma_f32 v[62:63], v[62:63], v[226:227], v[166:167] op_sel:[0,1,0] op_sel_hi:[1,1,1]
    v_pk_fma_f32 v[36:37], v[36:37], v[224:225], v[168:169] op_sel:[0,1,0] op_sel_hi:[1,1,1]
    v_pk_fma_f32 v[38:39], v[38:39], v[224:225], v[170:171] op_sel:[0,1,0] op_sel_hi:[1,1,1]
    v_pk_fma_f32 v[64:65], v[64:65], v[226:227], v[172:173] op_sel:[0,1,0] op_sel_hi:[1,1,1]
    v_pk_fma_f32 v[66:67], v[66:67], v[226:227], v[174:175] op_sel:[0,1,0] op_sel_hi:[1,1,1]
    v_pk_mul_f32 v[160:161], v[32:33], v[32:33]
    v_pk_mul_f32 v[162:163], v[34:35], v[34:35]
    v_pk_mul_f32 v[164:165], v[60:61], v[60:61]
    v_pk_mul_f32 v[166:167], v[62:63], v[62:63]
    v_pk_mul_f32 v[168:169], v[36:37], v[36:37]
    v_pk_mul_f32 v[170:171], v[38:39], v[38:39]
    v_pk_mul_f32 v[172:173], v[64:65], v[64:65]
    v_pk_mul_f32 v[174:175], v[66:67], v[66:67]
    v_pk_fma_f32 v[160:161], v[160:161], v[12:13], v[12:13] op_sel:[0,0,1] op_sel_hi:[1,0,1]
    v_pk_fma_f32 v[162:163], v[162:163], v[12:13], v[12:13] op_sel:[0,0,1] op_sel_hi:[1,0,1]
    v_pk_fma_f32 v[164:165], v[164:165], v[12:13], v[12:13] op_sel:[0,0,1] op_sel_hi:[1,0,1]
    v_pk_fma_f32 v[166:167], v[166:167], v[12:13], v[12:13] op_sel:[0,0,1] op_sel_hi:[1,0,1]
    v_pk_fma_f32 v[168:169], v[168:169], v[12:13], v[12:13] op_sel:[0,0,1] op_sel_hi:[1,0,1]
    v_pk_fma_f32 v[170:171], v[170:171], v[12:13], v[12:13] op_sel:[0,0,1] op_sel_hi:[1,0,1]
    v_pk_fma_f32 v[172:173], v[172:173], v[12:13], v[12:13] op_sel:[0,0,1] op_sel_hi:[1,0,1]
    v_pk_fma_f32 v[174:175], v[174:175], v[12:13], v[12:13] op_sel:[0,0,1] op_sel_hi:[1,0,1]
    v_pk_mul_f32 v[160:161], v[160:161], v[32:33]
    v_pk_mul_f32 v[162:163], v[162:163], v[34:35]
    v_pk_mul_f32 v[164:165], v[164:165], v[60:61]
    v_pk_mul_f32 v[166:167], v[166:167], v[62:63]
    v_pk_mul_f32 v[168:169], v[168:169], v[36:37]
    v_pk_mul_f32 v[170:171], v[170:171], v[38:39]
    v_pk_mul_f32 v[172:173], v[172:173], v[64:65]
    v_pk_mul_f32 v[174:175], v[174:175], v[66:67]
    v_exp_f32 v160, v160
    v_exp_f32 v161, v161
    v_exp_f32 v162, v162
    v_exp_f32 v163, v163
    v_exp_f32 v164, v164
    v_exp_f32 v165, v165
    v_exp_f32 v166, v166
    v_exp_f32 v167, v167
    v_exp_f32 v168, v168
    v_exp_f32 v169, v169
    v_exp_f32 v170, v170
    v_exp_f32 v171, v171
    v_exp_f32 v172, v172
    v_exp_f32 v173, v173
    v_exp_f32 v174, v174
    v_exp_f32 v175, v175
    v_pk_add_f32 v[160:161], v[160:161], 1.0 op_sel_hi:[1,0]
    v_pk_add_f32 v[162:163], v[162:163], 1.0 op_sel_hi:[1,0]
    v_pk_add_f32 v[164:165], v[164:165], 1.0 op_sel_hi:[1,0]
    v_pk_add_f32 v[166:167], v[166:167], 1.0 op_sel_hi:[1,0]
    v_pk_add_f32 v[168:169], v[168:169], 1.0 op_sel_hi:[1,0]
    v_pk_add_f32 v[170:171], v[170:171], 1.0 op_sel_hi:[1,0]
    v_pk_add_f32 v[172:173], v[172:173], 1.0 op_sel_hi:[1,0]
    v_pk_add_f32 v[174:175], v[174:175], 1.0 op_sel_hi:[1,0]
    v_rcp_f32 v160, v160
    v_rcp_f32 v161, v161
    v_rcp_f32 v162, v162
    v_rcp_f32 v163, v163
    v_rcp_f32 v164, v164
    v_rcp_f32 v165, v165
    v_rcp_f32 v166, v166
    v_rcp_f32 v167, v167
    v_rcp_f32 v168, v168
    v_rcp_f32 v169, v169
    v_rcp_f32 v170, v170
    v_rcp_f32 v171, v171
    v_rcp_f32 v172, v172
    v_rcp_f32 v173, v173
    v_rcp_f32 v174, v174
    v_rcp_f32 v175, v175
    s_nop 0
    v_pk_mul_f32 v[32:33], v[32:33], v[160:161]
    v_pk_mul_f32 v[34:35], v[34:35], v[162:163]
    v_pk_mul_f32 v[60:61], v[60:61], v[164:165]
    v_pk_mul_f32 v[62:63], v[62:63], v[166:167]
    v_pk_mul_f32 v[36:37], v[36:37], v[168:169]
    v_pk_mul_f32 v[38:39], v[38:39], v[170:171]
    v_pk_mul_f32 v[64:65], v[64:65], v[172:173]
    v_pk_mul_f32 v[66:67], v[66:67], v[174:175]
    v_cvt_pk_bf16_f32 v32, v32, v33
    v_cvt_pk_bf16_f32 v33, v34, v35
    v_cvt_pk_bf16_f32 v34, v36, v37
    v_cvt_pk_bf16_f32 v35, v38, v39
    v_cvt_pk_bf16_f32 v60, v60, v61
    v_cvt_pk_bf16_f32 v61, v62, v63
    v_cvt_pk_bf16_f32 v62, v64, v65
    v_cvt_pk_bf16_f32 v63, v66, v67
    s_nop 1
    v_permlane16_swap_b32 v32, v34
    v_permlane16_swap_b32 v33, v35
    v_permlane16_swap_b32 v60, v62
    v_permlane16_swap_b32 v61, v63
    s_cmp_eq_u32 s35, 15
    s_cbranch_scc1 k2_kernel_gs32
    buffer_store_dwordx4 v[32:35], v254, s[12:15], s52 offen offset:2048 sc1
    buffer_store_dwordx4 v[60:63], v254, s[12:15], s53 offen offset:2048 sc1
k2_kernel_gs32:
    v_pk_mul_f32 v[160:161], v[96:97], v[224:225] op_sel_hi:[1,0]
    v_pk_mul_f32 v[162:163], v[98:99], v[224:225] op_sel_hi:[1,0]
    v_pk_mul_f32 v[164:165], v[96:97], v[226:227] op_sel_hi:[1,0]
    v_pk_mul_f32 v[166:167], v[98:99], v[226:227] op_sel_hi:[1,0]
    v_pk_fma_f32 v[40:41], v[40:41], v[224:225], v[160:161] op_sel:[0,1,0] op_sel_hi:[1,1,1]
    v_pk_fma_f32 v[42:43], v[42:43], v[224:225], v[162:163] op_sel:[0,1,0] op_sel_hi:[1,1,1]
    v_pk_fma_f32 v[68:69], v[68:69], v[226:227], v[164:165] op_sel:[0,1,0] op_sel_hi:[1,1,1]
    v_pk_fma_f32 v[70:71], v[70:71], v[226:227], v[166:167] op_sel:[0,1,0] op_sel_hi:[1,1,1]
    v_pk_mul_f32 v[160:161], v[40:41], v[40:41]
    v_pk_mul_f32 v[162:163], v[42:43], v[42:43]
    v_pk_mul_f32 v[164:165], v[68:69], v[68:69]
    v_pk_mul_f32 v[166:167], v[70:71], v[70:71]
    v_pk_fma_f32 v[160:161], v[160:161], v[12:13], v[12:13] op_sel:[0,0,1] op_sel_hi:[1,0,1]
    v_pk_fma_f32 v[162:163], v[162:163], v[12:13], v[12:13] op_sel:[0,0,1] op_sel_hi:[1,0,1]
    v_pk_fma_f32 v[164:165], v[164:165], v[12:13], v[12:13] op_sel:[0,0,1] op_sel_hi:[1,0,1]
    v_pk_fma_f32 v[166:167], v[166:167], v[12:13], v[12:13] op_sel:[0,0,1] op_sel_hi:[1,0,1]
    v_pk_mul_f32 v[160:161], v[160:161], v[40:41]
    v_pk_mul_f32 v[162:163], v[162:163], v[42:43]
    v_pk_mul_f32 v[164:165], v[164:165], v[68:69]
    v_pk_mul_f32 v[166:167], v[166:167], v[70:71]
    v_exp_f32 v160, v160
    v_exp_f32 v161, v161
    v_exp_f32 v162, v162
    v_exp_f32 v163, v163
    v_exp_f32 v164, v164
    v_exp_f32 v165, v165
    v_exp_f32 v166, v166
    v_exp_f32 v167, v167
    v_pk_add_f32 v[160:161], v[160:161], 1.0 op_sel_hi:[1,0]
    v_pk_add_f32 v[162:163], v[162:163], 1.0 op_sel_hi:[1,0]
    v_pk_add_f32 v[164:165], v[164:165], 1.0 op_sel_hi:[1,0]
    v_pk_add_f32 v[166:167], v[166:167], 1.0 op_sel_hi:[1,0]
    v_rcp_f32 v160, v160
    v_rcp_f32 v161, v161
    v_rcp_f32 v162, v162
    v_rcp_f32 v163, v163
    v_rcp_f32 v164, v164
    v_rcp_f32 v165, v165
    v_rcp_f32 v166, v166
    v_rcp_f32 v167, v167
    s_nop 0
    v_pk_mul_f32 v[40:41], v[40:41], v[160:161]
    v_pk_mul_f32 v[42:43], v[42:43], v[162:163]
    v_pk_mul_f32 v[68:69], v[68:69], v[164:165]
    v_pk_mul_f32 v[70:71], v[70:71], v[166:167]
    v_cvt_pk_bf16_f32 v40, v40, v41
    v_cvt_pk_bf16_f32 v41, v42, v43
    v_cvt_pk_bf16_f32 v68, v68, v69
    v_cvt_pk_bf16_f32 v69, v70, v71
    s_cmp_eq_u32 s35, 15
    s_cbranch_scc1 k2_kernel_gs33
    buffer_store_dwordx2 v[40:41], v8, s[12:15], s52 offen offset:3072 sc1
    buffer_store_dwordx2 v[68:69], v8, s[12:15], s53 offen offset:3072 sc1
k2_kernel_gs33:
    s_waitcnt vmcnt(0)
    v_mov_b32 v9, 1
    v_mov_b32 v10, 6400
    s_mov_b64 exec, 1
    s_cmp_eq_u32 s31, 0
    s_cbranch_scc1 k2_kernel_slow34
    buffer_store_dword v9, v10, s[12:15], s49 offen
    s_branch k2_kernel_sent35
k2_kernel_slow34:
    buffer_store_dword v9, v10, s[12:15], s49 offen sc1
k2_kernel_sent35:
    s_mov_b64 exec, -1
    buffer_load_dwordx4 v[192:195], v2, s[12:15], s40 offen offset:0
    buffer_load_dwordx4 v[196:199], v2, s[12:15], s40 offen offset:1024
    buffer_load_dwordx4 v[200:203], v2, s[12:15], s40 offen offset:2048
    buffer_load_dwordx4 v[204:207], v2, s[12:15], s40 offen offset:3072
    s_add_u32 s40, s40, 4096
    buffer_load_dwordx4 v[208:211], v2, s[12:15], s40 offen offset:0
    buffer_load_dwordx4 v[212:215], v2, s[12:15], s40 offen offset:1024
    s_and_b32 s41, s32, 1
    s_lshl_b32 s41, s41, 1
    s_lshl_b32 s49, s34, 2
    s_add_u32 s49, s49, s41
    s_lshl_b32 s49, s49, 7
    s_add_u32 s49, s49, s37
    s_lshl_b32 s41, s30, 4
    s_add_u32 s49, s49, s41
    s_add_u32 s49, s49, 6400
    v_bfe_u32 v7, v1, 2, 1
    v_lshlrev_b32 v7, 7, v7
    v_and_b32 v9, 3, v1
    v_lshl_add_u32 v7, v9, 2, v7
    s_add_u32 s41, s30, 0
    s_and_b32 s41, s41, 3
    s_lshl_b32 s46, s32, 2
    s_add_u32 s41, s41, s46
    s_mul_i32 s41, s41, 55296
    s_mul_i32 s46, s30, 14336
    s_add_u32 s41, s41, s46
    s_add_u32 s41, s41, s36
    s_add_u32 s50, s41, 696320
    s_add_u32 s41, s30, 1
    s_and_b32 s41, s41, 3
    s_lshl_b32 s46, s32, 2
    s_add_u32 s41, s41, s46
    s_mul_i32 s41, s41, 55296
    s_mul_i32 s46, s30, 14336
    s_add_u32 s41, s41, s46
    s_add_u32 s41, s41, s36
    s_add_u32 s51, s41, 696320
    s_add_u32 s41, s30, 2
    s_and_b32 s41, s41, 3
    s_lshl_b32 s46, s32, 2
    s_add_u32 s41, s41, s46
    s_mul_i32 s41, s41, 55296
    s_mul_i32 s46, s30, 14336
    s_add_u32 s41, s41, s46
    s_add_u32 s41, s41, s36
    s_add_u32 s52, s41, 696320
    s_add_u32 s41, s30, 3
    s_and_b32 s41, s41, 3
    s_lshl_b32 s46, s32, 2
    s_add_u32 s41, s41, s46
    s_mul_i32 s41, s41, 55296
    s_mul_i32 s46, s30, 14336
    s_add_u32 s41, s41, s46
    s_add_u32 s41, s41, s36
    s_add_u32 s53, s41, 696320
    s_mov_b32 s43, 200000
k2_kernel_poll36:
    buffer_load_dword v9, v7, s[12:15], s49 offen sc1
    s_waitcnt vmcnt(0)
    v_cmp_ne_u32 vcc, 0, v9
    s_sub_u32 s43, s43, 1
    s_cmp_eq_u64 vcc, -1
    s_cbranch_scc1 k2_kernel_go37
    s_cmp_lg_u32 s43, 0
    s_cbranch_scc1 k2_kernel_poll36
k2_kernel_go37:
    s_add_u32 s41, s50, 0
    buffer_load_dwordx4 v[96:99], v2, s[12:15], s41 offen offset:0 sc1
    s_add_u32 s41, s51, 0
    buffer_load_dwordx4 v[100:103], v2, s[12:15], s41 offen offset:0 sc1
    s_add_u32 s41, s52, 0
    buffer_load_dwordx4 v[104:107], v2, s[12:15], s41 offen offset:0 sc1
    s_add_u32 s41, s53, 0
    buffer_load_dwordx4 v[108:111], v2, s[12:15], s41 offen offset:0 sc1
    s_add_u32 s41, s50, 0
    buffer_load_dwordx4 v[112:115], v2, s[12:15], s41 offen offset:1024 sc1
    s_add_u32 s41, s51, 0
    buffer_load_dwordx4 v[116:119], v2, s[12:15], s41 offen offset:1024 sc1
    s_add_u32 s41, s52, 0
    buffer_load_dwordx4 v[120:123], v2, s[12:15], s41 offen offset:1024 sc1
    s_add_u32 s41, s53, 0
    buffer_load_dwordx4 v[124:127], v2, s[12:15], s41 offen offset:1024 sc1
    s_waitcnt vmcnt(4)
    v_mfma_f32_16x16x32_bf16 v[16:19], a[0:3], v[96:99], 0
    v_mfma_f32_16x16x32_bf16 v[36:39], a[0:3], v[100:103], 0
    v_mfma_f32_16x16x32_bf16 v[56:59], a[0:3], v[104:107], 0
    v_mfma_f32_16x16x32_bf16 v[76:79], a[0:3], v[108:111], 0
    s_add_u32 s41, s50, 0
    buffer_load_dwordx4 v[128:131], v2, s[12:15], s41 offen offset:2048 sc1
    v_mfma_f32_16x16x32_bf16 v[20:23], a[4:7], v[96:99], 0
    v_mfma_f32_16x16x32_bf16 v[40:43], a[4:7], v[100:103], 0
    v_mfma_f32_16x16x32_bf16 v[60:63], a[4:7], v[104:107], 0
    v_mfma_f32_16x16x32_bf16 v[80:83], a[4:7], v[108:111], 0
    s_add_u32 s41, s51, 0
    buffer_load_dwordx4 v[132:135], v2, s[12:15], s41 offen offset:2048 sc1
    s_add_u32 s41, s52, 0
    buffer_load_dwordx4 v[136:139], v2, s[12:15], s41 offen offset:2048 sc1
    v_mfma_f32_16x16x32_bf16 v[24:27], a[8:11], v[96:99], 0
    v_mfma_f32_16x16x32_bf16 v[44:47], a[8:11], v[100:103], 0
    v_mfma_f32_16x16x32_bf16 v[64:67], a[8:11], v[104:107], 0
    v_mfma_f32_16x16x32_bf16 v[84:87], a[8:11], v[108:111], 0
    s_add_u32 s41, s53, 0
    buffer_load_dwordx4 v[140:143], v2, s[12:15], s41 offen offset:2048 sc1
    v_mfma_f32_16x16x32_bf16 v[28:31], a[12:15], v[96:99], 0
    v_mfma_f32_16x16x32_bf16 v[48:51], a[12:15], v[100:103], 0
    v_mfma_f32_16x16x32_bf16 v[68:71], a[12:15], v[104:107], 0
    v_mfma_f32_16x16x32_bf16 v[88:91], a[12:15], v[108:111], 0
    s_add_u32 s41, s50, 0
    buffer_load_dwordx4 v[144:147], v2, s[12:15], s41 offen offset:3072 sc1
    s_add_u32 s41, s51, 0
    buffer_load_dwordx4 v[148:151], v2, s[12:15], s41 offen offset:3072 sc1
    v_mfma_f32_16x16x32_bf16 v[32:35], a[16:19], v[96:99], 0
    v_mfma_f32_16x16x32_bf16 v[52:55], a[16:19], v[100:103], 0
    v_mfma_f32_16x16x32_bf16 v[72:75], a[16:19], v[104:107], 0
    v_mfma_f32_16x16x32_bf16 v[92:95], a[16:19], v[108:111], 0
    s_add_u32 s41, s52, 0
    buffer_load_dwordx4 v[152:155], v2, s[12:15], s41 offen offset:3072 sc1
    s_waitcnt vmcnt(7)
    v_mfma_f32_16x16x32_bf16 v[16:19], a[20:23], v[112:115], v[16:19]
    v_mfma_f32_16x16x32_bf16 v[36:39], a[20:23], v[116:119], v[36:39]
    v_mfma_f32_16x16x32_bf16 v[56:59], a[20:23], v[120:123], v[56:59]
    v_mfma_f32_16x16x32_bf16 v[76:79], a[20:23], v[124:127], v[76:79]
    s_add_u32 s41, s53, 0
    buffer_load_dwordx4 v[156:159], v2, s[12:15], s41 offen offset:3072 sc1
    v_mfma_f32_16x16x32_bf16 v[20:23], a[24:27], v[112:115], v[20:23]
    v_mfma_f32_16x16x32_bf16 v[40:43], a[24:27], v[116:119], v[40:43]
    v_mfma_f32_16x16x32_bf16 v[60:63], a[24:27], v[120:123], v[60:63]
    v_mfma_f32_16x16x32_bf16 v[80:83], a[24:27], v[124:127], v[80:83]
    s_add_u32 s41, s50, 4096
    buffer_load_dwordx4 v[160:163], v2, s[12:15], s41 offen offset:0 sc1
    s_add_u32 s41, s51, 4096
    buffer_load_dwordx4 v[164:167], v2, s[12:15], s41 offen offset:0 sc1
    v_mfma_f32_16x16x32_bf16 v[24:27], a[28:31], v[112:115], v[24:27]
    v_mfma_f32_16x16x32_bf16 v[44:47], a[28:31], v[116:119], v[44:47]
    v_mfma_f32_16x16x32_bf16 v[64:67], a[28:31], v[120:123], v[64:67]
    v_mfma_f32_16x16x32_bf16 v[84:87], a[28:31], v[124:127], v[84:87]
    s_add_u32 s41, s52, 4096
    buffer_load_dwordx4 v[168:171], v2, s[12:15], s41 offen offset:0 sc1
    v_mfma_f32_16x16x32_bf16 v[28:31], a[32:35], v[112:115], v[28:31]
    v_mfma_f32_16x16x32_bf16 v[48:51], a[32:35], v[116:119], v[48:51]
    v_mfma_f32_16x16x32_bf16 v[68:71], a[32:35], v[120:123], v[68:71]
    v_mfma_f32_16x16x32_bf16 v[88:91], a[32:35], v[124:127], v[88:91]
    s_add_u32 s41, s53, 4096
    buffer_load_dwordx4 v[172:175], v2, s[12:15], s41 offen offset:0 sc1
    s_add_u32 s41, s50, 4096
    buffer_load_dwordx4 v[176:179], v2, s[12:15], s41 offen offset:1024 sc1
    v_mfma_f32_16x16x32_bf16 v[32:35], a[36:39], v[112:115], v[32:35]
    v_mfma_f32_16x16x32_bf16 v[52:55], a[36:39], v[116:119], v[52:55]
    v_mfma_f32_16x16x32_bf16 v[72:75], a[36:39], v[120:123], v[72:75]
    v_mfma_f32_16x16x32_bf16 v[92:95], a[36:39], v[124:127], v[92:95]
    s_add_u32 s41, s51, 4096
    buffer_load_dwordx4 v[180:183], v2, s[12:15], s41 offen offset:1024 sc1
    s_waitcnt vmcnt(10)
    v_mfma_f32_16x16x32_bf16 v[16:19], a[40:43], v[128:131], v[16:19]
    v_mfma_f32_16x16x32_bf16 v[36:39], a[40:43], v[132:135], v[36:39]
    v_mfma_f32_16x16x32_bf16 v[56:59], a[40:43], v[136:139], v[56:59]
    v_mfma_f32_16x16x32_bf16 v[76:79], a[40:43], v[140:143], v[76:79]
    s_add_u32 s41, s52, 4096
    buffer_load_dwordx4 v[184:187], v2, s[12:15], s41 offen offset:1024 sc1
    v_mfma_f32_16x16x32_bf16 v[20:23], a[44:47], v[128:131], v[20:23]
    v_mfma_f32_16x16x32_bf16 v[40:43], a[44:47], v[132:135], v[40:43]
    v_mfma_f32_16x16x32_bf16 v[60:63], a[44:47], v[136:139], v[60:63]
    v_mfma_f32_16x16x32_bf16 v[80:83], a[44:47], v[140:143], v[80:83]
    s_add_u32 s41, s53, 4096
    buffer_load_dwordx4 v[188:191], v2, s[12:15], s41 offen offset:1024 sc1
    s_add_u32 s41, s50, 4096
    buffer_load_dwordx4 v[96:99], v2, s[12:15], s41 offen offset:2048 sc1
    v_mfma_f32_16x16x32_bf16 v[24:27], a[48:51], v[128:131], v[24:27]
    v_mfma_f32_16x16x32_bf16 v[44:47], a[48:51], v[132:135], v[44:47]
    v_mfma_f32_16x16x32_bf16 v[64:67], a[48:51], v[136:139], v[64:67]
    v_mfma_f32_16x16x32_bf16 v[84:87], a[48:51], v[140:143], v[84:87]
    s_add_u32 s41, s51, 4096
    buffer_load_dwordx4 v[100:103], v2, s[12:15], s41 offen offset:2048 sc1
    v_mfma_f32_16x16x32_bf16 v[28:31], a[52:55], v[128:131], v[28:31]
    v_mfma_f32_16x16x32_bf16 v[48:51], a[52:55], v[132:135], v[48:51]
    v_mfma_f32_16x16x32_bf16 v[68:71], a[52:55], v[136:139], v[68:71]
    v_mfma_f32_16x16x32_bf16 v[88:91], a[52:55], v[140:143], v[88:91]
    s_add_u32 s41, s52, 4096
    buffer_load_dwordx4 v[104:107], v2, s[12:15], s41 offen offset:2048 sc1
    v_mfma_f32_16x16x32_bf16 v[32:35], a[56:59], v[128:131], v[32:35]
    v_mfma_f32_16x16x32_bf16 v[52:55], a[56:59], v[132:135], v[52:55]
    v_mfma_f32_16x16x32_bf16 v[72:75], a[56:59], v[136:139], v[72:75]
    v_mfma_f32_16x16x32_bf16 v[92:95], a[56:59], v[140:143], v[92:95]
    s_add_u32 s41, s53, 4096
    buffer_load_dwordx4 v[108:111], v2, s[12:15], s41 offen offset:2048 sc1
    s_waitcnt vmcnt(12)
    v_mfma_f32_16x16x32_bf16 v[16:19], a[60:63], v[144:147], v[16:19]
    v_mfma_f32_16x16x32_bf16 v[36:39], a[60:63], v[148:151], v[36:39]
    v_mfma_f32_16x16x32_bf16 v[56:59], a[60:63], v[152:155], v[56:59]
    v_mfma_f32_16x16x32_bf16 v[76:79], a[60:63], v[156:159], v[76:79]
    s_add_u32 s41, s50, 4096
    buffer_load_dwordx4 v[112:115], v2, s[12:15], s41 offen offset:3072 sc1
    v_mfma_f32_16x16x32_bf16 v[20:23], a[64:67], v[144:147], v[20:23]
    v_mfma_f32_16x16x32_bf16 v[40:43], a[64:67], v[148:151], v[40:43]
    v_mfma_f32_16x16x32_bf16 v[60:63], a[64:67], v[152:155], v[60:63]
    v_mfma_f32_16x16x32_bf16 v[80:83], a[64:67], v[156:159], v[80:83]
    s_add_u32 s41, s51, 4096
    buffer_load_dwordx4 v[116:119], v2, s[12:15], s41 offen offset:3072 sc1
    v_mfma_f32_16x16x32_bf16 v[24:27], a[68:71], v[144:147], v[24:27]
    v_mfma_f32_16x16x32_bf16 v[44:47], a[68:71], v[148:151], v[44:47]
    v_mfma_f32_16x16x32_bf16 v[64:67], a[68:71], v[152:155], v[64:67]
    v_mfma_f32_16x16x32_bf16 v[84:87], a[68:71], v[156:159], v[84:87]
    s_add_u32 s41, s52, 4096
    buffer_load_dwordx4 v[120:123], v2, s[12:15], s41 offen offset:3072 sc1
    v_mfma_f32_16x16x32_bf16 v[28:31], a[72:75], v[144:147], v[28:31]
    v_mfma_f32_16x16x32_bf16 v[48:51], a[72:75], v[148:151], v[48:51]
    v_mfma_f32_16x16x32_bf16 v[68:71], a[72:75], v[152:155], v[68:71]
    v_mfma_f32_16x16x32_bf16 v[88:91], a[72:75], v[156:159], v[88:91]
    s_add_u32 s41, s53, 4096
    buffer_load_dwordx4 v[124:127], v2, s[12:15], s41 offen offset:3072 sc1
    v_mfma_f32_16x16x32_bf16 v[32:35], a[76:79], v[144:147], v[32:35]
    v_mfma_f32_16x16x32_bf16 v[52:55], a[76:79], v[148:151], v[52:55]
    v_mfma_f32_16x16x32_bf16 v[72:75], a[76:79], v[152:155], v[72:75]
    v_mfma_f32_16x16x32_bf16 v[92:95], a[76:79], v[156:159], v[92:95]
    s_add_u32 s41, s50, 8192
    buffer_load_dwordx4 v[128:131], v2, s[12:15], s41 offen offset:0 sc1
    s_waitcnt vmcnt(13)
    v_mfma_f32_16x16x32_bf16 v[16:19], a[80:83], v[160:163], v[16:19]
    v_mfma_f32_16x16x32_bf16 v[36:39], a[80:83], v[164:167], v[36:39]
    v_mfma_f32_16x16x32_bf16 v[56:59], a[80:83], v[168:171], v[56:59]
    v_mfma_f32_16x16x32_bf16 v[76:79], a[80:83], v[172:175], v[76:79]
    s_add_u32 s41, s51, 8192
    buffer_load_dwordx4 v[132:135], v2, s[12:15], s41 offen offset:0 sc1
    v_mfma_f32_16x16x32_bf16 v[20:23], a[84:87], v[160:163], v[20:23]
    v_mfma_f32_16x16x32_bf16 v[40:43], a[84:87], v[164:167], v[40:43]
    v_mfma_f32_16x16x32_bf16 v[60:63], a[84:87], v[168:171], v[60:63]
    v_mfma_f32_16x16x32_bf16 v[80:83], a[84:87], v[172:175], v[80:83]
    s_add_u32 s41, s52, 8192
    buffer_load_dwordx4 v[136:139], v2, s[12:15], s41 offen offset:0 sc1
    v_mfma_f32_16x16x32_bf16 v[24:27], a[88:91], v[160:163], v[24:27]
    v_mfma_f32_16x16x32_bf16 v[44:47], a[88:91], v[164:167], v[44:47]
    v_mfma_f32_16x16x32_bf16 v[64:67], a[88:91], v[168:171], v[64:67]
    v_mfma_f32_16x16x32_bf16 v[84:87], a[88:91], v[172:175], v[84:87]
    s_add_u32 s41, s53, 8192
    buffer_load_dwordx4 v[140:143], v2, s[12:15], s41 offen offset:0 sc1
    v_mfma_f32_16x16x32_bf16 v[28:31], a[92:95], v[160:163], v[28:31]
    v_mfma_f32_16x16x32_bf16 v[48:51], a[92:95], v[164:167], v[48:51]
    v_mfma_f32_16x16x32_bf16 v[68:71], a[92:95], v[168:171], v[68:71]
    v_mfma_f32_16x16x32_bf16 v[88:91], a[92:95], v[172:175], v[88:91]
    s_add_u32 s41, s50, 8192
    buffer_load_dwordx4 v[144:147], v2, s[12:15], s41 offen offset:1024 sc1
    v_mfma_f32_16x16x32_bf16 v[32:35], a[96:99], v[160:163], v[32:35]
    v_mfma_f32_16x16x32_bf16 v[52:55], a[96:99], v[164:167], v[52:55]
    v_mfma_f32_16x16x32_bf16 v[72:75], a[96:99], v[168:171], v[72:75]
    v_mfma_f32_16x16x32_bf16 v[92:95], a[96:99], v[172:175], v[92:95]
    s_add_u32 s41, s51, 8192
    buffer_load_dwordx4 v[148:151], v2, s[12:15], s41 offen offset:1024 sc1
    s_waitcnt vmcnt(14)
    v_mfma_f32_16x16x32_bf16 v[16:19], a[100:103], v[176:179], v[16:19]
    v_mfma_f32_16x16x32_bf16 v[36:39], a[100:103], v[180:183], v[36:39]
    v_mfma_f32_16x16x32_bf16 v[56:59], a[100:103], v[184:187], v[56:59]
    v_mfma_f32_16x16x32_bf16 v[76:79], a[100:103], v[188:191], v[76:79]
    s_add_u32 s41, s52, 8192
    buffer_load_dwordx4 v[152:155], v2, s[12:15], s41 offen offset:1024 sc1
    v_mfma_f32_16x16x32_bf16 v[20:23], a[104:107], v[176:179], v[20:23]
    v_mfma_f32_16x16x32_bf16 v[40:43], a[104:107], v[180:183], v[40:43]
    v_mfma_f32_16x16x32_bf16 v[60:63], a[104:107], v[184:187], v[60:63]
    v_mfma_f32_16x16x32_bf16 v[80:83], a[104:107], v[188:191], v[80:83]
    s_add_u32 s41, s53, 8192
    buffer_load_dwordx4 v[156:159], v2, s[12:15], s41 offen offset:1024 sc1
    v_mfma_f32_16x16x32_bf16 v[24:27], a[108:111], v[176:179], v[24:27]
    v_mfma_f32_16x16x32_bf16 v[44:47], a[108:111], v[180:183], v[44:47]
    v_mfma_f32_16x16x32_bf16 v[64:67], a[108:111], v[184:187], v[64:67]
    v_mfma_f32_16x16x32_bf16 v[84:87], a[108:111], v[188:191], v[84:87]
    s_add_u32 s41, s50, 8192
    buffer_load_dwordx4 v[160:163], v2, s[12:15], s41 offen offset:2048 sc1
    v_mfma_f32_16x16x32_bf16 v[28:31], a[112:115], v[176:179], v[28:31]
    v_mfma_f32_16x16x32_bf16 v[48:51], a[112:115], v[180:183], v[48:51]
    v_mfma_f32_16x16x32_bf16 v[68:71], a[112:115], v[184:187], v[68:71]
    v_mfma_f32_16x16x32_bf16 v[88:91], a[112:115], v[188:191], v[88:91]
    s_add_u32 s41, s51, 8192
    buffer_load_dwordx4 v[164:167], v2, s[12:15], s41 offen offset:2048 sc1
    v_mfma_f32_16x16x32_bf16 v[32:35], a[116:119], v[176:179], v[32:35]
    v_mfma_f32_16x16x32_bf16 v[52:55], a[116:119], v[180:183], v[52:55]
    v_mfma_f32_16x16x32_bf16 v[72:75], a[116:119], v[184:187], v[72:75]
    v_mfma_f32_16x16x32_bf16 v[92:95], a[116:119], v[188:191], v[92:95]
    s_add_u32 s41, s52, 8192
    buffer_load_dwordx4 v[168:171], v2, s[12:15], s41 offen offset:2048 sc1
    s_waitcnt vmcnt(15)
    v_mfma_f32_16x16x32_bf16 v[16:19], a[120:123], v[96:99], v[16:19]
    v_mfma_f32_16x16x32_bf16 v[36:39], a[120:123], v[100:103], v[36:39]
    v_mfma_f32_16x16x32_bf16 v[56:59], a[120:123], v[104:107], v[56:59]
    v_mfma_f32_16x16x32_bf16 v[76:79], a[120:123], v[108:111], v[76:79]
    s_add_u32 s41, s53, 8192
    buffer_load_dwordx4 v[172:175], v2, s[12:15], s41 offen offset:2048 sc1
    v_mfma_f32_16x16x32_bf16 v[20:23], a[124:127], v[96:99], v[20:23]
    v_mfma_f32_16x16x32_bf16 v[40:43], a[124:127], v[100:103], v[40:43]
    v_mfma_f32_16x16x32_bf16 v[60:63], a[124:127], v[104:107], v[60:63]
    v_mfma_f32_16x16x32_bf16 v[80:83], a[124:127], v[108:111], v[80:83]
    s_add_u32 s41, s50, 8192
    buffer_load_dwordx4 v[176:179], v2, s[12:15], s41 offen offset:3072 sc1
    v_mfma_f32_16x16x32_bf16 v[24:27], a[128:131], v[96:99], v[24:27]
    v_mfma_f32_16x16x32_bf16 v[44:47], a[128:131], v[100:103], v[44:47]
    v_mfma_f32_16x16x32_bf16 v[64:67], a[128:131], v[104:107], v[64:67]
    v_mfma_f32_16x16x32_bf16 v[84:87], a[128:131], v[108:111], v[84:87]
    s_add_u32 s41, s51, 8192
    buffer_load_dwordx4 v[180:183], v2, s[12:15], s41 offen offset:3072 sc1
    v_mfma_f32_16x16x32_bf16 v[28:31], a[132:135], v[96:99], v[28:31]
    v_mfma_f32_16x16x32_bf16 v[48:51], a[132:135], v[100:103], v[48:51]
    v_mfma_f32_16x16x32_bf16 v[68:71], a[132:135], v[104:107], v[68:71]
    v_mfma_f32_16x16x32_bf16 v[88:91], a[132:135], v[108:111], v[88:91]
    s_add_u32 s41, s52, 8192
    buffer_load_dwordx4 v[184:187], v2, s[12:15], s41 offen offset:3072 sc1
    v_mfma_f32_16x16x32_bf16 v[32:35], a[136:139], v[96:99], v[32:35]
    v_mfma_f32_16x16x32_bf16 v[52:55], a[136:139], v[100:103], v[52:55]
    v_mfma_f32_16x16x32_bf16 v[72:75], a[136:139], v[104:107], v[72:75]
    v_mfma_f32_16x16x32_bf16 v[92:95], a[136:139], v[108:111], v[92:95]
    s_add_u32 s41, s53, 8192
    buffer_load_dwordx4 v[188:191], v2, s[12:15], s41 offen offset:3072 sc1
    s_waitcnt vmcnt(16)
    v_mfma_f32_16x16x32_bf16 v[16:19], a[140:143], v[112:115], v[16:19]
    v_mfma_f32_16x16x32_bf16 v[36:39], a[140:143], v[116:119], v[36:39]
    v_mfma_f32_16x16x32_bf16 v[56:59], a[140:143], v[120:123], v[56:59]
    v_mfma_f32_16x16x32_bf16 v[76:79], a[140:143], v[124:127], v[76:79]
    v_mfma_f32_16x16x32_bf16 v[20:23], a[144:147], v[112:115], v[20:23]
    v_mfma_f32_16x16x32_bf16 v[40:43], a[144:147], v[116:119], v[40:43]
    v_mfma_f32_16x16x32_bf16 v[60:63], a[144:147], v[120:123], v[60:63]
    v_mfma_f32_16x16x32_bf16 v[80:83], a[144:147], v[124:127], v[80:83]
    s_add_u32 s41, s50, 12288
    buffer_load_dwordx4 v[96:99], v2, s[12:15], s41 offen offset:0 sc1
    v_mfma_f32_16x16x32_bf16 v[24:27], a[148:151], v[112:115], v[24:27]
    v_mfma_f32_16x16x32_bf16 v[44:47], a[148:151], v[116:119], v[44:47]
    v_mfma_f32_16x16x32_bf16 v[64:67], a[148:151], v[120:123], v[64:67]
    v_mfma_f32_16x16x32_bf16 v[84:87], a[148:151], v[124:127], v[84:87]
    s_add_u32 s41, s51, 12288
    buffer_load_dwordx4 v[100:103], v2, s[12:15], s41 offen offset:0 sc1
    v_mfma_f32_16x16x32_bf16 v[28:31], a[152:155], v[112:115], v[28:31]
    v_mfma_f32_16x16x32_bf16 v[48:51], a[152:155], v[116:119], v[48:51]
    v_mfma_f32_16x16x32_bf16 v[68:71], a[152:155], v[120:123], v[68:71]
    v_mfma_f32_16x16x32_bf16 v[88:91], a[152:155], v[124:127], v[88:91]
    s_add_u32 s41, s52, 12288
    buffer_load_dwordx4 v[104:107], v2, s[12:15], s41 offen offset:0 sc1
    v_mfma_f32_16x16x32_bf16 v[32:35], a[156:159], v[112:115], v[32:35]
    v_mfma_f32_16x16x32_bf16 v[52:55], a[156:159], v[116:119], v[52:55]
    v_mfma_f32_16x16x32_bf16 v[72:75], a[156:159], v[120:123], v[72:75]
    v_mfma_f32_16x16x32_bf16 v[92:95], a[156:159], v[124:127], v[92:95]
    s_add_u32 s41, s53, 12288
    buffer_load_dwordx4 v[108:111], v2, s[12:15], s41 offen offset:0 sc1
    s_waitcnt vmcnt(16)
    v_mfma_f32_16x16x32_bf16 v[16:19], a[160:163], v[128:131], v[16:19]
    v_mfma_f32_16x16x32_bf16 v[36:39], a[160:163], v[132:135], v[36:39]
    v_mfma_f32_16x16x32_bf16 v[56:59], a[160:163], v[136:139], v[56:59]
    v_mfma_f32_16x16x32_bf16 v[76:79], a[160:163], v[140:143], v[76:79]
    v_mfma_f32_16x16x32_bf16 v[20:23], a[164:167], v[128:131], v[20:23]
    v_mfma_f32_16x16x32_bf16 v[40:43], a[164:167], v[132:135], v[40:43]
    v_mfma_f32_16x16x32_bf16 v[60:63], a[164:167], v[136:139], v[60:63]
    v_mfma_f32_16x16x32_bf16 v[80:83], a[164:167], v[140:143], v[80:83]
    s_add_u32 s41, s50, 12288
    buffer_load_dwordx4 v[112:115], v2, s[12:15], s41 offen offset:1024 sc1
    v_mfma_f32_16x16x32_bf16 v[24:27], a[168:171], v[128:131], v[24:27]
    v_mfma_f32_16x16x32_bf16 v[44:47], a[168:171], v[132:135], v[44:47]
    v_mfma_f32_16x16x32_bf16 v[64:67], a[168:171], v[136:139], v[64:67]
    v_mfma_f32_16x16x32_bf16 v[84:87], a[168:171], v[140:143], v[84:87]
    s_add_u32 s41, s51, 12288
    buffer_load_dwordx4 v[116:119], v2, s[12:15], s41 offen offset:1024 sc1
    v_mfma_f32_16x16x32_bf16 v[28:31], a[172:175], v[128:131], v[28:31]
    v_mfma_f32_16x16x32_bf16 v[48:51], a[172:175], v[132:135], v[48:51]
    v_mfma_f32_16x16x32_bf16 v[68:71], a[172:175], v[136:139], v[68:71]
    v_mfma_f32_16x16x32_bf16 v[88:91], a[172:175], v[140:143], v[88:91]
    s_add_u32 s41, s52, 12288
    buffer_load_dwordx4 v[120:123], v2, s[12:15], s41 offen offset:1024 sc1
    v_mfma_f32_16x16x32_bf16 v[32:35], a[176:179], v[128:131], v[32:35]
    v_mfma_f32_16x16x32_bf16 v[52:55], a[176:179], v[132:135], v[52:55]
    v_mfma_f32_16x16x32_bf16 v[72:75], a[176:179], v[136:139], v[72:75]
    v_mfma_f32_16x16x32_bf16 v[92:95], a[176:179], v[140:143], v[92:95]
    s_add_u32 s41, s53, 12288
    buffer_load_dwordx4 v[124:127], v2, s[12:15], s41 offen offset:1024 sc1
    s_waitcnt vmcnt(16)
    v_mfma_f32_16x16x32_bf16 v[16:19], a[180:183], v[144:147], v[16:19]
    v_mfma_f32_16x16x32_bf16 v[36:39], a[180:183], v[148:151], v[36:39]
    v_mfma_f32_16x16x32_bf16 v[56:59], a[180:183], v[152:155], v[56:59]
    v_mfma_f32_16x16x32_bf16 v[76:79], a[180:183], v[156:159], v[76:79]
    v_mfma_f32_16x16x32_bf16 v[20:23], a[184:187], v[144:147], v[20:23]
    v_mfma_f32_16x16x32_bf16 v[40:43], a[184:187], v[148:151], v[40:43]
    v_mfma_f32_16x16x32_bf16 v[60:63], a[184:187], v[152:155], v[60:63]
    v_mfma_f32_16x16x32_bf16 v[80:83], a[184:187], v[156:159], v[80:83]
    v_mfma_f32_16x16x32_bf16 v[24:27], a[188:191], v[144:147], v[24:27]
    v_mfma_f32_16x16x32_bf16 v[44:47], a[188:191], v[148:151], v[44:47]
    v_mfma_f32_16x16x32_bf16 v[64:67], a[188:191], v[152:155], v[64:67]
    v_mfma_f32_16x16x32_bf16 v[84:87], a[188:191], v[156:159], v[84:87]
    v_mfma_f32_16x16x32_bf16 v[28:31], a[192:195], v[144:147], v[28:31]
    v_mfma_f32_16x16x32_bf16 v[48:51], a[192:195], v[148:151], v[48:51]
    v_mfma_f32_16x16x32_bf16 v[68:71], a[192:195], v[152:155], v[68:71]
    v_mfma_f32_16x16x32_bf16 v[88:91], a[192:195], v[156:159], v[88:91]
    v_mfma_f32_16x16x32_bf16 v[32:35], a[196:199], v[144:147], v[32:35]
    v_mfma_f32_16x16x32_bf16 v[52:55], a[196:199], v[148:151], v[52:55]
    v_mfma_f32_16x16x32_bf16 v[72:75], a[196:199], v[152:155], v[72:75]
    v_mfma_f32_16x16x32_bf16 v[92:95], a[196:199], v[156:159], v[92:95]
    s_waitcnt vmcnt(12)
    v_mfma_f32_16x16x32_bf16 v[16:19], a[200:203], v[160:163], v[16:19]
    v_mfma_f32_16x16x32_bf16 v[36:39], a[200:203], v[164:167], v[36:39]
    v_mfma_f32_16x16x32_bf16 v[56:59], a[200:203], v[168:171], v[56:59]
    v_mfma_f32_16x16x32_bf16 v[76:79], a[200:203], v[172:175], v[76:79]
    v_mfma_f32_16x16x32_bf16 v[20:23], a[204:207], v[160:163], v[20:23]
    v_mfma_f32_16x16x32_bf16 v[40:43], a[204:207], v[164:167], v[40:43]
    v_mfma_f32_16x16x32_bf16 v[60:63], a[204:207], v[168:171], v[60:63]
    v_mfma_f32_16x16x32_bf16 v[80:83], a[204:207], v[172:175], v[80:83]
    v_mfma_f32_16x16x32_bf16 v[24:27], a[208:211], v[160:163], v[24:27]
    v_mfma_f32_16x16x32_bf16 v[44:47], a[208:211], v[164:167], v[44:47]
    v_mfma_f32_16x16x32_bf16 v[64:67], a[208:211], v[168:171], v[64:67]
    v_mfma_f32_16x16x32_bf16 v[84:87], a[208:211], v[172:175], v[84:87]
    v_mfma_f32_16x16x32_bf16 v[28:31], a[212:215], v[160:163], v[28:31]
    v_mfma_f32_16x16x32_bf16 v[48:51], a[212:215], v[164:167], v[48:51]
    v_mfma_f32_16x16x32_bf16 v[68:71], a[212:215], v[168:171], v[68:71]
    v_mfma_f32_16x16x32_bf16 v[88:91], a[212:215], v[172:175], v[88:91]
    v_mfma_f32_16x16x32_bf16 v[32:35], a[216:219], v[160:163], v[32:35]
    v_mfma_f32_16x16x32_bf16 v[52:55], a[216:219], v[164:167], v[52:55]
    v_mfma_f32_16x16x32_bf16 v[72:75], a[216:219], v[168:171], v[72:75]
    v_mfma_f32_16x16x32_bf16 v[92:95], a[216:219], v[172:175], v[92:95]
    s_waitcnt vmcnt(8)
    v_mfma_f32_16x16x32_bf16 v[16:19], a[220:223], v[176:179], v[16:19]
    v_mfma_f32_16x16x32_bf16 v[36:39], a[220:223], v[180:183], v[36:39]
    v_mfma_f32_16x16x32_bf16 v[56:59], a[220:223], v[184:187], v[56:59]
    v_mfma_f32_16x16x32_bf16 v[76:79], a[220:223], v[188:191], v[76:79]
    v_mfma_f32_16x16x32_bf16 v[20:23], a[224:227], v[176:179], v[20:23]
    v_mfma_f32_16x16x32_bf16 v[40:43], a[224:227], v[180:183], v[40:43]
    v_mfma_f32_16x16x32_bf16 v[60:63], a[224:227], v[184:187], v[60:63]
    v_mfma_f32_16x16x32_bf16 v[80:83], a[224:227], v[188:191], v[80:83]
    v_mfma_f32_16x16x32_bf16 v[24:27], a[228:231], v[176:179], v[24:27]
    v_mfma_f32_16x16x32_bf16 v[44:47], a[228:231], v[180:183], v[44:47]
    v_mfma_f32_16x16x32_bf16 v[64:67], a[228:231], v[184:187], v[64:67]
    v_mfma_f32_16x16x32_bf16 v[84:87], a[228:231], v[188:191], v[84:87]
    v_mfma_f32_16x16x32_bf16 v[28:31], a[232:235], v[176:179], v[28:31]
    v_mfma_f32_16x16x32_bf16 v[48:51], a[232:235], v[180:183], v[48:51]
    v_mfma_f32_16x16x32_bf16 v[68:71], a[232:235], v[184:187], v[68:71]
    v_mfma_f32_16x16x32_bf16 v[88:91], a[232:235], v[188:191], v[88:91]
    v_mfma_f32_16x16x32_bf16 v[32:35], a[236:239], v[176:179], v[32:35]
    v_mfma_f32_16x16x32_bf16 v[52:55], a[236:239], v[180:183], v[52:55]
    v_mfma_f32_16x16x32_bf16 v[72:75], a[236:239], v[184:187], v[72:75]
    v_mfma_f32_16x16x32_bf16 v[92:95], a[236:239], v[188:191], v[92:95]
    s_cmp_eq_u32 s30, 3
    s_cbranch_scc1 k2_kernel_k4skip38
    s_waitcnt vmcnt(4)
    v_mfma_f32_16x16x32_bf16 v[16:19], a[240:243], v[96:99], v[16:19]
    v_mfma_f32_16x16x32_bf16 v[36:39], a[240:243], v[100:103], v[36:39]
    v_mfma_f32_16x16x32_bf16 v[56:59], a[240:243], v[104:107], v[56:59]
    v_mfma_f32_16x16x32_bf16 v[76:79], a[240:243], v[108:111], v[76:79]
    v_mfma_f32_16x16x32_bf16 v[20:23], a[244:247], v[96:99], v[20:23]
    v_mfma_f32_16x16x32_bf16 v[40:43], a[244:247], v[100:103], v[40:43]
    v_mfma_f32_16x16x32_bf16 v[60:63], a[244:247], v[104:107], v[60:63]
    v_mfma_f32_16x16x32_bf16 v[80:83], a[244:247], v[108:111], v[80:83]
    v_mfma_f32_16x16x32_bf16 v[24:27], a[248:251], v[96:99], v[24:27]
    v_mfma_f32_16x16x32_bf16 v[44:47], a[248:251], v[100:103], v[44:47]
    v_mfma_f32_16x16x32_bf16 v[64:67], a[248:251], v[104:107], v[64:67]
    v_mfma_f32_16x16x32_bf16 v[84:87], a[248:251], v[108:111], v[84:87]
    v_mfma_f32_16x16x32_bf16 v[28:31], a[252:255], v[96:99], v[28:31]
    v_mfma_f32_16x16x32_bf16 v[48:51], a[252:255], v[100:103], v[48:51]
    v_mfma_f32_16x16x32_bf16 v[68:71], a[252:255], v[104:107], v[68:71]
    v_mfma_f32_16x16x32_bf16 v[88:91], a[252:255], v[108:111], v[88:91]
    v_mfma_f32_16x16x32_bf16 v[32:35], v[192:195], v[96:99], v[32:35]
    v_mfma_f32_16x16x32_bf16 v[52:55], v[192:195], v[100:103], v[52:55]
    v_mfma_f32_16x16x32_bf16 v[72:75], v[192:195], v[104:107], v[72:75]
    v_mfma_f32_16x16x32_bf16 v[92:95], v[192:195], v[108:111], v[92:95]
    s_waitcnt vmcnt(0)
    v_mfma_f32_16x16x32_bf16 v[16:19], v[196:199], v[112:115], v[16:19]
    v_mfma_f32_16x16x32_bf16 v[36:39], v[196:199], v[116:119], v[36:39]
    v_mfma_f32_16x16x32_bf16 v[56:59], v[196:199], v[120:123], v[56:59]
    v_mfma_f32_16x16x32_bf16 v[76:79], v[196:199], v[124:127], v[76:79]
    v_mfma_f32_16x16x32_bf16 v[20:23], v[200:203], v[112:115], v[20:23]
    v_mfma_f32_16x16x32_bf16 v[40:43], v[200:203], v[116:119], v[40:43]
    v_mfma_f32_16x16x32_bf16 v[60:63], v[200:203], v[120:123], v[60:63]
    v_mfma_f32_16x16x32_bf16 v[80:83], v[200:203], v[124:127], v[80:83]
    v_mfma_f32_16x16x32_bf16 v[24:27], v[204:207], v[112:115], v[24:27]
    v_mfma_f32_16x16x32_bf16 v[44:47], v[204:207], v[116:119], v[44:47]
    v_mfma_f32_16x16x32_bf16 v[64:67], v[204:207], v[120:123], v[64:67]
    v_mfma_f32_16x16x32_bf16 v[84:87], v[204:207], v[124:127], v[84:87]
    v_mfma_f32_16x16x32_bf16 v[28:31], v[208:211], v[112:115], v[28:31]
    v_mfma_f32_16x16x32_bf16 v[48:51], v[208:211], v[116:119], v[48:51]
    v_mfma_f32_16x16x32_bf16 v[68:71], v[208:211], v[120:123], v[68:71]
    v_mfma_f32_16x16x32_bf16 v[88:91], v[208:211], v[124:127], v[88:91]
    v_mfma_f32_16x16x32_bf16 v[32:35], v[212:215], v[112:115], v[32:35]
    v_mfma_f32_16x16x32_bf16 v[52:55], v[212:215], v[116:119], v[52:55]
    v_mfma_f32_16x16x32_bf16 v[72:75], v[212:215], v[120:123], v[72:75]
    v_mfma_f32_16x16x32_bf16 v[92:95], v[212:215], v[124:127], v[92:95]
k2_kernel_k4skip38:
    s_waitcnt vmcnt(0)
    s_barrier
    s_add_u32 s41, s30, 1
    s_and_b32 s41, s41, 3
    s_mul_i32 s41, s41, 15360
    s_add_u32 s41, s41, 0
    v_add_u32 v9, s41, v2
    ds_write_b128 v9, v[36:39] offset:0
    ds_write_b128 v9, v[40:43] offset:1024
    ds_write_b128 v9, v[44:47] offset:2048
    ds_write_b128 v9, v[48:51] offset:3072
    ds_write_b128 v9, v[52:55] offset:4096
    s_add_u32 s41, s30, 2
    s_and_b32 s41, s41, 3
    s_mul_i32 s41, s41, 15360
    s_add_u32 s41, s41, 5120
    v_add_u32 v9, s41, v2
    ds_write_b128 v9, v[56:59] offset:0
    ds_write_b128 v9, v[60:63] offset:1024
    ds_write_b128 v9, v[64:67] offset:2048
    ds_write_b128 v9, v[68:71] offset:3072
    ds_write_b128 v9, v[72:75] offset:4096
    s_add_u32 s41, s30, 3
    s_and_b32 s41, s41, 3
    s_mul_i32 s41, s41, 15360
    s_add_u32 s41, s41, 10240
    v_add_u32 v9, s41, v2
    ds_write_b128 v9, v[76:79] offset:0
    ds_write_b128 v9, v[80:83] offset:1024
    ds_write_b128 v9, v[84:87] offset:2048
    ds_write_b128 v9, v[88:91] offset:3072
    ds_write_b128 v9, v[92:95] offset:4096
    v_lshlrev_b32 v10, 4, v3
    v_add_u32 v10, 157696, v10
    ds_read_b128 v[96:99], v10 offset:0
    ds_read_b128 v[100:103], v10 offset:64
    ds_read_b128 v[104:107], v10 offset:128
    ds_read_b128 v[108:111], v10 offset:192
    ds_read_b128 v[112:115], v10 offset:256
    s_mul_i32 s41, s30, 15360
    v_add_u32 v9, s41, v2
    s_waitcnt lgkmcnt(0)
    s_barrier
    ds_read_b128 v[116:119], v9 offset:0
    ds_read_b128 v[120:123], v9 offset:1024
    ds_read_b128 v[124:127], v9 offset:2048
    ds_read_b128 v[128:131], v9 offset:3072
    ds_read_b128 v[132:135], v9 offset:4096
    ds_read_b128 v[136:139], v9 offset:5120
    ds_read_b128 v[140:143], v9 offset:6144
    ds_read_b128 v[144:147], v9 offset:7168
    ds_read_b128 v[148:151], v9 offset:8192
    ds_read_b128 v[152:155], v9 offset:9216
    ds_read_b128 v[156:159], v9 offset:10240
    ds_read_b128 v[160:163], v9 offset:11264
    ds_read_b128 v[164:167], v9 offset:12288
    ds_read_b128 v[168:171], v9 offset:13312
    ds_read_b128 v[172:175], v9 offset:14336
    s_lshl_b32 s46, s32, 2
    s_add_u32 s46, s46, s30
    s_lshl_b32 s46, s46, 4
    s_lshl_b32 s47, s28, 8
    s_add_u32 s46, s46, s47
    v_add_u32 v10, s46, v4
    v_mul_u32_u24 v10, 1280, v10
    v_lshl_add_u32 v10, v3, 3, v10
    s_mul_i32 s47, s33, 160
    s_nop 1
    v_permlane16_swap_b32 v228, v230
    v_permlane16_swap_b32 v229, v231
    v_permlane16_swap_b32 v232, v234
    v_permlane16_swap_b32 v233, v235
    v_permlane16_swap_b32 v238, v240
    v_permlane16_swap_b32 v239, v241
    v_permlane16_swap_b32 v242, v244
    v_permlane16_swap_b32 v243, v245
    s_waitcnt lgkmcnt(0)
    v_pk_add_f32 v[16:17], v[16:17], v[116:117]
    v_pk_add_f32 v[18:19], v[18:19], v[118:119]
    v_pk_add_f32 v[20:21], v[20:21], v[120:121]
    v_pk_add_f32 v[22:23], v[22:23], v[122:123]
    v_pk_add_f32 v[24:25], v[24:25], v[124:125]
    v_pk_add_f32 v[26:27], v[26:27], v[126:127]
    v_pk_add_f32 v[28:29], v[28:29], v[128:129]
    v_pk_add_f32 v[30:31], v[30:31], v[130:131]
    v_pk_add_f32 v[32:33], v[32:33], v[132:133]
    v_pk_add_f32 v[34:35], v[34:35], v[134:135]
    v_pk_add_f32 v[16:17], v[16:17], v[136:137]
    v_pk_add_f32 v[18:19], v[18:19], v[138:139]
    v_pk_add_f32 v[20:21], v[20:21], v[140:141]
    v_pk_add_f32 v[22:23], v[22:23], v[142:143]
    v_pk_add_f32 v[24:25], v[24:25], v[144:145]
    v_pk_add_f32 v[26:27], v[26:27], v[146:147]
    v_pk_add_f32 v[28:29], v[28:29], v[148:149]
    v_pk_add_f32 v[30:31], v[30:31], v[150:151]
    v_pk_add_f32 v[32:33], v[32:33], v[152:153]
    v_pk_add_f32 v[34:35], v[34:35], v[154:155]
    v_pk_add_f32 v[16:17], v[16:17], v[156:157]
    v_pk_add_f32 v[18:19], v[18:19], v[158:159]
    v_pk_add_f32 v[20:21], v[20:21], v[160:161]
    v_pk_add_f32 v[22:23], v[22:23], v[162:163]
    v_pk_add_f32 v[24:25], v[24:25], v[164:165]
    v_pk_add_f32 v[26:27], v[26:27], v[166:167]
    v_pk_add_f32 v[28:29], v[28:29], v[168:169]
    v_pk_add_f32 v[30:31], v[30:31], v[170:171]
    v_pk_add_f32 v[32:33], v[32:33], v[172:173]
    v_pk_add_f32 v[34:35], v[34:35], v[174:175]
    v_lshlrev_b32 v116, 16, v238
    v_and_b32 v117, 0xffff0000, v238
    v_lshlrev_b32 v118, 16, v239
    v_and_b32 v119, 0xffff0000, v239
    v_lshlrev_b32 v136, 16, v228
    v_and_b32 v137, 0xffff0000, v228
    v_lshlrev_b32 v138, 16, v229
    v_and_b32 v139, 0xffff0000, v229
    v_lshlrev_b32 v120, 16, v240
    v_and_b32 v121, 0xffff0000, v240
    v_lshlrev_b32 v122, 16, v241
    v_and_b32 v123, 0xffff0000, v241
    v_lshlrev_b32 v140, 16, v230
    v_and_b32 v141, 0xffff0000, v230
    v_lshlrev_b32 v142, 16, v231
    v_and_b32 v143, 0xffff0000, v231
    v_lshlrev_b32 v124, 16, v242
    v_and_b32 v125, 0xffff0000, v242
    v_lshlrev_b32 v126, 16, v243
    v_and_b32 v127, 0xffff0000, v243
    v_lshlrev_b32 v144, 16, v232
    v_and_b32 v145, 0xffff0000, v232
    v_lshlrev_b32 v146, 16, v233
    v_and_b32 v147, 0xffff0000, v233
    v_lshlrev_b32 v128, 16, v244
    v_and_b32 v129, 0xffff0000, v244
    v_lshlrev_b32 v130, 16, v245
    v_and_b32 v131, 0xffff0000, v245
    v_lshlrev_b32 v148, 16, v234
    v_and_b32 v149, 0xffff0000, v234
    v_lshlrev_b32 v150, 16, v235
    v_and_b32 v151, 0xffff0000, v235
    v_lshlrev_b32 v132, 16, v246
    v_and_b32 v133, 0xffff0000, v246
    v_lshlrev_b32 v134, 16, v247
    v_and_b32 v135, 0xffff0000, v247
    v_lshlrev_b32 v152, 16, v236
    v_and_b32 v153, 0xffff0000, v236
    v_lshlrev_b32 v154, 16, v237
    v_and_b32 v155, 0xffff0000, v237
    v_pk_add_f32 v[16:17], v[16:17], v[116:117]
    v_pk_add_f32 v[18:19], v[18:19], v[118:119]
    v_pk_add_f32 v[20:21], v[20:21], v[120:121]
    v_pk_add_f32 v[22:23], v[22:23], v[122:123]
    v_pk_add_f32 v[24:25], v[24:25], v[124:125]
    v_pk_add_f32 v[26:27], v[26:27], v[126:127]
    v_pk_add_f32 v[28:29], v[28:29], v[128:129]
    v_pk_add_f32 v[30:31], v[30:31], v[130:131]
    v_pk_add_f32 v[32:33], v[32:33], v[132:133]
    v_pk_add_f32 v[34:35], v[34:35], v[134:135]
    v_pk_fma_f32 v[16:17], v[16:17], v[96:97], v[136:137]
    v_pk_fma_f32 v[18:19], v[18:19], v[98:99], v[138:139]
    v_pk_fma_f32 v[20:21], v[20:21], v[100:101], v[140:141]
    v_pk_fma_f32 v[22:23], v[22:23], v[102:103], v[142:143]
    v_pk_fma_f32 v[24:25], v[24:25], v[104:105], v[144:145]
    v_pk_fma_f32 v[26:27], v[26:27], v[106:107], v[146:147]
    v_pk_fma_f32 v[28:29], v[28:29], v[108:109], v[148:149]
    v_pk_fma_f32 v[30:31], v[30:31], v[110:111], v[150:151]
    v_pk_fma_f32 v[32:33], v[32:33], v[112:113], v[152:153]
    v_pk_fma_f32 v[34:35], v[34:35], v[114:115], v[154:155]
    v_cvt_pk_bf16_f32 v16, v16, v17
    v_cvt_pk_bf16_f32 v17, v18, v19
    v_cvt_pk_bf16_f32 v18, v20, v21
    v_cvt_pk_bf16_f32 v19, v22, v23
    v_cvt_pk_bf16_f32 v24, v24, v25
    v_cvt_pk_bf16_f32 v25, v26, v27
    v_cvt_pk_bf16_f32 v26, v28, v29
    v_cvt_pk_bf16_f32 v27, v30, v31
    v_cvt_pk_bf16_f32 v32, v32, v33
    v_cvt_pk_bf16_f32 v33, v34, v35
    s_nop 1
    v_permlane16_swap_b32 v16, v18
    v_permlane16_swap_b32 v17, v19
    v_permlane16_swap_b32 v24, v26
    v_permlane16_swap_b32 v25, v27
    v_and_b32 v9, 1, v3
    v_lshlrev_b32 v9, 5, v9
    v_lshrrev_b32 v11, 1, v3
    v_lshl_add_u32 v9, v11, 4, v9
    v_lshlrev_b32 v11, 3, v3
    v_sub_u32 v11, v10, v11
    v_add_u32 v11, v11, v9
    buffer_store_dwordx4 v[16:19], v11, s[24:27], s47 offen offset:0
    buffer_store_dwordx4 v[24:27], v11, s[24:27], s47 offen offset:64
    buffer_store_dwordx2 v[32:33], v10, s[24:27], s47 offen offset:128
    s_waitcnt vmcnt(0) lgkmcnt(0)
    s_endpgm
k2_end:
    s_endpgm
CODE_END:
    s_endpgm
.section .rodata,"a"
.p2align 6
.amdhsa_kernel k1_kernel
  .amdhsa_next_free_vgpr 256
  .amdhsa_next_free_sgpr 72
  .amdhsa_accum_offset 256
  .amdhsa_group_segment_fixed_size 0
  .amdhsa_kernarg_size 128
  .amdhsa_user_sgpr_count 2
  .amdhsa_user_sgpr_kernarg_segment_ptr 1
  .amdhsa_system_sgpr_workgroup_id_x 1
  .amdhsa_float_denorm_mode_32 3
.end_amdhsa_kernel
.p2align 6
.amdhsa_kernel k2_kernel
  .amdhsa_next_free_vgpr 512
  .amdhsa_next_free_sgpr 102
  .amdhsa_accum_offset 256
  .amdhsa_group_segment_fixed_size 0
  .amdhsa_kernarg_size 128
  .amdhsa_user_sgpr_count 2
  .amdhsa_user_sgpr_kernarg_segment_ptr 1
  .amdhsa_system_sgpr_workgroup_id_x 1
  .amdhsa_float_denorm_mode_32 3
.end_amdhsa_kernel
```

```asm
; @launch kernel=k1_kernel grid=(352,1,1) block=(256,1,1) lds=48128
; @launch kernel=k2_kernel grid=(256,1,1) block=(256,1,1) lds=163840
.amdgcn_target "amdgcn-amd-amdhsa--gfx950"
.text
.globl k1_kernel
.p2align 8
.type k1_kernel,@function
k1_kernel:
    s_cmp_ge_u32 s2, 352
    s_cbranch_scc1 k1_end
    s_load_dwordx4 s[4:7], s[0:1], 32
    s_load_dwordx2 s[10:11], s[0:1], 120
    s_load_dwordx4 s[12:15], s[0:1], 8
    s_load_dwordx2 s[8:9], s[0:1], 24
    v_lshrrev_b32 v2, 6, v0
    v_and_b32 v1, 63, v0
    v_readfirstlane_b32 s20, v2
    s_sub_u32 s54, s2, 160
    s_cmp_ge_u32 s2, 256
    s_cbranch_scc1 k1_side
    s_and_b32 s55, s2, 7
    s_lshr_b32 s56, s2, 3
    s_lshl_b32 s57, s55, 9
    s_add_u32 s57, s57, 9056256
    v_mov_b32 v250, 0
    s_waitcnt lgkmcnt(0)
    s_mov_b32 s28, s10
    s_mov_b32 s29, s11
    s_mov_b32 s30, 268435456
    s_mov_b32 s31, 0x00020000
    s_mov_b32 s16, s12
    s_mov_b32 s17, s13
    s_mov_b32 s18, 2621440
    s_mov_b32 s19, 0x00020000
    s_mov_b32 s40, s14
    s_mov_b32 s41, s15
    s_mov_b32 s42, 2621440
    s_mov_b32 s43, 0x00020000
    s_mov_b32 s44, s8
    s_mov_b32 s45, s9
    s_mov_b32 s46, 5120
    s_mov_b32 s47, 0x00020000
    v_mul_u32_u24 v4, 3277, v0
    v_lshrrev_b32 v4, 16, v4
    v_mul_u32_u24 v5, 20, v4
    v_sub_u32 v5, v0, v5
    s_lshl_b32 s21, s56, 6
    v_lshl_add_u32 v6, v4, 3, s21
    v_mul_u32_u24 v6, 1280, v6
    s_mul_i32 s22, s55, 160
    v_lshl_add_u32 v7, v5, 3, s22
    v_add_u32 v6, v6, v7
    v_subrev_u32 v8, 3840, v6
    v_add_u32 v9, 5120, v6
    s_movk_i32 s23, 160
    v_cmp_gt_u32 vcc, s23, v0
    s_and_saveexec_b64 s[60:61], vcc
    s_cbranch_execz k1_kvld
    buffer_load_dwordx2 v[10:11], v8, s[16:19], 0 offen offset:0
    buffer_load_dwordx2 v[12:13], v8, s[16:19], 0 offen offset:1280
    buffer_load_dwordx2 v[14:15], v8, s[16:19], 0 offen offset:2560
    buffer_load_dwordx2 v[16:17], v6, s[16:19], 0 offen offset:0
    buffer_load_dwordx2 v[18:19], v6, s[16:19], 0 offen offset:1280
    buffer_load_dwordx2 v[20:21], v6, s[16:19], 0 offen offset:2560
    buffer_load_dwordx2 v[22:23], v6, s[16:19], 0 offen offset:3840
    buffer_load_dwordx2 v[24:25], v9, s[16:19], 0 offen offset:0
    buffer_load_dwordx2 v[26:27], v9, s[16:19], 0 offen offset:1280
    buffer_load_dwordx2 v[28:29], v9, s[16:19], 0 offen offset:2560
    buffer_load_dwordx2 v[30:31], v9, s[16:19], 0 offen offset:3840
    v_lshlrev_b32 v150, 2, v7
    buffer_load_dwordx4 v[48:51], v150, s[44:47], 0 offen
    buffer_load_dwordx4 v[52:55], v150, s[44:47], 0 offen offset:16
    buffer_load_dwordx2 v[32:33], v6, s[40:43], 0 offen offset:0
    buffer_load_dwordx2 v[34:35], v6, s[40:43], 0 offen offset:1280
    buffer_load_dwordx2 v[36:37], v6, s[40:43], 0 offen offset:2560
    buffer_load_dwordx2 v[38:39], v6, s[40:43], 0 offen offset:3840
    buffer_load_dwordx2 v[40:41], v9, s[40:43], 0 offen offset:0
    buffer_load_dwordx2 v[42:43], v9, s[40:43], 0 offen offset:1280
    buffer_load_dwordx2 v[44:45], v9, s[40:43], 0 offen offset:2560
    buffer_load_dwordx2 v[46:47], v9, s[40:43], 0 offen offset:3840
k1_kvld:
    s_mov_b64 exec, -1
    buffer_load_dword v251, v250, s[28:31], s57 offen sc1
    v_and_b32 v249, 31, v1
    v_lshlrev_b32 v249, 2, v249
    buffer_load_dword v249, v249, s[28:31], s57 offen offset:256 sc1
    s_mov_b32 s24, s4
    s_mov_b32 s25, s5
    s_mov_b32 s26, 2621440
    s_mov_b32 s27, 0x00020000
    s_cmp_lt_u32 s56, 12
    s_cbranch_scc1 k1_kernel_nc1
    s_mul_i32 s58, s55, 20
    s_add_u32 s58, s58, s56
    s_sub_u32 s58, s58, 12
    s_lshl_b32 s21, s58, 2
    s_add_u32 s21, s21, s20
    s_mul_i32 s34, s20, 9472
    v_lshlrev_b32 v3, 4, v1
    s_lshl_b32 s35, s21, 12
    s_add_u32 s36, s34, 256
    s_mov_b32 m0, s36
    s_nop 0
    buffer_load_dwordx4 v3, s[24:27], s35 offen offset:0 lds
    buffer_load_dwordx4 v3, s[24:27], s35 offen offset:1024 lds
    buffer_load_dwordx4 v3, s[24:27], s35 offen offset:2048 lds
    buffer_load_dwordx4 v3, s[24:27], s35 offen offset:3072 lds
k1_kernel_nc1:
    s_mov_b64 exec, s[60:61]
    s_movk_i32 s23, 160
    v_cmp_gt_u32 vcc, s23, v0
    s_and_b64 exec, exec, vcc
    s_cbranch_execz k1_kvskip
    v_sub_u32 v150, 7, v4
    v_and_b32 v151, 7, v5
    v_xor_b32 v150, v150, v151
    v_lshlrev_b32 v150, 4, v150
    v_lshl_add_u32 v150, v5, 9, v150
    v_add_u32 v150, 37888, v150
    s_cmp_lt_u32 s56, 12
    s_cbranch_scc1 k1_w8
    s_waitcnt vmcnt(14)
    s_branch k1_w9
k1_w8:
    s_waitcnt vmcnt(10)
k1_w9:
    v_lshlrev_b32 v56, 16, v48
    v_and_b32 v60, 0xffff0000, v48
    v_lshlrev_b32 v64, 16, v49
    v_and_b32 v68, 0xffff0000, v49
    v_lshlrev_b32 v57, 16, v50
    v_and_b32 v61, 0xffff0000, v50
    v_lshlrev_b32 v65, 16, v51
    v_and_b32 v69, 0xffff0000, v51
    v_lshlrev_b32 v58, 16, v52
    v_and_b32 v62, 0xffff0000, v52
    v_lshlrev_b32 v66, 16, v53
    v_and_b32 v70, 0xffff0000, v53
    v_lshlrev_b32 v59, 16, v54
    v_and_b32 v63, 0xffff0000, v54
    v_lshlrev_b32 v67, 16, v55
    v_and_b32 v71, 0xffff0000, v55
    v_lshlrev_b32 v72, 16, v10
    v_and_b32 v73, 0xffff0000, v10
    v_lshlrev_b32 v74, 16, v11
    v_and_b32 v75, 0xffff0000, v11
    v_lshlrev_b32 v76, 16, v12
    v_and_b32 v77, 0xffff0000, v12
    v_lshlrev_b32 v78, 16, v13
    v_and_b32 v79, 0xffff0000, v13
    v_lshlrev_b32 v80, 16, v14
    v_and_b32 v81, 0xffff0000, v14
    v_lshlrev_b32 v82, 16, v15
    v_and_b32 v83, 0xffff0000, v15
    v_lshlrev_b32 v84, 16, v16
    v_and_b32 v85, 0xffff0000, v16
    v_lshlrev_b32 v86, 16, v17
    v_and_b32 v87, 0xffff0000, v17
    v_lshlrev_b32 v88, 16, v18
    v_and_b32 v89, 0xffff0000, v18
    v_lshlrev_b32 v90, 16, v19
    v_and_b32 v91, 0xffff0000, v19
    v_lshlrev_b32 v92, 16, v20
    v_and_b32 v93, 0xffff0000, v20
    v_lshlrev_b32 v94, 16, v21
    v_and_b32 v95, 0xffff0000, v21
    v_lshlrev_b32 v96, 16, v22
    v_and_b32 v97, 0xffff0000, v22
    v_lshlrev_b32 v98, 16, v23
    v_and_b32 v99, 0xffff0000, v23
    v_lshlrev_b32 v100, 16, v24
    v_and_b32 v101, 0xffff0000, v24
    v_lshlrev_b32 v102, 16, v25
    v_and_b32 v103, 0xffff0000, v25
    v_lshlrev_b32 v104, 16, v26
    v_and_b32 v105, 0xffff0000, v26
    v_lshlrev_b32 v106, 16, v27
    v_and_b32 v107, 0xffff0000, v27
    v_lshlrev_b32 v108, 16, v28
    v_and_b32 v109, 0xffff0000, v28
    v_lshlrev_b32 v110, 16, v29
    v_and_b32 v111, 0xffff0000, v29
    v_lshlrev_b32 v112, 16, v30
    v_and_b32 v113, 0xffff0000, v30
    v_lshlrev_b32 v114, 16, v31
    v_and_b32 v115, 0xffff0000, v31
    v_pk_mul_f32 v[116:117], v[72:73], v[68:69]
    v_pk_mul_f32 v[120:121], v[76:77], v[68:69]
    v_pk_mul_f32 v[124:125], v[80:81], v[68:69]
    v_pk_mul_f32 v[128:129], v[84:85], v[68:69]
    v_pk_mul_f32 v[132:133], v[88:89], v[68:69]
    v_pk_mul_f32 v[136:137], v[92:93], v[68:69]
    v_pk_mul_f32 v[140:141], v[96:97], v[68:69]
    v_pk_mul_f32 v[144:145], v[100:101], v[68:69]
    v_pk_fma_f32 v[116:117], v[76:77], v[64:65], v[116:117]
    v_pk_fma_f32 v[120:121], v[80:81], v[64:65], v[120:121]
    v_pk_fma_f32 v[124:125], v[84:85], v[64:65], v[124:125]
    v_pk_fma_f32 v[128:129], v[88:89], v[64:65], v[128:129]
    v_pk_fma_f32 v[132:133], v[92:93], v[64:65], v[132:133]
    v_pk_fma_f32 v[136:137], v[96:97], v[64:65], v[136:137]
    v_pk_fma_f32 v[140:141], v[100:101], v[64:65], v[140:141]
    v_pk_fma_f32 v[144:145], v[104:105], v[64:65], v[144:145]
    v_pk_fma_f32 v[116:117], v[80:81], v[60:61], v[116:117]
    v_pk_fma_f32 v[120:121], v[84:85], v[60:61], v[120:121]
    v_pk_fma_f32 v[124:125], v[88:89], v[60:61], v[124:125]
    v_pk_fma_f32 v[128:129], v[92:93], v[60:61], v[128:129]
    v_pk_fma_f32 v[132:133], v[96:97], v[60:61], v[132:133]
    v_pk_fma_f32 v[136:137], v[100:101], v[60:61], v[136:137]
    v_pk_fma_f32 v[140:141], v[104:105], v[60:61], v[140:141]
    v_pk_fma_f32 v[144:145], v[108:109], v[60:61], v[144:145]
    v_pk_fma_f32 v[116:117], v[84:85], v[56:57], v[116:117]
    v_pk_fma_f32 v[120:121], v[88:89], v[56:57], v[120:121]
    v_pk_fma_f32 v[124:125], v[92:93], v[56:57], v[124:125]
    v_pk_fma_f32 v[128:129], v[96:97], v[56:57], v[128:129]
    v_pk_fma_f32 v[132:133], v[100:101], v[56:57], v[132:133]
    v_pk_fma_f32 v[136:137], v[104:105], v[56:57], v[136:137]
    v_pk_fma_f32 v[140:141], v[108:109], v[56:57], v[140:141]
    v_pk_fma_f32 v[144:145], v[112:113], v[56:57], v[144:145]
    v_pk_mul_f32 v[118:119], v[74:75], v[70:71]
    v_pk_mul_f32 v[122:123], v[78:79], v[70:71]
    v_pk_mul_f32 v[126:127], v[82:83], v[70:71]
    v_pk_mul_f32 v[130:131], v[86:87], v[70:71]
    v_pk_mul_f32 v[134:135], v[90:91], v[70:71]
    v_pk_mul_f32 v[138:139], v[94:95], v[70:71]
    v_pk_mul_f32 v[142:143], v[98:99], v[70:71]
    v_pk_mul_f32 v[146:147], v[102:103], v[70:71]
    v_pk_fma_f32 v[118:119], v[78:79], v[66:67], v[118:119]
    v_pk_fma_f32 v[122:123], v[82:83], v[66:67], v[122:123]
    v_pk_fma_f32 v[126:127], v[86:87], v[66:67], v[126:127]
    v_pk_fma_f32 v[130:131], v[90:91], v[66:67], v[130:131]
    v_pk_fma_f32 v[134:135], v[94:95], v[66:67], v[134:135]
    v_pk_fma_f32 v[138:139], v[98:99], v[66:67], v[138:139]
    v_pk_fma_f32 v[142:143], v[102:103], v[66:67], v[142:143]
    v_pk_fma_f32 v[146:147], v[106:107], v[66:67], v[146:147]
    v_pk_fma_f32 v[118:119], v[82:83], v[62:63], v[118:119]
    v_pk_fma_f32 v[122:123], v[86:87], v[62:63], v[122:123]
    v_pk_fma_f32 v[126:127], v[90:91], v[62:63], v[126:127]
    v_pk_fma_f32 v[130:131], v[94:95], v[62:63], v[130:131]
    v_pk_fma_f32 v[134:135], v[98:99], v[62:63], v[134:135]
    v_pk_fma_f32 v[138:139], v[102:103], v[62:63], v[138:139]
    v_pk_fma_f32 v[142:143], v[106:107], v[62:63], v[142:143]
    v_pk_fma_f32 v[146:147], v[110:111], v[62:63], v[146:147]
    v_pk_fma_f32 v[118:119], v[86:87], v[58:59], v[118:119]
    v_pk_fma_f32 v[122:123], v[90:91], v[58:59], v[122:123]
    v_pk_fma_f32 v[126:127], v[94:95], v[58:59], v[126:127]
    v_pk_fma_f32 v[130:131], v[98:99], v[58:59], v[130:131]
    v_pk_fma_f32 v[134:135], v[102:103], v[58:59], v[134:135]
    v_pk_fma_f32 v[138:139], v[106:107], v[58:59], v[138:139]
    v_pk_fma_f32 v[142:143], v[110:111], v[58:59], v[142:143]
    v_pk_fma_f32 v[146:147], v[114:115], v[58:59], v[146:147]
    v_cvt_pk_bf16_f32 v154, v116, v117
    v_lshlrev_b32 v116, 16, v154
    v_and_b32 v117, 0xffff0000, v154
    v_cvt_pk_bf16_f32 v155, v118, v119
    v_lshlrev_b32 v118, 16, v155
    v_and_b32 v119, 0xffff0000, v155
    v_cvt_pk_bf16_f32 v156, v120, v121
    v_lshlrev_b32 v120, 16, v156
    v_and_b32 v121, 0xffff0000, v156
    v_cvt_pk_bf16_f32 v157, v122, v123
    v_lshlrev_b32 v122, 16, v157
    v_and_b32 v123, 0xffff0000, v157
    v_cvt_pk_bf16_f32 v158, v124, v125
    v_lshlrev_b32 v124, 16, v158
    v_and_b32 v125, 0xffff0000, v158
    v_cvt_pk_bf16_f32 v159, v126, v127
    v_lshlrev_b32 v126, 16, v159
    v_and_b32 v127, 0xffff0000, v159
    v_cvt_pk_bf16_f32 v160, v128, v129
    v_lshlrev_b32 v128, 16, v160
    v_and_b32 v129, 0xffff0000, v160
    v_cvt_pk_bf16_f32 v161, v130, v131
    v_lshlrev_b32 v130, 16, v161
    v_and_b32 v131, 0xffff0000, v161
    v_cvt_pk_bf16_f32 v154, v132, v133
    v_lshlrev_b32 v132, 16, v154
    v_and_b32 v133, 0xffff0000, v154
    v_cvt_pk_bf16_f32 v155, v134, v135
    v_lshlrev_b32 v134, 16, v155
    v_and_b32 v135, 0xffff0000, v155
    v_cvt_pk_bf16_f32 v156, v136, v137
    v_lshlrev_b32 v136, 16, v156
    v_and_b32 v137, 0xffff0000, v156
    v_cvt_pk_bf16_f32 v157, v138, v139
    v_lshlrev_b32 v138, 16, v157
    v_and_b32 v139, 0xffff0000, v157
    v_cvt_pk_bf16_f32 v158, v140, v141
    v_lshlrev_b32 v140, 16, v158
    v_and_b32 v141, 0xffff0000, v158
    v_cvt_pk_bf16_f32 v159, v142, v143
    v_lshlrev_b32 v142, 16, v159
    v_and_b32 v143, 0xffff0000, v159
    v_cvt_pk_bf16_f32 v160, v144, v145
    v_lshlrev_b32 v144, 16, v160
    v_and_b32 v145, 0xffff0000, v160
    v_cvt_pk_bf16_f32 v161, v146, v147
    v_lshlrev_b32 v146, 16, v161
    v_and_b32 v147, 0xffff0000, v161
    s_cmp_lt_u32 s56, 12
    s_cbranch_scc1 k1_w0
    s_waitcnt vmcnt(6)
    s_branch k1_w1
k1_w0:
    s_waitcnt vmcnt(2)
k1_w1:
    v_lshlrev_b32 v72, 16, v32
    v_and_b32 v73, 0xffff0000, v32
    v_lshlrev_b32 v74, 16, v33
    v_and_b32 v75, 0xffff0000, v33
    v_lshlrev_b32 v76, 16, v34
    v_and_b32 v77, 0xffff0000, v34
    v_lshlrev_b32 v78, 16, v35
    v_and_b32 v79, 0xffff0000, v35
    v_lshlrev_b32 v80, 16, v36
    v_and_b32 v81, 0xffff0000, v36
    v_lshlrev_b32 v82, 16, v37
    v_and_b32 v83, 0xffff0000, v37
    v_lshlrev_b32 v84, 16, v38
    v_and_b32 v85, 0xffff0000, v38
    v_lshlrev_b32 v86, 16, v39
    v_and_b32 v87, 0xffff0000, v39
    v_lshlrev_b32 v88, 16, v40
    v_and_b32 v89, 0xffff0000, v40
    v_lshlrev_b32 v90, 16, v41
    v_and_b32 v91, 0xffff0000, v41
    v_lshlrev_b32 v92, 16, v42
    v_and_b32 v93, 0xffff0000, v42
    v_lshlrev_b32 v94, 16, v43
    v_and_b32 v95, 0xffff0000, v43
    v_lshlrev_b32 v96, 16, v44
    v_and_b32 v97, 0xffff0000, v44
    v_lshlrev_b32 v98, 16, v45
    v_and_b32 v99, 0xffff0000, v45
    v_lshlrev_b32 v100, 16, v46
    v_and_b32 v101, 0xffff0000, v46
    v_lshlrev_b32 v102, 16, v47
    v_and_b32 v103, 0xffff0000, v47
    v_pk_mul_f32 v[116:117], v[116:117], v[72:73]
    v_pk_mul_f32 v[118:119], v[118:119], v[74:75]
    v_pk_mul_f32 v[120:121], v[120:121], v[76:77]
    v_pk_mul_f32 v[122:123], v[122:123], v[78:79]
    v_pk_mul_f32 v[124:125], v[124:125], v[80:81]
    v_pk_mul_f32 v[126:127], v[126:127], v[82:83]
    v_pk_mul_f32 v[128:129], v[128:129], v[84:85]
    v_pk_mul_f32 v[130:131], v[130:131], v[86:87]
    v_pk_mul_f32 v[132:133], v[132:133], v[88:89]
    v_pk_mul_f32 v[134:135], v[134:135], v[90:91]
    v_pk_mul_f32 v[136:137], v[136:137], v[92:93]
    v_pk_mul_f32 v[138:139], v[138:139], v[94:95]
    v_pk_mul_f32 v[140:141], v[140:141], v[96:97]
    v_pk_mul_f32 v[142:143], v[142:143], v[98:99]
    v_pk_mul_f32 v[144:145], v[144:145], v[100:101]
    v_pk_mul_f32 v[146:147], v[146:147], v[102:103]
    v_cvt_pk_bf16_f32 v10, v144, v140
    v_cvt_pk_bf16_f32 v11, v136, v132
    v_cvt_pk_bf16_f32 v12, v128, v124
    v_cvt_pk_bf16_f32 v13, v120, v116
    v_cvt_pk_bf16_f32 v14, v145, v141
    v_cvt_pk_bf16_f32 v15, v137, v133
    v_cvt_pk_bf16_f32 v16, v129, v125
    v_cvt_pk_bf16_f32 v17, v121, v117
    v_cvt_pk_bf16_f32 v18, v146, v142
    v_cvt_pk_bf16_f32 v19, v138, v134
    v_cvt_pk_bf16_f32 v20, v130, v126
    v_cvt_pk_bf16_f32 v21, v122, v118
    v_cvt_pk_bf16_f32 v22, v147, v143
    v_cvt_pk_bf16_f32 v23, v139, v135
    v_cvt_pk_bf16_f32 v24, v131, v127
    v_cvt_pk_bf16_f32 v25, v123, v119
    ds_write_b128 v150, v[10:13] offset:0
    ds_write_b128 v150, v[14:17] offset:128
    ds_write_b128 v150, v[18:21] offset:256
    ds_write_b128 v150, v[22:25] offset:384
k1_kvskip:
    s_mov_b64 exec, -1
    v_lshrrev_b32 v151, 3, v0
    v_and_b32 v152, 7, v0
    v_lshrrev_b32 v153, 2, v151
    v_and_b32 v153, 7, v153
    v_xor_b32 v153, v153, v152
    v_lshlrev_b32 v153, 4, v153
    v_lshl_add_u32 v153, v151, 7, v153
    v_add_u32 v153, 37888, v153
    v_mul_u32_u24 v151, 4224, v151
    v_lshl_add_u32 v154, v152, 4, v151
    s_mul_i32 s36, s55, 337920
    s_add_u32 s36, s36, 0
    s_lshl_b32 s37, s56, 7
    s_sub_u32 s38, 3968, s37
    s_add_u32 s38, s38, s36
    s_waitcnt lgkmcnt(0)
    s_barrier
    ds_read_b128 v[32:35], v153 offset:0
    ds_read_b128 v[36:39], v153 offset:4096
    ds_read_b128 v[40:43], v153 offset:8192
    s_waitcnt lgkmcnt(2)
    buffer_store_dwordx4 v[32:35], v154, s[28:31], s38 offen sc1
    s_add_u32 s38, s38, 135168
    s_waitcnt lgkmcnt(1)
    buffer_store_dwordx4 v[36:39], v154, s[28:31], s38 offen sc1
    s_add_u32 s38, s38, 135168
    s_movk_i32 s23, 128
    v_cmp_gt_u32 vcc, s23, v0
    s_and_saveexec_b64 s[60:61], vcc
    s_cbranch_execz k1_st2skip
    s_waitcnt lgkmcnt(0)
    buffer_store_dwordx4 v[40:43], v154, s[28:31], s38 offen sc1
    s_add_u32 s38, s38, 135168
k1_st2skip:
    s_mov_b64 exec, -1
    s_cmp_lg_u32 s56, 0
    s_cbranch_scc1 k1_kernel_L2
    v_mov_b32 v44, 0
    v_mov_b32 v45, 0
    v_mov_b32 v46, 0
    v_mov_b32 v47, 0
    s_add_u32 s36, s36, 4096
    buffer_store_dwordx4 v[44:47], v154, s[28:31], s36 offen sc1
    s_add_u32 s36, s36, 135168
    buffer_store_dwordx4 v[44:47], v154, s[28:31], s36 offen sc1
    s_add_u32 s36, s36, 135168
    s_movk_i32 s23, 128
    v_cmp_gt_u32 vcc, s23, v0
    s_and_b64 exec, exec, vcc
    s_cbranch_execz k1_kernel_L2
    buffer_store_dwordx4 v[44:47], v154, s[28:31], s36 offen sc1
    s_add_u32 s36, s36, 135168
k1_kernel_L2:
    s_mov_b64 exec, -1
    s_waitcnt vmcnt(0)
    v_add_u32 v251, 1, v251
    s_barrier
    s_cmp_lg_u32 s20, 0
    s_cbranch_scc1 k1_kernel_kf3
    s_lshl_b32 s23, s56, 2
    s_add_u32 s23, s23, s57
    s_mov_b64 exec, 1
    buffer_store_dword v251, v250, s[28:31], s23 offen offset:256
    buffer_store_dword v251, v250, s[28:31], s23 offen offset:128 sc1
    s_mov_b64 exec, -1
k1_kernel_kf3:
    s_lshl_b32 s54, s56, 3
    s_add_u32 s54, s54, s55
    s_cmp_lt_u32 s56, 12
    s_cbranch_scc1 k1_side2
    s_mov_b32 s2, s58
    s_setprio 3
    s_lshl_b32 s21, s2, 3
    s_add_u32 s22, s6, s21
    s_addc_u32 s23, s7, 0
    s_load_dwordx2 s[32:33], s[22:23], 0
    s_lshl_b32 s21, s2, 2
    s_add_u32 s21, s21, s20
    s_mul_i32 s34, s20, 9472
    v_lshlrev_b32 v3, 4, v1
    s_mul_i32 s37, s21, 4224
    s_add_u32 s37, s37, 0
    v_lshrrev_b32 v4, 3, v0
    v_mul_u32_u24 v4, 20480, v4
    s_lshr_b32 s38, s2, 1
    s_and_b32 s38, s38, 7
    v_and_b32 v5, 7, v0
    v_xor_b32 v5, s38, v5
    v_lshl_add_u32 v4, v5, 4, v4
    s_lshl_b32 s38, s2, 7
    v_add_u32 v20, 0, v1
    v_mul_u32_u24 v21, 3856, v20
    v_lshrrev_b32 v21, 16, v21
    v_mul_u32_u24 v22, 17, v21
    v_sub_u32 v22, v20, v22
    v_lshlrev_b32 v22, 4, v22
    v_lshlrev_b32 v21, 8, v21
    v_sub_u32 v22, v22, v21
    v_add_u32 v23, 3840, v22
    v_add_u32 v20, 64, v1
    v_mul_u32_u24 v21, 3856, v20
    v_lshrrev_b32 v21, 16, v21
    v_mul_u32_u24 v22, 17, v21
    v_sub_u32 v22, v20, v22
    v_lshlrev_b32 v22, 4, v22
    v_lshlrev_b32 v21, 8, v21
    v_sub_u32 v22, v22, v21
    v_add_u32 v24, 3840, v22
    v_add_u32 v20, 128, v1
    v_mul_u32_u24 v21, 3856, v20
    v_lshrrev_b32 v21, 16, v21
    v_mul_u32_u24 v22, 17, v21
    v_sub_u32 v22, v20, v22
    v_lshlrev_b32 v22, 4, v22
    v_lshlrev_b32 v21, 8, v21
    v_sub_u32 v22, v22, v21
    v_add_u32 v25, 3840, v22
    v_add_u32 v20, 192, v1
    v_mul_u32_u24 v21, 3856, v20
    v_lshrrev_b32 v21, 16, v21
    v_mul_u32_u24 v22, 17, v21
    v_sub_u32 v22, v20, v22
    v_lshlrev_b32 v22, 4, v22
    v_lshlrev_b32 v21, 8, v21
    v_sub_u32 v22, v22, v21
    v_add_u32 v26, 3840, v22
    v_add_u32 v20, 256, v1
    v_mul_u32_u24 v21, 3856, v20
    v_lshrrev_b32 v21, 16, v21
    v_mul_u32_u24 v22, 17, v21
    v_sub_u32 v22, v20, v22
    v_lshlrev_b32 v22, 4, v22
    v_lshlrev_b32 v21, 8, v21
    v_sub_u32 v22, v22, v21
    v_add_u32 v27, 3840, v22
    v_lshl_add_u32 v5, v1, 2, s34
    v_mov_b32 v6, 0
    ds_write_b32 v5, v6
    v_and_b32 v7, 15, v1
    v_bfe_u32 v8, v1, 4, 1
    v_lshrrev_b32 v9, 5, v1
    v_mul_u32_u24 v10, 272, v7
    v_lshl_add_u32 v10, v9, 4, v10
    v_add_u32 v10, s34, v10
    v_add_u32 v10, 4356, v10
    v_lshlrev_b32 v11, 2, v8
    v_sub_u32 v10, v10, v11
    v_and_b32 v12, 7, v1
    v_mul_u32_u24 v13, 272, v12
    v_lshl_add_u32 v13, v9, 4, v13
    v_add_u32 v13, s34, v13
    v_add_u32 v13, 4356, v13
    v_sub_u32 v13, v13, v11
    v_bfe_u32 v11, v1, 3, 1
    v_lshlrev_b32 v11, 4, v11
    v_sub_u32 v11, 16, v11
    v_and_b32 v14, 31, v1
    v_lshlrev_b32 v14, 3, v14
    v_lshl_add_u32 v14, v9, 4, v14
    v_add_u32 v14, s34, v14
    v_add_u32 v14, 8, v14
    v_cmp_ne_u32 vcc, 0, v12
    v_mov_b32 v16, 0
    s_nop 1
    v_cndmask_b32 v15, v16, -1, vcc
    s_waitcnt lgkmcnt(0)
    ds_read_b64 v[176:177], v14 offset:1792
    ds_read_b64 v[178:179], v14 offset:1800
    ds_read_b64 v[180:181], v14 offset:1824
    ds_read_b64 v[182:183], v14 offset:1832
    ds_read_b64 v[184:185], v14 offset:1856
    ds_read_b64 v[186:187], v14 offset:1864
    ds_read_b64 v[188:189], v14 offset:1888
    ds_read_b64 v[190:191], v14 offset:1896
    ds_read_b64 v[192:193], v14 offset:1920
    ds_read_b64 v[194:195], v14 offset:1928
    ds_read_b64 v[196:197], v14 offset:1952
    ds_read_b64 v[198:199], v14 offset:1960
    ds_read_b64 v[200:201], v14 offset:1984
    ds_read_b64 v[202:203], v14 offset:1992
    ds_read_b64 v[204:205], v14 offset:2016
    ds_read_b64 v[206:207], v14 offset:2024
    s_cmp_lg_u32 s20, 0
    s_cbranch_scc1 k1_kernel_kw4
    v_and_b32 v40, 31, v1
    v_lshlrev_b32 v40, 2, v40
    s_mov_b32 s23, 200000
    s_mov_b64 s[60:61], 0
k1_kernel_kp5:
    buffer_load_dword v41, v40, s[28:31], s57 offen offset:256 sc1
    s_waitcnt vmcnt(0)
    v_cmp_eq_u32 vcc, v251, v41
    s_sub_u32 s23, s23, 1
    s_or_b64 s[60:61], s[60:61], vcc
    s_cmp_eq_u64 s[60:61], -1
    s_cbranch_scc1 k1_kernel_kd6
    s_and_b32 s21, s23, 3
    s_cmp_lg_u32 s21, 0
    s_cbranch_scc1 k1_kernel_kq8
    buffer_load_dword v41, v40, s[28:31], s57 offen offset:128 sc1
    s_waitcnt vmcnt(0)
    v_cmp_eq_u32 vcc, v251, v41
    s_nop 1
    s_or_b64 s[60:61], s[60:61], vcc
    s_cmp_eq_u64 s[60:61], -1
    s_cbranch_scc1 k1_kernel_kd6
k1_kernel_kq8:
    s_sleep 2
    s_cmp_lg_u32 s23, 0
    s_cbranch_scc1 k1_kernel_kp5
k1_kernel_kd6:
    s_cmp_lg_u32 s56, 12
    s_cbranch_scc1 k1_kernel_kw4
    s_mov_b64 exec, 1
    buffer_store_dword v251, v250, s[28:31], s57 offen sc1
    s_mov_b64 exec, -1
k1_kernel_kw4:
    s_barrier
    s_add_u32 s36, s34, 4352
    s_mov_b32 m0, s36
    s_nop 0
    buffer_load_dwordx4 v23, s[28:31], s37 offen sc1 lds
    s_add_u32 s36, s34, 5376
    s_mov_b32 m0, s36
    s_nop 0
    buffer_load_dwordx4 v24, s[28:31], s37 offen sc1 lds
    s_add_u32 s36, s34, 6400
    s_mov_b32 m0, s36
    s_nop 0
    buffer_load_dwordx4 v25, s[28:31], s37 offen sc1 lds
    s_add_u32 s36, s34, 7424
    s_mov_b32 m0, s36
    s_nop 0
    buffer_load_dwordx4 v26, s[28:31], s37 offen sc1 lds
    s_add_u32 s36, s34, 8448
    s_mov_b32 m0, s36
    s_mov_b64 exec, 0xffff
    buffer_load_dwordx4 v27, s[28:31], s37 offen sc1 lds
    s_mov_b64 exec, -1
    s_waitcnt vmcnt(0) lgkmcnt(0)
    ds_read2_b32 v[64:65], v10 offset0:0 offset1:1
    ds_read2_b32 v[66:67], v10 offset0:2 offset1:3
    ds_read2_b32 v[68:69], v10 offset0:8 offset1:9
    ds_read2_b32 v[70:71], v10 offset0:10 offset1:11
    ds_read2_b32 v[72:73], v10 offset0:16 offset1:17
    ds_read2_b32 v[74:75], v10 offset0:18 offset1:19
    ds_read2_b32 v[76:77], v10 offset0:24 offset1:25
    ds_read2_b32 v[78:79], v10 offset0:26 offset1:27
    ds_read2_b32 v[80:81], v10 offset0:32 offset1:33
    ds_read2_b32 v[82:83], v10 offset0:34 offset1:35
    ds_read2_b32 v[84:85], v10 offset0:40 offset1:41
    ds_read2_b32 v[86:87], v10 offset0:42 offset1:43
    ds_read2_b32 v[88:89], v10 offset0:48 offset1:49
    ds_read2_b32 v[90:91], v10 offset0:50 offset1:51
    ds_read2_b32 v[92:93], v10 offset0:56 offset1:57
    ds_read2_b32 v[94:95], v10 offset0:58 offset1:59
    s_waitcnt lgkmcnt(0)
    v_mfma_f32_32x32x16_bf16 v[144:159], v[176:179], v[64:67], 0
    ds_read_b32 v16, v10 offset:16
    ds_read_b32 v17, v10 offset:48
    ds_read_b32 v18, v10 offset:80
    ds_read_b32 v19, v10 offset:112
    ds_read_b32 v20, v10 offset:144
    ds_read_b32 v21, v10 offset:176
    ds_read_b32 v22, v10 offset:208
    ds_read_b32 v23, v10 offset:240
    ds_read2_b32 v[96:97], v13 offset0:0 offset1:1
    ds_read2_b32 v[98:99], v13 offset0:2 offset1:3
    ds_read_b32 v24, v13 offset:16
    ds_read2_b32 v[100:101], v13 offset0:8 offset1:9
    ds_read2_b32 v[102:103], v13 offset0:10 offset1:11
    ds_read_b32 v25, v13 offset:48
    ds_read2_b32 v[104:105], v13 offset0:16 offset1:17
    ds_read2_b32 v[106:107], v13 offset0:18 offset1:19
    v_mfma_f32_32x32x16_bf16 v[144:159], v[180:183], v[68:71], v[144:159]
    ds_read_b32 v26, v13 offset:80
    ds_read2_b32 v[108:109], v13 offset0:24 offset1:25
    ds_read2_b32 v[110:111], v13 offset0:26 offset1:27
    ds_read_b32 v27, v13 offset:112
    ds_read2_b32 v[112:113], v13 offset0:32 offset1:33
    ds_read2_b32 v[114:115], v13 offset0:34 offset1:35
    ds_read_b32 v28, v13 offset:144
    ds_read2_b32 v[116:117], v13 offset0:40 offset1:41
    ds_read2_b32 v[118:119], v13 offset0:42 offset1:43
    ds_read_b32 v29, v13 offset:176
    ds_read2_b32 v[120:121], v13 offset0:48 offset1:49
    ds_read2_b32 v[122:123], v13 offset0:50 offset1:51
    ds_read_b32 v30, v13 offset:208
    ds_read2_b32 v[124:125], v13 offset0:56 offset1:57
    ds_read2_b32 v[126:127], v13 offset0:58 offset1:59
    ds_read_b32 v31, v13 offset:240
    v_mfma_f32_32x32x16_bf16 v[144:159], v[184:187], v[72:75], v[144:159]
    s_waitcnt lgkmcnt(15)
    s_waitcnt lgkmcnt(0)
    v_alignbit_b32 v32, v65, v64, 16
    v_alignbit_b32 v33, v66, v65, 16
    v_alignbit_b32 v34, v67, v66, 16
    v_alignbit_b32 v35, v16, v67, 16
    v_mfma_f32_32x32x16_bf16 v[144:159], v[188:191], v[76:79], v[144:159]
    v_alignbit_b32 v36, v69, v68, 16
    v_alignbit_b32 v37, v70, v69, 16
    v_alignbit_b32 v38, v71, v70, 16
    v_alignbit_b32 v39, v17, v71, 16
    v_alignbit_b32 v40, v73, v72, 16
    v_alignbit_b32 v41, v74, v73, 16
    v_mfma_f32_32x32x16_bf16 v[144:159], v[192:195], v[80:83], v[144:159]
    v_alignbit_b32 v42, v75, v74, 16
    v_alignbit_b32 v43, v18, v75, 16
    v_alignbit_b32 v44, v77, v76, 16
    v_alignbit_b32 v45, v78, v77, 16
    v_alignbit_b32 v46, v79, v78, 16
    v_alignbit_b32 v47, v19, v79, 16
    v_mfma_f32_32x32x16_bf16 v[144:159], v[196:199], v[84:87], v[144:159]
    v_alignbit_b32 v48, v81, v80, 16
    v_alignbit_b32 v49, v82, v81, 16
    v_alignbit_b32 v50, v83, v82, 16
    v_alignbit_b32 v51, v20, v83, 16
    v_alignbit_b32 v52, v85, v84, 16
    v_alignbit_b32 v53, v86, v85, 16
    v_mfma_f32_32x32x16_bf16 v[144:159], v[200:203], v[88:91], v[144:159]
    v_alignbit_b32 v54, v87, v86, 16
    v_alignbit_b32 v55, v21, v87, 16
    v_alignbit_b32 v56, v89, v88, 16
    v_alignbit_b32 v57, v90, v89, 16
    v_alignbit_b32 v58, v91, v90, 16
    v_alignbit_b32 v59, v22, v91, 16
    v_mfma_f32_32x32x16_bf16 v[144:159], v[204:207], v[92:95], v[144:159]
    v_alignbit_b32 v60, v93, v92, 16
    v_alignbit_b32 v61, v94, v93, 16
    v_alignbit_b32 v62, v95, v94, 16
    v_alignbit_b32 v63, v23, v95, 16
    s_nop 0
    v_mfma_f32_32x32x16_bf16 v[128:143], v[176:179], v[32:35], 0
    ds_read_b64 v[208:209], v14 offset:3840
    ds_read_b64 v[210:211], v14 offset:3848
    s_nop 2
    v_mfma_f32_32x32x16_bf16 v[128:143], v[180:183], v[36:39], v[128:143]
    ds_read_b64 v[212:213], v14 offset:3872
    ds_read_b64 v[214:215], v14 offset:3880
    s_nop 2
    v_mfma_f32_32x32x16_bf16 v[128:143], v[184:187], v[40:43], v[128:143]
    ds_read_b64 v[216:217], v14 offset:3904
    ds_read_b64 v[218:219], v14 offset:3912
    v_alignbit_b32 v96, v97, v96, v11
    v_alignbit_b32 v97, v98, v97, v11
    v_alignbit_b32 v98, v99, v98, v11
    v_alignbit_b32 v99, v24, v99, v11
    v_alignbit_b32 v100, v101, v100, v11
    v_alignbit_b32 v101, v102, v101, v11
    v_alignbit_b32 v102, v103, v102, v11
    v_alignbit_b32 v103, v25, v103, v11
    v_alignbit_b32 v104, v105, v104, v11
    v_mfma_f32_32x32x16_bf16 v[128:143], v[188:191], v[44:47], v[128:143]
    ds_read_b64 v[220:221], v14 offset:3936
    ds_read_b64 v[222:223], v14 offset:3944
    v_alignbit_b32 v105, v106, v105, v11
    v_alignbit_b32 v106, v107, v106, v11
    v_alignbit_b32 v107, v26, v107, v11
    v_alignbit_b32 v108, v109, v108, v11
    v_alignbit_b32 v109, v110, v109, v11
    v_alignbit_b32 v110, v111, v110, v11
    v_alignbit_b32 v111, v27, v111, v11
    v_mov_b32_dpp v144, v144 row_shr:1 row_mask:0xf bank_mask:0xf bound_ctrl:0
    v_mfma_f32_32x32x16_bf16 v[128:143], v[192:195], v[48:51], v[128:143]
    ds_read_b64 v[224:225], v14 offset:3968
    ds_read_b64 v[226:227], v14 offset:3976
    v_mov_b32_dpp v145, v145 row_shr:1 row_mask:0xf bank_mask:0xf bound_ctrl:0
    v_mov_b32_dpp v146, v146 row_shr:1 row_mask:0xf bank_mask:0xf bound_ctrl:0
    v_mov_b32_dpp v147, v147 row_shr:1 row_mask:0xf bank_mask:0xf bound_ctrl:0
    v_mov_b32_dpp v148, v148 row_shr:1 row_mask:0xf bank_mask:0xf bound_ctrl:0
    v_mov_b32_dpp v149, v149 row_shr:1 row_mask:0xf bank_mask:0xf bound_ctrl:0
    v_mov_b32_dpp v150, v150 row_shr:1 row_mask:0xf bank_mask:0xf bound_ctrl:0
    v_mov_b32_dpp v151, v151 row_shr:1 row_mask:0xf bank_mask:0xf bound_ctrl:0
    v_mov_b32_dpp v152, v152 row_shr:1 row_mask:0xf bank_mask:0xf bound_ctrl:0
    v_mfma_f32_32x32x16_bf16 v[128:143], v[196:199], v[52:55], v[128:143]
    ds_read_b64 v[228:229], v14 offset:4000
    ds_read_b64 v[230:231], v14 offset:4008
    v_mov_b32_dpp v153, v153 row_shr:1 row_mask:0xf bank_mask:0xf bound_ctrl:0
    v_mov_b32_dpp v154, v154 row_shr:1 row_mask:0xf bank_mask:0xf bound_ctrl:0
    v_mov_b32_dpp v155, v155 row_shr:1 row_mask:0xf bank_mask:0xf bound_ctrl:0
    v_mov_b32_dpp v156, v156 row_shr:1 row_mask:0xf bank_mask:0xf bound_ctrl:0
    v_mov_b32_dpp v157, v157 row_shr:1 row_mask:0xf bank_mask:0xf bound_ctrl:0
    v_mov_b32_dpp v158, v158 row_shr:1 row_mask:0xf bank_mask:0xf bound_ctrl:0
    v_mov_b32_dpp v159, v159 row_shr:1 row_mask:0xf bank_mask:0xf bound_ctrl:0
    v_alignbit_b32 v112, v113, v112, v11
    v_mfma_f32_32x32x16_bf16 v[128:143], v[200:203], v[56:59], v[128:143]
    ds_read_b64 v[232:233], v14 offset:4032
    ds_read_b64 v[234:235], v14 offset:4040
    v_alignbit_b32 v113, v114, v113, v11
    v_alignbit_b32 v114, v115, v114, v11
    v_alignbit_b32 v115, v28, v115, v11
    v_alignbit_b32 v116, v117, v116, v11
    v_alignbit_b32 v117, v118, v117, v11
    v_alignbit_b32 v118, v119, v118, v11
    v_alignbit_b32 v119, v29, v119, v11
    v_alignbit_b32 v120, v121, v120, v11
    v_mfma_f32_32x32x16_bf16 v[128:143], v[204:207], v[60:63], v[128:143]
    ds_read_b64 v[236:237], v14 offset:4064
    ds_read_b64 v[238:239], v14 offset:4072
    v_alignbit_b32 v121, v122, v121, v11
    v_alignbit_b32 v122, v123, v122, v11
    v_alignbit_b32 v123, v30, v123, v11
    v_alignbit_b32 v124, v125, v124, v11
    v_alignbit_b32 v125, v126, v125, v11
    v_alignbit_b32 v126, v127, v126, v11
    v_alignbit_b32 v127, v31, v127, v11
    s_nop 0
    s_waitcnt lgkmcnt(0)
    v_mfma_f32_32x32x16_bf16 v[160:175], v[208:211], v[96:99], 0
    ds_read_b64 v[176:177], v14 offset:1536
    ds_read_b64 v[178:179], v14 offset:1544
    ds_read_b64 v[180:181], v14 offset:1568
    ds_read_b64 v[182:183], v14 offset:1576
    s_nop 0
    v_mfma_f32_32x32x16_bf16 v[160:175], v[212:215], v[100:103], v[160:175]
    ds_read_b64 v[184:185], v14 offset:1600
    ds_read_b64 v[186:187], v14 offset:1608
    ds_read_b64 v[188:189], v14 offset:1632
    s_nop 1
    v_mfma_f32_32x32x16_bf16 v[160:175], v[216:219], v[104:107], v[160:175]
    ds_read_b64 v[190:191], v14 offset:1640
    ds_read_b64 v[192:193], v14 offset:1664
    ds_read_b64 v[194:195], v14 offset:1672
    v_mov_b32_dpp v128, v128 row_shr:1 row_mask:0xf bank_mask:0xf bound_ctrl:0
    v_mov_b32_dpp v129, v129 row_shr:1 row_mask:0xf bank_mask:0xf bound_ctrl:0
    v_mov_b32_dpp v130, v130 row_shr:1 row_mask:0xf bank_mask:0xf bound_ctrl:0
    v_mfma_f32_32x32x16_bf16 v[160:175], v[220:223], v[108:111], v[160:175]
    ds_read_b64 v[196:197], v14 offset:1696
    ds_read_b64 v[198:199], v14 offset:1704
    ds_read_b64 v[200:201], v14 offset:1728
    v_mov_b32_dpp v131, v131 row_shr:1 row_mask:0xf bank_mask:0xf bound_ctrl:0
    v_mov_b32_dpp v132, v132 row_shr:1 row_mask:0xf bank_mask:0xf bound_ctrl:0
    v_mov_b32_dpp v133, v133 row_shr:1 row_mask:0xf bank_mask:0xf bound_ctrl:0
    v_mfma_f32_32x32x16_bf16 v[160:175], v[224:227], v[112:115], v[160:175]
    ds_read_b64 v[202:203], v14 offset:1736
    ds_read_b64 v[204:205], v14 offset:1760
    ds_read_b64 v[206:207], v14 offset:1768
    v_mov_b32_dpp v134, v134 row_shr:1 row_mask:0xf bank_mask:0xf bound_ctrl:0
    v_mov_b32_dpp v135, v135 row_shr:1 row_mask:0xf bank_mask:0xf bound_ctrl:0
    v_mov_b32_dpp v136, v136 row_shr:1 row_mask:0xf bank_mask:0xf bound_ctrl:0
    v_mfma_f32_32x32x16_bf16 v[160:175], v[228:231], v[116:119], v[160:175]
    v_mov_b32_dpp v137, v137 row_shr:1 row_mask:0xf bank_mask:0xf bound_ctrl:0
    v_mov_b32_dpp v138, v138 row_shr:1 row_mask:0xf bank_mask:0xf bound_ctrl:0
    v_mov_b32_dpp v139, v139 row_shr:1 row_mask:0xf bank_mask:0xf bound_ctrl:0
    v_mfma_f32_32x32x16_bf16 v[160:175], v[232:235], v[120:123], v[160:175]
    v_mov_b32_dpp v140, v140 row_shr:1 row_mask:0xf bank_mask:0xf bound_ctrl:0
    v_mov_b32_dpp v141, v141 row_shr:1 row_mask:0xf bank_mask:0xf bound_ctrl:0
    v_mfma_f32_32x32x16_bf16 v[160:175], v[236:239], v[124:127], v[160:175]
    v_mov_b32_dpp v142, v142 row_shr:1 row_mask:0xf bank_mask:0xf bound_ctrl:0
    v_mov_b32_dpp v143, v143 row_shr:1 row_mask:0xf bank_mask:0xf bound_ctrl:0
    s_waitcnt lgkmcnt(0)
    v_mfma_f32_32x32x16_bf16 v[144:159], v[176:179], v[64:67], v[144:159]
    ds_read_b64 v[208:209], v14 offset:3584
    ds_read_b64 v[210:211], v14 offset:3592
    s_nop 2
    v_mfma_f32_32x32x16_bf16 v[144:159], v[180:183], v[68:71], v[144:159]
    ds_read_b64 v[212:213], v14 offset:3616
    ds_read_b64 v[214:215], v14 offset:3624
    s_nop 2
    v_mfma_f32_32x32x16_bf16 v[144:159], v[184:187], v[72:75], v[144:159]
    ds_read_b64 v[216:217], v14 offset:3648
    ds_read_b64 v[218:219], v14 offset:3656
    v_and_b32_dpp v160, v160, v15 row_shr:1 row_mask:0xf bank_mask:0xf bound_ctrl:0
    v_and_b32_dpp v161, v161, v15 row_shr:1 row_mask:0xf bank_mask:0xf bound_ctrl:0
    v_and_b32_dpp v162, v162, v15 row_shr:1 row_mask:0xf bank_mask:0xf bound_ctrl:0
    v_mfma_f32_32x32x16_bf16 v[144:159], v[188:191], v[76:79], v[144:159]
    ds_read_b64 v[220:221], v14 offset:3680
    ds_read_b64 v[222:223], v14 offset:3688
    v_and_b32_dpp v163, v163, v15 row_shr:1 row_mask:0xf bank_mask:0xf bound_ctrl:0
    v_and_b32_dpp v164, v164, v15 row_shr:1 row_mask:0xf bank_mask:0xf bound_ctrl:0
    v_and_b32_dpp v165, v165, v15 row_shr:1 row_mask:0xf bank_mask:0xf bound_ctrl:0
    v_mfma_f32_32x32x16_bf16 v[144:159], v[192:195], v[80:83], v[144:159]
    ds_read_b64 v[224:225], v14 offset:3712
    ds_read_b64 v[226:227], v14 offset:3720
    v_and_b32_dpp v166, v166, v15 row_shr:1 row_mask:0xf bank_mask:0xf bound_ctrl:0
    v_and_b32_dpp v167, v167, v15 row_shr:1 row_mask:0xf bank_mask:0xf bound_ctrl:0
    v_and_b32_dpp v168, v168, v15 row_shr:1 row_mask:0xf bank_mask:0xf bound_ctrl:0
    v_mfma_f32_32x32x16_bf16 v[144:159], v[196:199], v[84:87], v[144:159]
    ds_read_b64 v[228:229], v14 offset:3744
    ds_read_b64 v[230:231], v14 offset:3752
    v_and_b32_dpp v169, v169, v15 row_shr:1 row_mask:0xf bank_mask:0xf bound_ctrl:0
    v_and_b32_dpp v170, v170, v15 row_shr:1 row_mask:0xf bank_mask:0xf bound_ctrl:0
    v_and_b32_dpp v171, v171, v15 row_shr:1 row_mask:0xf bank_mask:0xf bound_ctrl:0
    v_mfma_f32_32x32x16_bf16 v[144:159], v[200:203], v[88:91], v[144:159]
    ds_read_b64 v[232:233], v14 offset:3776
    ds_read_b64 v[234:235], v14 offset:3784
    v_and_b32_dpp v172, v172, v15 row_shr:1 row_mask:0xf bank_mask:0xf bound_ctrl:0
    v_and_b32_dpp v173, v173, v15 row_shr:1 row_mask:0xf bank_mask:0xf bound_ctrl:0
    v_mfma_f32_32x32x16_bf16 v[144:159], v[204:207], v[92:95], v[144:159]
    ds_read_b64 v[236:237], v14 offset:3808
    ds_read_b64 v[238:239], v14 offset:3816
    v_and_b32_dpp v174, v174, v15 row_shr:1 row_mask:0xf bank_mask:0xf bound_ctrl:0
    v_and_b32_dpp v175, v175, v15 row_shr:1 row_mask:0xf bank_mask:0xf bound_ctrl:0
    v_mfma_f32_32x32x16_bf16 v[128:143], v[176:179], v[32:35], v[128:143]
    s_nop 4
    v_mfma_f32_32x32x16_bf16 v[128:143], v[180:183], v[36:39], v[128:143]
    s_nop 4
    v_mfma_f32_32x32x16_bf16 v[128:143], v[184:187], v[40:43], v[128:143]
    v_mov_b32_dpp v144, v144 row_shr:1 row_mask:0xf bank_mask:0xf bound_ctrl:0
    v_mov_b32_dpp v145, v145 row_shr:1 row_mask:0xf bank_mask:0xf bound_ctrl:0
    v_mov_b32_dpp v146, v146 row_shr:1 row_mask:0xf bank_mask:0xf bound_ctrl:0
    v_mfma_f32_32x32x16_bf16 v[128:143], v[188:191], v[44:47], v[128:143]
    v_mov_b32_dpp v147, v147 row_shr:1 row_mask:0xf bank_mask:0xf bound_ctrl:0
    v_mov_b32_dpp v148, v148 row_shr:1 row_mask:0xf bank_mask:0xf bound_ctrl:0
    v_mov_b32_dpp v149, v149 row_shr:1 row_mask:0xf bank_mask:0xf bound_ctrl:0
    v_mfma_f32_32x32x16_bf16 v[128:143], v[192:195], v[48:51], v[128:143]
    v_mov_b32_dpp v150, v150 row_shr:1 row_mask:0xf bank_mask:0xf bound_ctrl:0
    v_mov_b32_dpp v151, v151 row_shr:1 row_mask:0xf bank_mask:0xf bound_ctrl:0
    v_mov_b32_dpp v152, v152 row_shr:1 row_mask:0xf bank_mask:0xf bound_ctrl:0
    v_mfma_f32_32x32x16_bf16 v[128:143], v[196:199], v[52:55], v[128:143]
    v_mov_b32_dpp v153, v153 row_shr:1 row_mask:0xf bank_mask:0xf bound_ctrl:0
    v_mov_b32_dpp v154, v154 row_shr:1 row_mask:0xf bank_mask:0xf bound_ctrl:0
    v_mov_b32_dpp v155, v155 row_shr:1 row_mask:0xf bank_mask:0xf bound_ctrl:0
    v_mfma_f32_32x32x16_bf16 v[128:143], v[200:203], v[56:59], v[128:143]
    v_mov_b32_dpp v156, v156 row_shr:1 row_mask:0xf bank_mask:0xf bound_ctrl:0
    v_mov_b32_dpp v157, v157 row_shr:1 row_mask:0xf bank_mask:0xf bound_ctrl:0
    v_mfma_f32_32x32x16_bf16 v[128:143], v[204:207], v[60:63], v[128:143]
    v_mov_b32_dpp v158, v158 row_shr:1 row_mask:0xf bank_mask:0xf bound_ctrl:0
    v_mov_b32_dpp v159, v159 row_shr:1 row_mask:0xf bank_mask:0xf bound_ctrl:0
    s_waitcnt lgkmcnt(0)
    v_mfma_f32_32x32x16_bf16 v[160:175], v[208:211], v[96:99], v[160:175]
    ds_read_b64 v[176:177], v14 offset:1280
    ds_read_b64 v[178:179], v14 offset:1288
    ds_read_b64 v[180:181], v14 offset:1312
    ds_read_b64 v[182:183], v14 offset:1320
    s_nop 0
    v_mfma_f32_32x32x16_bf16 v[160:175], v[212:215], v[100:103], v[160:175]
    ds_read_b64 v[184:185], v14 offset:1344
    ds_read_b64 v[186:187], v14 offset:1352
    ds_read_b64 v[188:189], v14 offset:1376
    s_nop 1
    v_mfma_f32_32x32x16_bf16 v[160:175], v[216:219], v[104:107], v[160:175]
    ds_read_b64 v[190:191], v14 offset:1384
    ds_read_b64 v[192:193], v14 offset:1408
    ds_read_b64 v[194:195], v14 offset:1416
    v_mov_b32_dpp v128, v128 row_shr:1 row_mask:0xf bank_mask:0xf bound_ctrl:0
    v_mov_b32_dpp v129, v129 row_shr:1 row_mask:0xf bank_mask:0xf bound_ctrl:0
    v_mov_b32_dpp v130, v130 row_shr:1 row_mask:0xf bank_mask:0xf bound_ctrl:0
    v_mfma_f32_32x32x16_bf16 v[160:175], v[220:223], v[108:111], v[160:175]
    ds_read_b64 v[196:197], v14 offset:1440
    ds_read_b64 v[198:199], v14 offset:1448
    ds_read_b64 v[200:201], v14 offset:1472
    v_mov_b32_dpp v131, v131 row_shr:1 row_mask:0xf bank_mask:0xf bound_ctrl:0
    v_mov_b32_dpp v132, v132 row_shr:1 row_mask:0xf bank_mask:0xf bound_ctrl:0
    v_mov_b32_dpp v133, v133 row_shr:1 row_mask:0xf bank_mask:0xf bound_ctrl:0
    v_mfma_f32_32x32x16_bf16 v[160:175], v[224:227], v[112:115], v[160:175]
    ds_read_b64 v[202:203], v14 offset:1480
    ds_read_b64 v[204:205], v14 offset:1504
    ds_read_b64 v[206:207], v14 offset:1512
    v_mov_b32_dpp v134, v134 row_shr:1 row_mask:0xf bank_mask:0xf bound_ctrl:0
    v_mov_b32_dpp v135, v135 row_shr:1 row_mask:0xf bank_mask:0xf bound_ctrl:0
    v_mov_b32_dpp v136, v136 row_shr:1 row_mask:0xf bank_mask:0xf bound_ctrl:0
    v_mfma_f32_32x32x16_bf16 v[160:175], v[228:231], v[116:119], v[160:175]
    v_mov_b32_dpp v137, v137 row_shr:1 row_mask:0xf bank_mask:0xf bound_ctrl:0
    v_mov_b32_dpp v138, v138 row_shr:1 row_mask:0xf bank_mask:0xf bound_ctrl:0
    v_mov_b32_dpp v139, v139 row_shr:1 row_mask:0xf bank_mask:0xf bound_ctrl:0
    v_mfma_f32_32x32x16_bf16 v[160:175], v[232:235], v[120:123], v[160:175]
    v_mov_b32_dpp v140, v140 row_shr:1 row_mask:0xf bank_mask:0xf bound_ctrl:0
    v_mov_b32_dpp v141, v141 row_shr:1 row_mask:0xf bank_mask:0xf bound_ctrl:0
    v_mfma_f32_32x32x16_bf16 v[160:175], v[236:239], v[124:127], v[160:175]
    v_mov_b32_dpp v142, v142 row_shr:1 row_mask:0xf bank_mask:0xf bound_ctrl:0
    v_mov_b32_dpp v143, v143 row_shr:1 row_mask:0xf bank_mask:0xf bound_ctrl:0
    s_waitcnt lgkmcnt(0)
    v_mfma_f32_32x32x16_bf16 v[144:159], v[176:179], v[64:67], v[144:159]
    ds_read_b64 v[208:209], v14 offset:3328
    ds_read_b64 v[210:211], v14 offset:3336
    s_nop 2
    v_mfma_f32_32x32x16_bf16 v[144:159], v[180:183], v[68:71], v[144:159]
    ds_read_b64 v[212:213], v14 offset:3360
    ds_read_b64 v[214:215], v14 offset:3368
    s_nop 2
    v_mfma_f32_32x32x16_bf16 v[144:159], v[184:187], v[72:75], v[144:159]
    ds_read_b64 v[216:217], v14 offset:3392
    ds_read_b64 v[218:219], v14 offset:3400
    v_and_b32_dpp v160, v160, v15 row_shr:1 row_mask:0xf bank_mask:0xf bound_ctrl:0
    v_and_b32_dpp v161, v161, v15 row_shr:1 row_mask:0xf bank_mask:0xf bound_ctrl:0
    v_and_b32_dpp v162, v162, v15 row_shr:1 row_mask:0xf bank_mask:0xf bound_ctrl:0
    v_mfma_f32_32x32x16_bf16 v[144:159], v[188:191], v[76:79], v[144:159]
    ds_read_b64 v[220:221], v14 offset:3424
    ds_read_b64 v[222:223], v14 offset:3432
    v_and_b32_dpp v163, v163, v15 row_shr:1 row_mask:0xf bank_mask:0xf bound_ctrl:0
    v_and_b32_dpp v164, v164, v15 row_shr:1 row_mask:0xf bank_mask:0xf bound_ctrl:0
    v_and_b32_dpp v165, v165, v15 row_shr:1 row_mask:0xf bank_mask:0xf bound_ctrl:0
    v_mfma_f32_32x32x16_bf16 v[144:159], v[192:195], v[80:83], v[144:159]
    ds_read_b64 v[224:225], v14 offset:3456
    ds_read_b64 v[226:227], v14 offset:3464
    v_and_b32_dpp v166, v166, v15 row_shr:1 row_mask:0xf bank_mask:0xf bound_ctrl:0
    v_and_b32_dpp v167, v167, v15 row_shr:1 row_mask:0xf bank_mask:0xf bound_ctrl:0
    v_and_b32_dpp v168, v168, v15 row_shr:1 row_mask:0xf bank_mask:0xf bound_ctrl:0
    v_mfma_f32_32x32x16_bf16 v[144:159], v[196:199], v[84:87], v[144:159]
    ds_read_b64 v[228:229], v14 offset:3488
    ds_read_b64 v[230:231], v14 offset:3496
    v_and_b32_dpp v169, v169, v15 row_shr:1 row_mask:0xf bank_mask:0xf bound_ctrl:0
    v_and_b32_dpp v170, v170, v15 row_shr:1 row_mask:0xf bank_mask:0xf bound_ctrl:0
    v_and_b32_dpp v171, v171, v15 row_shr:1 row_mask:0xf bank_mask:0xf bound_ctrl:0
    v_mfma_f32_32x32x16_bf16 v[144:159], v[200:203], v[88:91], v[144:159]
    ds_read_b64 v[232:233], v14 offset:3520
    ds_read_b64 v[234:235], v14 offset:3528
    v_and_b32_dpp v172, v172, v15 row_shr:1 row_mask:0xf bank_mask:0xf bound_ctrl:0
    v_and_b32_dpp v173, v173, v15 row_shr:1 row_mask:0xf bank_mask:0xf bound_ctrl:0
    v_mfma_f32_32x32x16_bf16 v[144:159], v[204:207], v[92:95], v[144:159]
    ds_read_b64 v[236:237], v14 offset:3552
    ds_read_b64 v[238:239], v14 offset:3560
    v_and_b32_dpp v174, v174, v15 row_shr:1 row_mask:0xf bank_mask:0xf bound_ctrl:0
    v_and_b32_dpp v175, v175, v15 row_shr:1 row_mask:0xf bank_mask:0xf bound_ctrl:0
    v_mfma_f32_32x32x16_bf16 v[128:143], v[176:179], v[32:35], v[128:143]
    v_and_b32 v19, 31, v1
    s_nop 3
    v_mfma_f32_32x32x16_bf16 v[128:143], v[180:183], v[36:39], v[128:143]
    s_mov_b32 s50, 400384
    s_nop 3
    v_mfma_f32_32x32x16_bf16 v[128:143], v[184:187], v[40:43], v[128:143]
    v_mul_lo_u32 v19, v19, s50
    v_mov_b32_dpp v144, v144 row_shr:1 row_mask:0xf bank_mask:0xf bound_ctrl:0
    v_mov_b32_dpp v145, v145 row_shr:1 row_mask:0xf bank_mask:0xf bound_ctrl:0
    v_mov_b32_dpp v146, v146 row_shr:1 row_mask:0xf bank_mask:0xf bound_ctrl:0
    v_mfma_f32_32x32x16_bf16 v[128:143], v[188:191], v[44:47], v[128:143]
    s_mov_b32 s50, 9060352
    v_mov_b32_dpp v147, v147 row_shr:1 row_mask:0xf bank_mask:0xf bound_ctrl:0
    v_mov_b32_dpp v148, v148 row_shr:1 row_mask:0xf bank_mask:0xf bound_ctrl:0
    v_mov_b32_dpp v149, v149 row_shr:1 row_mask:0xf bank_mask:0xf bound_ctrl:0
    v_mfma_f32_32x32x16_bf16 v[128:143], v[192:195], v[48:51], v[128:143]
    buffer_load_dword v28, v19, s[28:31], s50 offen
    v_mov_b32_dpp v150, v150 row_shr:1 row_mask:0xf bank_mask:0xf bound_ctrl:0
    v_mov_b32_dpp v151, v151 row_shr:1 row_mask:0xf bank_mask:0xf bound_ctrl:0
    v_mov_b32_dpp v152, v152 row_shr:1 row_mask:0xf bank_mask:0xf bound_ctrl:0
    v_mfma_f32_32x32x16_bf16 v[128:143], v[196:199], v[52:55], v[128:143]
    v_mov_b32_dpp v153, v153 row_shr:1 row_mask:0xf bank_mask:0xf bound_ctrl:0
    v_mov_b32_dpp v154, v154 row_shr:1 row_mask:0xf bank_mask:0xf bound_ctrl:0
    v_mov_b32_dpp v155, v155 row_shr:1 row_mask:0xf bank_mask:0xf bound_ctrl:0
    v_mfma_f32_32x32x16_bf16 v[128:143], v[200:203], v[56:59], v[128:143]
    v_mov_b32_dpp v156, v156 row_shr:1 row_mask:0xf bank_mask:0xf bound_ctrl:0
    v_mov_b32_dpp v157, v157 row_shr:1 row_mask:0xf bank_mask:0xf bound_ctrl:0
    v_mfma_f32_32x32x16_bf16 v[128:143], v[204:207], v[60:63], v[128:143]
    v_mov_b32_dpp v158, v158 row_shr:1 row_mask:0xf bank_mask:0xf bound_ctrl:0
    v_mov_b32_dpp v159, v159 row_shr:1 row_mask:0xf bank_mask:0xf bound_ctrl:0
    s_waitcnt lgkmcnt(0)
    v_mfma_f32_32x32x16_bf16 v[160:175], v[208:211], v[96:99], v[160:175]
    ds_read_b64 v[176:177], v14 offset:1024
    ds_read_b64 v[178:179], v14 offset:1032
    ds_read_b64 v[180:181], v14 offset:1056
    ds_read_b64 v[182:183], v14 offset:1064
    s_nop 0
    v_mfma_f32_32x32x16_bf16 v[160:175], v[212:215], v[100:103], v[160:175]
    ds_read_b64 v[184:185], v14 offset:1088
    ds_read_b64 v[186:187], v14 offset:1096
    ds_read_b64 v[188:189], v14 offset:1120
    s_nop 1
    v_mfma_f32_32x32x16_bf16 v[160:175], v[216:219], v[104:107], v[160:175]
    ds_read_b64 v[190:191], v14 offset:1128
    ds_read_b64 v[192:193], v14 offset:1152
    ds_read_b64 v[194:195], v14 offset:1160
    v_mov_b32_dpp v128, v128 row_shr:1 row_mask:0xf bank_mask:0xf bound_ctrl:0
    v_mov_b32_dpp v129, v129 row_shr:1 row_mask:0xf bank_mask:0xf bound_ctrl:0
    v_mov_b32_dpp v130, v130 row_shr:1 row_mask:0xf bank_mask:0xf bound_ctrl:0
    v_mfma_f32_32x32x16_bf16 v[160:175], v[220:223], v[108:111], v[160:175]
    ds_read_b64 v[196:197], v14 offset:1184
    ds_read_b64 v[198:199], v14 offset:1192
    ds_read_b64 v[200:201], v14 offset:1216
    v_mov_b32_dpp v131, v131 row_shr:1 row_mask:0xf bank_mask:0xf bound_ctrl:0
    v_mov_b32_dpp v132, v132 row_shr:1 row_mask:0xf bank_mask:0xf bound_ctrl:0
    v_mov_b32_dpp v133, v133 row_shr:1 row_mask:0xf bank_mask:0xf bound_ctrl:0
    v_mfma_f32_32x32x16_bf16 v[160:175], v[224:227], v[112:115], v[160:175]
    ds_read_b64 v[202:203], v14 offset:1224
    ds_read_b64 v[204:205], v14 offset:1248
    ds_read_b64 v[206:207], v14 offset:1256
    v_mov_b32_dpp v134, v134 row_shr:1 row_mask:0xf bank_mask:0xf bound_ctrl:0
    v_mov_b32_dpp v135, v135 row_shr:1 row_mask:0xf bank_mask:0xf bound_ctrl:0
    v_mov_b32_dpp v136, v136 row_shr:1 row_mask:0xf bank_mask:0xf bound_ctrl:0
    v_mfma_f32_32x32x16_bf16 v[160:175], v[228:231], v[116:119], v[160:175]
    v_mov_b32_dpp v137, v137 row_shr:1 row_mask:0xf bank_mask:0xf bound_ctrl:0
    v_mov_b32_dpp v138, v138 row_shr:1 row_mask:0xf bank_mask:0xf bound_ctrl:0
    v_mov_b32_dpp v139, v139 row_shr:1 row_mask:0xf bank_mask:0xf bound_ctrl:0
    v_mfma_f32_32x32x16_bf16 v[160:175], v[232:235], v[120:123], v[160:175]
    v_mov_b32_dpp v140, v140 row_shr:1 row_mask:0xf bank_mask:0xf bound_ctrl:0
    v_mov_b32_dpp v141, v141 row_shr:1 row_mask:0xf bank_mask:0xf bound_ctrl:0
    v_mfma_f32_32x32x16_bf16 v[160:175], v[236:239], v[124:127], v[160:175]
    v_mov_b32_dpp v142, v142 row_shr:1 row_mask:0xf bank_mask:0xf bound_ctrl:0
    v_mov_b32_dpp v143, v143 row_shr:1 row_mask:0xf bank_mask:0xf bound_ctrl:0
    s_waitcnt lgkmcnt(0)
    v_mfma_f32_32x32x16_bf16 v[144:159], v[176:179], v[64:67], v[144:159]
    ds_read_b64 v[208:209], v14 offset:3072
    ds_read_b64 v[210:211], v14 offset:3080
    s_nop 2
    v_mfma_f32_32x32x16_bf16 v[144:159], v[180:183], v[68:71], v[144:159]
    ds_read_b64 v[212:213], v14 offset:3104
    ds_read_b64 v[214:215], v14 offset:3112
    s_nop 2
    v_mfma_f32_32x32x16_bf16 v[144:159], v[184:187], v[72:75], v[144:159]
    ds_read_b64 v[216:217], v14 offset:3136
    ds_read_b64 v[218:219], v14 offset:3144
    v_and_b32_dpp v160, v160, v15 row_shr:1 row_mask:0xf bank_mask:0xf bound_ctrl:0
    v_and_b32_dpp v161, v161, v15 row_shr:1 row_mask:0xf bank_mask:0xf bound_ctrl:0
    v_and_b32_dpp v162, v162, v15 row_shr:1 row_mask:0xf bank_mask:0xf bound_ctrl:0
    v_mfma_f32_32x32x16_bf16 v[144:159], v[188:191], v[76:79], v[144:159]
    ds_read_b64 v[220:221], v14 offset:3168
    ds_read_b64 v[222:223], v14 offset:3176
    v_and_b32_dpp v163, v163, v15 row_shr:1 row_mask:0xf bank_mask:0xf bound_ctrl:0
    v_and_b32_dpp v164, v164, v15 row_shr:1 row_mask:0xf bank_mask:0xf bound_ctrl:0
    v_and_b32_dpp v165, v165, v15 row_shr:1 row_mask:0xf bank_mask:0xf bound_ctrl:0
    v_mfma_f32_32x32x16_bf16 v[144:159], v[192:195], v[80:83], v[144:159]
    ds_read_b64 v[224:225], v14 offset:3200
    ds_read_b64 v[226:227], v14 offset:3208
    v_and_b32_dpp v166, v166, v15 row_shr:1 row_mask:0xf bank_mask:0xf bound_ctrl:0
    v_and_b32_dpp v167, v167, v15 row_shr:1 row_mask:0xf bank_mask:0xf bound_ctrl:0
    v_and_b32_dpp v168, v168, v15 row_shr:1 row_mask:0xf bank_mask:0xf bound_ctrl:0
    v_mfma_f32_32x32x16_bf16 v[144:159], v[196:199], v[84:87], v[144:159]
    ds_read_b64 v[228:229], v14 offset:3232
    ds_read_b64 v[230:231], v14 offset:3240
    v_and_b32_dpp v169, v169, v15 row_shr:1 row_mask:0xf bank_mask:0xf bound_ctrl:0
    v_and_b32_dpp v170, v170, v15 row_shr:1 row_mask:0xf bank_mask:0xf bound_ctrl:0
    v_and_b32_dpp v171, v171, v15 row_shr:1 row_mask:0xf bank_mask:0xf bound_ctrl:0
    v_mfma_f32_32x32x16_bf16 v[144:159], v[200:203], v[88:91], v[144:159]
    ds_read_b64 v[232:233], v14 offset:3264
    ds_read_b64 v[234:235], v14 offset:3272
    v_and_b32_dpp v172, v172, v15 row_shr:1 row_mask:0xf bank_mask:0xf bound_ctrl:0
    v_and_b32_dpp v173, v173, v15 row_shr:1 row_mask:0xf bank_mask:0xf bound_ctrl:0
    v_mfma_f32_32x32x16_bf16 v[144:159], v[204:207], v[92:95], v[144:159]
    ds_read_b64 v[236:237], v14 offset:3296
    ds_read_b64 v[238:239], v14 offset:3304
    v_and_b32_dpp v174, v174, v15 row_shr:1 row_mask:0xf bank_mask:0xf bound_ctrl:0
    v_and_b32_dpp v175, v175, v15 row_shr:1 row_mask:0xf bank_mask:0xf bound_ctrl:0
    v_mfma_f32_32x32x16_bf16 v[128:143], v[176:179], v[32:35], v[128:143]
    s_nop 4
    v_mfma_f32_32x32x16_bf16 v[128:143], v[180:183], v[36:39], v[128:143]
    s_nop 4
    v_mfma_f32_32x32x16_bf16 v[128:143], v[184:187], v[40:43], v[128:143]
    v_mov_b32_dpp v144, v144 row_shr:1 row_mask:0xf bank_mask:0xf bound_ctrl:0
    v_mov_b32_dpp v145, v145 row_shr:1 row_mask:0xf bank_mask:0xf bound_ctrl:0
    v_mov_b32_dpp v146, v146 row_shr:1 row_mask:0xf bank_mask:0xf bound_ctrl:0
    v_mfma_f32_32x32x16_bf16 v[128:143], v[188:191], v[44:47], v[128:143]
    v_mov_b32_dpp v147, v147 row_shr:1 row_mask:0xf bank_mask:0xf bound_ctrl:0
    v_mov_b32_dpp v148, v148 row_shr:1 row_mask:0xf bank_mask:0xf bound_ctrl:0
    v_mov_b32_dpp v149, v149 row_shr:1 row_mask:0xf bank_mask:0xf bound_ctrl:0
    v_mfma_f32_32x32x16_bf16 v[128:143], v[192:195], v[48:51], v[128:143]
    v_mov_b32_dpp v150, v150 row_shr:1 row_mask:0xf bank_mask:0xf bound_ctrl:0
    v_mov_b32_dpp v151, v151 row_shr:1 row_mask:0xf bank_mask:0xf bound_ctrl:0
    v_mov_b32_dpp v152, v152 row_shr:1 row_mask:0xf bank_mask:0xf bound_ctrl:0
    v_mfma_f32_32x32x16_bf16 v[128:143], v[196:199], v[52:55], v[128:143]
    v_mov_b32_dpp v153, v153 row_shr:1 row_mask:0xf bank_mask:0xf bound_ctrl:0
    v_mov_b32_dpp v154, v154 row_shr:1 row_mask:0xf bank_mask:0xf bound_ctrl:0
    v_mov_b32_dpp v155, v155 row_shr:1 row_mask:0xf bank_mask:0xf bound_ctrl:0
    v_mfma_f32_32x32x16_bf16 v[128:143], v[200:203], v[56:59], v[128:143]
    v_mov_b32_dpp v156, v156 row_shr:1 row_mask:0xf bank_mask:0xf bound_ctrl:0
    v_mov_b32_dpp v157, v157 row_shr:1 row_mask:0xf bank_mask:0xf bound_ctrl:0
    v_mfma_f32_32x32x16_bf16 v[128:143], v[204:207], v[60:63], v[128:143]
    v_mov_b32_dpp v158, v158 row_shr:1 row_mask:0xf bank_mask:0xf bound_ctrl:0
    v_mov_b32_dpp v159, v159 row_shr:1 row_mask:0xf bank_mask:0xf bound_ctrl:0
    s_waitcnt lgkmcnt(0)
    v_mfma_f32_32x32x16_bf16 v[160:175], v[208:211], v[96:99], v[160:175]
    ds_read_b64 v[176:177], v14 offset:768
    ds_read_b64 v[178:179], v14 offset:776
    ds_read_b64 v[180:181], v14 offset:800
    ds_read_b64 v[182:183], v14 offset:808
    s_nop 0
    v_mfma_f32_32x32x16_bf16 v[160:175], v[212:215], v[100:103], v[160:175]
    ds_read_b64 v[184:185], v14 offset:832
    ds_read_b64 v[186:187], v14 offset:840
    ds_read_b64 v[188:189], v14 offset:864
    s_nop 1
    v_mfma_f32_32x32x16_bf16 v[160:175], v[216:219], v[104:107], v[160:175]
    ds_read_b64 v[190:191], v14 offset:872
    ds_read_b64 v[192:193], v14 offset:896
    ds_read_b64 v[194:195], v14 offset:904
    v_mov_b32_dpp v128, v128 row_shr:1 row_mask:0xf bank_mask:0xf bound_ctrl:0
    v_mov_b32_dpp v129, v129 row_shr:1 row_mask:0xf bank_mask:0xf bound_ctrl:0
    v_mov_b32_dpp v130, v130 row_shr:1 row_mask:0xf bank_mask:0xf bound_ctrl:0
    v_mfma_f32_32x32x16_bf16 v[160:175], v[220:223], v[108:111], v[160:175]
    ds_read_b64 v[196:197], v14 offset:928
    ds_read_b64 v[198:199], v14 offset:936
    ds_read_b64 v[200:201], v14 offset:960
    v_mov_b32_dpp v131, v131 row_shr:1 row_mask:0xf bank_mask:0xf bound_ctrl:0
    v_mov_b32_dpp v132, v132 row_shr:1 row_mask:0xf bank_mask:0xf bound_ctrl:0
    v_mov_b32_dpp v133, v133 row_shr:1 row_mask:0xf bank_mask:0xf bound_ctrl:0
    v_mfma_f32_32x32x16_bf16 v[160:175], v[224:227], v[112:115], v[160:175]
    ds_read_b64 v[202:203], v14 offset:968
    ds_read_b64 v[204:205], v14 offset:992
    ds_read_b64 v[206:207], v14 offset:1000
    v_mov_b32_dpp v134, v134 row_shr:1 row_mask:0xf bank_mask:0xf bound_ctrl:0
    v_mov_b32_dpp v135, v135 row_shr:1 row_mask:0xf bank_mask:0xf bound_ctrl:0
    v_mov_b32_dpp v136, v136 row_shr:1 row_mask:0xf bank_mask:0xf bound_ctrl:0
    v_mfma_f32_32x32x16_bf16 v[160:175], v[228:231], v[116:119], v[160:175]
    v_mov_b32_dpp v137, v137 row_shr:1 row_mask:0xf bank_mask:0xf bound_ctrl:0
    v_mov_b32_dpp v138, v138 row_shr:1 row_mask:0xf bank_mask:0xf bound_ctrl:0
    v_mov_b32_dpp v139, v139 row_shr:1 row_mask:0xf bank_mask:0xf bound_ctrl:0
    v_mfma_f32_32x32x16_bf16 v[160:175], v[232:235], v[120:123], v[160:175]
    v_mov_b32_dpp v140, v140 row_shr:1 row_mask:0xf bank_mask:0xf bound_ctrl:0
    v_mov_b32_dpp v141, v141 row_shr:1 row_mask:0xf bank_mask:0xf bound_ctrl:0
    v_mfma_f32_32x32x16_bf16 v[160:175], v[236:239], v[124:127], v[160:175]
    v_mov_b32_dpp v142, v142 row_shr:1 row_mask:0xf bank_mask:0xf bound_ctrl:0
    v_mov_b32_dpp v143, v143 row_shr:1 row_mask:0xf bank_mask:0xf bound_ctrl:0
    s_waitcnt lgkmcnt(0)
    v_mfma_f32_32x32x16_bf16 v[144:159], v[176:179], v[64:67], v[144:159]
    ds_read_b64 v[208:209], v14 offset:2816
    ds_read_b64 v[210:211], v14 offset:2824
    s_nop 2
    v_mfma_f32_32x32x16_bf16 v[144:159], v[180:183], v[68:71], v[144:159]
    ds_read_b64 v[212:213], v14 offset:2848
    ds_read_b64 v[214:215], v14 offset:2856
    s_nop 2
    v_mfma_f32_32x32x16_bf16 v[144:159], v[184:187], v[72:75], v[144:159]
    ds_read_b64 v[216:217], v14 offset:2880
    ds_read_b64 v[218:219], v14 offset:2888
    v_and_b32_dpp v160, v160, v15 row_shr:1 row_mask:0xf bank_mask:0xf bound_ctrl:0
    v_and_b32_dpp v161, v161, v15 row_shr:1 row_mask:0xf bank_mask:0xf bound_ctrl:0
    v_and_b32_dpp v162, v162, v15 row_shr:1 row_mask:0xf bank_mask:0xf bound_ctrl:0
    v_mfma_f32_32x32x16_bf16 v[144:159], v[188:191], v[76:79], v[144:159]
    ds_read_b64 v[220:221], v14 offset:2912
    ds_read_b64 v[222:223], v14 offset:2920
    v_and_b32_dpp v163, v163, v15 row_shr:1 row_mask:0xf bank_mask:0xf bound_ctrl:0
    v_and_b32_dpp v164, v164, v15 row_shr:1 row_mask:0xf bank_mask:0xf bound_ctrl:0
    v_and_b32_dpp v165, v165, v15 row_shr:1 row_mask:0xf bank_mask:0xf bound_ctrl:0
    v_mfma_f32_32x32x16_bf16 v[144:159], v[192:195], v[80:83], v[144:159]
    ds_read_b64 v[224:225], v14 offset:2944
    ds_read_b64 v[226:227], v14 offset:2952
    v_and_b32_dpp v166, v166, v15 row_shr:1 row_mask:0xf bank_mask:0xf bound_ctrl:0
    v_and_b32_dpp v167, v167, v15 row_shr:1 row_mask:0xf bank_mask:0xf bound_ctrl:0
    v_and_b32_dpp v168, v168, v15 row_shr:1 row_mask:0xf bank_mask:0xf bound_ctrl:0
    v_mfma_f32_32x32x16_bf16 v[144:159], v[196:199], v[84:87], v[144:159]
    ds_read_b64 v[228:229], v14 offset:2976
    ds_read_b64 v[230:231], v14 offset:2984
    v_and_b32_dpp v169, v169, v15 row_shr:1 row_mask:0xf bank_mask:0xf bound_ctrl:0
    v_and_b32_dpp v170, v170, v15 row_shr:1 row_mask:0xf bank_mask:0xf bound_ctrl:0
    v_and_b32_dpp v171, v171, v15 row_shr:1 row_mask:0xf bank_mask:0xf bound_ctrl:0
    v_mfma_f32_32x32x16_bf16 v[144:159], v[200:203], v[88:91], v[144:159]
    ds_read_b64 v[232:233], v14 offset:3008
    ds_read_b64 v[234:235], v14 offset:3016
    v_and_b32_dpp v172, v172, v15 row_shr:1 row_mask:0xf bank_mask:0xf bound_ctrl:0
    v_and_b32_dpp v173, v173, v15 row_shr:1 row_mask:0xf bank_mask:0xf bound_ctrl:0
    v_mfma_f32_32x32x16_bf16 v[144:159], v[204:207], v[92:95], v[144:159]
    ds_read_b64 v[236:237], v14 offset:3040
    ds_read_b64 v[238:239], v14 offset:3048
    v_and_b32_dpp v174, v174, v15 row_shr:1 row_mask:0xf bank_mask:0xf bound_ctrl:0
    v_and_b32_dpp v175, v175, v15 row_shr:1 row_mask:0xf bank_mask:0xf bound_ctrl:0
    v_mfma_f32_32x32x16_bf16 v[128:143], v[176:179], v[32:35], v[128:143]
    s_nop 4
    v_mfma_f32_32x32x16_bf16 v[128:143], v[180:183], v[36:39], v[128:143]
    s_nop 4
    v_mfma_f32_32x32x16_bf16 v[128:143], v[184:187], v[40:43], v[128:143]
    v_mov_b32_dpp v144, v144 row_shr:1 row_mask:0xf bank_mask:0xf bound_ctrl:0
    v_mov_b32_dpp v145, v145 row_shr:1 row_mask:0xf bank_mask:0xf bound_ctrl:0
    v_mov_b32_dpp v146, v146 row_shr:1 row_mask:0xf bank_mask:0xf bound_ctrl:0
    v_mfma_f32_32x32x16_bf16 v[128:143], v[188:191], v[44:47], v[128:143]
    v_mov_b32_dpp v147, v147 row_shr:1 row_mask:0xf bank_mask:0xf bound_ctrl:0
    v_mov_b32_dpp v148, v148 row_shr:1 row_mask:0xf bank_mask:0xf bound_ctrl:0
    v_mov_b32_dpp v149, v149 row_shr:1 row_mask:0xf bank_mask:0xf bound_ctrl:0
    v_mfma_f32_32x32x16_bf16 v[128:143], v[192:195], v[48:51], v[128:143]
    v_mov_b32_dpp v150, v150 row_shr:1 row_mask:0xf bank_mask:0xf bound_ctrl:0
    v_mov_b32_dpp v151, v151 row_shr:1 row_mask:0xf bank_mask:0xf bound_ctrl:0
    v_mov_b32_dpp v152, v152 row_shr:1 row_mask:0xf bank_mask:0xf bound_ctrl:0
    v_mfma_f32_32x32x16_bf16 v[128:143], v[196:199], v[52:55], v[128:143]
    v_mov_b32_dpp v153, v153 row_shr:1 row_mask:0xf bank_mask:0xf bound_ctrl:0
    v_mov_b32_dpp v154, v154 row_shr:1 row_mask:0xf bank_mask:0xf bound_ctrl:0
    v_mov_b32_dpp v155, v155 row_shr:1 row_mask:0xf bank_mask:0xf bound_ctrl:0
    v_mfma_f32_32x32x16_bf16 v[128:143], v[200:203], v[56:59], v[128:143]
    v_mov_b32_dpp v156, v156 row_shr:1 row_mask:0xf bank_mask:0xf bound_ctrl:0
    v_mov_b32_dpp v157, v157 row_shr:1 row_mask:0xf bank_mask:0xf bound_ctrl:0
    v_mfma_f32_32x32x16_bf16 v[128:143], v[204:207], v[60:63], v[128:143]
    v_mov_b32_dpp v158, v158 row_shr:1 row_mask:0xf bank_mask:0xf bound_ctrl:0
    v_mov_b32_dpp v159, v159 row_shr:1 row_mask:0xf bank_mask:0xf bound_ctrl:0
    s_waitcnt lgkmcnt(0)
    v_mfma_f32_32x32x16_bf16 v[160:175], v[208:211], v[96:99], v[160:175]
    ds_read_b64 v[176:177], v14 offset:512
    ds_read_b64 v[178:179], v14 offset:520
    ds_read_b64 v[180:181], v14 offset:544
    ds_read_b64 v[182:183], v14 offset:552
    s_nop 0
    v_mfma_f32_32x32x16_bf16 v[160:175], v[212:215], v[100:103], v[160:175]
    ds_read_b64 v[184:185], v14 offset:576
    ds_read_b64 v[186:187], v14 offset:584
    ds_read_b64 v[188:189], v14 offset:608
    s_nop 1
    v_mfma_f32_32x32x16_bf16 v[160:175], v[216:219], v[104:107], v[160:175]
    ds_read_b64 v[190:191], v14 offset:616
    ds_read_b64 v[192:193], v14 offset:640
    ds_read_b64 v[194:195], v14 offset:648
    v_mov_b32_dpp v128, v128 row_shr:1 row_mask:0xf bank_mask:0xf bound_ctrl:0
    v_mov_b32_dpp v129, v129 row_shr:1 row_mask:0xf bank_mask:0xf bound_ctrl:0
    v_mov_b32_dpp v130, v130 row_shr:1 row_mask:0xf bank_mask:0xf bound_ctrl:0
    v_mfma_f32_32x32x16_bf16 v[160:175], v[220:223], v[108:111], v[160:175]
    ds_read_b64 v[196:197], v14 offset:672
    ds_read_b64 v[198:199], v14 offset:680
    ds_read_b64 v[200:201], v14 offset:704
    v_mov_b32_dpp v131, v131 row_shr:1 row_mask:0xf bank_mask:0xf bound_ctrl:0
    v_mov_b32_dpp v132, v132 row_shr:1 row_mask:0xf bank_mask:0xf bound_ctrl:0
    v_mov_b32_dpp v133, v133 row_shr:1 row_mask:0xf bank_mask:0xf bound_ctrl:0
    v_mfma_f32_32x32x16_bf16 v[160:175], v[224:227], v[112:115], v[160:175]
    ds_read_b64 v[202:203], v14 offset:712
    ds_read_b64 v[204:205], v14 offset:736
    ds_read_b64 v[206:207], v14 offset:744
    v_mov_b32_dpp v134, v134 row_shr:1 row_mask:0xf bank_mask:0xf bound_ctrl:0
    v_mov_b32_dpp v135, v135 row_shr:1 row_mask:0xf bank_mask:0xf bound_ctrl:0
    v_mov_b32_dpp v136, v136 row_shr:1 row_mask:0xf bank_mask:0xf bound_ctrl:0
    v_mfma_f32_32x32x16_bf16 v[160:175], v[228:231], v[116:119], v[160:175]
    v_mov_b32_dpp v137, v137 row_shr:1 row_mask:0xf bank_mask:0xf bound_ctrl:0
    v_mov_b32_dpp v138, v138 row_shr:1 row_mask:0xf bank_mask:0xf bound_ctrl:0
    v_mov_b32_dpp v139, v139 row_shr:1 row_mask:0xf bank_mask:0xf bound_ctrl:0
    v_mfma_f32_32x32x16_bf16 v[160:175], v[232:235], v[120:123], v[160:175]
    v_mov_b32_dpp v140, v140 row_shr:1 row_mask:0xf bank_mask:0xf bound_ctrl:0
    v_mov_b32_dpp v141, v141 row_shr:1 row_mask:0xf bank_mask:0xf bound_ctrl:0
    v_mfma_f32_32x32x16_bf16 v[160:175], v[236:239], v[124:127], v[160:175]
    v_mov_b32_dpp v142, v142 row_shr:1 row_mask:0xf bank_mask:0xf bound_ctrl:0
    v_mov_b32_dpp v143, v143 row_shr:1 row_mask:0xf bank_mask:0xf bound_ctrl:0
    s_waitcnt lgkmcnt(0)
    v_mfma_f32_32x32x16_bf16 v[144:159], v[176:179], v[64:67], v[144:159]
    ds_read_b64 v[208:209], v14 offset:2560
    ds_read_b64 v[210:211], v14 offset:2568
    s_nop 2
    v_mfma_f32_32x32x16_bf16 v[144:159], v[180:183], v[68:71], v[144:159]
    ds_read_b64 v[212:213], v14 offset:2592
    ds_read_b64 v[214:215], v14 offset:2600
    s_nop 2
    v_mfma_f32_32x32x16_bf16 v[144:159], v[184:187], v[72:75], v[144:159]
    ds_read_b64 v[216:217], v14 offset:2624
    ds_read_b64 v[218:219], v14 offset:2632
    v_and_b32_dpp v160, v160, v15 row_shr:1 row_mask:0xf bank_mask:0xf bound_ctrl:0
    v_and_b32_dpp v161, v161, v15 row_shr:1 row_mask:0xf bank_mask:0xf bound_ctrl:0
    v_and_b32_dpp v162, v162, v15 row_shr:1 row_mask:0xf bank_mask:0xf bound_ctrl:0
    v_mfma_f32_32x32x16_bf16 v[144:159], v[188:191], v[76:79], v[144:159]
    ds_read_b64 v[220:221], v14 offset:2656
    ds_read_b64 v[222:223], v14 offset:2664
    v_and_b32_dpp v163, v163, v15 row_shr:1 row_mask:0xf bank_mask:0xf bound_ctrl:0
    v_and_b32_dpp v164, v164, v15 row_shr:1 row_mask:0xf bank_mask:0xf bound_ctrl:0
    v_and_b32_dpp v165, v165, v15 row_shr:1 row_mask:0xf bank_mask:0xf bound_ctrl:0
    v_mfma_f32_32x32x16_bf16 v[144:159], v[192:195], v[80:83], v[144:159]
    ds_read_b64 v[224:225], v14 offset:2688
    ds_read_b64 v[226:227], v14 offset:2696
    v_and_b32_dpp v166, v166, v15 row_shr:1 row_mask:0xf bank_mask:0xf bound_ctrl:0
    v_and_b32_dpp v167, v167, v15 row_shr:1 row_mask:0xf bank_mask:0xf bound_ctrl:0
    v_and_b32_dpp v168, v168, v15 row_shr:1 row_mask:0xf bank_mask:0xf bound_ctrl:0
    v_mfma_f32_32x32x16_bf16 v[144:159], v[196:199], v[84:87], v[144:159]
    ds_read_b64 v[228:229], v14 offset:2720
    ds_read_b64 v[230:231], v14 offset:2728
    v_and_b32_dpp v169, v169, v15 row_shr:1 row_mask:0xf bank_mask:0xf bound_ctrl:0
    v_and_b32_dpp v170, v170, v15 row_shr:1 row_mask:0xf bank_mask:0xf bound_ctrl:0
    v_and_b32_dpp v171, v171, v15 row_shr:1 row_mask:0xf bank_mask:0xf bound_ctrl:0
    v_mfma_f32_32x32x16_bf16 v[144:159], v[200:203], v[88:91], v[144:159]
    ds_read_b64 v[232:233], v14 offset:2752
    ds_read_b64 v[234:235], v14 offset:2760
    v_and_b32_dpp v172, v172, v15 row_shr:1 row_mask:0xf bank_mask:0xf bound_ctrl:0
    v_and_b32_dpp v173, v173, v15 row_shr:1 row_mask:0xf bank_mask:0xf bound_ctrl:0
    v_mfma_f32_32x32x16_bf16 v[144:159], v[204:207], v[92:95], v[144:159]
    ds_read_b64 v[236:237], v14 offset:2784
    ds_read_b64 v[238:239], v14 offset:2792
    v_and_b32_dpp v174, v174, v15 row_shr:1 row_mask:0xf bank_mask:0xf bound_ctrl:0
    v_and_b32_dpp v175, v175, v15 row_shr:1 row_mask:0xf bank_mask:0xf bound_ctrl:0
    v_mfma_f32_32x32x16_bf16 v[128:143], v[176:179], v[32:35], v[128:143]
    s_nop 4
    v_mfma_f32_32x32x16_bf16 v[128:143], v[180:183], v[36:39], v[128:143]
    s_nop 4
    v_mfma_f32_32x32x16_bf16 v[128:143], v[184:187], v[40:43], v[128:143]
    v_mov_b32_dpp v144, v144 row_shr:1 row_mask:0xf bank_mask:0xf bound_ctrl:0
    v_mov_b32_dpp v145, v145 row_shr:1 row_mask:0xf bank_mask:0xf bound_ctrl:0
    v_mov_b32_dpp v146, v146 row_shr:1 row_mask:0xf bank_mask:0xf bound_ctrl:0
    v_mfma_f32_32x32x16_bf16 v[128:143], v[188:191], v[44:47], v[128:143]
    v_mov_b32_dpp v147, v147 row_shr:1 row_mask:0xf bank_mask:0xf bound_ctrl:0
    v_mov_b32_dpp v148, v148 row_shr:1 row_mask:0xf bank_mask:0xf bound_ctrl:0
    v_mov_b32_dpp v149, v149 row_shr:1 row_mask:0xf bank_mask:0xf bound_ctrl:0
    v_mfma_f32_32x32x16_bf16 v[128:143], v[192:195], v[48:51], v[128:143]
    v_mov_b32_dpp v150, v150 row_shr:1 row_mask:0xf bank_mask:0xf bound_ctrl:0
    v_mov_b32_dpp v151, v151 row_shr:1 row_mask:0xf bank_mask:0xf bound_ctrl:0
    v_mov_b32_dpp v152, v152 row_shr:1 row_mask:0xf bank_mask:0xf bound_ctrl:0
    v_mfma_f32_32x32x16_bf16 v[128:143], v[196:199], v[52:55], v[128:143]
    v_mov_b32_dpp v153, v153 row_shr:1 row_mask:0xf bank_mask:0xf bound_ctrl:0
    v_mov_b32_dpp v154, v154 row_shr:1 row_mask:0xf bank_mask:0xf bound_ctrl:0
    v_mov_b32_dpp v155, v155 row_shr:1 row_mask:0xf bank_mask:0xf bound_ctrl:0
    v_mfma_f32_32x32x16_bf16 v[128:143], v[200:203], v[56:59], v[128:143]
    v_mov_b32_dpp v156, v156 row_shr:1 row_mask:0xf bank_mask:0xf bound_ctrl:0
    v_mov_b32_dpp v157, v157 row_shr:1 row_mask:0xf bank_mask:0xf bound_ctrl:0
    v_mfma_f32_32x32x16_bf16 v[128:143], v[204:207], v[60:63], v[128:143]
    v_mov_b32_dpp v158, v158 row_shr:1 row_mask:0xf bank_mask:0xf bound_ctrl:0
    v_mov_b32_dpp v159, v159 row_shr:1 row_mask:0xf bank_mask:0xf bound_ctrl:0
    s_waitcnt lgkmcnt(0)
    v_mfma_f32_32x32x16_bf16 v[160:175], v[208:211], v[96:99], v[160:175]
    ds_read_b64 v[176:177], v14 offset:256
    ds_read_b64 v[178:179], v14 offset:264
    ds_read_b64 v[180:181], v14 offset:288
    ds_read_b64 v[182:183], v14 offset:296
    s_nop 0
    v_mfma_f32_32x32x16_bf16 v[160:175], v[212:215], v[100:103], v[160:175]
    ds_read_b64 v[184:185], v14 offset:320
    ds_read_b64 v[186:187], v14 offset:328
    ds_read_b64 v[188:189], v14 offset:352
    s_nop 1
    v_mfma_f32_32x32x16_bf16 v[160:175], v[216:219], v[104:107], v[160:175]
    ds_read_b64 v[190:191], v14 offset:360
    ds_read_b64 v[192:193], v14 offset:384
    ds_read_b64 v[194:195], v14 offset:392
    v_mov_b32_dpp v128, v128 row_shr:1 row_mask:0xf bank_mask:0xf bound_ctrl:0
    v_mov_b32_dpp v129, v129 row_shr:1 row_mask:0xf bank_mask:0xf bound_ctrl:0
    v_mov_b32_dpp v130, v130 row_shr:1 row_mask:0xf bank_mask:0xf bound_ctrl:0
    v_mfma_f32_32x32x16_bf16 v[160:175], v[220:223], v[108:111], v[160:175]
    ds_read_b64 v[196:197], v14 offset:416
    ds_read_b64 v[198:199], v14 offset:424
    ds_read_b64 v[200:201], v14 offset:448
    v_mov_b32_dpp v131, v131 row_shr:1 row_mask:0xf bank_mask:0xf bound_ctrl:0
    v_mov_b32_dpp v132, v132 row_shr:1 row_mask:0xf bank_mask:0xf bound_ctrl:0
    v_mov_b32_dpp v133, v133 row_shr:1 row_mask:0xf bank_mask:0xf bound_ctrl:0
    v_mfma_f32_32x32x16_bf16 v[160:175], v[224:227], v[112:115], v[160:175]
    ds_read_b64 v[202:203], v14 offset:456
    ds_read_b64 v[204:205], v14 offset:480
    ds_read_b64 v[206:207], v14 offset:488
    v_mov_b32_dpp v134, v134 row_shr:1 row_mask:0xf bank_mask:0xf bound_ctrl:0
    v_mov_b32_dpp v135, v135 row_shr:1 row_mask:0xf bank_mask:0xf bound_ctrl:0
    v_mov_b32_dpp v136, v136 row_shr:1 row_mask:0xf bank_mask:0xf bound_ctrl:0
    v_mfma_f32_32x32x16_bf16 v[160:175], v[228:231], v[116:119], v[160:175]
    v_mov_b32_dpp v137, v137 row_shr:1 row_mask:0xf bank_mask:0xf bound_ctrl:0
    v_mov_b32_dpp v138, v138 row_shr:1 row_mask:0xf bank_mask:0xf bound_ctrl:0
    v_mov_b32_dpp v139, v139 row_shr:1 row_mask:0xf bank_mask:0xf bound_ctrl:0
    v_mfma_f32_32x32x16_bf16 v[160:175], v[232:235], v[120:123], v[160:175]
    v_mov_b32_dpp v140, v140 row_shr:1 row_mask:0xf bank_mask:0xf bound_ctrl:0
    v_mov_b32_dpp v141, v141 row_shr:1 row_mask:0xf bank_mask:0xf bound_ctrl:0
    v_mfma_f32_32x32x16_bf16 v[160:175], v[236:239], v[124:127], v[160:175]
    v_mov_b32_dpp v142, v142 row_shr:1 row_mask:0xf bank_mask:0xf bound_ctrl:0
    v_mov_b32_dpp v143, v143 row_shr:1 row_mask:0xf bank_mask:0xf bound_ctrl:0
    s_waitcnt lgkmcnt(0)
    v_mfma_f32_32x32x16_bf16 v[144:159], v[176:179], v[64:67], v[144:159]
    ds_read_b64 v[208:209], v14 offset:2304
    ds_read_b64 v[210:211], v14 offset:2312
    s_nop 2
    v_mfma_f32_32x32x16_bf16 v[144:159], v[180:183], v[68:71], v[144:159]
    ds_read_b64 v[212:213], v14 offset:2336
    ds_read_b64 v[214:215], v14 offset:2344
    s_nop 2
    v_mfma_f32_32x32x16_bf16 v[144:159], v[184:187], v[72:75], v[144:159]
    ds_read_b64 v[216:217], v14 offset:2368
    ds_read_b64 v[218:219], v14 offset:2376
    v_and_b32_dpp v160, v160, v15 row_shr:1 row_mask:0xf bank_mask:0xf bound_ctrl:0
    v_and_b32_dpp v161, v161, v15 row_shr:1 row_mask:0xf bank_mask:0xf bound_ctrl:0
    v_and_b32_dpp v162, v162, v15 row_shr:1 row_mask:0xf bank_mask:0xf bound_ctrl:0
    v_mfma_f32_32x32x16_bf16 v[144:159], v[188:191], v[76:79], v[144:159]
    ds_read_b64 v[220:221], v14 offset:2400
    ds_read_b64 v[222:223], v14 offset:2408
    v_and_b32_dpp v163, v163, v15 row_shr:1 row_mask:0xf bank_mask:0xf bound_ctrl:0
    v_and_b32_dpp v164, v164, v15 row_shr:1 row_mask:0xf bank_mask:0xf bound_ctrl:0
    v_and_b32_dpp v165, v165, v15 row_shr:1 row_mask:0xf bank_mask:0xf bound_ctrl:0
    v_mfma_f32_32x32x16_bf16 v[144:159], v[192:195], v[80:83], v[144:159]
    ds_read_b64 v[224:225], v14 offset:2432
    ds_read_b64 v[226:227], v14 offset:2440
    v_and_b32_dpp v166, v166, v15 row_shr:1 row_mask:0xf bank_mask:0xf bound_ctrl:0
    v_and_b32_dpp v167, v167, v15 row_shr:1 row_mask:0xf bank_mask:0xf bound_ctrl:0
    v_and_b32_dpp v168, v168, v15 row_shr:1 row_mask:0xf bank_mask:0xf bound_ctrl:0
    v_mfma_f32_32x32x16_bf16 v[144:159], v[196:199], v[84:87], v[144:159]
    ds_read_b64 v[228:229], v14 offset:2464
    ds_read_b64 v[230:231], v14 offset:2472
    v_and_b32_dpp v169, v169, v15 row_shr:1 row_mask:0xf bank_mask:0xf bound_ctrl:0
    v_and_b32_dpp v170, v170, v15 row_shr:1 row_mask:0xf bank_mask:0xf bound_ctrl:0
    v_and_b32_dpp v171, v171, v15 row_shr:1 row_mask:0xf bank_mask:0xf bound_ctrl:0
    v_mfma_f32_32x32x16_bf16 v[144:159], v[200:203], v[88:91], v[144:159]
    ds_read_b64 v[232:233], v14 offset:2496
    ds_read_b64 v[234:235], v14 offset:2504
    v_and_b32_dpp v172, v172, v15 row_shr:1 row_mask:0xf bank_mask:0xf bound_ctrl:0
    v_and_b32_dpp v173, v173, v15 row_shr:1 row_mask:0xf bank_mask:0xf bound_ctrl:0
    v_mfma_f32_32x32x16_bf16 v[144:159], v[204:207], v[92:95], v[144:159]
    ds_read_b64 v[236:237], v14 offset:2528
    ds_read_b64 v[238:239], v14 offset:2536
    v_and_b32_dpp v174, v174, v15 row_shr:1 row_mask:0xf bank_mask:0xf bound_ctrl:0
    v_and_b32_dpp v175, v175, v15 row_shr:1 row_mask:0xf bank_mask:0xf bound_ctrl:0
    v_mfma_f32_32x32x16_bf16 v[128:143], v[176:179], v[32:35], v[128:143]
    s_nop 4
    v_mfma_f32_32x32x16_bf16 v[128:143], v[180:183], v[36:39], v[128:143]
    s_nop 4
    v_mfma_f32_32x32x16_bf16 v[128:143], v[184:187], v[40:43], v[128:143]
    v_mov_b32_dpp v144, v144 row_shr:1 row_mask:0xf bank_mask:0xf bound_ctrl:0
    v_mov_b32_dpp v145, v145 row_shr:1 row_mask:0xf bank_mask:0xf bound_ctrl:0
    v_mov_b32_dpp v146, v146 row_shr:1 row_mask:0xf bank_mask:0xf bound_ctrl:0
    v_mfma_f32_32x32x16_bf16 v[128:143], v[188:191], v[44:47], v[128:143]
    v_mov_b32_dpp v147, v147 row_shr:1 row_mask:0xf bank_mask:0xf bound_ctrl:0
    v_mov_b32_dpp v148, v148 row_shr:1 row_mask:0xf bank_mask:0xf bound_ctrl:0
    v_mov_b32_dpp v149, v149 row_shr:1 row_mask:0xf bank_mask:0xf bound_ctrl:0
    v_mfma_f32_32x32x16_bf16 v[128:143], v[192:195], v[48:51], v[128:143]
    v_mov_b32_dpp v150, v150 row_shr:1 row_mask:0xf bank_mask:0xf bound_ctrl:0
    v_mov_b32_dpp v151, v151 row_shr:1 row_mask:0xf bank_mask:0xf bound_ctrl:0
    v_mov_b32_dpp v152, v152 row_shr:1 row_mask:0xf bank_mask:0xf bound_ctrl:0
    v_mfma_f32_32x32x16_bf16 v[128:143], v[196:199], v[52:55], v[128:143]
    v_mov_b32_dpp v153, v153 row_shr:1 row_mask:0xf bank_mask:0xf bound_ctrl:0
    v_mov_b32_dpp v154, v154 row_shr:1 row_mask:0xf bank_mask:0xf bound_ctrl:0
    v_mov_b32_dpp v155, v155 row_shr:1 row_mask:0xf bank_mask:0xf bound_ctrl:0
    v_mfma_f32_32x32x16_bf16 v[128:143], v[200:203], v[56:59], v[128:143]
    v_mov_b32_dpp v156, v156 row_shr:1 row_mask:0xf bank_mask:0xf bound_ctrl:0
    v_mov_b32_dpp v157, v157 row_shr:1 row_mask:0xf bank_mask:0xf bound_ctrl:0
    v_mfma_f32_32x32x16_bf16 v[128:143], v[204:207], v[60:63], v[128:143]
    v_mov_b32_dpp v158, v158 row_shr:1 row_mask:0xf bank_mask:0xf bound_ctrl:0
    v_mov_b32_dpp v159, v159 row_shr:1 row_mask:0xf bank_mask:0xf bound_ctrl:0
    s_waitcnt lgkmcnt(0)
    v_mfma_f32_32x32x16_bf16 v[160:175], v[208:211], v[96:99], v[160:175]
    ds_read_b64 v[176:177], v14 offset:0
    ds_read_b64 v[178:179], v14 offset:8
    ds_read_b64 v[180:181], v14 offset:32
    ds_read_b64 v[182:183], v14 offset:40
    s_nop 0
    v_mfma_f32_32x32x16_bf16 v[160:175], v[212:215], v[100:103], v[160:175]
    ds_read_b64 v[184:185], v14 offset:64
    ds_read_b64 v[186:187], v14 offset:72
    ds_read_b64 v[188:189], v14 offset:96
    s_nop 1
    v_mfma_f32_32x32x16_bf16 v[160:175], v[216:219], v[104:107], v[160:175]
    ds_read_b64 v[190:191], v14 offset:104
    ds_read_b64 v[192:193], v14 offset:128
    ds_read_b64 v[194:195], v14 offset:136
    v_mov_b32_dpp v128, v128 row_shr:1 row_mask:0xf bank_mask:0xf bound_ctrl:0
    v_mov_b32_dpp v129, v129 row_shr:1 row_mask:0xf bank_mask:0xf bound_ctrl:0
    v_mov_b32_dpp v130, v130 row_shr:1 row_mask:0xf bank_mask:0xf bound_ctrl:0
    v_mfma_f32_32x32x16_bf16 v[160:175], v[220:223], v[108:111], v[160:175]
    ds_read_b64 v[196:197], v14 offset:160
    ds_read_b64 v[198:199], v14 offset:168
    ds_read_b64 v[200:201], v14 offset:192
    v_mov_b32_dpp v131, v131 row_shr:1 row_mask:0xf bank_mask:0xf bound_ctrl:0
    v_mov_b32_dpp v132, v132 row_shr:1 row_mask:0xf bank_mask:0xf bound_ctrl:0
    v_mov_b32_dpp v133, v133 row_shr:1 row_mask:0xf bank_mask:0xf bound_ctrl:0
    v_mfma_f32_32x32x16_bf16 v[160:175], v[224:227], v[112:115], v[160:175]
    ds_read_b64 v[202:203], v14 offset:200
    ds_read_b64 v[204:205], v14 offset:224
    ds_read_b64 v[206:207], v14 offset:232
    v_mov_b32_dpp v134, v134 row_shr:1 row_mask:0xf bank_mask:0xf bound_ctrl:0
    v_mov_b32_dpp v135, v135 row_shr:1 row_mask:0xf bank_mask:0xf bound_ctrl:0
    v_mov_b32_dpp v136, v136 row_shr:1 row_mask:0xf bank_mask:0xf bound_ctrl:0
    v_mfma_f32_32x32x16_bf16 v[160:175], v[228:231], v[116:119], v[160:175]
    v_mov_b32_dpp v137, v137 row_shr:1 row_mask:0xf bank_mask:0xf bound_ctrl:0
    v_mov_b32_dpp v138, v138 row_shr:1 row_mask:0xf bank_mask:0xf bound_ctrl:0
    v_mov_b32_dpp v139, v139 row_shr:1 row_mask:0xf bank_mask:0xf bound_ctrl:0
    v_mfma_f32_32x32x16_bf16 v[160:175], v[232:235], v[120:123], v[160:175]
    v_mov_b32_dpp v140, v140 row_shr:1 row_mask:0xf bank_mask:0xf bound_ctrl:0
    v_mov_b32_dpp v141, v141 row_shr:1 row_mask:0xf bank_mask:0xf bound_ctrl:0
    v_mfma_f32_32x32x16_bf16 v[160:175], v[236:239], v[124:127], v[160:175]
    v_mov_b32_dpp v142, v142 row_shr:1 row_mask:0xf bank_mask:0xf bound_ctrl:0
    v_mov_b32_dpp v143, v143 row_shr:1 row_mask:0xf bank_mask:0xf bound_ctrl:0
    s_waitcnt lgkmcnt(0)
    v_mfma_f32_32x32x16_bf16 v[144:159], v[176:179], v[64:67], v[144:159]
    ds_read_b64 v[208:209], v14 offset:2048
    ds_read_b64 v[210:211], v14 offset:2056
    s_nop 2
    v_mfma_f32_32x32x16_bf16 v[144:159], v[180:183], v[68:71], v[144:159]
    ds_read_b64 v[212:213], v14 offset:2080
    ds_read_b64 v[214:215], v14 offset:2088
    s_nop 2
    v_mfma_f32_32x32x16_bf16 v[144:159], v[184:187], v[72:75], v[144:159]
    ds_read_b64 v[216:217], v14 offset:2112
    ds_read_b64 v[218:219], v14 offset:2120
    v_and_b32_dpp v160, v160, v15 row_shr:1 row_mask:0xf bank_mask:0xf bound_ctrl:0
    v_and_b32_dpp v161, v161, v15 row_shr:1 row_mask:0xf bank_mask:0xf bound_ctrl:0
    v_and_b32_dpp v162, v162, v15 row_shr:1 row_mask:0xf bank_mask:0xf bound_ctrl:0
    v_mfma_f32_32x32x16_bf16 v[144:159], v[188:191], v[76:79], v[144:159]
    ds_read_b64 v[220:221], v14 offset:2144
    ds_read_b64 v[222:223], v14 offset:2152
    v_and_b32_dpp v163, v163, v15 row_shr:1 row_mask:0xf bank_mask:0xf bound_ctrl:0
    v_and_b32_dpp v164, v164, v15 row_shr:1 row_mask:0xf bank_mask:0xf bound_ctrl:0
    v_and_b32_dpp v165, v165, v15 row_shr:1 row_mask:0xf bank_mask:0xf bound_ctrl:0
    v_mfma_f32_32x32x16_bf16 v[144:159], v[192:195], v[80:83], v[144:159]
    ds_read_b64 v[224:225], v14 offset:2176
    ds_read_b64 v[226:227], v14 offset:2184
    v_and_b32_dpp v166, v166, v15 row_shr:1 row_mask:0xf bank_mask:0xf bound_ctrl:0
    v_and_b32_dpp v167, v167, v15 row_shr:1 row_mask:0xf bank_mask:0xf bound_ctrl:0
    v_and_b32_dpp v168, v168, v15 row_shr:1 row_mask:0xf bank_mask:0xf bound_ctrl:0
    v_mfma_f32_32x32x16_bf16 v[144:159], v[196:199], v[84:87], v[144:159]
    ds_read_b64 v[228:229], v14 offset:2208
    ds_read_b64 v[230:231], v14 offset:2216
    v_and_b32_dpp v169, v169, v15 row_shr:1 row_mask:0xf bank_mask:0xf bound_ctrl:0
    v_and_b32_dpp v170, v170, v15 row_shr:1 row_mask:0xf bank_mask:0xf bound_ctrl:0
    v_and_b32_dpp v171, v171, v15 row_shr:1 row_mask:0xf bank_mask:0xf bound_ctrl:0
    v_mfma_f32_32x32x16_bf16 v[144:159], v[200:203], v[88:91], v[144:159]
    ds_read_b64 v[232:233], v14 offset:2240
    ds_read_b64 v[234:235], v14 offset:2248
    v_and_b32_dpp v172, v172, v15 row_shr:1 row_mask:0xf bank_mask:0xf bound_ctrl:0
    v_and_b32_dpp v173, v173, v15 row_shr:1 row_mask:0xf bank_mask:0xf bound_ctrl:0
    v_mfma_f32_32x32x16_bf16 v[144:159], v[204:207], v[92:95], v[144:159]
    ds_read_b64 v[236:237], v14 offset:2272
    ds_read_b64 v[238:239], v14 offset:2280
    v_and_b32_dpp v174, v174, v15 row_shr:1 row_mask:0xf bank_mask:0xf bound_ctrl:0
    v_and_b32_dpp v175, v175, v15 row_shr:1 row_mask:0xf bank_mask:0xf bound_ctrl:0
    v_mfma_f32_32x32x16_bf16 v[128:143], v[176:179], v[32:35], v[128:143]
    v_mfma_f32_32x32x16_bf16 v[128:143], v[180:183], v[36:39], v[128:143]
    v_mfma_f32_32x32x16_bf16 v[128:143], v[184:187], v[40:43], v[128:143]
    v_mul_u32_u24 v16, 272, v7
    v_add_u32 v16, s34, v16
    v_add_u32 v16, 4388, v16
    v_lshlrev_b32 v17, 2, v8
    v_sub_u32 v16, v16, v17
    v_lshlrev_b32 v17, 5, v9
    v_sub_u32 v16, v16, v17
    v_mfma_f32_32x32x16_bf16 v[128:143], v[188:191], v[44:47], v[128:143]
    ds_read_b32 v64, v16 offset:216
    ds_read_b32 v65, v16 offset:208
    ds_read_b32 v66, v16 offset:200
    ds_read_b32 v67, v16 offset:192
    ds_read_b32 v68, v16 offset:152
    ds_read_b32 v69, v16 offset:144
    v_mfma_f32_32x32x16_bf16 v[128:143], v[192:195], v[48:51], v[128:143]
    ds_read_b32 v70, v16 offset:136
    ds_read_b32 v71, v16 offset:128
    ds_read_b32 v72, v16 offset:88
    ds_read_b32 v73, v16 offset:80
    ds_read_b32 v74, v16 offset:72
    ds_read_b32 v75, v16 offset:64
    v_mfma_f32_32x32x16_bf16 v[128:143], v[196:199], v[52:55], v[128:143]
    ds_read_b32 v76, v16 offset:24
    ds_read_b32 v77, v16 offset:16
    ds_read_b32 v78, v16 offset:8
    ds_read_b32 v79, v16 offset:0
    s_lshr_b32 s44, s20, 1
    s_and_b32 s45, s20, 1
    v_mfma_f32_32x32x16_bf16 v[128:143], v[200:203], v[56:59], v[128:143]
    s_cmp_eq_u32 s44, 1
    s_cselect_b32 s44, s33, s32
    s_lshl_b32 s46, s44, 16
    s_and_b32 s47, s44, 0xffff0000
    s_cmp_eq_u32 s45, 1
    s_cselect_b32 s44, s47, s46
    v_mfma_f32_32x32x16_bf16 v[128:143], v[204:207], v[60:63], v[128:143]
    v_mul_u32_u24 v18, 264, v7
    v_lshl_add_u32 v18, v9, 5, v18
    v_lshl_add_u32 v18, v8, 2, v18
    v_add_u32 v18, s34, v18
    v_mul_u32_u24 v17, 264, v2
    v_lshl_add_u32 v17, v1, 2, v17
    s_waitcnt lgkmcnt(0)
    v_mfma_f32_32x32x16_bf16 v[160:175], v[208:211], v[96:99], v[160:175]
    v_mfma_f32_32x32x16_bf16 v[160:175], v[212:215], v[100:103], v[160:175]
    v_mfma_f32_32x32x16_bf16 v[160:175], v[216:219], v[104:107], v[160:175]
    v_and_b32 v80, 0xffff0000, v64
    v_lshlrev_b32 v64, 16, v64
    v_and_b32 v81, 0xffff0000, v65
    v_lshlrev_b32 v65, 16, v65
    v_and_b32 v82, 0xffff0000, v66
    v_lshlrev_b32 v66, 16, v66
    v_mfma_f32_32x32x16_bf16 v[160:175], v[220:223], v[108:111], v[160:175]
    v_and_b32 v83, 0xffff0000, v67
    v_lshlrev_b32 v67, 16, v67
    v_and_b32 v84, 0xffff0000, v68
    v_lshlrev_b32 v68, 16, v68
    v_and_b32 v85, 0xffff0000, v69
    v_lshlrev_b32 v69, 16, v69
    v_mfma_f32_32x32x16_bf16 v[160:175], v[224:227], v[112:115], v[160:175]
    v_and_b32 v86, 0xffff0000, v70
    v_lshlrev_b32 v70, 16, v70
    v_and_b32 v87, 0xffff0000, v71
    v_lshlrev_b32 v71, 16, v71
    v_and_b32 v88, 0xffff0000, v72
    v_mfma_f32_32x32x16_bf16 v[160:175], v[228:231], v[116:119], v[160:175]
    v_lshlrev_b32 v72, 16, v72
    v_and_b32 v89, 0xffff0000, v73
    v_lshlrev_b32 v73, 16, v73
    v_and_b32 v90, 0xffff0000, v74
    v_lshlrev_b32 v74, 16, v74
    v_mfma_f32_32x32x16_bf16 v[160:175], v[232:235], v[120:123], v[160:175]
    v_and_b32 v91, 0xffff0000, v75
    v_lshlrev_b32 v75, 16, v75
    v_and_b32 v92, 0xffff0000, v76
    v_lshlrev_b32 v76, 16, v76
    v_and_b32 v93, 0xffff0000, v77
    v_mfma_f32_32x32x16_bf16 v[160:175], v[236:239], v[124:127], v[160:175]
    v_lshlrev_b32 v77, 16, v77
    v_and_b32 v94, 0xffff0000, v78
    v_lshlrev_b32 v78, 16, v78
    v_and_b32 v95, 0xffff0000, v79
    v_lshlrev_b32 v79, 16, v79
    s_mov_b32 s48, 0x05040100
    s_mov_b32 s49, 0x07060302
    s_nop 11
    v_add_f32_dpp v128, v160, v128 row_shr:8 row_mask:0xf bank_mask:0xf bound_ctrl:0
    v_add_f32_dpp v129, v161, v129 row_shr:8 row_mask:0xf bank_mask:0xf bound_ctrl:0
    v_add_f32_dpp v130, v162, v130 row_shr:8 row_mask:0xf bank_mask:0xf bound_ctrl:0
    v_add_f32_dpp v131, v163, v131 row_shr:8 row_mask:0xf bank_mask:0xf bound_ctrl:0
    v_add_f32_dpp v132, v164, v132 row_shr:8 row_mask:0xf bank_mask:0xf bound_ctrl:0
    v_add_f32_dpp v133, v165, v133 row_shr:8 row_mask:0xf bank_mask:0xf bound_ctrl:0
    v_add_f32_dpp v134, v166, v134 row_shr:8 row_mask:0xf bank_mask:0xf bound_ctrl:0
    v_add_f32_dpp v135, v167, v135 row_shr:8 row_mask:0xf bank_mask:0xf bound_ctrl:0
    v_add_f32_dpp v136, v168, v136 row_shr:8 row_mask:0xf bank_mask:0xf bound_ctrl:0
    v_add_f32_dpp v137, v169, v137 row_shr:8 row_mask:0xf bank_mask:0xf bound_ctrl:0
    v_add_f32_dpp v138, v170, v138 row_shr:8 row_mask:0xf bank_mask:0xf bound_ctrl:0
    v_add_f32_dpp v139, v171, v139 row_shr:8 row_mask:0xf bank_mask:0xf bound_ctrl:0
    v_add_f32_dpp v140, v172, v140 row_shr:8 row_mask:0xf bank_mask:0xf bound_ctrl:0
    v_add_f32_dpp v141, v173, v141 row_shr:8 row_mask:0xf bank_mask:0xf bound_ctrl:0
    v_add_f32_dpp v142, v174, v142 row_shr:8 row_mask:0xf bank_mask:0xf bound_ctrl:0
    v_add_f32_dpp v143, v175, v143 row_shr:8 row_mask:0xf bank_mask:0xf bound_ctrl:0
    s_mov_b32 s42, 0xff00ff00
    s_mov_b32 s43, 0xff00ff00
    s_mov_b64 exec, s[42:43]
    v_add_f32 v144, v160, v144
    v_add_f32 v145, v161, v145
    v_add_f32 v146, v162, v146
    v_add_f32 v147, v163, v147
    v_add_f32 v148, v164, v148
    v_add_f32 v149, v165, v149
    v_add_f32 v150, v166, v150
    v_add_f32 v151, v167, v151
    v_add_f32 v152, v168, v152
    v_add_f32 v153, v169, v153
    v_add_f32 v154, v170, v154
    v_add_f32 v155, v171, v155
    v_add_f32 v156, v172, v156
    v_add_f32 v157, v173, v157
    v_add_f32 v158, v174, v158
    v_add_f32 v159, v175, v159
    s_mov_b64 exec, -1
    v_fma_f32 v128, v80, s44, v128
    v_fma_f32 v144, v64, s44, v144
    v_fma_f32 v129, v81, s44, v129
    v_fma_f32 v145, v65, s44, v145
    v_fma_f32 v130, v82, s44, v130
    v_fma_f32 v146, v66, s44, v146
    v_fma_f32 v131, v83, s44, v131
    v_fma_f32 v147, v67, s44, v147
    v_fma_f32 v132, v84, s44, v132
    v_fma_f32 v148, v68, s44, v148
    v_fma_f32 v133, v85, s44, v133
    v_fma_f32 v149, v69, s44, v149
    v_fma_f32 v134, v86, s44, v134
    v_fma_f32 v150, v70, s44, v150
    v_fma_f32 v135, v87, s44, v135
    v_fma_f32 v151, v71, s44, v151
    v_fma_f32 v136, v88, s44, v136
    v_fma_f32 v152, v72, s44, v152
    v_fma_f32 v137, v89, s44, v137
    v_fma_f32 v153, v73, s44, v153
    v_fma_f32 v138, v90, s44, v138
    v_fma_f32 v154, v74, s44, v154
    v_fma_f32 v139, v91, s44, v139
    v_fma_f32 v155, v75, s44, v155
    v_fma_f32 v140, v92, s44, v140
    v_fma_f32 v156, v76, s44, v156
    v_fma_f32 v141, v93, s44, v141
    v_fma_f32 v157, v77, s44, v157
    v_fma_f32 v142, v94, s44, v142
    v_fma_f32 v158, v78, s44, v158
    v_fma_f32 v143, v95, s44, v143
    v_fma_f32 v159, v79, s44, v159
    v_cvt_pk_bf16_f32 v32, v128, v144
    v_cvt_pk_bf16_f32 v33, v129, v145
    v_cvt_pk_bf16_f32 v34, v130, v146
    v_cvt_pk_bf16_f32 v35, v131, v147
    v_cvt_pk_bf16_f32 v36, v132, v148
    v_cvt_pk_bf16_f32 v37, v133, v149
    v_cvt_pk_bf16_f32 v38, v134, v150
    v_cvt_pk_bf16_f32 v39, v135, v151
    v_cvt_pk_bf16_f32 v40, v136, v152
    v_cvt_pk_bf16_f32 v41, v137, v153
    v_cvt_pk_bf16_f32 v42, v138, v154
    v_cvt_pk_bf16_f32 v43, v139, v155
    v_cvt_pk_bf16_f32 v44, v140, v156
    v_cvt_pk_bf16_f32 v45, v141, v157
    v_cvt_pk_bf16_f32 v46, v142, v158
    v_cvt_pk_bf16_f32 v47, v143, v159
    ds_write_b32 v18, v32 offset:0
    ds_write_b32 v18, v33 offset:8
    ds_write_b32 v18, v34 offset:16
    ds_write_b32 v18, v35 offset:24
    ds_write_b32 v18, v36 offset:64
    ds_write_b32 v18, v37 offset:72
    ds_write_b32 v18, v38 offset:80
    ds_write_b32 v18, v39 offset:88
    ds_write_b32 v18, v40 offset:128
    ds_write_b32 v18, v41 offset:136
    ds_write_b32 v18, v42 offset:144
    ds_write_b32 v18, v43 offset:152
    ds_write_b32 v18, v44 offset:192
    ds_write_b32 v18, v45 offset:200
    ds_write_b32 v18, v46 offset:208
    ds_write_b32 v18, v47 offset:216
    s_waitcnt lgkmcnt(0)
    s_barrier
    ds_read_b32 v48, v17 offset:0
    ds_read_b32 v49, v17 offset:9472
    ds_read_b32 v50, v17 offset:18944
    ds_read_b32 v51, v17 offset:28416
    ds_read_b32 v52, v17 offset:1056
    ds_read_b32 v53, v17 offset:10528
    ds_read_b32 v54, v17 offset:20000
    ds_read_b32 v55, v17 offset:29472
    ds_read_b32 v56, v17 offset:2112
    ds_read_b32 v57, v17 offset:11584
    ds_read_b32 v58, v17 offset:21056
    ds_read_b32 v59, v17 offset:30528
    ds_read_b32 v60, v17 offset:3168
    ds_read_b32 v61, v17 offset:12640
    ds_read_b32 v62, v17 offset:22112
    ds_read_b32 v63, v17 offset:31584
    s_waitcnt lgkmcnt(0)
    v_perm_b32 v96, v49, v48, s48
    v_perm_b32 v98, v49, v48, s49
    v_perm_b32 v97, v51, v50, s48
    v_perm_b32 v99, v51, v50, s49
    v_perm_b32 v100, v53, v52, s48
    v_perm_b32 v102, v53, v52, s49
    v_perm_b32 v101, v55, v54, s48
    v_perm_b32 v103, v55, v54, s49
    v_perm_b32 v104, v57, v56, s48
    v_perm_b32 v106, v57, v56, s49
    v_perm_b32 v105, v59, v58, s48
    v_perm_b32 v107, v59, v58, s49
    v_perm_b32 v108, v61, v60, s48
    v_perm_b32 v110, v61, v60, s49
    v_perm_b32 v109, v63, v62, s48
    v_perm_b32 v111, v63, v62, s49
    v_lshrrev_b32 v20, 3, v0
    v_lshrrev_b32 v21, 4, v20
    v_and_b32 v22, 15, v20
    v_mul_u32_u24 v23, 20480, v20
    v_sub_u32 v23, v4, v23
    s_mov_b32 s40, 1601536
    v_mul_lo_u32 v24, v21, s40
    v_add_u32 v24, v24, v23
    v_add_u32 v25, 1, v22
    v_mul_u32_u24 v25, 20480, v25
    v_add_u32 v25, v25, v24
    v_cmp_eq_u32 s[42:43], 15, v22
    v_cmp_eq_u32 s[44:45], 0, v22
    v_add_u32 v26, 3203072, v24
    v_add_u32 v27, 348160, v24
    v_cndmask_b32 v26, v27, v26, s[42:43]
    v_cmp_ne_u32 vcc, 0, v20
    s_and_b64 s[46:47], s[44:45], vcc
    s_or_b64 s[46:47], s[46:47], s[42:43]
    v_cmp_ne_u32 vcc, 31, v20
    s_and_b64 s[52:53], s[42:43], vcc
    s_or_b64 s[52:53], s[52:53], s[44:45]
    s_or_b64 s[44:45], s[44:45], s[42:43]
    s_add_u32 s39, s38, 9060352
    buffer_store_dwordx4 v[96:99], v25, s[28:31], s39 offen sc1
    s_mov_b64 exec, s[46:47]
    s_cbranch_execz k1_kernel_halo9
    s_sub_u32 s41, s39, 1601536
    buffer_store_dwordx4 v[96:99], v26, s[28:31], s41 offen sc1
k1_kernel_halo9:
    s_mov_b64 exec, -1
    s_add_u32 s39, s39, 3203072
    buffer_store_dwordx4 v[100:103], v25, s[28:31], s39 offen sc1
    s_mov_b64 exec, s[44:45]
    s_cbranch_execz k1_kernel_halo10
    s_sub_u32 s41, s39, 1601536
    buffer_store_dwordx4 v[100:103], v26, s[28:31], s41 offen sc1
k1_kernel_halo10:
    s_mov_b64 exec, -1
    s_add_u32 s39, s39, 3203072
    buffer_store_dwordx4 v[104:107], v25, s[28:31], s39 offen sc1
    s_mov_b64 exec, s[44:45]
    s_cbranch_execz k1_kernel_halo11
    s_sub_u32 s41, s39, 1601536
    buffer_store_dwordx4 v[104:107], v26, s[28:31], s41 offen sc1
k1_kernel_halo11:
    s_mov_b64 exec, -1
    s_add_u32 s39, s39, 3203072
    buffer_store_dwordx4 v[108:111], v25, s[28:31], s39 offen sc1
    s_mov_b64 exec, s[52:53]
    s_cbranch_execz k1_kernel_halo12
    s_sub_u32 s41, s39, 1601536
    buffer_store_dwordx4 v[108:111], v26, s[28:31], s41 offen sc1
k1_kernel_halo12:
    s_mov_b64 exec, -1
    s_add_u32 s39, s39, 3203072
    s_waitcnt vmcnt(0)
    s_endpgm
k1_side:
    s_cmp_ge_u32 s54, 188
    s_cbranch_scc1 k1_end
    s_cmp_lt_u32 s54, 128
    s_cbranch_scc1 k1_kernel_sx13
    s_mov_b32 s61, s54
    s_cmp_lg_u32 s20, 0
    s_cbranch_scc1 k1_kernel_sw15
    s_and_b32 s55, s2, 7
    s_lshl_b32 s57, s55, 9
    s_add_u32 s57, s57, 9056256
    v_mov_b32 v250, 0
    v_and_b32 v248, 31, v0
    v_lshlrev_b32 v248, 2, v248
    s_waitcnt lgkmcnt(0)
    s_mov_b32 s28, s10
    s_mov_b32 s29, s11
    s_mov_b32 s30, 268435456
    s_mov_b32 s31, 0x00020000
    buffer_load_dword v251, v250, s[28:31], s57 offen sc1
    s_mov_b32 s23, 1
    s_waitcnt vmcnt(0)
    v_add_u32 v251, 1, v251
k1_kernel_sw14:
    buffer_load_dword v249, v248, s[28:31], s57 offen offset:256 sc1
    s_waitcnt vmcnt(0)
    v_cmp_eq_u32 vcc, v251, v249
    s_sub_u32 s23, s23, 1
    s_cmp_eq_u64 vcc, -1
    s_cbranch_scc1 k1_kernel_sw15
    s_sleep 16
    s_cmp_lg_u32 s23, 0
    s_cbranch_scc1 k1_kernel_sw14
k1_kernel_sw15:
    s_barrier
    s_mov_b32 s54, s61
k1_kernel_sx13:
    s_cmp_lt_u32 s54, 128
    s_cbranch_scc1 k1_pf
    s_branch k1_mod0
k1_side2:
    s_load_dwordx2 s[10:11], s[0:1], 120
    s_load_dwordx8 s[12:19], s[0:1], 56
    v_lshrrev_b32 v2, 6, v0
    v_and_b32 v1, 63, v0
    v_readfirstlane_b32 s20, v2
    s_waitcnt lgkmcnt(0)
    s_mov_b32 s28, s10
    s_mov_b32 s29, s11
    s_mov_b32 s30, 268435456
    s_mov_b32 s31, 0x00020000
    s_sub_u32 s21, s54, 0
    v_lshrrev_b32 v3, 3, v0
    v_and_b32 v4, 7, v0
    v_mul_u32_u24 v5, 144, v3
    v_lshl_add_u32 v5, v4, 4, v5
    v_and_b32 v6, 15, v1
    v_lshrrev_b32 v7, 4, v1
    v_lshrrev_b32 v8, 2, v6
    v_lshl_add_u32 v8, v7, 3, v8
    v_mul_u32_u24 v8, 144, v8
    v_and_b32 v9, 3, v6
    v_lshl_add_u32 v8, v9, 3, v8
    s_lshl_b32 s22, s20, 5
    v_add_u32 v8, s22, v8
    v_lshlrev_b32 v9, 4, v1
    s_cmp_lt_u32 s21, 10
    s_cbranch_scc1 k1_kernel_pk16
    s_cmp_lt_u32 s21, 20
    s_cbranch_scc1 k1_kernel_pk17
    s_cmp_lt_u32 s21, 48
    s_cbranch_scc1 k1_kernel_pk18
    s_cmp_lt_u32 s21, 78
    s_cbranch_scc1 k1_kernel_pk19
    s_branch k1_kernel_pke20
k1_kernel_pk16:
    s_mov_b32 s24, s12
    s_mov_b32 s25, s13
    s_mov_b32 s26, 819200
    s_mov_b32 s27, 0x00020000
    s_sub_u32 s32, s21, 0
    s_mul_i32 s33, s32, 52429
    s_lshr_b32 s33, s33, 18
    s_mul_i32 s34, s33, 5
    s_sub_u32 s34, s32, s34
    s_lshl_b32 s34, s34, 1
    v_mul_u32_u24 v10, 1280, v3
    v_lshl_add_u32 v10, v4, 4, v10
    s_mul_i32 s35, s33, 409600
    s_lshl_b32 s36, s34, 7
    s_add_u32 s35, s35, s36
    buffer_load_dwordx4 v[32:35], v10, s[24:27], s35 offen offset:0
    s_add_u32 s35, s35, 40960
    buffer_load_dwordx4 v[36:39], v10, s[24:27], s35 offen offset:0
    s_add_u32 s35, s35, 40960
    buffer_load_dwordx4 v[40:43], v10, s[24:27], s35 offen offset:0
    s_add_u32 s35, s35, 40960
    buffer_load_dwordx4 v[44:47], v10, s[24:27], s35 offen offset:0
    s_add_u32 s35, s35, 40960
    buffer_load_dwordx4 v[48:51], v10, s[24:27], s35 offen offset:0
    s_add_u32 s35, s35, 40960
    buffer_load_dwordx4 v[52:55], v10, s[24:27], s35 offen offset:0
    s_add_u32 s35, s35, 40960
    buffer_load_dwordx4 v[56:59], v10, s[24:27], s35 offen offset:0
    s_add_u32 s35, s35, 40960
    buffer_load_dwordx4 v[60:63], v10, s[24:27], s35 offen offset:0
    s_add_u32 s35, s35, 40960
    buffer_load_dwordx4 v[64:67], v10, s[24:27], s35 offen offset:0
    s_add_u32 s35, s35, 40960
    buffer_load_dwordx4 v[68:71], v10, s[24:27], s35 offen offset:0
    s_sub_u32 s35, s35, 368640
    buffer_load_dwordx4 v[72:75], v10, s[24:27], s35 offen offset:128
    s_add_u32 s35, s35, 40960
    buffer_load_dwordx4 v[76:79], v10, s[24:27], s35 offen offset:128
    s_add_u32 s35, s35, 40960
    buffer_load_dwordx4 v[80:83], v10, s[24:27], s35 offen offset:128
    s_add_u32 s35, s35, 40960
    buffer_load_dwordx4 v[84:87], v10, s[24:27], s35 offen offset:128
    s_add_u32 s35, s35, 40960
    buffer_load_dwordx4 v[88:91], v10, s[24:27], s35 offen offset:128
    s_add_u32 s35, s35, 40960
    buffer_load_dwordx4 v[92:95], v10, s[24:27], s35 offen offset:128
    s_add_u32 s35, s35, 40960
    buffer_load_dwordx4 v[96:99], v10, s[24:27], s35 offen offset:128
    s_add_u32 s35, s35, 40960
    buffer_load_dwordx4 v[100:103], v10, s[24:27], s35 offen offset:128
    s_add_u32 s35, s35, 40960
    buffer_load_dwordx4 v[104:107], v10, s[24:27], s35 offen offset:128
    s_add_u32 s35, s35, 40960
    buffer_load_dwordx4 v[108:111], v10, s[24:27], s35 offen offset:128
    s_lshl_b32 s36, s34, 2
    s_add_u32 s36, s36, s20
    s_mul_i32 s38, s36, 52429
    s_lshr_b32 s38, s38, 18
    s_mul_i32 s39, s38, 5
    s_sub_u32 s39, s36, s39
    s_mul_i32 s37, s38, 100
    s_mul_i32 s40, s33, 50
    s_add_u32 s37, s37, s40
    s_add_u32 s37, s37, s39
    s_lshl_b32 s37, s37, 10
    s_add_u32 s37, s37, 2764800
    s_waitcnt vmcnt(19)
    ds_write_b128 v5, v[32:35] offset:0
    s_waitcnt vmcnt(18)
    ds_write_b128 v5, v[36:39] offset:4608
    s_waitcnt vmcnt(17)
    ds_write_b128 v5, v[40:43] offset:9216
    s_waitcnt vmcnt(16)
    ds_write_b128 v5, v[44:47] offset:13824
    s_waitcnt vmcnt(15)
    ds_write_b128 v5, v[48:51] offset:18432
    s_waitcnt vmcnt(14)
    ds_write_b128 v5, v[52:55] offset:23040
    s_waitcnt vmcnt(13)
    ds_write_b128 v5, v[56:59] offset:27648
    s_waitcnt vmcnt(12)
    ds_write_b128 v5, v[60:63] offset:32256
    s_waitcnt vmcnt(11)
    ds_write_b128 v5, v[64:67] offset:36864
    s_waitcnt vmcnt(10)
    ds_write_b128 v5, v[68:71] offset:41472
    s_waitcnt lgkmcnt(0)
    s_barrier
    ds_read_b64_tr_b16 v[32:33], v8 offset:0
    ds_read_b64_tr_b16 v[34:35], v8 offset:576
    ds_read_b64_tr_b16 v[36:37], v8 offset:4608
    ds_read_b64_tr_b16 v[38:39], v8 offset:5184
    ds_read_b64_tr_b16 v[40:41], v8 offset:9216
    ds_read_b64_tr_b16 v[42:43], v8 offset:9792
    ds_read_b64_tr_b16 v[44:45], v8 offset:13824
    ds_read_b64_tr_b16 v[46:47], v8 offset:14400
    ds_read_b64_tr_b16 v[48:49], v8 offset:18432
    ds_read_b64_tr_b16 v[50:51], v8 offset:19008
    ds_read_b64_tr_b16 v[52:53], v8 offset:23040
    ds_read_b64_tr_b16 v[54:55], v8 offset:23616
    ds_read_b64_tr_b16 v[56:57], v8 offset:27648
    ds_read_b64_tr_b16 v[58:59], v8 offset:28224
    ds_read_b64_tr_b16 v[60:61], v8 offset:32256
    ds_read_b64_tr_b16 v[62:63], v8 offset:32832
    ds_read_b64_tr_b16 v[64:65], v8 offset:36864
    ds_read_b64_tr_b16 v[66:67], v8 offset:37440
    ds_read_b64_tr_b16 v[68:69], v8 offset:41472
    ds_read_b64_tr_b16 v[70:71], v8 offset:42048
    v_mov_b32 v12, 0
    v_mov_b32 v13, 0x3f803f80
    s_waitcnt lgkmcnt(15)
    s_add_u32 s38, s37, 0
    buffer_store_dwordx4 v[32:35], v9, s[28:31], s38 offen sc1
    v_dot2_f32_bf16 v12, v32, v13, v12
    v_dot2_f32_bf16 v12, v33, v13, v12
    v_dot2_f32_bf16 v12, v34, v13, v12
    v_dot2_f32_bf16 v12, v35, v13, v12
    s_waitcnt lgkmcnt(15)
    s_add_u32 s38, s37, 5120
    buffer_store_dwordx4 v[36:39], v9, s[28:31], s38 offen sc1
    v_dot2_f32_bf16 v12, v36, v13, v12
    v_dot2_f32_bf16 v12, v37, v13, v12
    v_dot2_f32_bf16 v12, v38, v13, v12
    v_dot2_f32_bf16 v12, v39, v13, v12
    s_waitcnt lgkmcnt(14)
    s_add_u32 s38, s37, 10240
    buffer_store_dwordx4 v[40:43], v9, s[28:31], s38 offen sc1
    v_dot2_f32_bf16 v12, v40, v13, v12
    v_dot2_f32_bf16 v12, v41, v13, v12
    v_dot2_f32_bf16 v12, v42, v13, v12
    v_dot2_f32_bf16 v12, v43, v13, v12
    s_waitcnt lgkmcnt(12)
    s_add_u32 s38, s37, 15360
    buffer_store_dwordx4 v[44:47], v9, s[28:31], s38 offen sc1
    v_dot2_f32_bf16 v12, v44, v13, v12
    v_dot2_f32_bf16 v12, v45, v13, v12
    v_dot2_f32_bf16 v12, v46, v13, v12
    v_dot2_f32_bf16 v12, v47, v13, v12
    s_waitcnt lgkmcnt(10)
    s_add_u32 s38, s37, 20480
    buffer_store_dwordx4 v[48:51], v9, s[28:31], s38 offen sc1
    v_dot2_f32_bf16 v12, v48, v13, v12
    v_dot2_f32_bf16 v12, v49, v13, v12
    v_dot2_f32_bf16 v12, v50, v13, v12
    v_dot2_f32_bf16 v12, v51, v13, v12
    s_waitcnt lgkmcnt(8)
    s_add_u32 s38, s37, 25600
    buffer_store_dwordx4 v[52:55], v9, s[28:31], s38 offen sc1
    v_dot2_f32_bf16 v12, v52, v13, v12
    v_dot2_f32_bf16 v12, v53, v13, v12
    v_dot2_f32_bf16 v12, v54, v13, v12
    v_dot2_f32_bf16 v12, v55, v13, v12
    s_waitcnt lgkmcnt(6)
    s_add_u32 s38, s37, 30720
    buffer_store_dwordx4 v[56:59], v9, s[28:31], s38 offen sc1
    v_dot2_f32_bf16 v12, v56, v13, v12
    v_dot2_f32_bf16 v12, v57, v13, v12
    v_dot2_f32_bf16 v12, v58, v13, v12
    v_dot2_f32_bf16 v12, v59, v13, v12
    s_waitcnt lgkmcnt(4)
    s_add_u32 s38, s37, 35840
    buffer_store_dwordx4 v[60:63], v9, s[28:31], s38 offen sc1
    v_dot2_f32_bf16 v12, v60, v13, v12
    v_dot2_f32_bf16 v12, v61, v13, v12
    v_dot2_f32_bf16 v12, v62, v13, v12
    v_dot2_f32_bf16 v12, v63, v13, v12
    s_waitcnt lgkmcnt(2)
    s_add_u32 s38, s37, 40960
    buffer_store_dwordx4 v[64:67], v9, s[28:31], s38 offen sc1
    v_dot2_f32_bf16 v12, v64, v13, v12
    v_dot2_f32_bf16 v12, v65, v13, v12
    v_dot2_f32_bf16 v12, v66, v13, v12
    v_dot2_f32_bf16 v12, v67, v13, v12
    s_waitcnt lgkmcnt(0)
    s_add_u32 s38, s37, 46080
    buffer_store_dwordx4 v[68:71], v9, s[28:31], s38 offen sc1
    v_dot2_f32_bf16 v12, v68, v13, v12
    v_dot2_f32_bf16 v12, v69, v13, v12
    v_dot2_f32_bf16 v12, v70, v13, v12
    v_dot2_f32_bf16 v12, v71, v13, v12
    s_nop 2
    v_mov_b32 v13, v12
    s_nop 1
    v_permlane32_swap_b32 v13, v12
    v_add_f32 v12, v12, v13
    v_mov_b32 v13, v12
    s_nop 1
    v_permlane16_swap_b32 v13, v12
    v_add_f32 v12, v12, v13
    s_mul_i32 s38, s33, 7168
    s_lshl_b32 s39, s36, 6
    s_add_u32 s38, s38, s39
    s_add_u32 s38, s38, 2748416
    v_lshlrev_b32 v14, 2, v1
    v_cmp_gt_u32 vcc, 16, v1
    s_and_saveexec_b64 s[40:41], vcc
    buffer_store_dword v12, v14, s[28:31], s38 offen sc1
    s_mov_b64 exec, -1
    s_add_u32 s34, s34, 1
    s_barrier
    s_lshl_b32 s36, s34, 2
    s_add_u32 s36, s36, s20
    s_mul_i32 s38, s36, 52429
    s_lshr_b32 s38, s38, 18
    s_mul_i32 s39, s38, 5
    s_sub_u32 s39, s36, s39
    s_mul_i32 s37, s38, 100
    s_mul_i32 s40, s33, 50
    s_add_u32 s37, s37, s40
    s_add_u32 s37, s37, s39
    s_lshl_b32 s37, s37, 10
    s_add_u32 s37, s37, 2764800
    s_waitcnt vmcnt(20)
    ds_write_b128 v5, v[72:75] offset:0
    s_waitcnt vmcnt(19)
    ds_write_b128 v5, v[76:79] offset:4608
    s_waitcnt vmcnt(18)
    ds_write_b128 v5, v[80:83] offset:9216
    s_waitcnt vmcnt(17)
    ds_write_b128 v5, v[84:87] offset:13824
    s_waitcnt vmcnt(16)
    ds_write_b128 v5, v[88:91] offset:18432
    s_waitcnt vmcnt(15)
    ds_write_b128 v5, v[92:95] offset:23040
    s_waitcnt vmcnt(14)
    ds_write_b128 v5, v[96:99] offset:27648
    s_waitcnt vmcnt(13)
    ds_write_b128 v5, v[100:103] offset:32256
    s_waitcnt vmcnt(12)
    ds_write_b128 v5, v[104:107] offset:36864
    s_waitcnt vmcnt(11)
    ds_write_b128 v5, v[108:111] offset:41472
    s_waitcnt lgkmcnt(0)
    s_barrier
    ds_read_b64_tr_b16 v[72:73], v8 offset:0
    ds_read_b64_tr_b16 v[74:75], v8 offset:576
    ds_read_b64_tr_b16 v[76:77], v8 offset:4608
    ds_read_b64_tr_b16 v[78:79], v8 offset:5184
    ds_read_b64_tr_b16 v[80:81], v8 offset:9216
    ds_read_b64_tr_b16 v[82:83], v8 offset:9792
    ds_read_b64_tr_b16 v[84:85], v8 offset:13824
    ds_read_b64_tr_b16 v[86:87], v8 offset:14400
    ds_read_b64_tr_b16 v[88:89], v8 offset:18432
    ds_read_b64_tr_b16 v[90:91], v8 offset:19008
    ds_read_b64_tr_b16 v[92:93], v8 offset:23040
    ds_read_b64_tr_b16 v[94:95], v8 offset:23616
    ds_read_b64_tr_b16 v[96:97], v8 offset:27648
    ds_read_b64_tr_b16 v[98:99], v8 offset:28224
    ds_read_b64_tr_b16 v[100:101], v8 offset:32256
    ds_read_b64_tr_b16 v[102:103], v8 offset:32832
    ds_read_b64_tr_b16 v[104:105], v8 offset:36864
    ds_read_b64_tr_b16 v[106:107], v8 offset:37440
    ds_read_b64_tr_b16 v[108:109], v8 offset:41472
    ds_read_b64_tr_b16 v[110:111], v8 offset:42048
    v_mov_b32 v12, 0
    v_mov_b32 v13, 0x3f803f80
    s_waitcnt lgkmcnt(15)
    s_add_u32 s38, s37, 0
    buffer_store_dwordx4 v[72:75], v9, s[28:31], s38 offen sc1
    v_dot2_f32_bf16 v12, v72, v13, v12
    v_dot2_f32_bf16 v12, v73, v13, v12
    v_dot2_f32_bf16 v12, v74, v13, v12
    v_dot2_f32_bf16 v12, v75, v13, v12
    s_waitcnt lgkmcnt(15)
    s_add_u32 s38, s37, 5120
    buffer_store_dwordx4 v[76:79], v9, s[28:31], s38 offen sc1
    v_dot2_f32_bf16 v12, v76, v13, v12
    v_dot2_f32_bf16 v12, v77, v13, v12
    v_dot2_f32_bf16 v12, v78, v13, v12
    v_dot2_f32_bf16 v12, v79, v13, v12
    s_waitcnt lgkmcnt(14)
    s_add_u32 s38, s37, 10240
    buffer_store_dwordx4 v[80:83], v9, s[28:31], s38 offen sc1
    v_dot2_f32_bf16 v12, v80, v13, v12
    v_dot2_f32_bf16 v12, v81, v13, v12
    v_dot2_f32_bf16 v12, v82, v13, v12
    v_dot2_f32_bf16 v12, v83, v13, v12
    s_waitcnt lgkmcnt(12)
    s_add_u32 s38, s37, 15360
    buffer_store_dwordx4 v[84:87], v9, s[28:31], s38 offen sc1
    v_dot2_f32_bf16 v12, v84, v13, v12
    v_dot2_f32_bf16 v12, v85, v13, v12
    v_dot2_f32_bf16 v12, v86, v13, v12
    v_dot2_f32_bf16 v12, v87, v13, v12
    s_waitcnt lgkmcnt(10)
    s_add_u32 s38, s37, 20480
    buffer_store_dwordx4 v[88:91], v9, s[28:31], s38 offen sc1
    v_dot2_f32_bf16 v12, v88, v13, v12
    v_dot2_f32_bf16 v12, v89, v13, v12
    v_dot2_f32_bf16 v12, v90, v13, v12
    v_dot2_f32_bf16 v12, v91, v13, v12
    s_waitcnt lgkmcnt(8)
    s_add_u32 s38, s37, 25600
    buffer_store_dwordx4 v[92:95], v9, s[28:31], s38 offen sc1
    v_dot2_f32_bf16 v12, v92, v13, v12
    v_dot2_f32_bf16 v12, v93, v13, v12
    v_dot2_f32_bf16 v12, v94, v13, v12
    v_dot2_f32_bf16 v12, v95, v13, v12
    s_waitcnt lgkmcnt(6)
    s_add_u32 s38, s37, 30720
    buffer_store_dwordx4 v[96:99], v9, s[28:31], s38 offen sc1
    v_dot2_f32_bf16 v12, v96, v13, v12
    v_dot2_f32_bf16 v12, v97, v13, v12
    v_dot2_f32_bf16 v12, v98, v13, v12
    v_dot2_f32_bf16 v12, v99, v13, v12
    s_waitcnt lgkmcnt(4)
    s_add_u32 s38, s37, 35840
    buffer_store_dwordx4 v[100:103], v9, s[28:31], s38 offen sc1
    v_dot2_f32_bf16 v12, v100, v13, v12
    v_dot2_f32_bf16 v12, v101, v13, v12
    v_dot2_f32_bf16 v12, v102, v13, v12
    v_dot2_f32_bf16 v12, v103, v13, v12
    s_waitcnt lgkmcnt(2)
    s_add_u32 s38, s37, 40960
    buffer_store_dwordx4 v[104:107], v9, s[28:31], s38 offen sc1
    v_dot2_f32_bf16 v12, v104, v13, v12
    v_dot2_f32_bf16 v12, v105, v13, v12
    v_dot2_f32_bf16 v12, v106, v13, v12
    v_dot2_f32_bf16 v12, v107, v13, v12
    s_waitcnt lgkmcnt(0)
    s_add_u32 s38, s37, 46080
    buffer_store_dwordx4 v[108:111], v9, s[28:31], s38 offen sc1
    v_dot2_f32_bf16 v12, v108, v13, v12
    v_dot2_f32_bf16 v12, v109, v13, v12
    v_dot2_f32_bf16 v12, v110, v13, v12
    v_dot2_f32_bf16 v12, v111, v13, v12
    s_nop 2
    v_mov_b32 v13, v12
    s_nop 1
    v_permlane32_swap_b32 v13, v12
    v_add_f32 v12, v12, v13
    v_mov_b32 v13, v12
    s_nop 1
    v_permlane16_swap_b32 v13, v12
    v_add_f32 v12, v12, v13
    s_mul_i32 s38, s33, 7168
    s_lshl_b32 s39, s36, 6
    s_add_u32 s38, s38, s39
    s_add_u32 s38, s38, 2748416
    v_lshlrev_b32 v14, 2, v1
    v_cmp_gt_u32 vcc, 16, v1
    s_and_saveexec_b64 s[40:41], vcc
    buffer_store_dword v12, v14, s[28:31], s38 offen sc1
    s_mov_b64 exec, -1
    s_endpgm
k1_kernel_pk17:
    s_mov_b32 s24, s14
    s_mov_b32 s25, s15
    s_mov_b32 s26, 819200
    s_mov_b32 s27, 0x00020000
    s_sub_u32 s32, s21, 10
    s_mul_i32 s33, s32, 52429
    s_lshr_b32 s33, s33, 18
    s_mul_i32 s34, s33, 5
    s_sub_u32 s34, s32, s34
    s_lshl_b32 s34, s34, 1
    v_mul_u32_u24 v10, 1280, v3
    v_lshl_add_u32 v10, v4, 4, v10
    s_mul_i32 s35, s33, 409600
    s_lshl_b32 s36, s34, 7
    s_add_u32 s35, s35, s36
    buffer_load_dwordx4 v[32:35], v10, s[24:27], s35 offen offset:0
    s_add_u32 s35, s35, 40960
    buffer_load_dwordx4 v[36:39], v10, s[24:27], s35 offen offset:0
    s_add_u32 s35, s35, 40960
    buffer_load_dwordx4 v[40:43], v10, s[24:27], s35 offen offset:0
    s_add_u32 s35, s35, 40960
    buffer_load_dwordx4 v[44:47], v10, s[24:27], s35 offen offset:0
    s_add_u32 s35, s35, 40960
    buffer_load_dwordx4 v[48:51], v10, s[24:27], s35 offen offset:0
    s_add_u32 s35, s35, 40960
    buffer_load_dwordx4 v[52:55], v10, s[24:27], s35 offen offset:0
    s_add_u32 s35, s35, 40960
    buffer_load_dwordx4 v[56:59], v10, s[24:27], s35 offen offset:0
    s_add_u32 s35, s35, 40960
    buffer_load_dwordx4 v[60:63], v10, s[24:27], s35 offen offset:0
    s_add_u32 s35, s35, 40960
    buffer_load_dwordx4 v[64:67], v10, s[24:27], s35 offen offset:0
    s_add_u32 s35, s35, 40960
    buffer_load_dwordx4 v[68:71], v10, s[24:27], s35 offen offset:0
    s_sub_u32 s35, s35, 368640
    buffer_load_dwordx4 v[72:75], v10, s[24:27], s35 offen offset:128
    s_add_u32 s35, s35, 40960
    buffer_load_dwordx4 v[76:79], v10, s[24:27], s35 offen offset:128
    s_add_u32 s35, s35, 40960
    buffer_load_dwordx4 v[80:83], v10, s[24:27], s35 offen offset:128
    s_add_u32 s35, s35, 40960
    buffer_load_dwordx4 v[84:87], v10, s[24:27], s35 offen offset:128
    s_add_u32 s35, s35, 40960
    buffer_load_dwordx4 v[88:91], v10, s[24:27], s35 offen offset:128
    s_add_u32 s35, s35, 40960
    buffer_load_dwordx4 v[92:95], v10, s[24:27], s35 offen offset:128
    s_add_u32 s35, s35, 40960
    buffer_load_dwordx4 v[96:99], v10, s[24:27], s35 offen offset:128
    s_add_u32 s35, s35, 40960
    buffer_load_dwordx4 v[100:103], v10, s[24:27], s35 offen offset:128
    s_add_u32 s35, s35, 40960
    buffer_load_dwordx4 v[104:107], v10, s[24:27], s35 offen offset:128
    s_add_u32 s35, s35, 40960
    buffer_load_dwordx4 v[108:111], v10, s[24:27], s35 offen offset:128
    s_lshl_b32 s36, s34, 2
    s_add_u32 s36, s36, s20
    s_mul_i32 s38, s36, 52429
    s_lshr_b32 s38, s38, 18
    s_mul_i32 s39, s38, 5
    s_sub_u32 s39, s36, s39
    s_mul_i32 s37, s38, 100
    s_mul_i32 s40, s33, 50
    s_add_u32 s37, s37, s40
    s_add_u32 s37, s37, s39
    s_lshl_b32 s37, s37, 10
    s_add_u32 s37, s37, 3584000
    s_waitcnt vmcnt(19)
    ds_write_b128 v5, v[32:35] offset:0
    s_waitcnt vmcnt(18)
    ds_write_b128 v5, v[36:39] offset:4608
    s_waitcnt vmcnt(17)
    ds_write_b128 v5, v[40:43] offset:9216
    s_waitcnt vmcnt(16)
    ds_write_b128 v5, v[44:47] offset:13824
    s_waitcnt vmcnt(15)
    ds_write_b128 v5, v[48:51] offset:18432
    s_waitcnt vmcnt(14)
    ds_write_b128 v5, v[52:55] offset:23040
    s_waitcnt vmcnt(13)
    ds_write_b128 v5, v[56:59] offset:27648
    s_waitcnt vmcnt(12)
    ds_write_b128 v5, v[60:63] offset:32256
    s_waitcnt vmcnt(11)
    ds_write_b128 v5, v[64:67] offset:36864
    s_waitcnt vmcnt(10)
    ds_write_b128 v5, v[68:71] offset:41472
    s_waitcnt lgkmcnt(0)
    s_barrier
    ds_read_b64_tr_b16 v[32:33], v8 offset:0
    ds_read_b64_tr_b16 v[34:35], v8 offset:576
    ds_read_b64_tr_b16 v[36:37], v8 offset:4608
    ds_read_b64_tr_b16 v[38:39], v8 offset:5184
    ds_read_b64_tr_b16 v[40:41], v8 offset:9216
    ds_read_b64_tr_b16 v[42:43], v8 offset:9792
    ds_read_b64_tr_b16 v[44:45], v8 offset:13824
    ds_read_b64_tr_b16 v[46:47], v8 offset:14400
    ds_read_b64_tr_b16 v[48:49], v8 offset:18432
    ds_read_b64_tr_b16 v[50:51], v8 offset:19008
    ds_read_b64_tr_b16 v[52:53], v8 offset:23040
    ds_read_b64_tr_b16 v[54:55], v8 offset:23616
    ds_read_b64_tr_b16 v[56:57], v8 offset:27648
    ds_read_b64_tr_b16 v[58:59], v8 offset:28224
    ds_read_b64_tr_b16 v[60:61], v8 offset:32256
    ds_read_b64_tr_b16 v[62:63], v8 offset:32832
    ds_read_b64_tr_b16 v[64:65], v8 offset:36864
    ds_read_b64_tr_b16 v[66:67], v8 offset:37440
    ds_read_b64_tr_b16 v[68:69], v8 offset:41472
    ds_read_b64_tr_b16 v[70:71], v8 offset:42048
    s_waitcnt lgkmcnt(15)
    s_add_u32 s38, s37, 0
    buffer_store_dwordx4 v[32:35], v9, s[28:31], s38 offen sc1
    s_waitcnt lgkmcnt(15)
    s_add_u32 s38, s37, 5120
    buffer_store_dwordx4 v[36:39], v9, s[28:31], s38 offen sc1
    s_waitcnt lgkmcnt(14)
    s_add_u32 s38, s37, 10240
    buffer_store_dwordx4 v[40:43], v9, s[28:31], s38 offen sc1
    s_waitcnt lgkmcnt(12)
    s_add_u32 s38, s37, 15360
    buffer_store_dwordx4 v[44:47], v9, s[28:31], s38 offen sc1
    s_waitcnt lgkmcnt(10)
    s_add_u32 s38, s37, 20480
    buffer_store_dwordx4 v[48:51], v9, s[28:31], s38 offen sc1
    s_waitcnt lgkmcnt(8)
    s_add_u32 s38, s37, 25600
    buffer_store_dwordx4 v[52:55], v9, s[28:31], s38 offen sc1
    s_waitcnt lgkmcnt(6)
    s_add_u32 s38, s37, 30720
    buffer_store_dwordx4 v[56:59], v9, s[28:31], s38 offen sc1
    s_waitcnt lgkmcnt(4)
    s_add_u32 s38, s37, 35840
    buffer_store_dwordx4 v[60:63], v9, s[28:31], s38 offen sc1
    s_waitcnt lgkmcnt(2)
    s_add_u32 s38, s37, 40960
    buffer_store_dwordx4 v[64:67], v9, s[28:31], s38 offen sc1
    s_waitcnt lgkmcnt(0)
    s_add_u32 s38, s37, 46080
    buffer_store_dwordx4 v[68:71], v9, s[28:31], s38 offen sc1
    s_add_u32 s34, s34, 1
    s_barrier
    s_lshl_b32 s36, s34, 2
    s_add_u32 s36, s36, s20
    s_mul_i32 s38, s36, 52429
    s_lshr_b32 s38, s38, 18
    s_mul_i32 s39, s38, 5
    s_sub_u32 s39, s36, s39
    s_mul_i32 s37, s38, 100
    s_mul_i32 s40, s33, 50
    s_add_u32 s37, s37, s40
    s_add_u32 s37, s37, s39
    s_lshl_b32 s37, s37, 10
    s_add_u32 s37, s37, 3584000
    s_waitcnt vmcnt(19)
    ds_write_b128 v5, v[72:75] offset:0
    s_waitcnt vmcnt(18)
    ds_write_b128 v5, v[76:79] offset:4608
    s_waitcnt vmcnt(17)
    ds_write_b128 v5, v[80:83] offset:9216
    s_waitcnt vmcnt(16)
    ds_write_b128 v5, v[84:87] offset:13824
    s_waitcnt vmcnt(15)
    ds_write_b128 v5, v[88:91] offset:18432
    s_waitcnt vmcnt(14)
    ds_write_b128 v5, v[92:95] offset:23040
    s_waitcnt vmcnt(13)
    ds_write_b128 v5, v[96:99] offset:27648
    s_waitcnt vmcnt(12)
    ds_write_b128 v5, v[100:103] offset:32256
    s_waitcnt vmcnt(11)
    ds_write_b128 v5, v[104:107] offset:36864
    s_waitcnt vmcnt(10)
    ds_write_b128 v5, v[108:111] offset:41472
    s_waitcnt lgkmcnt(0)
    s_barrier
    ds_read_b64_tr_b16 v[72:73], v8 offset:0
    ds_read_b64_tr_b16 v[74:75], v8 offset:576
    ds_read_b64_tr_b16 v[76:77], v8 offset:4608
    ds_read_b64_tr_b16 v[78:79], v8 offset:5184
    ds_read_b64_tr_b16 v[80:81], v8 offset:9216
    ds_read_b64_tr_b16 v[82:83], v8 offset:9792
    ds_read_b64_tr_b16 v[84:85], v8 offset:13824
    ds_read_b64_tr_b16 v[86:87], v8 offset:14400
    ds_read_b64_tr_b16 v[88:89], v8 offset:18432
    ds_read_b64_tr_b16 v[90:91], v8 offset:19008
    ds_read_b64_tr_b16 v[92:93], v8 offset:23040
    ds_read_b64_tr_b16 v[94:95], v8 offset:23616
    ds_read_b64_tr_b16 v[96:97], v8 offset:27648
    ds_read_b64_tr_b16 v[98:99], v8 offset:28224
    ds_read_b64_tr_b16 v[100:101], v8 offset:32256
    ds_read_b64_tr_b16 v[102:103], v8 offset:32832
    ds_read_b64_tr_b16 v[104:105], v8 offset:36864
    ds_read_b64_tr_b16 v[106:107], v8 offset:37440
    ds_read_b64_tr_b16 v[108:109], v8 offset:41472
    ds_read_b64_tr_b16 v[110:111], v8 offset:42048
    s_waitcnt lgkmcnt(15)
    s_add_u32 s38, s37, 0
    buffer_store_dwordx4 v[72:75], v9, s[28:31], s38 offen sc1
    s_waitcnt lgkmcnt(15)
    s_add_u32 s38, s37, 5120
    buffer_store_dwordx4 v[76:79], v9, s[28:31], s38 offen sc1
    s_waitcnt lgkmcnt(14)
    s_add_u32 s38, s37, 10240
    buffer_store_dwordx4 v[80:83], v9, s[28:31], s38 offen sc1
    s_waitcnt lgkmcnt(12)
    s_add_u32 s38, s37, 15360
    buffer_store_dwordx4 v[84:87], v9, s[28:31], s38 offen sc1
    s_waitcnt lgkmcnt(10)
    s_add_u32 s38, s37, 20480
    buffer_store_dwordx4 v[88:91], v9, s[28:31], s38 offen sc1
    s_waitcnt lgkmcnt(8)
    s_add_u32 s38, s37, 25600
    buffer_store_dwordx4 v[92:95], v9, s[28:31], s38 offen sc1
    s_waitcnt lgkmcnt(6)
    s_add_u32 s38, s37, 30720
    buffer_store_dwordx4 v[96:99], v9, s[28:31], s38 offen sc1
    s_waitcnt lgkmcnt(4)
    s_add_u32 s38, s37, 35840
    buffer_store_dwordx4 v[100:103], v9, s[28:31], s38 offen sc1
    s_waitcnt lgkmcnt(2)
    s_add_u32 s38, s37, 40960
    buffer_store_dwordx4 v[104:107], v9, s[28:31], s38 offen sc1
    s_waitcnt lgkmcnt(0)
    s_add_u32 s38, s37, 46080
    buffer_store_dwordx4 v[108:111], v9, s[28:31], s38 offen sc1
    s_endpgm
k1_kernel_pk18:
    s_mov_b32 s24, s16
    s_mov_b32 s25, s17
    s_mov_b32 s26, 2211840
    s_mov_b32 s27, 0x00020000
    s_sub_u32 s32, s21, 20
    s_mul_i32 s33, s32, 4682
    s_lshr_b32 s33, s33, 16
    s_mul_i32 s34, s33, 14
    s_sub_u32 s34, s32, s34
    s_lshl_b32 s34, s34, 1
    v_mul_u32_u24 v10, 3456, v3
    v_lshl_add_u32 v10, v4, 4, v10
    s_mul_i32 s35, s33, 1105920
    s_lshl_b32 s36, s34, 7
    s_add_u32 s35, s35, s36
    buffer_load_dwordx4 v[32:35], v10, s[24:27], s35 offen offset:0
    s_add_u32 s35, s35, 110592
    buffer_load_dwordx4 v[36:39], v10, s[24:27], s35 offen offset:0
    s_add_u32 s35, s35, 110592
    buffer_load_dwordx4 v[40:43], v10, s[24:27], s35 offen offset:0
    s_add_u32 s35, s35, 110592
    buffer_load_dwordx4 v[44:47], v10, s[24:27], s35 offen offset:0
    s_add_u32 s35, s35, 110592
    buffer_load_dwordx4 v[48:51], v10, s[24:27], s35 offen offset:0
    s_add_u32 s35, s35, 110592
    buffer_load_dwordx4 v[52:55], v10, s[24:27], s35 offen offset:0
    s_add_u32 s35, s35, 110592
    buffer_load_dwordx4 v[56:59], v10, s[24:27], s35 offen offset:0
    s_add_u32 s35, s35, 110592
    buffer_load_dwordx4 v[60:63], v10, s[24:27], s35 offen offset:0
    s_add_u32 s35, s35, 110592
    buffer_load_dwordx4 v[64:67], v10, s[24:27], s35 offen offset:0
    s_add_u32 s35, s35, 110592
    buffer_load_dwordx4 v[68:71], v10, s[24:27], s35 offen offset:0
    s_sub_u32 s35, s35, 995328
    buffer_load_dwordx4 v[72:75], v10, s[24:27], s35 offen offset:128
    s_add_u32 s35, s35, 110592
    buffer_load_dwordx4 v[76:79], v10, s[24:27], s35 offen offset:128
    s_add_u32 s35, s35, 110592
    buffer_load_dwordx4 v[80:83], v10, s[24:27], s35 offen offset:128
    s_add_u32 s35, s35, 110592
    buffer_load_dwordx4 v[84:87], v10, s[24:27], s35 offen offset:128
    s_add_u32 s35, s35, 110592
    buffer_load_dwordx4 v[88:91], v10, s[24:27], s35 offen offset:128
    s_add_u32 s35, s35, 110592
    buffer_load_dwordx4 v[92:95], v10, s[24:27], s35 offen offset:128
    s_add_u32 s35, s35, 110592
    buffer_load_dwordx4 v[96:99], v10, s[24:27], s35 offen offset:128
    s_add_u32 s35, s35, 110592
    buffer_load_dwordx4 v[100:103], v10, s[24:27], s35 offen offset:128
    s_add_u32 s35, s35, 110592
    buffer_load_dwordx4 v[104:107], v10, s[24:27], s35 offen offset:128
    s_add_u32 s35, s35, 110592
    buffer_load_dwordx4 v[108:111], v10, s[24:27], s35 offen offset:128
    s_lshl_b32 s36, s34, 2
    s_add_u32 s36, s36, s20
    s_mul_i32 s38, s36, 9363
    s_lshr_b32 s38, s38, 16
    s_mul_i32 s39, s38, 7
    s_sub_u32 s39, s36, s39
    s_mul_i32 s37, s38, 140
    s_mul_i32 s40, s33, 70
    s_add_u32 s37, s37, s40
    s_add_u32 s37, s37, s39
    s_lshl_b32 s37, s37, 10
    s_add_u32 s37, s37, 4403200
    s_waitcnt vmcnt(19)
    ds_write_b128 v5, v[32:35] offset:0
    s_waitcnt vmcnt(18)
    ds_write_b128 v5, v[36:39] offset:4608
    s_waitcnt vmcnt(17)
    ds_write_b128 v5, v[40:43] offset:9216
    s_waitcnt vmcnt(16)
    ds_write_b128 v5, v[44:47] offset:13824
    s_waitcnt vmcnt(15)
    ds_write_b128 v5, v[48:51] offset:18432
    s_waitcnt vmcnt(14)
    ds_write_b128 v5, v[52:55] offset:23040
    s_waitcnt vmcnt(13)
    ds_write_b128 v5, v[56:59] offset:27648
    s_waitcnt vmcnt(12)
    ds_write_b128 v5, v[60:63] offset:32256
    s_waitcnt vmcnt(11)
    ds_write_b128 v5, v[64:67] offset:36864
    s_waitcnt vmcnt(10)
    ds_write_b128 v5, v[68:71] offset:41472
    s_waitcnt lgkmcnt(0)
    s_barrier
    ds_read_b64_tr_b16 v[32:33], v8 offset:0
    ds_read_b64_tr_b16 v[34:35], v8 offset:576
    ds_read_b64_tr_b16 v[36:37], v8 offset:4608
    ds_read_b64_tr_b16 v[38:39], v8 offset:5184
    ds_read_b64_tr_b16 v[40:41], v8 offset:9216
    ds_read_b64_tr_b16 v[42:43], v8 offset:9792
    ds_read_b64_tr_b16 v[44:45], v8 offset:13824
    ds_read_b64_tr_b16 v[46:47], v8 offset:14400
    ds_read_b64_tr_b16 v[48:49], v8 offset:18432
    ds_read_b64_tr_b16 v[50:51], v8 offset:19008
    ds_read_b64_tr_b16 v[52:53], v8 offset:23040
    ds_read_b64_tr_b16 v[54:55], v8 offset:23616
    ds_read_b64_tr_b16 v[56:57], v8 offset:27648
    ds_read_b64_tr_b16 v[58:59], v8 offset:28224
    ds_read_b64_tr_b16 v[60:61], v8 offset:32256
    ds_read_b64_tr_b16 v[62:63], v8 offset:32832
    ds_read_b64_tr_b16 v[64:65], v8 offset:36864
    ds_read_b64_tr_b16 v[66:67], v8 offset:37440
    ds_read_b64_tr_b16 v[68:69], v8 offset:41472
    ds_read_b64_tr_b16 v[70:71], v8 offset:42048
    v_mov_b32 v12, 0
    v_mov_b32 v13, 0x3f803f80
    s_waitcnt lgkmcnt(15)
    s_add_u32 s38, s37, 0
    buffer_store_dwordx4 v[32:35], v9, s[28:31], s38 offen sc1
    v_dot2_f32_bf16 v12, v32, v13, v12
    v_dot2_f32_bf16 v12, v33, v13, v12
    v_dot2_f32_bf16 v12, v34, v13, v12
    v_dot2_f32_bf16 v12, v35, v13, v12
    s_waitcnt lgkmcnt(15)
    s_add_u32 s38, s37, 7168
    buffer_store_dwordx4 v[36:39], v9, s[28:31], s38 offen sc1
    v_dot2_f32_bf16 v12, v36, v13, v12
    v_dot2_f32_bf16 v12, v37, v13, v12
    v_dot2_f32_bf16 v12, v38, v13, v12
    v_dot2_f32_bf16 v12, v39, v13, v12
    s_waitcnt lgkmcnt(14)
    s_add_u32 s38, s37, 14336
    buffer_store_dwordx4 v[40:43], v9, s[28:31], s38 offen sc1
    v_dot2_f32_bf16 v12, v40, v13, v12
    v_dot2_f32_bf16 v12, v41, v13, v12
    v_dot2_f32_bf16 v12, v42, v13, v12
    v_dot2_f32_bf16 v12, v43, v13, v12
    s_waitcnt lgkmcnt(12)
    s_add_u32 s38, s37, 21504
    buffer_store_dwordx4 v[44:47], v9, s[28:31], s38 offen sc1
    v_dot2_f32_bf16 v12, v44, v13, v12
    v_dot2_f32_bf16 v12, v45, v13, v12
    v_dot2_f32_bf16 v12, v46, v13, v12
    v_dot2_f32_bf16 v12, v47, v13, v12
    s_waitcnt lgkmcnt(10)
    s_add_u32 s38, s37, 28672
    buffer_store_dwordx4 v[48:51], v9, s[28:31], s38 offen sc1
    v_dot2_f32_bf16 v12, v48, v13, v12
    v_dot2_f32_bf16 v12, v49, v13, v12
    v_dot2_f32_bf16 v12, v50, v13, v12
    v_dot2_f32_bf16 v12, v51, v13, v12
    s_waitcnt lgkmcnt(8)
    s_add_u32 s38, s37, 35840
    buffer_store_dwordx4 v[52:55], v9, s[28:31], s38 offen sc1
    v_dot2_f32_bf16 v12, v52, v13, v12
    v_dot2_f32_bf16 v12, v53, v13, v12
    v_dot2_f32_bf16 v12, v54, v13, v12
    v_dot2_f32_bf16 v12, v55, v13, v12
    s_waitcnt lgkmcnt(6)
    s_add_u32 s38, s37, 43008
    buffer_store_dwordx4 v[56:59], v9, s[28:31], s38 offen sc1
    v_dot2_f32_bf16 v12, v56, v13, v12
    v_dot2_f32_bf16 v12, v57, v13, v12
    v_dot2_f32_bf16 v12, v58, v13, v12
    v_dot2_f32_bf16 v12, v59, v13, v12
    s_waitcnt lgkmcnt(4)
    s_add_u32 s38, s37, 50176
    buffer_store_dwordx4 v[60:63], v9, s[28:31], s38 offen sc1
    v_dot2_f32_bf16 v12, v60, v13, v12
    v_dot2_f32_bf16 v12, v61, v13, v12
    v_dot2_f32_bf16 v12, v62, v13, v12
    v_dot2_f32_bf16 v12, v63, v13, v12
    s_waitcnt lgkmcnt(2)
    s_add_u32 s38, s37, 57344
    buffer_store_dwordx4 v[64:67], v9, s[28:31], s38 offen sc1
    v_dot2_f32_bf16 v12, v64, v13, v12
    v_dot2_f32_bf16 v12, v65, v13, v12
    v_dot2_f32_bf16 v12, v66, v13, v12
    v_dot2_f32_bf16 v12, v67, v13, v12
    s_waitcnt lgkmcnt(0)
    s_add_u32 s38, s37, 64512
    buffer_store_dwordx4 v[68:71], v9, s[28:31], s38 offen sc1
    v_dot2_f32_bf16 v12, v68, v13, v12
    v_dot2_f32_bf16 v12, v69, v13, v12
    v_dot2_f32_bf16 v12, v70, v13, v12
    v_dot2_f32_bf16 v12, v71, v13, v12
    s_nop 2
    v_mov_b32 v13, v12
    s_nop 1
    v_permlane32_swap_b32 v13, v12
    v_add_f32 v12, v12, v13
    v_mov_b32 v13, v12
    s_nop 1
    v_permlane16_swap_b32 v13, v12
    v_add_f32 v12, v12, v13
    s_mul_i32 s38, s33, 7168
    s_lshl_b32 s39, s36, 6
    s_add_u32 s38, s38, s39
    s_add_u32 s38, s38, 2732032
    v_lshlrev_b32 v14, 2, v1
    v_cmp_gt_u32 vcc, 16, v1
    s_and_saveexec_b64 s[40:41], vcc
    buffer_store_dword v12, v14, s[28:31], s38 offen sc1
    s_mov_b64 exec, -1
    s_add_u32 s34, s34, 1
    s_barrier
    s_lshl_b32 s36, s34, 2
    s_add_u32 s36, s36, s20
    s_mul_i32 s38, s36, 9363
    s_lshr_b32 s38, s38, 16
    s_mul_i32 s39, s38, 7
    s_sub_u32 s39, s36, s39
    s_mul_i32 s37, s38, 140
    s_mul_i32 s40, s33, 70
    s_add_u32 s37, s37, s40
    s_add_u32 s37, s37, s39
    s_lshl_b32 s37, s37, 10
    s_add_u32 s37, s37, 4403200
    s_waitcnt vmcnt(20)
    ds_write_b128 v5, v[72:75] offset:0
    s_waitcnt vmcnt(19)
    ds_write_b128 v5, v[76:79] offset:4608
    s_waitcnt vmcnt(18)
    ds_write_b128 v5, v[80:83] offset:9216
    s_waitcnt vmcnt(17)
    ds_write_b128 v5, v[84:87] offset:13824
    s_waitcnt vmcnt(16)
    ds_write_b128 v5, v[88:91] offset:18432
    s_waitcnt vmcnt(15)
    ds_write_b128 v5, v[92:95] offset:23040
    s_waitcnt vmcnt(14)
    ds_write_b128 v5, v[96:99] offset:27648
    s_waitcnt vmcnt(13)
    ds_write_b128 v5, v[100:103] offset:32256
    s_waitcnt vmcnt(12)
    ds_write_b128 v5, v[104:107] offset:36864
    s_waitcnt vmcnt(11)
    ds_write_b128 v5, v[108:111] offset:41472
    s_waitcnt lgkmcnt(0)
    s_barrier
    ds_read_b64_tr_b16 v[72:73], v8 offset:0
    ds_read_b64_tr_b16 v[74:75], v8 offset:576
    ds_read_b64_tr_b16 v[76:77], v8 offset:4608
    ds_read_b64_tr_b16 v[78:79], v8 offset:5184
    ds_read_b64_tr_b16 v[80:81], v8 offset:9216
    ds_read_b64_tr_b16 v[82:83], v8 offset:9792
    ds_read_b64_tr_b16 v[84:85], v8 offset:13824
    ds_read_b64_tr_b16 v[86:87], v8 offset:14400
    ds_read_b64_tr_b16 v[88:89], v8 offset:18432
    ds_read_b64_tr_b16 v[90:91], v8 offset:19008
    ds_read_b64_tr_b16 v[92:93], v8 offset:23040
    ds_read_b64_tr_b16 v[94:95], v8 offset:23616
    ds_read_b64_tr_b16 v[96:97], v8 offset:27648
    ds_read_b64_tr_b16 v[98:99], v8 offset:28224
    ds_read_b64_tr_b16 v[100:101], v8 offset:32256
    ds_read_b64_tr_b16 v[102:103], v8 offset:32832
    ds_read_b64_tr_b16 v[104:105], v8 offset:36864
    ds_read_b64_tr_b16 v[106:107], v8 offset:37440
    ds_read_b64_tr_b16 v[108:109], v8 offset:41472
    ds_read_b64_tr_b16 v[110:111], v8 offset:42048
    v_mov_b32 v12, 0
    v_mov_b32 v13, 0x3f803f80
    s_waitcnt lgkmcnt(15)
    s_add_u32 s38, s37, 0
    buffer_store_dwordx4 v[72:75], v9, s[28:31], s38 offen sc1
    v_dot2_f32_bf16 v12, v72, v13, v12
    v_dot2_f32_bf16 v12, v73, v13, v12
    v_dot2_f32_bf16 v12, v74, v13, v12
    v_dot2_f32_bf16 v12, v75, v13, v12
    s_waitcnt lgkmcnt(15)
    s_add_u32 s38, s37, 7168
    buffer_store_dwordx4 v[76:79], v9, s[28:31], s38 offen sc1
    v_dot2_f32_bf16 v12, v76, v13, v12
    v_dot2_f32_bf16 v12, v77, v13, v12
    v_dot2_f32_bf16 v12, v78, v13, v12
    v_dot2_f32_bf16 v12, v79, v13, v12
    s_waitcnt lgkmcnt(14)
    s_add_u32 s38, s37, 14336
    buffer_store_dwordx4 v[80:83], v9, s[28:31], s38 offen sc1
    v_dot2_f32_bf16 v12, v80, v13, v12
    v_dot2_f32_bf16 v12, v81, v13, v12
    v_dot2_f32_bf16 v12, v82, v13, v12
    v_dot2_f32_bf16 v12, v83, v13, v12
    s_waitcnt lgkmcnt(12)
    s_add_u32 s38, s37, 21504
    buffer_store_dwordx4 v[84:87], v9, s[28:31], s38 offen sc1
    v_dot2_f32_bf16 v12, v84, v13, v12
    v_dot2_f32_bf16 v12, v85, v13, v12
    v_dot2_f32_bf16 v12, v86, v13, v12
    v_dot2_f32_bf16 v12, v87, v13, v12
    s_waitcnt lgkmcnt(10)
    s_add_u32 s38, s37, 28672
    buffer_store_dwordx4 v[88:91], v9, s[28:31], s38 offen sc1
    v_dot2_f32_bf16 v12, v88, v13, v12
    v_dot2_f32_bf16 v12, v89, v13, v12
    v_dot2_f32_bf16 v12, v90, v13, v12
    v_dot2_f32_bf16 v12, v91, v13, v12
    s_waitcnt lgkmcnt(8)
    s_add_u32 s38, s37, 35840
    buffer_store_dwordx4 v[92:95], v9, s[28:31], s38 offen sc1
    v_dot2_f32_bf16 v12, v92, v13, v12
    v_dot2_f32_bf16 v12, v93, v13, v12
    v_dot2_f32_bf16 v12, v94, v13, v12
    v_dot2_f32_bf16 v12, v95, v13, v12
    s_waitcnt lgkmcnt(6)
    s_add_u32 s38, s37, 43008
    buffer_store_dwordx4 v[96:99], v9, s[28:31], s38 offen sc1
    v_dot2_f32_bf16 v12, v96, v13, v12
    v_dot2_f32_bf16 v12, v97, v13, v12
    v_dot2_f32_bf16 v12, v98, v13, v12
    v_dot2_f32_bf16 v12, v99, v13, v12
    s_waitcnt lgkmcnt(4)
    s_add_u32 s38, s37, 50176
    buffer_store_dwordx4 v[100:103], v9, s[28:31], s38 offen sc1
    v_dot2_f32_bf16 v12, v100, v13, v12
    v_dot2_f32_bf16 v12, v101, v13, v12
    v_dot2_f32_bf16 v12, v102, v13, v12
    v_dot2_f32_bf16 v12, v103, v13, v12
    s_waitcnt lgkmcnt(2)
    s_add_u32 s38, s37, 57344
    buffer_store_dwordx4 v[104:107], v9, s[28:31], s38 offen sc1
    v_dot2_f32_bf16 v12, v104, v13, v12
    v_dot2_f32_bf16 v12, v105, v13, v12
    v_dot2_f32_bf16 v12, v106, v13, v12
    v_dot2_f32_bf16 v12, v107, v13, v12
    s_waitcnt lgkmcnt(0)
    s_add_u32 s38, s37, 64512
    buffer_store_dwordx4 v[108:111], v9, s[28:31], s38 offen sc1
    v_dot2_f32_bf16 v12, v108, v13, v12
    v_dot2_f32_bf16 v12, v109, v13, v12
    v_dot2_f32_bf16 v12, v110, v13, v12
    v_dot2_f32_bf16 v12, v111, v13, v12
    s_nop 2
    v_mov_b32 v13, v12
    s_nop 1
    v_permlane32_swap_b32 v13, v12
    v_add_f32 v12, v12, v13
    v_mov_b32 v13, v12
    s_nop 1
    v_permlane16_swap_b32 v13, v12
    v_add_f32 v12, v12, v13
    s_mul_i32 s38, s33, 7168
    s_lshl_b32 s39, s36, 6
    s_add_u32 s38, s38, s39
    s_add_u32 s38, s38, 2732032
    v_lshlrev_b32 v14, 2, v1
    v_cmp_gt_u32 vcc, 16, v1
    s_and_saveexec_b64 s[40:41], vcc
    buffer_store_dword v12, v14, s[28:31], s38 offen sc1
    s_mov_b64 exec, -1
    s_endpgm
k1_kernel_pk19:
    s_mov_b32 s24, s18
    s_mov_b32 s25, s19
    s_mov_b32 s26, 2211840
    s_mov_b32 s27, 0x00020000
    s_sub_u32 s32, s21, 48
    s_mul_i32 s33, s32, 52429
    s_lshr_b32 s33, s33, 18
    s_mul_i32 s34, s33, 5
    s_sub_u32 s34, s32, s34
    s_lshl_b32 s34, s34, 1
    v_mul_u32_u24 v10, 1280, v3
    v_lshl_add_u32 v10, v4, 4, v10
    s_mul_i32 s35, s33, 368640
    s_lshl_b32 s36, s34, 7
    s_add_u32 s35, s35, s36
    buffer_load_dwordx4 v[32:35], v10, s[24:27], s35 offen offset:0
    s_add_u32 s35, s35, 40960
    buffer_load_dwordx4 v[36:39], v10, s[24:27], s35 offen offset:0
    s_add_u32 s35, s35, 40960
    buffer_load_dwordx4 v[40:43], v10, s[24:27], s35 offen offset:0
    s_add_u32 s35, s35, 40960
    buffer_load_dwordx4 v[44:47], v10, s[24:27], s35 offen offset:0
    s_add_u32 s35, s35, 40960
    buffer_load_dwordx4 v[48:51], v10, s[24:27], s35 offen offset:0
    s_add_u32 s35, s35, 40960
    buffer_load_dwordx4 v[52:55], v10, s[24:27], s35 offen offset:0
    s_add_u32 s35, s35, 40960
    buffer_load_dwordx4 v[56:59], v10, s[24:27], s35 offen offset:0
    s_add_u32 s35, s35, 40960
    buffer_load_dwordx4 v[60:63], v10, s[24:27], s35 offen offset:0
    s_add_u32 s35, s35, 40960
    buffer_load_dwordx4 v[64:67], v10, s[24:27], s35 offen offset:0
    s_sub_u32 s35, s35, 327680
    buffer_load_dwordx4 v[72:75], v10, s[24:27], s35 offen offset:128
    s_add_u32 s35, s35, 40960
    buffer_load_dwordx4 v[76:79], v10, s[24:27], s35 offen offset:128
    s_add_u32 s35, s35, 40960
    buffer_load_dwordx4 v[80:83], v10, s[24:27], s35 offen offset:128
    s_add_u32 s35, s35, 40960
    buffer_load_dwordx4 v[84:87], v10, s[24:27], s35 offen offset:128
    s_add_u32 s35, s35, 40960
    buffer_load_dwordx4 v[88:91], v10, s[24:27], s35 offen offset:128
    s_add_u32 s35, s35, 40960
    buffer_load_dwordx4 v[92:95], v10, s[24:27], s35 offen offset:128
    s_add_u32 s35, s35, 40960
    buffer_load_dwordx4 v[96:99], v10, s[24:27], s35 offen offset:128
    s_add_u32 s35, s35, 40960
    buffer_load_dwordx4 v[100:103], v10, s[24:27], s35 offen offset:128
    s_add_u32 s35, s35, 40960
    buffer_load_dwordx4 v[104:107], v10, s[24:27], s35 offen offset:128
    s_lshl_b32 s36, s34, 2
    s_add_u32 s36, s36, s20
    s_mul_i32 s38, s36, 52429
    s_lshr_b32 s38, s38, 18
    s_mul_i32 s39, s38, 5
    s_sub_u32 s39, s36, s39
    s_mul_i32 s37, s38, 280
    s_mul_i32 s40, s33, 45
    s_add_u32 s37, s37, s40
    s_add_u32 s37, s37, s39
    s_lshl_b32 s37, s37, 10
    s_add_u32 s37, s37, 6696960
    s_waitcnt vmcnt(17)
    ds_write_b128 v5, v[32:35] offset:0
    s_waitcnt vmcnt(16)
    ds_write_b128 v5, v[36:39] offset:4608
    s_waitcnt vmcnt(15)
    ds_write_b128 v5, v[40:43] offset:9216
    s_waitcnt vmcnt(14)
    ds_write_b128 v5, v[44:47] offset:13824
    s_waitcnt vmcnt(13)
    ds_write_b128 v5, v[48:51] offset:18432
    s_waitcnt vmcnt(12)
    ds_write_b128 v5, v[52:55] offset:23040
    s_waitcnt vmcnt(11)
    ds_write_b128 v5, v[56:59] offset:27648
    s_waitcnt vmcnt(10)
    ds_write_b128 v5, v[60:63] offset:32256
    s_waitcnt vmcnt(9)
    ds_write_b128 v5, v[64:67] offset:36864
    s_waitcnt lgkmcnt(0)
    s_barrier
    ds_read_b64_tr_b16 v[32:33], v8 offset:0
    ds_read_b64_tr_b16 v[34:35], v8 offset:576
    ds_read_b64_tr_b16 v[36:37], v8 offset:4608
    ds_read_b64_tr_b16 v[38:39], v8 offset:5184
    ds_read_b64_tr_b16 v[40:41], v8 offset:9216
    ds_read_b64_tr_b16 v[42:43], v8 offset:9792
    ds_read_b64_tr_b16 v[44:45], v8 offset:13824
    ds_read_b64_tr_b16 v[46:47], v8 offset:14400
    ds_read_b64_tr_b16 v[48:49], v8 offset:18432
    ds_read_b64_tr_b16 v[50:51], v8 offset:19008
    ds_read_b64_tr_b16 v[52:53], v8 offset:23040
    ds_read_b64_tr_b16 v[54:55], v8 offset:23616
    ds_read_b64_tr_b16 v[56:57], v8 offset:27648
    ds_read_b64_tr_b16 v[58:59], v8 offset:28224
    ds_read_b64_tr_b16 v[60:61], v8 offset:32256
    ds_read_b64_tr_b16 v[62:63], v8 offset:32832
    ds_read_b64_tr_b16 v[64:65], v8 offset:36864
    ds_read_b64_tr_b16 v[66:67], v8 offset:37440
    s_waitcnt lgkmcnt(15)
    s_add_u32 s38, s37, 0
    buffer_store_dwordx4 v[32:35], v9, s[28:31], s38 offen sc1
    s_waitcnt lgkmcnt(14)
    s_add_u32 s38, s37, 5120
    buffer_store_dwordx4 v[36:39], v9, s[28:31], s38 offen sc1
    s_waitcnt lgkmcnt(12)
    s_add_u32 s38, s37, 10240
    buffer_store_dwordx4 v[40:43], v9, s[28:31], s38 offen sc1
    s_waitcnt lgkmcnt(10)
    s_add_u32 s38, s37, 15360
    buffer_store_dwordx4 v[44:47], v9, s[28:31], s38 offen sc1
    s_waitcnt lgkmcnt(8)
    s_add_u32 s38, s37, 20480
    buffer_store_dwordx4 v[48:51], v9, s[28:31], s38 offen sc1
    s_waitcnt lgkmcnt(6)
    s_add_u32 s38, s37, 25600
    buffer_store_dwordx4 v[52:55], v9, s[28:31], s38 offen sc1
    s_waitcnt lgkmcnt(4)
    s_add_u32 s38, s37, 30720
    buffer_store_dwordx4 v[56:59], v9, s[28:31], s38 offen sc1
    s_waitcnt lgkmcnt(2)
    s_add_u32 s38, s37, 35840
    buffer_store_dwordx4 v[60:63], v9, s[28:31], s38 offen sc1
    s_waitcnt lgkmcnt(0)
    s_add_u32 s38, s37, 40960
    buffer_store_dwordx4 v[64:67], v9, s[28:31], s38 offen sc1
    s_add_u32 s34, s34, 1
    s_barrier
    s_lshl_b32 s36, s34, 2
    s_add_u32 s36, s36, s20
    s_mul_i32 s38, s36, 52429
    s_lshr_b32 s38, s38, 18
    s_mul_i32 s39, s38, 5
    s_sub_u32 s39, s36, s39
    s_mul_i32 s37, s38, 280
    s_mul_i32 s40, s33, 45
    s_add_u32 s37, s37, s40
    s_add_u32 s37, s37, s39
    s_lshl_b32 s37, s37, 10
    s_add_u32 s37, s37, 6696960
    s_waitcnt vmcnt(17)
    ds_write_b128 v5, v[72:75] offset:0
    s_waitcnt vmcnt(16)
    ds_write_b128 v5, v[76:79] offset:4608
    s_waitcnt vmcnt(15)
    ds_write_b128 v5, v[80:83] offset:9216
    s_waitcnt vmcnt(14)
    ds_write_b128 v5, v[84:87] offset:13824
    s_waitcnt vmcnt(13)
    ds_write_b128 v5, v[88:91] offset:18432
    s_waitcnt vmcnt(12)
    ds_write_b128 v5, v[92:95] offset:23040
    s_waitcnt vmcnt(11)
    ds_write_b128 v5, v[96:99] offset:27648
    s_waitcnt vmcnt(10)
    ds_write_b128 v5, v[100:103] offset:32256
    s_waitcnt vmcnt(9)
    ds_write_b128 v5, v[104:107] offset:36864
    s_waitcnt lgkmcnt(0)
    s_barrier
    ds_read_b64_tr_b16 v[72:73], v8 offset:0
    ds_read_b64_tr_b16 v[74:75], v8 offset:576
    ds_read_b64_tr_b16 v[76:77], v8 offset:4608
    ds_read_b64_tr_b16 v[78:79], v8 offset:5184
    ds_read_b64_tr_b16 v[80:81], v8 offset:9216
    ds_read_b64_tr_b16 v[82:83], v8 offset:9792
    ds_read_b64_tr_b16 v[84:85], v8 offset:13824
    ds_read_b64_tr_b16 v[86:87], v8 offset:14400
    ds_read_b64_tr_b16 v[88:89], v8 offset:18432
    ds_read_b64_tr_b16 v[90:91], v8 offset:19008
    ds_read_b64_tr_b16 v[92:93], v8 offset:23040
    ds_read_b64_tr_b16 v[94:95], v8 offset:23616
    ds_read_b64_tr_b16 v[96:97], v8 offset:27648
    ds_read_b64_tr_b16 v[98:99], v8 offset:28224
    ds_read_b64_tr_b16 v[100:101], v8 offset:32256
    ds_read_b64_tr_b16 v[102:103], v8 offset:32832
    ds_read_b64_tr_b16 v[104:105], v8 offset:36864
    ds_read_b64_tr_b16 v[106:107], v8 offset:37440
    s_waitcnt lgkmcnt(15)
    s_add_u32 s38, s37, 0
    buffer_store_dwordx4 v[72:75], v9, s[28:31], s38 offen sc1
    s_waitcnt lgkmcnt(14)
    s_add_u32 s38, s37, 5120
    buffer_store_dwordx4 v[76:79], v9, s[28:31], s38 offen sc1
    s_waitcnt lgkmcnt(12)
    s_add_u32 s38, s37, 10240
    buffer_store_dwordx4 v[80:83], v9, s[28:31], s38 offen sc1
    s_waitcnt lgkmcnt(10)
    s_add_u32 s38, s37, 15360
    buffer_store_dwordx4 v[84:87], v9, s[28:31], s38 offen sc1
    s_waitcnt lgkmcnt(8)
    s_add_u32 s38, s37, 20480
    buffer_store_dwordx4 v[88:91], v9, s[28:31], s38 offen sc1
    s_waitcnt lgkmcnt(6)
    s_add_u32 s38, s37, 25600
    buffer_store_dwordx4 v[92:95], v9, s[28:31], s38 offen sc1
    s_waitcnt lgkmcnt(4)
    s_add_u32 s38, s37, 30720
    buffer_store_dwordx4 v[96:99], v9, s[28:31], s38 offen sc1
    s_waitcnt lgkmcnt(2)
    s_add_u32 s38, s37, 35840
    buffer_store_dwordx4 v[100:103], v9, s[28:31], s38 offen sc1
    s_waitcnt lgkmcnt(0)
    s_add_u32 s38, s37, 40960
    buffer_store_dwordx4 v[104:107], v9, s[28:31], s38 offen sc1
    s_endpgm
k1_kernel_pke20:
    s_endpgm
k1_mod0:
    s_sub_u32 s54, s54, 128
    s_waitcnt lgkmcnt(0)
    s_mov_b32 s28, s10
    s_mov_b32 s29, s11
    s_mov_b32 s30, 268435456
    s_mov_b32 s31, 0x00020000
k1_modf:
    s_load_dwordx4 s[12:15], s[0:1], 88
    s_mov_b32 s32, s54
    v_and_b32 v3, 7, v0
    v_lshrrev_b32 v4, 3, v0
    v_lshlrev_b32 v5, 1, v4
    v_mul_u32_u24 v6, 7680, v4
    s_lshl_b32 s36, s32, 7
    v_lshl_add_u32 v7, v3, 4, s36
    v_add_u32 v6, v6, v7
    s_waitcnt lgkmcnt(0)
    s_mov_b32 s16, s12
    s_mov_b32 s17, s13
    s_mov_b32 s18, 1280
    s_mov_b32 s19, 0x00020000
    s_mov_b32 s20, s14
    s_mov_b32 s21, s15
    s_mov_b32 s22, 4915200
    s_mov_b32 s23, 0x00020000
    buffer_load_ushort v10, v5, s[16:19], 0 offen offset:0
    buffer_load_ushort v11, v5, s[16:19], 0 offen offset:64
    buffer_load_ushort v12, v5, s[16:19], 0 offen offset:128
    buffer_load_ushort v13, v5, s[16:19], 0 offen offset:192
    buffer_load_ushort v14, v5, s[16:19], 0 offen offset:256
    buffer_load_ushort v15, v5, s[16:19], 0 offen offset:320
    buffer_load_ushort v16, v5, s[16:19], 0 offen offset:384
    buffer_load_ushort v17, v5, s[16:19], 0 offen offset:448
    buffer_load_ushort v18, v5, s[16:19], 0 offen offset:512
    buffer_load_ushort v19, v5, s[16:19], 0 offen offset:576
    buffer_load_ushort v20, v5, s[16:19], 0 offen offset:640
    buffer_load_ushort v21, v5, s[16:19], 0 offen offset:704
    buffer_load_ushort v22, v5, s[16:19], 0 offen offset:768
    buffer_load_ushort v23, v5, s[16:19], 0 offen offset:832
    buffer_load_ushort v24, v5, s[16:19], 0 offen offset:896
    buffer_load_ushort v25, v5, s[16:19], 0 offen offset:960
    buffer_load_ushort v26, v5, s[16:19], 0 offen offset:1024
    buffer_load_ushort v27, v5, s[16:19], 0 offen offset:1088
    buffer_load_ushort v28, v5, s[16:19], 0 offen offset:1152
    buffer_load_ushort v29, v5, s[16:19], 0 offen offset:1216
    s_mov_b32 s37, 0
    buffer_load_dwordx4 v[32:35], v6, s[20:23], s37 offen
    s_mov_b32 s37, 245760
    buffer_load_dwordx4 v[36:39], v6, s[20:23], s37 offen
    s_mov_b32 s37, 491520
    buffer_load_dwordx4 v[40:43], v6, s[20:23], s37 offen
    s_mov_b32 s37, 737280
    buffer_load_dwordx4 v[44:47], v6, s[20:23], s37 offen
    s_mov_b32 s37, 983040
    buffer_load_dwordx4 v[48:51], v6, s[20:23], s37 offen
    s_mov_b32 s37, 1228800
    buffer_load_dwordx4 v[52:55], v6, s[20:23], s37 offen
    s_mov_b32 s37, 1474560
    buffer_load_dwordx4 v[56:59], v6, s[20:23], s37 offen
    s_mov_b32 s37, 1720320
    buffer_load_dwordx4 v[60:63], v6, s[20:23], s37 offen
    s_mov_b32 s37, 1966080
    buffer_load_dwordx4 v[64:67], v6, s[20:23], s37 offen
    s_mov_b32 s37, 2211840
    buffer_load_dwordx4 v[68:71], v6, s[20:23], s37 offen
    s_mov_b32 s37, 2457600
    buffer_load_dwordx4 v[72:75], v6, s[20:23], s37 offen
    s_mov_b32 s37, 2703360
    buffer_load_dwordx4 v[76:79], v6, s[20:23], s37 offen
    s_mov_b32 s37, 2949120
    buffer_load_dwordx4 v[80:83], v6, s[20:23], s37 offen
    s_mov_b32 s37, 3194880
    buffer_load_dwordx4 v[84:87], v6, s[20:23], s37 offen
    s_mov_b32 s37, 3440640
    buffer_load_dwordx4 v[88:91], v6, s[20:23], s37 offen
    s_mov_b32 s37, 3686400
    buffer_load_dwordx4 v[92:95], v6, s[20:23], s37 offen
    s_mov_b32 s37, 3932160
    buffer_load_dwordx4 v[96:99], v6, s[20:23], s37 offen
    s_mov_b32 s37, 4177920
    buffer_load_dwordx4 v[100:103], v6, s[20:23], s37 offen
    s_mov_b32 s37, 4423680
    buffer_load_dwordx4 v[104:107], v6, s[20:23], s37 offen
    s_mov_b32 s37, 4669440
    buffer_load_dwordx4 v[108:111], v6, s[20:23], s37 offen
    s_waitcnt vmcnt(20)
    v_lshlrev_b32 v10, 16, v10
    v_mul_f32 v120, 0xbfb8aa3b, v10
    v_exp_f32 v120, v120
    v_lshlrev_b32 v11, 16, v11
    v_mul_f32 v121, 0xbfb8aa3b, v11
    v_exp_f32 v121, v121
    v_lshlrev_b32 v12, 16, v12
    v_mul_f32 v122, 0xbfb8aa3b, v12
    v_exp_f32 v122, v122
    v_lshlrev_b32 v13, 16, v13
    v_mul_f32 v123, 0xbfb8aa3b, v13
    v_exp_f32 v123, v123
    v_lshlrev_b32 v14, 16, v14
    v_mul_f32 v124, 0xbfb8aa3b, v14
    v_exp_f32 v124, v124
    v_lshlrev_b32 v15, 16, v15
    v_mul_f32 v125, 0xbfb8aa3b, v15
    v_exp_f32 v125, v125
    v_lshlrev_b32 v16, 16, v16
    v_mul_f32 v126, 0xbfb8aa3b, v16
    v_exp_f32 v126, v126
    v_lshlrev_b32 v17, 16, v17
    v_mul_f32 v127, 0xbfb8aa3b, v17
    v_exp_f32 v127, v127
    v_lshlrev_b32 v18, 16, v18
    v_mul_f32 v128, 0xbfb8aa3b, v18
    v_exp_f32 v128, v128
    v_lshlrev_b32 v19, 16, v19
    v_mul_f32 v129, 0xbfb8aa3b, v19
    v_exp_f32 v129, v129
    v_lshlrev_b32 v20, 16, v20
    v_mul_f32 v130, 0xbfb8aa3b, v20
    v_exp_f32 v130, v130
    v_lshlrev_b32 v21, 16, v21
    v_mul_f32 v131, 0xbfb8aa3b, v21
    v_exp_f32 v131, v131
    v_lshlrev_b32 v22, 16, v22
    v_mul_f32 v132, 0xbfb8aa3b, v22
    v_exp_f32 v132, v132
    v_lshlrev_b32 v23, 16, v23
    v_mul_f32 v133, 0xbfb8aa3b, v23
    v_exp_f32 v133, v133
    v_lshlrev_b32 v24, 16, v24
    v_mul_f32 v134, 0xbfb8aa3b, v24
    v_exp_f32 v134, v134
    v_lshlrev_b32 v25, 16, v25
    v_mul_f32 v135, 0xbfb8aa3b, v25
    v_exp_f32 v135, v135
    v_lshlrev_b32 v26, 16, v26
    v_mul_f32 v136, 0xbfb8aa3b, v26
    v_exp_f32 v136, v136
    v_lshlrev_b32 v27, 16, v27
    v_mul_f32 v137, 0xbfb8aa3b, v27
    v_exp_f32 v137, v137
    v_lshlrev_b32 v28, 16, v28
    v_mul_f32 v138, 0xbfb8aa3b, v28
    v_exp_f32 v138, v138
    v_lshlrev_b32 v29, 16, v29
    v_mul_f32 v139, 0xbfb8aa3b, v29
    v_exp_f32 v139, v139
    v_add_f32 v120, 1.0, v120
    v_rcp_f32 v120, v120
    v_add_f32 v121, 1.0, v121
    v_rcp_f32 v121, v121
    v_add_f32 v122, 1.0, v122
    v_rcp_f32 v122, v122
    v_add_f32 v123, 1.0, v123
    v_rcp_f32 v123, v123
    v_add_f32 v124, 1.0, v124
    v_rcp_f32 v124, v124
    v_add_f32 v125, 1.0, v125
    v_rcp_f32 v125, v125
    v_add_f32 v126, 1.0, v126
    v_rcp_f32 v126, v126
    v_add_f32 v127, 1.0, v127
    v_rcp_f32 v127, v127
    v_add_f32 v128, 1.0, v128
    v_rcp_f32 v128, v128
    v_add_f32 v129, 1.0, v129
    v_rcp_f32 v129, v129
    v_add_f32 v130, 1.0, v130
    v_rcp_f32 v130, v130
    v_add_f32 v131, 1.0, v131
    v_rcp_f32 v131, v131
    v_add_f32 v132, 1.0, v132
    v_rcp_f32 v132, v132
    v_add_f32 v133, 1.0, v133
    v_rcp_f32 v133, v133
    v_add_f32 v134, 1.0, v134
    v_rcp_f32 v134, v134
    v_add_f32 v135, 1.0, v135
    v_rcp_f32 v135, v135
    v_add_f32 v136, 1.0, v136
    v_rcp_f32 v136, v136
    v_add_f32 v137, 1.0, v137
    v_rcp_f32 v137, v137
    v_add_f32 v138, 1.0, v138
    v_rcp_f32 v138, v138
    v_add_f32 v139, 1.0, v139
    v_rcp_f32 v139, v139
    s_nop 0
    v_mul_f32 v10, v10, v120
    v_mul_f32 v11, v11, v121
    v_mul_f32 v12, v12, v122
    v_mul_f32 v13, v13, v123
    v_mul_f32 v14, v14, v124
    v_mul_f32 v15, v15, v125
    v_mul_f32 v16, v16, v126
    v_mul_f32 v17, v17, v127
    v_mul_f32 v18, v18, v128
    v_mul_f32 v19, v19, v129
    v_mul_f32 v20, v20, v130
    v_mul_f32 v21, v21, v131
    v_mul_f32 v22, v22, v132
    v_mul_f32 v23, v23, v133
    v_mul_f32 v24, v24, v134
    v_mul_f32 v25, v25, v135
    v_mul_f32 v26, v26, v136
    v_mul_f32 v27, v27, v137
    v_mul_f32 v28, v28, v138
    v_mul_f32 v29, v29, v139
    v_cvt_pk_bf16_f32 v120, v10, v11
    v_lshlrev_b32 v10, 16, v120
    v_and_b32 v11, 0xffff0000, v120
    v_cvt_pk_bf16_f32 v120, v12, v13
    v_lshlrev_b32 v12, 16, v120
    v_and_b32 v13, 0xffff0000, v120
    v_cvt_pk_bf16_f32 v120, v14, v15
    v_lshlrev_b32 v14, 16, v120
    v_and_b32 v15, 0xffff0000, v120
    v_cvt_pk_bf16_f32 v120, v16, v17
    v_lshlrev_b32 v16, 16, v120
    v_and_b32 v17, 0xffff0000, v120
    v_cvt_pk_bf16_f32 v120, v18, v19
    v_lshlrev_b32 v18, 16, v120
    v_and_b32 v19, 0xffff0000, v120
    v_cvt_pk_bf16_f32 v120, v20, v21
    v_lshlrev_b32 v20, 16, v120
    v_and_b32 v21, 0xffff0000, v120
    v_cvt_pk_bf16_f32 v120, v22, v23
    v_lshlrev_b32 v22, 16, v120
    v_and_b32 v23, 0xffff0000, v120
    v_cvt_pk_bf16_f32 v120, v24, v25
    v_lshlrev_b32 v24, 16, v120
    v_and_b32 v25, 0xffff0000, v120
    v_cvt_pk_bf16_f32 v120, v26, v27
    v_lshlrev_b32 v26, 16, v120
    v_and_b32 v27, 0xffff0000, v120
    v_cvt_pk_bf16_f32 v120, v28, v29
    v_lshlrev_b32 v28, 16, v120
    v_and_b32 v29, 0xffff0000, v120
    v_mov_b32 v112, 0
    v_mov_b32 v113, 0
    v_mov_b32 v114, 0
    v_mov_b32 v115, 0
    v_mov_b32 v116, 0
    v_mov_b32 v117, 0
    v_mov_b32 v118, 0
    v_mov_b32 v119, 0
    s_waitcnt vmcnt(19)
    v_lshlrev_b32 v120, 16, v32
    v_and_b32 v121, 0xffff0000, v32
    v_lshlrev_b32 v122, 16, v33
    v_and_b32 v123, 0xffff0000, v33
    v_lshlrev_b32 v124, 16, v34
    v_and_b32 v125, 0xffff0000, v34
    v_lshlrev_b32 v126, 16, v35
    v_and_b32 v127, 0xffff0000, v35
    v_pk_fma_f32 v[112:113], v[120:121], v[10:11], v[112:113] op_sel:[0,0,0] op_sel_hi:[1,0,1]
    v_pk_fma_f32 v[114:115], v[122:123], v[10:11], v[114:115] op_sel:[0,0,0] op_sel_hi:[1,0,1]
    v_pk_fma_f32 v[116:117], v[124:125], v[10:11], v[116:117] op_sel:[0,0,0] op_sel_hi:[1,0,1]
    v_pk_fma_f32 v[118:119], v[126:127], v[10:11], v[118:119] op_sel:[0,0,0] op_sel_hi:[1,0,1]
    s_waitcnt vmcnt(18)
    v_lshlrev_b32 v120, 16, v36
    v_and_b32 v121, 0xffff0000, v36
    v_lshlrev_b32 v122, 16, v37
    v_and_b32 v123, 0xffff0000, v37
    v_lshlrev_b32 v124, 16, v38
    v_and_b32 v125, 0xffff0000, v38
    v_lshlrev_b32 v126, 16, v39
    v_and_b32 v127, 0xffff0000, v39
    v_pk_fma_f32 v[112:113], v[120:121], v[10:11], v[112:113] op_sel:[0,1,0] op_sel_hi:[1,1,1]
    v_pk_fma_f32 v[114:115], v[122:123], v[10:11], v[114:115] op_sel:[0,1,0] op_sel_hi:[1,1,1]
    v_pk_fma_f32 v[116:117], v[124:125], v[10:11], v[116:117] op_sel:[0,1,0] op_sel_hi:[1,1,1]
    v_pk_fma_f32 v[118:119], v[126:127], v[10:11], v[118:119] op_sel:[0,1,0] op_sel_hi:[1,1,1]
    s_waitcnt vmcnt(17)
    v_lshlrev_b32 v120, 16, v40
    v_and_b32 v121, 0xffff0000, v40
    v_lshlrev_b32 v122, 16, v41
    v_and_b32 v123, 0xffff0000, v41
    v_lshlrev_b32 v124, 16, v42
    v_and_b32 v125, 0xffff0000, v42
    v_lshlrev_b32 v126, 16, v43
    v_and_b32 v127, 0xffff0000, v43
    v_pk_fma_f32 v[112:113], v[120:121], v[12:13], v[112:113] op_sel:[0,0,0] op_sel_hi:[1,0,1]
    v_pk_fma_f32 v[114:115], v[122:123], v[12:13], v[114:115] op_sel:[0,0,0] op_sel_hi:[1,0,1]
    v_pk_fma_f32 v[116:117], v[124:125], v[12:13], v[116:117] op_sel:[0,0,0] op_sel_hi:[1,0,1]
    v_pk_fma_f32 v[118:119], v[126:127], v[12:13], v[118:119] op_sel:[0,0,0] op_sel_hi:[1,0,1]
    s_waitcnt vmcnt(16)
    v_lshlrev_b32 v120, 16, v44
    v_and_b32 v121, 0xffff0000, v44
    v_lshlrev_b32 v122, 16, v45
    v_and_b32 v123, 0xffff0000, v45
    v_lshlrev_b32 v124, 16, v46
    v_and_b32 v125, 0xffff0000, v46
    v_lshlrev_b32 v126, 16, v47
    v_and_b32 v127, 0xffff0000, v47
    v_pk_fma_f32 v[112:113], v[120:121], v[12:13], v[112:113] op_sel:[0,1,0] op_sel_hi:[1,1,1]
    v_pk_fma_f32 v[114:115], v[122:123], v[12:13], v[114:115] op_sel:[0,1,0] op_sel_hi:[1,1,1]
    v_pk_fma_f32 v[116:117], v[124:125], v[12:13], v[116:117] op_sel:[0,1,0] op_sel_hi:[1,1,1]
    v_pk_fma_f32 v[118:119], v[126:127], v[12:13], v[118:119] op_sel:[0,1,0] op_sel_hi:[1,1,1]
    s_waitcnt vmcnt(15)
    v_lshlrev_b32 v120, 16, v48
    v_and_b32 v121, 0xffff0000, v48
    v_lshlrev_b32 v122, 16, v49
    v_and_b32 v123, 0xffff0000, v49
    v_lshlrev_b32 v124, 16, v50
    v_and_b32 v125, 0xffff0000, v50
    v_lshlrev_b32 v126, 16, v51
    v_and_b32 v127, 0xffff0000, v51
    v_pk_fma_f32 v[112:113], v[120:121], v[14:15], v[112:113] op_sel:[0,0,0] op_sel_hi:[1,0,1]
    v_pk_fma_f32 v[114:115], v[122:123], v[14:15], v[114:115] op_sel:[0,0,0] op_sel_hi:[1,0,1]
    v_pk_fma_f32 v[116:117], v[124:125], v[14:15], v[116:117] op_sel:[0,0,0] op_sel_hi:[1,0,1]
    v_pk_fma_f32 v[118:119], v[126:127], v[14:15], v[118:119] op_sel:[0,0,0] op_sel_hi:[1,0,1]
    s_waitcnt vmcnt(14)
    v_lshlrev_b32 v120, 16, v52
    v_and_b32 v121, 0xffff0000, v52
    v_lshlrev_b32 v122, 16, v53
    v_and_b32 v123, 0xffff0000, v53
    v_lshlrev_b32 v124, 16, v54
    v_and_b32 v125, 0xffff0000, v54
    v_lshlrev_b32 v126, 16, v55
    v_and_b32 v127, 0xffff0000, v55
    v_pk_fma_f32 v[112:113], v[120:121], v[14:15], v[112:113] op_sel:[0,1,0] op_sel_hi:[1,1,1]
    v_pk_fma_f32 v[114:115], v[122:123], v[14:15], v[114:115] op_sel:[0,1,0] op_sel_hi:[1,1,1]
    v_pk_fma_f32 v[116:117], v[124:125], v[14:15], v[116:117] op_sel:[0,1,0] op_sel_hi:[1,1,1]
    v_pk_fma_f32 v[118:119], v[126:127], v[14:15], v[118:119] op_sel:[0,1,0] op_sel_hi:[1,1,1]
    s_waitcnt vmcnt(13)
    v_lshlrev_b32 v120, 16, v56
    v_and_b32 v121, 0xffff0000, v56
    v_lshlrev_b32 v122, 16, v57
    v_and_b32 v123, 0xffff0000, v57
    v_lshlrev_b32 v124, 16, v58
    v_and_b32 v125, 0xffff0000, v58
    v_lshlrev_b32 v126, 16, v59
    v_and_b32 v127, 0xffff0000, v59
    v_pk_fma_f32 v[112:113], v[120:121], v[16:17], v[112:113] op_sel:[0,0,0] op_sel_hi:[1,0,1]
    v_pk_fma_f32 v[114:115], v[122:123], v[16:17], v[114:115] op_sel:[0,0,0] op_sel_hi:[1,0,1]
    v_pk_fma_f32 v[116:117], v[124:125], v[16:17], v[116:117] op_sel:[0,0,0] op_sel_hi:[1,0,1]
    v_pk_fma_f32 v[118:119], v[126:127], v[16:17], v[118:119] op_sel:[0,0,0] op_sel_hi:[1,0,1]
    s_waitcnt vmcnt(12)
    v_lshlrev_b32 v120, 16, v60
    v_and_b32 v121, 0xffff0000, v60
    v_lshlrev_b32 v122, 16, v61
    v_and_b32 v123, 0xffff0000, v61
    v_lshlrev_b32 v124, 16, v62
    v_and_b32 v125, 0xffff0000, v62
    v_lshlrev_b32 v126, 16, v63
    v_and_b32 v127, 0xffff0000, v63
    v_pk_fma_f32 v[112:113], v[120:121], v[16:17], v[112:113] op_sel:[0,1,0] op_sel_hi:[1,1,1]
    v_pk_fma_f32 v[114:115], v[122:123], v[16:17], v[114:115] op_sel:[0,1,0] op_sel_hi:[1,1,1]
    v_pk_fma_f32 v[116:117], v[124:125], v[16:17], v[116:117] op_sel:[0,1,0] op_sel_hi:[1,1,1]
    v_pk_fma_f32 v[118:119], v[126:127], v[16:17], v[118:119] op_sel:[0,1,0] op_sel_hi:[1,1,1]
    s_waitcnt vmcnt(11)
    v_lshlrev_b32 v120, 16, v64
    v_and_b32 v121, 0xffff0000, v64
    v_lshlrev_b32 v122, 16, v65
    v_and_b32 v123, 0xffff0000, v65
    v_lshlrev_b32 v124, 16, v66
    v_and_b32 v125, 0xffff0000, v66
    v_lshlrev_b32 v126, 16, v67
    v_and_b32 v127, 0xffff0000, v67
    v_pk_fma_f32 v[112:113], v[120:121], v[18:19], v[112:113] op_sel:[0,0,0] op_sel_hi:[1,0,1]
    v_pk_fma_f32 v[114:115], v[122:123], v[18:19], v[114:115] op_sel:[0,0,0] op_sel_hi:[1,0,1]
    v_pk_fma_f32 v[116:117], v[124:125], v[18:19], v[116:117] op_sel:[0,0,0] op_sel_hi:[1,0,1]
    v_pk_fma_f32 v[118:119], v[126:127], v[18:19], v[118:119] op_sel:[0,0,0] op_sel_hi:[1,0,1]
    s_waitcnt vmcnt(10)
    v_lshlrev_b32 v120, 16, v68
    v_and_b32 v121, 0xffff0000, v68
    v_lshlrev_b32 v122, 16, v69
    v_and_b32 v123, 0xffff0000, v69
    v_lshlrev_b32 v124, 16, v70
    v_and_b32 v125, 0xffff0000, v70
    v_lshlrev_b32 v126, 16, v71
    v_and_b32 v127, 0xffff0000, v71
    v_pk_fma_f32 v[112:113], v[120:121], v[18:19], v[112:113] op_sel:[0,1,0] op_sel_hi:[1,1,1]
    v_pk_fma_f32 v[114:115], v[122:123], v[18:19], v[114:115] op_sel:[0,1,0] op_sel_hi:[1,1,1]
    v_pk_fma_f32 v[116:117], v[124:125], v[18:19], v[116:117] op_sel:[0,1,0] op_sel_hi:[1,1,1]
    v_pk_fma_f32 v[118:119], v[126:127], v[18:19], v[118:119] op_sel:[0,1,0] op_sel_hi:[1,1,1]
    s_waitcnt vmcnt(9)
    v_lshlrev_b32 v120, 16, v72
    v_and_b32 v121, 0xffff0000, v72
    v_lshlrev_b32 v122, 16, v73
    v_and_b32 v123, 0xffff0000, v73
    v_lshlrev_b32 v124, 16, v74
    v_and_b32 v125, 0xffff0000, v74
    v_lshlrev_b32 v126, 16, v75
    v_and_b32 v127, 0xffff0000, v75
    v_pk_fma_f32 v[112:113], v[120:121], v[20:21], v[112:113] op_sel:[0,0,0] op_sel_hi:[1,0,1]
    v_pk_fma_f32 v[114:115], v[122:123], v[20:21], v[114:115] op_sel:[0,0,0] op_sel_hi:[1,0,1]
    v_pk_fma_f32 v[116:117], v[124:125], v[20:21], v[116:117] op_sel:[0,0,0] op_sel_hi:[1,0,1]
    v_pk_fma_f32 v[118:119], v[126:127], v[20:21], v[118:119] op_sel:[0,0,0] op_sel_hi:[1,0,1]
    s_waitcnt vmcnt(8)
    v_lshlrev_b32 v120, 16, v76
    v_and_b32 v121, 0xffff0000, v76
    v_lshlrev_b32 v122, 16, v77
    v_and_b32 v123, 0xffff0000, v77
    v_lshlrev_b32 v124, 16, v78
    v_and_b32 v125, 0xffff0000, v78
    v_lshlrev_b32 v126, 16, v79
    v_and_b32 v127, 0xffff0000, v79
    v_pk_fma_f32 v[112:113], v[120:121], v[20:21], v[112:113] op_sel:[0,1,0] op_sel_hi:[1,1,1]
    v_pk_fma_f32 v[114:115], v[122:123], v[20:21], v[114:115] op_sel:[0,1,0] op_sel_hi:[1,1,1]
    v_pk_fma_f32 v[116:117], v[124:125], v[20:21], v[116:117] op_sel:[0,1,0] op_sel_hi:[1,1,1]
    v_pk_fma_f32 v[118:119], v[126:127], v[20:21], v[118:119] op_sel:[0,1,0] op_sel_hi:[1,1,1]
    s_waitcnt vmcnt(7)
    v_lshlrev_b32 v120, 16, v80
    v_and_b32 v121, 0xffff0000, v80
    v_lshlrev_b32 v122, 16, v81
    v_and_b32 v123, 0xffff0000, v81
    v_lshlrev_b32 v124, 16, v82
    v_and_b32 v125, 0xffff0000, v82
    v_lshlrev_b32 v126, 16, v83
    v_and_b32 v127, 0xffff0000, v83
    v_pk_fma_f32 v[112:113], v[120:121], v[22:23], v[112:113] op_sel:[0,0,0] op_sel_hi:[1,0,1]
    v_pk_fma_f32 v[114:115], v[122:123], v[22:23], v[114:115] op_sel:[0,0,0] op_sel_hi:[1,0,1]
    v_pk_fma_f32 v[116:117], v[124:125], v[22:23], v[116:117] op_sel:[0,0,0] op_sel_hi:[1,0,1]
    v_pk_fma_f32 v[118:119], v[126:127], v[22:23], v[118:119] op_sel:[0,0,0] op_sel_hi:[1,0,1]
    s_waitcnt vmcnt(6)
    v_lshlrev_b32 v120, 16, v84
    v_and_b32 v121, 0xffff0000, v84
    v_lshlrev_b32 v122, 16, v85
    v_and_b32 v123, 0xffff0000, v85
    v_lshlrev_b32 v124, 16, v86
    v_and_b32 v125, 0xffff0000, v86
    v_lshlrev_b32 v126, 16, v87
    v_and_b32 v127, 0xffff0000, v87
    v_pk_fma_f32 v[112:113], v[120:121], v[22:23], v[112:113] op_sel:[0,1,0] op_sel_hi:[1,1,1]
    v_pk_fma_f32 v[114:115], v[122:123], v[22:23], v[114:115] op_sel:[0,1,0] op_sel_hi:[1,1,1]
    v_pk_fma_f32 v[116:117], v[124:125], v[22:23], v[116:117] op_sel:[0,1,0] op_sel_hi:[1,1,1]
    v_pk_fma_f32 v[118:119], v[126:127], v[22:23], v[118:119] op_sel:[0,1,0] op_sel_hi:[1,1,1]
    s_waitcnt vmcnt(5)
    v_lshlrev_b32 v120, 16, v88
    v_and_b32 v121, 0xffff0000, v88
    v_lshlrev_b32 v122, 16, v89
    v_and_b32 v123, 0xffff0000, v89
    v_lshlrev_b32 v124, 16, v90
    v_and_b32 v125, 0xffff0000, v90
    v_lshlrev_b32 v126, 16, v91
    v_and_b32 v127, 0xffff0000, v91
    v_pk_fma_f32 v[112:113], v[120:121], v[24:25], v[112:113] op_sel:[0,0,0] op_sel_hi:[1,0,1]
    v_pk_fma_f32 v[114:115], v[122:123], v[24:25], v[114:115] op_sel:[0,0,0] op_sel_hi:[1,0,1]
    v_pk_fma_f32 v[116:117], v[124:125], v[24:25], v[116:117] op_sel:[0,0,0] op_sel_hi:[1,0,1]
    v_pk_fma_f32 v[118:119], v[126:127], v[24:25], v[118:119] op_sel:[0,0,0] op_sel_hi:[1,0,1]
    s_waitcnt vmcnt(4)
    v_lshlrev_b32 v120, 16, v92
    v_and_b32 v121, 0xffff0000, v92
    v_lshlrev_b32 v122, 16, v93
    v_and_b32 v123, 0xffff0000, v93
    v_lshlrev_b32 v124, 16, v94
    v_and_b32 v125, 0xffff0000, v94
    v_lshlrev_b32 v126, 16, v95
    v_and_b32 v127, 0xffff0000, v95
    v_pk_fma_f32 v[112:113], v[120:121], v[24:25], v[112:113] op_sel:[0,1,0] op_sel_hi:[1,1,1]
    v_pk_fma_f32 v[114:115], v[122:123], v[24:25], v[114:115] op_sel:[0,1,0] op_sel_hi:[1,1,1]
    v_pk_fma_f32 v[116:117], v[124:125], v[24:25], v[116:117] op_sel:[0,1,0] op_sel_hi:[1,1,1]
    v_pk_fma_f32 v[118:119], v[126:127], v[24:25], v[118:119] op_sel:[0,1,0] op_sel_hi:[1,1,1]
    s_waitcnt vmcnt(3)
    v_lshlrev_b32 v120, 16, v96
    v_and_b32 v121, 0xffff0000, v96
    v_lshlrev_b32 v122, 16, v97
    v_and_b32 v123, 0xffff0000, v97
    v_lshlrev_b32 v124, 16, v98
    v_and_b32 v125, 0xffff0000, v98
    v_lshlrev_b32 v126, 16, v99
    v_and_b32 v127, 0xffff0000, v99
    v_pk_fma_f32 v[112:113], v[120:121], v[26:27], v[112:113] op_sel:[0,0,0] op_sel_hi:[1,0,1]
    v_pk_fma_f32 v[114:115], v[122:123], v[26:27], v[114:115] op_sel:[0,0,0] op_sel_hi:[1,0,1]
    v_pk_fma_f32 v[116:117], v[124:125], v[26:27], v[116:117] op_sel:[0,0,0] op_sel_hi:[1,0,1]
    v_pk_fma_f32 v[118:119], v[126:127], v[26:27], v[118:119] op_sel:[0,0,0] op_sel_hi:[1,0,1]
    s_waitcnt vmcnt(2)
    v_lshlrev_b32 v120, 16, v100
    v_and_b32 v121, 0xffff0000, v100
    v_lshlrev_b32 v122, 16, v101
    v_and_b32 v123, 0xffff0000, v101
    v_lshlrev_b32 v124, 16, v102
    v_and_b32 v125, 0xffff0000, v102
    v_lshlrev_b32 v126, 16, v103
    v_and_b32 v127, 0xffff0000, v103
    v_pk_fma_f32 v[112:113], v[120:121], v[26:27], v[112:113] op_sel:[0,1,0] op_sel_hi:[1,1,1]
    v_pk_fma_f32 v[114:115], v[122:123], v[26:27], v[114:115] op_sel:[0,1,0] op_sel_hi:[1,1,1]
    v_pk_fma_f32 v[116:117], v[124:125], v[26:27], v[116:117] op_sel:[0,1,0] op_sel_hi:[1,1,1]
    v_pk_fma_f32 v[118:119], v[126:127], v[26:27], v[118:119] op_sel:[0,1,0] op_sel_hi:[1,1,1]
    s_waitcnt vmcnt(1)
    v_lshlrev_b32 v120, 16, v104
    v_and_b32 v121, 0xffff0000, v104
    v_lshlrev_b32 v122, 16, v105
    v_and_b32 v123, 0xffff0000, v105
    v_lshlrev_b32 v124, 16, v106
    v_and_b32 v125, 0xffff0000, v106
    v_lshlrev_b32 v126, 16, v107
    v_and_b32 v127, 0xffff0000, v107
    v_pk_fma_f32 v[112:113], v[120:121], v[28:29], v[112:113] op_sel:[0,0,0] op_sel_hi:[1,0,1]
    v_pk_fma_f32 v[114:115], v[122:123], v[28:29], v[114:115] op_sel:[0,0,0] op_sel_hi:[1,0,1]
    v_pk_fma_f32 v[116:117], v[124:125], v[28:29], v[116:117] op_sel:[0,0,0] op_sel_hi:[1,0,1]
    v_pk_fma_f32 v[118:119], v[126:127], v[28:29], v[118:119] op_sel:[0,0,0] op_sel_hi:[1,0,1]
    s_waitcnt vmcnt(0)
    v_lshlrev_b32 v120, 16, v108
    v_and_b32 v121, 0xffff0000, v108
    v_lshlrev_b32 v122, 16, v109
    v_and_b32 v123, 0xffff0000, v109
    v_lshlrev_b32 v124, 16, v110
    v_and_b32 v125, 0xffff0000, v110
    v_lshlrev_b32 v126, 16, v111
    v_and_b32 v127, 0xffff0000, v111
    v_pk_fma_f32 v[112:113], v[120:121], v[28:29], v[112:113] op_sel:[0,1,0] op_sel_hi:[1,1,1]
    v_pk_fma_f32 v[114:115], v[122:123], v[28:29], v[114:115] op_sel:[0,1,0] op_sel_hi:[1,1,1]
    v_pk_fma_f32 v[116:117], v[124:125], v[28:29], v[116:117] op_sel:[0,1,0] op_sel_hi:[1,1,1]
    v_pk_fma_f32 v[118:119], v[126:127], v[28:29], v[118:119] op_sel:[0,1,0] op_sel_hi:[1,1,1]
    v_lshlrev_b32 v7, 5, v0
    ds_write_b128 v7, v[112:115]
    ds_write_b128 v7, v[116:119] offset:16
    s_waitcnt lgkmcnt(0)
    s_barrier
    v_cmp_gt_u32 vcc, 64, v0
    s_and_saveexec_b64 s[42:43], vcc
    s_cbranch_execz k1_end
    v_lshlrev_b32 v7, 2, v0
    ds_read_b32 v32, v7 offset:0
    ds_read_b32 v33, v7 offset:256
    ds_read_b32 v34, v7 offset:512
    ds_read_b32 v35, v7 offset:768
    ds_read_b32 v36, v7 offset:1024
    ds_read_b32 v37, v7 offset:1280
    ds_read_b32 v38, v7 offset:1536
    ds_read_b32 v39, v7 offset:1792
    ds_read_b32 v40, v7 offset:2048
    ds_read_b32 v41, v7 offset:2304
    ds_read_b32 v42, v7 offset:2560
    ds_read_b32 v43, v7 offset:2816
    ds_read_b32 v44, v7 offset:3072
    ds_read_b32 v45, v7 offset:3328
    ds_read_b32 v46, v7 offset:3584
    ds_read_b32 v47, v7 offset:3840
    ds_read_b32 v48, v7 offset:4096
    ds_read_b32 v49, v7 offset:4352
    ds_read_b32 v50, v7 offset:4608
    ds_read_b32 v51, v7 offset:4864
    ds_read_b32 v52, v7 offset:5120
    ds_read_b32 v53, v7 offset:5376
    ds_read_b32 v54, v7 offset:5632
    ds_read_b32 v55, v7 offset:5888
    ds_read_b32 v56, v7 offset:6144
    ds_read_b32 v57, v7 offset:6400
    ds_read_b32 v58, v7 offset:6656
    ds_read_b32 v59, v7 offset:6912
    ds_read_b32 v60, v7 offset:7168
    ds_read_b32 v61, v7 offset:7424
    ds_read_b32 v62, v7 offset:7680
    ds_read_b32 v63, v7 offset:7936
    s_waitcnt lgkmcnt(0)
    v_add_f32 v32, v32, v48
    v_add_f32 v33, v33, v49
    v_add_f32 v34, v34, v50
    v_add_f32 v35, v35, v51
    v_add_f32 v36, v36, v52
    v_add_f32 v37, v37, v53
    v_add_f32 v38, v38, v54
    v_add_f32 v39, v39, v55
    v_add_f32 v40, v40, v56
    v_add_f32 v41, v41, v57
    v_add_f32 v42, v42, v58
    v_add_f32 v43, v43, v59
    v_add_f32 v44, v44, v60
    v_add_f32 v45, v45, v61
    v_add_f32 v46, v46, v62
    v_add_f32 v47, v47, v63
    v_add_f32 v32, v32, v40
    v_add_f32 v33, v33, v41
    v_add_f32 v34, v34, v42
    v_add_f32 v35, v35, v43
    v_add_f32 v36, v36, v44
    v_add_f32 v37, v37, v45
    v_add_f32 v38, v38, v46
    v_add_f32 v39, v39, v47
    v_add_f32 v32, v32, v36
    v_add_f32 v33, v33, v37
    v_add_f32 v34, v34, v38
    v_add_f32 v35, v35, v39
    v_add_f32 v32, v32, v34
    v_add_f32 v33, v33, v35
    v_add_f32 v32, v32, v33
    s_movk_i32 s22, 640
    v_cvt_pk_bf16_f32 v32, v32, v32
    v_lshlrev_b32 v32, 16, v32
    v_add_f32 v33, 1.0, v32
    v_cvt_pk_bf16_f32 v33, v33, v33
    v_lshlrev_b32 v33, 16, v33
    s_lshl_b32 s33, s32, 6
    v_add_u32 v34, s33, v0
    v_subrev_u32 v35, 640, v34
    v_cmp_gt_u32 vcc, 640, v35
    v_subrev_u32 v35, 2560, v34
    v_cmp_gt_u32 s[40:41], s22, v35
    s_or_b64 vcc, vcc, s[40:41]
    v_cndmask_b32 v32, v32, v33, vcc
    s_lshl_b32 s21, s32, 8
    s_add_u32 s21, s21, 2711552
    buffer_store_dword v32, v7, s[28:31], s21 offen sc1
k1_end:
    s_endpgm
k1_pf:
    s_waitcnt lgkmcnt(0)
    s_load_dwordx2 s[4:5], s[0:1], 0
    v_lshlrev_b32 v3, 7, v1
    v_lshlrev_b32 v1, 4, v1
    s_sub_u32 s24, s54, 96
    s_lshr_b32 s24, s24, 3
    s_lshl_b32 s24, s24, 2
    s_add_u32 s24, s24, s20
    s_and_b32 s22, s2, 7
    s_mul_i32 s21, s24, 20480
    s_mul_i32 s23, s22, 327680
    s_add_u32 s21, s21, s23
    s_waitcnt lgkmcnt(0)
    s_mov_b32 s16, s4
    s_mov_b32 s17, s5
    s_mov_b32 s18, 2621440
    s_mov_b32 s19, 0x00020000
    s_mov_b32 s28, s10
    s_mov_b32 s29, s11
    s_mov_b32 s30, 268435456
    s_mov_b32 s31, 0x00020000
    s_sub_u32 s36, s54, 96
    s_cmp_ge_u32 s36, 16
    s_cbranch_scc1 k1_kernel_zf21
    s_lshl_b32 s36, s36, 12
    s_add_u32 s36, s36, 8990720
    v_lshlrev_b32 v5, 4, v0
    v_mov_b32 v60, 0
    v_mov_b32 v61, 0
    v_mov_b32 v62, 0
    v_mov_b32 v63, 0
    buffer_store_dwordx4 v[60:63], v5, s[28:31], s36 offen sc1
k1_kernel_zf21:
    s_sub_u32 s36, s54, 96
    s_lshr_b32 s36, s36, 3
    s_mul_i32 s36, s36, 5120
    s_and_b32 s37, s2, 7
    s_mul_i32 s37, s37, 1601536
    s_add_u32 s36, s36, s37
    s_add_u32 s36, s36, 10641408
    v_lshlrev_b32 v5, 4, v0
    v_mov_b32 v60, 0
    v_mov_b32 v61, 0
    v_mov_b32 v62, 0
    v_mov_b32 v63, 0
    buffer_store_dwordx4 v[60:63], v5, s[28:31], s36 offen sc1
    s_add_u32 s36, s36, 4096
    s_cmp_lg_u32 s20, 0
    s_cbranch_scc1 k1_zst
    buffer_store_dwordx4 v[60:63], v5, s[28:31], s36 offen sc1
k1_zst:
    s_and_b32 s37, s2, 7
    s_cmp_eq_u32 s37, 0
    s_cselect_b32 s38, 9060352, 0
    s_cmp_eq_u32 s37, 7
    s_cselect_b32 s38, 20619264, s38
    s_cmp_eq_u32 s38, 0
    s_cbranch_scc1 k1_zht
    s_sub_u32 s36, s54, 96
    s_lshr_b32 s36, s36, 3
    s_mul_i32 s36, s36, 5120
    s_add_u32 s36, s36, s38
    buffer_store_dwordx4 v[60:63], v5, s[28:31], s36 offen sc1
    s_add_u32 s36, s36, 4096
    s_cmp_lg_u32 s20, 0
    s_cbranch_scc1 k1_zht
    buffer_store_dwordx4 v[60:63], v5, s[28:31], s36 offen sc1
k1_zht:
    s_getpc_b64 s[40:41]
k1_pcref:
    s_sub_u32 s40, s40, k1_pcref-k1_kernel
    s_subb_u32 s41, s41, 0
    s_lshl_b32 s42, s24, 12
    s_add_u32 s43, s42, 0
    s_min_u32 s43, s43, (CODE_END-k1_kernel-1020)&0xfffffff0
    v_add_u32 v6, s43, v1
    global_load_dwordx4 v[64:67], v6, s[40:41]
    s_add_u32 s43, s42, 1024
    s_min_u32 s43, s43, (CODE_END-k1_kernel-1020)&0xfffffff0
    v_add_u32 v6, s43, v1
    global_load_dwordx4 v[68:71], v6, s[40:41]
    s_add_u32 s43, s42, 2048
    s_min_u32 s43, s43, (CODE_END-k1_kernel-1020)&0xfffffff0
    v_add_u32 v6, s43, v1
    global_load_dwordx4 v[72:75], v6, s[40:41]
    s_add_u32 s43, s42, 3072
    s_min_u32 s43, s43, (CODE_END-k1_kernel-1020)&0xfffffff0
    v_add_u32 v6, s43, v1
    global_load_dwordx4 v[76:79], v6, s[40:41]
    s_mov_b32 s61, s21
    s_mov_b32 s62, s24
    s_waitcnt vmcnt(0)
    s_cmp_lg_u32 s20, 0
    s_cbranch_scc1 k1_kernel_sw23
    s_and_b32 s55, s2, 7
    s_lshl_b32 s57, s55, 9
    s_add_u32 s57, s57, 9056256
    v_mov_b32 v250, 0
    v_and_b32 v248, 31, v0
    v_lshlrev_b32 v248, 2, v248
    s_waitcnt lgkmcnt(0)
    s_mov_b32 s28, s10
    s_mov_b32 s29, s11
    s_mov_b32 s30, 268435456
    s_mov_b32 s31, 0x00020000
    buffer_load_dword v251, v250, s[28:31], s57 offen sc1
    s_mov_b32 s23, 1
    s_waitcnt vmcnt(0)
    v_add_u32 v251, 1, v251
k1_kernel_sw22:
    buffer_load_dword v249, v248, s[28:31], s57 offen offset:256 sc1
    s_waitcnt vmcnt(0)
    v_cmp_eq_u32 vcc, v251, v249
    s_sub_u32 s23, s23, 1
    s_cmp_eq_u64 vcc, -1
    s_cbranch_scc1 k1_kernel_sw23
    s_sleep 16
    s_cmp_lg_u32 s23, 0
    s_cbranch_scc1 k1_kernel_sw22
k1_kernel_sw23:
    s_barrier
    s_mov_b32 s21, s61
    s_mov_b32 s24, s62
    s_mov_b32 s28, s10
    s_mov_b32 s29, s11
    s_mov_b32 s30, 268435456
    s_mov_b32 s31, 0x00020000
    buffer_load_dwordx4 v[8:11], v1, s[16:19], s21 offen offset:0
    buffer_load_dwordx4 v[12:15], v1, s[16:19], s21 offen offset:1024
    buffer_load_dwordx4 v[16:19], v1, s[16:19], s21 offen offset:2048
    buffer_load_dwordx4 v[20:23], v1, s[16:19], s21 offen offset:3072
    s_add_u32 s21, s21, 4096
    buffer_load_dwordx4 v[24:27], v1, s[16:19], s21 offen offset:0
    buffer_load_dwordx4 v[28:31], v1, s[16:19], s21 offen offset:1024
    buffer_load_dwordx4 v[32:35], v1, s[16:19], s21 offen offset:2048
    buffer_load_dwordx4 v[36:39], v1, s[16:19], s21 offen offset:3072
    s_add_u32 s21, s21, 4096
    buffer_load_dwordx4 v[40:43], v1, s[16:19], s21 offen offset:0
    buffer_load_dwordx4 v[44:47], v1, s[16:19], s21 offen offset:1024
    buffer_load_dwordx4 v[8:11], v1, s[16:19], s21 offen offset:2048
    buffer_load_dwordx4 v[12:15], v1, s[16:19], s21 offen offset:3072
    s_add_u32 s21, s21, 4096
    buffer_load_dwordx4 v[16:19], v1, s[16:19], s21 offen offset:0
    buffer_load_dwordx4 v[20:23], v1, s[16:19], s21 offen offset:1024
    buffer_load_dwordx4 v[24:27], v1, s[16:19], s21 offen offset:2048
    buffer_load_dwordx4 v[28:31], v1, s[16:19], s21 offen offset:3072
    s_add_u32 s21, s21, 4096
    buffer_load_dwordx4 v[32:35], v1, s[16:19], s21 offen offset:0
    buffer_load_dwordx4 v[36:39], v1, s[16:19], s21 offen offset:1024
    buffer_load_dwordx4 v[40:43], v1, s[16:19], s21 offen offset:2048
    buffer_load_dwordx4 v[44:47], v1, s[16:19], s21 offen offset:3072
    s_add_u32 s21, s21, 4096
    s_mul_i32 s22, s22, 1601536
    s_add_u32 s22, s22, 9060352
    s_waitcnt vmcnt(0)
    s_endpgm
.globl k2_kernel
.p2align 8
.type k2_kernel,@function
k2_kernel:
    s_cmp_ge_u32 s2, 256
    s_cbranch_scc1 k2_end
    s_load_dwordx2 s[4:5], s[0:1], 0
    s_load_dwordx2 s[6:7], s[0:1], 104
    s_load_dwordx2 s[8:9], s[0:1], 120
    s_getreg_b32 s42, hwreg(HW_REG_XCC_ID, 0, 4)
    v_lshrrev_b32 v2, 6, v0
    v_and_b32 v1, 63, v0
    v_readfirstlane_b32 s30, v2
    s_and_b32 s28, s2, 7
    s_lshr_b32 s29, s2, 3
    s_lshr_b32 s32, s29, 3
    s_and_b32 s33, s29, 7
    s_lshr_b32 s34, s29, 4
    s_and_b32 s35, s29, 15
    s_mul_i32 s36, s28, 1601536
    s_add_u32 s36, s36, 9060352
    s_lshl_b32 s37, s28, 13
    s_add_u32 s37, s37, 8990720
    s_add_u32 s42, s42, 1
    s_mov_b32 s31, 0
    v_lshlrev_b32 v2, 4, v1
    v_lshrrev_b32 v3, 4, v1
    v_and_b32 v4, 15, v1
    v_lshrrev_b32 v8, 1, v3
    v_lshl_add_u32 v8, v8, 4, v4
    v_and_b32 v9, 1, v3
    v_lshl_add_u32 v8, v8, 1, v9
    v_lshlrev_b32 v8, 3, v8
    v_lshlrev_b32 v5, 7, v1
    v_and_b32 v9, 1, v3
    v_lshlrev_b32 v9, 1, v9
    v_lshrrev_b32 v10, 1, v3
    v_or_b32 v9, v9, v10
    v_lshlrev_b32 v9, 8, v9
    v_lshl_add_u32 v254, v4, 4, v9
    s_waitcnt lgkmcnt(0)
    s_mov_b32 s12, s8
    s_mov_b32 s13, s9
    s_mov_b32 s14, 268435456
    s_mov_b32 s15, 0x00020000
    s_mov_b32 s16, s4
    s_mov_b32 s17, s5
    s_mov_b32 s18, 2621440
    s_mov_b32 s19, 0x00020000
    s_mov_b32 s24, s6
    s_mov_b32 s25, s7
    s_mov_b32 s26, 2621440
    s_mov_b32 s27, 0x00020000
    s_cmp_lg_u32 s30, 0
    s_cbranch_scc1 k2_kernel_L1
    s_lshl_b32 s41, s29, 2
    s_add_u32 s41, s41, s37
    v_mov_b32 v9, s42
    v_mov_b32 v10, 7424
    s_mov_b64 exec, 1
    buffer_store_dword v9, v10, s[12:15], s41 offen sc1
    s_mov_b64 exec, -1
k2_kernel_L1:
    s_mul_i32 s44, s33, 102400
    s_mul_i32 s45, s35, 143360
    s_add_u32 s45, s45, 4403200
    s_mul_i32 s40, s33, 286720
    s_mul_i32 s41, s30, 71680
    s_add_u32 s40, s40, s41
    s_add_u32 s40, s40, 6696960
    s_lshl_b32 s46, s32, 2
    s_add_u32 s46, s46, s30
    s_mul_i32 s47, s46, 20480
    s_mul_i32 s41, s33, 2560
    s_add_u32 s47, s47, s41
    s_add_u32 s54, s47, s36
    s_lshl_b32 s55, s46, 7
    s_add_u32 s55, s55, s37
    s_mul_i32 s22, s28, 327680
    s_add_u32 s22, s22, s47
    s_add_u32 s22, s22, 0
    s_mul_i32 s38, s30, 25600
    s_add_u32 s39, s38, s44
    s_add_u32 s39, s39, 2764800
    s_add_u32 s38, s38, 0
    s_cmp_ge_u32 s29, 18
    s_cbranch_scc1 k2_kernel_nob02
    s_lshl_b32 s46, s28, 8
    s_lshl_b32 s47, s29, 4
    s_add_u32 s46, s46, s47
    s_sub_u32 s46, s46, 16
    s_lshl_b32 s47, s30, 2
    s_add_u32 s47, s47, s46
    v_add_u32 v11, s47, v3
    s_movk_i32 s48, 1280
    v_mul_lo_u32 v6, v11, s48
    v_lshl_add_u32 v6, v4, 4, v6
    buffer_load_dwordx4 v[16:19], v6, s[16:19], 0 offen offset:0
    buffer_load_dwordx4 v[20:23], v6, s[16:19], 0 offen offset:256
    buffer_load_dwordx4 v[24:27], v6, s[16:19], 0 offen offset:512
    buffer_load_dwordx4 v[28:31], v6, s[16:19], 0 offen offset:768
    buffer_load_dwordx4 v[32:35], v6, s[16:19], 0 offen offset:1024
    s_mul_i32 s47, s29, 20480
    s_mul_i32 s48, s30, 5120
    s_add_u32 s47, s47, s48
    s_add_u32 s47, s47, s36
    v_add_u32 v12, s47, v2
    s_add_u32 s48, s48, 135168
    s_mov_b32 m0, s48
    s_nop 0
    buffer_load_dwordx4 v12, s[12:15], 0 offen offset:0 lds
    buffer_load_dwordx4 v12, s[12:15], 0 offen offset:1024 lds
    buffer_load_dwordx4 v12, s[12:15], 0 offen offset:2048 lds
    buffer_load_dwordx4 v12, s[12:15], 0 offen offset:3072 lds
    s_add_u32 s48, s48, 4096
    s_mov_b32 m0, s48
    s_movk_i32 s47, 4096
    buffer_load_dwordx4 v12, s[12:15], s47 offen lds
    s_lshl_b32 s47, s30, 12
    s_add_u32 s48, s47, 118784
    s_add_u32 s41, s47, 0
    s_min_u32 s41, s41, 14336
    s_add_u32 s41, s41, 2711552
    s_add_u32 m0, s48, 0
    s_nop 0
    buffer_load_dwordx4 v2, s[12:15], s41 offen lds
    s_add_u32 s41, s47, 1024
    s_min_u32 s41, s41, 14336
    s_add_u32 s41, s41, 2711552
    s_add_u32 m0, s48, 1024
    s_nop 0
    buffer_load_dwordx4 v2, s[12:15], s41 offen lds
    s_add_u32 s41, s47, 2048
    s_min_u32 s41, s41, 14336
    s_add_u32 s41, s41, 2711552
    s_add_u32 m0, s48, 2048
    s_nop 0
    buffer_load_dwordx4 v2, s[12:15], s41 offen lds
    s_add_u32 s41, s47, 3072
    s_min_u32 s41, s41, 14336
    s_add_u32 s41, s41, 2711552
    s_add_u32 m0, s48, 3072
    s_nop 0
    buffer_load_dwordx4 v2, s[12:15], s41 offen lds
    v_lshl_add_u32 v15, s30, 2, v3
    v_lshrrev_b32 v7, 1, v15
    v_and_b32 v9, 7, v4
    v_xor_b32 v7, v7, v9
    v_and_b32 v9, 1, v15
    v_lshl_add_u32 v7, v7, 1, v9
    v_lshlrev_b32 v7, 3, v7
    v_lshl_add_u32 v7, v4, 8, v7
    v_add_u32 v7, 135168, v7
    v_lshlrev_b32 v10, 5, v4
    v_add_u32 v10, 118784, v10
    v_lshrrev_b32 v12, 2, v4
    v_and_b32 v13, 3, v4
    v_lshl_add_u32 v13, v13, 4, v15
    v_lshlrev_b32 v13, 4, v13
    v_lshl_add_u32 v6, v12, 10, v13
    s_movk_i32 s48, 2048
    v_cmp_gt_u32 s[50:51], s48, v11
    v_mov_b32 v120, 0
    v_mov_b32 v121, 0
    v_mov_b32 v124, 0
    v_mov_b32 v125, 0
    v_mov_b32 v126, 0x3f803f80
    s_waitcnt vmcnt(9)
    v_dot2_f32_bf16 v120, v16, v126, v120
    v_dot2_f32_bf16 v121, v16, v16, v121
    v_lshlrev_b32 v56, 16, v16
    v_and_b32 v57, 0xffff0000, v16
    v_dot2_f32_bf16 v120, v17, v126, v120
    v_dot2_f32_bf16 v121, v17, v17, v121
    v_lshlrev_b32 v58, 16, v17
    v_and_b32 v59, 0xffff0000, v17
    v_dot2_f32_bf16 v120, v18, v126, v120
    v_dot2_f32_bf16 v121, v18, v18, v121
    v_lshlrev_b32 v60, 16, v18
    v_and_b32 v61, 0xffff0000, v18
    s_cmp_eq_u32 s30, 1
    s_cbranch_scc1 k2_kernel_sm4
    s_cmp_ge_u32 s30, 2
    s_cbranch_scc1 k2_kernel_sm5
    s_mul_i32 s41, s33, 320
    s_add_u32 s41, s41, 2748416
    s_mov_b32 m0, 155648
    s_mov_b64 exec, 0xfffff
    buffer_load_dwordx4 v2, s[12:15], s41 offen lds
    s_add_u32 s41, s41, 7168
    s_mov_b32 m0, 156160
    s_nop 0
    buffer_load_dwordx4 v2, s[12:15], s41 offen lds
    s_branch k2_kernel_sm6
k2_kernel_sm4:
    s_mul_i32 s41, s35, 448
    s_add_u32 s41, s41, 2732032
    s_mov_b32 m0, 156672
    s_mov_b64 exec, 0xfffffff
    buffer_load_dwordx4 v2, s[12:15], s41 offen lds
    s_add_u32 s41, s41, 7168
    s_mov_b32 m0, 157184
    s_nop 0
    buffer_load_dwordx4 v2, s[12:15], s41 offen lds
    s_branch k2_kernel_sm6
k2_kernel_sm5:
    s_mul_i32 s41, s33, 320
    s_add_u32 s41, s41, 2724352
    s_mov_b32 m0, 157696
    s_mov_b64 exec, 0xfffff
    buffer_load_dwordx4 v2, s[12:15], s41 offen lds
k2_kernel_sm6:
    s_mov_b64 exec, -1
    v_dot2_f32_bf16 v120, v19, v126, v120
    v_dot2_f32_bf16 v121, v19, v19, v121
    v_lshlrev_b32 v62, 16, v19
    v_and_b32 v63, 0xffff0000, v19
    v_dot2_f32_bf16 v120, v20, v126, v120
    v_dot2_f32_bf16 v121, v20, v20, v121
    v_lshlrev_b32 v64, 16, v20
    v_and_b32 v65, 0xffff0000, v20
    s_mov_b32 m0, s38
    s_nop 0
    buffer_load_dwordx4 v2, s[12:15], s39 offen offset:0 lds
    v_dot2_f32_bf16 v120, v21, v126, v120
    v_dot2_f32_bf16 v121, v21, v21, v121
    v_lshlrev_b32 v66, 16, v21
    v_and_b32 v67, 0xffff0000, v21
    v_dot2_f32_bf16 v120, v22, v126, v120
    v_dot2_f32_bf16 v121, v22, v22, v121
    v_lshlrev_b32 v68, 16, v22
    v_and_b32 v69, 0xffff0000, v22
    s_mov_b32 m0, s38
    s_nop 0
    buffer_load_dwordx4 v2, s[12:15], s39 offen offset:1024 lds
    v_dot2_f32_bf16 v120, v23, v126, v120
    v_dot2_f32_bf16 v121, v23, v23, v121
    v_lshlrev_b32 v70, 16, v23
    v_and_b32 v71, 0xffff0000, v23
    v_dot2_f32_bf16 v120, v24, v126, v120
    v_dot2_f32_bf16 v121, v24, v24, v121
    v_lshlrev_b32 v72, 16, v24
    v_and_b32 v73, 0xffff0000, v24
    s_mov_b32 m0, s38
    s_nop 0
    buffer_load_dwordx4 v2, s[12:15], s39 offen offset:2048 lds
    v_dot2_f32_bf16 v120, v25, v126, v120
    v_dot2_f32_bf16 v121, v25, v25, v121
    v_lshlrev_b32 v74, 16, v25
    v_and_b32 v75, 0xffff0000, v25
    v_dot2_f32_bf16 v120, v26, v126, v120
    v_dot2_f32_bf16 v121, v26, v26, v121
    v_lshlrev_b32 v76, 16, v26
    v_and_b32 v77, 0xffff0000, v26
    s_mov_b32 m0, s38
    s_nop 0
    buffer_load_dwordx4 v2, s[12:15], s39 offen offset:3072 lds
    s_add_u32 s38, s38, 4096
    s_add_u32 s39, s39, 4096
    v_dot2_f32_bf16 v120, v27, v126, v120
    v_dot2_f32_bf16 v121, v27, v27, v121
    v_lshlrev_b32 v78, 16, v27
    v_and_b32 v79, 0xffff0000, v27
    v_dot2_f32_bf16 v120, v28, v126, v120
    v_dot2_f32_bf16 v121, v28, v28, v121
    v_lshlrev_b32 v80, 16, v28
    v_and_b32 v81, 0xffff0000, v28
    s_mov_b32 m0, s38
    s_nop 0
    buffer_load_dwordx4 v2, s[12:15], s39 offen offset:0 lds
    v_dot2_f32_bf16 v120, v29, v126, v120
    v_dot2_f32_bf16 v121, v29, v29, v121
    v_lshlrev_b32 v82, 16, v29
    v_and_b32 v83, 0xffff0000, v29
    v_dot2_f32_bf16 v120, v30, v126, v120
    v_dot2_f32_bf16 v121, v30, v30, v121
    v_lshlrev_b32 v84, 16, v30
    v_and_b32 v85, 0xffff0000, v30
    s_mov_b32 m0, s38
    s_nop 0
    buffer_load_dwordx4 v2, s[12:15], s39 offen offset:1024 lds
    v_dot2_f32_bf16 v120, v31, v126, v120
    v_dot2_f32_bf16 v121, v31, v31, v121
    v_lshlrev_b32 v86, 16, v31
    v_and_b32 v87, 0xffff0000, v31
    v_dot2_f32_bf16 v120, v32, v126, v120
    v_dot2_f32_bf16 v121, v32, v32, v121
    v_lshlrev_b32 v88, 16, v32
    v_and_b32 v89, 0xffff0000, v32
    s_mov_b32 m0, s38
    s_nop 0
    buffer_load_dwordx4 v2, s[12:15], s39 offen offset:2048 lds
    v_dot2_f32_bf16 v120, v33, v126, v120
    v_dot2_f32_bf16 v121, v33, v33, v121
    v_lshlrev_b32 v90, 16, v33
    v_and_b32 v91, 0xffff0000, v33
    v_dot2_f32_bf16 v120, v34, v126, v120
    v_dot2_f32_bf16 v121, v34, v34, v121
    v_lshlrev_b32 v92, 16, v34
    v_and_b32 v93, 0xffff0000, v34
    s_mov_b32 m0, s38
    s_nop 0
    buffer_load_dwordx4 v2, s[12:15], s39 offen offset:3072 lds
    s_add_u32 s38, s38, 4096
    s_add_u32 s39, s39, 4096
    v_dot2_f32_bf16 v120, v35, v126, v120
    v_dot2_f32_bf16 v121, v35, v35, v121
    v_lshlrev_b32 v94, 16, v35
    v_and_b32 v95, 0xffff0000, v35
    s_nop 1
    s_nop 0
    v_add_f32_dpp v120, v120, v120 quad_perm:[1,0,3,2] row_mask:0xf bank_mask:0xf
    v_add_f32_dpp v121, v121, v121 quad_perm:[1,0,3,2] row_mask:0xf bank_mask:0xf
    s_nop 0
    v_add_f32_dpp v120, v120, v120 quad_perm:[2,3,0,1] row_mask:0xf bank_mask:0xf
    v_add_f32_dpp v121, v121, v121 quad_perm:[2,3,0,1] row_mask:0xf bank_mask:0xf
    s_nop 0
    v_add_f32_dpp v120, v120, v120 row_half_mirror row_mask:0xf bank_mask:0xf
    v_add_f32_dpp v121, v121, v121 row_half_mirror row_mask:0xf bank_mask:0xf
    s_nop 0
    v_add_f32_dpp v120, v120, v120 row_mirror row_mask:0xf bank_mask:0xf
    v_add_f32_dpp v121, v121, v121 row_mirror row_mask:0xf bank_mask:0xf
    v_mul_f32 v120, 0x3acccccd, v120
    v_mul_f32 v121, 0x3acccccd, v121
    v_fma_f32 v121, -v120, v120, v121
    v_max_f32 v121, 0, v121
    v_cvt_pk_bf16_f32 v122, v120, v121
    v_lshlrev_b32 v120, 16, v122
    v_and_b32 v121, 0xffff0000, v122
    v_add_f32 v121, 0x3727c5ac, v121
    v_cvt_pk_bf16_f32 v122, v121, v121
    v_lshlrev_b32 v121, 16, v122
    v_sqrt_f32 v121, v121
    s_nop 0
    v_cvt_pk_bf16_f32 v122, v121, v121
    v_lshlrev_b32 v121, 16, v122
    v_rcp_f32 v121, v121
    s_nop 0
    v_mul_f32 v120, v120, v121
    v_sub_f32 v120, 0, v120
    s_waitcnt vmcnt(9)
    s_barrier
    ds_read_b64 v[36:37], v7 offset:0
    ds_read_b64 v[38:39], v7 offset:128
    ds_read_b64 v[40:41], v7 offset:4096
    ds_read_b64 v[42:43], v7 offset:4224
    ds_read_b64 v[44:45], v7 offset:8192
    ds_read_b64 v[46:47], v7 offset:8320
    ds_read_b64 v[48:49], v7 offset:12288
    ds_read_b64 v[50:51], v7 offset:12416
    ds_read_b64 v[52:53], v7 offset:16384
    ds_read_b64 v[54:55], v7 offset:16512
    ds_read_b128 v[96:99], v10 offset:2560
    ds_read_b128 v[100:103], v10 offset:2576
    ds_read_b128 v[104:107], v10 offset:0
    ds_read_b128 v[108:111], v10 offset:16
    ds_read_b128 v[112:115], v10 offset:5120
    ds_read_b128 v[116:119], v10 offset:5136
    ds_read_b128 v[160:163], v10 offset:3072
    ds_read_b128 v[164:167], v10 offset:3088
    ds_read_b128 v[168:171], v10 offset:512
    ds_read_b128 v[172:175], v10 offset:528
    ds_read_b128 v[176:179], v10 offset:5632
    ds_read_b128 v[180:183], v10 offset:5648
    s_waitcnt lgkmcnt(6)
    v_lshlrev_b32 v152, 16, v36
    v_and_b32 v153, 0xffff0000, v36
    v_lshlrev_b32 v154, 16, v37
    v_and_b32 v155, 0xffff0000, v37
    v_lshlrev_b32 v156, 16, v38
    v_and_b32 v157, 0xffff0000, v38
    v_lshlrev_b32 v158, 16, v39
    v_and_b32 v159, 0xffff0000, v39
    v_pk_fma_f32 v[144:145], v[56:57], v[120:121], v[120:121] op_sel:[0,1,0] op_sel_hi:[1,1,0]
    v_pk_fma_f32 v[146:147], v[58:59], v[120:121], v[120:121] op_sel:[0,1,0] op_sel_hi:[1,1,0]
    v_pk_fma_f32 v[148:149], v[60:61], v[120:121], v[120:121] op_sel:[0,1,0] op_sel_hi:[1,1,0]
    v_pk_fma_f32 v[150:151], v[62:63], v[120:121], v[120:121] op_sel:[0,1,0] op_sel_hi:[1,1,0]
    v_pk_fma_f32 v[144:145], v[144:145], v[96:97], v[104:105]
    v_pk_fma_f32 v[146:147], v[146:147], v[98:99], v[106:107]
    v_pk_fma_f32 v[148:149], v[148:149], v[100:101], v[108:109]
    v_pk_fma_f32 v[150:151], v[150:151], v[102:103], v[110:111]
    v_pk_mul_f32 v[144:145], v[144:145], v[152:153]
    v_pk_mul_f32 v[146:147], v[146:147], v[154:155]
    v_pk_mul_f32 v[148:149], v[148:149], v[156:157]
    v_pk_mul_f32 v[150:151], v[150:151], v[158:159]
    v_pk_fma_f32 v[56:57], v[112:113], v[144:145], v[56:57]
    v_pk_fma_f32 v[58:59], v[114:115], v[146:147], v[58:59]
    v_pk_fma_f32 v[60:61], v[116:117], v[148:149], v[60:61]
    v_pk_fma_f32 v[62:63], v[118:119], v[150:151], v[62:63]
    v_cvt_pk_bf16_f32 v16, v56, v57
    v_cvt_pk_bf16_f32 v17, v58, v59
    v_cvt_pk_bf16_f32 v18, v60, v61
    v_cvt_pk_bf16_f32 v19, v62, v63
    v_dot2_f32_bf16 v124, v16, v126, v124
    v_dot2_f32_bf16 v125, v16, v16, v125
    v_dot2_f32_bf16 v124, v17, v126, v124
    v_dot2_f32_bf16 v125, v17, v17, v125
    v_dot2_f32_bf16 v124, v18, v126, v124
    v_dot2_f32_bf16 v125, v18, v18, v125
    v_dot2_f32_bf16 v124, v19, v126, v124
    v_dot2_f32_bf16 v125, v19, v19, v125
    ds_read_b128 v[96:99], v10 offset:3584
    ds_read_b128 v[100:103], v10 offset:3600
    ds_read_b128 v[104:107], v10 offset:1024
    ds_read_b128 v[108:111], v10 offset:1040
    ds_read_b128 v[112:115], v10 offset:6144
    ds_read_b128 v[116:119], v10 offset:6160
    s_waitcnt lgkmcnt(6)
    v_lshlrev_b32 v152, 16, v40
    v_and_b32 v153, 0xffff0000, v40
    v_lshlrev_b32 v154, 16, v41
    v_and_b32 v155, 0xffff0000, v41
    v_lshlrev_b32 v156, 16, v42
    v_and_b32 v157, 0xffff0000, v42
    v_lshlrev_b32 v158, 16, v43
    v_and_b32 v159, 0xffff0000, v43
    v_pk_fma_f32 v[144:145], v[64:65], v[120:121], v[120:121] op_sel:[0,1,0] op_sel_hi:[1,1,0]
    v_pk_fma_f32 v[146:147], v[66:67], v[120:121], v[120:121] op_sel:[0,1,0] op_sel_hi:[1,1,0]
    v_pk_fma_f32 v[148:149], v[68:69], v[120:121], v[120:121] op_sel:[0,1,0] op_sel_hi:[1,1,0]
    v_pk_fma_f32 v[150:151], v[70:71], v[120:121], v[120:121] op_sel:[0,1,0] op_sel_hi:[1,1,0]
    v_pk_fma_f32 v[144:145], v[144:145], v[160:161], v[168:169]
    v_pk_fma_f32 v[146:147], v[146:147], v[162:163], v[170:171]
    v_pk_fma_f32 v[148:149], v[148:149], v[164:165], v[172:173]
    v_pk_fma_f32 v[150:151], v[150:151], v[166:167], v[174:175]
    v_pk_mul_f32 v[144:145], v[144:145], v[152:153]
    v_pk_mul_f32 v[146:147], v[146:147], v[154:155]
    v_pk_mul_f32 v[148:149], v[148:149], v[156:157]
    v_pk_mul_f32 v[150:151], v[150:151], v[158:159]
    v_pk_fma_f32 v[64:65], v[176:177], v[144:145], v[64:65]
    v_pk_fma_f32 v[66:67], v[178:179], v[146:147], v[66:67]
    v_pk_fma_f32 v[68:69], v[180:181], v[148:149], v[68:69]
    v_pk_fma_f32 v[70:71], v[182:183], v[150:151], v[70:71]
    v_cvt_pk_bf16_f32 v20, v64, v65
    v_cvt_pk_bf16_f32 v21, v66, v67
    v_cvt_pk_bf16_f32 v22, v68, v69
    v_cvt_pk_bf16_f32 v23, v70, v71
    v_dot2_f32_bf16 v124, v20, v126, v124
    v_dot2_f32_bf16 v125, v20, v20, v125
    v_dot2_f32_bf16 v124, v21, v126, v124
    v_dot2_f32_bf16 v125, v21, v21, v125
    v_dot2_f32_bf16 v124, v22, v126, v124
    v_dot2_f32_bf16 v125, v22, v22, v125
    v_dot2_f32_bf16 v124, v23, v126, v124
    v_dot2_f32_bf16 v125, v23, v23, v125
    ds_read_b128 v[160:163], v10 offset:4096
    ds_read_b128 v[164:167], v10 offset:4112
    ds_read_b128 v[168:171], v10 offset:1536
    ds_read_b128 v[172:175], v10 offset:1552
    ds_read_b128 v[176:179], v10 offset:6656
    ds_read_b128 v[180:183], v10 offset:6672
    s_waitcnt lgkmcnt(6)
    v_lshlrev_b32 v152, 16, v44
    v_and_b32 v153, 0xffff0000, v44
    v_lshlrev_b32 v154, 16, v45
    v_and_b32 v155, 0xffff0000, v45
    v_lshlrev_b32 v156, 16, v46
    v_and_b32 v157, 0xffff0000, v46
    v_lshlrev_b32 v158, 16, v47
    v_and_b32 v159, 0xffff0000, v47
    v_pk_fma_f32 v[144:145], v[72:73], v[120:121], v[120:121] op_sel:[0,1,0] op_sel_hi:[1,1,0]
    v_pk_fma_f32 v[146:147], v[74:75], v[120:121], v[120:121] op_sel:[0,1,0] op_sel_hi:[1,1,0]
    v_pk_fma_f32 v[148:149], v[76:77], v[120:121], v[120:121] op_sel:[0,1,0] op_sel_hi:[1,1,0]
    v_pk_fma_f32 v[150:151], v[78:79], v[120:121], v[120:121] op_sel:[0,1,0] op_sel_hi:[1,1,0]
    v_pk_fma_f32 v[144:145], v[144:145], v[96:97], v[104:105]
    v_pk_fma_f32 v[146:147], v[146:147], v[98:99], v[106:107]
    v_pk_fma_f32 v[148:149], v[148:149], v[100:101], v[108:109]
    v_pk_fma_f32 v[150:151], v[150:151], v[102:103], v[110:111]
    v_pk_mul_f32 v[144:145], v[144:145], v[152:153]
    v_pk_mul_f32 v[146:147], v[146:147], v[154:155]
    v_pk_mul_f32 v[148:149], v[148:149], v[156:157]
    v_pk_mul_f32 v[150:151], v[150:151], v[158:159]
    v_pk_fma_f32 v[72:73], v[112:113], v[144:145], v[72:73]
    v_pk_fma_f32 v[74:75], v[114:115], v[146:147], v[74:75]
    v_pk_fma_f32 v[76:77], v[116:117], v[148:149], v[76:77]
    v_pk_fma_f32 v[78:79], v[118:119], v[150:151], v[78:79]
    v_cvt_pk_bf16_f32 v24, v72, v73
    v_cvt_pk_bf16_f32 v25, v74, v75
    v_cvt_pk_bf16_f32 v26, v76, v77
    v_cvt_pk_bf16_f32 v27, v78, v79
    v_dot2_f32_bf16 v124, v24, v126, v124
    v_dot2_f32_bf16 v125, v24, v24, v125
    v_dot2_f32_bf16 v124, v25, v126, v124
    v_dot2_f32_bf16 v125, v25, v25, v125
    v_dot2_f32_bf16 v124, v26, v126, v124
    v_dot2_f32_bf16 v125, v26, v26, v125
    v_dot2_f32_bf16 v124, v27, v126, v124
    v_dot2_f32_bf16 v125, v27, v27, v125
    ds_read_b128 v[96:99], v10 offset:4608
    ds_read_b128 v[100:103], v10 offset:4624
    ds_read_b128 v[104:107], v10 offset:2048
    ds_read_b128 v[108:111], v10 offset:2064
    ds_read_b128 v[112:115], v10 offset:7168
    ds_read_b128 v[116:119], v10 offset:7184
    s_waitcnt lgkmcnt(6)
    v_lshlrev_b32 v152, 16, v48
    v_and_b32 v153, 0xffff0000, v48
    v_lshlrev_b32 v154, 16, v49
    v_and_b32 v155, 0xffff0000, v49
    v_lshlrev_b32 v156, 16, v50
    v_and_b32 v157, 0xffff0000, v50
    v_lshlrev_b32 v158, 16, v51
    v_and_b32 v159, 0xffff0000, v51
    v_pk_fma_f32 v[144:145], v[80:81], v[120:121], v[120:121] op_sel:[0,1,0] op_sel_hi:[1,1,0]
    v_pk_fma_f32 v[146:147], v[82:83], v[120:121], v[120:121] op_sel:[0,1,0] op_sel_hi:[1,1,0]
    v_pk_fma_f32 v[148:149], v[84:85], v[120:121], v[120:121] op_sel:[0,1,0] op_sel_hi:[1,1,0]
    v_pk_fma_f32 v[150:151], v[86:87], v[120:121], v[120:121] op_sel:[0,1,0] op_sel_hi:[1,1,0]
    v_pk_fma_f32 v[144:145], v[144:145], v[160:161], v[168:169]
    v_pk_fma_f32 v[146:147], v[146:147], v[162:163], v[170:171]
    v_pk_fma_f32 v[148:149], v[148:149], v[164:165], v[172:173]
    v_pk_fma_f32 v[150:151], v[150:151], v[166:167], v[174:175]
    v_pk_mul_f32 v[144:145], v[144:145], v[152:153]
    v_pk_mul_f32 v[146:147], v[146:147], v[154:155]
    v_pk_mul_f32 v[148:149], v[148:149], v[156:157]
    v_pk_mul_f32 v[150:151], v[150:151], v[158:159]
    v_pk_fma_f32 v[80:81], v[176:177], v[144:145], v[80:81]
    v_pk_fma_f32 v[82:83], v[178:179], v[146:147], v[82:83]
    v_pk_fma_f32 v[84:85], v[180:181], v[148:149], v[84:85]
    v_pk_fma_f32 v[86:87], v[182:183], v[150:151], v[86:87]
    v_cvt_pk_bf16_f32 v28, v80, v81
    v_cvt_pk_bf16_f32 v29, v82, v83
    v_cvt_pk_bf16_f32 v30, v84, v85
    v_cvt_pk_bf16_f32 v31, v86, v87
    v_dot2_f32_bf16 v124, v28, v126, v124
    v_dot2_f32_bf16 v125, v28, v28, v125
    v_dot2_f32_bf16 v124, v29, v126, v124
    v_dot2_f32_bf16 v125, v29, v29, v125
    v_dot2_f32_bf16 v124, v30, v126, v124
    v_dot2_f32_bf16 v125, v30, v30, v125
    v_dot2_f32_bf16 v124, v31, v126, v124
    v_dot2_f32_bf16 v125, v31, v31, v125
    s_waitcnt lgkmcnt(0)
    v_lshlrev_b32 v152, 16, v52
    v_and_b32 v153, 0xffff0000, v52
    v_lshlrev_b32 v154, 16, v53
    v_and_b32 v155, 0xffff0000, v53
    v_lshlrev_b32 v156, 16, v54
    v_and_b32 v157, 0xffff0000, v54
    v_lshlrev_b32 v158, 16, v55
    v_and_b32 v159, 0xffff0000, v55
    v_pk_fma_f32 v[144:145], v[88:89], v[120:121], v[120:121] op_sel:[0,1,0] op_sel_hi:[1,1,0]
    v_pk_fma_f32 v[146:147], v[90:91], v[120:121], v[120:121] op_sel:[0,1,0] op_sel_hi:[1,1,0]
    v_pk_fma_f32 v[148:149], v[92:93], v[120:121], v[120:121] op_sel:[0,1,0] op_sel_hi:[1,1,0]
    v_pk_fma_f32 v[150:151], v[94:95], v[120:121], v[120:121] op_sel:[0,1,0] op_sel_hi:[1,1,0]
    v_pk_fma_f32 v[144:145], v[144:145], v[96:97], v[104:105]
    v_pk_fma_f32 v[146:147], v[146:147], v[98:99], v[106:107]
    v_pk_fma_f32 v[148:149], v[148:149], v[100:101], v[108:109]
    v_pk_fma_f32 v[150:151], v[150:151], v[102:103], v[110:111]
    v_pk_mul_f32 v[144:145], v[144:145], v[152:153]
    v_pk_mul_f32 v[146:147], v[146:147], v[154:155]
    v_pk_mul_f32 v[148:149], v[148:149], v[156:157]
    v_pk_mul_f32 v[150:151], v[150:151], v[158:159]
    v_pk_fma_f32 v[88:89], v[112:113], v[144:145], v[88:89]
    v_pk_fma_f32 v[90:91], v[114:115], v[146:147], v[90:91]
    v_pk_fma_f32 v[92:93], v[116:117], v[148:149], v[92:93]
    v_pk_fma_f32 v[94:95], v[118:119], v[150:151], v[94:95]
    v_cvt_pk_bf16_f32 v32, v88, v89
    v_cvt_pk_bf16_f32 v33, v90, v91
    v_cvt_pk_bf16_f32 v34, v92, v93
    v_cvt_pk_bf16_f32 v35, v94, v95
    v_dot2_f32_bf16 v124, v32, v126, v124
    v_dot2_f32_bf16 v125, v32, v32, v125
    v_dot2_f32_bf16 v124, v33, v126, v124
    v_dot2_f32_bf16 v125, v33, v33, v125
    v_dot2_f32_bf16 v124, v34, v126, v124
    v_dot2_f32_bf16 v125, v34, v34, v125
    v_dot2_f32_bf16 v124, v35, v126, v124
    v_dot2_f32_bf16 v125, v35, v35, v125
    v_and_b32 v191, 31, v1
    v_lshlrev_b32 v191, 2, v191
    s_add_u32 s41, s37, 7424
    buffer_load_dword v190, v191, s[12:15], s41 offen sc1
    ds_read_b128 v[96:99], v10 offset:10240
    ds_read_b128 v[100:103], v10 offset:10256
    ds_read_b128 v[104:107], v10 offset:7680
    ds_read_b128 v[108:111], v10 offset:7696
    s_nop 1
    s_nop 0
    v_add_f32_dpp v124, v124, v124 quad_perm:[1,0,3,2] row_mask:0xf bank_mask:0xf
    v_add_f32_dpp v125, v125, v125 quad_perm:[1,0,3,2] row_mask:0xf bank_mask:0xf
    s_nop 0
    v_add_f32_dpp v124, v124, v124 quad_perm:[2,3,0,1] row_mask:0xf bank_mask:0xf
    v_add_f32_dpp v125, v125, v125 quad_perm:[2,3,0,1] row_mask:0xf bank_mask:0xf
    s_nop 0
    v_add_f32_dpp v124, v124, v124 row_half_mirror row_mask:0xf bank_mask:0xf
    v_add_f32_dpp v125, v125, v125 row_half_mirror row_mask:0xf bank_mask:0xf
    s_nop 0
    v_add_f32_dpp v124, v124, v124 row_mirror row_mask:0xf bank_mask:0xf
    v_add_f32_dpp v125, v125, v125 row_mirror row_mask:0xf bank_mask:0xf
    v_mul_f32 v124, 0x3acccccd, v124
    v_mul_f32 v125, 0x3acccccd, v125
    v_fma_f32 v125, -v124, v124, v125
    v_max_f32 v125, 0, v125
    v_cvt_pk_bf16_f32 v122, v124, v125
    v_lshlrev_b32 v124, 16, v122
    v_and_b32 v125, 0xffff0000, v122
    v_add_f32 v125, 0x3727c5ac, v125
    v_cvt_pk_bf16_f32 v122, v125, v125
    v_lshlrev_b32 v125, 16, v122
    v_sqrt_f32 v125, v125
    s_nop 0
    v_cvt_pk_bf16_f32 v122, v125, v125
    v_lshlrev_b32 v125, 16, v122
    v_rcp_f32 v125, v125
    s_nop 0
    v_mul_f32 v124, v124, v125
    v_sub_f32 v124, 0, v124
    v_mov_b32 v120, 0
    v_mov_b32 v121, 0
    ds_read_b128 v[160:163], v10 offset:10752
    ds_read_b128 v[164:167], v10 offset:10768
    ds_read_b128 v[168:171], v10 offset:8192
    ds_read_b128 v[172:175], v10 offset:8208
    s_waitcnt lgkmcnt(4)
    v_pk_fma_f32 v[56:57], v[56:57], v[124:125], v[124:125] op_sel:[0,1,0] op_sel_hi:[1,1,0]
    v_pk_fma_f32 v[58:59], v[58:59], v[124:125], v[124:125] op_sel:[0,1,0] op_sel_hi:[1,1,0]
    v_pk_fma_f32 v[60:61], v[60:61], v[124:125], v[124:125] op_sel:[0,1,0] op_sel_hi:[1,1,0]
    v_pk_fma_f32 v[62:63], v[62:63], v[124:125], v[124:125] op_sel:[0,1,0] op_sel_hi:[1,1,0]
    v_pk_fma_f32 v[56:57], v[56:57], v[96:97], v[104:105]
    v_pk_fma_f32 v[58:59], v[58:59], v[98:99], v[106:107]
    v_pk_fma_f32 v[60:61], v[60:61], v[100:101], v[108:109]
    v_pk_fma_f32 v[62:63], v[62:63], v[102:103], v[110:111]
    v_cvt_pk_bf16_f32 v36, v56, v57
    v_cvt_pk_bf16_f32 v37, v58, v59
    v_cvt_pk_bf16_f32 v38, v60, v61
    v_cvt_pk_bf16_f32 v39, v62, v63
    v_dot2_f32_bf16 v120, v36, v126, v120
    v_dot2_f32_bf16 v121, v36, v36, v121
    v_dot2_f32_bf16 v120, v37, v126, v120
    v_dot2_f32_bf16 v121, v37, v37, v121
    v_dot2_f32_bf16 v120, v38, v126, v120
    v_dot2_f32_bf16 v121, v38, v38, v121
    v_dot2_f32_bf16 v120, v39, v126, v120
    v_dot2_f32_bf16 v121, v39, v39, v121
    ds_read_b128 v[96:99], v10 offset:11264
    ds_read_b128 v[100:103], v10 offset:11280
    ds_read_b128 v[104:107], v10 offset:8704
    ds_read_b128 v[108:111], v10 offset:8720
    s_waitcnt lgkmcnt(4)
    v_pk_fma_f32 v[64:65], v[64:65], v[124:125], v[124:125] op_sel:[0,1,0] op_sel_hi:[1,1,0]
    v_pk_fma_f32 v[66:67], v[66:67], v[124:125], v[124:125] op_sel:[0,1,0] op_sel_hi:[1,1,0]
    v_pk_fma_f32 v[68:69], v[68:69], v[124:125], v[124:125] op_sel:[0,1,0] op_sel_hi:[1,1,0]
    v_pk_fma_f32 v[70:71], v[70:71], v[124:125], v[124:125] op_sel:[0,1,0] op_sel_hi:[1,1,0]
    v_pk_fma_f32 v[64:65], v[64:65], v[160:161], v[168:169]
    v_pk_fma_f32 v[66:67], v[66:67], v[162:163], v[170:171]
    v_pk_fma_f32 v[68:69], v[68:69], v[164:165], v[172:173]
    v_pk_fma_f32 v[70:71], v[70:71], v[166:167], v[174:175]
    v_cvt_pk_bf16_f32 v40, v64, v65
    v_cvt_pk_bf16_f32 v41, v66, v67
    v_cvt_pk_bf16_f32 v42, v68, v69
    v_cvt_pk_bf16_f32 v43, v70, v71
    v_dot2_f32_bf16 v120, v40, v126, v120
    v_dot2_f32_bf16 v121, v40, v40, v121
    v_dot2_f32_bf16 v120, v41, v126, v120
    v_dot2_f32_bf16 v121, v41, v41, v121
    v_dot2_f32_bf16 v120, v42, v126, v120
    v_dot2_f32_bf16 v121, v42, v42, v121
    v_dot2_f32_bf16 v120, v43, v126, v120
    v_dot2_f32_bf16 v121, v43, v43, v121
    ds_read_b128 v[160:163], v10 offset:11776
    ds_read_b128 v[164:167], v10 offset:11792
    ds_read_b128 v[168:171], v10 offset:9216
    ds_read_b128 v[172:175], v10 offset:9232
    s_waitcnt lgkmcnt(4)
    v_pk_fma_f32 v[72:73], v[72:73], v[124:125], v[124:125] op_sel:[0,1,0] op_sel_hi:[1,1,0]
    v_pk_fma_f32 v[74:75], v[74:75], v[124:125], v[124:125] op_sel:[0,1,0] op_sel_hi:[1,1,0]
    v_pk_fma_f32 v[76:77], v[76:77], v[124:125], v[124:125] op_sel:[0,1,0] op_sel_hi:[1,1,0]
    v_pk_fma_f32 v[78:79], v[78:79], v[124:125], v[124:125] op_sel:[0,1,0] op_sel_hi:[1,1,0]
    v_pk_fma_f32 v[72:73], v[72:73], v[96:97], v[104:105]
    v_pk_fma_f32 v[74:75], v[74:75], v[98:99], v[106:107]
    v_pk_fma_f32 v[76:77], v[76:77], v[100:101], v[108:109]
    v_pk_fma_f32 v[78:79], v[78:79], v[102:103], v[110:111]
    v_cvt_pk_bf16_f32 v44, v72, v73
    v_cvt_pk_bf16_f32 v45, v74, v75
    v_cvt_pk_bf16_f32 v46, v76, v77
    v_cvt_pk_bf16_f32 v47, v78, v79
    v_dot2_f32_bf16 v120, v44, v126, v120
    v_dot2_f32_bf16 v121, v44, v44, v121
    v_dot2_f32_bf16 v120, v45, v126, v120
    v_dot2_f32_bf16 v121, v45, v45, v121
    v_dot2_f32_bf16 v120, v46, v126, v120
    v_dot2_f32_bf16 v121, v46, v46, v121
    v_dot2_f32_bf16 v120, v47, v126, v120
    v_dot2_f32_bf16 v121, v47, v47, v121
    ds_read_b128 v[96:99], v10 offset:12288
    ds_read_b128 v[100:103], v10 offset:12304
    ds_read_b128 v[104:107], v10 offset:9728
    ds_read_b128 v[108:111], v10 offset:9744
    s_waitcnt lgkmcnt(4)
    v_pk_fma_f32 v[80:81], v[80:81], v[124:125], v[124:125] op_sel:[0,1,0] op_sel_hi:[1,1,0]
    v_pk_fma_f32 v[82:83], v[82:83], v[124:125], v[124:125] op_sel:[0,1,0] op_sel_hi:[1,1,0]
    v_pk_fma_f32 v[84:85], v[84:85], v[124:125], v[124:125] op_sel:[0,1,0] op_sel_hi:[1,1,0]
    v_pk_fma_f32 v[86:87], v[86:87], v[124:125], v[124:125] op_sel:[0,1,0] op_sel_hi:[1,1,0]
    v_pk_fma_f32 v[80:81], v[80:81], v[160:161], v[168:169]
    v_pk_fma_f32 v[82:83], v[82:83], v[162:163], v[170:171]
    v_pk_fma_f32 v[84:85], v[84:85], v[164:165], v[172:173]
    v_pk_fma_f32 v[86:87], v[86:87], v[166:167], v[174:175]
    v_cvt_pk_bf16_f32 v48, v80, v81
    v_cvt_pk_bf16_f32 v49, v82, v83
    v_cvt_pk_bf16_f32 v50, v84, v85
    v_cvt_pk_bf16_f32 v51, v86, v87
    v_dot2_f32_bf16 v120, v48, v126, v120
    v_dot2_f32_bf16 v121, v48, v48, v121
    v_dot2_f32_bf16 v120, v49, v126, v120
    v_dot2_f32_bf16 v121, v49, v49, v121
    v_dot2_f32_bf16 v120, v50, v126, v120
    v_dot2_f32_bf16 v121, v50, v50, v121
    v_dot2_f32_bf16 v120, v51, v126, v120
    v_dot2_f32_bf16 v121, v51, v51, v121
    s_waitcnt lgkmcnt(0)
    v_pk_fma_f32 v[88:89], v[88:89], v[124:125], v[124:125] op_sel:[0,1,0] op_sel_hi:[1,1,0]
    v_pk_fma_f32 v[90:91], v[90:91], v[124:125], v[124:125] op_sel:[0,1,0] op_sel_hi:[1,1,0]
    v_pk_fma_f32 v[92:93], v[92:93], v[124:125], v[124:125] op_sel:[0,1,0] op_sel_hi:[1,1,0]
    v_pk_fma_f32 v[94:95], v[94:95], v[124:125], v[124:125] op_sel:[0,1,0] op_sel_hi:[1,1,0]
    v_pk_fma_f32 v[88:89], v[88:89], v[96:97], v[104:105]
    v_pk_fma_f32 v[90:91], v[90:91], v[98:99], v[106:107]
    v_pk_fma_f32 v[92:93], v[92:93], v[100:101], v[108:109]
    v_pk_fma_f32 v[94:95], v[94:95], v[102:103], v[110:111]
    v_cvt_pk_bf16_f32 v52, v88, v89
    v_cvt_pk_bf16_f32 v53, v90, v91
    v_cvt_pk_bf16_f32 v54, v92, v93
    v_cvt_pk_bf16_f32 v55, v94, v95
    v_dot2_f32_bf16 v120, v52, v126, v120
    v_dot2_f32_bf16 v121, v52, v52, v121
    v_dot2_f32_bf16 v120, v53, v126, v120
    v_dot2_f32_bf16 v121, v53, v53, v121
    v_dot2_f32_bf16 v120, v54, v126, v120
    v_dot2_f32_bf16 v121, v54, v54, v121
    v_dot2_f32_bf16 v120, v55, v126, v120
    v_dot2_f32_bf16 v121, v55, v55, v121
    s_nop 1
    s_nop 0
    v_add_f32_dpp v120, v120, v120 quad_perm:[1,0,3,2] row_mask:0xf bank_mask:0xf
    v_add_f32_dpp v121, v121, v121 quad_perm:[1,0,3,2] row_mask:0xf bank_mask:0xf
    s_nop 0
    v_add_f32_dpp v120, v120, v120 quad_perm:[2,3,0,1] row_mask:0xf bank_mask:0xf
    v_add_f32_dpp v121, v121, v121 quad_perm:[2,3,0,1] row_mask:0xf bank_mask:0xf
    s_nop 0
    v_add_f32_dpp v120, v120, v120 row_half_mirror row_mask:0xf bank_mask:0xf
    v_add_f32_dpp v121, v121, v121 row_half_mirror row_mask:0xf bank_mask:0xf
    s_nop 0
    v_add_f32_dpp v120, v120, v120 row_mirror row_mask:0xf bank_mask:0xf
    v_add_f32_dpp v121, v121, v121 row_mirror row_mask:0xf bank_mask:0xf
    v_mul_f32 v120, 0x3acccccd, v120
    v_mul_f32 v121, 0x3acccccd, v121
    v_fma_f32 v121, -v120, v120, v121
    v_max_f32 v121, 0, v121
    v_cvt_pk_bf16_f32 v122, v120, v121
    v_lshlrev_b32 v120, 16, v122
    v_and_b32 v121, 0xffff0000, v122
    v_add_f32 v121, 0x3727c5ac, v121
    v_cvt_pk_bf16_f32 v122, v121, v121
    v_lshlrev_b32 v121, 16, v122
    v_sqrt_f32 v121, v121
    s_nop 0
    v_cvt_pk_bf16_f32 v122, v121, v121
    v_lshlrev_b32 v121, 16, v122
    v_rcp_f32 v121, v121
    s_nop 0
    v_mul_f32 v120, v120, v121
    v_sub_f32 v120, 0, v120
    v_cndmask_b32 v120, 0, v120, s[50:51]
    v_cndmask_b32 v121, 0, v121, s[50:51]
    s_mul_i32 s46, s29, 20480
    s_add_u32 s46, s46, s36
    s_add_u32 s47, s46, 348160
    s_lshl_b32 s48, s29, 7
    s_add_u32 s48, s48, s36
    s_add_u32 s48, s48, 1597440
    v_lshlrev_b32 v12, 3, v15
    s_lshl_b32 s49, s29, 7
    s_add_u32 s49, s49, s37
    s_lshl_b32 s41, s30, 2
    s_add_u32 s49, s49, s41
    s_waitcnt vmcnt(0)
    s_mov_b32 s43, 200000
k2_kernel_xp7:
    v_cmp_ne_u32 vcc, 0, v190
    s_sub_u32 s43, s43, 1
    s_cmp_eq_u64 vcc, -1
    s_cbranch_scc1 k2_kernel_xd8
    s_cmp_eq_u32 s43, 0
    s_cbranch_scc1 k2_kernel_xd8
    s_add_u32 s41, s37, 7424
    buffer_load_dword v190, v191, s[12:15], s41 offen sc1
    s_waitcnt vmcnt(0)
    s_branch k2_kernel_xp7
k2_kernel_xd8:
    v_cmp_eq_u32 vcc, s42, v190
    s_nop 1
    s_cmp_eq_u64 vcc, -1
    s_cselect_b32 s31, 1, 0
    s_barrier
    v_and_b32 v9, 7, v4
    v_xor_b32 v9, v15, v9
    v_and_b32 v10, 3, v4
    v_lshl_add_u32 v9, v10, 4, v9
    v_lshrrev_b32 v10, 2, v4
    v_lshl_add_u32 v9, v10, 6, v9
    v_lshlrev_b32 v9, 4, v9
    v_add_u32 v9, 114688, v9
    ds_write_b128 v9, v[36:39] offset:0
    ds_write_b128 v9, v[16:19] offset:20480
    ds_write_b128 v9, v[40:43] offset:4096
    ds_write_b128 v9, v[20:23] offset:24576
    ds_write_b128 v9, v[44:47] offset:8192
    ds_write_b128 v9, v[24:27] offset:28672
    ds_write_b128 v9, v[48:51] offset:12288
    ds_write_b128 v9, v[28:31] offset:32768
    ds_write_b128 v9, v[52:55] offset:16384
    ds_write_b128 v9, v[32:35] offset:36864
    v_xor_b32 v9, v4, v3
    v_xor_b32 v10, 4, v9
    v_lshl_add_u32 v9, v3, 4, v9
    v_lshl_add_u32 v10, v3, 4, v10
    s_mul_i32 s41, s30, 5120
    s_add_u32 s41, s41, 114688
    v_lshl_add_u32 v9, v9, 4, s41
    v_lshl_add_u32 v10, v10, 4, s41
    s_cmp_eq_u32 s30, 1
    s_cselect_b32 s41, 1, 0
    s_cmp_eq_u32 s30, 3
    s_cselect_b32 s41, 1, s41
    s_cmp_eq_u32 s41, 1
    v_mov_b32 v11, v9
    s_cbranch_scc0 k2_noswap
    v_mov_b32 v9, v10
    v_mov_b32 v10, v11
k2_noswap:
    s_mul_i32 s41, s30, 5120
    s_add_u32 s46, s46, s41
    s_add_u32 s47, s47, s41
    s_waitcnt lgkmcnt(0)
    s_barrier
    ds_read_b128 v[36:39], v9 offset:0
    ds_read_b128 v[40:43], v10 offset:1024
    ds_read_b128 v[44:47], v9 offset:2048
    ds_read_b128 v[48:51], v10 offset:3072
    ds_read_b128 v[52:55], v9 offset:4096
    ds_read_b128 v[220:223], v9 offset:20480
    ds_read_b128 v[224:227], v10 offset:21504
    ds_read_b128 v[228:231], v9 offset:22528
    ds_read_b128 v[232:235], v10 offset:23552
    ds_read_b128 v[236:239], v9 offset:24576
    s_add_u32 s52, s46, 4096
    s_sub_u32 s41, s29, 1
    s_cmp_lt_u32 s41, 16
    s_cselect_b32 s20, s47, 0x90000000
    s_cmp_eq_u32 s31, 0
    s_cbranch_scc1 k2_kernel_slow9
    s_waitcnt lgkmcnt(9)
    buffer_store_dwordx4 v[36:39], v2, s[12:15], s46 offen offset:0
    s_waitcnt lgkmcnt(8)
    buffer_store_dwordx4 v[40:43], v2, s[12:15], s46 offen offset:1024
    s_waitcnt lgkmcnt(7)
    buffer_store_dwordx4 v[44:47], v2, s[12:15], s46 offen offset:2048
    s_waitcnt lgkmcnt(6)
    buffer_store_dwordx4 v[48:51], v2, s[12:15], s46 offen offset:3072
    s_waitcnt lgkmcnt(5)
    buffer_store_dwordx4 v[52:55], v2, s[12:15], s52 offen offset:0
    v_cmp_eq_u32 vcc, 0, v4
    s_and_saveexec_b64 s[50:51], vcc
    buffer_store_dwordx2 v[120:121], v12, s[12:15], s48 offen
    s_mov_b64 exec, -1
    s_waitcnt vmcnt(0)
    v_mov_b32 v9, 1
    v_mov_b32 v10, 0
    s_mov_b64 exec, 1
    buffer_store_dword v9, v10, s[12:15], s49 offen
    s_mov_b64 exec, -1
    s_branch k2_kernel_sent10
k2_kernel_slow9:
    s_waitcnt lgkmcnt(9)
    buffer_store_dwordx4 v[36:39], v2, s[12:15], s46 offen offset:0 sc1
    s_waitcnt lgkmcnt(8)
    buffer_store_dwordx4 v[40:43], v2, s[12:15], s46 offen offset:1024 sc1
    s_waitcnt lgkmcnt(7)
    buffer_store_dwordx4 v[44:47], v2, s[12:15], s46 offen offset:2048 sc1
    s_waitcnt lgkmcnt(6)
    buffer_store_dwordx4 v[48:51], v2, s[12:15], s46 offen offset:3072 sc1
    s_waitcnt lgkmcnt(5)
    buffer_store_dwordx4 v[52:55], v2, s[12:15], s52 offen offset:0 sc1
    v_cmp_eq_u32 vcc, 0, v4
    s_and_saveexec_b64 s[50:51], vcc
    buffer_store_dwordx2 v[120:121], v12, s[12:15], s48 offen sc1
    s_mov_b64 exec, -1
    s_waitcnt vmcnt(0)
    v_mov_b32 v9, 1
    v_mov_b32 v10, 0
    s_mov_b64 exec, 1
    buffer_store_dword v9, v10, s[12:15], s49 offen sc1
    s_mov_b64 exec, -1
k2_kernel_sent10:
    s_mov_b32 s21, s49
    s_mov_b32 m0, s38
    s_nop 0
    buffer_load_dwordx4 v2, s[12:15], s39 offen offset:0 lds
    s_mov_b32 m0, s38
    s_nop 0
    buffer_load_dwordx4 v2, s[12:15], s39 offen offset:1024 lds
    s_mov_b32 m0, s38
    s_nop 0
    buffer_load_dwordx4 v2, s[12:15], s39 offen offset:2048 lds
    s_mov_b32 m0, s38
    s_nop 0
    buffer_load_dwordx4 v2, s[12:15], s39 offen offset:3072 lds
    s_add_u32 s38, s38, 4096
    s_add_u32 s39, s39, 4096
    s_mov_b32 m0, s38
    s_nop 0
    buffer_load_dwordx4 v2, s[12:15], s39 offen offset:0 lds
    s_mov_b32 m0, s38
    s_nop 0
    buffer_load_dwordx4 v2, s[12:15], s39 offen offset:1024 lds
    s_mov_b32 m0, s38
    s_nop 0
    buffer_load_dwordx4 v2, s[12:15], s39 offen offset:2048 lds
    s_mov_b32 m0, s38
    s_nop 0
    buffer_load_dwordx4 v2, s[12:15], s39 offen offset:3072 lds
    s_add_u32 s38, s38, 4096
    s_add_u32 s39, s39, 4096
    s_mov_b32 m0, s38
    s_nop 0
    buffer_load_dwordx4 v2, s[12:15], s39 offen offset:0 lds
    s_mov_b32 m0, s38
    s_nop 0
    buffer_load_dwordx4 v2, s[12:15], s39 offen offset:1024 lds
    s_mov_b32 m0, s38
    s_nop 0
    buffer_load_dwordx4 v2, s[12:15], s39 offen offset:2048 lds
    s_mov_b32 m0, s38
    s_nop 0
    buffer_load_dwordx4 v2, s[12:15], s39 offen offset:3072 lds
    s_add_u32 s38, s38, 4096
    s_add_u32 s39, s39, 4096
    s_mov_b32 m0, s38
    s_nop 0
    buffer_load_dwordx4 v2, s[12:15], s39 offen offset:0 lds
    s_mov_b32 m0, s38
    s_nop 0
    buffer_load_dwordx4 v2, s[12:15], s39 offen offset:1024 lds
    s_mov_b32 m0, s38
    s_nop 0
    buffer_load_dwordx4 v2, s[12:15], s39 offen offset:2048 lds
    s_mov_b32 m0, s38
    s_nop 0
    buffer_load_dwordx4 v2, s[12:15], s39 offen offset:3072 lds
    s_add_u32 s38, s38, 4096
    s_add_u32 s39, s39, 4096
    s_mov_b32 m0, s38
    s_nop 0
    buffer_load_dwordx4 v2, s[12:15], s39 offen offset:0 lds
    s_branch k2_kernel_join03
k2_kernel_nob02:
    s_mov_b32 s21, 0
    s_mov_b32 s20, 0x90000000
    s_mul_i32 s38, s30, 25600
    s_add_u32 s39, s38, s44
    s_add_u32 s39, s39, 2764800
    v_and_b32 v191, 31, v1
    v_lshlrev_b32 v191, 2, v191
    s_add_u32 s41, s37, 7424
    buffer_load_dword v190, v191, s[12:15], s41 offen sc1
    s_waitcnt vmcnt(0)
    s_mov_b32 s43, 200000
k2_kernel_xp11:
    v_cmp_ne_u32 vcc, 0, v190
    s_sub_u32 s43, s43, 1
    s_cmp_eq_u64 vcc, -1
    s_cbranch_scc1 k2_kernel_xd12
    s_cmp_eq_u32 s43, 0
    s_cbranch_scc1 k2_kernel_xd12
    s_add_u32 s41, s37, 7424
    buffer_load_dword v190, v191, s[12:15], s41 offen sc1
    s_waitcnt vmcnt(0)
    s_branch k2_kernel_xp11
k2_kernel_xd12:
    v_cmp_eq_u32 vcc, s42, v190
    s_nop 1
    s_cmp_eq_u64 vcc, -1
    s_cselect_b32 s31, 1, 0
    s_cmp_eq_u32 s30, 1
    s_cbranch_scc1 k2_kernel_sm13
    s_cmp_ge_u32 s30, 2
    s_cbranch_scc1 k2_kernel_sm14
    s_mul_i32 s41, s33, 320
    s_add_u32 s41, s41, 2748416
    s_mov_b32 m0, 155648
    s_mov_b64 exec, 0xfffff
    buffer_load_dwordx4 v2, s[12:15], s41 offen lds
    s_add_u32 s41, s41, 7168
    s_mov_b32 m0, 156160
    s_nop 0
    buffer_load_dwordx4 v2, s[12:15], s41 offen lds
    s_branch k2_kernel_sm15
k2_kernel_sm13:
    s_mul_i32 s41, s35, 448
    s_add_u32 s41, s41, 2732032
    s_mov_b32 m0, 156672
    s_mov_b64 exec, 0xfffffff
    buffer_load_dwordx4 v2, s[12:15], s41 offen lds
    s_add_u32 s41, s41, 7168
    s_mov_b32 m0, 157184
    s_nop 0
    buffer_load_dwordx4 v2, s[12:15], s41 offen lds
    s_branch k2_kernel_sm15
k2_kernel_sm14:
    s_mul_i32 s41, s33, 320
    s_add_u32 s41, s41, 2724352
    s_mov_b32 m0, 157696
    s_mov_b64 exec, 0xfffff
    buffer_load_dwordx4 v2, s[12:15], s41 offen lds
k2_kernel_sm15:
    s_mov_b64 exec, -1
    s_mov_b32 m0, s38
    s_nop 0
    buffer_load_dwordx4 v2, s[12:15], s39 offen offset:0 lds
    s_mov_b32 m0, s38
    s_nop 0
    buffer_load_dwordx4 v2, s[12:15], s39 offen offset:1024 lds
    s_mov_b32 m0, s38
    s_nop 0
    buffer_load_dwordx4 v2, s[12:15], s39 offen offset:2048 lds
    s_mov_b32 m0, s38
    s_nop 0
    buffer_load_dwordx4 v2, s[12:15], s39 offen offset:3072 lds
    s_add_u32 s38, s38, 4096
    s_add_u32 s39, s39, 4096
    s_mov_b32 m0, s38
    s_nop 0
    buffer_load_dwordx4 v2, s[12:15], s39 offen offset:0 lds
    s_mov_b32 m0, s38
    s_nop 0
    buffer_load_dwordx4 v2, s[12:15], s39 offen offset:1024 lds
    s_mov_b32 m0, s38
    s_nop 0
    buffer_load_dwordx4 v2, s[12:15], s39 offen offset:2048 lds
    s_mov_b32 m0, s38
    s_nop 0
    buffer_load_dwordx4 v2, s[12:15], s39 offen offset:3072 lds
    s_add_u32 s38, s38, 4096
    s_add_u32 s39, s39, 4096
    s_mov_b32 m0, s38
    s_nop 0
    buffer_load_dwordx4 v2, s[12:15], s39 offen offset:0 lds
    s_mov_b32 m0, s38
    s_nop 0
    buffer_load_dwordx4 v2, s[12:15], s39 offen offset:1024 lds
    s_mov_b32 m0, s38
    s_nop 0
    buffer_load_dwordx4 v2, s[12:15], s39 offen offset:2048 lds
    s_mov_b32 m0, s38
    s_nop 0
    buffer_load_dwordx4 v2, s[12:15], s39 offen offset:3072 lds
    s_add_u32 s38, s38, 4096
    s_add_u32 s39, s39, 4096
    s_mov_b32 m0, s38
    s_nop 0
    buffer_load_dwordx4 v2, s[12:15], s39 offen offset:0 lds
    s_mov_b32 m0, s38
    s_nop 0
    buffer_load_dwordx4 v2, s[12:15], s39 offen offset:1024 lds
    s_mov_b32 m0, s38
    s_nop 0
    buffer_load_dwordx4 v2, s[12:15], s39 offen offset:2048 lds
    s_mov_b32 m0, s38
    s_nop 0
    buffer_load_dwordx4 v2, s[12:15], s39 offen offset:3072 lds
    s_add_u32 s38, s38, 4096
    s_add_u32 s39, s39, 4096
    s_mov_b32 m0, s38
    s_nop 0
    buffer_load_dwordx4 v2, s[12:15], s39 offen offset:0 lds
    s_mov_b32 m0, s38
    s_nop 0
    buffer_load_dwordx4 v2, s[12:15], s39 offen offset:1024 lds
    s_mov_b32 m0, s38
    s_nop 0
    buffer_load_dwordx4 v2, s[12:15], s39 offen offset:2048 lds
    s_mov_b32 m0, s38
    s_nop 0
    buffer_load_dwordx4 v2, s[12:15], s39 offen offset:3072 lds
    s_add_u32 s38, s38, 4096
    s_add_u32 s39, s39, 4096
    s_mov_b32 m0, s38
    s_nop 0
    buffer_load_dwordx4 v2, s[12:15], s39 offen offset:0 lds
    s_mov_b32 m0, s38
    s_nop 0
    buffer_load_dwordx4 v2, s[12:15], s39 offen offset:1024 lds
    s_mov_b32 m0, s38
    s_nop 0
    buffer_load_dwordx4 v2, s[12:15], s39 offen offset:2048 lds
    s_mov_b32 m0, s38
    s_nop 0
    buffer_load_dwordx4 v2, s[12:15], s39 offen offset:3072 lds
    s_add_u32 s38, s38, 4096
    s_add_u32 s39, s39, 4096
    s_mov_b32 m0, s38
    s_nop 0
    buffer_load_dwordx4 v2, s[12:15], s39 offen offset:0 lds
    s_mul_i32 s47, s28, 327680
    s_lshl_b32 s48, s29, 13
    s_add_u32 s47, s47, s48
    v_mov_b32 v101, 0
    s_mov_b64 exec, 1
    buffer_load_dword v102, v101, s[24:27], s47 offen
    s_mov_b64 exec, -1
    s_cmp_eq_u32 s31, 0
    s_cbranch_scc1 k2_kernel_nt16
    s_sub_u32 s47, s29, 18
    s_lshl_b32 s47, s47, 2
    s_add_u32 s47, s47, s30
    s_mul_i32 s48, s47, 6144
    s_min_u32 s48, s48, 321536
    s_mul_i32 s49, s28, 327680
    s_add_u32 s48, s48, s49
    s_add_u32 s48, s48, 0
    buffer_load_dwordx4 v[64:67], v2, s[12:15], s48 offen offset:0
    buffer_load_dwordx4 v[68:71], v2, s[12:15], s48 offen offset:1024
    buffer_load_dwordx4 v[72:75], v2, s[12:15], s48 offen offset:2048
    buffer_load_dwordx4 v[76:79], v2, s[12:15], s48 offen offset:3072
    s_add_u32 s48, s48, 4096
    buffer_load_dwordx4 v[80:83], v2, s[12:15], s48 offen offset:0
    buffer_load_dwordx4 v[84:87], v2, s[12:15], s48 offen offset:1024
    s_mul_i32 s48, s47, 384
    s_min_u32 s48, s48, 20096
    s_add_u32 s48, s48, s36
    s_add_u32 s48, s48, 1581056
    s_mov_b64 exec, 7
    buffer_load_dword v100, v5, s[12:15], s48 offen
    s_mov_b64 exec, -1
k2_kernel_nt16:
k2_kernel_join03:
    s_lshl_b32 s46, s32, 2
    s_add_u32 s46, s46, s30
    s_lshr_b32 s47, s33, 1
    s_and_b32 s48, s47, 1
    s_lshr_b32 s47, s47, 1
    s_add_u32 s47, s47, 1
    s_sub_u32 s49, 0, s47
    s_cmp_eq_u32 s48, 1
    s_cselect_b32 s47, s47, s49
    s_lshl_b32 s49, s46, 4
    s_add_u32 s49, s49, 16
    s_add_u32 s49, s49, s47
    v_add_u32 v9, s49, v4
    v_lshrrev_b32 v10, 4, v9
    v_mul_u32_u24 v6, 20480, v10
    v_and_b32 v10, 15, v9
    v_lshl_add_u32 v10, v3, 4, v10
    v_lshl_add_u32 v6, v10, 4, v6
    v_lshlrev_b32 v13, 3, v9
    s_add_u32 s49, s46, s48
    s_lshl_b32 s49, s49, 7
    s_add_u32 s49, s49, s37
    v_bfe_u32 v7, v1, 2, 1
    v_lshlrev_b32 v7, 7, v7
    v_and_b32 v9, 3, v1
    v_lshl_add_u32 v7, v9, 2, v7
    s_mov_b32 s43, 200000
k2_kernel_poll17:
    buffer_load_dword v9, v7, s[12:15], s49 offen sc1
    s_waitcnt vmcnt(0)
    v_cmp_ne_u32 vcc, 0, v9
    s_sub_u32 s43, s43, 1
    s_cmp_eq_u64 vcc, -1
    s_cbranch_scc1 k2_kernel_go18
    s_cmp_lg_u32 s43, 0
    s_cbranch_scc1 k2_kernel_poll17
k2_kernel_go18:
    s_add_u32 s41, s36, 0
    buffer_load_dwordx4 v[16:19], v6, s[12:15], s41 offen offset:0 sc1
    s_add_u32 s41, s36, 0
    buffer_load_dwordx4 v[20:23], v6, s[12:15], s41 offen offset:1024 sc1
    s_add_u32 s41, s36, 0
    buffer_load_dwordx4 v[24:27], v6, s[12:15], s41 offen offset:2048 sc1
    s_add_u32 s41, s36, 0
    buffer_load_dwordx4 v[28:31], v6, s[12:15], s41 offen offset:3072 sc1
    s_add_u32 s41, s36, 1597440
    buffer_load_dwordx2 v[176:177], v13, s[12:15], s41 offen sc1
    v_mov_b32 v14, v2
    v_add_u32 v15, 0x10000, v2
    v_add_u32 v11, 0x20000, v2
    s_barrier
    s_mul_i32 s38, s30, 13312
    s_add_u32 s39, s38, s44
    s_add_u32 s39, s39, 3584000
    s_add_u32 s38, s38, 102400
    ds_read_b128 v[96:99], v14 offset:0
    ds_read_b128 v[100:103], v14 offset:1024
    ds_read_b128 v[104:107], v14 offset:2048
    ds_read_b128 v[108:111], v14 offset:3072
    ds_read_b128 v[112:115], v14 offset:4096
    ds_read_b128 v[116:119], v14 offset:5120
    ds_read_b128 v[120:123], v14 offset:6144
    ds_read_b128 v[124:127], v14 offset:7168
    ds_read_b128 v[128:131], v14 offset:8192
    ds_read_b128 v[132:135], v14 offset:9216
    s_waitcnt vmcnt(4)
    s_waitcnt lgkmcnt(5)
    v_mfma_f32_16x16x32_bf16 v[156:159], v[96:99], v[16:19], 0
    s_add_u32 s41, s36, 4096
    buffer_load_dwordx4 v[32:35], v6, s[12:15], s41 offen offset:0 sc1
    v_mfma_f32_16x16x32_bf16 v[160:163], v[100:103], v[16:19], 0
    ds_read_b128 v[136:139], v14 offset:10240
    v_mfma_f32_16x16x32_bf16 v[164:167], v[104:107], v[16:19], 0
    ds_read_b128 v[140:143], v14 offset:11264
    v_mfma_f32_16x16x32_bf16 v[168:171], v[108:111], v[16:19], 0
    ds_read_b128 v[144:147], v14 offset:12288
    s_add_u32 s41, s36, 4096
    buffer_load_dwordx4 v[36:39], v6, s[12:15], s41 offen offset:1024 sc1
    v_mfma_f32_16x16x32_bf16 v[172:175], v[112:115], v[16:19], 0
    ds_read_b128 v[148:151], v14 offset:13312
    ds_read_b128 v[152:155], v14 offset:14336
    s_waitcnt vmcnt(5)
    s_waitcnt lgkmcnt(5)
    v_mfma_f32_16x16x32_bf16 v[156:159], v[116:119], v[20:23], v[156:159]
    s_add_u32 s41, s36, 4096
    buffer_load_dwordx4 v[40:43], v6, s[12:15], s41 offen offset:2048 sc1
    v_mfma_f32_16x16x32_bf16 v[160:163], v[120:123], v[20:23], v[160:163]
    ds_read_b128 v[96:99], v14 offset:15360
    v_mfma_f32_16x16x32_bf16 v[164:167], v[124:127], v[20:23], v[164:167]
    ds_read_b128 v[100:103], v14 offset:16384
    v_mfma_f32_16x16x32_bf16 v[168:171], v[128:131], v[20:23], v[168:171]
    ds_read_b128 v[104:107], v14 offset:17408
    s_add_u32 s41, s36, 4096
    buffer_load_dwordx4 v[44:47], v6, s[12:15], s41 offen offset:3072 sc1
    v_mfma_f32_16x16x32_bf16 v[172:175], v[132:135], v[20:23], v[172:175]
    ds_read_b128 v[108:111], v14 offset:18432
    ds_read_b128 v[112:115], v14 offset:19456
    s_waitcnt vmcnt(6)
    s_waitcnt lgkmcnt(5)
    v_mfma_f32_16x16x32_bf16 v[156:159], v[136:139], v[24:27], v[156:159]
    s_add_u32 s41, s36, 8192
    buffer_load_dwordx4 v[48:51], v6, s[12:15], s41 offen offset:0 sc1
    v_mfma_f32_16x16x32_bf16 v[160:163], v[140:143], v[24:27], v[160:163]
    ds_read_b128 v[116:119], v14 offset:20480
    v_mfma_f32_16x16x32_bf16 v[164:167], v[144:147], v[24:27], v[164:167]
    ds_read_b128 v[120:123], v14 offset:21504
    v_mfma_f32_16x16x32_bf16 v[168:171], v[148:151], v[24:27], v[168:171]
    ds_read_b128 v[124:127], v14 offset:22528
    s_add_u32 s41, s36, 8192
    buffer_load_dwordx4 v[52:55], v6, s[12:15], s41 offen offset:1024 sc1
    v_mfma_f32_16x16x32_bf16 v[172:175], v[152:155], v[24:27], v[172:175]
    ds_read_b128 v[128:131], v14 offset:23552
    ds_read_b128 v[132:135], v14 offset:24576
    s_waitcnt vmcnt(7)
    s_waitcnt lgkmcnt(5)
    v_mfma_f32_16x16x32_bf16 v[156:159], v[96:99], v[28:31], v[156:159]
    s_add_u32 s41, s36, 8192
    buffer_load_dwordx4 v[56:59], v6, s[12:15], s41 offen offset:2048 sc1
    v_mfma_f32_16x16x32_bf16 v[160:163], v[100:103], v[28:31], v[160:163]
    ds_read_b128 v[136:139], v14 offset:25600
    v_mfma_f32_16x16x32_bf16 v[164:167], v[104:107], v[28:31], v[164:167]
    ds_read_b128 v[140:143], v14 offset:26624
    v_mfma_f32_16x16x32_bf16 v[168:171], v[108:111], v[28:31], v[168:171]
    ds_read_b128 v[144:147], v14 offset:27648
    s_add_u32 s41, s36, 8192
    buffer_load_dwordx4 v[60:63], v6, s[12:15], s41 offen offset:3072 sc1
    v_mfma_f32_16x16x32_bf16 v[172:175], v[112:115], v[28:31], v[172:175]
    ds_read_b128 v[148:151], v14 offset:28672
    ds_read_b128 v[152:155], v14 offset:29696
    s_waitcnt vmcnt(7)
    s_waitcnt lgkmcnt(5)
    v_mfma_f32_16x16x32_bf16 v[156:159], v[116:119], v[32:35], v[156:159]
    s_add_u32 s41, s36, 12288
    buffer_load_dwordx4 v[64:67], v6, s[12:15], s41 offen offset:0 sc1
    v_mfma_f32_16x16x32_bf16 v[160:163], v[120:123], v[32:35], v[160:163]
    ds_read_b128 v[96:99], v14 offset:30720
    v_mfma_f32_16x16x32_bf16 v[164:167], v[124:127], v[32:35], v[164:167]
    ds_read_b128 v[100:103], v14 offset:31744
    v_mfma_f32_16x16x32_bf16 v[168:171], v[128:131], v[32:35], v[168:171]
    ds_read_b128 v[104:107], v14 offset:32768
    s_add_u32 s41, s36, 12288
    buffer_load_dwordx4 v[68:71], v6, s[12:15], s41 offen offset:1024 sc1
    v_mfma_f32_16x16x32_bf16 v[172:175], v[132:135], v[32:35], v[172:175]
    ds_read_b128 v[108:111], v14 offset:33792
    ds_read_b128 v[112:115], v14 offset:34816
    s_waitcnt vmcnt(8)
    s_waitcnt lgkmcnt(5)
    v_mfma_f32_16x16x32_bf16 v[156:159], v[136:139], v[36:39], v[156:159]
    s_add_u32 s41, s36, 12288
    buffer_load_dwordx4 v[72:75], v6, s[12:15], s41 offen offset:2048 sc1
    v_mfma_f32_16x16x32_bf16 v[160:163], v[140:143], v[36:39], v[160:163]
    ds_read_b128 v[116:119], v14 offset:35840
    v_mfma_f32_16x16x32_bf16 v[164:167], v[144:147], v[36:39], v[164:167]
    ds_read_b128 v[120:123], v14 offset:36864
    v_mfma_f32_16x16x32_bf16 v[168:171], v[148:151], v[36:39], v[168:171]
    ds_read_b128 v[124:127], v14 offset:37888
    s_add_u32 s41, s36, 12288
    buffer_load_dwordx4 v[76:79], v6, s[12:15], s41 offen offset:3072 sc1
    v_mfma_f32_16x16x32_bf16 v[172:175], v[152:155], v[36:39], v[172:175]
    ds_read_b128 v[128:131], v14 offset:38912
    ds_read_b128 v[132:135], v14 offset:39936
    s_waitcnt vmcnt(9)
    s_waitcnt lgkmcnt(5)
    v_mfma_f32_16x16x32_bf16 v[156:159], v[96:99], v[40:43], v[156:159]
    s_add_u32 s41, s36, 16384
    buffer_load_dwordx4 v[80:83], v6, s[12:15], s41 offen offset:0 sc1
    v_mfma_f32_16x16x32_bf16 v[160:163], v[100:103], v[40:43], v[160:163]
    ds_read_b128 v[136:139], v14 offset:40960
    v_mfma_f32_16x16x32_bf16 v[164:167], v[104:107], v[40:43], v[164:167]
    ds_read_b128 v[140:143], v14 offset:41984
    v_mfma_f32_16x16x32_bf16 v[168:171], v[108:111], v[40:43], v[168:171]
    ds_read_b128 v[144:147], v14 offset:43008
    s_add_u32 s41, s36, 16384
    buffer_load_dwordx4 v[84:87], v6, s[12:15], s41 offen offset:1024 sc1
    v_mfma_f32_16x16x32_bf16 v[172:175], v[112:115], v[40:43], v[172:175]
    ds_read_b128 v[148:151], v14 offset:44032
    ds_read_b128 v[152:155], v14 offset:45056
    s_waitcnt vmcnt(10)
    s_waitcnt lgkmcnt(5)
    v_mfma_f32_16x16x32_bf16 v[156:159], v[116:119], v[44:47], v[156:159]
    s_add_u32 s41, s36, 16384
    buffer_load_dwordx4 v[88:91], v6, s[12:15], s41 offen offset:2048 sc1
    v_mfma_f32_16x16x32_bf16 v[160:163], v[120:123], v[44:47], v[160:163]
    ds_read_b128 v[96:99], v14 offset:46080
    v_mfma_f32_16x16x32_bf16 v[164:167], v[124:127], v[44:47], v[164:167]
    ds_read_b128 v[100:103], v14 offset:47104
    v_mfma_f32_16x16x32_bf16 v[168:171], v[128:131], v[44:47], v[168:171]
    ds_read_b128 v[104:107], v14 offset:48128
    s_add_u32 s41, s36, 16384
    buffer_load_dwordx4 v[92:95], v6, s[12:15], s41 offen offset:3072 sc1
    v_mfma_f32_16x16x32_bf16 v[172:175], v[132:135], v[44:47], v[172:175]
    ds_read_b128 v[108:111], v14 offset:49152
    ds_read_b128 v[112:115], v14 offset:50176
    s_waitcnt vmcnt(11)
    s_waitcnt lgkmcnt(5)
    v_mfma_f32_16x16x32_bf16 v[156:159], v[136:139], v[48:51], v[156:159]
    v_mfma_f32_16x16x32_bf16 v[160:163], v[140:143], v[48:51], v[160:163]
    ds_read_b128 v[116:119], v14 offset:51200
    s_mov_b32 m0, s38
    s_nop 0
    buffer_load_dwordx4 v2, s[12:15], s39 offen offset:0 lds
    v_mfma_f32_16x16x32_bf16 v[164:167], v[144:147], v[48:51], v[164:167]
    ds_read_b128 v[120:123], v14 offset:52224
    v_mfma_f32_16x16x32_bf16 v[168:171], v[148:151], v[48:51], v[168:171]
    ds_read_b128 v[124:127], v14 offset:53248
    v_mfma_f32_16x16x32_bf16 v[172:175], v[152:155], v[48:51], v[172:175]
    ds_read_b128 v[128:131], v14 offset:54272
    ds_read_b128 v[132:135], v14 offset:55296
    s_add_u32 s41, s20, 0
    buffer_store_dwordx4 v[220:223], v2, s[12:15], s41 offen sc1
    s_waitcnt vmcnt(12)
    s_waitcnt lgkmcnt(5)
    s_barrier
    v_mfma_f32_16x16x32_bf16 v[156:159], v[96:99], v[52:55], v[156:159]
    v_mfma_f32_16x16x32_bf16 v[160:163], v[100:103], v[52:55], v[160:163]
    ds_read_b128 v[136:139], v14 offset:56320
    s_mov_b32 m0, s38
    s_nop 0
    buffer_load_dwordx4 v2, s[12:15], s39 offen offset:1024 lds
    v_mfma_f32_16x16x32_bf16 v[164:167], v[104:107], v[52:55], v[164:167]
    ds_read_b128 v[140:143], v14 offset:57344
    v_mfma_f32_16x16x32_bf16 v[168:171], v[108:111], v[52:55], v[168:171]
    ds_read_b128 v[144:147], v14 offset:58368
    v_mfma_f32_16x16x32_bf16 v[172:175], v[112:115], v[52:55], v[172:175]
    ds_read_b128 v[148:151], v14 offset:59392
    ds_read_b128 v[152:155], v14 offset:60416
    s_add_u32 s41, s20, 1024
    buffer_store_dwordx4 v[224:227], v2, s[12:15], s41 offen sc1
    s_waitcnt vmcnt(13)
    s_waitcnt lgkmcnt(5)
    v_mfma_f32_16x16x32_bf16 v[156:159], v[116:119], v[56:59], v[156:159]
    v_mfma_f32_16x16x32_bf16 v[160:163], v[120:123], v[56:59], v[160:163]
    ds_read_b128 v[96:99], v14 offset:61440
    s_mov_b32 m0, s38
    s_nop 0
    buffer_load_dwordx4 v2, s[12:15], s39 offen offset:2048 lds
    v_mfma_f32_16x16x32_bf16 v[164:167], v[124:127], v[56:59], v[164:167]
    ds_read_b128 v[100:103], v14 offset:62464
    v_mfma_f32_16x16x32_bf16 v[168:171], v[128:131], v[56:59], v[168:171]
    ds_read_b128 v[104:107], v14 offset:63488
    v_mfma_f32_16x16x32_bf16 v[172:175], v[132:135], v[56:59], v[172:175]
    ds_read_b128 v[108:111], v14 offset:64512
    ds_read_b128 v[112:115], v15 offset:0
    s_add_u32 s41, s20, 2048
    buffer_store_dwordx4 v[228:231], v2, s[12:15], s41 offen sc1
    s_waitcnt vmcnt(14)
    s_waitcnt lgkmcnt(5)
    v_mfma_f32_16x16x32_bf16 v[156:159], v[136:139], v[60:63], v[156:159]
    v_mfma_f32_16x16x32_bf16 v[160:163], v[140:143], v[60:63], v[160:163]
    ds_read_b128 v[116:119], v15 offset:1024
    s_mov_b32 m0, s38
    s_nop 0
    buffer_load_dwordx4 v2, s[12:15], s39 offen offset:3072 lds
    s_add_u32 s38, s38, 4096
    s_add_u32 s39, s39, 4096
    v_mfma_f32_16x16x32_bf16 v[164:167], v[144:147], v[60:63], v[164:167]
    ds_read_b128 v[120:123], v15 offset:2048
    v_mfma_f32_16x16x32_bf16 v[168:171], v[148:151], v[60:63], v[168:171]
    ds_read_b128 v[124:127], v15 offset:3072
    v_mfma_f32_16x16x32_bf16 v[172:175], v[152:155], v[60:63], v[172:175]
    ds_read_b128 v[128:131], v15 offset:4096
    ds_read_b128 v[132:135], v15 offset:5120
    s_add_u32 s41, s20, 3072
    buffer_store_dwordx4 v[232:235], v2, s[12:15], s41 offen sc1
    s_waitcnt vmcnt(15)
    s_waitcnt lgkmcnt(5)
    v_mfma_f32_16x16x32_bf16 v[156:159], v[96:99], v[64:67], v[156:159]
    v_mfma_f32_16x16x32_bf16 v[160:163], v[100:103], v[64:67], v[160:163]
    ds_read_b128 v[136:139], v15 offset:6144
    s_mov_b32 m0, s38
    s_nop 0
    buffer_load_dwordx4 v2, s[12:15], s39 offen offset:0 lds
    v_mfma_f32_16x16x32_bf16 v[164:167], v[104:107], v[64:67], v[164:167]
    ds_read_b128 v[140:143], v15 offset:7168
    v_mfma_f32_16x16x32_bf16 v[168:171], v[108:111], v[64:67], v[168:171]
    ds_read_b128 v[144:147], v15 offset:8192
    v_mfma_f32_16x16x32_bf16 v[172:175], v[112:115], v[64:67], v[172:175]
    ds_read_b128 v[148:151], v15 offset:9216
    ds_read_b128 v[152:155], v15 offset:10240
    s_add_u32 s41, s20, 4096
    buffer_store_dwordx4 v[236:239], v2, s[12:15], s41 offen sc1
    s_waitcnt vmcnt(16)
    s_waitcnt lgkmcnt(5)
    v_mfma_f32_16x16x32_bf16 v[156:159], v[116:119], v[68:71], v[156:159]
    v_mfma_f32_16x16x32_bf16 v[160:163], v[120:123], v[68:71], v[160:163]
    ds_read_b128 v[96:99], v15 offset:11264
    s_mov_b32 m0, s38
    s_nop 0
    buffer_load_dwordx4 v2, s[12:15], s39 offen offset:1024 lds
    v_mfma_f32_16x16x32_bf16 v[164:167], v[124:127], v[68:71], v[164:167]
    ds_read_b128 v[100:103], v15 offset:12288
    v_mfma_f32_16x16x32_bf16 v[168:171], v[128:131], v[68:71], v[168:171]
    ds_read_b128 v[104:107], v15 offset:13312
    v_mfma_f32_16x16x32_bf16 v[172:175], v[132:135], v[68:71], v[172:175]
    ds_read_b128 v[108:111], v15 offset:14336
    ds_read_b128 v[112:115], v15 offset:15360
    s_mov_b32 m0, s38
    s_nop 0
    buffer_load_dwordx4 v2, s[12:15], s39 offen offset:2048 lds
    s_waitcnt vmcnt(17)
    s_waitcnt lgkmcnt(5)
    v_mfma_f32_16x16x32_bf16 v[156:159], v[136:139], v[72:75], v[156:159]
    v_mfma_f32_16x16x32_bf16 v[160:163], v[140:143], v[72:75], v[160:163]
    ds_read_b128 v[116:119], v15 offset:16384
    s_mov_b32 m0, s38
    s_nop 0
    buffer_load_dwordx4 v2, s[12:15], s39 offen offset:3072 lds
    s_add_u32 s38, s38, 4096
    s_add_u32 s39, s39, 4096
    v_mfma_f32_16x16x32_bf16 v[164:167], v[144:147], v[72:75], v[164:167]
    ds_read_b128 v[120:123], v15 offset:17408
    v_mfma_f32_16x16x32_bf16 v[168:171], v[148:151], v[72:75], v[168:171]
    ds_read_b128 v[124:127], v15 offset:18432
    v_mfma_f32_16x16x32_bf16 v[172:175], v[152:155], v[72:75], v[172:175]
    ds_read_b128 v[128:131], v15 offset:19456
    ds_read_b128 v[132:135], v15 offset:20480
    s_mov_b32 m0, s38
    s_nop 0
    buffer_load_dwordx4 v2, s[12:15], s39 offen offset:0 lds
    s_waitcnt vmcnt(18)
    s_waitcnt lgkmcnt(5)
    v_mfma_f32_16x16x32_bf16 v[156:159], v[96:99], v[76:79], v[156:159]
    v_mfma_f32_16x16x32_bf16 v[160:163], v[100:103], v[76:79], v[160:163]
    ds_read_b128 v[136:139], v15 offset:21504
    s_mov_b32 m0, s38
    s_nop 0
    buffer_load_dwordx4 v2, s[12:15], s39 offen offset:1024 lds
    v_mfma_f32_16x16x32_bf16 v[164:167], v[104:107], v[76:79], v[164:167]
    ds_read_b128 v[140:143], v15 offset:22528
    v_mfma_f32_16x16x32_bf16 v[168:171], v[108:111], v[76:79], v[168:171]
    ds_read_b128 v[144:147], v15 offset:23552
    v_mfma_f32_16x16x32_bf16 v[172:175], v[112:115], v[76:79], v[172:175]
    ds_read_b128 v[148:151], v15 offset:24576
    ds_read_b128 v[152:155], v15 offset:25600
    s_mov_b32 m0, s38
    s_nop 0
    buffer_load_dwordx4 v2, s[12:15], s39 offen offset:2048 lds
    s_waitcnt vmcnt(19)
    s_waitcnt lgkmcnt(5)
    v_mfma_f32_16x16x32_bf16 v[156:159], v[116:119], v[80:83], v[156:159]
    v_mfma_f32_16x16x32_bf16 v[160:163], v[120:123], v[80:83], v[160:163]
    ds_read_b128 v[96:99], v15 offset:26624
    s_mov_b32 m0, s38
    s_nop 0
    buffer_load_dwordx4 v2, s[12:15], s39 offen offset:3072 lds
    s_add_u32 s38, s38, 4096
    s_add_u32 s39, s39, 4096
    v_mfma_f32_16x16x32_bf16 v[164:167], v[124:127], v[80:83], v[164:167]
    ds_read_b128 v[100:103], v15 offset:27648
    v_mfma_f32_16x16x32_bf16 v[168:171], v[128:131], v[80:83], v[168:171]
    ds_read_b128 v[104:107], v15 offset:28672
    v_mfma_f32_16x16x32_bf16 v[172:175], v[132:135], v[80:83], v[172:175]
    ds_read_b128 v[108:111], v15 offset:29696
    ds_read_b128 v[112:115], v15 offset:30720
    s_mov_b32 m0, s38
    s_nop 0
    buffer_load_dwordx4 v2, s[12:15], s39 offen offset:0 lds
    s_waitcnt vmcnt(20)
    s_waitcnt lgkmcnt(5)
    v_mfma_f32_16x16x32_bf16 v[156:159], v[136:139], v[84:87], v[156:159]
    v_mfma_f32_16x16x32_bf16 v[160:163], v[140:143], v[84:87], v[160:163]
    ds_read_b128 v[116:119], v15 offset:31744
    s_mul_i32 s38, s30, 12288
    s_add_u32 s39, s38, s44
    s_add_u32 s39, s39, 3637248
    s_add_u32 s38, s38, 0
    s_mov_b32 m0, s38
    s_nop 0
    buffer_load_dwordx4 v2, s[12:15], s39 offen offset:0 lds
    v_mfma_f32_16x16x32_bf16 v[164:167], v[144:147], v[84:87], v[164:167]
    ds_read_b128 v[120:123], v15 offset:32768
    v_mfma_f32_16x16x32_bf16 v[168:171], v[148:151], v[84:87], v[168:171]
    ds_read_b128 v[124:127], v15 offset:33792
    v_mfma_f32_16x16x32_bf16 v[172:175], v[152:155], v[84:87], v[172:175]
    ds_read_b128 v[128:131], v15 offset:34816
    ds_read_b128 v[132:135], v15 offset:35840
    s_mov_b32 m0, s38
    s_nop 0
    buffer_load_dwordx4 v2, s[12:15], s39 offen offset:1024 lds
    s_waitcnt vmcnt(21)
    s_waitcnt lgkmcnt(5)
    v_mfma_f32_16x16x32_bf16 v[156:159], v[96:99], v[88:91], v[156:159]
    v_mfma_f32_16x16x32_bf16 v[160:163], v[100:103], v[88:91], v[160:163]
    s_mov_b32 m0, s38
    s_nop 0
    buffer_load_dwordx4 v2, s[12:15], s39 offen offset:2048 lds
    v_mfma_f32_16x16x32_bf16 v[164:167], v[104:107], v[88:91], v[164:167]
    v_mfma_f32_16x16x32_bf16 v[168:171], v[108:111], v[88:91], v[168:171]
    v_mfma_f32_16x16x32_bf16 v[172:175], v[112:115], v[88:91], v[172:175]
    s_mov_b32 m0, s38
    s_nop 0
    buffer_load_dwordx4 v2, s[12:15], s39 offen offset:3072 lds
    s_add_u32 s38, s38, 4096
    s_add_u32 s39, s39, 4096
    s_waitcnt vmcnt(22)
    s_waitcnt lgkmcnt(0)
    v_mfma_f32_16x16x32_bf16 v[156:159], v[116:119], v[92:95], v[156:159]
    v_mfma_f32_16x16x32_bf16 v[160:163], v[120:123], v[92:95], v[160:163]
    s_mov_b32 m0, s38
    s_nop 0
    buffer_load_dwordx4 v2, s[12:15], s39 offen offset:0 lds
    v_mfma_f32_16x16x32_bf16 v[164:167], v[124:127], v[92:95], v[164:167]
    v_mfma_f32_16x16x32_bf16 v[168:171], v[128:131], v[92:95], v[168:171]
    v_mfma_f32_16x16x32_bf16 v[172:175], v[132:135], v[92:95], v[172:175]
    s_mov_b32 m0, s38
    s_nop 0
    buffer_load_dwordx4 v2, s[12:15], s39 offen offset:1024 lds
    s_barrier
    s_mov_b32 m0, s38
    s_nop 0
    buffer_load_dwordx4 v2, s[12:15], s39 offen offset:2048 lds
    s_mov_b32 m0, s38
    s_nop 0
    buffer_load_dwordx4 v2, s[12:15], s39 offen offset:3072 lds
    s_add_u32 s38, s38, 4096
    s_add_u32 s39, s39, 4096
    s_mov_b32 m0, s38
    s_nop 0
    buffer_load_dwordx4 v2, s[12:15], s39 offen offset:0 lds
    s_mov_b32 m0, s38
    s_nop 0
    buffer_load_dwordx4 v2, s[12:15], s39 offen offset:1024 lds
    s_mov_b32 m0, s38
    s_nop 0
    buffer_load_dwordx4 v2, s[12:15], s39 offen offset:2048 lds
    s_mov_b32 m0, s38
    s_nop 0
    buffer_load_dwordx4 v2, s[12:15], s39 offen offset:3072 lds
    s_mul_i32 s38, s30, 13312
    s_add_u32 s39, s38, s45
    s_add_u32 s39, s39, 0
    s_add_u32 s38, s38, 49152
    s_mov_b32 m0, s38
    s_nop 0
    buffer_load_dwordx4 v2, s[12:15], s39 offen offset:0 lds
    s_mov_b32 m0, s38
    s_nop 0
    buffer_load_dwordx4 v2, s[12:15], s39 offen offset:1024 lds
    s_mov_b32 m0, s38
    s_nop 0
    buffer_load_dwordx4 v2, s[12:15], s39 offen offset:2048 lds
    s_mov_b32 m0, s38
    s_nop 0
    buffer_load_dwordx4 v2, s[12:15], s39 offen offset:3072 lds
    s_add_u32 s38, s38, 4096
    s_add_u32 s39, s39, 4096
    s_mov_b32 m0, s38
    s_nop 0
    buffer_load_dwordx4 v2, s[12:15], s39 offen offset:0 lds
    s_mov_b32 m0, s38
    s_nop 0
    buffer_load_dwordx4 v2, s[12:15], s39 offen offset:1024 lds
    s_mov_b32 m0, s38
    s_nop 0
    buffer_load_dwordx4 v2, s[12:15], s39 offen offset:2048 lds
    s_mov_b32 m0, s38
    s_nop 0
    buffer_load_dwordx4 v2, s[12:15], s39 offen offset:3072 lds
    s_add_u32 s38, s38, 4096
    s_add_u32 s39, s39, 4096
    s_mov_b32 m0, s38
    s_nop 0
    buffer_load_dwordx4 v2, s[12:15], s39 offen offset:0 lds
    s_mov_b32 m0, s38
    s_nop 0
    buffer_load_dwordx4 v2, s[12:15], s39 offen offset:1024 lds
    s_mov_b32 m0, s38
    s_nop 0
    buffer_load_dwordx4 v2, s[12:15], s39 offen offset:2048 lds
    s_mov_b32 m0, s38
    s_nop 0
    buffer_load_dwordx4 v2, s[12:15], s39 offen offset:3072 lds
    s_add_u32 s38, s38, 4096
    s_add_u32 s39, s39, 4096
    s_mov_b32 m0, s38
    s_nop 0
    buffer_load_dwordx4 v2, s[12:15], s39 offen offset:0 lds
    v_lshlrev_b32 v9, 4, v3
    v_add_u32 v9, 155648, v9
    v_mov_b32 v12, 0xbdd2d3e8
    v_mov_b32 v13, 0xc0135761
    ds_read_b128 v[180:183], v9 offset:0
    ds_read_b128 v[200:203], v9 offset:512
    ds_read_b128 v[184:187], v9 offset:64
    ds_read_b128 v[204:207], v9 offset:576
    ds_read_b128 v[188:191], v9 offset:128
    ds_read_b128 v[208:211], v9 offset:640
    ds_read_b128 v[192:195], v9 offset:192
    ds_read_b128 v[212:215], v9 offset:704
    ds_read_b128 v[196:199], v9 offset:256
    ds_read_b128 v[216:219], v9 offset:768
    s_waitcnt lgkmcnt(0)
    v_pk_add_f32 v[180:181], v[180:181], v[200:201]
    v_pk_add_f32 v[182:183], v[182:183], v[202:203]
    v_pk_add_f32 v[184:185], v[184:185], v[204:205]
    v_pk_add_f32 v[186:187], v[186:187], v[206:207]
    v_pk_add_f32 v[188:189], v[188:189], v[208:209]
    v_pk_add_f32 v[190:191], v[190:191], v[210:211]
    v_pk_add_f32 v[192:193], v[192:193], v[212:213]
    v_pk_add_f32 v[194:195], v[194:195], v[214:215]
    v_pk_add_f32 v[196:197], v[196:197], v[216:217]
    v_pk_add_f32 v[198:199], v[198:199], v[218:219]
    v_pk_mul_f32 v[200:201], v[180:181], v[176:177] op_sel_hi:[1,0]
    v_pk_mul_f32 v[202:203], v[182:183], v[176:177] op_sel_hi:[1,0]
    v_pk_mul_f32 v[204:205], v[184:185], v[176:177] op_sel_hi:[1,0]
    v_pk_mul_f32 v[206:207], v[186:187], v[176:177] op_sel_hi:[1,0]
    v_pk_mul_f32 v[208:209], v[188:189], v[176:177] op_sel_hi:[1,0]
    v_pk_mul_f32 v[210:211], v[190:191], v[176:177] op_sel_hi:[1,0]
    v_pk_mul_f32 v[212:213], v[192:193], v[176:177] op_sel_hi:[1,0]
    v_pk_mul_f32 v[214:215], v[194:195], v[176:177] op_sel_hi:[1,0]
    v_pk_mul_f32 v[216:217], v[196:197], v[176:177] op_sel_hi:[1,0]
    v_pk_mul_f32 v[218:219], v[198:199], v[176:177] op_sel_hi:[1,0]
    v_pk_fma_f32 v[156:157], v[156:157], v[176:177], v[200:201] op_sel:[0,1,0] op_sel_hi:[1,1,1]
    v_pk_fma_f32 v[158:159], v[158:159], v[176:177], v[202:203] op_sel:[0,1,0] op_sel_hi:[1,1,1]
    v_pk_fma_f32 v[160:161], v[160:161], v[176:177], v[204:205] op_sel:[0,1,0] op_sel_hi:[1,1,1]
    v_pk_fma_f32 v[162:163], v[162:163], v[176:177], v[206:207] op_sel:[0,1,0] op_sel_hi:[1,1,1]
    v_pk_fma_f32 v[164:165], v[164:165], v[176:177], v[208:209] op_sel:[0,1,0] op_sel_hi:[1,1,1]
    v_pk_fma_f32 v[166:167], v[166:167], v[176:177], v[210:211] op_sel:[0,1,0] op_sel_hi:[1,1,1]
    v_pk_fma_f32 v[168:169], v[168:169], v[176:177], v[212:213] op_sel:[0,1,0] op_sel_hi:[1,1,1]
    v_pk_fma_f32 v[170:171], v[170:171], v[176:177], v[214:215] op_sel:[0,1,0] op_sel_hi:[1,1,1]
    v_pk_fma_f32 v[172:173], v[172:173], v[176:177], v[216:217] op_sel:[0,1,0] op_sel_hi:[1,1,1]
    v_pk_fma_f32 v[174:175], v[174:175], v[176:177], v[218:219] op_sel:[0,1,0] op_sel_hi:[1,1,1]
    v_pk_mul_f32 v[200:201], v[156:157], v[156:157]
    v_pk_mul_f32 v[202:203], v[158:159], v[158:159]
    v_pk_mul_f32 v[204:205], v[160:161], v[160:161]
    v_pk_mul_f32 v[206:207], v[162:163], v[162:163]
    v_pk_mul_f32 v[208:209], v[164:165], v[164:165]
    v_pk_mul_f32 v[210:211], v[166:167], v[166:167]
    v_pk_mul_f32 v[212:213], v[168:169], v[168:169]
    v_pk_mul_f32 v[214:215], v[170:171], v[170:171]
    v_pk_mul_f32 v[216:217], v[172:173], v[172:173]
    v_pk_mul_f32 v[218:219], v[174:175], v[174:175]
    v_pk_fma_f32 v[200:201], v[200:201], v[12:13], v[12:13] op_sel:[0,0,1] op_sel_hi:[1,0,1]
    v_pk_fma_f32 v[202:203], v[202:203], v[12:13], v[12:13] op_sel:[0,0,1] op_sel_hi:[1,0,1]
    v_pk_fma_f32 v[204:205], v[204:205], v[12:13], v[12:13] op_sel:[0,0,1] op_sel_hi:[1,0,1]
    v_pk_fma_f32 v[206:207], v[206:207], v[12:13], v[12:13] op_sel:[0,0,1] op_sel_hi:[1,0,1]
    v_pk_fma_f32 v[208:209], v[208:209], v[12:13], v[12:13] op_sel:[0,0,1] op_sel_hi:[1,0,1]
    v_pk_fma_f32 v[210:211], v[210:211], v[12:13], v[12:13] op_sel:[0,0,1] op_sel_hi:[1,0,1]
    v_pk_fma_f32 v[212:213], v[212:213], v[12:13], v[12:13] op_sel:[0,0,1] op_sel_hi:[1,0,1]
    v_pk_fma_f32 v[214:215], v[214:215], v[12:13], v[12:13] op_sel:[0,0,1] op_sel_hi:[1,0,1]
    v_pk_fma_f32 v[216:217], v[216:217], v[12:13], v[12:13] op_sel:[0,0,1] op_sel_hi:[1,0,1]
    v_pk_fma_f32 v[218:219], v[218:219], v[12:13], v[12:13] op_sel:[0,0,1] op_sel_hi:[1,0,1]
    v_pk_mul_f32 v[200:201], v[200:201], v[156:157]
    v_pk_mul_f32 v[202:203], v[202:203], v[158:159]
    v_pk_mul_f32 v[204:205], v[204:205], v[160:161]
    v_pk_mul_f32 v[206:207], v[206:207], v[162:163]
    v_pk_mul_f32 v[208:209], v[208:209], v[164:165]
    v_pk_mul_f32 v[210:211], v[210:211], v[166:167]
    v_pk_mul_f32 v[212:213], v[212:213], v[168:169]
    v_pk_mul_f32 v[214:215], v[214:215], v[170:171]
    v_pk_mul_f32 v[216:217], v[216:217], v[172:173]
    v_pk_mul_f32 v[218:219], v[218:219], v[174:175]
    v_exp_f32 v200, v200
    v_exp_f32 v201, v201
    v_exp_f32 v202, v202
    v_exp_f32 v203, v203
    v_exp_f32 v204, v204
    v_exp_f32 v205, v205
    v_exp_f32 v206, v206
    v_exp_f32 v207, v207
    v_exp_f32 v208, v208
    v_exp_f32 v209, v209
    v_exp_f32 v210, v210
    v_exp_f32 v211, v211
    v_exp_f32 v212, v212
    v_exp_f32 v213, v213
    v_exp_f32 v214, v214
    v_exp_f32 v215, v215
    v_exp_f32 v216, v216
    v_exp_f32 v217, v217
    v_exp_f32 v218, v218
    v_exp_f32 v219, v219
    v_pk_add_f32 v[200:201], v[200:201], 1.0 op_sel_hi:[1,0]
    v_pk_add_f32 v[202:203], v[202:203], 1.0 op_sel_hi:[1,0]
    v_pk_add_f32 v[204:205], v[204:205], 1.0 op_sel_hi:[1,0]
    v_pk_add_f32 v[206:207], v[206:207], 1.0 op_sel_hi:[1,0]
    v_pk_add_f32 v[208:209], v[208:209], 1.0 op_sel_hi:[1,0]
    v_pk_add_f32 v[210:211], v[210:211], 1.0 op_sel_hi:[1,0]
    v_pk_add_f32 v[212:213], v[212:213], 1.0 op_sel_hi:[1,0]
    v_pk_add_f32 v[214:215], v[214:215], 1.0 op_sel_hi:[1,0]
    v_pk_add_f32 v[216:217], v[216:217], 1.0 op_sel_hi:[1,0]
    v_pk_add_f32 v[218:219], v[218:219], 1.0 op_sel_hi:[1,0]
    v_rcp_f32 v200, v200
    v_rcp_f32 v201, v201
    v_rcp_f32 v202, v202
    v_rcp_f32 v203, v203
    v_rcp_f32 v204, v204
    v_rcp_f32 v205, v205
    v_rcp_f32 v206, v206
    v_rcp_f32 v207, v207
    v_rcp_f32 v208, v208
    v_rcp_f32 v209, v209
    v_rcp_f32 v210, v210
    v_rcp_f32 v211, v211
    v_rcp_f32 v212, v212
    v_rcp_f32 v213, v213
    v_rcp_f32 v214, v214
    v_rcp_f32 v215, v215
    v_rcp_f32 v216, v216
    v_rcp_f32 v217, v217
    v_rcp_f32 v218, v218
    v_rcp_f32 v219, v219
    s_nop 0
    v_pk_mul_f32 v[156:157], v[156:157], v[200:201]
    v_pk_mul_f32 v[158:159], v[158:159], v[202:203]
    v_pk_mul_f32 v[160:161], v[160:161], v[204:205]
    v_pk_mul_f32 v[162:163], v[162:163], v[206:207]
    v_pk_mul_f32 v[164:165], v[164:165], v[208:209]
    v_pk_mul_f32 v[166:167], v[166:167], v[210:211]
    v_pk_mul_f32 v[168:169], v[168:169], v[212:213]
    v_pk_mul_f32 v[170:171], v[170:171], v[214:215]
    v_pk_mul_f32 v[172:173], v[172:173], v[216:217]
    v_pk_mul_f32 v[174:175], v[174:175], v[218:219]
    v_cvt_pk_bf16_f32 v156, v156, v157
    v_cvt_pk_bf16_f32 v157, v158, v159
    v_cvt_pk_bf16_f32 v158, v160, v161
    v_cvt_pk_bf16_f32 v159, v162, v163
    v_cvt_pk_bf16_f32 v164, v164, v165
    v_cvt_pk_bf16_f32 v165, v166, v167
    v_cvt_pk_bf16_f32 v166, v168, v169
    v_cvt_pk_bf16_f32 v167, v170, v171
    v_cvt_pk_bf16_f32 v172, v172, v173
    v_cvt_pk_bf16_f32 v173, v174, v175
    s_nop 1
    v_permlane16_swap_b32 v156, v158
    v_permlane16_swap_b32 v157, v159
    v_permlane16_swap_b32 v164, v166
    v_permlane16_swap_b32 v165, v167
    s_mov_b32 s46, s22
    s_lshl_b32 s41, s33, 2
    s_add_u32 s49, s55, s41
    s_cmp_eq_u32 s31, 0
    s_cbranch_scc1 k2_kernel_slow19
    buffer_store_dwordx4 v[156:159], v254, s[12:15], s46 offen offset:0
    buffer_store_dwordx4 v[164:167], v254, s[12:15], s46 offen offset:1024
    buffer_store_dwordx2 v[172:173], v8, s[12:15], s46 offen offset:2048
    s_waitcnt vmcnt(0)
    v_mov_b32 v9, 1
    v_mov_b32 v10, 2304
    s_mov_b64 exec, 1
    buffer_store_dword v9, v10, s[12:15], s49 offen
    s_mov_b64 exec, -1
    s_branch k2_kernel_sent20
k2_kernel_slow19:
    buffer_store_dwordx4 v[156:159], v254, s[12:15], s46 offen offset:0 sc1
    buffer_store_dwordx4 v[164:167], v254, s[12:15], s46 offen offset:1024 sc1
    buffer_store_dwordx2 v[172:173], v8, s[12:15], s46 offen offset:2048 sc1
    s_waitcnt vmcnt(0)
    v_mov_b32 v9, 1
    v_mov_b32 v10, 2304
    s_mov_b64 exec, 1
    buffer_store_dword v9, v10, s[12:15], s49 offen sc1
    s_mov_b64 exec, -1
k2_kernel_sent20:
    s_cmp_eq_u32 s21, 0
    s_cbranch_scc1 k2_kernel_xas23
    v_mov_b32 v9, 3
    v_mov_b32 v10, 0
    s_mov_b64 exec, 1
    s_cmp_eq_u32 s31, 0
    s_cbranch_scc1 k2_kernel_xas21
    buffer_store_dword v9, v10, s[12:15], s21 offen
    s_branch k2_kernel_xas22
k2_kernel_xas21:
    buffer_store_dword v9, v10, s[12:15], s21 offen sc1
k2_kernel_xas22:
    s_mov_b64 exec, -1
k2_kernel_xas23:
    s_sub_u32 s41, s55, s37
    s_lshr_b32 s41, s41, 7
    v_bfe_u32 v7, v1, 3, 2
    v_min_u32 v7, 2, v7
    v_add_u32 v7, s41, v7
    v_subrev_u32 v7, 1, v7
    v_max_i32 v7, 0, v7
    v_min_i32 v7, 15, v7
    v_lshlrev_b32 v7, 7, v7
    v_and_b32 v9, 7, v1
    v_lshl_add_u32 v7, v9, 2, v7
    s_add_u32 s49, s37, 2304
    s_mov_b32 s43, 200000
k2_kernel_poll24:
    buffer_load_dword v9, v7, s[12:15], s49 offen sc1
    s_waitcnt vmcnt(0)
    v_cmp_ne_u32 vcc, 0, v9
    s_sub_u32 s43, s43, 1
    s_cmp_eq_u64 vcc, -1
    s_cbranch_scc1 k2_kernel_go25
    s_cmp_lg_u32 s43, 0
    s_cbranch_scc1 k2_kernel_poll24
k2_kernel_go25:
    s_mul_i32 s41, s33, 2560
    s_sub_u32 s47, s22, s41
    s_mov_b32 s52, s47
    s_add_u32 s41, s52, 0
    buffer_load_dwordx4 v[16:19], v2, s[12:15], s41 offen offset:0 sc1
    s_add_u32 s41, s52, 0
    buffer_load_dwordx4 v[20:23], v2, s[12:15], s41 offen offset:1024 sc1
    s_add_u32 s41, s52, 0
    buffer_load_dwordx4 v[24:27], v2, s[12:15], s41 offen offset:2048 sc1
    s_add_u32 s41, s52, 0
    buffer_load_dwordx4 v[28:31], v2, s[12:15], s41 offen offset:3072 sc1
    s_add_u32 s41, s54, 20480
    s_mov_b32 s48, s41
    s_sub_u32 s41, s55, s37
    s_lshl_b32 s41, s41, 3
    s_add_u32 s46, s41, s36
    s_add_u32 s46, s46, 1581056
    s_barrier
    ds_read_b128 v[96:99], v15 offset:36864
    ds_read_b128 v[100:103], v15 offset:37888
    ds_read_b128 v[104:107], v15 offset:38912
    ds_read_b128 v[108:111], v15 offset:39936
    ds_read_b128 v[112:115], v15 offset:40960
    ds_read_b128 v[116:119], v15 offset:41984
    ds_read_b128 v[120:123], v15 offset:43008
    ds_read_b128 v[124:127], v15 offset:44032
    ds_read_b128 v[128:131], v15 offset:45056
    ds_read_b128 v[132:135], v15 offset:46080
    s_waitcnt vmcnt(3)
    s_waitcnt lgkmcnt(5)
    v_mfma_f32_16x16x32_bf16 v[156:159], v[96:99], v[16:19], 0
    s_add_u32 s41, s52, 4096
    buffer_load_dwordx4 v[32:35], v2, s[12:15], s41 offen offset:0 sc1
    v_mfma_f32_16x16x32_bf16 v[160:163], v[100:103], v[16:19], 0
    ds_read_b128 v[136:139], v15 offset:47104
    v_mfma_f32_16x16x32_bf16 v[164:167], v[104:107], v[16:19], 0
    ds_read_b128 v[140:143], v15 offset:48128
    v_mfma_f32_16x16x32_bf16 v[168:171], v[108:111], v[16:19], 0
    ds_read_b128 v[144:147], v15 offset:49152
    s_add_u32 s41, s52, 4096
    buffer_load_dwordx4 v[36:39], v2, s[12:15], s41 offen offset:1024 sc1
    v_mfma_f32_16x16x32_bf16 v[172:175], v[112:115], v[16:19], 0
    ds_read_b128 v[148:151], v15 offset:50176
    ds_read_b128 v[152:155], v15 offset:51200
    s_waitcnt vmcnt(4)
    s_waitcnt lgkmcnt(5)
    v_mfma_f32_16x16x32_bf16 v[156:159], v[116:119], v[20:23], v[156:159]
    s_add_u32 s41, s52, 4096
    buffer_load_dwordx4 v[40:43], v2, s[12:15], s41 offen offset:2048 sc1
    v_mfma_f32_16x16x32_bf16 v[160:163], v[120:123], v[20:23], v[160:163]
    ds_read_b128 v[96:99], v15 offset:52224
    v_mfma_f32_16x16x32_bf16 v[164:167], v[124:127], v[20:23], v[164:167]
    ds_read_b128 v[100:103], v15 offset:53248
    v_mfma_f32_16x16x32_bf16 v[168:171], v[128:131], v[20:23], v[168:171]
    ds_read_b128 v[104:107], v15 offset:54272
    s_add_u32 s41, s52, 4096
    buffer_load_dwordx4 v[44:47], v2, s[12:15], s41 offen offset:3072 sc1
    v_mfma_f32_16x16x32_bf16 v[172:175], v[132:135], v[20:23], v[172:175]
    ds_read_b128 v[108:111], v15 offset:55296
    ds_read_b128 v[112:115], v15 offset:56320
    s_waitcnt vmcnt(5)
    s_waitcnt lgkmcnt(5)
    v_mfma_f32_16x16x32_bf16 v[156:159], v[136:139], v[24:27], v[156:159]
    s_add_u32 s41, s52, 8192
    buffer_load_dwordx4 v[48:51], v2, s[12:15], s41 offen offset:0 sc1
    v_mfma_f32_16x16x32_bf16 v[160:163], v[140:143], v[24:27], v[160:163]
    ds_read_b128 v[116:119], v15 offset:57344
    v_mfma_f32_16x16x32_bf16 v[164:167], v[144:147], v[24:27], v[164:167]
    ds_read_b128 v[120:123], v15 offset:58368
    v_mfma_f32_16x16x32_bf16 v[168:171], v[148:151], v[24:27], v[168:171]
    ds_read_b128 v[124:127], v15 offset:59392
    s_add_u32 s41, s52, 8192
    buffer_load_dwordx4 v[52:55], v2, s[12:15], s41 offen offset:1024 sc1
    v_mfma_f32_16x16x32_bf16 v[172:175], v[152:155], v[24:27], v[172:175]
    ds_read_b128 v[128:131], v15 offset:60416
    ds_read_b128 v[132:135], v15 offset:61440
    s_waitcnt vmcnt(6)
    s_waitcnt lgkmcnt(5)
    v_mfma_f32_16x16x32_bf16 v[156:159], v[96:99], v[28:31], v[156:159]
    s_add_u32 s41, s52, 8192
    buffer_load_dwordx4 v[56:59], v2, s[12:15], s41 offen offset:2048 sc1
    v_mfma_f32_16x16x32_bf16 v[160:163], v[100:103], v[28:31], v[160:163]
    ds_read_b128 v[136:139], v15 offset:62464
    v_mfma_f32_16x16x32_bf16 v[164:167], v[104:107], v[28:31], v[164:167]
    ds_read_b128 v[140:143], v15 offset:63488
    v_mfma_f32_16x16x32_bf16 v[168:171], v[108:111], v[28:31], v[168:171]
    ds_read_b128 v[144:147], v15 offset:64512
    s_add_u32 s41, s52, 8192
    buffer_load_dwordx4 v[60:63], v2, s[12:15], s41 offen offset:3072 sc1
    v_mfma_f32_16x16x32_bf16 v[172:175], v[112:115], v[28:31], v[172:175]
    ds_read_b128 v[148:151], v11 offset:0
    ds_read_b128 v[152:155], v11 offset:1024
    s_waitcnt vmcnt(7)
    s_waitcnt lgkmcnt(5)
    v_mfma_f32_16x16x32_bf16 v[156:159], v[116:119], v[32:35], v[156:159]
    s_add_u32 s41, s52, 12288
    buffer_load_dwordx4 v[64:67], v2, s[12:15], s41 offen offset:0 sc1
    v_mfma_f32_16x16x32_bf16 v[160:163], v[120:123], v[32:35], v[160:163]
    ds_read_b128 v[96:99], v11 offset:2048
    v_mfma_f32_16x16x32_bf16 v[164:167], v[124:127], v[32:35], v[164:167]
    ds_read_b128 v[100:103], v11 offset:3072
    v_mfma_f32_16x16x32_bf16 v[168:171], v[128:131], v[32:35], v[168:171]
    ds_read_b128 v[104:107], v11 offset:4096
    s_add_u32 s41, s52, 12288
    buffer_load_dwordx4 v[68:71], v2, s[12:15], s41 offen offset:1024 sc1
    v_mfma_f32_16x16x32_bf16 v[172:175], v[132:135], v[32:35], v[172:175]
    ds_read_b128 v[108:111], v11 offset:5120
    ds_read_b128 v[112:115], v11 offset:6144
    s_waitcnt vmcnt(8)
    s_waitcnt lgkmcnt(5)
    v_mfma_f32_16x16x32_bf16 v[156:159], v[136:139], v[36:39], v[156:159]
    s_add_u32 s41, s52, 12288
    buffer_load_dwordx4 v[72:75], v2, s[12:15], s41 offen offset:2048 sc1
    v_mfma_f32_16x16x32_bf16 v[160:163], v[140:143], v[36:39], v[160:163]
    ds_read_b128 v[116:119], v11 offset:7168
    v_mfma_f32_16x16x32_bf16 v[164:167], v[144:147], v[36:39], v[164:167]
    ds_read_b128 v[120:123], v11 offset:8192
    v_mfma_f32_16x16x32_bf16 v[168:171], v[148:151], v[36:39], v[168:171]
    ds_read_b128 v[124:127], v11 offset:9216
    s_add_u32 s41, s52, 12288
    buffer_load_dwordx4 v[76:79], v2, s[12:15], s41 offen offset:3072 sc1
    v_mfma_f32_16x16x32_bf16 v[172:175], v[152:155], v[36:39], v[172:175]
    ds_read_b128 v[128:131], v11 offset:10240
    ds_read_b128 v[132:135], v11 offset:11264
    s_waitcnt vmcnt(9)
    s_waitcnt lgkmcnt(5)
    v_mfma_f32_16x16x32_bf16 v[156:159], v[96:99], v[40:43], v[156:159]
    s_add_u32 s41, s52, 16384
    buffer_load_dwordx4 v[80:83], v2, s[12:15], s41 offen offset:0 sc1
    v_mfma_f32_16x16x32_bf16 v[160:163], v[100:103], v[40:43], v[160:163]
    ds_read_b128 v[136:139], v11 offset:12288
    v_mfma_f32_16x16x32_bf16 v[164:167], v[104:107], v[40:43], v[164:167]
    ds_read_b128 v[140:143], v11 offset:13312
    v_mfma_f32_16x16x32_bf16 v[168:171], v[108:111], v[40:43], v[168:171]
    ds_read_b128 v[144:147], v11 offset:14336
    s_add_u32 s41, s52, 16384
    buffer_load_dwordx4 v[84:87], v2, s[12:15], s41 offen offset:1024 sc1
    v_mfma_f32_16x16x32_bf16 v[172:175], v[112:115], v[40:43], v[172:175]
    ds_read_b128 v[148:151], v11 offset:15360
    ds_read_b128 v[152:155], v11 offset:16384
    s_waitcnt vmcnt(10)
    s_waitcnt lgkmcnt(5)
    v_mfma_f32_16x16x32_bf16 v[156:159], v[116:119], v[44:47], v[156:159]
    s_add_u32 s41, s52, 16384
    buffer_load_dwordx4 v[88:91], v2, s[12:15], s41 offen offset:2048 sc1
    v_mfma_f32_16x16x32_bf16 v[160:163], v[120:123], v[44:47], v[160:163]
    ds_read_b128 v[96:99], v11 offset:17408
    v_mfma_f32_16x16x32_bf16 v[164:167], v[124:127], v[44:47], v[164:167]
    ds_read_b128 v[100:103], v11 offset:18432
    v_mfma_f32_16x16x32_bf16 v[168:171], v[128:131], v[44:47], v[168:171]
    ds_read_b128 v[104:107], v11 offset:19456
    s_add_u32 s41, s52, 16384
    buffer_load_dwordx4 v[92:95], v2, s[12:15], s41 offen offset:3072 sc1
    v_mfma_f32_16x16x32_bf16 v[172:175], v[132:135], v[44:47], v[172:175]
    ds_read_b128 v[108:111], v11 offset:20480
    ds_read_b128 v[112:115], v11 offset:21504
    s_waitcnt vmcnt(11)
    s_waitcnt lgkmcnt(5)
    v_mfma_f32_16x16x32_bf16 v[156:159], v[136:139], v[48:51], v[156:159]
    v_mfma_f32_16x16x32_bf16 v[160:163], v[140:143], v[48:51], v[160:163]
    ds_read_b128 v[116:119], v11 offset:22528
    buffer_load_dwordx4 v[176:179], v254, s[12:15], s48 offen sc1
    buffer_load_dwordx4 v[180:183], v254, s[12:15], s48 offen offset:1024 sc1
    buffer_load_dwordx2 v[184:185], v8, s[12:15], s48 offen offset:2048 sc1
    v_mfma_f32_16x16x32_bf16 v[164:167], v[144:147], v[48:51], v[164:167]
    ds_read_b128 v[120:123], v11 offset:23552
    v_mfma_f32_16x16x32_bf16 v[168:171], v[148:151], v[48:51], v[168:171]
    ds_read_b128 v[124:127], v14 offset:0
    v_mfma_f32_16x16x32_bf16 v[172:175], v[152:155], v[48:51], v[172:175]
    ds_read_b128 v[128:131], v14 offset:1024
    ds_read_b128 v[132:135], v14 offset:2048
    s_waitcnt vmcnt(13)
    s_waitcnt lgkmcnt(5)
    s_barrier
    v_mfma_f32_16x16x32_bf16 v[156:159], v[96:99], v[52:55], v[156:159]
    v_mfma_f32_16x16x32_bf16 v[160:163], v[100:103], v[52:55], v[160:163]
    ds_read_b128 v[136:139], v14 offset:3072
    v_mfma_f32_16x16x32_bf16 v[164:167], v[104:107], v[52:55], v[164:167]
    ds_read_b128 v[140:143], v14 offset:4096
    v_mfma_f32_16x16x32_bf16 v[168:171], v[108:111], v[52:55], v[168:171]
    ds_read_b128 v[144:147], v14 offset:5120
    v_mfma_f32_16x16x32_bf16 v[172:175], v[112:115], v[52:55], v[172:175]
    ds_read_b128 v[148:151], v14 offset:6144
    ds_read_b128 v[152:155], v14 offset:7168
    s_waitcnt vmcnt(12)
    s_waitcnt lgkmcnt(5)
    v_mfma_f32_16x16x32_bf16 v[156:159], v[116:119], v[56:59], v[156:159]
    v_mfma_f32_16x16x32_bf16 v[160:163], v[120:123], v[56:59], v[160:163]
    ds_read_b128 v[96:99], v14 offset:8192
    s_mul_i32 s38, s30, 12288
    s_add_u32 s39, s38, s45
    s_add_u32 s39, s39, 53248
    s_add_u32 s38, s38, 102400
    s_mov_b32 m0, s38
    s_nop 0
    buffer_load_dwordx4 v2, s[12:15], s39 offen offset:0 lds
    v_mfma_f32_16x16x32_bf16 v[164:167], v[124:127], v[56:59], v[164:167]
    ds_read_b128 v[100:103], v14 offset:9216
    v_mfma_f32_16x16x32_bf16 v[168:171], v[128:131], v[56:59], v[168:171]
    ds_read_b128 v[104:107], v14 offset:10240
    v_mfma_f32_16x16x32_bf16 v[172:175], v[132:135], v[56:59], v[172:175]
    ds_read_b128 v[108:111], v14 offset:11264
    ds_read_b128 v[112:115], v14 offset:12288
    s_mov_b32 m0, s38
    s_nop 0
    buffer_load_dwordx4 v2, s[12:15], s39 offen offset:1024 lds
    s_waitcnt vmcnt(13)
    s_waitcnt lgkmcnt(5)
    v_mfma_f32_16x16x32_bf16 v[156:159], v[136:139], v[60:63], v[156:159]
    v_mfma_f32_16x16x32_bf16 v[160:163], v[140:143], v[60:63], v[160:163]
    ds_read_b128 v[116:119], v14 offset:13312
    s_mov_b32 m0, s38
    s_nop 0
    buffer_load_dwordx4 v2, s[12:15], s39 offen offset:2048 lds
    v_mfma_f32_16x16x32_bf16 v[164:167], v[144:147], v[60:63], v[164:167]
    ds_read_b128 v[120:123], v14 offset:14336
    v_mfma_f32_16x16x32_bf16 v[168:171], v[148:151], v[60:63], v[168:171]
    ds_read_b128 v[124:127], v14 offset:15360
    v_mfma_f32_16x16x32_bf16 v[172:175], v[152:155], v[60:63], v[172:175]
    ds_read_b128 v[128:131], v14 offset:16384
    ds_read_b128 v[132:135], v14 offset:17408
    s_mov_b32 m0, s38
    s_nop 0
    buffer_load_dwordx4 v2, s[12:15], s39 offen offset:3072 lds
    s_add_u32 s38, s38, 4096
    s_add_u32 s39, s39, 4096
    s_waitcnt vmcnt(14)
    s_waitcnt lgkmcnt(5)
    v_mfma_f32_16x16x32_bf16 v[156:159], v[96:99], v[64:67], v[156:159]
    v_mfma_f32_16x16x32_bf16 v[160:163], v[100:103], v[64:67], v[160:163]
    ds_read_b128 v[136:139], v14 offset:18432
    s_mov_b32 m0, s38
    s_nop 0
    buffer_load_dwordx4 v2, s[12:15], s39 offen offset:0 lds
    v_mfma_f32_16x16x32_bf16 v[164:167], v[104:107], v[64:67], v[164:167]
    ds_read_b128 v[140:143], v14 offset:19456
    v_mfma_f32_16x16x32_bf16 v[168:171], v[108:111], v[64:67], v[168:171]
    ds_read_b128 v[144:147], v14 offset:20480
    v_mfma_f32_16x16x32_bf16 v[172:175], v[112:115], v[64:67], v[172:175]
    ds_read_b128 v[148:151], v14 offset:21504
    ds_read_b128 v[152:155], v14 offset:22528
    s_mov_b32 m0, s38
    s_nop 0
    buffer_load_dwordx4 v2, s[12:15], s39 offen offset:1024 lds
    s_waitcnt vmcnt(15)
    s_waitcnt lgkmcnt(5)
    v_mfma_f32_16x16x32_bf16 v[156:159], v[116:119], v[68:71], v[156:159]
    v_mfma_f32_16x16x32_bf16 v[160:163], v[120:123], v[68:71], v[160:163]
    ds_read_b128 v[96:99], v14 offset:23552
    s_mov_b32 m0, s38
    s_nop 0
    buffer_load_dwordx4 v2, s[12:15], s39 offen offset:2048 lds
    v_mfma_f32_16x16x32_bf16 v[164:167], v[124:127], v[68:71], v[164:167]
    ds_read_b128 v[100:103], v14 offset:24576
    v_mfma_f32_16x16x32_bf16 v[168:171], v[128:131], v[68:71], v[168:171]
    ds_read_b128 v[104:107], v14 offset:25600
    v_mfma_f32_16x16x32_bf16 v[172:175], v[132:135], v[68:71], v[172:175]
    ds_read_b128 v[108:111], v14 offset:26624
    ds_read_b128 v[112:115], v14 offset:27648
    s_mov_b32 m0, s38
    s_nop 0
    buffer_load_dwordx4 v2, s[12:15], s39 offen offset:3072 lds
    s_add_u32 s38, s38, 4096
    s_add_u32 s39, s39, 4096
    s_waitcnt vmcnt(16)
    s_waitcnt lgkmcnt(5)
    v_mfma_f32_16x16x32_bf16 v[156:159], v[136:139], v[72:75], v[156:159]
    v_mfma_f32_16x16x32_bf16 v[160:163], v[140:143], v[72:75], v[160:163]
    ds_read_b128 v[116:119], v14 offset:28672
    s_mov_b32 m0, s38
    s_nop 0
    buffer_load_dwordx4 v2, s[12:15], s39 offen offset:0 lds
    v_mfma_f32_16x16x32_bf16 v[164:167], v[144:147], v[72:75], v[164:167]
    ds_read_b128 v[120:123], v14 offset:29696
    v_mfma_f32_16x16x32_bf16 v[168:171], v[148:151], v[72:75], v[168:171]
    ds_read_b128 v[124:127], v14 offset:30720
    v_mfma_f32_16x16x32_bf16 v[172:175], v[152:155], v[72:75], v[172:175]
    ds_read_b128 v[128:131], v14 offset:31744
    ds_read_b128 v[132:135], v14 offset:32768
    s_mov_b32 m0, s38
    s_nop 0
    buffer_load_dwordx4 v2, s[12:15], s39 offen offset:1024 lds
    s_waitcnt vmcnt(17)
    s_waitcnt lgkmcnt(5)
    v_mfma_f32_16x16x32_bf16 v[156:159], v[96:99], v[76:79], v[156:159]
    v_mfma_f32_16x16x32_bf16 v[160:163], v[100:103], v[76:79], v[160:163]
    ds_read_b128 v[136:139], v14 offset:33792
    s_mov_b32 m0, s38
    s_nop 0
    buffer_load_dwordx4 v2, s[12:15], s39 offen offset:2048 lds
    v_mfma_f32_16x16x32_bf16 v[164:167], v[104:107], v[76:79], v[164:167]
    ds_read_b128 v[140:143], v14 offset:34816
    v_mfma_f32_16x16x32_bf16 v[168:171], v[108:111], v[76:79], v[168:171]
    ds_read_b128 v[144:147], v14 offset:35840
    v_mfma_f32_16x16x32_bf16 v[172:175], v[112:115], v[76:79], v[172:175]
    ds_read_b128 v[148:151], v14 offset:36864
    ds_read_b128 v[152:155], v14 offset:37888
    s_mov_b32 m0, s38
    s_nop 0
    buffer_load_dwordx4 v2, s[12:15], s39 offen offset:3072 lds
    s_waitcnt vmcnt(18)
    s_waitcnt lgkmcnt(5)
    v_mfma_f32_16x16x32_bf16 v[156:159], v[116:119], v[80:83], v[156:159]
    v_mfma_f32_16x16x32_bf16 v[160:163], v[120:123], v[80:83], v[160:163]
    ds_read_b128 v[96:99], v14 offset:38912
    v_mfma_f32_16x16x32_bf16 v[164:167], v[124:127], v[80:83], v[164:167]
    ds_read_b128 v[100:103], v14 offset:39936
    v_mfma_f32_16x16x32_bf16 v[168:171], v[128:131], v[80:83], v[168:171]
    ds_read_b128 v[104:107], v14 offset:40960
    v_mfma_f32_16x16x32_bf16 v[172:175], v[132:135], v[80:83], v[172:175]
    ds_read_b128 v[108:111], v14 offset:41984
    ds_read_b128 v[112:115], v14 offset:43008
    s_waitcnt vmcnt(17)
    s_waitcnt lgkmcnt(5)
    v_mfma_f32_16x16x32_bf16 v[156:159], v[136:139], v[84:87], v[156:159]
    v_mfma_f32_16x16x32_bf16 v[160:163], v[140:143], v[84:87], v[160:163]
    ds_read_b128 v[116:119], v14 offset:44032
    v_mfma_f32_16x16x32_bf16 v[164:167], v[144:147], v[84:87], v[164:167]
    ds_read_b128 v[120:123], v14 offset:45056
    v_mfma_f32_16x16x32_bf16 v[168:171], v[148:151], v[84:87], v[168:171]
    ds_read_b128 v[124:127], v14 offset:46080
    v_mfma_f32_16x16x32_bf16 v[172:175], v[152:155], v[84:87], v[172:175]
    ds_read_b128 v[128:131], v14 offset:47104
    ds_read_b128 v[132:135], v14 offset:48128
    s_waitcnt vmcnt(16)
    s_waitcnt lgkmcnt(5)
    v_mfma_f32_16x16x32_bf16 v[156:159], v[96:99], v[88:91], v[156:159]
    v_mfma_f32_16x16x32_bf16 v[160:163], v[100:103], v[88:91], v[160:163]
    v_mfma_f32_16x16x32_bf16 v[164:167], v[104:107], v[88:91], v[164:167]
    v_mfma_f32_16x16x32_bf16 v[168:171], v[108:111], v[88:91], v[168:171]
    v_mfma_f32_16x16x32_bf16 v[172:175], v[112:115], v[88:91], v[172:175]
    s_waitcnt vmcnt(15)
    s_waitcnt lgkmcnt(0)
    v_mfma_f32_16x16x32_bf16 v[156:159], v[116:119], v[92:95], v[156:159]
    v_mfma_f32_16x16x32_bf16 v[160:163], v[120:123], v[92:95], v[160:163]
    v_mfma_f32_16x16x32_bf16 v[164:167], v[124:127], v[92:95], v[164:167]
    v_mfma_f32_16x16x32_bf16 v[168:171], v[128:131], v[92:95], v[168:171]
    v_mfma_f32_16x16x32_bf16 v[172:175], v[132:135], v[92:95], v[172:175]
    s_barrier
    s_mul_i32 s38, s30, 1024
    s_add_u32 s39, s38, s45
    s_add_u32 s39, s39, 102400
    s_add_u32 s38, s38, 151552
    s_mov_b32 m0, s38
    s_nop 0
    buffer_load_dwordx4 v2, s[12:15], s39 offen offset:0 lds
    s_mul_i32 s38, s30, 9216
    s_add_u32 s39, s38, s45
    s_add_u32 s39, s39, 106496
    s_add_u32 s38, s38, 0
    s_mov_b32 m0, s38
    s_nop 0
    buffer_load_dwordx4 v2, s[12:15], s39 offen offset:0 lds
    s_mov_b32 m0, s38
    s_nop 0
    buffer_load_dwordx4 v2, s[12:15], s39 offen offset:1024 lds
    s_mov_b32 m0, s38
    s_nop 0
    buffer_load_dwordx4 v2, s[12:15], s39 offen offset:2048 lds
    s_mov_b32 m0, s38
    s_nop 0
    buffer_load_dwordx4 v2, s[12:15], s39 offen offset:3072 lds
    s_add_u32 s38, s38, 4096
    s_add_u32 s39, s39, 4096
    s_mov_b32 m0, s38
    s_nop 0
    buffer_load_dwordx4 v2, s[12:15], s39 offen offset:0 lds
    s_mov_b32 m0, s38
    s_nop 0
    buffer_load_dwordx4 v2, s[12:15], s39 offen offset:1024 lds
    s_mov_b32 m0, s38
    s_nop 0
    buffer_load_dwordx4 v2, s[12:15], s39 offen offset:2048 lds
    s_mov_b32 m0, s38
    s_nop 0
    buffer_load_dwordx4 v2, s[12:15], s39 offen offset:3072 lds
    s_add_u32 s38, s38, 4096
    s_add_u32 s39, s39, 4096
    s_mov_b32 m0, s38
    s_nop 0
    buffer_load_dwordx4 v2, s[12:15], s39 offen offset:0 lds
    v_mov_b32 v196, 0x3f803f80
    v_mov_b32 v198, 0
    v_mov_b32 v199, 0
    s_waitcnt vmcnt(22)
    s_nop 1
    v_permlane16_swap_b32 v176, v178
    v_permlane16_swap_b32 v177, v179
    v_permlane16_swap_b32 v180, v182
    v_permlane16_swap_b32 v181, v183
    s_nop 1
    v_lshlrev_b32 v200, 16, v176
    v_and_b32 v201, 0xffff0000, v176
    v_lshlrev_b32 v202, 16, v177
    v_and_b32 v203, 0xffff0000, v177
    v_lshlrev_b32 v204, 16, v178
    v_and_b32 v205, 0xffff0000, v178
    v_lshlrev_b32 v206, 16, v179
    v_and_b32 v207, 0xffff0000, v179
    v_lshlrev_b32 v208, 16, v180
    v_and_b32 v209, 0xffff0000, v180
    v_lshlrev_b32 v210, 16, v181
    v_and_b32 v211, 0xffff0000, v181
    v_lshlrev_b32 v212, 16, v182
    v_and_b32 v213, 0xffff0000, v182
    v_lshlrev_b32 v214, 16, v183
    v_and_b32 v215, 0xffff0000, v183
    v_lshlrev_b32 v216, 16, v184
    v_and_b32 v217, 0xffff0000, v184
    v_lshlrev_b32 v218, 16, v185
    v_and_b32 v219, 0xffff0000, v185
    v_pk_add_f32 v[156:157], v[156:157], v[200:201]
    v_pk_add_f32 v[158:159], v[158:159], v[202:203]
    v_pk_add_f32 v[160:161], v[160:161], v[204:205]
    v_pk_add_f32 v[162:163], v[162:163], v[206:207]
    v_pk_add_f32 v[164:165], v[164:165], v[208:209]
    v_pk_add_f32 v[166:167], v[166:167], v[210:211]
    v_pk_add_f32 v[168:169], v[168:169], v[212:213]
    v_pk_add_f32 v[170:171], v[170:171], v[214:215]
    v_pk_add_f32 v[172:173], v[172:173], v[216:217]
    v_pk_add_f32 v[174:175], v[174:175], v[218:219]
    v_cvt_pk_bf16_f32 v156, v156, v157
    v_cvt_pk_bf16_f32 v157, v158, v159
    v_cvt_pk_bf16_f32 v158, v160, v161
    v_cvt_pk_bf16_f32 v159, v162, v163
    v_cvt_pk_bf16_f32 v164, v164, v165
    v_cvt_pk_bf16_f32 v165, v166, v167
    v_cvt_pk_bf16_f32 v166, v168, v169
    v_cvt_pk_bf16_f32 v167, v170, v171
    v_cvt_pk_bf16_f32 v172, v172, v173
    v_cvt_pk_bf16_f32 v173, v174, v175
    v_dot2_f32_bf16 v198, v156, v196, v198
    v_dot2_f32_bf16 v199, v156, v156, v199
    v_dot2_f32_bf16 v198, v157, v196, v198
    v_dot2_f32_bf16 v199, v157, v157, v199
    v_dot2_f32_bf16 v198, v158, v196, v198
    v_dot2_f32_bf16 v199, v158, v158, v199
    v_dot2_f32_bf16 v198, v159, v196, v198
    v_dot2_f32_bf16 v199, v159, v159, v199
    v_dot2_f32_bf16 v198, v164, v196, v198
    v_dot2_f32_bf16 v199, v164, v164, v199
    v_dot2_f32_bf16 v198, v165, v196, v198
    v_dot2_f32_bf16 v199, v165, v165, v199
    v_dot2_f32_bf16 v198, v166, v196, v198
    v_dot2_f32_bf16 v199, v166, v166, v199
    v_dot2_f32_bf16 v198, v167, v196, v198
    v_dot2_f32_bf16 v199, v167, v167, v199
    v_dot2_f32_bf16 v198, v172, v196, v198
    v_dot2_f32_bf16 v199, v172, v172, v199
    v_dot2_f32_bf16 v198, v173, v196, v198
    v_dot2_f32_bf16 v199, v173, v173, v199
    s_nop 1
    s_nop 1
    v_permlane16_swap_b32 v156, v158
    v_permlane16_swap_b32 v157, v159
    v_permlane16_swap_b32 v164, v166
    v_permlane16_swap_b32 v165, v167
    s_nop 2
    v_mov_b32 v188, v198
    v_mov_b32 v189, v199
    s_nop 1
    v_permlane32_swap_b32 v188, v198
    v_permlane32_swap_b32 v189, v199
    s_nop 0
    v_add_f32 v198, v198, v188
    v_add_f32 v199, v199, v189
    v_mov_b32 v188, v198
    v_mov_b32 v189, v199
    s_nop 1
    v_permlane16_swap_b32 v188, v198
    v_permlane16_swap_b32 v189, v199
    s_nop 0
    v_add_f32 v198, v198, v188
    v_add_f32 v199, v199, v189
    s_add_u32 s47, s54, 20480
    v_lshlrev_b32 v9, 6, v4
    s_lshl_b32 s41, s33, 3
    s_add_u32 s46, s46, s41
    s_lshl_b32 s41, s33, 2
    s_add_u32 s49, s55, s41
    v_mov_b32 v11, v9
    s_cmp_eq_u32 s31, 0
    s_cbranch_scc1 k2_kernel_slow26
    buffer_store_dwordx4 v[156:159], v254, s[12:15], s47 offen offset:0
    buffer_store_dwordx4 v[164:167], v254, s[12:15], s47 offen offset:1024
    buffer_store_dwordx2 v[172:173], v8, s[12:15], s47 offen offset:2048
    s_mov_b64 exec, 0xffff
    buffer_store_dwordx2 v[198:199], v11, s[12:15], s46 offen
    s_mov_b64 exec, -1
    s_waitcnt vmcnt(0)
    v_mov_b32 v9, 1
    v_mov_b32 v10, 4352
    s_mov_b64 exec, 1
    buffer_store_dword v9, v10, s[12:15], s49 offen
    s_mov_b64 exec, -1
    s_branch k2_kernel_sent27
k2_kernel_slow26:
    buffer_store_dwordx4 v[156:159], v254, s[12:15], s47 offen offset:0 sc1
    buffer_store_dwordx4 v[164:167], v254, s[12:15], s47 offen offset:1024 sc1
    buffer_store_dwordx2 v[172:173], v8, s[12:15], s47 offen offset:2048 sc1
    s_mov_b64 exec, 0xffff
    buffer_store_dwordx2 v[198:199], v11, s[12:15], s46 offen sc1
    s_mov_b64 exec, -1
    s_waitcnt vmcnt(0)
    v_mov_b32 v9, 1
    v_mov_b32 v10, 4352
    s_mov_b64 exec, 1
    buffer_store_dword v9, v10, s[12:15], s49 offen sc1
    s_mov_b64 exec, -1
k2_kernel_sent27:
    s_lshl_b32 s46, s34, 3
    s_lshl_b32 s47, s30, 1
    s_add_u32 s46, s46, s47
    s_lshl_b32 s49, s46, 7
    s_add_u32 s49, s49, 4352
    v_bfe_u32 v7, v1, 3, 1
    v_lshlrev_b32 v7, 7, v7
    v_and_b32 v9, 7, v1
    v_lshl_add_u32 v7, v9, 2, v7
    v_add_u32 v7, s49, v7
    s_sub_u32 s49, s55, s37
    s_add_u32 s49, s49, 128
    v_and_b32 v9, 3, v1
    v_lshlrev_b32 v9, 2, v9
    v_add_u32 v9, s49, v9
    v_and_b32 v10, 16, v1
    v_cmp_ne_u32 vcc, 0, v10
    v_mov_b32 v11, 1
    v_mov_b32 v10, 3
    v_cndmask_b32 v7, v7, v9, vcc
    v_cndmask_b32 v10, v11, v10, vcc
    s_mov_b32 s43, 200000
k2_kernel_poll28:
    buffer_load_dword v9, v7, s[12:15], s37 offen sc1
    s_waitcnt vmcnt(0)
    v_cmp_le_u32 vcc, v10, v9
    s_sub_u32 s43, s43, 1
    s_cmp_eq_u64 vcc, -1
    s_cbranch_scc1 k2_kernel_go29
    s_cmp_lg_u32 s43, 0
    s_cbranch_scc1 k2_kernel_poll28
k2_kernel_go29:
    s_mul_i32 s47, s46, 20480
    s_add_u32 s47, s47, s36
    s_add_u32 s47, s47, 20480
    s_add_u32 s48, s47, 20480
    s_add_u32 s41, s47, 0
    buffer_load_dwordx4 v[72:75], v2, s[12:15], s41 offen offset:0 sc1
    s_add_u32 s41, s48, 0
    buffer_load_dwordx4 v[76:79], v2, s[12:15], s41 offen offset:0 sc1
    s_add_u32 s41, s47, 0
    buffer_load_dwordx4 v[80:83], v2, s[12:15], s41 offen offset:1024 sc1
    s_add_u32 s41, s48, 0
    buffer_load_dwordx4 v[84:87], v2, s[12:15], s41 offen offset:1024 sc1
    s_add_u32 s41, s47, 0
    buffer_load_dwordx4 v[88:91], v2, s[12:15], s41 offen offset:2048 sc1
    s_add_u32 s41, s48, 0
    buffer_load_dwordx4 v[92:95], v2, s[12:15], s41 offen offset:2048 sc1
    v_lshlrev_b32 v9, 6, v4
    v_lshl_add_u32 v9, v3, 4, v9
    s_lshl_b32 s41, s46, 10
    s_add_u32 s41, s41, s36
    s_add_u32 s41, s41, 1581056
    buffer_load_dwordx4 v[216:219], v9, s[12:15], s41 offen offset:0 sc1
    buffer_load_dwordx4 v[220:223], v9, s[12:15], s41 offen offset:1024 sc1
    s_mul_i32 s52, s46, 55296
    s_mul_i32 s41, s35, 3584
    s_add_u32 s52, s52, s41
    s_add_u32 s52, s52, s36
    s_add_u32 s52, s52, 696320
    s_add_u32 s53, s52, 55296
    s_barrier
    v_add_u32 v11, 0x20000, v2
    ds_read_b128 v[160:163], v14 offset:49152
    ds_read_b128 v[164:167], v14 offset:50176
    ds_read_b128 v[168:171], v14 offset:51200
    ds_read_b128 v[172:175], v14 offset:52224
    ds_read_b128 v[176:179], v14 offset:53248
    ds_read_b128 v[180:183], v14 offset:54272
    ds_read_b128 v[184:187], v14 offset:55296
    s_waitcnt vmcnt(6)
    s_waitcnt lgkmcnt(6)
    v_mfma_f32_16x16x32_bf16 v[16:19], v[160:163], v[72:75], 0
    v_mfma_f32_16x16x32_bf16 v[44:47], v[160:163], v[76:79], 0
    ds_read_b128 v[188:191], v14 offset:56320
    s_waitcnt lgkmcnt(6)
    v_mfma_f32_16x16x32_bf16 v[20:23], v[164:167], v[72:75], 0
    v_mfma_f32_16x16x32_bf16 v[48:51], v[164:167], v[76:79], 0
    ds_read_b128 v[192:195], v14 offset:57344
    s_add_u32 s41, s47, 0
    buffer_load_dwordx4 v[96:99], v2, s[12:15], s41 offen offset:3072 sc1
    s_add_u32 s41, s48, 0
    buffer_load_dwordx4 v[100:103], v2, s[12:15], s41 offen offset:3072 sc1
    s_waitcnt lgkmcnt(6)
    v_mfma_f32_16x16x32_bf16 v[24:27], v[168:171], v[72:75], 0
    v_mfma_f32_16x16x32_bf16 v[52:55], v[168:171], v[76:79], 0
    ds_read_b128 v[196:199], v14 offset:58368
    s_waitcnt lgkmcnt(6)
    v_mfma_f32_16x16x32_bf16 v[28:31], v[172:175], v[72:75], 0
    v_mfma_f32_16x16x32_bf16 v[56:59], v[172:175], v[76:79], 0
    ds_read_b128 v[200:203], v14 offset:59392
    s_waitcnt lgkmcnt(6)
    v_mfma_f32_16x16x32_bf16 v[32:35], v[176:179], v[72:75], 0
    v_mfma_f32_16x16x32_bf16 v[60:63], v[176:179], v[76:79], 0
    ds_read_b128 v[204:207], v14 offset:60416
    s_add_u32 s41, s47, 4096
    buffer_load_dwordx4 v[104:107], v2, s[12:15], s41 offen offset:0 sc1
    s_add_u32 s41, s48, 4096
    buffer_load_dwordx4 v[108:111], v2, s[12:15], s41 offen offset:0 sc1
    s_waitcnt lgkmcnt(6)
    v_mfma_f32_16x16x32_bf16 v[36:39], v[180:183], v[72:75], 0
    v_mfma_f32_16x16x32_bf16 v[64:67], v[180:183], v[76:79], 0
    ds_read_b128 v[208:211], v14 offset:61440
    s_waitcnt lgkmcnt(6)
    v_mfma_f32_16x16x32_bf16 v[40:43], v[184:187], v[72:75], 0
    v_mfma_f32_16x16x32_bf16 v[68:71], v[184:187], v[76:79], 0
    ds_read_b128 v[212:215], v14 offset:62464
    s_waitcnt vmcnt(8)
    s_waitcnt lgkmcnt(6)
    v_mfma_f32_16x16x32_bf16 v[16:19], v[188:191], v[80:83], v[16:19]
    v_mfma_f32_16x16x32_bf16 v[44:47], v[188:191], v[84:87], v[44:47]
    ds_read_b128 v[160:163], v14 offset:63488
    s_waitcnt lgkmcnt(6)
    v_mfma_f32_16x16x32_bf16 v[20:23], v[192:195], v[80:83], v[20:23]
    v_mfma_f32_16x16x32_bf16 v[48:51], v[192:195], v[84:87], v[48:51]
    ds_read_b128 v[164:167], v14 offset:64512
    s_add_u32 s41, s47, 4096
    buffer_load_dwordx4 v[112:115], v2, s[12:15], s41 offen offset:1024 sc1
    s_add_u32 s41, s48, 4096
    buffer_load_dwordx4 v[116:119], v2, s[12:15], s41 offen offset:1024 sc1
    s_waitcnt lgkmcnt(6)
    v_mfma_f32_16x16x32_bf16 v[24:27], v[196:199], v[80:83], v[24:27]
    v_mfma_f32_16x16x32_bf16 v[52:55], v[196:199], v[84:87], v[52:55]
    ds_read_b128 v[168:171], v15 offset:0
    buffer_load_dwordx4 a[0:3], v2, s[12:15], s40 offen offset:0
    s_waitcnt lgkmcnt(6)
    v_mfma_f32_16x16x32_bf16 v[28:31], v[200:203], v[80:83], v[28:31]
    v_mfma_f32_16x16x32_bf16 v[56:59], v[200:203], v[84:87], v[56:59]
    ds_read_b128 v[172:175], v15 offset:1024
    buffer_load_dwordx4 a[4:7], v2, s[12:15], s40 offen offset:1024
    s_waitcnt lgkmcnt(6)
    v_mfma_f32_16x16x32_bf16 v[32:35], v[204:207], v[80:83], v[32:35]
    v_mfma_f32_16x16x32_bf16 v[60:63], v[204:207], v[84:87], v[60:63]
    ds_read_b128 v[176:179], v15 offset:2048
    s_add_u32 s41, s47, 4096
    buffer_load_dwordx4 v[120:123], v2, s[12:15], s41 offen offset:2048 sc1
    s_add_u32 s41, s48, 4096
    buffer_load_dwordx4 v[124:127], v2, s[12:15], s41 offen offset:2048 sc1
    s_waitcnt lgkmcnt(6)
    v_mfma_f32_16x16x32_bf16 v[36:39], v[208:211], v[80:83], v[36:39]
    v_mfma_f32_16x16x32_bf16 v[64:67], v[208:211], v[84:87], v[64:67]
    ds_read_b128 v[180:183], v15 offset:3072
    buffer_load_dwordx4 a[8:11], v2, s[12:15], s40 offen offset:2048
    s_waitcnt lgkmcnt(6)
    v_mfma_f32_16x16x32_bf16 v[40:43], v[212:215], v[80:83], v[40:43]
    v_mfma_f32_16x16x32_bf16 v[68:71], v[212:215], v[84:87], v[68:71]
    ds_read_b128 v[184:187], v15 offset:4096
    s_waitcnt vmcnt(13)
    s_waitcnt lgkmcnt(6)
    v_mfma_f32_16x16x32_bf16 v[16:19], v[160:163], v[88:91], v[16:19]
    v_mfma_f32_16x16x32_bf16 v[44:47], v[160:163], v[92:95], v[44:47]
    ds_read_b128 v[188:191], v15 offset:5120
    s_waitcnt lgkmcnt(6)
    v_mfma_f32_16x16x32_bf16 v[20:23], v[164:167], v[88:91], v[20:23]
    v_mfma_f32_16x16x32_bf16 v[48:51], v[164:167], v[92:95], v[48:51]
    ds_read_b128 v[192:195], v15 offset:6144
    s_add_u32 s41, s47, 4096
    buffer_load_dwordx4 v[128:131], v2, s[12:15], s41 offen offset:3072 sc1
    s_add_u32 s41, s48, 4096
    buffer_load_dwordx4 v[132:135], v2, s[12:15], s41 offen offset:3072 sc1
    s_waitcnt lgkmcnt(6)
    v_mfma_f32_16x16x32_bf16 v[24:27], v[168:171], v[88:91], v[24:27]
    v_mfma_f32_16x16x32_bf16 v[52:55], v[168:171], v[92:95], v[52:55]
    ds_read_b128 v[196:199], v15 offset:7168
    buffer_load_dwordx4 a[12:15], v2, s[12:15], s40 offen offset:3072
    s_add_u32 s40, s40, 4096
    s_waitcnt lgkmcnt(6)
    v_mfma_f32_16x16x32_bf16 v[28:31], v[172:175], v[88:91], v[28:31]
    v_mfma_f32_16x16x32_bf16 v[56:59], v[172:175], v[92:95], v[56:59]
    ds_read_b128 v[200:203], v15 offset:8192
    buffer_load_dwordx4 a[16:19], v2, s[12:15], s40 offen offset:0
    s_waitcnt lgkmcnt(6)
    v_mfma_f32_16x16x32_bf16 v[32:35], v[176:179], v[88:91], v[32:35]
    v_mfma_f32_16x16x32_bf16 v[60:63], v[176:179], v[92:95], v[60:63]
    ds_read_b128 v[204:207], v15 offset:9216
    s_add_u32 s41, s47, 8192
    buffer_load_dwordx4 v[136:139], v2, s[12:15], s41 offen offset:0 sc1
    s_add_u32 s41, s48, 8192
    buffer_load_dwordx4 v[140:143], v2, s[12:15], s41 offen offset:0 sc1
    s_waitcnt lgkmcnt(6)
    v_mfma_f32_16x16x32_bf16 v[36:39], v[180:183], v[88:91], v[36:39]
    v_mfma_f32_16x16x32_bf16 v[64:67], v[180:183], v[92:95], v[64:67]
    ds_read_b128 v[208:211], v15 offset:10240
    buffer_load_dwordx4 a[20:23], v2, s[12:15], s40 offen offset:1024
    s_waitcnt lgkmcnt(6)
    v_mfma_f32_16x16x32_bf16 v[40:43], v[184:187], v[88:91], v[40:43]
    v_mfma_f32_16x16x32_bf16 v[68:71], v[184:187], v[92:95], v[68:71]
    ds_read_b128 v[212:215], v15 offset:11264
    s_waitcnt vmcnt(16)
    s_waitcnt lgkmcnt(6)
    v_mfma_f32_16x16x32_bf16 v[16:19], v[188:191], v[96:99], v[16:19]
    v_mfma_f32_16x16x32_bf16 v[44:47], v[188:191], v[100:103], v[44:47]
    ds_read_b128 v[160:163], v15 offset:12288
    s_waitcnt lgkmcnt(6)
    v_mfma_f32_16x16x32_bf16 v[20:23], v[192:195], v[96:99], v[20:23]
    v_mfma_f32_16x16x32_bf16 v[48:51], v[192:195], v[100:103], v[48:51]
    ds_read_b128 v[164:167], v15 offset:13312
    s_add_u32 s41, s47, 8192
    buffer_load_dwordx4 v[144:147], v2, s[12:15], s41 offen offset:1024 sc1
    s_add_u32 s41, s48, 8192
    buffer_load_dwordx4 v[148:151], v2, s[12:15], s41 offen offset:1024 sc1
    s_waitcnt lgkmcnt(6)
    v_mfma_f32_16x16x32_bf16 v[24:27], v[196:199], v[96:99], v[24:27]
    v_mfma_f32_16x16x32_bf16 v[52:55], v[196:199], v[100:103], v[52:55]
    ds_read_b128 v[168:171], v15 offset:14336
    buffer_load_dwordx4 a[24:27], v2, s[12:15], s40 offen offset:2048
    s_waitcnt lgkmcnt(6)
    v_mfma_f32_16x16x32_bf16 v[28:31], v[200:203], v[96:99], v[28:31]
    v_mfma_f32_16x16x32_bf16 v[56:59], v[200:203], v[100:103], v[56:59]
    ds_read_b128 v[172:175], v15 offset:15360
    buffer_load_dwordx4 a[28:31], v2, s[12:15], s40 offen offset:3072
    s_add_u32 s40, s40, 4096
    s_waitcnt lgkmcnt(6)
    v_mfma_f32_16x16x32_bf16 v[32:35], v[204:207], v[96:99], v[32:35]
    v_mfma_f32_16x16x32_bf16 v[60:63], v[204:207], v[100:103], v[60:63]
    ds_read_b128 v[176:179], v15 offset:16384
    s_waitcnt lgkmcnt(6)
    v_mfma_f32_16x16x32_bf16 v[36:39], v[208:211], v[96:99], v[36:39]
    v_mfma_f32_16x16x32_bf16 v[64:67], v[208:211], v[100:103], v[64:67]
    ds_read_b128 v[180:183], v15 offset:17408
    buffer_load_dwordx4 a[32:35], v2, s[12:15], s40 offen offset:0
    s_waitcnt lgkmcnt(6)
    v_mfma_f32_16x16x32_bf16 v[40:43], v[212:215], v[96:99], v[40:43]
    v_mfma_f32_16x16x32_bf16 v[68:71], v[212:215], v[100:103], v[68:71]
    ds_read_b128 v[184:187], v15 offset:18432
    s_waitcnt vmcnt(19)
    s_waitcnt lgkmcnt(6)
    v_mfma_f32_16x16x32_bf16 v[16:19], v[160:163], v[104:107], v[16:19]
    v_mfma_f32_16x16x32_bf16 v[44:47], v[160:163], v[108:111], v[44:47]
    ds_read_b128 v[188:191], v15 offset:19456
    s_waitcnt lgkmcnt(6)
    v_mfma_f32_16x16x32_bf16 v[20:23], v[164:167], v[104:107], v[20:23]
    v_mfma_f32_16x16x32_bf16 v[48:51], v[164:167], v[108:111], v[48:51]
    ds_read_b128 v[192:195], v15 offset:20480
    s_add_u32 s41, s47, 8192
    buffer_load_dwordx4 v[152:155], v2, s[12:15], s41 offen offset:2048 sc1
    s_add_u32 s41, s48, 8192
    buffer_load_dwordx4 v[156:159], v2, s[12:15], s41 offen offset:2048 sc1
    s_waitcnt lgkmcnt(6)
    v_mfma_f32_16x16x32_bf16 v[24:27], v[168:171], v[104:107], v[24:27]
    v_mfma_f32_16x16x32_bf16 v[52:55], v[168:171], v[108:111], v[52:55]
    ds_read_b128 v[196:199], v15 offset:21504
    buffer_load_dwordx4 a[36:39], v2, s[12:15], s40 offen offset:1024
    s_waitcnt lgkmcnt(6)
    v_mfma_f32_16x16x32_bf16 v[28:31], v[172:175], v[104:107], v[28:31]
    v_mfma_f32_16x16x32_bf16 v[56:59], v[172:175], v[108:111], v[56:59]
    ds_read_b128 v[200:203], v15 offset:22528
    buffer_load_dwordx4 a[40:43], v2, s[12:15], s40 offen offset:2048
    s_waitcnt lgkmcnt(6)
    v_mfma_f32_16x16x32_bf16 v[32:35], v[176:179], v[104:107], v[32:35]
    v_mfma_f32_16x16x32_bf16 v[60:63], v[176:179], v[108:111], v[60:63]
    ds_read_b128 v[204:207], v15 offset:23552
    s_waitcnt lgkmcnt(6)
    v_mfma_f32_16x16x32_bf16 v[36:39], v[180:183], v[104:107], v[36:39]
    v_mfma_f32_16x16x32_bf16 v[64:67], v[180:183], v[108:111], v[64:67]
    ds_read_b128 v[208:211], v15 offset:24576
    buffer_load_dwordx4 a[44:47], v2, s[12:15], s40 offen offset:3072
    s_add_u32 s40, s40, 4096
    s_waitcnt lgkmcnt(6)
    v_mfma_f32_16x16x32_bf16 v[40:43], v[184:187], v[104:107], v[40:43]
    v_mfma_f32_16x16x32_bf16 v[68:71], v[184:187], v[108:111], v[68:71]
    ds_read_b128 v[212:215], v15 offset:25600
    s_waitcnt vmcnt(22)
    s_waitcnt lgkmcnt(6)
    v_mfma_f32_16x16x32_bf16 v[16:19], v[188:191], v[112:115], v[16:19]
    v_mfma_f32_16x16x32_bf16 v[44:47], v[188:191], v[116:119], v[44:47]
    ds_read_b128 v[160:163], v15 offset:26624
    v_add_f32 v224, v216, v218
    v_add_f32 v225, v217, v219
    s_waitcnt lgkmcnt(6)
    v_mfma_f32_16x16x32_bf16 v[20:23], v[192:195], v[112:115], v[20:23]
    v_mfma_f32_16x16x32_bf16 v[48:51], v[192:195], v[116:119], v[48:51]
    ds_read_b128 v[164:167], v15 offset:27648
    s_add_u32 s41, s47, 8192
    buffer_load_dwordx4 v[72:75], v2, s[12:15], s41 offen offset:3072 sc1
    s_add_u32 s41, s48, 8192
    buffer_load_dwordx4 v[76:79], v2, s[12:15], s41 offen offset:3072 sc1
    v_mov_b32 v216, v224
    v_mov_b32 v217, v225
    s_waitcnt lgkmcnt(6)
    v_mfma_f32_16x16x32_bf16 v[24:27], v[196:199], v[112:115], v[24:27]
    v_mfma_f32_16x16x32_bf16 v[52:55], v[196:199], v[116:119], v[52:55]
    ds_read_b128 v[168:171], v15 offset:28672
    buffer_load_dwordx4 a[48:51], v2, s[12:15], s40 offen offset:0
    s_nop 1
    v_permlane32_swap_b32 v216, v224
    s_waitcnt lgkmcnt(6)
    v_mfma_f32_16x16x32_bf16 v[28:31], v[200:203], v[112:115], v[28:31]
    v_mfma_f32_16x16x32_bf16 v[56:59], v[200:203], v[116:119], v[56:59]
    ds_read_b128 v[172:175], v15 offset:29696
    buffer_load_dwordx4 a[52:55], v2, s[12:15], s40 offen offset:1024
    v_permlane32_swap_b32 v217, v225
    s_nop 0
    s_waitcnt lgkmcnt(6)
    v_mfma_f32_16x16x32_bf16 v[32:35], v[204:207], v[112:115], v[32:35]
    v_mfma_f32_16x16x32_bf16 v[60:63], v[204:207], v[116:119], v[60:63]
    ds_read_b128 v[176:179], v15 offset:30720
    v_add_f32 v224, v224, v216
    v_add_f32 v225, v225, v217
    s_waitcnt lgkmcnt(6)
    v_mfma_f32_16x16x32_bf16 v[36:39], v[208:211], v[112:115], v[36:39]
    v_mfma_f32_16x16x32_bf16 v[64:67], v[208:211], v[116:119], v[64:67]
    ds_read_b128 v[180:183], v15 offset:31744
    buffer_load_dwordx4 a[56:59], v2, s[12:15], s40 offen offset:2048
    v_mov_b32 v216, v224
    v_mov_b32 v217, v225
    s_waitcnt lgkmcnt(6)
    v_mfma_f32_16x16x32_bf16 v[40:43], v[212:215], v[112:115], v[40:43]
    v_mfma_f32_16x16x32_bf16 v[68:71], v[212:215], v[116:119], v[68:71]
    ds_read_b128 v[184:187], v15 offset:32768
    s_nop 1
    v_permlane16_swap_b32 v216, v224
    s_waitcnt vmcnt(23)
    s_waitcnt lgkmcnt(6)
    v_mfma_f32_16x16x32_bf16 v[16:19], v[160:163], v[120:123], v[16:19]
    v_mfma_f32_16x16x32_bf16 v[44:47], v[160:163], v[124:127], v[44:47]
    ds_read_b128 v[188:191], v15 offset:33792
    v_permlane16_swap_b32 v217, v225
    s_nop 0
    s_waitcnt lgkmcnt(6)
    v_mfma_f32_16x16x32_bf16 v[20:23], v[164:167], v[120:123], v[20:23]
    v_mfma_f32_16x16x32_bf16 v[48:51], v[164:167], v[124:127], v[48:51]
    ds_read_b128 v[192:195], v15 offset:34816
    s_add_u32 s41, s47, 12288
    buffer_load_dwordx4 v[80:83], v2, s[12:15], s41 offen offset:0 sc1
    s_add_u32 s41, s48, 12288
    buffer_load_dwordx4 v[84:87], v2, s[12:15], s41 offen offset:0 sc1
    v_add_f32 v224, v224, v216
    v_add_f32 v225, v225, v217
    s_waitcnt lgkmcnt(6)
    v_mfma_f32_16x16x32_bf16 v[24:27], v[168:171], v[120:123], v[24:27]
    v_mfma_f32_16x16x32_bf16 v[52:55], v[168:171], v[124:127], v[52:55]
    ds_read_b128 v[196:199], v15 offset:35840
    buffer_load_dwordx4 a[60:63], v2, s[12:15], s40 offen offset:3072
    s_add_u32 s40, s40, 4096
    v_mul_f32 v224, 0x3acccccd, v224
    v_mul_f32 v225, 0x3acccccd, v225
    s_waitcnt lgkmcnt(6)
    v_mfma_f32_16x16x32_bf16 v[28:31], v[172:175], v[120:123], v[28:31]
    v_mfma_f32_16x16x32_bf16 v[56:59], v[172:175], v[124:127], v[56:59]
    ds_read_b128 v[200:203], v15 offset:36864
    buffer_load_dwordx4 a[64:67], v2, s[12:15], s40 offen offset:0
    v_fma_f32 v225, -v224, v224, v225
    v_max_f32 v225, 0, v225
    s_waitcnt lgkmcnt(6)
    v_mfma_f32_16x16x32_bf16 v[32:35], v[176:179], v[120:123], v[32:35]
    v_mfma_f32_16x16x32_bf16 v[60:63], v[176:179], v[124:127], v[60:63]
    ds_read_b128 v[204:207], v15 offset:37888
    v_cvt_pk_bf16_f32 v216, v224, v225
    v_lshlrev_b32 v224, 16, v216
    s_waitcnt lgkmcnt(6)
    v_mfma_f32_16x16x32_bf16 v[36:39], v[180:183], v[120:123], v[36:39]
    v_mfma_f32_16x16x32_bf16 v[64:67], v[180:183], v[124:127], v[64:67]
    ds_read_b128 v[208:211], v15 offset:38912
    buffer_load_dwordx4 a[68:71], v2, s[12:15], s40 offen offset:1024
    v_and_b32 v225, 0xffff0000, v216
    v_add_f32 v225, 0x3727c5ac, v225
    s_waitcnt lgkmcnt(6)
    v_mfma_f32_16x16x32_bf16 v[40:43], v[184:187], v[120:123], v[40:43]
    v_mfma_f32_16x16x32_bf16 v[68:71], v[184:187], v[124:127], v[68:71]
    ds_read_b128 v[212:215], v15 offset:39936
    v_cvt_pk_bf16_f32 v216, v225, v225
    v_lshlrev_b32 v225, 16, v216
    s_waitcnt vmcnt(25)
    s_waitcnt lgkmcnt(6)
    v_mfma_f32_16x16x32_bf16 v[16:19], v[188:191], v[128:131], v[16:19]
    v_mfma_f32_16x16x32_bf16 v[44:47], v[188:191], v[132:135], v[44:47]
    ds_read_b128 v[160:163], v15 offset:40960
    v_sqrt_f32 v225, v225
    s_nop 0
    s_waitcnt lgkmcnt(6)
    v_mfma_f32_16x16x32_bf16 v[20:23], v[192:195], v[128:131], v[20:23]
    v_mfma_f32_16x16x32_bf16 v[48:51], v[192:195], v[132:135], v[48:51]
    ds_read_b128 v[164:167], v15 offset:41984
    s_add_u32 s41, s47, 12288
    buffer_load_dwordx4 v[88:91], v2, s[12:15], s41 offen offset:1024 sc1
    s_add_u32 s41, s48, 12288
    buffer_load_dwordx4 v[92:95], v2, s[12:15], s41 offen offset:1024 sc1
    v_cvt_pk_bf16_f32 v216, v225, v225
    v_lshlrev_b32 v225, 16, v216
    s_waitcnt lgkmcnt(6)
    v_mfma_f32_16x16x32_bf16 v[24:27], v[196:199], v[128:131], v[24:27]
    v_mfma_f32_16x16x32_bf16 v[52:55], v[196:199], v[132:135], v[52:55]
    ds_read_b128 v[168:171], v15 offset:43008
    buffer_load_dwordx4 a[72:75], v2, s[12:15], s40 offen offset:2048
    v_rcp_f32 v225, v225
    s_nop 0
    s_waitcnt lgkmcnt(6)
    v_mfma_f32_16x16x32_bf16 v[28:31], v[200:203], v[128:131], v[28:31]
    v_mfma_f32_16x16x32_bf16 v[56:59], v[200:203], v[132:135], v[56:59]
    ds_read_b128 v[172:175], v15 offset:44032
    buffer_load_dwordx4 a[76:79], v2, s[12:15], s40 offen offset:3072
    s_add_u32 s40, s40, 4096
    v_mul_f32 v224, v224, v225
    v_sub_f32 v224, 0, v224
    s_waitcnt lgkmcnt(6)
    v_mfma_f32_16x16x32_bf16 v[32:35], v[204:207], v[128:131], v[32:35]
    v_mfma_f32_16x16x32_bf16 v[60:63], v[204:207], v[132:135], v[60:63]
    ds_read_b128 v[176:179], v15 offset:45056
    v_add_f32 v226, v220, v222
    v_add_f32 v227, v221, v223
    s_waitcnt lgkmcnt(6)
    v_mfma_f32_16x16x32_bf16 v[36:39], v[208:211], v[128:131], v[36:39]
    v_mfma_f32_16x16x32_bf16 v[64:67], v[208:211], v[132:135], v[64:67]
    ds_read_b128 v[180:183], v15 offset:46080
    buffer_load_dwordx4 a[80:83], v2, s[12:15], s40 offen offset:0
    v_mov_b32 v216, v226
    v_mov_b32 v217, v227
    s_waitcnt lgkmcnt(6)
    v_mfma_f32_16x16x32_bf16 v[40:43], v[212:215], v[128:131], v[40:43]
    v_mfma_f32_16x16x32_bf16 v[68:71], v[212:215], v[132:135], v[68:71]
    ds_read_b128 v[184:187], v15 offset:47104
    s_nop 1
    v_permlane32_swap_b32 v216, v226
    s_waitcnt vmcnt(26)
    s_waitcnt lgkmcnt(6)
    v_mfma_f32_16x16x32_bf16 v[16:19], v[160:163], v[136:139], v[16:19]
    v_mfma_f32_16x16x32_bf16 v[44:47], v[160:163], v[140:143], v[44:47]
    ds_read_b128 v[188:191], v15 offset:48128
    v_permlane32_swap_b32 v217, v227
    s_nop 0
    s_waitcnt lgkmcnt(6)
    v_mfma_f32_16x16x32_bf16 v[20:23], v[164:167], v[136:139], v[20:23]
    v_mfma_f32_16x16x32_bf16 v[48:51], v[164:167], v[140:143], v[48:51]
    ds_read_b128 v[192:195], v15 offset:49152
    s_add_u32 s41, s47, 12288
    buffer_load_dwordx4 v[96:99], v2, s[12:15], s41 offen offset:2048 sc1
    s_add_u32 s41, s48, 12288
    buffer_load_dwordx4 v[100:103], v2, s[12:15], s41 offen offset:2048 sc1
    v_add_f32 v226, v226, v216
    v_add_f32 v227, v227, v217
    s_waitcnt lgkmcnt(6)
    v_mfma_f32_16x16x32_bf16 v[24:27], v[168:171], v[136:139], v[24:27]
    v_mfma_f32_16x16x32_bf16 v[52:55], v[168:171], v[140:143], v[52:55]
    ds_read_b128 v[196:199], v15 offset:50176
    buffer_load_dwordx4 a[84:87], v2, s[12:15], s40 offen offset:1024
    v_mov_b32 v216, v226
    v_mov_b32 v217, v227
    s_waitcnt lgkmcnt(6)
    v_mfma_f32_16x16x32_bf16 v[28:31], v[172:175], v[136:139], v[28:31]
    v_mfma_f32_16x16x32_bf16 v[56:59], v[172:175], v[140:143], v[56:59]
    ds_read_b128 v[200:203], v15 offset:51200
    buffer_load_dwordx4 a[88:91], v2, s[12:15], s40 offen offset:2048
    s_nop 1
    v_permlane16_swap_b32 v216, v226
    s_waitcnt lgkmcnt(6)
    v_mfma_f32_16x16x32_bf16 v[32:35], v[176:179], v[136:139], v[32:35]
    v_mfma_f32_16x16x32_bf16 v[60:63], v[176:179], v[140:143], v[60:63]
    ds_read_b128 v[204:207], v15 offset:52224
    v_permlane16_swap_b32 v217, v227
    s_nop 0
    s_waitcnt lgkmcnt(6)
    v_mfma_f32_16x16x32_bf16 v[36:39], v[180:183], v[136:139], v[36:39]
    v_mfma_f32_16x16x32_bf16 v[64:67], v[180:183], v[140:143], v[64:67]
    ds_read_b128 v[208:211], v15 offset:53248
    buffer_load_dwordx4 a[92:95], v2, s[12:15], s40 offen offset:3072
    s_add_u32 s40, s40, 4096
    v_add_f32 v226, v226, v216
    v_add_f32 v227, v227, v217
    s_waitcnt lgkmcnt(6)
    v_mfma_f32_16x16x32_bf16 v[40:43], v[184:187], v[136:139], v[40:43]
    v_mfma_f32_16x16x32_bf16 v[68:71], v[184:187], v[140:143], v[68:71]
    ds_read_b128 v[212:215], v15 offset:54272
    v_mul_f32 v226, 0x3acccccd, v226
    v_mul_f32 v227, 0x3acccccd, v227
    s_waitcnt vmcnt(28)
    s_waitcnt lgkmcnt(6)
    v_mfma_f32_16x16x32_bf16 v[16:19], v[188:191], v[144:147], v[16:19]
    v_mfma_f32_16x16x32_bf16 v[44:47], v[188:191], v[148:151], v[44:47]
    ds_read_b128 v[160:163], v15 offset:55296
    v_fma_f32 v227, -v226, v226, v227
    v_max_f32 v227, 0, v227
    s_waitcnt lgkmcnt(6)
    v_mfma_f32_16x16x32_bf16 v[20:23], v[192:195], v[144:147], v[20:23]
    v_mfma_f32_16x16x32_bf16 v[48:51], v[192:195], v[148:151], v[48:51]
    ds_read_b128 v[164:167], v15 offset:56320
    s_add_u32 s41, s47, 12288
    buffer_load_dwordx4 v[104:107], v2, s[12:15], s41 offen offset:3072 sc1
    s_add_u32 s41, s48, 12288
    buffer_load_dwordx4 v[108:111], v2, s[12:15], s41 offen offset:3072 sc1
    v_cvt_pk_bf16_f32 v216, v226, v227
    v_lshlrev_b32 v226, 16, v216
    s_waitcnt lgkmcnt(6)
    v_mfma_f32_16x16x32_bf16 v[24:27], v[196:199], v[144:147], v[24:27]
    v_mfma_f32_16x16x32_bf16 v[52:55], v[196:199], v[148:151], v[52:55]
    ds_read_b128 v[168:171], v15 offset:57344
    buffer_load_dwordx4 a[96:99], v2, s[12:15], s40 offen offset:0
    v_and_b32 v227, 0xffff0000, v216
    v_add_f32 v227, 0x3727c5ac, v227
    s_waitcnt lgkmcnt(6)
    v_mfma_f32_16x16x32_bf16 v[28:31], v[200:203], v[144:147], v[28:31]
    v_mfma_f32_16x16x32_bf16 v[56:59], v[200:203], v[148:151], v[56:59]
    ds_read_b128 v[172:175], v15 offset:58368
    buffer_load_dwordx4 a[100:103], v2, s[12:15], s40 offen offset:1024
    v_cvt_pk_bf16_f32 v216, v227, v227
    v_lshlrev_b32 v227, 16, v216
    s_waitcnt lgkmcnt(6)
    v_mfma_f32_16x16x32_bf16 v[32:35], v[204:207], v[144:147], v[32:35]
    v_mfma_f32_16x16x32_bf16 v[60:63], v[204:207], v[148:151], v[60:63]
    ds_read_b128 v[176:179], v15 offset:59392
    v_sqrt_f32 v227, v227
    s_nop 0
    s_waitcnt lgkmcnt(6)
    v_mfma_f32_16x16x32_bf16 v[36:39], v[208:211], v[144:147], v[36:39]
    v_mfma_f32_16x16x32_bf16 v[64:67], v[208:211], v[148:151], v[64:67]
    ds_read_b128 v[180:183], v15 offset:60416
    buffer_load_dwordx4 a[104:107], v2, s[12:15], s40 offen offset:2048
    v_cvt_pk_bf16_f32 v216, v227, v227
    v_lshlrev_b32 v227, 16, v216
    s_waitcnt lgkmcnt(6)
    v_mfma_f32_16x16x32_bf16 v[40:43], v[212:215], v[144:147], v[40:43]
    v_mfma_f32_16x16x32_bf16 v[68:71], v[212:215], v[148:151], v[68:71]
    ds_read_b128 v[184:187], v15 offset:61440
    v_rcp_f32 v227, v227
    s_nop 0
    s_waitcnt vmcnt(28)
    s_waitcnt lgkmcnt(6)
    v_mfma_f32_16x16x32_bf16 v[16:19], v[160:163], v[152:155], v[16:19]
    v_mfma_f32_16x16x32_bf16 v[44:47], v[160:163], v[156:159], v[44:47]
    ds_read_b128 v[188:191], v15 offset:62464
    v_mul_f32 v226, v226, v227
    v_sub_f32 v226, 0, v226
    s_waitcnt lgkmcnt(6)
    v_mfma_f32_16x16x32_bf16 v[20:23], v[164:167], v[152:155], v[20:23]
    v_mfma_f32_16x16x32_bf16 v[48:51], v[164:167], v[156:159], v[48:51]
    ds_read_b128 v[192:195], v15 offset:63488
    s_add_u32 s41, s47, 16384
    buffer_load_dwordx4 v[112:115], v2, s[12:15], s41 offen offset:0 sc1
    s_add_u32 s41, s48, 16384
    buffer_load_dwordx4 v[116:119], v2, s[12:15], s41 offen offset:0 sc1
    s_waitcnt lgkmcnt(6)
    v_mfma_f32_16x16x32_bf16 v[24:27], v[168:171], v[152:155], v[24:27]
    v_mfma_f32_16x16x32_bf16 v[52:55], v[168:171], v[156:159], v[52:55]
    ds_read_b128 v[196:199], v15 offset:64512
    buffer_load_dwordx4 a[108:111], v2, s[12:15], s40 offen offset:3072
    s_add_u32 s40, s40, 4096
    s_waitcnt lgkmcnt(6)
    v_mfma_f32_16x16x32_bf16 v[28:31], v[172:175], v[152:155], v[28:31]
    v_mfma_f32_16x16x32_bf16 v[56:59], v[172:175], v[156:159], v[56:59]
    ds_read_b128 v[200:203], v11 offset:0
    buffer_load_dwordx4 a[112:115], v2, s[12:15], s40 offen offset:0
    s_waitcnt lgkmcnt(6)
    v_mfma_f32_16x16x32_bf16 v[32:35], v[176:179], v[152:155], v[32:35]
    v_mfma_f32_16x16x32_bf16 v[60:63], v[176:179], v[156:159], v[60:63]
    ds_read_b128 v[204:207], v11 offset:1024
    s_waitcnt lgkmcnt(6)
    v_mfma_f32_16x16x32_bf16 v[36:39], v[180:183], v[152:155], v[36:39]
    v_mfma_f32_16x16x32_bf16 v[64:67], v[180:183], v[156:159], v[64:67]
    ds_read_b128 v[208:211], v11 offset:2048
    buffer_load_dwordx4 a[116:119], v2, s[12:15], s40 offen offset:1024
    s_waitcnt lgkmcnt(6)
    v_mfma_f32_16x16x32_bf16 v[40:43], v[184:187], v[152:155], v[40:43]
    v_mfma_f32_16x16x32_bf16 v[68:71], v[184:187], v[156:159], v[68:71]
    ds_read_b128 v[212:215], v11 offset:3072
    s_waitcnt vmcnt(28)
    s_waitcnt lgkmcnt(6)
    v_mfma_f32_16x16x32_bf16 v[16:19], v[188:191], v[72:75], v[16:19]
    v_mfma_f32_16x16x32_bf16 v[44:47], v[188:191], v[76:79], v[44:47]
    ds_read_b128 v[160:163], v11 offset:4096
    s_waitcnt lgkmcnt(6)
    v_mfma_f32_16x16x32_bf16 v[20:23], v[192:195], v[72:75], v[20:23]
    v_mfma_f32_16x16x32_bf16 v[48:51], v[192:195], v[76:79], v[48:51]
    ds_read_b128 v[164:167], v11 offset:5120
    s_add_u32 s41, s47, 16384
    buffer_load_dwordx4 v[120:123], v2, s[12:15], s41 offen offset:1024 sc1
    s_add_u32 s41, s48, 16384
    buffer_load_dwordx4 v[124:127], v2, s[12:15], s41 offen offset:1024 sc1
    s_waitcnt lgkmcnt(6)
    v_mfma_f32_16x16x32_bf16 v[24:27], v[196:199], v[72:75], v[24:27]
    v_mfma_f32_16x16x32_bf16 v[52:55], v[196:199], v[76:79], v[52:55]
    ds_read_b128 v[168:171], v11 offset:6144
    buffer_load_dwordx4 a[120:123], v2, s[12:15], s40 offen offset:2048
    s_waitcnt lgkmcnt(6)
    v_mfma_f32_16x16x32_bf16 v[28:31], v[200:203], v[72:75], v[28:31]
    v_mfma_f32_16x16x32_bf16 v[56:59], v[200:203], v[76:79], v[56:59]
    ds_read_b128 v[172:175], v11 offset:7168
    buffer_load_dwordx4 a[124:127], v2, s[12:15], s40 offen offset:3072
    s_add_u32 s40, s40, 4096
    s_waitcnt lgkmcnt(6)
    v_mfma_f32_16x16x32_bf16 v[32:35], v[204:207], v[72:75], v[32:35]
    v_mfma_f32_16x16x32_bf16 v[60:63], v[204:207], v[76:79], v[60:63]
    ds_read_b128 v[176:179], v11 offset:8192
    s_waitcnt lgkmcnt(6)
    v_mfma_f32_16x16x32_bf16 v[36:39], v[208:211], v[72:75], v[36:39]
    v_mfma_f32_16x16x32_bf16 v[64:67], v[208:211], v[76:79], v[64:67]
    ds_read_b128 v[180:183], v11 offset:9216
    buffer_load_dwordx4 a[128:131], v2, s[12:15], s40 offen offset:0
    s_waitcnt lgkmcnt(6)
    v_mfma_f32_16x16x32_bf16 v[40:43], v[212:215], v[72:75], v[40:43]
    v_mfma_f32_16x16x32_bf16 v[68:71], v[212:215], v[76:79], v[68:71]
    ds_read_b128 v[184:187], v11 offset:10240
    s_waitcnt vmcnt(28)
    s_waitcnt lgkmcnt(6)
    v_mfma_f32_16x16x32_bf16 v[16:19], v[160:163], v[80:83], v[16:19]
    v_mfma_f32_16x16x32_bf16 v[44:47], v[160:163], v[84:87], v[44:47]
    ds_read_b128 v[188:191], v11 offset:11264
    s_waitcnt lgkmcnt(6)
    v_mfma_f32_16x16x32_bf16 v[20:23], v[164:167], v[80:83], v[20:23]
    v_mfma_f32_16x16x32_bf16 v[48:51], v[164:167], v[84:87], v[48:51]
    ds_read_b128 v[192:195], v11 offset:12288
    s_add_u32 s41, s47, 16384
    buffer_load_dwordx4 v[128:131], v2, s[12:15], s41 offen offset:2048 sc1
    s_add_u32 s41, s48, 16384
    buffer_load_dwordx4 v[132:135], v2, s[12:15], s41 offen offset:2048 sc1
    s_waitcnt lgkmcnt(6)
    v_mfma_f32_16x16x32_bf16 v[24:27], v[168:171], v[80:83], v[24:27]
    v_mfma_f32_16x16x32_bf16 v[52:55], v[168:171], v[84:87], v[52:55]
    ds_read_b128 v[196:199], v11 offset:13312
    buffer_load_dwordx4 a[132:135], v2, s[12:15], s40 offen offset:1024
    s_waitcnt lgkmcnt(6)
    v_mfma_f32_16x16x32_bf16 v[28:31], v[172:175], v[80:83], v[28:31]
    v_mfma_f32_16x16x32_bf16 v[56:59], v[172:175], v[84:87], v[56:59]
    ds_read_b128 v[200:203], v11 offset:14336
    buffer_load_dwordx4 a[136:139], v2, s[12:15], s40 offen offset:2048
    s_waitcnt lgkmcnt(6)
    v_mfma_f32_16x16x32_bf16 v[32:35], v[176:179], v[80:83], v[32:35]
    v_mfma_f32_16x16x32_bf16 v[60:63], v[176:179], v[84:87], v[60:63]
    ds_read_b128 v[204:207], v11 offset:15360
    s_waitcnt lgkmcnt(6)
    v_mfma_f32_16x16x32_bf16 v[36:39], v[180:183], v[80:83], v[36:39]
    v_mfma_f32_16x16x32_bf16 v[64:67], v[180:183], v[84:87], v[64:67]
    ds_read_b128 v[208:211], v11 offset:16384
    buffer_load_dwordx4 a[140:143], v2, s[12:15], s40 offen offset:3072
    s_add_u32 s40, s40, 4096
    s_waitcnt lgkmcnt(6)
    v_mfma_f32_16x16x32_bf16 v[40:43], v[184:187], v[80:83], v[40:43]
    v_mfma_f32_16x16x32_bf16 v[68:71], v[184:187], v[84:87], v[68:71]
    ds_read_b128 v[212:215], v11 offset:17408
    buffer_load_dwordx4 a[144:147], v2, s[12:15], s40 offen offset:0
    s_waitcnt vmcnt(29)
    s_waitcnt lgkmcnt(6)
    v_mfma_f32_16x16x32_bf16 v[16:19], v[188:191], v[88:91], v[16:19]
    v_mfma_f32_16x16x32_bf16 v[44:47], v[188:191], v[92:95], v[44:47]
    ds_read_b128 v[160:163], v11 offset:18432
    s_waitcnt lgkmcnt(6)
    v_mfma_f32_16x16x32_bf16 v[20:23], v[192:195], v[88:91], v[20:23]
    v_mfma_f32_16x16x32_bf16 v[48:51], v[192:195], v[92:95], v[48:51]
    ds_read_b128 v[164:167], v11 offset:19456
    s_add_u32 s41, s47, 16384
    buffer_load_dwordx4 v[136:139], v2, s[12:15], s41 offen offset:3072 sc1
    s_add_u32 s41, s48, 16384
    buffer_load_dwordx4 v[140:143], v2, s[12:15], s41 offen offset:3072 sc1
    s_waitcnt lgkmcnt(6)
    v_mfma_f32_16x16x32_bf16 v[24:27], v[196:199], v[88:91], v[24:27]
    v_mfma_f32_16x16x32_bf16 v[52:55], v[196:199], v[92:95], v[52:55]
    ds_read_b128 v[168:171], v11 offset:20480
    buffer_load_dwordx4 a[148:151], v2, s[12:15], s40 offen offset:1024
    s_waitcnt lgkmcnt(6)
    v_mfma_f32_16x16x32_bf16 v[28:31], v[200:203], v[88:91], v[28:31]
    v_mfma_f32_16x16x32_bf16 v[56:59], v[200:203], v[92:95], v[56:59]
    ds_read_b128 v[172:175], v11 offset:21504
    buffer_load_dwordx4 a[152:155], v2, s[12:15], s40 offen offset:2048
    s_waitcnt lgkmcnt(6)
    v_mfma_f32_16x16x32_bf16 v[32:35], v[204:207], v[88:91], v[32:35]
    v_mfma_f32_16x16x32_bf16 v[60:63], v[204:207], v[92:95], v[60:63]
    ds_read_b128 v[176:179], v11 offset:22528
    s_waitcnt lgkmcnt(6)
    v_mfma_f32_16x16x32_bf16 v[36:39], v[208:211], v[88:91], v[36:39]
    v_mfma_f32_16x16x32_bf16 v[64:67], v[208:211], v[92:95], v[64:67]
    ds_read_b128 v[180:183], v11 offset:23552
    buffer_load_dwordx4 a[156:159], v2, s[12:15], s40 offen offset:3072
    s_add_u32 s40, s40, 4096
    s_waitcnt lgkmcnt(6)
    v_mfma_f32_16x16x32_bf16 v[40:43], v[212:215], v[88:91], v[40:43]
    v_mfma_f32_16x16x32_bf16 v[68:71], v[212:215], v[92:95], v[68:71]
    ds_read_b128 v[184:187], v14 offset:0
    buffer_load_dwordx4 a[160:163], v2, s[12:15], s40 offen offset:0
    s_add_u32 s48, s54, 368640
    buffer_load_dwordx4 v[228:231], v254, s[12:15], s48 offen sc1
    buffer_load_dwordx4 v[232:235], v254, s[12:15], s48 offen offset:1024 sc1
    buffer_load_dwordx2 v[236:237], v8, s[12:15], s48 offen offset:2048 sc1
    s_waitcnt vmcnt(33)
    s_waitcnt lgkmcnt(6)
    v_mfma_f32_16x16x32_bf16 v[16:19], v[160:163], v[96:99], v[16:19]
    v_mfma_f32_16x16x32_bf16 v[44:47], v[160:163], v[100:103], v[44:47]
    ds_read_b128 v[188:191], v14 offset:1024
    s_waitcnt lgkmcnt(6)
    v_mfma_f32_16x16x32_bf16 v[20:23], v[164:167], v[96:99], v[20:23]
    v_mfma_f32_16x16x32_bf16 v[48:51], v[164:167], v[100:103], v[48:51]
    ds_read_b128 v[192:195], v14 offset:2048
    s_waitcnt lgkmcnt(6)
    v_mfma_f32_16x16x32_bf16 v[24:27], v[168:171], v[96:99], v[24:27]
    v_mfma_f32_16x16x32_bf16 v[52:55], v[168:171], v[100:103], v[52:55]
    ds_read_b128 v[196:199], v14 offset:3072
    buffer_load_dwordx4 a[164:167], v2, s[12:15], s40 offen offset:1024
    s_waitcnt lgkmcnt(6)
    v_mfma_f32_16x16x32_bf16 v[28:31], v[172:175], v[96:99], v[28:31]
    v_mfma_f32_16x16x32_bf16 v[56:59], v[172:175], v[100:103], v[56:59]
    ds_read_b128 v[200:203], v14 offset:4096
    buffer_load_dwordx4 a[168:171], v2, s[12:15], s40 offen offset:2048
    s_waitcnt lgkmcnt(6)
    v_mfma_f32_16x16x32_bf16 v[32:35], v[176:179], v[96:99], v[32:35]
    v_mfma_f32_16x16x32_bf16 v[60:63], v[176:179], v[100:103], v[60:63]
    ds_read_b128 v[204:207], v14 offset:5120
    s_waitcnt lgkmcnt(6)
    v_mfma_f32_16x16x32_bf16 v[36:39], v[180:183], v[96:99], v[36:39]
    v_mfma_f32_16x16x32_bf16 v[64:67], v[180:183], v[100:103], v[64:67]
    ds_read_b128 v[208:211], v14 offset:6144
    buffer_load_dwordx4 a[172:175], v2, s[12:15], s40 offen offset:3072
    s_add_u32 s40, s40, 4096
    s_waitcnt lgkmcnt(6)
    v_mfma_f32_16x16x32_bf16 v[40:43], v[184:187], v[96:99], v[40:43]
    v_mfma_f32_16x16x32_bf16 v[68:71], v[184:187], v[100:103], v[68:71]
    ds_read_b128 v[212:215], v14 offset:7168
    buffer_load_dwordx4 a[176:179], v2, s[12:15], s40 offen offset:0
    s_add_u32 s48, s54, 20480
    buffer_load_dwordx4 v[238:241], v254, s[12:15], s48 offen sc1
    buffer_load_dwordx4 v[242:245], v254, s[12:15], s48 offen offset:1024 sc1
    buffer_load_dwordx2 v[246:247], v8, s[12:15], s48 offen offset:2048 sc1
    s_waitcnt vmcnt(35)
    s_waitcnt lgkmcnt(6)
    v_mfma_f32_16x16x32_bf16 v[16:19], v[188:191], v[104:107], v[16:19]
    v_mfma_f32_16x16x32_bf16 v[44:47], v[188:191], v[108:111], v[44:47]
    ds_read_b128 v[160:163], v14 offset:8192
    s_waitcnt lgkmcnt(6)
    v_mfma_f32_16x16x32_bf16 v[20:23], v[192:195], v[104:107], v[20:23]
    v_mfma_f32_16x16x32_bf16 v[48:51], v[192:195], v[108:111], v[48:51]
    ds_read_b128 v[164:167], v14 offset:9216
    s_waitcnt lgkmcnt(6)
    v_mfma_f32_16x16x32_bf16 v[24:27], v[196:199], v[104:107], v[24:27]
    v_mfma_f32_16x16x32_bf16 v[52:55], v[196:199], v[108:111], v[52:55]
    ds_read_b128 v[168:171], v14 offset:10240
    buffer_load_dwordx4 a[180:183], v2, s[12:15], s40 offen offset:1024
    s_waitcnt lgkmcnt(6)
    v_mfma_f32_16x16x32_bf16 v[28:31], v[200:203], v[104:107], v[28:31]
    v_mfma_f32_16x16x32_bf16 v[56:59], v[200:203], v[108:111], v[56:59]
    ds_read_b128 v[172:175], v14 offset:11264
    buffer_load_dwordx4 a[184:187], v2, s[12:15], s40 offen offset:2048
    s_waitcnt lgkmcnt(6)
    v_mfma_f32_16x16x32_bf16 v[32:35], v[204:207], v[104:107], v[32:35]
    v_mfma_f32_16x16x32_bf16 v[60:63], v[204:207], v[108:111], v[60:63]
    ds_read_b128 v[176:179], v14 offset:12288
    s_waitcnt lgkmcnt(6)
    v_mfma_f32_16x16x32_bf16 v[36:39], v[208:211], v[104:107], v[36:39]
    v_mfma_f32_16x16x32_bf16 v[64:67], v[208:211], v[108:111], v[64:67]
    ds_read_b128 v[180:183], v14 offset:13312
    buffer_load_dwordx4 a[188:191], v2, s[12:15], s40 offen offset:3072
    s_add_u32 s40, s40, 4096
    s_waitcnt lgkmcnt(6)
    v_mfma_f32_16x16x32_bf16 v[40:43], v[212:215], v[104:107], v[40:43]
    v_mfma_f32_16x16x32_bf16 v[68:71], v[212:215], v[108:111], v[68:71]
    ds_read_b128 v[184:187], v14 offset:14336
    buffer_load_dwordx4 a[192:195], v2, s[12:15], s40 offen offset:0
    s_waitcnt vmcnt(34)
    s_waitcnt lgkmcnt(6)
    v_mfma_f32_16x16x32_bf16 v[16:19], v[160:163], v[112:115], v[16:19]
    v_mfma_f32_16x16x32_bf16 v[44:47], v[160:163], v[116:119], v[44:47]
    ds_read_b128 v[188:191], v14 offset:15360
    s_waitcnt lgkmcnt(6)
    v_mfma_f32_16x16x32_bf16 v[20:23], v[164:167], v[112:115], v[20:23]
    v_mfma_f32_16x16x32_bf16 v[48:51], v[164:167], v[116:119], v[48:51]
    ds_read_b128 v[192:195], v14 offset:16384
    s_waitcnt lgkmcnt(6)
    v_mfma_f32_16x16x32_bf16 v[24:27], v[168:171], v[112:115], v[24:27]
    v_mfma_f32_16x16x32_bf16 v[52:55], v[168:171], v[116:119], v[52:55]
    ds_read_b128 v[196:199], v14 offset:17408
    buffer_load_dwordx4 a[196:199], v2, s[12:15], s40 offen offset:1024
    s_waitcnt lgkmcnt(6)
    v_mfma_f32_16x16x32_bf16 v[28:31], v[172:175], v[112:115], v[28:31]
    v_mfma_f32_16x16x32_bf16 v[56:59], v[172:175], v[116:119], v[56:59]
    ds_read_b128 v[200:203], v14 offset:18432
    buffer_load_dwordx4 a[200:203], v2, s[12:15], s40 offen offset:2048
    s_waitcnt lgkmcnt(6)
    v_mfma_f32_16x16x32_bf16 v[32:35], v[176:179], v[112:115], v[32:35]
    v_mfma_f32_16x16x32_bf16 v[60:63], v[176:179], v[116:119], v[60:63]
    ds_read_b128 v[204:207], v14 offset:19456
    s_waitcnt lgkmcnt(6)
    v_mfma_f32_16x16x32_bf16 v[36:39], v[180:183], v[112:115], v[36:39]
    v_mfma_f32_16x16x32_bf16 v[64:67], v[180:183], v[116:119], v[64:67]
    ds_read_b128 v[208:211], v14 offset:20480
    buffer_load_dwordx4 a[204:207], v2, s[12:15], s40 offen offset:3072
    s_add_u32 s40, s40, 4096
    s_waitcnt lgkmcnt(6)
    v_mfma_f32_16x16x32_bf16 v[40:43], v[184:187], v[112:115], v[40:43]
    v_mfma_f32_16x16x32_bf16 v[68:71], v[184:187], v[116:119], v[68:71]
    ds_read_b128 v[212:215], v14 offset:21504
    buffer_load_dwordx4 a[208:211], v2, s[12:15], s40 offen offset:0
    s_waitcnt vmcnt(33)
    s_waitcnt lgkmcnt(6)
    v_mfma_f32_16x16x32_bf16 v[16:19], v[188:191], v[120:123], v[16:19]
    v_mfma_f32_16x16x32_bf16 v[44:47], v[188:191], v[124:127], v[44:47]
    ds_read_b128 v[160:163], v14 offset:22528
    s_waitcnt lgkmcnt(6)
    v_mfma_f32_16x16x32_bf16 v[20:23], v[192:195], v[120:123], v[20:23]
    v_mfma_f32_16x16x32_bf16 v[48:51], v[192:195], v[124:127], v[48:51]
    ds_read_b128 v[164:167], v14 offset:23552
    s_waitcnt lgkmcnt(6)
    v_mfma_f32_16x16x32_bf16 v[24:27], v[196:199], v[120:123], v[24:27]
    v_mfma_f32_16x16x32_bf16 v[52:55], v[196:199], v[124:127], v[52:55]
    ds_read_b128 v[168:171], v14 offset:24576
    buffer_load_dwordx4 a[212:215], v2, s[12:15], s40 offen offset:1024
    s_waitcnt lgkmcnt(6)
    v_mfma_f32_16x16x32_bf16 v[28:31], v[200:203], v[120:123], v[28:31]
    v_mfma_f32_16x16x32_bf16 v[56:59], v[200:203], v[124:127], v[56:59]
    ds_read_b128 v[172:175], v14 offset:25600
    buffer_load_dwordx4 a[216:219], v2, s[12:15], s40 offen offset:2048
    s_waitcnt lgkmcnt(6)
    v_mfma_f32_16x16x32_bf16 v[32:35], v[204:207], v[120:123], v[32:35]
    v_mfma_f32_16x16x32_bf16 v[60:63], v[204:207], v[124:127], v[60:63]
    ds_read_b128 v[176:179], v14 offset:26624
    s_waitcnt lgkmcnt(6)
    v_mfma_f32_16x16x32_bf16 v[36:39], v[208:211], v[120:123], v[36:39]
    v_mfma_f32_16x16x32_bf16 v[64:67], v[208:211], v[124:127], v[64:67]
    ds_read_b128 v[180:183], v14 offset:27648
    buffer_load_dwordx4 a[220:223], v2, s[12:15], s40 offen offset:3072
    s_add_u32 s40, s40, 4096
    s_waitcnt lgkmcnt(6)
    v_mfma_f32_16x16x32_bf16 v[40:43], v[212:215], v[120:123], v[40:43]
    v_mfma_f32_16x16x32_bf16 v[68:71], v[212:215], v[124:127], v[68:71]
    ds_read_b128 v[184:187], v14 offset:28672
    buffer_load_dwordx4 a[224:227], v2, s[12:15], s40 offen offset:0
    s_waitcnt vmcnt(32)
    s_waitcnt lgkmcnt(6)
    v_mfma_f32_16x16x32_bf16 v[16:19], v[160:163], v[128:131], v[16:19]
    v_mfma_f32_16x16x32_bf16 v[44:47], v[160:163], v[132:135], v[44:47]
    ds_read_b128 v[188:191], v14 offset:29696
    s_waitcnt lgkmcnt(6)
    v_mfma_f32_16x16x32_bf16 v[20:23], v[164:167], v[128:131], v[20:23]
    v_mfma_f32_16x16x32_bf16 v[48:51], v[164:167], v[132:135], v[48:51]
    ds_read_b128 v[192:195], v14 offset:30720
    s_waitcnt lgkmcnt(6)
    v_mfma_f32_16x16x32_bf16 v[24:27], v[168:171], v[128:131], v[24:27]
    v_mfma_f32_16x16x32_bf16 v[52:55], v[168:171], v[132:135], v[52:55]
    ds_read_b128 v[196:199], v14 offset:31744
    buffer_load_dwordx4 a[228:231], v2, s[12:15], s40 offen offset:1024
    s_waitcnt lgkmcnt(6)
    v_mfma_f32_16x16x32_bf16 v[28:31], v[172:175], v[128:131], v[28:31]
    v_mfma_f32_16x16x32_bf16 v[56:59], v[172:175], v[132:135], v[56:59]
    ds_read_b128 v[200:203], v14 offset:32768
    buffer_load_dwordx4 a[232:235], v2, s[12:15], s40 offen offset:2048
    s_waitcnt lgkmcnt(6)
    v_mfma_f32_16x16x32_bf16 v[32:35], v[176:179], v[128:131], v[32:35]
    v_mfma_f32_16x16x32_bf16 v[60:63], v[176:179], v[132:135], v[60:63]
    ds_read_b128 v[204:207], v14 offset:33792
    s_waitcnt lgkmcnt(6)
    v_mfma_f32_16x16x32_bf16 v[36:39], v[180:183], v[128:131], v[36:39]
    v_mfma_f32_16x16x32_bf16 v[64:67], v[180:183], v[132:135], v[64:67]
    ds_read_b128 v[208:211], v14 offset:34816
    buffer_load_dwordx4 a[236:239], v2, s[12:15], s40 offen offset:3072
    s_add_u32 s40, s40, 4096
    s_cmp_eq_u32 s30, 3
    s_cselect_b32 s41, 61440, 0
    s_sub_u32 s40, s40, s41
    s_waitcnt lgkmcnt(6)
    v_mfma_f32_16x16x32_bf16 v[40:43], v[184:187], v[128:131], v[40:43]
    v_mfma_f32_16x16x32_bf16 v[68:71], v[184:187], v[132:135], v[68:71]
    ds_read_b128 v[212:215], v14 offset:35840
    buffer_load_dwordx4 a[240:243], v2, s[12:15], s40 offen offset:0
    s_waitcnt vmcnt(30)
    s_waitcnt lgkmcnt(6)
    v_mfma_f32_16x16x32_bf16 v[16:19], v[188:191], v[136:139], v[16:19]
    v_mfma_f32_16x16x32_bf16 v[44:47], v[188:191], v[140:143], v[44:47]
    s_waitcnt lgkmcnt(5)
    v_mfma_f32_16x16x32_bf16 v[20:23], v[192:195], v[136:139], v[20:23]
    v_mfma_f32_16x16x32_bf16 v[48:51], v[192:195], v[140:143], v[48:51]
    s_waitcnt lgkmcnt(4)
    v_mfma_f32_16x16x32_bf16 v[24:27], v[196:199], v[136:139], v[24:27]
    v_mfma_f32_16x16x32_bf16 v[52:55], v[196:199], v[140:143], v[52:55]
    buffer_load_dwordx4 a[244:247], v2, s[12:15], s40 offen offset:1024
    s_waitcnt lgkmcnt(3)
    v_mfma_f32_16x16x32_bf16 v[28:31], v[200:203], v[136:139], v[28:31]
    v_mfma_f32_16x16x32_bf16 v[56:59], v[200:203], v[140:143], v[56:59]
    buffer_load_dwordx4 a[248:251], v2, s[12:15], s40 offen offset:2048
    s_waitcnt lgkmcnt(2)
    v_mfma_f32_16x16x32_bf16 v[32:35], v[204:207], v[136:139], v[32:35]
    v_mfma_f32_16x16x32_bf16 v[60:63], v[204:207], v[140:143], v[60:63]
    s_waitcnt lgkmcnt(1)
    v_mfma_f32_16x16x32_bf16 v[36:39], v[208:211], v[136:139], v[36:39]
    v_mfma_f32_16x16x32_bf16 v[64:67], v[208:211], v[140:143], v[64:67]
    buffer_load_dwordx4 a[252:255], v2, s[12:15], s40 offen offset:3072
    s_add_u32 s40, s40, 4096
    s_waitcnt lgkmcnt(0)
    v_mfma_f32_16x16x32_bf16 v[40:43], v[212:215], v[136:139], v[40:43]
    v_mfma_f32_16x16x32_bf16 v[68:71], v[212:215], v[140:143], v[68:71]
    v_lshlrev_b32 v9, 4, v3
    v_add_u32 v9, 156672, v9
    v_mov_b32 v12, 0xbdd2d3e8
    v_mov_b32 v13, 0xc0135761
    ds_read_b128 v[72:75], v9 offset:0
    ds_read_b128 v[100:103], v9 offset:512
    ds_read_b128 v[76:79], v9 offset:64
    ds_read_b128 v[104:107], v9 offset:576
    ds_read_b128 v[80:83], v9 offset:128
    ds_read_b128 v[108:111], v9 offset:640
    ds_read_b128 v[84:87], v9 offset:192
    ds_read_b128 v[112:115], v9 offset:704
    ds_read_b128 v[88:91], v9 offset:256
    ds_read_b128 v[116:119], v9 offset:768
    ds_read_b128 v[92:95], v9 offset:320
    ds_read_b128 v[120:123], v9 offset:832
    ds_read_b128 v[96:99], v9 offset:384
    ds_read_b128 v[124:127], v9 offset:896
    s_waitcnt lgkmcnt(0)
    v_pk_add_f32 v[72:73], v[72:73], v[100:101]
    v_pk_add_f32 v[74:75], v[74:75], v[102:103]
    v_pk_add_f32 v[76:77], v[76:77], v[104:105]
    v_pk_add_f32 v[78:79], v[78:79], v[106:107]
    v_pk_add_f32 v[80:81], v[80:81], v[108:109]
    v_pk_add_f32 v[82:83], v[82:83], v[110:111]
    v_pk_add_f32 v[84:85], v[84:85], v[112:113]
    v_pk_add_f32 v[86:87], v[86:87], v[114:115]
    v_pk_add_f32 v[88:89], v[88:89], v[116:117]
    v_pk_add_f32 v[90:91], v[90:91], v[118:119]
    v_pk_add_f32 v[92:93], v[92:93], v[120:121]
    v_pk_add_f32 v[94:95], v[94:95], v[122:123]
    v_pk_add_f32 v[96:97], v[96:97], v[124:125]
    v_pk_add_f32 v[98:99], v[98:99], v[126:127]
    s_lshl_b32 s49, s34, 2
    s_add_u32 s49, s49, s30
    s_lshl_b32 s49, s49, 7
    s_add_u32 s49, s49, s37
    s_lshl_b32 s41, s35, 2
    s_add_u32 s49, s49, s41
    v_pk_mul_f32 v[160:161], v[72:73], v[224:225] op_sel_hi:[1,0]
    v_pk_mul_f32 v[162:163], v[74:75], v[224:225] op_sel_hi:[1,0]
    v_pk_mul_f32 v[164:165], v[72:73], v[226:227] op_sel_hi:[1,0]
    v_pk_mul_f32 v[166:167], v[74:75], v[226:227] op_sel_hi:[1,0]
    v_pk_mul_f32 v[168:169], v[76:77], v[224:225] op_sel_hi:[1,0]
    v_pk_mul_f32 v[170:171], v[78:79], v[224:225] op_sel_hi:[1,0]
    v_pk_mul_f32 v[172:173], v[76:77], v[226:227] op_sel_hi:[1,0]
    v_pk_mul_f32 v[174:175], v[78:79], v[226:227] op_sel_hi:[1,0]
    v_pk_fma_f32 v[16:17], v[16:17], v[224:225], v[160:161] op_sel:[0,1,0] op_sel_hi:[1,1,1]
    v_pk_fma_f32 v[18:19], v[18:19], v[224:225], v[162:163] op_sel:[0,1,0] op_sel_hi:[1,1,1]
    v_pk_fma_f32 v[44:45], v[44:45], v[226:227], v[164:165] op_sel:[0,1,0] op_sel_hi:[1,1,1]
    v_pk_fma_f32 v[46:47], v[46:47], v[226:227], v[166:167] op_sel:[0,1,0] op_sel_hi:[1,1,1]
    v_pk_fma_f32 v[20:21], v[20:21], v[224:225], v[168:169] op_sel:[0,1,0] op_sel_hi:[1,1,1]
    v_pk_fma_f32 v[22:23], v[22:23], v[224:225], v[170:171] op_sel:[0,1,0] op_sel_hi:[1,1,1]
    v_pk_fma_f32 v[48:49], v[48:49], v[226:227], v[172:173] op_sel:[0,1,0] op_sel_hi:[1,1,1]
    v_pk_fma_f32 v[50:51], v[50:51], v[226:227], v[174:175] op_sel:[0,1,0] op_sel_hi:[1,1,1]
    v_pk_mul_f32 v[160:161], v[16:17], v[16:17]
    v_pk_mul_f32 v[162:163], v[18:19], v[18:19]
    v_pk_mul_f32 v[164:165], v[44:45], v[44:45]
    v_pk_mul_f32 v[166:167], v[46:47], v[46:47]
    v_pk_mul_f32 v[168:169], v[20:21], v[20:21]
    v_pk_mul_f32 v[170:171], v[22:23], v[22:23]
    v_pk_mul_f32 v[172:173], v[48:49], v[48:49]
    v_pk_mul_f32 v[174:175], v[50:51], v[50:51]
    v_pk_fma_f32 v[160:161], v[160:161], v[12:13], v[12:13] op_sel:[0,0,1] op_sel_hi:[1,0,1]
    v_pk_fma_f32 v[162:163], v[162:163], v[12:13], v[12:13] op_sel:[0,0,1] op_sel_hi:[1,0,1]
    v_pk_fma_f32 v[164:165], v[164:165], v[12:13], v[12:13] op_sel:[0,0,1] op_sel_hi:[1,0,1]
    v_pk_fma_f32 v[166:167], v[166:167], v[12:13], v[12:13] op_sel:[0,0,1] op_sel_hi:[1,0,1]
    v_pk_fma_f32 v[168:169], v[168:169], v[12:13], v[12:13] op_sel:[0,0,1] op_sel_hi:[1,0,1]
    v_pk_fma_f32 v[170:171], v[170:171], v[12:13], v[12:13] op_sel:[0,0,1] op_sel_hi:[1,0,1]
    v_pk_fma_f32 v[172:173], v[172:173], v[12:13], v[12:13] op_sel:[0,0,1] op_sel_hi:[1,0,1]
    v_pk_fma_f32 v[174:175], v[174:175], v[12:13], v[12:13] op_sel:[0,0,1] op_sel_hi:[1,0,1]
    v_pk_mul_f32 v[160:161], v[160:161], v[16:17]
    v_pk_mul_f32 v[162:163], v[162:163], v[18:19]
    v_pk_mul_f32 v[164:165], v[164:165], v[44:45]
    v_pk_mul_f32 v[166:167], v[166:167], v[46:47]
    v_pk_mul_f32 v[168:169], v[168:169], v[20:21]
    v_pk_mul_f32 v[170:171], v[170:171], v[22:23]
    v_pk_mul_f32 v[172:173], v[172:173], v[48:49]
    v_pk_mul_f32 v[174:175], v[174:175], v[50:51]
    v_exp_f32 v160, v160
    v_exp_f32 v161, v161
    v_exp_f32 v162, v162
    v_exp_f32 v163, v163
    v_exp_f32 v164, v164
    v_exp_f32 v165, v165
    v_exp_f32 v166, v166
    v_exp_f32 v167, v167
    v_exp_f32 v168, v168
    v_exp_f32 v169, v169
    v_exp_f32 v170, v170
    v_exp_f32 v171, v171
    v_exp_f32 v172, v172
    v_exp_f32 v173, v173
    v_exp_f32 v174, v174
    v_exp_f32 v175, v175
    v_pk_add_f32 v[160:161], v[160:161], 1.0 op_sel_hi:[1,0]
    v_pk_add_f32 v[162:163], v[162:163], 1.0 op_sel_hi:[1,0]
    v_pk_add_f32 v[164:165], v[164:165], 1.0 op_sel_hi:[1,0]
    v_pk_add_f32 v[166:167], v[166:167], 1.0 op_sel_hi:[1,0]
    v_pk_add_f32 v[168:169], v[168:169], 1.0 op_sel_hi:[1,0]
    v_pk_add_f32 v[170:171], v[170:171], 1.0 op_sel_hi:[1,0]
    v_pk_add_f32 v[172:173], v[172:173], 1.0 op_sel_hi:[1,0]
    v_pk_add_f32 v[174:175], v[174:175], 1.0 op_sel_hi:[1,0]
    v_rcp_f32 v160, v160
    v_rcp_f32 v161, v161
    v_rcp_f32 v162, v162
    v_rcp_f32 v163, v163
    v_rcp_f32 v164, v164
    v_rcp_f32 v165, v165
    v_rcp_f32 v166, v166
    v_rcp_f32 v167, v167
    v_rcp_f32 v168, v168
    v_rcp_f32 v169, v169
    v_rcp_f32 v170, v170
    v_rcp_f32 v171, v171
    v_rcp_f32 v172, v172
    v_rcp_f32 v173, v173
    v_rcp_f32 v174, v174
    v_rcp_f32 v175, v175
    s_nop 0
    v_pk_mul_f32 v[16:17], v[16:17], v[160:161]
    v_pk_mul_f32 v[18:19], v[18:19], v[162:163]
    v_pk_mul_f32 v[44:45], v[44:45], v[164:165]
    v_pk_mul_f32 v[46:47], v[46:47], v[166:167]
    v_pk_mul_f32 v[20:21], v[20:21], v[168:169]
    v_pk_mul_f32 v[22:23], v[22:23], v[170:171]
    v_pk_mul_f32 v[48:49], v[48:49], v[172:173]
    v_pk_mul_f32 v[50:51], v[50:51], v[174:175]
    v_cvt_pk_bf16_f32 v16, v16, v17
    v_cvt_pk_bf16_f32 v17, v18, v19
    v_cvt_pk_bf16_f32 v18, v20, v21
    v_cvt_pk_bf16_f32 v19, v22, v23
    v_cvt_pk_bf16_f32 v44, v44, v45
    v_cvt_pk_bf16_f32 v45, v46, v47
    v_cvt_pk_bf16_f32 v46, v48, v49
    v_cvt_pk_bf16_f32 v47, v50, v51
    s_nop 1
    v_permlane16_swap_b32 v16, v18
    v_permlane16_swap_b32 v17, v19
    v_permlane16_swap_b32 v44, v46
    v_permlane16_swap_b32 v45, v47
    buffer_store_dwordx4 v[16:19], v254, s[12:15], s52 offen offset:0 sc1
    buffer_store_dwordx4 v[44:47], v254, s[12:15], s53 offen offset:0 sc1
k2_kernel_gs30:
    v_pk_mul_f32 v[160:161], v[80:81], v[224:225] op_sel_hi:[1,0]
    v_pk_mul_f32 v[162:163], v[82:83], v[224:225] op_sel_hi:[1,0]
    v_pk_mul_f32 v[164:165], v[80:81], v[226:227] op_sel_hi:[1,0]
    v_pk_mul_f32 v[166:167], v[82:83], v[226:227] op_sel_hi:[1,0]
    v_pk_mul_f32 v[168:169], v[84:85], v[224:225] op_sel_hi:[1,0]
    v_pk_mul_f32 v[170:171], v[86:87], v[224:225] op_sel_hi:[1,0]
    v_pk_mul_f32 v[172:173], v[84:85], v[226:227] op_sel_hi:[1,0]
    v_pk_mul_f32 v[174:175], v[86:87], v[226:227] op_sel_hi:[1,0]
    v_pk_fma_f32 v[24:25], v[24:25], v[224:225], v[160:161] op_sel:[0,1,0] op_sel_hi:[1,1,1]
    v_pk_fma_f32 v[26:27], v[26:27], v[224:225], v[162:163] op_sel:[0,1,0] op_sel_hi:[1,1,1]
    v_pk_fma_f32 v[52:53], v[52:53], v[226:227], v[164:165] op_sel:[0,1,0] op_sel_hi:[1,1,1]
    v_pk_fma_f32 v[54:55], v[54:55], v[226:227], v[166:167] op_sel:[0,1,0] op_sel_hi:[1,1,1]
    v_pk_fma_f32 v[28:29], v[28:29], v[224:225], v[168:169] op_sel:[0,1,0] op_sel_hi:[1,1,1]
    v_pk_fma_f32 v[30:31], v[30:31], v[224:225], v[170:171] op_sel:[0,1,0] op_sel_hi:[1,1,1]
    v_pk_fma_f32 v[56:57], v[56:57], v[226:227], v[172:173] op_sel:[0,1,0] op_sel_hi:[1,1,1]
    v_pk_fma_f32 v[58:59], v[58:59], v[226:227], v[174:175] op_sel:[0,1,0] op_sel_hi:[1,1,1]
    v_pk_mul_f32 v[160:161], v[24:25], v[24:25]
    v_pk_mul_f32 v[162:163], v[26:27], v[26:27]
    v_pk_mul_f32 v[164:165], v[52:53], v[52:53]
    v_pk_mul_f32 v[166:167], v[54:55], v[54:55]
    v_pk_mul_f32 v[168:169], v[28:29], v[28:29]
    v_pk_mul_f32 v[170:171], v[30:31], v[30:31]
    v_pk_mul_f32 v[172:173], v[56:57], v[56:57]
    v_pk_mul_f32 v[174:175], v[58:59], v[58:59]
    v_pk_fma_f32 v[160:161], v[160:161], v[12:13], v[12:13] op_sel:[0,0,1] op_sel_hi:[1,0,1]
    v_pk_fma_f32 v[162:163], v[162:163], v[12:13], v[12:13] op_sel:[0,0,1] op_sel_hi:[1,0,1]
    v_pk_fma_f32 v[164:165], v[164:165], v[12:13], v[12:13] op_sel:[0,0,1] op_sel_hi:[1,0,1]
    v_pk_fma_f32 v[166:167], v[166:167], v[12:13], v[12:13] op_sel:[0,0,1] op_sel_hi:[1,0,1]
    v_pk_fma_f32 v[168:169], v[168:169], v[12:13], v[12:13] op_sel:[0,0,1] op_sel_hi:[1,0,1]
    v_pk_fma_f32 v[170:171], v[170:171], v[12:13], v[12:13] op_sel:[0,0,1] op_sel_hi:[1,0,1]
    v_pk_fma_f32 v[172:173], v[172:173], v[12:13], v[12:13] op_sel:[0,0,1] op_sel_hi:[1,0,1]
    v_pk_fma_f32 v[174:175], v[174:175], v[12:13], v[12:13] op_sel:[0,0,1] op_sel_hi:[1,0,1]
    v_pk_mul_f32 v[160:161], v[160:161], v[24:25]
    v_pk_mul_f32 v[162:163], v[162:163], v[26:27]
    v_pk_mul_f32 v[164:165], v[164:165], v[52:53]
    v_pk_mul_f32 v[166:167], v[166:167], v[54:55]
    v_pk_mul_f32 v[168:169], v[168:169], v[28:29]
    v_pk_mul_f32 v[170:171], v[170:171], v[30:31]
    v_pk_mul_f32 v[172:173], v[172:173], v[56:57]
    v_pk_mul_f32 v[174:175], v[174:175], v[58:59]
    v_exp_f32 v160, v160
    v_exp_f32 v161, v161
    v_exp_f32 v162, v162
    v_exp_f32 v163, v163
    v_exp_f32 v164, v164
    v_exp_f32 v165, v165
    v_exp_f32 v166, v166
    v_exp_f32 v167, v167
    v_exp_f32 v168, v168
    v_exp_f32 v169, v169
    v_exp_f32 v170, v170
    v_exp_f32 v171, v171
    v_exp_f32 v172, v172
    v_exp_f32 v173, v173
    v_exp_f32 v174, v174
    v_exp_f32 v175, v175
    v_pk_add_f32 v[160:161], v[160:161], 1.0 op_sel_hi:[1,0]
    v_pk_add_f32 v[162:163], v[162:163], 1.0 op_sel_hi:[1,0]
    v_pk_add_f32 v[164:165], v[164:165], 1.0 op_sel_hi:[1,0]
    v_pk_add_f32 v[166:167], v[166:167], 1.0 op_sel_hi:[1,0]
    v_pk_add_f32 v[168:169], v[168:169], 1.0 op_sel_hi:[1,0]
    v_pk_add_f32 v[170:171], v[170:171], 1.0 op_sel_hi:[1,0]
    v_pk_add_f32 v[172:173], v[172:173], 1.0 op_sel_hi:[1,0]
    v_pk_add_f32 v[174:175], v[174:175], 1.0 op_sel_hi:[1,0]
    v_rcp_f32 v160, v160
    v_rcp_f32 v161, v161
    v_rcp_f32 v162, v162
    v_rcp_f32 v163, v163
    v_rcp_f32 v164, v164
    v_rcp_f32 v165, v165
    v_rcp_f32 v166, v166
    v_rcp_f32 v167, v167
    v_rcp_f32 v168, v168
    v_rcp_f32 v169, v169
    v_rcp_f32 v170, v170
    v_rcp_f32 v171, v171
    v_rcp_f32 v172, v172
    v_rcp_f32 v173, v173
    v_rcp_f32 v174, v174
    v_rcp_f32 v175, v175
    s_nop 0
    v_pk_mul_f32 v[24:25], v[24:25], v[160:161]
    v_pk_mul_f32 v[26:27], v[26:27], v[162:163]
    v_pk_mul_f32 v[52:53], v[52:53], v[164:165]
    v_pk_mul_f32 v[54:55], v[54:55], v[166:167]
    v_pk_mul_f32 v[28:29], v[28:29], v[168:169]
    v_pk_mul_f32 v[30:31], v[30:31], v[170:171]
    v_pk_mul_f32 v[56:57], v[56:57], v[172:173]
    v_pk_mul_f32 v[58:59], v[58:59], v[174:175]
    v_cvt_pk_bf16_f32 v24, v24, v25
    v_cvt_pk_bf16_f32 v25, v26, v27
    v_cvt_pk_bf16_f32 v26, v28, v29
    v_cvt_pk_bf16_f32 v27, v30, v31
    v_cvt_pk_bf16_f32 v52, v52, v53
    v_cvt_pk_bf16_f32 v53, v54, v55
    v_cvt_pk_bf16_f32 v54, v56, v57
    v_cvt_pk_bf16_f32 v55, v58, v59
    s_nop 1
    v_permlane16_swap_b32 v24, v26
    v_permlane16_swap_b32 v25, v27
    v_permlane16_swap_b32 v52, v54
    v_permlane16_swap_b32 v53, v55
    s_cmp_eq_u32 s35, 15
    s_cselect_b32 s46, 0xffff, -1
    s_mov_b32 exec_lo, s46
    s_mov_b32 exec_hi, s46
    buffer_store_dwordx4 v[24:27], v254, s[12:15], s52 offen offset:1024 sc1
    buffer_store_dwordx4 v[52:55], v254, s[12:15], s53 offen offset:1024 sc1
    s_mov_b64 exec, -1
k2_kernel_gs31:
    v_pk_mul_f32 v[160:161], v[88:89], v[224:225] op_sel_hi:[1,0]
    v_pk_mul_f32 v[162:163], v[90:91], v[224:225] op_sel_hi:[1,0]
    v_pk_mul_f32 v[164:165], v[88:89], v[226:227] op_sel_hi:[1,0]
    v_pk_mul_f32 v[166:167], v[90:91], v[226:227] op_sel_hi:[1,0]
    v_pk_mul_f32 v[168:169], v[92:93], v[224:225] op_sel_hi:[1,0]
    v_pk_mul_f32 v[170:171], v[94:95], v[224:225] op_sel_hi:[1,0]
    v_pk_mul_f32 v[172:173], v[92:93], v[226:227] op_sel_hi:[1,0]
    v_pk_mul_f32 v[174:175], v[94:95], v[226:227] op_sel_hi:[1,0]
    v_pk_fma_f32 v[32:33], v[32:33], v[224:225], v[160:161] op_sel:[0,1,0] op_sel_hi:[1,1,1]
    v_pk_fma_f32 v[34:35], v[34:35], v[224:225], v[162:163] op_sel:[0,1,0] op_sel_hi:[1,1,1]
    v_pk_fma_f32 v[60:61], v[60:61], v[226:227], v[164:165] op_sel:[0,1,0] op_sel_hi:[1,1,1]
    v_pk_fma_f32 v[62:63], v[62:63], v[226:227], v[166:167] op_sel:[0,1,0] op_sel_hi:[1,1,1]
    v_pk_fma_f32 v[36:37], v[36:37], v[224:225], v[168:169] op_sel:[0,1,0] op_sel_hi:[1,1,1]
    v_pk_fma_f32 v[38:39], v[38:39], v[224:225], v[170:171] op_sel:[0,1,0] op_sel_hi:[1,1,1]
    v_pk_fma_f32 v[64:65], v[64:65], v[226:227], v[172:173] op_sel:[0,1,0] op_sel_hi:[1,1,1]
    v_pk_fma_f32 v[66:67], v[66:67], v[226:227], v[174:175] op_sel:[0,1,0] op_sel_hi:[1,1,1]
    v_pk_mul_f32 v[160:161], v[32:33], v[32:33]
    v_pk_mul_f32 v[162:163], v[34:35], v[34:35]
    v_pk_mul_f32 v[164:165], v[60:61], v[60:61]
    v_pk_mul_f32 v[166:167], v[62:63], v[62:63]
    v_pk_mul_f32 v[168:169], v[36:37], v[36:37]
    v_pk_mul_f32 v[170:171], v[38:39], v[38:39]
    v_pk_mul_f32 v[172:173], v[64:65], v[64:65]
    v_pk_mul_f32 v[174:175], v[66:67], v[66:67]
    v_pk_fma_f32 v[160:161], v[160:161], v[12:13], v[12:13] op_sel:[0,0,1] op_sel_hi:[1,0,1]
    v_pk_fma_f32 v[162:163], v[162:163], v[12:13], v[12:13] op_sel:[0,0,1] op_sel_hi:[1,0,1]
    v_pk_fma_f32 v[164:165], v[164:165], v[12:13], v[12:13] op_sel:[0,0,1] op_sel_hi:[1,0,1]
    v_pk_fma_f32 v[166:167], v[166:167], v[12:13], v[12:13] op_sel:[0,0,1] op_sel_hi:[1,0,1]
    v_pk_fma_f32 v[168:169], v[168:169], v[12:13], v[12:13] op_sel:[0,0,1] op_sel_hi:[1,0,1]
    v_pk_fma_f32 v[170:171], v[170:171], v[12:13], v[12:13] op_sel:[0,0,1] op_sel_hi:[1,0,1]
    v_pk_fma_f32 v[172:173], v[172:173], v[12:13], v[12:13] op_sel:[0,0,1] op_sel_hi:[1,0,1]
    v_pk_fma_f32 v[174:175], v[174:175], v[12:13], v[12:13] op_sel:[0,0,1] op_sel_hi:[1,0,1]
    v_pk_mul_f32 v[160:161], v[160:161], v[32:33]
    v_pk_mul_f32 v[162:163], v[162:163], v[34:35]
    v_pk_mul_f32 v[164:165], v[164:165], v[60:61]
    v_pk_mul_f32 v[166:167], v[166:167], v[62:63]
    v_pk_mul_f32 v[168:169], v[168:169], v[36:37]
    v_pk_mul_f32 v[170:171], v[170:171], v[38:39]
    v_pk_mul_f32 v[172:173], v[172:173], v[64:65]
    v_pk_mul_f32 v[174:175], v[174:175], v[66:67]
    v_exp_f32 v160, v160
    v_exp_f32 v161, v161
    v_exp_f32 v162, v162
    v_exp_f32 v163, v163
    v_exp_f32 v164, v164
    v_exp_f32 v165, v165
    v_exp_f32 v166, v166
    v_exp_f32 v167, v167
    v_exp_f32 v168, v168
    v_exp_f32 v169, v169
    v_exp_f32 v170, v170
    v_exp_f32 v171, v171
    v_exp_f32 v172, v172
    v_exp_f32 v173, v173
    v_exp_f32 v174, v174
    v_exp_f32 v175, v175
    v_pk_add_f32 v[160:161], v[160:161], 1.0 op_sel_hi:[1,0]
    v_pk_add_f32 v[162:163], v[162:163], 1.0 op_sel_hi:[1,0]
    v_pk_add_f32 v[164:165], v[164:165], 1.0 op_sel_hi:[1,0]
    v_pk_add_f32 v[166:167], v[166:167], 1.0 op_sel_hi:[1,0]
    v_pk_add_f32 v[168:169], v[168:169], 1.0 op_sel_hi:[1,0]
    v_pk_add_f32 v[170:171], v[170:171], 1.0 op_sel_hi:[1,0]
    v_pk_add_f32 v[172:173], v[172:173], 1.0 op_sel_hi:[1,0]
    v_pk_add_f32 v[174:175], v[174:175], 1.0 op_sel_hi:[1,0]
    v_rcp_f32 v160, v160
    v_rcp_f32 v161, v161
    v_rcp_f32 v162, v162
    v_rcp_f32 v163, v163
    v_rcp_f32 v164, v164
    v_rcp_f32 v165, v165
    v_rcp_f32 v166, v166
    v_rcp_f32 v167, v167
    v_rcp_f32 v168, v168
    v_rcp_f32 v169, v169
    v_rcp_f32 v170, v170
    v_rcp_f32 v171, v171
    v_rcp_f32 v172, v172
    v_rcp_f32 v173, v173
    v_rcp_f32 v174, v174
    v_rcp_f32 v175, v175
    s_nop 0
    v_pk_mul_f32 v[32:33], v[32:33], v[160:161]
    v_pk_mul_f32 v[34:35], v[34:35], v[162:163]
    v_pk_mul_f32 v[60:61], v[60:61], v[164:165]
    v_pk_mul_f32 v[62:63], v[62:63], v[166:167]
    v_pk_mul_f32 v[36:37], v[36:37], v[168:169]
    v_pk_mul_f32 v[38:39], v[38:39], v[170:171]
    v_pk_mul_f32 v[64:65], v[64:65], v[172:173]
    v_pk_mul_f32 v[66:67], v[66:67], v[174:175]
    v_cvt_pk_bf16_f32 v32, v32, v33
    v_cvt_pk_bf16_f32 v33, v34, v35
    v_cvt_pk_bf16_f32 v34, v36, v37
    v_cvt_pk_bf16_f32 v35, v38, v39
    v_cvt_pk_bf16_f32 v60, v60, v61
    v_cvt_pk_bf16_f32 v61, v62, v63
    v_cvt_pk_bf16_f32 v62, v64, v65
    v_cvt_pk_bf16_f32 v63, v66, v67
    s_nop 1
    v_permlane16_swap_b32 v32, v34
    v_permlane16_swap_b32 v33, v35
    v_permlane16_swap_b32 v60, v62
    v_permlane16_swap_b32 v61, v63
    s_cmp_eq_u32 s35, 15
    s_cbranch_scc1 k2_kernel_gs32
    buffer_store_dwordx4 v[32:35], v254, s[12:15], s52 offen offset:2048 sc1
    buffer_store_dwordx4 v[60:63], v254, s[12:15], s53 offen offset:2048 sc1
k2_kernel_gs32:
    v_pk_mul_f32 v[160:161], v[96:97], v[224:225] op_sel_hi:[1,0]
    v_pk_mul_f32 v[162:163], v[98:99], v[224:225] op_sel_hi:[1,0]
    v_pk_mul_f32 v[164:165], v[96:97], v[226:227] op_sel_hi:[1,0]
    v_pk_mul_f32 v[166:167], v[98:99], v[226:227] op_sel_hi:[1,0]
    v_pk_fma_f32 v[40:41], v[40:41], v[224:225], v[160:161] op_sel:[0,1,0] op_sel_hi:[1,1,1]
    v_pk_fma_f32 v[42:43], v[42:43], v[224:225], v[162:163] op_sel:[0,1,0] op_sel_hi:[1,1,1]
    v_pk_fma_f32 v[68:69], v[68:69], v[226:227], v[164:165] op_sel:[0,1,0] op_sel_hi:[1,1,1]
    v_pk_fma_f32 v[70:71], v[70:71], v[226:227], v[166:167] op_sel:[0,1,0] op_sel_hi:[1,1,1]
    v_pk_mul_f32 v[160:161], v[40:41], v[40:41]
    v_pk_mul_f32 v[162:163], v[42:43], v[42:43]
    v_pk_mul_f32 v[164:165], v[68:69], v[68:69]
    v_pk_mul_f32 v[166:167], v[70:71], v[70:71]
    v_pk_fma_f32 v[160:161], v[160:161], v[12:13], v[12:13] op_sel:[0,0,1] op_sel_hi:[1,0,1]
    v_pk_fma_f32 v[162:163], v[162:163], v[12:13], v[12:13] op_sel:[0,0,1] op_sel_hi:[1,0,1]
    v_pk_fma_f32 v[164:165], v[164:165], v[12:13], v[12:13] op_sel:[0,0,1] op_sel_hi:[1,0,1]
    v_pk_fma_f32 v[166:167], v[166:167], v[12:13], v[12:13] op_sel:[0,0,1] op_sel_hi:[1,0,1]
    v_pk_mul_f32 v[160:161], v[160:161], v[40:41]
    v_pk_mul_f32 v[162:163], v[162:163], v[42:43]
    v_pk_mul_f32 v[164:165], v[164:165], v[68:69]
    v_pk_mul_f32 v[166:167], v[166:167], v[70:71]
    v_exp_f32 v160, v160
    v_exp_f32 v161, v161
    v_exp_f32 v162, v162
    v_exp_f32 v163, v163
    v_exp_f32 v164, v164
    v_exp_f32 v165, v165
    v_exp_f32 v166, v166
    v_exp_f32 v167, v167
    v_pk_add_f32 v[160:161], v[160:161], 1.0 op_sel_hi:[1,0]
    v_pk_add_f32 v[162:163], v[162:163], 1.0 op_sel_hi:[1,0]
    v_pk_add_f32 v[164:165], v[164:165], 1.0 op_sel_hi:[1,0]
    v_pk_add_f32 v[166:167], v[166:167], 1.0 op_sel_hi:[1,0]
    v_rcp_f32 v160, v160
    v_rcp_f32 v161, v161
    v_rcp_f32 v162, v162
    v_rcp_f32 v163, v163
    v_rcp_f32 v164, v164
    v_rcp_f32 v165, v165
    v_rcp_f32 v166, v166
    v_rcp_f32 v167, v167
    s_nop 0
    v_pk_mul_f32 v[40:41], v[40:41], v[160:161]
    v_pk_mul_f32 v[42:43], v[42:43], v[162:163]
    v_pk_mul_f32 v[68:69], v[68:69], v[164:165]
    v_pk_mul_f32 v[70:71], v[70:71], v[166:167]
    v_cvt_pk_bf16_f32 v40, v40, v41
    v_cvt_pk_bf16_f32 v41, v42, v43
    v_cvt_pk_bf16_f32 v68, v68, v69
    v_cvt_pk_bf16_f32 v69, v70, v71
    s_cmp_eq_u32 s35, 15
    s_cbranch_scc1 k2_kernel_gs33
    buffer_store_dwordx2 v[40:41], v8, s[12:15], s52 offen offset:3072 sc1
    buffer_store_dwordx2 v[68:69], v8, s[12:15], s53 offen offset:3072 sc1
k2_kernel_gs33:
    s_waitcnt vmcnt(0)
    v_mov_b32 v9, 1
    v_mov_b32 v10, 6400
    s_mov_b64 exec, 1
    s_cmp_eq_u32 s31, 0
    s_cbranch_scc1 k2_kernel_slow34
    buffer_store_dword v9, v10, s[12:15], s49 offen
    s_branch k2_kernel_sent35
k2_kernel_slow34:
    buffer_store_dword v9, v10, s[12:15], s49 offen sc1
k2_kernel_sent35:
    s_mov_b64 exec, -1
    buffer_load_dwordx4 v[192:195], v2, s[12:15], s40 offen offset:0
    buffer_load_dwordx4 v[196:199], v2, s[12:15], s40 offen offset:1024
    buffer_load_dwordx4 v[200:203], v2, s[12:15], s40 offen offset:2048
    buffer_load_dwordx4 v[204:207], v2, s[12:15], s40 offen offset:3072
    s_add_u32 s40, s40, 4096
    buffer_load_dwordx4 v[208:211], v2, s[12:15], s40 offen offset:0
    buffer_load_dwordx4 v[212:215], v2, s[12:15], s40 offen offset:1024
    s_and_b32 s41, s32, 1
    s_lshl_b32 s41, s41, 1
    s_lshl_b32 s49, s34, 2
    s_add_u32 s49, s49, s41
    s_lshl_b32 s49, s49, 7
    s_add_u32 s49, s49, s37
    s_lshl_b32 s41, s30, 4
    s_add_u32 s49, s49, s41
    s_add_u32 s49, s49, 6400
    v_bfe_u32 v7, v1, 2, 1
    v_lshlrev_b32 v7, 7, v7
    v_and_b32 v9, 3, v1
    v_lshl_add_u32 v7, v9, 2, v7
    s_add_u32 s41, s30, 0
    s_and_b32 s41, s41, 3
    s_lshl_b32 s46, s32, 2
    s_add_u32 s41, s41, s46
    s_mul_i32 s41, s41, 55296
    s_mul_i32 s46, s30, 14336
    s_add_u32 s41, s41, s46
    s_add_u32 s41, s41, s36
    s_add_u32 s50, s41, 696320
    s_add_u32 s41, s30, 1
    s_and_b32 s41, s41, 3
    s_lshl_b32 s46, s32, 2
    s_add_u32 s41, s41, s46
    s_mul_i32 s41, s41, 55296
    s_mul_i32 s46, s30, 14336
    s_add_u32 s41, s41, s46
    s_add_u32 s41, s41, s36
    s_add_u32 s51, s41, 696320
    s_add_u32 s41, s30, 2
    s_and_b32 s41, s41, 3
    s_lshl_b32 s46, s32, 2
    s_add_u32 s41, s41, s46
    s_mul_i32 s41, s41, 55296
    s_mul_i32 s46, s30, 14336
    s_add_u32 s41, s41, s46
    s_add_u32 s41, s41, s36
    s_add_u32 s52, s41, 696320
    s_add_u32 s41, s30, 3
    s_and_b32 s41, s41, 3
    s_lshl_b32 s46, s32, 2
    s_add_u32 s41, s41, s46
    s_mul_i32 s41, s41, 55296
    s_mul_i32 s46, s30, 14336
    s_add_u32 s41, s41, s46
    s_add_u32 s41, s41, s36
    s_add_u32 s53, s41, 696320
    s_mov_b32 s43, 200000
k2_kernel_poll36:
    buffer_load_dword v9, v7, s[12:15], s49 offen sc1
    s_waitcnt vmcnt(0)
    v_cmp_ne_u32 vcc, 0, v9
    s_sub_u32 s43, s43, 1
    s_cmp_eq_u64 vcc, -1
    s_cbranch_scc1 k2_kernel_go37
    s_cmp_lg_u32 s43, 0
    s_cbranch_scc1 k2_kernel_poll36
k2_kernel_go37:
    s_add_u32 s41, s50, 0
    buffer_load_dwordx4 v[96:99], v2, s[12:15], s41 offen offset:0 sc1
    s_add_u32 s41, s51, 0
    buffer_load_dwordx4 v[100:103], v2, s[12:15], s41 offen offset:0 sc1
    s_add_u32 s41, s52, 0
    buffer_load_dwordx4 v[104:107], v2, s[12:15], s41 offen offset:0 sc1
    s_add_u32 s41, s53, 0
    buffer_load_dwordx4 v[108:111], v2, s[12:15], s41 offen offset:0 sc1
    s_add_u32 s41, s50, 0
    buffer_load_dwordx4 v[112:115], v2, s[12:15], s41 offen offset:1024 sc1
    s_add_u32 s41, s51, 0
    buffer_load_dwordx4 v[116:119], v2, s[12:15], s41 offen offset:1024 sc1
    s_add_u32 s41, s52, 0
    buffer_load_dwordx4 v[120:123], v2, s[12:15], s41 offen offset:1024 sc1
    s_add_u32 s41, s53, 0
    buffer_load_dwordx4 v[124:127], v2, s[12:15], s41 offen offset:1024 sc1
    s_waitcnt vmcnt(4)
    v_mfma_f32_16x16x32_bf16 v[16:19], a[0:3], v[96:99], 0
    v_mfma_f32_16x16x32_bf16 v[36:39], a[0:3], v[100:103], 0
    v_mfma_f32_16x16x32_bf16 v[56:59], a[0:3], v[104:107], 0
    v_mfma_f32_16x16x32_bf16 v[76:79], a[0:3], v[108:111], 0
    s_add_u32 s41, s50, 0
    buffer_load_dwordx4 v[128:131], v2, s[12:15], s41 offen offset:2048 sc1
    v_mfma_f32_16x16x32_bf16 v[20:23], a[4:7], v[96:99], 0
    v_mfma_f32_16x16x32_bf16 v[40:43], a[4:7], v[100:103], 0
    v_mfma_f32_16x16x32_bf16 v[60:63], a[4:7], v[104:107], 0
    v_mfma_f32_16x16x32_bf16 v[80:83], a[4:7], v[108:111], 0
    s_add_u32 s41, s51, 0
    buffer_load_dwordx4 v[132:135], v2, s[12:15], s41 offen offset:2048 sc1
    s_add_u32 s41, s52, 0
    buffer_load_dwordx4 v[136:139], v2, s[12:15], s41 offen offset:2048 sc1
    v_mfma_f32_16x16x32_bf16 v[24:27], a[8:11], v[96:99], 0
    v_mfma_f32_16x16x32_bf16 v[44:47], a[8:11], v[100:103], 0
    v_mfma_f32_16x16x32_bf16 v[64:67], a[8:11], v[104:107], 0
    v_mfma_f32_16x16x32_bf16 v[84:87], a[8:11], v[108:111], 0
    s_add_u32 s41, s53, 0
    buffer_load_dwordx4 v[140:143], v2, s[12:15], s41 offen offset:2048 sc1
    v_mfma_f32_16x16x32_bf16 v[28:31], a[12:15], v[96:99], 0
    v_mfma_f32_16x16x32_bf16 v[48:51], a[12:15], v[100:103], 0
    v_mfma_f32_16x16x32_bf16 v[68:71], a[12:15], v[104:107], 0
    v_mfma_f32_16x16x32_bf16 v[88:91], a[12:15], v[108:111], 0
    s_add_u32 s41, s50, 0
    buffer_load_dwordx4 v[144:147], v2, s[12:15], s41 offen offset:3072 sc1
    s_add_u32 s41, s51, 0
    buffer_load_dwordx4 v[148:151], v2, s[12:15], s41 offen offset:3072 sc1
    v_mfma_f32_16x16x32_bf16 v[32:35], a[16:19], v[96:99], 0
    v_mfma_f32_16x16x32_bf16 v[52:55], a[16:19], v[100:103], 0
    v_mfma_f32_16x16x32_bf16 v[72:75], a[16:19], v[104:107], 0
    v_mfma_f32_16x16x32_bf16 v[92:95], a[16:19], v[108:111], 0
    s_add_u32 s41, s52, 0
    buffer_load_dwordx4 v[152:155], v2, s[12:15], s41 offen offset:3072 sc1
    s_waitcnt vmcnt(7)
    v_mfma_f32_16x16x32_bf16 v[16:19], a[20:23], v[112:115], v[16:19]
    v_mfma_f32_16x16x32_bf16 v[36:39], a[20:23], v[116:119], v[36:39]
    v_mfma_f32_16x16x32_bf16 v[56:59], a[20:23], v[120:123], v[56:59]
    v_mfma_f32_16x16x32_bf16 v[76:79], a[20:23], v[124:127], v[76:79]
    s_add_u32 s41, s53, 0
    buffer_load_dwordx4 v[156:159], v2, s[12:15], s41 offen offset:3072 sc1
    v_mfma_f32_16x16x32_bf16 v[20:23], a[24:27], v[112:115], v[20:23]
    v_mfma_f32_16x16x32_bf16 v[40:43], a[24:27], v[116:119], v[40:43]
    v_mfma_f32_16x16x32_bf16 v[60:63], a[24:27], v[120:123], v[60:63]
    v_mfma_f32_16x16x32_bf16 v[80:83], a[24:27], v[124:127], v[80:83]
    s_add_u32 s41, s50, 4096
    buffer_load_dwordx4 v[160:163], v2, s[12:15], s41 offen offset:0 sc1
    s_add_u32 s41, s51, 4096
    buffer_load_dwordx4 v[164:167], v2, s[12:15], s41 offen offset:0 sc1
    v_mfma_f32_16x16x32_bf16 v[24:27], a[28:31], v[112:115], v[24:27]
    v_mfma_f32_16x16x32_bf16 v[44:47], a[28:31], v[116:119], v[44:47]
    v_mfma_f32_16x16x32_bf16 v[64:67], a[28:31], v[120:123], v[64:67]
    v_mfma_f32_16x16x32_bf16 v[84:87], a[28:31], v[124:127], v[84:87]
    s_add_u32 s41, s52, 4096
    buffer_load_dwordx4 v[168:171], v2, s[12:15], s41 offen offset:0 sc1
    v_mfma_f32_16x16x32_bf16 v[28:31], a[32:35], v[112:115], v[28:31]
    v_mfma_f32_16x16x32_bf16 v[48:51], a[32:35], v[116:119], v[48:51]
    v_mfma_f32_16x16x32_bf16 v[68:71], a[32:35], v[120:123], v[68:71]
    v_mfma_f32_16x16x32_bf16 v[88:91], a[32:35], v[124:127], v[88:91]
    s_add_u32 s41, s53, 4096
    buffer_load_dwordx4 v[172:175], v2, s[12:15], s41 offen offset:0 sc1
    s_add_u32 s41, s50, 4096
    buffer_load_dwordx4 v[176:179], v2, s[12:15], s41 offen offset:1024 sc1
    v_mfma_f32_16x16x32_bf16 v[32:35], a[36:39], v[112:115], v[32:35]
    v_mfma_f32_16x16x32_bf16 v[52:55], a[36:39], v[116:119], v[52:55]
    v_mfma_f32_16x16x32_bf16 v[72:75], a[36:39], v[120:123], v[72:75]
    v_mfma_f32_16x16x32_bf16 v[92:95], a[36:39], v[124:127], v[92:95]
    s_add_u32 s41, s51, 4096
    buffer_load_dwordx4 v[180:183], v2, s[12:15], s41 offen offset:1024 sc1
    s_waitcnt vmcnt(10)
    v_mfma_f32_16x16x32_bf16 v[16:19], a[40:43], v[128:131], v[16:19]
    v_mfma_f32_16x16x32_bf16 v[36:39], a[40:43], v[132:135], v[36:39]
    v_mfma_f32_16x16x32_bf16 v[56:59], a[40:43], v[136:139], v[56:59]
    v_mfma_f32_16x16x32_bf16 v[76:79], a[40:43], v[140:143], v[76:79]
    s_add_u32 s41, s52, 4096
    buffer_load_dwordx4 v[184:187], v2, s[12:15], s41 offen offset:1024 sc1
    v_mfma_f32_16x16x32_bf16 v[20:23], a[44:47], v[128:131], v[20:23]
    v_mfma_f32_16x16x32_bf16 v[40:43], a[44:47], v[132:135], v[40:43]
    v_mfma_f32_16x16x32_bf16 v[60:63], a[44:47], v[136:139], v[60:63]
    v_mfma_f32_16x16x32_bf16 v[80:83], a[44:47], v[140:143], v[80:83]
    s_add_u32 s41, s53, 4096
    buffer_load_dwordx4 v[188:191], v2, s[12:15], s41 offen offset:1024 sc1
    s_add_u32 s41, s50, 4096
    buffer_load_dwordx4 v[96:99], v2, s[12:15], s41 offen offset:2048 sc1
    v_mfma_f32_16x16x32_bf16 v[24:27], a[48:51], v[128:131], v[24:27]
    v_mfma_f32_16x16x32_bf16 v[44:47], a[48:51], v[132:135], v[44:47]
    v_mfma_f32_16x16x32_bf16 v[64:67], a[48:51], v[136:139], v[64:67]
    v_mfma_f32_16x16x32_bf16 v[84:87], a[48:51], v[140:143], v[84:87]
    s_add_u32 s41, s51, 4096
    buffer_load_dwordx4 v[100:103], v2, s[12:15], s41 offen offset:2048 sc1
    v_mfma_f32_16x16x32_bf16 v[28:31], a[52:55], v[128:131], v[28:31]
    v_mfma_f32_16x16x32_bf16 v[48:51], a[52:55], v[132:135], v[48:51]
    v_mfma_f32_16x16x32_bf16 v[68:71], a[52:55], v[136:139], v[68:71]
    v_mfma_f32_16x16x32_bf16 v[88:91], a[52:55], v[140:143], v[88:91]
    s_add_u32 s41, s52, 4096
    buffer_load_dwordx4 v[104:107], v2, s[12:15], s41 offen offset:2048 sc1
    v_mfma_f32_16x16x32_bf16 v[32:35], a[56:59], v[128:131], v[32:35]
    v_mfma_f32_16x16x32_bf16 v[52:55], a[56:59], v[132:135], v[52:55]
    v_mfma_f32_16x16x32_bf16 v[72:75], a[56:59], v[136:139], v[72:75]
    v_mfma_f32_16x16x32_bf16 v[92:95], a[56:59], v[140:143], v[92:95]
    s_add_u32 s41, s53, 4096
    buffer_load_dwordx4 v[108:111], v2, s[12:15], s41 offen offset:2048 sc1
    s_waitcnt vmcnt(12)
    v_mfma_f32_16x16x32_bf16 v[16:19], a[60:63], v[144:147], v[16:19]
    v_mfma_f32_16x16x32_bf16 v[36:39], a[60:63], v[148:151], v[36:39]
    v_mfma_f32_16x16x32_bf16 v[56:59], a[60:63], v[152:155], v[56:59]
    v_mfma_f32_16x16x32_bf16 v[76:79], a[60:63], v[156:159], v[76:79]
    s_add_u32 s41, s50, 4096
    buffer_load_dwordx4 v[112:115], v2, s[12:15], s41 offen offset:3072 sc1
    v_mfma_f32_16x16x32_bf16 v[20:23], a[64:67], v[144:147], v[20:23]
    v_mfma_f32_16x16x32_bf16 v[40:43], a[64:67], v[148:151], v[40:43]
    v_mfma_f32_16x16x32_bf16 v[60:63], a[64:67], v[152:155], v[60:63]
    v_mfma_f32_16x16x32_bf16 v[80:83], a[64:67], v[156:159], v[80:83]
    s_add_u32 s41, s51, 4096
    buffer_load_dwordx4 v[116:119], v2, s[12:15], s41 offen offset:3072 sc1
    v_mfma_f32_16x16x32_bf16 v[24:27], a[68:71], v[144:147], v[24:27]
    v_mfma_f32_16x16x32_bf16 v[44:47], a[68:71], v[148:151], v[44:47]
    v_mfma_f32_16x16x32_bf16 v[64:67], a[68:71], v[152:155], v[64:67]
    v_mfma_f32_16x16x32_bf16 v[84:87], a[68:71], v[156:159], v[84:87]
    s_add_u32 s41, s52, 4096
    buffer_load_dwordx4 v[120:123], v2, s[12:15], s41 offen offset:3072 sc1
    v_mfma_f32_16x16x32_bf16 v[28:31], a[72:75], v[144:147], v[28:31]
    v_mfma_f32_16x16x32_bf16 v[48:51], a[72:75], v[148:151], v[48:51]
    v_mfma_f32_16x16x32_bf16 v[68:71], a[72:75], v[152:155], v[68:71]
    v_mfma_f32_16x16x32_bf16 v[88:91], a[72:75], v[156:159], v[88:91]
    s_add_u32 s41, s53, 4096
    buffer_load_dwordx4 v[124:127], v2, s[12:15], s41 offen offset:3072 sc1
    v_mfma_f32_16x16x32_bf16 v[32:35], a[76:79], v[144:147], v[32:35]
    v_mfma_f32_16x16x32_bf16 v[52:55], a[76:79], v[148:151], v[52:55]
    v_mfma_f32_16x16x32_bf16 v[72:75], a[76:79], v[152:155], v[72:75]
    v_mfma_f32_16x16x32_bf16 v[92:95], a[76:79], v[156:159], v[92:95]
    s_add_u32 s41, s50, 8192
    buffer_load_dwordx4 v[128:131], v2, s[12:15], s41 offen offset:0 sc1
    s_waitcnt vmcnt(13)
    v_mfma_f32_16x16x32_bf16 v[16:19], a[80:83], v[160:163], v[16:19]
    v_mfma_f32_16x16x32_bf16 v[36:39], a[80:83], v[164:167], v[36:39]
    v_mfma_f32_16x16x32_bf16 v[56:59], a[80:83], v[168:171], v[56:59]
    v_mfma_f32_16x16x32_bf16 v[76:79], a[80:83], v[172:175], v[76:79]
    s_add_u32 s41, s51, 8192
    buffer_load_dwordx4 v[132:135], v2, s[12:15], s41 offen offset:0 sc1
    v_mfma_f32_16x16x32_bf16 v[20:23], a[84:87], v[160:163], v[20:23]
    v_mfma_f32_16x16x32_bf16 v[40:43], a[84:87], v[164:167], v[40:43]
    v_mfma_f32_16x16x32_bf16 v[60:63], a[84:87], v[168:171], v[60:63]
    v_mfma_f32_16x16x32_bf16 v[80:83], a[84:87], v[172:175], v[80:83]
    s_add_u32 s41, s52, 8192
    buffer_load_dwordx4 v[136:139], v2, s[12:15], s41 offen offset:0 sc1
    v_mfma_f32_16x16x32_bf16 v[24:27], a[88:91], v[160:163], v[24:27]
    v_mfma_f32_16x16x32_bf16 v[44:47], a[88:91], v[164:167], v[44:47]
    v_mfma_f32_16x16x32_bf16 v[64:67], a[88:91], v[168:171], v[64:67]
    v_mfma_f32_16x16x32_bf16 v[84:87], a[88:91], v[172:175], v[84:87]
    s_add_u32 s41, s53, 8192
    buffer_load_dwordx4 v[140:143], v2, s[12:15], s41 offen offset:0 sc1
    v_mfma_f32_16x16x32_bf16 v[28:31], a[92:95], v[160:163], v[28:31]
    v_mfma_f32_16x16x32_bf16 v[48:51], a[92:95], v[164:167], v[48:51]
    v_mfma_f32_16x16x32_bf16 v[68:71], a[92:95], v[168:171], v[68:71]
    v_mfma_f32_16x16x32_bf16 v[88:91], a[92:95], v[172:175], v[88:91]
    s_add_u32 s41, s50, 8192
    buffer_load_dwordx4 v[144:147], v2, s[12:15], s41 offen offset:1024 sc1
    v_mfma_f32_16x16x32_bf16 v[32:35], a[96:99], v[160:163], v[32:35]
    v_mfma_f32_16x16x32_bf16 v[52:55], a[96:99], v[164:167], v[52:55]
    v_mfma_f32_16x16x32_bf16 v[72:75], a[96:99], v[168:171], v[72:75]
    v_mfma_f32_16x16x32_bf16 v[92:95], a[96:99], v[172:175], v[92:95]
    s_add_u32 s41, s51, 8192
    buffer_load_dwordx4 v[148:151], v2, s[12:15], s41 offen offset:1024 sc1
    s_waitcnt vmcnt(14)
    v_mfma_f32_16x16x32_bf16 v[16:19], a[100:103], v[176:179], v[16:19]
    v_mfma_f32_16x16x32_bf16 v[36:39], a[100:103], v[180:183], v[36:39]
    v_mfma_f32_16x16x32_bf16 v[56:59], a[100:103], v[184:187], v[56:59]
    v_mfma_f32_16x16x32_bf16 v[76:79], a[100:103], v[188:191], v[76:79]
    s_add_u32 s41, s52, 8192
    buffer_load_dwordx4 v[152:155], v2, s[12:15], s41 offen offset:1024 sc1
    v_mfma_f32_16x16x32_bf16 v[20:23], a[104:107], v[176:179], v[20:23]
    v_mfma_f32_16x16x32_bf16 v[40:43], a[104:107], v[180:183], v[40:43]
    v_mfma_f32_16x16x32_bf16 v[60:63], a[104:107], v[184:187], v[60:63]
    v_mfma_f32_16x16x32_bf16 v[80:83], a[104:107], v[188:191], v[80:83]
    s_add_u32 s41, s53, 8192
    buffer_load_dwordx4 v[156:159], v2, s[12:15], s41 offen offset:1024 sc1
    v_mfma_f32_16x16x32_bf16 v[24:27], a[108:111], v[176:179], v[24:27]
    v_mfma_f32_16x16x32_bf16 v[44:47], a[108:111], v[180:183], v[44:47]
    v_mfma_f32_16x16x32_bf16 v[64:67], a[108:111], v[184:187], v[64:67]
    v_mfma_f32_16x16x32_bf16 v[84:87], a[108:111], v[188:191], v[84:87]
    s_add_u32 s41, s50, 8192
    buffer_load_dwordx4 v[160:163], v2, s[12:15], s41 offen offset:2048 sc1
    v_mfma_f32_16x16x32_bf16 v[28:31], a[112:115], v[176:179], v[28:31]
    v_mfma_f32_16x16x32_bf16 v[48:51], a[112:115], v[180:183], v[48:51]
    v_mfma_f32_16x16x32_bf16 v[68:71], a[112:115], v[184:187], v[68:71]
    v_mfma_f32_16x16x32_bf16 v[88:91], a[112:115], v[188:191], v[88:91]
    s_add_u32 s41, s51, 8192
    buffer_load_dwordx4 v[164:167], v2, s[12:15], s41 offen offset:2048 sc1
    v_mfma_f32_16x16x32_bf16 v[32:35], a[116:119], v[176:179], v[32:35]
    v_mfma_f32_16x16x32_bf16 v[52:55], a[116:119], v[180:183], v[52:55]
    v_mfma_f32_16x16x32_bf16 v[72:75], a[116:119], v[184:187], v[72:75]
    v_mfma_f32_16x16x32_bf16 v[92:95], a[116:119], v[188:191], v[92:95]
    s_add_u32 s41, s52, 8192
    buffer_load_dwordx4 v[168:171], v2, s[12:15], s41 offen offset:2048 sc1
    s_waitcnt vmcnt(15)
    v_mfma_f32_16x16x32_bf16 v[16:19], a[120:123], v[96:99], v[16:19]
    v_mfma_f32_16x16x32_bf16 v[36:39], a[120:123], v[100:103], v[36:39]
    v_mfma_f32_16x16x32_bf16 v[56:59], a[120:123], v[104:107], v[56:59]
    v_mfma_f32_16x16x32_bf16 v[76:79], a[120:123], v[108:111], v[76:79]
    s_add_u32 s41, s53, 8192
    buffer_load_dwordx4 v[172:175], v2, s[12:15], s41 offen offset:2048 sc1
    v_mfma_f32_16x16x32_bf16 v[20:23], a[124:127], v[96:99], v[20:23]
    v_mfma_f32_16x16x32_bf16 v[40:43], a[124:127], v[100:103], v[40:43]
    v_mfma_f32_16x16x32_bf16 v[60:63], a[124:127], v[104:107], v[60:63]
    v_mfma_f32_16x16x32_bf16 v[80:83], a[124:127], v[108:111], v[80:83]
    s_add_u32 s41, s50, 8192
    buffer_load_dwordx4 v[176:179], v2, s[12:15], s41 offen offset:3072 sc1
    v_mfma_f32_16x16x32_bf16 v[24:27], a[128:131], v[96:99], v[24:27]
    v_mfma_f32_16x16x32_bf16 v[44:47], a[128:131], v[100:103], v[44:47]
    v_mfma_f32_16x16x32_bf16 v[64:67], a[128:131], v[104:107], v[64:67]
    v_mfma_f32_16x16x32_bf16 v[84:87], a[128:131], v[108:111], v[84:87]
    s_add_u32 s41, s51, 8192
    buffer_load_dwordx4 v[180:183], v2, s[12:15], s41 offen offset:3072 sc1
    v_mfma_f32_16x16x32_bf16 v[28:31], a[132:135], v[96:99], v[28:31]
    v_mfma_f32_16x16x32_bf16 v[48:51], a[132:135], v[100:103], v[48:51]
    v_mfma_f32_16x16x32_bf16 v[68:71], a[132:135], v[104:107], v[68:71]
    v_mfma_f32_16x16x32_bf16 v[88:91], a[132:135], v[108:111], v[88:91]
    s_add_u32 s41, s52, 8192
    buffer_load_dwordx4 v[184:187], v2, s[12:15], s41 offen offset:3072 sc1
    v_mfma_f32_16x16x32_bf16 v[32:35], a[136:139], v[96:99], v[32:35]
    v_mfma_f32_16x16x32_bf16 v[52:55], a[136:139], v[100:103], v[52:55]
    v_mfma_f32_16x16x32_bf16 v[72:75], a[136:139], v[104:107], v[72:75]
    v_mfma_f32_16x16x32_bf16 v[92:95], a[136:139], v[108:111], v[92:95]
    s_add_u32 s41, s53, 8192
    buffer_load_dwordx4 v[188:191], v2, s[12:15], s41 offen offset:3072 sc1
    s_waitcnt vmcnt(16)
    v_mfma_f32_16x16x32_bf16 v[16:19], a[140:143], v[112:115], v[16:19]
    v_mfma_f32_16x16x32_bf16 v[36:39], a[140:143], v[116:119], v[36:39]
    v_mfma_f32_16x16x32_bf16 v[56:59], a[140:143], v[120:123], v[56:59]
    v_mfma_f32_16x16x32_bf16 v[76:79], a[140:143], v[124:127], v[76:79]
    v_mfma_f32_16x16x32_bf16 v[20:23], a[144:147], v[112:115], v[20:23]
    v_mfma_f32_16x16x32_bf16 v[40:43], a[144:147], v[116:119], v[40:43]
    v_mfma_f32_16x16x32_bf16 v[60:63], a[144:147], v[120:123], v[60:63]
    v_mfma_f32_16x16x32_bf16 v[80:83], a[144:147], v[124:127], v[80:83]
    s_add_u32 s41, s50, 12288
    buffer_load_dwordx4 v[96:99], v2, s[12:15], s41 offen offset:0 sc1
    v_mfma_f32_16x16x32_bf16 v[24:27], a[148:151], v[112:115], v[24:27]
    v_mfma_f32_16x16x32_bf16 v[44:47], a[148:151], v[116:119], v[44:47]
    v_mfma_f32_16x16x32_bf16 v[64:67], a[148:151], v[120:123], v[64:67]
    v_mfma_f32_16x16x32_bf16 v[84:87], a[148:151], v[124:127], v[84:87]
    s_add_u32 s41, s51, 12288
    buffer_load_dwordx4 v[100:103], v2, s[12:15], s41 offen offset:0 sc1
    v_mfma_f32_16x16x32_bf16 v[28:31], a[152:155], v[112:115], v[28:31]
    v_mfma_f32_16x16x32_bf16 v[48:51], a[152:155], v[116:119], v[48:51]
    v_mfma_f32_16x16x32_bf16 v[68:71], a[152:155], v[120:123], v[68:71]
    v_mfma_f32_16x16x32_bf16 v[88:91], a[152:155], v[124:127], v[88:91]
    s_add_u32 s41, s52, 12288
    buffer_load_dwordx4 v[104:107], v2, s[12:15], s41 offen offset:0 sc1
    v_mfma_f32_16x16x32_bf16 v[32:35], a[156:159], v[112:115], v[32:35]
    v_mfma_f32_16x16x32_bf16 v[52:55], a[156:159], v[116:119], v[52:55]
    v_mfma_f32_16x16x32_bf16 v[72:75], a[156:159], v[120:123], v[72:75]
    v_mfma_f32_16x16x32_bf16 v[92:95], a[156:159], v[124:127], v[92:95]
    s_add_u32 s41, s53, 12288
    buffer_load_dwordx4 v[108:111], v2, s[12:15], s41 offen offset:0 sc1
    s_waitcnt vmcnt(16)
    v_mfma_f32_16x16x32_bf16 v[16:19], a[160:163], v[128:131], v[16:19]
    v_mfma_f32_16x16x32_bf16 v[36:39], a[160:163], v[132:135], v[36:39]
    v_mfma_f32_16x16x32_bf16 v[56:59], a[160:163], v[136:139], v[56:59]
    v_mfma_f32_16x16x32_bf16 v[76:79], a[160:163], v[140:143], v[76:79]
    v_mfma_f32_16x16x32_bf16 v[20:23], a[164:167], v[128:131], v[20:23]
    v_mfma_f32_16x16x32_bf16 v[40:43], a[164:167], v[132:135], v[40:43]
    v_mfma_f32_16x16x32_bf16 v[60:63], a[164:167], v[136:139], v[60:63]
    v_mfma_f32_16x16x32_bf16 v[80:83], a[164:167], v[140:143], v[80:83]
    s_add_u32 s41, s50, 12288
    buffer_load_dwordx4 v[112:115], v2, s[12:15], s41 offen offset:1024 sc1
    v_mfma_f32_16x16x32_bf16 v[24:27], a[168:171], v[128:131], v[24:27]
    v_mfma_f32_16x16x32_bf16 v[44:47], a[168:171], v[132:135], v[44:47]
    v_mfma_f32_16x16x32_bf16 v[64:67], a[168:171], v[136:139], v[64:67]
    v_mfma_f32_16x16x32_bf16 v[84:87], a[168:171], v[140:143], v[84:87]
    s_add_u32 s41, s51, 12288
    buffer_load_dwordx4 v[116:119], v2, s[12:15], s41 offen offset:1024 sc1
    v_mfma_f32_16x16x32_bf16 v[28:31], a[172:175], v[128:131], v[28:31]
    v_mfma_f32_16x16x32_bf16 v[48:51], a[172:175], v[132:135], v[48:51]
    v_mfma_f32_16x16x32_bf16 v[68:71], a[172:175], v[136:139], v[68:71]
    v_mfma_f32_16x16x32_bf16 v[88:91], a[172:175], v[140:143], v[88:91]
    s_add_u32 s41, s52, 12288
    buffer_load_dwordx4 v[120:123], v2, s[12:15], s41 offen offset:1024 sc1
    v_mfma_f32_16x16x32_bf16 v[32:35], a[176:179], v[128:131], v[32:35]
    v_mfma_f32_16x16x32_bf16 v[52:55], a[176:179], v[132:135], v[52:55]
    v_mfma_f32_16x16x32_bf16 v[72:75], a[176:179], v[136:139], v[72:75]
    v_mfma_f32_16x16x32_bf16 v[92:95], a[176:179], v[140:143], v[92:95]
    s_add_u32 s41, s53, 12288
    buffer_load_dwordx4 v[124:127], v2, s[12:15], s41 offen offset:1024 sc1
    s_waitcnt vmcnt(16)
    v_mfma_f32_16x16x32_bf16 v[16:19], a[180:183], v[144:147], v[16:19]
    v_mfma_f32_16x16x32_bf16 v[36:39], a[180:183], v[148:151], v[36:39]
    v_mfma_f32_16x16x32_bf16 v[56:59], a[180:183], v[152:155], v[56:59]
    v_mfma_f32_16x16x32_bf16 v[76:79], a[180:183], v[156:159], v[76:79]
    v_mfma_f32_16x16x32_bf16 v[20:23], a[184:187], v[144:147], v[20:23]
    v_mfma_f32_16x16x32_bf16 v[40:43], a[184:187], v[148:151], v[40:43]
    v_mfma_f32_16x16x32_bf16 v[60:63], a[184:187], v[152:155], v[60:63]
    v_mfma_f32_16x16x32_bf16 v[80:83], a[184:187], v[156:159], v[80:83]
    v_mfma_f32_16x16x32_bf16 v[24:27], a[188:191], v[144:147], v[24:27]
    v_mfma_f32_16x16x32_bf16 v[44:47], a[188:191], v[148:151], v[44:47]
    v_mfma_f32_16x16x32_bf16 v[64:67], a[188:191], v[152:155], v[64:67]
    v_mfma_f32_16x16x32_bf16 v[84:87], a[188:191], v[156:159], v[84:87]
    v_mfma_f32_16x16x32_bf16 v[28:31], a[192:195], v[144:147], v[28:31]
    v_mfma_f32_16x16x32_bf16 v[48:51], a[192:195], v[148:151], v[48:51]
    v_mfma_f32_16x16x32_bf16 v[68:71], a[192:195], v[152:155], v[68:71]
    v_mfma_f32_16x16x32_bf16 v[88:91], a[192:195], v[156:159], v[88:91]
    v_mfma_f32_16x16x32_bf16 v[32:35], a[196:199], v[144:147], v[32:35]
    v_mfma_f32_16x16x32_bf16 v[52:55], a[196:199], v[148:151], v[52:55]
    v_mfma_f32_16x16x32_bf16 v[72:75], a[196:199], v[152:155], v[72:75]
    v_mfma_f32_16x16x32_bf16 v[92:95], a[196:199], v[156:159], v[92:95]
    s_waitcnt vmcnt(12)
    v_mfma_f32_16x16x32_bf16 v[16:19], a[200:203], v[160:163], v[16:19]
    v_mfma_f32_16x16x32_bf16 v[36:39], a[200:203], v[164:167], v[36:39]
    v_mfma_f32_16x16x32_bf16 v[56:59], a[200:203], v[168:171], v[56:59]
    v_mfma_f32_16x16x32_bf16 v[76:79], a[200:203], v[172:175], v[76:79]
    v_mfma_f32_16x16x32_bf16 v[20:23], a[204:207], v[160:163], v[20:23]
    v_mfma_f32_16x16x32_bf16 v[40:43], a[204:207], v[164:167], v[40:43]
    v_mfma_f32_16x16x32_bf16 v[60:63], a[204:207], v[168:171], v[60:63]
    v_mfma_f32_16x16x32_bf16 v[80:83], a[204:207], v[172:175], v[80:83]
    v_mfma_f32_16x16x32_bf16 v[24:27], a[208:211], v[160:163], v[24:27]
    v_mfma_f32_16x16x32_bf16 v[44:47], a[208:211], v[164:167], v[44:47]
    v_mfma_f32_16x16x32_bf16 v[64:67], a[208:211], v[168:171], v[64:67]
    v_mfma_f32_16x16x32_bf16 v[84:87], a[208:211], v[172:175], v[84:87]
    v_mfma_f32_16x16x32_bf16 v[28:31], a[212:215], v[160:163], v[28:31]
    v_mfma_f32_16x16x32_bf16 v[48:51], a[212:215], v[164:167], v[48:51]
    v_mfma_f32_16x16x32_bf16 v[68:71], a[212:215], v[168:171], v[68:71]
    v_mfma_f32_16x16x32_bf16 v[88:91], a[212:215], v[172:175], v[88:91]
    v_mfma_f32_16x16x32_bf16 v[32:35], a[216:219], v[160:163], v[32:35]
    v_mfma_f32_16x16x32_bf16 v[52:55], a[216:219], v[164:167], v[52:55]
    v_mfma_f32_16x16x32_bf16 v[72:75], a[216:219], v[168:171], v[72:75]
    v_mfma_f32_16x16x32_bf16 v[92:95], a[216:219], v[172:175], v[92:95]
    s_waitcnt vmcnt(8)
    v_mfma_f32_16x16x32_bf16 v[16:19], a[220:223], v[176:179], v[16:19]
    v_mfma_f32_16x16x32_bf16 v[36:39], a[220:223], v[180:183], v[36:39]
    v_mfma_f32_16x16x32_bf16 v[56:59], a[220:223], v[184:187], v[56:59]
    v_mfma_f32_16x16x32_bf16 v[76:79], a[220:223], v[188:191], v[76:79]
    v_mfma_f32_16x16x32_bf16 v[20:23], a[224:227], v[176:179], v[20:23]
    v_mfma_f32_16x16x32_bf16 v[40:43], a[224:227], v[180:183], v[40:43]
    v_mfma_f32_16x16x32_bf16 v[60:63], a[224:227], v[184:187], v[60:63]
    v_mfma_f32_16x16x32_bf16 v[80:83], a[224:227], v[188:191], v[80:83]
    v_mfma_f32_16x16x32_bf16 v[24:27], a[228:231], v[176:179], v[24:27]
    v_mfma_f32_16x16x32_bf16 v[44:47], a[228:231], v[180:183], v[44:47]
    v_mfma_f32_16x16x32_bf16 v[64:67], a[228:231], v[184:187], v[64:67]
    v_mfma_f32_16x16x32_bf16 v[84:87], a[228:231], v[188:191], v[84:87]
    v_mfma_f32_16x16x32_bf16 v[28:31], a[232:235], v[176:179], v[28:31]
    v_mfma_f32_16x16x32_bf16 v[48:51], a[232:235], v[180:183], v[48:51]
    v_mfma_f32_16x16x32_bf16 v[68:71], a[232:235], v[184:187], v[68:71]
    v_mfma_f32_16x16x32_bf16 v[88:91], a[232:235], v[188:191], v[88:91]
    v_mfma_f32_16x16x32_bf16 v[32:35], a[236:239], v[176:179], v[32:35]
    v_mfma_f32_16x16x32_bf16 v[52:55], a[236:239], v[180:183], v[52:55]
    v_mfma_f32_16x16x32_bf16 v[72:75], a[236:239], v[184:187], v[72:75]
    v_mfma_f32_16x16x32_bf16 v[92:95], a[236:239], v[188:191], v[92:95]
    s_cmp_eq_u32 s30, 3
    s_cbranch_scc1 k2_kernel_k4skip38
    s_waitcnt vmcnt(4)
    v_mfma_f32_16x16x32_bf16 v[16:19], a[240:243], v[96:99], v[16:19]
    v_mfma_f32_16x16x32_bf16 v[36:39], a[240:243], v[100:103], v[36:39]
    v_mfma_f32_16x16x32_bf16 v[56:59], a[240:243], v[104:107], v[56:59]
    v_mfma_f32_16x16x32_bf16 v[76:79], a[240:243], v[108:111], v[76:79]
    v_mfma_f32_16x16x32_bf16 v[20:23], a[244:247], v[96:99], v[20:23]
    v_mfma_f32_16x16x32_bf16 v[40:43], a[244:247], v[100:103], v[40:43]
    v_mfma_f32_16x16x32_bf16 v[60:63], a[244:247], v[104:107], v[60:63]
    v_mfma_f32_16x16x32_bf16 v[80:83], a[244:247], v[108:111], v[80:83]
    v_mfma_f32_16x16x32_bf16 v[24:27], a[248:251], v[96:99], v[24:27]
    v_mfma_f32_16x16x32_bf16 v[44:47], a[248:251], v[100:103], v[44:47]
    v_mfma_f32_16x16x32_bf16 v[64:67], a[248:251], v[104:107], v[64:67]
    v_mfma_f32_16x16x32_bf16 v[84:87], a[248:251], v[108:111], v[84:87]
    v_mfma_f32_16x16x32_bf16 v[28:31], a[252:255], v[96:99], v[28:31]
    v_mfma_f32_16x16x32_bf16 v[48:51], a[252:255], v[100:103], v[48:51]
    v_mfma_f32_16x16x32_bf16 v[68:71], a[252:255], v[104:107], v[68:71]
    v_mfma_f32_16x16x32_bf16 v[88:91], a[252:255], v[108:111], v[88:91]
    v_mfma_f32_16x16x32_bf16 v[32:35], v[192:195], v[96:99], v[32:35]
    v_mfma_f32_16x16x32_bf16 v[52:55], v[192:195], v[100:103], v[52:55]
    v_mfma_f32_16x16x32_bf16 v[72:75], v[192:195], v[104:107], v[72:75]
    v_mfma_f32_16x16x32_bf16 v[92:95], v[192:195], v[108:111], v[92:95]
    s_waitcnt vmcnt(0)
    v_mfma_f32_16x16x32_bf16 v[16:19], v[196:199], v[112:115], v[16:19]
    v_mfma_f32_16x16x32_bf16 v[36:39], v[196:199], v[116:119], v[36:39]
    v_mfma_f32_16x16x32_bf16 v[56:59], v[196:199], v[120:123], v[56:59]
    v_mfma_f32_16x16x32_bf16 v[76:79], v[196:199], v[124:127], v[76:79]
    v_mfma_f32_16x16x32_bf16 v[20:23], v[200:203], v[112:115], v[20:23]
    v_mfma_f32_16x16x32_bf16 v[40:43], v[200:203], v[116:119], v[40:43]
    v_mfma_f32_16x16x32_bf16 v[60:63], v[200:203], v[120:123], v[60:63]
    v_mfma_f32_16x16x32_bf16 v[80:83], v[200:203], v[124:127], v[80:83]
    v_mfma_f32_16x16x32_bf16 v[24:27], v[204:207], v[112:115], v[24:27]
    v_mfma_f32_16x16x32_bf16 v[44:47], v[204:207], v[116:119], v[44:47]
    v_mfma_f32_16x16x32_bf16 v[64:67], v[204:207], v[120:123], v[64:67]
    v_mfma_f32_16x16x32_bf16 v[84:87], v[204:207], v[124:127], v[84:87]
    v_mfma_f32_16x16x32_bf16 v[28:31], v[208:211], v[112:115], v[28:31]
    v_mfma_f32_16x16x32_bf16 v[48:51], v[208:211], v[116:119], v[48:51]
    v_mfma_f32_16x16x32_bf16 v[68:71], v[208:211], v[120:123], v[68:71]
    v_mfma_f32_16x16x32_bf16 v[88:91], v[208:211], v[124:127], v[88:91]
    v_mfma_f32_16x16x32_bf16 v[32:35], v[212:215], v[112:115], v[32:35]
    v_mfma_f32_16x16x32_bf16 v[52:55], v[212:215], v[116:119], v[52:55]
    v_mfma_f32_16x16x32_bf16 v[72:75], v[212:215], v[120:123], v[72:75]
    v_mfma_f32_16x16x32_bf16 v[92:95], v[212:215], v[124:127], v[92:95]
k2_kernel_k4skip38:
    s_waitcnt vmcnt(0)
    s_barrier
    s_add_u32 s41, s30, 1
    s_and_b32 s41, s41, 3
    s_mul_i32 s41, s41, 15360
    s_add_u32 s41, s41, 0
    v_add_u32 v9, s41, v2
    ds_write_b128 v9, v[36:39] offset:0
    ds_write_b128 v9, v[40:43] offset:1024
    ds_write_b128 v9, v[44:47] offset:2048
    ds_write_b128 v9, v[48:51] offset:3072
    ds_write_b128 v9, v[52:55] offset:4096
    s_add_u32 s41, s30, 2
    s_and_b32 s41, s41, 3
    s_mul_i32 s41, s41, 15360
    s_add_u32 s41, s41, 5120
    v_add_u32 v9, s41, v2
    ds_write_b128 v9, v[56:59] offset:0
    ds_write_b128 v9, v[60:63] offset:1024
    ds_write_b128 v9, v[64:67] offset:2048
    ds_write_b128 v9, v[68:71] offset:3072
    ds_write_b128 v9, v[72:75] offset:4096
    s_add_u32 s41, s30, 3
    s_and_b32 s41, s41, 3
    s_mul_i32 s41, s41, 15360
    s_add_u32 s41, s41, 10240
    v_add_u32 v9, s41, v2
    ds_write_b128 v9, v[76:79] offset:0
    ds_write_b128 v9, v[80:83] offset:1024
    ds_write_b128 v9, v[84:87] offset:2048
    ds_write_b128 v9, v[88:91] offset:3072
    ds_write_b128 v9, v[92:95] offset:4096
    v_lshlrev_b32 v10, 4, v3
    v_add_u32 v10, 157696, v10
    ds_read_b128 v[96:99], v10 offset:0
    ds_read_b128 v[100:103], v10 offset:64
    ds_read_b128 v[104:107], v10 offset:128
    ds_read_b128 v[108:111], v10 offset:192
    ds_read_b128 v[112:115], v10 offset:256
    s_mul_i32 s41, s30, 15360
    v_add_u32 v9, s41, v2
    s_waitcnt lgkmcnt(0)
    s_barrier
    ds_read_b128 v[116:119], v9 offset:0
    ds_read_b128 v[120:123], v9 offset:1024
    ds_read_b128 v[124:127], v9 offset:2048
    ds_read_b128 v[128:131], v9 offset:3072
    ds_read_b128 v[132:135], v9 offset:4096
    ds_read_b128 v[136:139], v9 offset:5120
    ds_read_b128 v[140:143], v9 offset:6144
    ds_read_b128 v[144:147], v9 offset:7168
    ds_read_b128 v[148:151], v9 offset:8192
    ds_read_b128 v[152:155], v9 offset:9216
    ds_read_b128 v[156:159], v9 offset:10240
    ds_read_b128 v[160:163], v9 offset:11264
    ds_read_b128 v[164:167], v9 offset:12288
    ds_read_b128 v[168:171], v9 offset:13312
    ds_read_b128 v[172:175], v9 offset:14336
    s_lshl_b32 s46, s32, 2
    s_add_u32 s46, s46, s30
    s_lshl_b32 s46, s46, 4
    s_lshl_b32 s47, s28, 8
    s_add_u32 s46, s46, s47
    v_add_u32 v10, s46, v4
    v_mul_u32_u24 v10, 1280, v10
    v_lshl_add_u32 v10, v3, 3, v10
    s_mul_i32 s47, s33, 160
    s_nop 1
    v_permlane16_swap_b32 v228, v230
    v_permlane16_swap_b32 v229, v231
    v_permlane16_swap_b32 v232, v234
    v_permlane16_swap_b32 v233, v235
    v_permlane16_swap_b32 v238, v240
    v_permlane16_swap_b32 v239, v241
    v_permlane16_swap_b32 v242, v244
    v_permlane16_swap_b32 v243, v245
    s_waitcnt lgkmcnt(0)
    v_pk_add_f32 v[16:17], v[16:17], v[116:117]
    v_pk_add_f32 v[18:19], v[18:19], v[118:119]
    v_pk_add_f32 v[20:21], v[20:21], v[120:121]
    v_pk_add_f32 v[22:23], v[22:23], v[122:123]
    v_pk_add_f32 v[24:25], v[24:25], v[124:125]
    v_pk_add_f32 v[26:27], v[26:27], v[126:127]
    v_pk_add_f32 v[28:29], v[28:29], v[128:129]
    v_pk_add_f32 v[30:31], v[30:31], v[130:131]
    v_pk_add_f32 v[32:33], v[32:33], v[132:133]
    v_pk_add_f32 v[34:35], v[34:35], v[134:135]
    v_pk_add_f32 v[16:17], v[16:17], v[136:137]
    v_pk_add_f32 v[18:19], v[18:19], v[138:139]
    v_pk_add_f32 v[20:21], v[20:21], v[140:141]
    v_pk_add_f32 v[22:23], v[22:23], v[142:143]
    v_pk_add_f32 v[24:25], v[24:25], v[144:145]
    v_pk_add_f32 v[26:27], v[26:27], v[146:147]
    v_pk_add_f32 v[28:29], v[28:29], v[148:149]
    v_pk_add_f32 v[30:31], v[30:31], v[150:151]
    v_pk_add_f32 v[32:33], v[32:33], v[152:153]
    v_pk_add_f32 v[34:35], v[34:35], v[154:155]
    v_pk_add_f32 v[16:17], v[16:17], v[156:157]
    v_pk_add_f32 v[18:19], v[18:19], v[158:159]
    v_pk_add_f32 v[20:21], v[20:21], v[160:161]
    v_pk_add_f32 v[22:23], v[22:23], v[162:163]
    v_pk_add_f32 v[24:25], v[24:25], v[164:165]
    v_pk_add_f32 v[26:27], v[26:27], v[166:167]
    v_pk_add_f32 v[28:29], v[28:29], v[168:169]
    v_pk_add_f32 v[30:31], v[30:31], v[170:171]
    v_pk_add_f32 v[32:33], v[32:33], v[172:173]
    v_pk_add_f32 v[34:35], v[34:35], v[174:175]
    v_lshlrev_b32 v116, 16, v238
    v_and_b32 v117, 0xffff0000, v238
    v_lshlrev_b32 v118, 16, v239
    v_and_b32 v119, 0xffff0000, v239
    v_lshlrev_b32 v136, 16, v228
    v_and_b32 v137, 0xffff0000, v228
    v_lshlrev_b32 v138, 16, v229
    v_and_b32 v139, 0xffff0000, v229
    v_lshlrev_b32 v120, 16, v240
    v_and_b32 v121, 0xffff0000, v240
    v_lshlrev_b32 v122, 16, v241
    v_and_b32 v123, 0xffff0000, v241
    v_lshlrev_b32 v140, 16, v230
    v_and_b32 v141, 0xffff0000, v230
    v_lshlrev_b32 v142, 16, v231
    v_and_b32 v143, 0xffff0000, v231
    v_lshlrev_b32 v124, 16, v242
    v_and_b32 v125, 0xffff0000, v242
    v_lshlrev_b32 v126, 16, v243
    v_and_b32 v127, 0xffff0000, v243
    v_lshlrev_b32 v144, 16, v232
    v_and_b32 v145, 0xffff0000, v232
    v_lshlrev_b32 v146, 16, v233
    v_and_b32 v147, 0xffff0000, v233
    v_lshlrev_b32 v128, 16, v244
    v_and_b32 v129, 0xffff0000, v244
    v_lshlrev_b32 v130, 16, v245
    v_and_b32 v131, 0xffff0000, v245
    v_lshlrev_b32 v148, 16, v234
    v_and_b32 v149, 0xffff0000, v234
    v_lshlrev_b32 v150, 16, v235
    v_and_b32 v151, 0xffff0000, v235
    v_lshlrev_b32 v132, 16, v246
    v_and_b32 v133, 0xffff0000, v246
    v_lshlrev_b32 v134, 16, v247
    v_and_b32 v135, 0xffff0000, v247
    v_lshlrev_b32 v152, 16, v236
    v_and_b32 v153, 0xffff0000, v236
    v_lshlrev_b32 v154, 16, v237
    v_and_b32 v155, 0xffff0000, v237
    v_pk_add_f32 v[16:17], v[16:17], v[116:117]
    v_pk_add_f32 v[18:19], v[18:19], v[118:119]
    v_pk_add_f32 v[20:21], v[20:21], v[120:121]
    v_pk_add_f32 v[22:23], v[22:23], v[122:123]
    v_pk_add_f32 v[24:25], v[24:25], v[124:125]
    v_pk_add_f32 v[26:27], v[26:27], v[126:127]
    v_pk_add_f32 v[28:29], v[28:29], v[128:129]
    v_pk_add_f32 v[30:31], v[30:31], v[130:131]
    v_pk_add_f32 v[32:33], v[32:33], v[132:133]
    v_pk_add_f32 v[34:35], v[34:35], v[134:135]
    v_pk_fma_f32 v[16:17], v[16:17], v[96:97], v[136:137]
    v_pk_fma_f32 v[18:19], v[18:19], v[98:99], v[138:139]
    v_pk_fma_f32 v[20:21], v[20:21], v[100:101], v[140:141]
    v_pk_fma_f32 v[22:23], v[22:23], v[102:103], v[142:143]
    v_pk_fma_f32 v[24:25], v[24:25], v[104:105], v[144:145]
    v_pk_fma_f32 v[26:27], v[26:27], v[106:107], v[146:147]
    v_pk_fma_f32 v[28:29], v[28:29], v[108:109], v[148:149]
    v_pk_fma_f32 v[30:31], v[30:31], v[110:111], v[150:151]
    v_pk_fma_f32 v[32:33], v[32:33], v[112:113], v[152:153]
    v_pk_fma_f32 v[34:35], v[34:35], v[114:115], v[154:155]
    v_cvt_pk_bf16_f32 v16, v16, v17
    v_cvt_pk_bf16_f32 v17, v18, v19
    v_cvt_pk_bf16_f32 v18, v20, v21
    v_cvt_pk_bf16_f32 v19, v22, v23
    v_cvt_pk_bf16_f32 v24, v24, v25
    v_cvt_pk_bf16_f32 v25, v26, v27
    v_cvt_pk_bf16_f32 v26, v28, v29
    v_cvt_pk_bf16_f32 v27, v30, v31
    v_cvt_pk_bf16_f32 v32, v32, v33
    v_cvt_pk_bf16_f32 v33, v34, v35
    s_nop 1
    v_permlane16_swap_b32 v16, v18
    v_permlane16_swap_b32 v17, v19
    v_permlane16_swap_b32 v24, v26
    v_permlane16_swap_b32 v25, v27
    v_and_b32 v9, 1, v3
    v_lshlrev_b32 v9, 5, v9
    v_lshrrev_b32 v11, 1, v3
    v_lshl_add_u32 v9, v11, 4, v9
    v_lshlrev_b32 v11, 3, v3
    v_sub_u32 v11, v10, v11
    v_add_u32 v11, v11, v9
    buffer_store_dwordx4 v[16:19], v11, s[24:27], s47 offen offset:0
    buffer_store_dwordx4 v[24:27], v11, s[24:27], s47 offen offset:64
    buffer_store_dwordx2 v[32:33], v10, s[24:27], s47 offen offset:128
    s_waitcnt vmcnt(0) lgkmcnt(0)
    s_endpgm
k2_end:
    s_endpgm
CODE_END:
    s_endpgm
.section .rodata,"a"
.p2align 6
.amdhsa_kernel k1_kernel
  .amdhsa_next_free_vgpr 256
  .amdhsa_next_free_sgpr 72
  .amdhsa_accum_offset 256
  .amdhsa_group_segment_fixed_size 0
  .amdhsa_kernarg_size 128
  .amdhsa_user_sgpr_count 2
  .amdhsa_user_sgpr_kernarg_segment_ptr 1
  .amdhsa_system_sgpr_workgroup_id_x 1
  .amdhsa_float_denorm_mode_32 3
.end_amdhsa_kernel
.p2align 6
.amdhsa_kernel k2_kernel
  .amdhsa_next_free_vgpr 512
  .amdhsa_next_free_sgpr 102
  .amdhsa_accum_offset 256
  .amdhsa_group_segment_fixed_size 0
  .amdhsa_kernarg_size 128
  .amdhsa_user_sgpr_count 2
  .amdhsa_user_sgpr_kernarg_segment_ptr 1
  .amdhsa_system_sgpr_workgroup_id_x 1
  .amdhsa_float_denorm_mode_32 3
.end_amdhsa_kernel
```

```asm
; @launch kernel=k1_kernel grid=(352,1,1) block=(256,1,1) lds=48128
; @launch kernel=k2_kernel grid=(256,1,1) block=(256,1,1) lds=163840
.amdgcn_target "amdgcn-amd-amdhsa--gfx950"
.text
.globl k1_kernel
.p2align 8
.type k1_kernel,@function
k1_kernel:
    s_cmp_ge_u32 s2, 352
    s_cbranch_scc1 k1_end
    s_load_dwordx4 s[4:7], s[0:1], 32
    s_load_dwordx2 s[10:11], s[0:1], 120
    s_load_dwordx4 s[12:15], s[0:1], 8
    s_load_dwordx2 s[8:9], s[0:1], 24
    v_lshrrev_b32 v2, 6, v0
    v_and_b32 v1, 63, v0
    v_readfirstlane_b32 s20, v2
    s_sub_u32 s54, s2, 160
    s_cmp_ge_u32 s2, 256
    s_cbranch_scc1 k1_side
    s_and_b32 s55, s2, 7
    s_lshr_b32 s56, s2, 3
    s_lshl_b32 s57, s55, 9
    s_add_u32 s57, s57, 9056256
    v_mov_b32 v250, 0
    s_waitcnt lgkmcnt(0)
    s_mov_b32 s28, s10
    s_mov_b32 s29, s11
    s_mov_b32 s30, 268435456
    s_mov_b32 s31, 0x00020000
    s_mov_b32 s16, s12
    s_mov_b32 s17, s13
    s_mov_b32 s18, 2621440
    s_mov_b32 s19, 0x00020000
    s_mov_b32 s40, s14
    s_mov_b32 s41, s15
    s_mov_b32 s42, 2621440
    s_mov_b32 s43, 0x00020000
    s_mov_b32 s44, s8
    s_mov_b32 s45, s9
    s_mov_b32 s46, 5120
    s_mov_b32 s47, 0x00020000
    v_mul_u32_u24 v4, 3277, v0
    v_lshrrev_b32 v4, 16, v4
    v_mul_u32_u24 v5, 20, v4
    v_sub_u32 v5, v0, v5
    s_lshl_b32 s21, s56, 6
    v_lshl_add_u32 v6, v4, 3, s21
    v_mul_u32_u24 v6, 1280, v6
    s_mul_i32 s22, s55, 160
    v_lshl_add_u32 v7, v5, 3, s22
    v_add_u32 v6, v6, v7
    v_subrev_u32 v8, 3840, v6
    v_add_u32 v9, 5120, v6
    s_movk_i32 s23, 160
    v_cmp_gt_u32 vcc, s23, v0
    s_and_saveexec_b64 s[60:61], vcc
    s_cbranch_execz k1_kvld
    buffer_load_dwordx2 v[10:11], v8, s[16:19], 0 offen offset:0
    buffer_load_dwordx2 v[12:13], v8, s[16:19], 0 offen offset:1280
    buffer_load_dwordx2 v[14:15], v8, s[16:19], 0 offen offset:2560
    buffer_load_dwordx2 v[16:17], v6, s[16:19], 0 offen offset:0
    buffer_load_dwordx2 v[18:19], v6, s[16:19], 0 offen offset:1280
    buffer_load_dwordx2 v[20:21], v6, s[16:19], 0 offen offset:2560
    buffer_load_dwordx2 v[22:23], v6, s[16:19], 0 offen offset:3840
    buffer_load_dwordx2 v[24:25], v9, s[16:19], 0 offen offset:0
    buffer_load_dwordx2 v[26:27], v9, s[16:19], 0 offen offset:1280
    buffer_load_dwordx2 v[28:29], v9, s[16:19], 0 offen offset:2560
    buffer_load_dwordx2 v[30:31], v9, s[16:19], 0 offen offset:3840
    v_lshlrev_b32 v150, 2, v7
    buffer_load_dwordx4 v[48:51], v150, s[44:47], 0 offen
    buffer_load_dwordx4 v[52:55], v150, s[44:47], 0 offen offset:16
    buffer_load_dwordx2 v[32:33], v6, s[40:43], 0 offen offset:0
    buffer_load_dwordx2 v[34:35], v6, s[40:43], 0 offen offset:1280
    buffer_load_dwordx2 v[36:37], v6, s[40:43], 0 offen offset:2560
    buffer_load_dwordx2 v[38:39], v6, s[40:43], 0 offen offset:3840
    buffer_load_dwordx2 v[40:41], v9, s[40:43], 0 offen offset:0
    buffer_load_dwordx2 v[42:43], v9, s[40:43], 0 offen offset:1280
    buffer_load_dwordx2 v[44:45], v9, s[40:43], 0 offen offset:2560
    buffer_load_dwordx2 v[46:47], v9, s[40:43], 0 offen offset:3840
k1_kvld:
    s_mov_b64 exec, -1
    buffer_load_dword v251, v250, s[28:31], s57 offen sc1
    v_and_b32 v249, 31, v1
    v_lshlrev_b32 v249, 2, v249
    buffer_load_dword v249, v249, s[28:31], s57 offen offset:256 sc1
    s_mov_b32 s24, s4
    s_mov_b32 s25, s5
    s_mov_b32 s26, 2621440
    s_mov_b32 s27, 0x00020000
    s_cmp_lt_u32 s56, 12
    s_cbranch_scc1 k1_kernel_nc1
    s_mul_i32 s58, s55, 20
    s_add_u32 s58, s58, s56
    s_sub_u32 s58, s58, 12
    s_lshl_b32 s21, s58, 3
    s_add_u32 s22, s6, s21
    s_addc_u32 s23, s7, 0
    s_load_dwordx2 s[32:33], s[22:23], 0
    s_lshl_b32 s21, s58, 2
    s_add_u32 s21, s21, s20
    s_mul_i32 s34, s20, 9472
    v_lshlrev_b32 v3, 4, v1
    s_lshl_b32 s35, s21, 12
    s_add_u32 s36, s34, 256
    s_mov_b32 m0, s36
    s_nop 0
    buffer_load_dwordx4 v3, s[24:27], s35 offen offset:0 lds
    buffer_load_dwordx4 v3, s[24:27], s35 offen offset:1024 lds
    buffer_load_dwordx4 v3, s[24:27], s35 offen offset:2048 lds
    buffer_load_dwordx4 v3, s[24:27], s35 offen offset:3072 lds
k1_kernel_nc1:
    s_mov_b64 exec, s[60:61]
    s_movk_i32 s23, 160
    v_cmp_gt_u32 vcc, s23, v0
    s_and_b64 exec, exec, vcc
    s_cbranch_execz k1_kvskip
    v_sub_u32 v150, 7, v4
    v_and_b32 v151, 7, v5
    v_xor_b32 v150, v150, v151
    v_lshlrev_b32 v150, 4, v150
    v_lshl_add_u32 v150, v5, 9, v150
    v_add_u32 v150, 37888, v150
    s_cmp_lt_u32 s56, 12
    s_cbranch_scc1 k1_w8
    s_waitcnt vmcnt(14)
    s_branch k1_w9
k1_w8:
    s_waitcnt vmcnt(10)
k1_w9:
    v_lshlrev_b32 v56, 16, v48
    v_and_b32 v60, 0xffff0000, v48
    v_lshlrev_b32 v64, 16, v49
    v_and_b32 v68, 0xffff0000, v49
    v_lshlrev_b32 v57, 16, v50
    v_and_b32 v61, 0xffff0000, v50
    v_lshlrev_b32 v65, 16, v51
    v_and_b32 v69, 0xffff0000, v51
    v_lshlrev_b32 v58, 16, v52
    v_and_b32 v62, 0xffff0000, v52
    v_lshlrev_b32 v66, 16, v53
    v_and_b32 v70, 0xffff0000, v53
    v_lshlrev_b32 v59, 16, v54
    v_and_b32 v63, 0xffff0000, v54
    v_lshlrev_b32 v67, 16, v55
    v_and_b32 v71, 0xffff0000, v55
    v_lshlrev_b32 v72, 16, v10
    v_and_b32 v73, 0xffff0000, v10
    v_lshlrev_b32 v74, 16, v11
    v_and_b32 v75, 0xffff0000, v11
    v_lshlrev_b32 v76, 16, v12
    v_and_b32 v77, 0xffff0000, v12
    v_lshlrev_b32 v78, 16, v13
    v_and_b32 v79, 0xffff0000, v13
    v_lshlrev_b32 v80, 16, v14
    v_and_b32 v81, 0xffff0000, v14
    v_lshlrev_b32 v82, 16, v15
    v_and_b32 v83, 0xffff0000, v15
    v_lshlrev_b32 v84, 16, v16
    v_and_b32 v85, 0xffff0000, v16
    v_lshlrev_b32 v86, 16, v17
    v_and_b32 v87, 0xffff0000, v17
    v_lshlrev_b32 v88, 16, v18
    v_and_b32 v89, 0xffff0000, v18
    v_lshlrev_b32 v90, 16, v19
    v_and_b32 v91, 0xffff0000, v19
    v_lshlrev_b32 v92, 16, v20
    v_and_b32 v93, 0xffff0000, v20
    v_lshlrev_b32 v94, 16, v21
    v_and_b32 v95, 0xffff0000, v21
    v_lshlrev_b32 v96, 16, v22
    v_and_b32 v97, 0xffff0000, v22
    v_lshlrev_b32 v98, 16, v23
    v_and_b32 v99, 0xffff0000, v23
    v_lshlrev_b32 v100, 16, v24
    v_and_b32 v101, 0xffff0000, v24
    v_lshlrev_b32 v102, 16, v25
    v_and_b32 v103, 0xffff0000, v25
    v_lshlrev_b32 v104, 16, v26
    v_and_b32 v105, 0xffff0000, v26
    v_lshlrev_b32 v106, 16, v27
    v_and_b32 v107, 0xffff0000, v27
    v_lshlrev_b32 v108, 16, v28
    v_and_b32 v109, 0xffff0000, v28
    v_lshlrev_b32 v110, 16, v29
    v_and_b32 v111, 0xffff0000, v29
    v_lshlrev_b32 v112, 16, v30
    v_and_b32 v113, 0xffff0000, v30
    v_lshlrev_b32 v114, 16, v31
    v_and_b32 v115, 0xffff0000, v31
    v_pk_mul_f32 v[116:117], v[72:73], v[68:69]
    v_pk_mul_f32 v[120:121], v[76:77], v[68:69]
    v_pk_mul_f32 v[124:125], v[80:81], v[68:69]
    v_pk_mul_f32 v[128:129], v[84:85], v[68:69]
    v_pk_mul_f32 v[132:133], v[88:89], v[68:69]
    v_pk_mul_f32 v[136:137], v[92:93], v[68:69]
    v_pk_mul_f32 v[140:141], v[96:97], v[68:69]
    v_pk_mul_f32 v[144:145], v[100:101], v[68:69]
    v_pk_fma_f32 v[116:117], v[76:77], v[64:65], v[116:117]
    v_pk_fma_f32 v[120:121], v[80:81], v[64:65], v[120:121]
    v_pk_fma_f32 v[124:125], v[84:85], v[64:65], v[124:125]
    v_pk_fma_f32 v[128:129], v[88:89], v[64:65], v[128:129]
    v_pk_fma_f32 v[132:133], v[92:93], v[64:65], v[132:133]
    v_pk_fma_f32 v[136:137], v[96:97], v[64:65], v[136:137]
    v_pk_fma_f32 v[140:141], v[100:101], v[64:65], v[140:141]
    v_pk_fma_f32 v[144:145], v[104:105], v[64:65], v[144:145]
    v_pk_fma_f32 v[116:117], v[80:81], v[60:61], v[116:117]
    v_pk_fma_f32 v[120:121], v[84:85], v[60:61], v[120:121]
    v_pk_fma_f32 v[124:125], v[88:89], v[60:61], v[124:125]
    v_pk_fma_f32 v[128:129], v[92:93], v[60:61], v[128:129]
    v_pk_fma_f32 v[132:133], v[96:97], v[60:61], v[132:133]
    v_pk_fma_f32 v[136:137], v[100:101], v[60:61], v[136:137]
    v_pk_fma_f32 v[140:141], v[104:105], v[60:61], v[140:141]
    v_pk_fma_f32 v[144:145], v[108:109], v[60:61], v[144:145]
    v_pk_fma_f32 v[116:117], v[84:85], v[56:57], v[116:117]
    v_pk_fma_f32 v[120:121], v[88:89], v[56:57], v[120:121]
    v_pk_fma_f32 v[124:125], v[92:93], v[56:57], v[124:125]
    v_pk_fma_f32 v[128:129], v[96:97], v[56:57], v[128:129]
    v_pk_fma_f32 v[132:133], v[100:101], v[56:57], v[132:133]
    v_pk_fma_f32 v[136:137], v[104:105], v[56:57], v[136:137]
    v_pk_fma_f32 v[140:141], v[108:109], v[56:57], v[140:141]
    v_pk_fma_f32 v[144:145], v[112:113], v[56:57], v[144:145]
    v_pk_mul_f32 v[118:119], v[74:75], v[70:71]
    v_pk_mul_f32 v[122:123], v[78:79], v[70:71]
    v_pk_mul_f32 v[126:127], v[82:83], v[70:71]
    v_pk_mul_f32 v[130:131], v[86:87], v[70:71]
    v_pk_mul_f32 v[134:135], v[90:91], v[70:71]
    v_pk_mul_f32 v[138:139], v[94:95], v[70:71]
    v_pk_mul_f32 v[142:143], v[98:99], v[70:71]
    v_pk_mul_f32 v[146:147], v[102:103], v[70:71]
    v_pk_fma_f32 v[118:119], v[78:79], v[66:67], v[118:119]
    v_pk_fma_f32 v[122:123], v[82:83], v[66:67], v[122:123]
    v_pk_fma_f32 v[126:127], v[86:87], v[66:67], v[126:127]
    v_pk_fma_f32 v[130:131], v[90:91], v[66:67], v[130:131]
    v_pk_fma_f32 v[134:135], v[94:95], v[66:67], v[134:135]
    v_pk_fma_f32 v[138:139], v[98:99], v[66:67], v[138:139]
    v_pk_fma_f32 v[142:143], v[102:103], v[66:67], v[142:143]
    v_pk_fma_f32 v[146:147], v[106:107], v[66:67], v[146:147]
    v_pk_fma_f32 v[118:119], v[82:83], v[62:63], v[118:119]
    v_pk_fma_f32 v[122:123], v[86:87], v[62:63], v[122:123]
    v_pk_fma_f32 v[126:127], v[90:91], v[62:63], v[126:127]
    v_pk_fma_f32 v[130:131], v[94:95], v[62:63], v[130:131]
    v_pk_fma_f32 v[134:135], v[98:99], v[62:63], v[134:135]
    v_pk_fma_f32 v[138:139], v[102:103], v[62:63], v[138:139]
    v_pk_fma_f32 v[142:143], v[106:107], v[62:63], v[142:143]
    v_pk_fma_f32 v[146:147], v[110:111], v[62:63], v[146:147]
    v_pk_fma_f32 v[118:119], v[86:87], v[58:59], v[118:119]
    v_pk_fma_f32 v[122:123], v[90:91], v[58:59], v[122:123]
    v_pk_fma_f32 v[126:127], v[94:95], v[58:59], v[126:127]
    v_pk_fma_f32 v[130:131], v[98:99], v[58:59], v[130:131]
    v_pk_fma_f32 v[134:135], v[102:103], v[58:59], v[134:135]
    v_pk_fma_f32 v[138:139], v[106:107], v[58:59], v[138:139]
    v_pk_fma_f32 v[142:143], v[110:111], v[58:59], v[142:143]
    v_pk_fma_f32 v[146:147], v[114:115], v[58:59], v[146:147]
    v_cvt_pk_bf16_f32 v154, v116, v117
    v_lshlrev_b32 v116, 16, v154
    v_and_b32 v117, 0xffff0000, v154
    v_cvt_pk_bf16_f32 v155, v118, v119
    v_lshlrev_b32 v118, 16, v155
    v_and_b32 v119, 0xffff0000, v155
    v_cvt_pk_bf16_f32 v156, v120, v121
    v_lshlrev_b32 v120, 16, v156
    v_and_b32 v121, 0xffff0000, v156
    v_cvt_pk_bf16_f32 v157, v122, v123
    v_lshlrev_b32 v122, 16, v157
    v_and_b32 v123, 0xffff0000, v157
    v_cvt_pk_bf16_f32 v158, v124, v125
    v_lshlrev_b32 v124, 16, v158
    v_and_b32 v125, 0xffff0000, v158
    v_cvt_pk_bf16_f32 v159, v126, v127
    v_lshlrev_b32 v126, 16, v159
    v_and_b32 v127, 0xffff0000, v159
    v_cvt_pk_bf16_f32 v160, v128, v129
    v_lshlrev_b32 v128, 16, v160
    v_and_b32 v129, 0xffff0000, v160
    v_cvt_pk_bf16_f32 v161, v130, v131
    v_lshlrev_b32 v130, 16, v161
    v_and_b32 v131, 0xffff0000, v161
    v_cvt_pk_bf16_f32 v154, v132, v133
    v_lshlrev_b32 v132, 16, v154
    v_and_b32 v133, 0xffff0000, v154
    v_cvt_pk_bf16_f32 v155, v134, v135
    v_lshlrev_b32 v134, 16, v155
    v_and_b32 v135, 0xffff0000, v155
    v_cvt_pk_bf16_f32 v156, v136, v137
    v_lshlrev_b32 v136, 16, v156
    v_and_b32 v137, 0xffff0000, v156
    v_cvt_pk_bf16_f32 v157, v138, v139
    v_lshlrev_b32 v138, 16, v157
    v_and_b32 v139, 0xffff0000, v157
    v_cvt_pk_bf16_f32 v158, v140, v141
    v_lshlrev_b32 v140, 16, v158
    v_and_b32 v141, 0xffff0000, v158
    v_cvt_pk_bf16_f32 v159, v142, v143
    v_lshlrev_b32 v142, 16, v159
    v_and_b32 v143, 0xffff0000, v159
    v_cvt_pk_bf16_f32 v160, v144, v145
    v_lshlrev_b32 v144, 16, v160
    v_and_b32 v145, 0xffff0000, v160
    v_cvt_pk_bf16_f32 v161, v146, v147
    v_lshlrev_b32 v146, 16, v161
    v_and_b32 v147, 0xffff0000, v161
    s_cmp_lt_u32 s56, 12
    s_cbranch_scc1 k1_w0
    s_waitcnt vmcnt(6)
    s_branch k1_w1
k1_w0:
    s_waitcnt vmcnt(2)
k1_w1:
    v_lshlrev_b32 v72, 16, v32
    v_and_b32 v73, 0xffff0000, v32
    v_lshlrev_b32 v74, 16, v33
    v_and_b32 v75, 0xffff0000, v33
    v_lshlrev_b32 v76, 16, v34
    v_and_b32 v77, 0xffff0000, v34
    v_lshlrev_b32 v78, 16, v35
    v_and_b32 v79, 0xffff0000, v35
    v_lshlrev_b32 v80, 16, v36
    v_and_b32 v81, 0xffff0000, v36
    v_lshlrev_b32 v82, 16, v37
    v_and_b32 v83, 0xffff0000, v37
    v_lshlrev_b32 v84, 16, v38
    v_and_b32 v85, 0xffff0000, v38
    v_lshlrev_b32 v86, 16, v39
    v_and_b32 v87, 0xffff0000, v39
    v_lshlrev_b32 v88, 16, v40
    v_and_b32 v89, 0xffff0000, v40
    v_lshlrev_b32 v90, 16, v41
    v_and_b32 v91, 0xffff0000, v41
    v_lshlrev_b32 v92, 16, v42
    v_and_b32 v93, 0xffff0000, v42
    v_lshlrev_b32 v94, 16, v43
    v_and_b32 v95, 0xffff0000, v43
    v_lshlrev_b32 v96, 16, v44
    v_and_b32 v97, 0xffff0000, v44
    v_lshlrev_b32 v98, 16, v45
    v_and_b32 v99, 0xffff0000, v45
    v_lshlrev_b32 v100, 16, v46
    v_and_b32 v101, 0xffff0000, v46
    v_lshlrev_b32 v102, 16, v47
    v_and_b32 v103, 0xffff0000, v47
    v_pk_mul_f32 v[116:117], v[116:117], v[72:73]
    v_pk_mul_f32 v[118:119], v[118:119], v[74:75]
    v_pk_mul_f32 v[120:121], v[120:121], v[76:77]
    v_pk_mul_f32 v[122:123], v[122:123], v[78:79]
    v_pk_mul_f32 v[124:125], v[124:125], v[80:81]
    v_pk_mul_f32 v[126:127], v[126:127], v[82:83]
    v_pk_mul_f32 v[128:129], v[128:129], v[84:85]
    v_pk_mul_f32 v[130:131], v[130:131], v[86:87]
    v_pk_mul_f32 v[132:133], v[132:133], v[88:89]
    v_pk_mul_f32 v[134:135], v[134:135], v[90:91]
    v_pk_mul_f32 v[136:137], v[136:137], v[92:93]
    v_pk_mul_f32 v[138:139], v[138:139], v[94:95]
    v_pk_mul_f32 v[140:141], v[140:141], v[96:97]
    v_pk_mul_f32 v[142:143], v[142:143], v[98:99]
    v_pk_mul_f32 v[144:145], v[144:145], v[100:101]
    v_pk_mul_f32 v[146:147], v[146:147], v[102:103]
    v_cvt_pk_bf16_f32 v10, v144, v140
    v_cvt_pk_bf16_f32 v11, v136, v132
    v_cvt_pk_bf16_f32 v12, v128, v124
    v_cvt_pk_bf16_f32 v13, v120, v116
    v_cvt_pk_bf16_f32 v14, v145, v141
    v_cvt_pk_bf16_f32 v15, v137, v133
    v_cvt_pk_bf16_f32 v16, v129, v125
    v_cvt_pk_bf16_f32 v17, v121, v117
    v_cvt_pk_bf16_f32 v18, v146, v142
    v_cvt_pk_bf16_f32 v19, v138, v134
    v_cvt_pk_bf16_f32 v20, v130, v126
    v_cvt_pk_bf16_f32 v21, v122, v118
    v_cvt_pk_bf16_f32 v22, v147, v143
    v_cvt_pk_bf16_f32 v23, v139, v135
    v_cvt_pk_bf16_f32 v24, v131, v127
    v_cvt_pk_bf16_f32 v25, v123, v119
    ds_write_b128 v150, v[10:13] offset:0
    ds_write_b128 v150, v[14:17] offset:128
    ds_write_b128 v150, v[18:21] offset:256
    ds_write_b128 v150, v[22:25] offset:384
k1_kvskip:
    s_mov_b64 exec, -1
    v_lshrrev_b32 v151, 3, v0
    v_and_b32 v152, 7, v0
    v_lshrrev_b32 v153, 2, v151
    v_and_b32 v153, 7, v153
    v_xor_b32 v153, v153, v152
    v_lshlrev_b32 v153, 4, v153
    v_lshl_add_u32 v153, v151, 7, v153
    v_add_u32 v153, 37888, v153
    v_mul_u32_u24 v151, 4224, v151
    v_lshl_add_u32 v154, v152, 4, v151
    s_mul_i32 s36, s55, 337920
    s_add_u32 s36, s36, 0
    s_lshl_b32 s37, s56, 7
    s_sub_u32 s38, 3968, s37
    s_add_u32 s38, s38, s36
    s_waitcnt lgkmcnt(0)
    s_barrier
    ds_read_b128 v[32:35], v153 offset:0
    ds_read_b128 v[36:39], v153 offset:4096
    ds_read_b128 v[40:43], v153 offset:8192
    s_waitcnt lgkmcnt(2)
    buffer_store_dwordx4 v[32:35], v154, s[28:31], s38 offen sc1
    s_add_u32 s38, s38, 135168
    s_waitcnt lgkmcnt(1)
    buffer_store_dwordx4 v[36:39], v154, s[28:31], s38 offen sc1
    s_add_u32 s38, s38, 135168
    s_movk_i32 s23, 128
    v_cmp_gt_u32 vcc, s23, v0
    s_and_saveexec_b64 s[60:61], vcc
    s_cbranch_execz k1_st2skip
    s_waitcnt lgkmcnt(0)
    buffer_store_dwordx4 v[40:43], v154, s[28:31], s38 offen sc1
    s_add_u32 s38, s38, 135168
k1_st2skip:
    s_mov_b64 exec, -1
    s_cmp_lg_u32 s56, 0
    s_cbranch_scc1 k1_kernel_L2
    v_mov_b32 v44, 0
    v_mov_b32 v45, 0
    v_mov_b32 v46, 0
    v_mov_b32 v47, 0
    s_add_u32 s36, s36, 4096
    buffer_store_dwordx4 v[44:47], v154, s[28:31], s36 offen sc1
    s_add_u32 s36, s36, 135168
    buffer_store_dwordx4 v[44:47], v154, s[28:31], s36 offen sc1
    s_add_u32 s36, s36, 135168
    s_movk_i32 s23, 128
    v_cmp_gt_u32 vcc, s23, v0
    s_and_b64 exec, exec, vcc
    s_cbranch_execz k1_kernel_L2
    buffer_store_dwordx4 v[44:47], v154, s[28:31], s36 offen sc1
    s_add_u32 s36, s36, 135168
k1_kernel_L2:
    s_mov_b64 exec, -1
    s_waitcnt vmcnt(0)
    v_add_u32 v251, 1, v251
    s_barrier
    s_cmp_lg_u32 s20, 0
    s_cbranch_scc1 k1_kernel_kf3
    s_lshl_b32 s23, s56, 2
    s_add_u32 s23, s23, s57
    s_mov_b64 exec, 1
    buffer_store_dword v251, v250, s[28:31], s23 offen offset:256
    buffer_store_dword v251, v250, s[28:31], s23 offen offset:128 sc1
    s_mov_b64 exec, -1
k1_kernel_kf3:
    s_lshl_b32 s54, s56, 3
    s_add_u32 s54, s54, s55
    s_cmp_lt_u32 s56, 12
    s_cbranch_scc1 k1_side2
    s_mov_b32 s2, s58
    s_setprio 3
    s_lshl_b32 s21, s2, 2
    s_add_u32 s21, s21, s20
    s_mul_i32 s34, s20, 9472
    v_lshlrev_b32 v3, 4, v1
    s_mul_i32 s37, s21, 4224
    s_add_u32 s37, s37, 0
    v_lshrrev_b32 v4, 3, v0
    v_mul_u32_u24 v4, 20480, v4
    s_lshr_b32 s38, s2, 1
    s_and_b32 s38, s38, 7
    v_and_b32 v5, 7, v0
    v_xor_b32 v5, s38, v5
    v_lshl_add_u32 v4, v5, 4, v4
    s_lshl_b32 s38, s2, 7
    v_add_u32 v20, 0, v1
    v_mul_u32_u24 v21, 3856, v20
    v_lshrrev_b32 v21, 16, v21
    v_mul_u32_u24 v22, 17, v21
    v_sub_u32 v22, v20, v22
    v_lshlrev_b32 v22, 4, v22
    v_lshlrev_b32 v21, 8, v21
    v_sub_u32 v22, v22, v21
    v_add_u32 v23, 3840, v22
    v_add_u32 v20, 64, v1
    v_mul_u32_u24 v21, 3856, v20
    v_lshrrev_b32 v21, 16, v21
    v_mul_u32_u24 v22, 17, v21
    v_sub_u32 v22, v20, v22
    v_lshlrev_b32 v22, 4, v22
    v_lshlrev_b32 v21, 8, v21
    v_sub_u32 v22, v22, v21
    v_add_u32 v24, 3840, v22
    v_add_u32 v20, 128, v1
    v_mul_u32_u24 v21, 3856, v20
    v_lshrrev_b32 v21, 16, v21
    v_mul_u32_u24 v22, 17, v21
    v_sub_u32 v22, v20, v22
    v_lshlrev_b32 v22, 4, v22
    v_lshlrev_b32 v21, 8, v21
    v_sub_u32 v22, v22, v21
    v_add_u32 v25, 3840, v22
    v_add_u32 v20, 192, v1
    v_mul_u32_u24 v21, 3856, v20
    v_lshrrev_b32 v21, 16, v21
    v_mul_u32_u24 v22, 17, v21
    v_sub_u32 v22, v20, v22
    v_lshlrev_b32 v22, 4, v22
    v_lshlrev_b32 v21, 8, v21
    v_sub_u32 v22, v22, v21
    v_add_u32 v26, 3840, v22
    v_add_u32 v20, 256, v1
    v_mul_u32_u24 v21, 3856, v20
    v_lshrrev_b32 v21, 16, v21
    v_mul_u32_u24 v22, 17, v21
    v_sub_u32 v22, v20, v22
    v_lshlrev_b32 v22, 4, v22
    v_lshlrev_b32 v21, 8, v21
    v_sub_u32 v22, v22, v21
    v_add_u32 v27, 3840, v22
    v_lshl_add_u32 v5, v1, 2, s34
    v_mov_b32 v6, 0
    ds_write_b32 v5, v6
    v_and_b32 v7, 15, v1
    v_bfe_u32 v8, v1, 4, 1
    v_lshrrev_b32 v9, 5, v1
    v_mul_u32_u24 v10, 272, v7
    v_lshl_add_u32 v10, v9, 4, v10
    v_add_u32 v10, s34, v10
    v_add_u32 v10, 4356, v10
    v_lshlrev_b32 v11, 2, v8
    v_sub_u32 v10, v10, v11
    v_and_b32 v12, 7, v1
    v_mul_u32_u24 v13, 272, v12
    v_lshl_add_u32 v13, v9, 4, v13
    v_add_u32 v13, s34, v13
    v_add_u32 v13, 4356, v13
    v_sub_u32 v13, v13, v11
    v_bfe_u32 v11, v1, 3, 1
    v_lshlrev_b32 v11, 4, v11
    v_sub_u32 v11, 16, v11
    v_and_b32 v14, 31, v1
    v_lshlrev_b32 v14, 3, v14
    v_lshl_add_u32 v14, v9, 4, v14
    v_add_u32 v14, s34, v14
    v_add_u32 v14, 8, v14
    v_cmp_ne_u32 vcc, 0, v12
    v_mov_b32 v16, 0
    s_nop 1
    v_cndmask_b32 v15, v16, -1, vcc
    s_waitcnt lgkmcnt(0)
    ds_read_b64 v[176:177], v14 offset:1792
    ds_read_b64 v[178:179], v14 offset:1800
    ds_read_b64 v[180:181], v14 offset:1824
    ds_read_b64 v[182:183], v14 offset:1832
    ds_read_b64 v[184:185], v14 offset:1856
    ds_read_b64 v[186:187], v14 offset:1864
    ds_read_b64 v[188:189], v14 offset:1888
    ds_read_b64 v[190:191], v14 offset:1896
    ds_read_b64 v[192:193], v14 offset:1920
    ds_read_b64 v[194:195], v14 offset:1928
    ds_read_b64 v[196:197], v14 offset:1952
    ds_read_b64 v[198:199], v14 offset:1960
    ds_read_b64 v[200:201], v14 offset:1984
    ds_read_b64 v[202:203], v14 offset:1992
    ds_read_b64 v[204:205], v14 offset:2016
    ds_read_b64 v[206:207], v14 offset:2024
    s_cmp_lg_u32 s20, 0
    s_cbranch_scc1 k1_kernel_kw4
    v_and_b32 v40, 31, v1
    v_lshlrev_b32 v40, 2, v40
    s_mov_b32 s23, 200000
    s_mov_b64 s[60:61], 0
k1_kernel_kp5:
    buffer_load_dword v41, v40, s[28:31], s57 offen offset:256 sc1
    s_waitcnt vmcnt(0)
    v_cmp_eq_u32 vcc, v251, v41
    s_sub_u32 s23, s23, 1
    s_or_b64 s[60:61], s[60:61], vcc
    s_cmp_eq_u64 s[60:61], -1
    s_cbranch_scc1 k1_kernel_kd6
    s_and_b32 s21, s23, 3
    s_cmp_lg_u32 s21, 0
    s_cbranch_scc1 k1_kernel_kq8
    buffer_load_dword v41, v40, s[28:31], s57 offen offset:128 sc1
    s_waitcnt vmcnt(0)
    v_cmp_eq_u32 vcc, v251, v41
    s_nop 1
    s_or_b64 s[60:61], s[60:61], vcc
    s_cmp_eq_u64 s[60:61], -1
    s_cbranch_scc1 k1_kernel_kd6
k1_kernel_kq8:
    s_sleep 2
    s_cmp_lg_u32 s23, 0
    s_cbranch_scc1 k1_kernel_kp5
k1_kernel_kd6:
    s_cmp_lg_u32 s56, 12
    s_cbranch_scc1 k1_kernel_kw4
    s_mov_b64 exec, 1
    buffer_store_dword v251, v250, s[28:31], s57 offen sc1
    s_mov_b64 exec, -1
k1_kernel_kw4:
    s_barrier
    s_add_u32 s36, s34, 4352
    s_mov_b32 m0, s36
    s_nop 0
    buffer_load_dwordx4 v23, s[28:31], s37 offen sc1 lds
    s_add_u32 s36, s34, 5376
    s_mov_b32 m0, s36
    s_nop 0
    buffer_load_dwordx4 v24, s[28:31], s37 offen sc1 lds
    s_add_u32 s36, s34, 6400
    s_mov_b32 m0, s36
    s_nop 0
    buffer_load_dwordx4 v25, s[28:31], s37 offen sc1 lds
    s_add_u32 s36, s34, 7424
    s_mov_b32 m0, s36
    s_nop 0
    buffer_load_dwordx4 v26, s[28:31], s37 offen sc1 lds
    s_add_u32 s36, s34, 8448
    s_mov_b32 m0, s36
    s_mov_b64 exec, 0xffff
    buffer_load_dwordx4 v27, s[28:31], s37 offen sc1 lds
    s_mov_b64 exec, -1
    s_waitcnt vmcnt(0) lgkmcnt(0)
    ds_read2_b32 v[64:65], v10 offset0:0 offset1:1
    ds_read2_b32 v[66:67], v10 offset0:2 offset1:3
    ds_read2_b32 v[68:69], v10 offset0:8 offset1:9
    ds_read2_b32 v[70:71], v10 offset0:10 offset1:11
    ds_read2_b32 v[72:73], v10 offset0:16 offset1:17
    ds_read2_b32 v[74:75], v10 offset0:18 offset1:19
    ds_read2_b32 v[76:77], v10 offset0:24 offset1:25
    ds_read2_b32 v[78:79], v10 offset0:26 offset1:27
    ds_read2_b32 v[80:81], v10 offset0:32 offset1:33
    ds_read2_b32 v[82:83], v10 offset0:34 offset1:35
    ds_read2_b32 v[84:85], v10 offset0:40 offset1:41
    ds_read2_b32 v[86:87], v10 offset0:42 offset1:43
    ds_read2_b32 v[88:89], v10 offset0:48 offset1:49
    ds_read2_b32 v[90:91], v10 offset0:50 offset1:51
    ds_read2_b32 v[92:93], v10 offset0:56 offset1:57
    ds_read2_b32 v[94:95], v10 offset0:58 offset1:59
    s_waitcnt lgkmcnt(0)
    v_mfma_f32_32x32x16_bf16 v[144:159], v[176:179], v[64:67], 0
    ds_read_b32 v16, v10 offset:16
    ds_read_b32 v17, v10 offset:48
    ds_read_b32 v18, v10 offset:80
    ds_read_b32 v19, v10 offset:112
    ds_read_b32 v20, v10 offset:144
    ds_read_b32 v21, v10 offset:176
    ds_read_b32 v22, v10 offset:208
    ds_read_b32 v23, v10 offset:240
    ds_read2_b32 v[96:97], v13 offset0:0 offset1:1
    ds_read2_b32 v[98:99], v13 offset0:2 offset1:3
    ds_read_b32 v24, v13 offset:16
    ds_read2_b32 v[100:101], v13 offset0:8 offset1:9
    ds_read2_b32 v[102:103], v13 offset0:10 offset1:11
    ds_read_b32 v25, v13 offset:48
    ds_read2_b32 v[104:105], v13 offset0:16 offset1:17
    ds_read2_b32 v[106:107], v13 offset0:18 offset1:19
    v_mfma_f32_32x32x16_bf16 v[144:159], v[180:183], v[68:71], v[144:159]
    ds_read_b32 v26, v13 offset:80
    ds_read2_b32 v[108:109], v13 offset0:24 offset1:25
    ds_read2_b32 v[110:111], v13 offset0:26 offset1:27
    ds_read_b32 v27, v13 offset:112
    ds_read2_b32 v[112:113], v13 offset0:32 offset1:33
    ds_read2_b32 v[114:115], v13 offset0:34 offset1:35
    ds_read_b32 v28, v13 offset:144
    ds_read2_b32 v[116:117], v13 offset0:40 offset1:41
    ds_read2_b32 v[118:119], v13 offset0:42 offset1:43
    ds_read_b32 v29, v13 offset:176
    ds_read2_b32 v[120:121], v13 offset0:48 offset1:49
    ds_read2_b32 v[122:123], v13 offset0:50 offset1:51
    ds_read_b32 v30, v13 offset:208
    ds_read2_b32 v[124:125], v13 offset0:56 offset1:57
    ds_read2_b32 v[126:127], v13 offset0:58 offset1:59
    ds_read_b32 v31, v13 offset:240
    v_mfma_f32_32x32x16_bf16 v[144:159], v[184:187], v[72:75], v[144:159]
    s_waitcnt lgkmcnt(15)
    s_waitcnt lgkmcnt(0)
    v_alignbit_b32 v32, v65, v64, 16
    v_alignbit_b32 v33, v66, v65, 16
    v_alignbit_b32 v34, v67, v66, 16
    v_alignbit_b32 v35, v16, v67, 16
    v_mfma_f32_32x32x16_bf16 v[144:159], v[188:191], v[76:79], v[144:159]
    v_alignbit_b32 v36, v69, v68, 16
    v_alignbit_b32 v37, v70, v69, 16
    v_alignbit_b32 v38, v71, v70, 16
    v_alignbit_b32 v39, v17, v71, 16
    v_alignbit_b32 v40, v73, v72, 16
    v_alignbit_b32 v41, v74, v73, 16
    v_mfma_f32_32x32x16_bf16 v[144:159], v[192:195], v[80:83], v[144:159]
    v_alignbit_b32 v42, v75, v74, 16
    v_alignbit_b32 v43, v18, v75, 16
    v_alignbit_b32 v44, v77, v76, 16
    v_alignbit_b32 v45, v78, v77, 16
    v_alignbit_b32 v46, v79, v78, 16
    v_alignbit_b32 v47, v19, v79, 16
    v_mfma_f32_32x32x16_bf16 v[144:159], v[196:199], v[84:87], v[144:159]
    v_alignbit_b32 v48, v81, v80, 16
    v_alignbit_b32 v49, v82, v81, 16
    v_alignbit_b32 v50, v83, v82, 16
    v_alignbit_b32 v51, v20, v83, 16
    v_alignbit_b32 v52, v85, v84, 16
    v_alignbit_b32 v53, v86, v85, 16
    v_mfma_f32_32x32x16_bf16 v[144:159], v[200:203], v[88:91], v[144:159]
    v_alignbit_b32 v54, v87, v86, 16
    v_alignbit_b32 v55, v21, v87, 16
    v_alignbit_b32 v56, v89, v88, 16
    v_alignbit_b32 v57, v90, v89, 16
    v_alignbit_b32 v58, v91, v90, 16
    v_alignbit_b32 v59, v22, v91, 16
    v_mfma_f32_32x32x16_bf16 v[144:159], v[204:207], v[92:95], v[144:159]
    v_alignbit_b32 v60, v93, v92, 16
    v_alignbit_b32 v61, v94, v93, 16
    v_alignbit_b32 v62, v95, v94, 16
    v_alignbit_b32 v63, v23, v95, 16
    s_nop 0
    v_mfma_f32_32x32x16_bf16 v[128:143], v[176:179], v[32:35], 0
    ds_read_b64 v[208:209], v14 offset:3840
    ds_read_b64 v[210:211], v14 offset:3848
    s_nop 2
    v_mfma_f32_32x32x16_bf16 v[128:143], v[180:183], v[36:39], v[128:143]
    ds_read_b64 v[212:213], v14 offset:3872
    ds_read_b64 v[214:215], v14 offset:3880
    s_nop 2
    v_mfma_f32_32x32x16_bf16 v[128:143], v[184:187], v[40:43], v[128:143]
    ds_read_b64 v[216:217], v14 offset:3904
    ds_read_b64 v[218:219], v14 offset:3912
    v_alignbit_b32 v96, v97, v96, v11
    v_alignbit_b32 v97, v98, v97, v11
    v_alignbit_b32 v98, v99, v98, v11
    v_alignbit_b32 v99, v24, v99, v11
    v_alignbit_b32 v100, v101, v100, v11
    v_alignbit_b32 v101, v102, v101, v11
    v_alignbit_b32 v102, v103, v102, v11
    v_alignbit_b32 v103, v25, v103, v11
    v_alignbit_b32 v104, v105, v104, v11
    v_mfma_f32_32x32x16_bf16 v[128:143], v[188:191], v[44:47], v[128:143]
    ds_read_b64 v[220:221], v14 offset:3936
    ds_read_b64 v[222:223], v14 offset:3944
    v_alignbit_b32 v105, v106, v105, v11
    v_alignbit_b32 v106, v107, v106, v11
    v_alignbit_b32 v107, v26, v107, v11
    v_alignbit_b32 v108, v109, v108, v11
    v_alignbit_b32 v109, v110, v109, v11
    v_alignbit_b32 v110, v111, v110, v11
    v_alignbit_b32 v111, v27, v111, v11
    v_mov_b32_dpp v144, v144 row_shr:1 row_mask:0xf bank_mask:0xf bound_ctrl:0
    v_mfma_f32_32x32x16_bf16 v[128:143], v[192:195], v[48:51], v[128:143]
    ds_read_b64 v[224:225], v14 offset:3968
    ds_read_b64 v[226:227], v14 offset:3976
    v_mov_b32_dpp v145, v145 row_shr:1 row_mask:0xf bank_mask:0xf bound_ctrl:0
    v_mov_b32_dpp v146, v146 row_shr:1 row_mask:0xf bank_mask:0xf bound_ctrl:0
    v_mov_b32_dpp v147, v147 row_shr:1 row_mask:0xf bank_mask:0xf bound_ctrl:0
    v_mov_b32_dpp v148, v148 row_shr:1 row_mask:0xf bank_mask:0xf bound_ctrl:0
    v_mov_b32_dpp v149, v149 row_shr:1 row_mask:0xf bank_mask:0xf bound_ctrl:0
    v_mov_b32_dpp v150, v150 row_shr:1 row_mask:0xf bank_mask:0xf bound_ctrl:0
    v_mov_b32_dpp v151, v151 row_shr:1 row_mask:0xf bank_mask:0xf bound_ctrl:0
    v_mov_b32_dpp v152, v152 row_shr:1 row_mask:0xf bank_mask:0xf bound_ctrl:0
    v_mfma_f32_32x32x16_bf16 v[128:143], v[196:199], v[52:55], v[128:143]
    ds_read_b64 v[228:229], v14 offset:4000
    ds_read_b64 v[230:231], v14 offset:4008
    v_mov_b32_dpp v153, v153 row_shr:1 row_mask:0xf bank_mask:0xf bound_ctrl:0
    v_mov_b32_dpp v154, v154 row_shr:1 row_mask:0xf bank_mask:0xf bound_ctrl:0
    v_mov_b32_dpp v155, v155 row_shr:1 row_mask:0xf bank_mask:0xf bound_ctrl:0
    v_mov_b32_dpp v156, v156 row_shr:1 row_mask:0xf bank_mask:0xf bound_ctrl:0
    v_mov_b32_dpp v157, v157 row_shr:1 row_mask:0xf bank_mask:0xf bound_ctrl:0
    v_mov_b32_dpp v158, v158 row_shr:1 row_mask:0xf bank_mask:0xf bound_ctrl:0
    v_mov_b32_dpp v159, v159 row_shr:1 row_mask:0xf bank_mask:0xf bound_ctrl:0
    v_alignbit_b32 v112, v113, v112, v11
    v_mfma_f32_32x32x16_bf16 v[128:143], v[200:203], v[56:59], v[128:143]
    ds_read_b64 v[232:233], v14 offset:4032
    ds_read_b64 v[234:235], v14 offset:4040
    v_alignbit_b32 v113, v114, v113, v11
    v_alignbit_b32 v114, v115, v114, v11
    v_alignbit_b32 v115, v28, v115, v11
    v_alignbit_b32 v116, v117, v116, v11
    v_alignbit_b32 v117, v118, v117, v11
    v_alignbit_b32 v118, v119, v118, v11
    v_alignbit_b32 v119, v29, v119, v11
    v_alignbit_b32 v120, v121, v120, v11
    v_mfma_f32_32x32x16_bf16 v[128:143], v[204:207], v[60:63], v[128:143]
    ds_read_b64 v[236:237], v14 offset:4064
    ds_read_b64 v[238:239], v14 offset:4072
    v_alignbit_b32 v121, v122, v121, v11
    v_alignbit_b32 v122, v123, v122, v11
    v_alignbit_b32 v123, v30, v123, v11
    v_alignbit_b32 v124, v125, v124, v11
    v_alignbit_b32 v125, v126, v125, v11
    v_alignbit_b32 v126, v127, v126, v11
    v_alignbit_b32 v127, v31, v127, v11
    s_nop 0
    s_waitcnt lgkmcnt(0)
    v_mfma_f32_32x32x16_bf16 v[160:175], v[208:211], v[96:99], 0
    ds_read_b64 v[176:177], v14 offset:1536
    ds_read_b64 v[178:179], v14 offset:1544
    ds_read_b64 v[180:181], v14 offset:1568
    ds_read_b64 v[182:183], v14 offset:1576
    s_nop 0
    v_mfma_f32_32x32x16_bf16 v[160:175], v[212:215], v[100:103], v[160:175]
    ds_read_b64 v[184:185], v14 offset:1600
    ds_read_b64 v[186:187], v14 offset:1608
    ds_read_b64 v[188:189], v14 offset:1632
    s_nop 1
    v_mfma_f32_32x32x16_bf16 v[160:175], v[216:219], v[104:107], v[160:175]
    ds_read_b64 v[190:191], v14 offset:1640
    ds_read_b64 v[192:193], v14 offset:1664
    ds_read_b64 v[194:195], v14 offset:1672
    v_mov_b32_dpp v128, v128 row_shr:1 row_mask:0xf bank_mask:0xf bound_ctrl:0
    v_mov_b32_dpp v129, v129 row_shr:1 row_mask:0xf bank_mask:0xf bound_ctrl:0
    v_mov_b32_dpp v130, v130 row_shr:1 row_mask:0xf bank_mask:0xf bound_ctrl:0
    v_mfma_f32_32x32x16_bf16 v[160:175], v[220:223], v[108:111], v[160:175]
    ds_read_b64 v[196:197], v14 offset:1696
    ds_read_b64 v[198:199], v14 offset:1704
    ds_read_b64 v[200:201], v14 offset:1728
    v_mov_b32_dpp v131, v131 row_shr:1 row_mask:0xf bank_mask:0xf bound_ctrl:0
    v_mov_b32_dpp v132, v132 row_shr:1 row_mask:0xf bank_mask:0xf bound_ctrl:0
    v_mov_b32_dpp v133, v133 row_shr:1 row_mask:0xf bank_mask:0xf bound_ctrl:0
    v_mfma_f32_32x32x16_bf16 v[160:175], v[224:227], v[112:115], v[160:175]
    ds_read_b64 v[202:203], v14 offset:1736
    ds_read_b64 v[204:205], v14 offset:1760
    ds_read_b64 v[206:207], v14 offset:1768
    v_mov_b32_dpp v134, v134 row_shr:1 row_mask:0xf bank_mask:0xf bound_ctrl:0
    v_mov_b32_dpp v135, v135 row_shr:1 row_mask:0xf bank_mask:0xf bound_ctrl:0
    v_mov_b32_dpp v136, v136 row_shr:1 row_mask:0xf bank_mask:0xf bound_ctrl:0
    v_mfma_f32_32x32x16_bf16 v[160:175], v[228:231], v[116:119], v[160:175]
    v_mov_b32_dpp v137, v137 row_shr:1 row_mask:0xf bank_mask:0xf bound_ctrl:0
    v_mov_b32_dpp v138, v138 row_shr:1 row_mask:0xf bank_mask:0xf bound_ctrl:0
    v_mov_b32_dpp v139, v139 row_shr:1 row_mask:0xf bank_mask:0xf bound_ctrl:0
    v_mfma_f32_32x32x16_bf16 v[160:175], v[232:235], v[120:123], v[160:175]
    v_mov_b32_dpp v140, v140 row_shr:1 row_mask:0xf bank_mask:0xf bound_ctrl:0
    v_mov_b32_dpp v141, v141 row_shr:1 row_mask:0xf bank_mask:0xf bound_ctrl:0
    v_mfma_f32_32x32x16_bf16 v[160:175], v[236:239], v[124:127], v[160:175]
    v_mov_b32_dpp v142, v142 row_shr:1 row_mask:0xf bank_mask:0xf bound_ctrl:0
    v_mov_b32_dpp v143, v143 row_shr:1 row_mask:0xf bank_mask:0xf bound_ctrl:0
    s_waitcnt lgkmcnt(0)
    v_mfma_f32_32x32x16_bf16 v[144:159], v[176:179], v[64:67], v[144:159]
    ds_read_b64 v[208:209], v14 offset:3584
    ds_read_b64 v[210:211], v14 offset:3592
    s_nop 2
    v_mfma_f32_32x32x16_bf16 v[144:159], v[180:183], v[68:71], v[144:159]
    ds_read_b64 v[212:213], v14 offset:3616
    ds_read_b64 v[214:215], v14 offset:3624
    s_nop 2
    v_mfma_f32_32x32x16_bf16 v[144:159], v[184:187], v[72:75], v[144:159]
    ds_read_b64 v[216:217], v14 offset:3648
    ds_read_b64 v[218:219], v14 offset:3656
    v_and_b32_dpp v160, v160, v15 row_shr:1 row_mask:0xf bank_mask:0xf bound_ctrl:0
    v_and_b32_dpp v161, v161, v15 row_shr:1 row_mask:0xf bank_mask:0xf bound_ctrl:0
    v_and_b32_dpp v162, v162, v15 row_shr:1 row_mask:0xf bank_mask:0xf bound_ctrl:0
    v_mfma_f32_32x32x16_bf16 v[144:159], v[188:191], v[76:79], v[144:159]
    ds_read_b64 v[220:221], v14 offset:3680
    ds_read_b64 v[222:223], v14 offset:3688
    v_and_b32_dpp v163, v163, v15 row_shr:1 row_mask:0xf bank_mask:0xf bound_ctrl:0
    v_and_b32_dpp v164, v164, v15 row_shr:1 row_mask:0xf bank_mask:0xf bound_ctrl:0
    v_and_b32_dpp v165, v165, v15 row_shr:1 row_mask:0xf bank_mask:0xf bound_ctrl:0
    v_mfma_f32_32x32x16_bf16 v[144:159], v[192:195], v[80:83], v[144:159]
    ds_read_b64 v[224:225], v14 offset:3712
    ds_read_b64 v[226:227], v14 offset:3720
    v_and_b32_dpp v166, v166, v15 row_shr:1 row_mask:0xf bank_mask:0xf bound_ctrl:0
    v_and_b32_dpp v167, v167, v15 row_shr:1 row_mask:0xf bank_mask:0xf bound_ctrl:0
    v_and_b32_dpp v168, v168, v15 row_shr:1 row_mask:0xf bank_mask:0xf bound_ctrl:0
    v_mfma_f32_32x32x16_bf16 v[144:159], v[196:199], v[84:87], v[144:159]
    ds_read_b64 v[228:229], v14 offset:3744
    ds_read_b64 v[230:231], v14 offset:3752
    v_and_b32_dpp v169, v169, v15 row_shr:1 row_mask:0xf bank_mask:0xf bound_ctrl:0
    v_and_b32_dpp v170, v170, v15 row_shr:1 row_mask:0xf bank_mask:0xf bound_ctrl:0
    v_and_b32_dpp v171, v171, v15 row_shr:1 row_mask:0xf bank_mask:0xf bound_ctrl:0
    v_mfma_f32_32x32x16_bf16 v[144:159], v[200:203], v[88:91], v[144:159]
    ds_read_b64 v[232:233], v14 offset:3776
    ds_read_b64 v[234:235], v14 offset:3784
    v_and_b32_dpp v172, v172, v15 row_shr:1 row_mask:0xf bank_mask:0xf bound_ctrl:0
    v_and_b32_dpp v173, v173, v15 row_shr:1 row_mask:0xf bank_mask:0xf bound_ctrl:0
    v_mfma_f32_32x32x16_bf16 v[144:159], v[204:207], v[92:95], v[144:159]
    ds_read_b64 v[236:237], v14 offset:3808
    ds_read_b64 v[238:239], v14 offset:3816
    v_and_b32_dpp v174, v174, v15 row_shr:1 row_mask:0xf bank_mask:0xf bound_ctrl:0
    v_and_b32_dpp v175, v175, v15 row_shr:1 row_mask:0xf bank_mask:0xf bound_ctrl:0
    v_mfma_f32_32x32x16_bf16 v[128:143], v[176:179], v[32:35], v[128:143]
    s_nop 4
    v_mfma_f32_32x32x16_bf16 v[128:143], v[180:183], v[36:39], v[128:143]
    s_nop 4
    v_mfma_f32_32x32x16_bf16 v[128:143], v[184:187], v[40:43], v[128:143]
    v_mov_b32_dpp v144, v144 row_shr:1 row_mask:0xf bank_mask:0xf bound_ctrl:0
    v_mov_b32_dpp v145, v145 row_shr:1 row_mask:0xf bank_mask:0xf bound_ctrl:0
    v_mov_b32_dpp v146, v146 row_shr:1 row_mask:0xf bank_mask:0xf bound_ctrl:0
    v_mfma_f32_32x32x16_bf16 v[128:143], v[188:191], v[44:47], v[128:143]
    v_mov_b32_dpp v147, v147 row_shr:1 row_mask:0xf bank_mask:0xf bound_ctrl:0
    v_mov_b32_dpp v148, v148 row_shr:1 row_mask:0xf bank_mask:0xf bound_ctrl:0
    v_mov_b32_dpp v149, v149 row_shr:1 row_mask:0xf bank_mask:0xf bound_ctrl:0
    v_mfma_f32_32x32x16_bf16 v[128:143], v[192:195], v[48:51], v[128:143]
    v_mov_b32_dpp v150, v150 row_shr:1 row_mask:0xf bank_mask:0xf bound_ctrl:0
    v_mov_b32_dpp v151, v151 row_shr:1 row_mask:0xf bank_mask:0xf bound_ctrl:0
    v_mov_b32_dpp v152, v152 row_shr:1 row_mask:0xf bank_mask:0xf bound_ctrl:0
    v_mfma_f32_32x32x16_bf16 v[128:143], v[196:199], v[52:55], v[128:143]
    v_mov_b32_dpp v153, v153 row_shr:1 row_mask:0xf bank_mask:0xf bound_ctrl:0
    v_mov_b32_dpp v154, v154 row_shr:1 row_mask:0xf bank_mask:0xf bound_ctrl:0
    v_mov_b32_dpp v155, v155 row_shr:1 row_mask:0xf bank_mask:0xf bound_ctrl:0
    v_mfma_f32_32x32x16_bf16 v[128:143], v[200:203], v[56:59], v[128:143]
    v_mov_b32_dpp v156, v156 row_shr:1 row_mask:0xf bank_mask:0xf bound_ctrl:0
    v_mov_b32_dpp v157, v157 row_shr:1 row_mask:0xf bank_mask:0xf bound_ctrl:0
    v_mfma_f32_32x32x16_bf16 v[128:143], v[204:207], v[60:63], v[128:143]
    v_mov_b32_dpp v158, v158 row_shr:1 row_mask:0xf bank_mask:0xf bound_ctrl:0
    v_mov_b32_dpp v159, v159 row_shr:1 row_mask:0xf bank_mask:0xf bound_ctrl:0
    s_waitcnt lgkmcnt(0)
    v_mfma_f32_32x32x16_bf16 v[160:175], v[208:211], v[96:99], v[160:175]
    ds_read_b64 v[176:177], v14 offset:1280
    ds_read_b64 v[178:179], v14 offset:1288
    ds_read_b64 v[180:181], v14 offset:1312
    ds_read_b64 v[182:183], v14 offset:1320
    s_nop 0
    v_mfma_f32_32x32x16_bf16 v[160:175], v[212:215], v[100:103], v[160:175]
    ds_read_b64 v[184:185], v14 offset:1344
    ds_read_b64 v[186:187], v14 offset:1352
    ds_read_b64 v[188:189], v14 offset:1376
    s_nop 1
    v_mfma_f32_32x32x16_bf16 v[160:175], v[216:219], v[104:107], v[160:175]
    ds_read_b64 v[190:191], v14 offset:1384
    ds_read_b64 v[192:193], v14 offset:1408
    ds_read_b64 v[194:195], v14 offset:1416
    v_mov_b32_dpp v128, v128 row_shr:1 row_mask:0xf bank_mask:0xf bound_ctrl:0
    v_mov_b32_dpp v129, v129 row_shr:1 row_mask:0xf bank_mask:0xf bound_ctrl:0
    v_mov_b32_dpp v130, v130 row_shr:1 row_mask:0xf bank_mask:0xf bound_ctrl:0
    v_mfma_f32_32x32x16_bf16 v[160:175], v[220:223], v[108:111], v[160:175]
    ds_read_b64 v[196:197], v14 offset:1440
    ds_read_b64 v[198:199], v14 offset:1448
    ds_read_b64 v[200:201], v14 offset:1472
    v_mov_b32_dpp v131, v131 row_shr:1 row_mask:0xf bank_mask:0xf bound_ctrl:0
    v_mov_b32_dpp v132, v132 row_shr:1 row_mask:0xf bank_mask:0xf bound_ctrl:0
    v_mov_b32_dpp v133, v133 row_shr:1 row_mask:0xf bank_mask:0xf bound_ctrl:0
    v_mfma_f32_32x32x16_bf16 v[160:175], v[224:227], v[112:115], v[160:175]
    ds_read_b64 v[202:203], v14 offset:1480
    ds_read_b64 v[204:205], v14 offset:1504
    ds_read_b64 v[206:207], v14 offset:1512
    v_mov_b32_dpp v134, v134 row_shr:1 row_mask:0xf bank_mask:0xf bound_ctrl:0
    v_mov_b32_dpp v135, v135 row_shr:1 row_mask:0xf bank_mask:0xf bound_ctrl:0
    v_mov_b32_dpp v136, v136 row_shr:1 row_mask:0xf bank_mask:0xf bound_ctrl:0
    v_mfma_f32_32x32x16_bf16 v[160:175], v[228:231], v[116:119], v[160:175]
    v_mov_b32_dpp v137, v137 row_shr:1 row_mask:0xf bank_mask:0xf bound_ctrl:0
    v_mov_b32_dpp v138, v138 row_shr:1 row_mask:0xf bank_mask:0xf bound_ctrl:0
    v_mov_b32_dpp v139, v139 row_shr:1 row_mask:0xf bank_mask:0xf bound_ctrl:0
    v_mfma_f32_32x32x16_bf16 v[160:175], v[232:235], v[120:123], v[160:175]
    v_mov_b32_dpp v140, v140 row_shr:1 row_mask:0xf bank_mask:0xf bound_ctrl:0
    v_mov_b32_dpp v141, v141 row_shr:1 row_mask:0xf bank_mask:0xf bound_ctrl:0
    v_mfma_f32_32x32x16_bf16 v[160:175], v[236:239], v[124:127], v[160:175]
    v_mov_b32_dpp v142, v142 row_shr:1 row_mask:0xf bank_mask:0xf bound_ctrl:0
    v_mov_b32_dpp v143, v143 row_shr:1 row_mask:0xf bank_mask:0xf bound_ctrl:0
    s_waitcnt lgkmcnt(0)
    v_mfma_f32_32x32x16_bf16 v[144:159], v[176:179], v[64:67], v[144:159]
    ds_read_b64 v[208:209], v14 offset:3328
    ds_read_b64 v[210:211], v14 offset:3336
    s_nop 2
    v_mfma_f32_32x32x16_bf16 v[144:159], v[180:183], v[68:71], v[144:159]
    ds_read_b64 v[212:213], v14 offset:3360
    ds_read_b64 v[214:215], v14 offset:3368
    s_nop 2
    v_mfma_f32_32x32x16_bf16 v[144:159], v[184:187], v[72:75], v[144:159]
    ds_read_b64 v[216:217], v14 offset:3392
    ds_read_b64 v[218:219], v14 offset:3400
    v_and_b32_dpp v160, v160, v15 row_shr:1 row_mask:0xf bank_mask:0xf bound_ctrl:0
    v_and_b32_dpp v161, v161, v15 row_shr:1 row_mask:0xf bank_mask:0xf bound_ctrl:0
    v_and_b32_dpp v162, v162, v15 row_shr:1 row_mask:0xf bank_mask:0xf bound_ctrl:0
    v_mfma_f32_32x32x16_bf16 v[144:159], v[188:191], v[76:79], v[144:159]
    ds_read_b64 v[220:221], v14 offset:3424
    ds_read_b64 v[222:223], v14 offset:3432
    v_and_b32_dpp v163, v163, v15 row_shr:1 row_mask:0xf bank_mask:0xf bound_ctrl:0
    v_and_b32_dpp v164, v164, v15 row_shr:1 row_mask:0xf bank_mask:0xf bound_ctrl:0
    v_and_b32_dpp v165, v165, v15 row_shr:1 row_mask:0xf bank_mask:0xf bound_ctrl:0
    v_mfma_f32_32x32x16_bf16 v[144:159], v[192:195], v[80:83], v[144:159]
    ds_read_b64 v[224:225], v14 offset:3456
    ds_read_b64 v[226:227], v14 offset:3464
    v_and_b32_dpp v166, v166, v15 row_shr:1 row_mask:0xf bank_mask:0xf bound_ctrl:0
    v_and_b32_dpp v167, v167, v15 row_shr:1 row_mask:0xf bank_mask:0xf bound_ctrl:0
    v_and_b32_dpp v168, v168, v15 row_shr:1 row_mask:0xf bank_mask:0xf bound_ctrl:0
    v_mfma_f32_32x32x16_bf16 v[144:159], v[196:199], v[84:87], v[144:159]
    ds_read_b64 v[228:229], v14 offset:3488
    ds_read_b64 v[230:231], v14 offset:3496
    v_and_b32_dpp v169, v169, v15 row_shr:1 row_mask:0xf bank_mask:0xf bound_ctrl:0
    v_and_b32_dpp v170, v170, v15 row_shr:1 row_mask:0xf bank_mask:0xf bound_ctrl:0
    v_and_b32_dpp v171, v171, v15 row_shr:1 row_mask:0xf bank_mask:0xf bound_ctrl:0
    v_mfma_f32_32x32x16_bf16 v[144:159], v[200:203], v[88:91], v[144:159]
    ds_read_b64 v[232:233], v14 offset:3520
    ds_read_b64 v[234:235], v14 offset:3528
    v_and_b32_dpp v172, v172, v15 row_shr:1 row_mask:0xf bank_mask:0xf bound_ctrl:0
    v_and_b32_dpp v173, v173, v15 row_shr:1 row_mask:0xf bank_mask:0xf bound_ctrl:0
    v_mfma_f32_32x32x16_bf16 v[144:159], v[204:207], v[92:95], v[144:159]
    ds_read_b64 v[236:237], v14 offset:3552
    ds_read_b64 v[238:239], v14 offset:3560
    v_and_b32_dpp v174, v174, v15 row_shr:1 row_mask:0xf bank_mask:0xf bound_ctrl:0
    v_and_b32_dpp v175, v175, v15 row_shr:1 row_mask:0xf bank_mask:0xf bound_ctrl:0
    v_mfma_f32_32x32x16_bf16 v[128:143], v[176:179], v[32:35], v[128:143]
    v_and_b32 v19, 31, v1
    s_nop 3
    v_mfma_f32_32x32x16_bf16 v[128:143], v[180:183], v[36:39], v[128:143]
    s_mov_b32 s50, 400384
    s_nop 3
    v_mfma_f32_32x32x16_bf16 v[128:143], v[184:187], v[40:43], v[128:143]
    v_mul_lo_u32 v19, v19, s50
    v_mov_b32_dpp v144, v144 row_shr:1 row_mask:0xf bank_mask:0xf bound_ctrl:0
    v_mov_b32_dpp v145, v145 row_shr:1 row_mask:0xf bank_mask:0xf bound_ctrl:0
    v_mov_b32_dpp v146, v146 row_shr:1 row_mask:0xf bank_mask:0xf bound_ctrl:0
    v_mfma_f32_32x32x16_bf16 v[128:143], v[188:191], v[44:47], v[128:143]
    s_mov_b32 s50, 9060352
    v_mov_b32_dpp v147, v147 row_shr:1 row_mask:0xf bank_mask:0xf bound_ctrl:0
    v_mov_b32_dpp v148, v148 row_shr:1 row_mask:0xf bank_mask:0xf bound_ctrl:0
    v_mov_b32_dpp v149, v149 row_shr:1 row_mask:0xf bank_mask:0xf bound_ctrl:0
    v_mfma_f32_32x32x16_bf16 v[128:143], v[192:195], v[48:51], v[128:143]
    buffer_load_dword v28, v19, s[28:31], s50 offen
    v_mov_b32_dpp v150, v150 row_shr:1 row_mask:0xf bank_mask:0xf bound_ctrl:0
    v_mov_b32_dpp v151, v151 row_shr:1 row_mask:0xf bank_mask:0xf bound_ctrl:0
    v_mov_b32_dpp v152, v152 row_shr:1 row_mask:0xf bank_mask:0xf bound_ctrl:0
    v_mfma_f32_32x32x16_bf16 v[128:143], v[196:199], v[52:55], v[128:143]
    v_mov_b32_dpp v153, v153 row_shr:1 row_mask:0xf bank_mask:0xf bound_ctrl:0
    v_mov_b32_dpp v154, v154 row_shr:1 row_mask:0xf bank_mask:0xf bound_ctrl:0
    v_mov_b32_dpp v155, v155 row_shr:1 row_mask:0xf bank_mask:0xf bound_ctrl:0
    v_mfma_f32_32x32x16_bf16 v[128:143], v[200:203], v[56:59], v[128:143]
    v_mov_b32_dpp v156, v156 row_shr:1 row_mask:0xf bank_mask:0xf bound_ctrl:0
    v_mov_b32_dpp v157, v157 row_shr:1 row_mask:0xf bank_mask:0xf bound_ctrl:0
    v_mfma_f32_32x32x16_bf16 v[128:143], v[204:207], v[60:63], v[128:143]
    v_mov_b32_dpp v158, v158 row_shr:1 row_mask:0xf bank_mask:0xf bound_ctrl:0
    v_mov_b32_dpp v159, v159 row_shr:1 row_mask:0xf bank_mask:0xf bound_ctrl:0
    s_waitcnt lgkmcnt(0)
    v_mfma_f32_32x32x16_bf16 v[160:175], v[208:211], v[96:99], v[160:175]
    ds_read_b64 v[176:177], v14 offset:1024
    ds_read_b64 v[178:179], v14 offset:1032
    ds_read_b64 v[180:181], v14 offset:1056
    ds_read_b64 v[182:183], v14 offset:1064
    s_nop 0
    v_mfma_f32_32x32x16_bf16 v[160:175], v[212:215], v[100:103], v[160:175]
    ds_read_b64 v[184:185], v14 offset:1088
    ds_read_b64 v[186:187], v14 offset:1096
    ds_read_b64 v[188:189], v14 offset:1120
    s_nop 1
    v_mfma_f32_32x32x16_bf16 v[160:175], v[216:219], v[104:107], v[160:175]
    ds_read_b64 v[190:191], v14 offset:1128
    ds_read_b64 v[192:193], v14 offset:1152
    ds_read_b64 v[194:195], v14 offset:1160
    v_mov_b32_dpp v128, v128 row_shr:1 row_mask:0xf bank_mask:0xf bound_ctrl:0
    v_mov_b32_dpp v129, v129 row_shr:1 row_mask:0xf bank_mask:0xf bound_ctrl:0
    v_mov_b32_dpp v130, v130 row_shr:1 row_mask:0xf bank_mask:0xf bound_ctrl:0
    v_mfma_f32_32x32x16_bf16 v[160:175], v[220:223], v[108:111], v[160:175]
    ds_read_b64 v[196:197], v14 offset:1184
    ds_read_b64 v[198:199], v14 offset:1192
    ds_read_b64 v[200:201], v14 offset:1216
    v_mov_b32_dpp v131, v131 row_shr:1 row_mask:0xf bank_mask:0xf bound_ctrl:0
    v_mov_b32_dpp v132, v132 row_shr:1 row_mask:0xf bank_mask:0xf bound_ctrl:0
    v_mov_b32_dpp v133, v133 row_shr:1 row_mask:0xf bank_mask:0xf bound_ctrl:0
    v_mfma_f32_32x32x16_bf16 v[160:175], v[224:227], v[112:115], v[160:175]
    ds_read_b64 v[202:203], v14 offset:1224
    ds_read_b64 v[204:205], v14 offset:1248
    ds_read_b64 v[206:207], v14 offset:1256
    v_mov_b32_dpp v134, v134 row_shr:1 row_mask:0xf bank_mask:0xf bound_ctrl:0
    v_mov_b32_dpp v135, v135 row_shr:1 row_mask:0xf bank_mask:0xf bound_ctrl:0
    v_mov_b32_dpp v136, v136 row_shr:1 row_mask:0xf bank_mask:0xf bound_ctrl:0
    v_mfma_f32_32x32x16_bf16 v[160:175], v[228:231], v[116:119], v[160:175]
    v_mov_b32_dpp v137, v137 row_shr:1 row_mask:0xf bank_mask:0xf bound_ctrl:0
    v_mov_b32_dpp v138, v138 row_shr:1 row_mask:0xf bank_mask:0xf bound_ctrl:0
    v_mov_b32_dpp v139, v139 row_shr:1 row_mask:0xf bank_mask:0xf bound_ctrl:0
    v_mfma_f32_32x32x16_bf16 v[160:175], v[232:235], v[120:123], v[160:175]
    v_mov_b32_dpp v140, v140 row_shr:1 row_mask:0xf bank_mask:0xf bound_ctrl:0
    v_mov_b32_dpp v141, v141 row_shr:1 row_mask:0xf bank_mask:0xf bound_ctrl:0
    v_mfma_f32_32x32x16_bf16 v[160:175], v[236:239], v[124:127], v[160:175]
    v_mov_b32_dpp v142, v142 row_shr:1 row_mask:0xf bank_mask:0xf bound_ctrl:0
    v_mov_b32_dpp v143, v143 row_shr:1 row_mask:0xf bank_mask:0xf bound_ctrl:0
    s_waitcnt lgkmcnt(0)
    v_mfma_f32_32x32x16_bf16 v[144:159], v[176:179], v[64:67], v[144:159]
    ds_read_b64 v[208:209], v14 offset:3072
    ds_read_b64 v[210:211], v14 offset:3080
    s_nop 2
    v_mfma_f32_32x32x16_bf16 v[144:159], v[180:183], v[68:71], v[144:159]
    ds_read_b64 v[212:213], v14 offset:3104
    ds_read_b64 v[214:215], v14 offset:3112
    s_nop 2
    v_mfma_f32_32x32x16_bf16 v[144:159], v[184:187], v[72:75], v[144:159]
    ds_read_b64 v[216:217], v14 offset:3136
    ds_read_b64 v[218:219], v14 offset:3144
    v_and_b32_dpp v160, v160, v15 row_shr:1 row_mask:0xf bank_mask:0xf bound_ctrl:0
    v_and_b32_dpp v161, v161, v15 row_shr:1 row_mask:0xf bank_mask:0xf bound_ctrl:0
    v_and_b32_dpp v162, v162, v15 row_shr:1 row_mask:0xf bank_mask:0xf bound_ctrl:0
    v_mfma_f32_32x32x16_bf16 v[144:159], v[188:191], v[76:79], v[144:159]
    ds_read_b64 v[220:221], v14 offset:3168
    ds_read_b64 v[222:223], v14 offset:3176
    v_and_b32_dpp v163, v163, v15 row_shr:1 row_mask:0xf bank_mask:0xf bound_ctrl:0
    v_and_b32_dpp v164, v164, v15 row_shr:1 row_mask:0xf bank_mask:0xf bound_ctrl:0
    v_and_b32_dpp v165, v165, v15 row_shr:1 row_mask:0xf bank_mask:0xf bound_ctrl:0
    v_mfma_f32_32x32x16_bf16 v[144:159], v[192:195], v[80:83], v[144:159]
    ds_read_b64 v[224:225], v14 offset:3200
    ds_read_b64 v[226:227], v14 offset:3208
    v_and_b32_dpp v166, v166, v15 row_shr:1 row_mask:0xf bank_mask:0xf bound_ctrl:0
    v_and_b32_dpp v167, v167, v15 row_shr:1 row_mask:0xf bank_mask:0xf bound_ctrl:0
    v_and_b32_dpp v168, v168, v15 row_shr:1 row_mask:0xf bank_mask:0xf bound_ctrl:0
    v_mfma_f32_32x32x16_bf16 v[144:159], v[196:199], v[84:87], v[144:159]
    ds_read_b64 v[228:229], v14 offset:3232
    ds_read_b64 v[230:231], v14 offset:3240
    v_and_b32_dpp v169, v169, v15 row_shr:1 row_mask:0xf bank_mask:0xf bound_ctrl:0
    v_and_b32_dpp v170, v170, v15 row_shr:1 row_mask:0xf bank_mask:0xf bound_ctrl:0
    v_and_b32_dpp v171, v171, v15 row_shr:1 row_mask:0xf bank_mask:0xf bound_ctrl:0
    v_mfma_f32_32x32x16_bf16 v[144:159], v[200:203], v[88:91], v[144:159]
    ds_read_b64 v[232:233], v14 offset:3264
    ds_read_b64 v[234:235], v14 offset:3272
    v_and_b32_dpp v172, v172, v15 row_shr:1 row_mask:0xf bank_mask:0xf bound_ctrl:0
    v_and_b32_dpp v173, v173, v15 row_shr:1 row_mask:0xf bank_mask:0xf bound_ctrl:0
    v_mfma_f32_32x32x16_bf16 v[144:159], v[204:207], v[92:95], v[144:159]
    ds_read_b64 v[236:237], v14 offset:3296
    ds_read_b64 v[238:239], v14 offset:3304
    v_and_b32_dpp v174, v174, v15 row_shr:1 row_mask:0xf bank_mask:0xf bound_ctrl:0
    v_and_b32_dpp v175, v175, v15 row_shr:1 row_mask:0xf bank_mask:0xf bound_ctrl:0
    v_mfma_f32_32x32x16_bf16 v[128:143], v[176:179], v[32:35], v[128:143]
    s_nop 4
    v_mfma_f32_32x32x16_bf16 v[128:143], v[180:183], v[36:39], v[128:143]
    s_nop 4
    v_mfma_f32_32x32x16_bf16 v[128:143], v[184:187], v[40:43], v[128:143]
    v_mov_b32_dpp v144, v144 row_shr:1 row_mask:0xf bank_mask:0xf bound_ctrl:0
    v_mov_b32_dpp v145, v145 row_shr:1 row_mask:0xf bank_mask:0xf bound_ctrl:0
    v_mov_b32_dpp v146, v146 row_shr:1 row_mask:0xf bank_mask:0xf bound_ctrl:0
    v_mfma_f32_32x32x16_bf16 v[128:143], v[188:191], v[44:47], v[128:143]
    v_mov_b32_dpp v147, v147 row_shr:1 row_mask:0xf bank_mask:0xf bound_ctrl:0
    v_mov_b32_dpp v148, v148 row_shr:1 row_mask:0xf bank_mask:0xf bound_ctrl:0
    v_mov_b32_dpp v149, v149 row_shr:1 row_mask:0xf bank_mask:0xf bound_ctrl:0
    v_mfma_f32_32x32x16_bf16 v[128:143], v[192:195], v[48:51], v[128:143]
    v_mov_b32_dpp v150, v150 row_shr:1 row_mask:0xf bank_mask:0xf bound_ctrl:0
    v_mov_b32_dpp v151, v151 row_shr:1 row_mask:0xf bank_mask:0xf bound_ctrl:0
    v_mov_b32_dpp v152, v152 row_shr:1 row_mask:0xf bank_mask:0xf bound_ctrl:0
    v_mfma_f32_32x32x16_bf16 v[128:143], v[196:199], v[52:55], v[128:143]
    v_mov_b32_dpp v153, v153 row_shr:1 row_mask:0xf bank_mask:0xf bound_ctrl:0
    v_mov_b32_dpp v154, v154 row_shr:1 row_mask:0xf bank_mask:0xf bound_ctrl:0
    v_mov_b32_dpp v155, v155 row_shr:1 row_mask:0xf bank_mask:0xf bound_ctrl:0
    v_mfma_f32_32x32x16_bf16 v[128:143], v[200:203], v[56:59], v[128:143]
    v_mov_b32_dpp v156, v156 row_shr:1 row_mask:0xf bank_mask:0xf bound_ctrl:0
    v_mov_b32_dpp v157, v157 row_shr:1 row_mask:0xf bank_mask:0xf bound_ctrl:0
    v_mfma_f32_32x32x16_bf16 v[128:143], v[204:207], v[60:63], v[128:143]
    v_mov_b32_dpp v158, v158 row_shr:1 row_mask:0xf bank_mask:0xf bound_ctrl:0
    v_mov_b32_dpp v159, v159 row_shr:1 row_mask:0xf bank_mask:0xf bound_ctrl:0
    s_waitcnt lgkmcnt(0)
    v_mfma_f32_32x32x16_bf16 v[160:175], v[208:211], v[96:99], v[160:175]
    ds_read_b64 v[176:177], v14 offset:768
    ds_read_b64 v[178:179], v14 offset:776
    ds_read_b64 v[180:181], v14 offset:800
    ds_read_b64 v[182:183], v14 offset:808
    s_nop 0
    v_mfma_f32_32x32x16_bf16 v[160:175], v[212:215], v[100:103], v[160:175]
    ds_read_b64 v[184:185], v14 offset:832
    ds_read_b64 v[186:187], v14 offset:840
    ds_read_b64 v[188:189], v14 offset:864
    s_nop 1
    v_mfma_f32_32x32x16_bf16 v[160:175], v[216:219], v[104:107], v[160:175]
    ds_read_b64 v[190:191], v14 offset:872
    ds_read_b64 v[192:193], v14 offset:896
    ds_read_b64 v[194:195], v14 offset:904
    v_mov_b32_dpp v128, v128 row_shr:1 row_mask:0xf bank_mask:0xf bound_ctrl:0
    v_mov_b32_dpp v129, v129 row_shr:1 row_mask:0xf bank_mask:0xf bound_ctrl:0
    v_mov_b32_dpp v130, v130 row_shr:1 row_mask:0xf bank_mask:0xf bound_ctrl:0
    v_mfma_f32_32x32x16_bf16 v[160:175], v[220:223], v[108:111], v[160:175]
    ds_read_b64 v[196:197], v14 offset:928
    ds_read_b64 v[198:199], v14 offset:936
    ds_read_b64 v[200:201], v14 offset:960
    v_mov_b32_dpp v131, v131 row_shr:1 row_mask:0xf bank_mask:0xf bound_ctrl:0
    v_mov_b32_dpp v132, v132 row_shr:1 row_mask:0xf bank_mask:0xf bound_ctrl:0
    v_mov_b32_dpp v133, v133 row_shr:1 row_mask:0xf bank_mask:0xf bound_ctrl:0
    v_mfma_f32_32x32x16_bf16 v[160:175], v[224:227], v[112:115], v[160:175]
    ds_read_b64 v[202:203], v14 offset:968
    ds_read_b64 v[204:205], v14 offset:992
    ds_read_b64 v[206:207], v14 offset:1000
    v_mov_b32_dpp v134, v134 row_shr:1 row_mask:0xf bank_mask:0xf bound_ctrl:0
    v_mov_b32_dpp v135, v135 row_shr:1 row_mask:0xf bank_mask:0xf bound_ctrl:0
    v_mov_b32_dpp v136, v136 row_shr:1 row_mask:0xf bank_mask:0xf bound_ctrl:0
    v_mfma_f32_32x32x16_bf16 v[160:175], v[228:231], v[116:119], v[160:175]
    v_mov_b32_dpp v137, v137 row_shr:1 row_mask:0xf bank_mask:0xf bound_ctrl:0
    v_mov_b32_dpp v138, v138 row_shr:1 row_mask:0xf bank_mask:0xf bound_ctrl:0
    v_mov_b32_dpp v139, v139 row_shr:1 row_mask:0xf bank_mask:0xf bound_ctrl:0
    v_mfma_f32_32x32x16_bf16 v[160:175], v[232:235], v[120:123], v[160:175]
    v_mov_b32_dpp v140, v140 row_shr:1 row_mask:0xf bank_mask:0xf bound_ctrl:0
    v_mov_b32_dpp v141, v141 row_shr:1 row_mask:0xf bank_mask:0xf bound_ctrl:0
    v_mfma_f32_32x32x16_bf16 v[160:175], v[236:239], v[124:127], v[160:175]
    v_mov_b32_dpp v142, v142 row_shr:1 row_mask:0xf bank_mask:0xf bound_ctrl:0
    v_mov_b32_dpp v143, v143 row_shr:1 row_mask:0xf bank_mask:0xf bound_ctrl:0
    s_waitcnt lgkmcnt(0)
    v_mfma_f32_32x32x16_bf16 v[144:159], v[176:179], v[64:67], v[144:159]
    ds_read_b64 v[208:209], v14 offset:2816
    ds_read_b64 v[210:211], v14 offset:2824
    s_nop 2
    v_mfma_f32_32x32x16_bf16 v[144:159], v[180:183], v[68:71], v[144:159]
    ds_read_b64 v[212:213], v14 offset:2848
    ds_read_b64 v[214:215], v14 offset:2856
    s_nop 2
    v_mfma_f32_32x32x16_bf16 v[144:159], v[184:187], v[72:75], v[144:159]
    ds_read_b64 v[216:217], v14 offset:2880
    ds_read_b64 v[218:219], v14 offset:2888
    v_and_b32_dpp v160, v160, v15 row_shr:1 row_mask:0xf bank_mask:0xf bound_ctrl:0
    v_and_b32_dpp v161, v161, v15 row_shr:1 row_mask:0xf bank_mask:0xf bound_ctrl:0
    v_and_b32_dpp v162, v162, v15 row_shr:1 row_mask:0xf bank_mask:0xf bound_ctrl:0
    v_mfma_f32_32x32x16_bf16 v[144:159], v[188:191], v[76:79], v[144:159]
    ds_read_b64 v[220:221], v14 offset:2912
    ds_read_b64 v[222:223], v14 offset:2920
    v_and_b32_dpp v163, v163, v15 row_shr:1 row_mask:0xf bank_mask:0xf bound_ctrl:0
    v_and_b32_dpp v164, v164, v15 row_shr:1 row_mask:0xf bank_mask:0xf bound_ctrl:0
    v_and_b32_dpp v165, v165, v15 row_shr:1 row_mask:0xf bank_mask:0xf bound_ctrl:0
    v_mfma_f32_32x32x16_bf16 v[144:159], v[192:195], v[80:83], v[144:159]
    ds_read_b64 v[224:225], v14 offset:2944
    ds_read_b64 v[226:227], v14 offset:2952
    v_and_b32_dpp v166, v166, v15 row_shr:1 row_mask:0xf bank_mask:0xf bound_ctrl:0
    v_and_b32_dpp v167, v167, v15 row_shr:1 row_mask:0xf bank_mask:0xf bound_ctrl:0
    v_and_b32_dpp v168, v168, v15 row_shr:1 row_mask:0xf bank_mask:0xf bound_ctrl:0
    v_mfma_f32_32x32x16_bf16 v[144:159], v[196:199], v[84:87], v[144:159]
    ds_read_b64 v[228:229], v14 offset:2976
    ds_read_b64 v[230:231], v14 offset:2984
    v_and_b32_dpp v169, v169, v15 row_shr:1 row_mask:0xf bank_mask:0xf bound_ctrl:0
    v_and_b32_dpp v170, v170, v15 row_shr:1 row_mask:0xf bank_mask:0xf bound_ctrl:0
    v_and_b32_dpp v171, v171, v15 row_shr:1 row_mask:0xf bank_mask:0xf bound_ctrl:0
    v_mfma_f32_32x32x16_bf16 v[144:159], v[200:203], v[88:91], v[144:159]
    ds_read_b64 v[232:233], v14 offset:3008
    ds_read_b64 v[234:235], v14 offset:3016
    v_and_b32_dpp v172, v172, v15 row_shr:1 row_mask:0xf bank_mask:0xf bound_ctrl:0
    v_and_b32_dpp v173, v173, v15 row_shr:1 row_mask:0xf bank_mask:0xf bound_ctrl:0
    v_mfma_f32_32x32x16_bf16 v[144:159], v[204:207], v[92:95], v[144:159]
    ds_read_b64 v[236:237], v14 offset:3040
    ds_read_b64 v[238:239], v14 offset:3048
    v_and_b32_dpp v174, v174, v15 row_shr:1 row_mask:0xf bank_mask:0xf bound_ctrl:0
    v_and_b32_dpp v175, v175, v15 row_shr:1 row_mask:0xf bank_mask:0xf bound_ctrl:0
    v_mfma_f32_32x32x16_bf16 v[128:143], v[176:179], v[32:35], v[128:143]
    s_nop 4
    v_mfma_f32_32x32x16_bf16 v[128:143], v[180:183], v[36:39], v[128:143]
    s_nop 4
    v_mfma_f32_32x32x16_bf16 v[128:143], v[184:187], v[40:43], v[128:143]
    v_mov_b32_dpp v144, v144 row_shr:1 row_mask:0xf bank_mask:0xf bound_ctrl:0
    v_mov_b32_dpp v145, v145 row_shr:1 row_mask:0xf bank_mask:0xf bound_ctrl:0
    v_mov_b32_dpp v146, v146 row_shr:1 row_mask:0xf bank_mask:0xf bound_ctrl:0
    v_mfma_f32_32x32x16_bf16 v[128:143], v[188:191], v[44:47], v[128:143]
    v_mov_b32_dpp v147, v147 row_shr:1 row_mask:0xf bank_mask:0xf bound_ctrl:0
    v_mov_b32_dpp v148, v148 row_shr:1 row_mask:0xf bank_mask:0xf bound_ctrl:0
    v_mov_b32_dpp v149, v149 row_shr:1 row_mask:0xf bank_mask:0xf bound_ctrl:0
    v_mfma_f32_32x32x16_bf16 v[128:143], v[192:195], v[48:51], v[128:143]
    v_mov_b32_dpp v150, v150 row_shr:1 row_mask:0xf bank_mask:0xf bound_ctrl:0
    v_mov_b32_dpp v151, v151 row_shr:1 row_mask:0xf bank_mask:0xf bound_ctrl:0
    v_mov_b32_dpp v152, v152 row_shr:1 row_mask:0xf bank_mask:0xf bound_ctrl:0
    v_mfma_f32_32x32x16_bf16 v[128:143], v[196:199], v[52:55], v[128:143]
    v_mov_b32_dpp v153, v153 row_shr:1 row_mask:0xf bank_mask:0xf bound_ctrl:0
    v_mov_b32_dpp v154, v154 row_shr:1 row_mask:0xf bank_mask:0xf bound_ctrl:0
    v_mov_b32_dpp v155, v155 row_shr:1 row_mask:0xf bank_mask:0xf bound_ctrl:0
    v_mfma_f32_32x32x16_bf16 v[128:143], v[200:203], v[56:59], v[128:143]
    v_mov_b32_dpp v156, v156 row_shr:1 row_mask:0xf bank_mask:0xf bound_ctrl:0
    v_mov_b32_dpp v157, v157 row_shr:1 row_mask:0xf bank_mask:0xf bound_ctrl:0
    v_mfma_f32_32x32x16_bf16 v[128:143], v[204:207], v[60:63], v[128:143]
    v_mov_b32_dpp v158, v158 row_shr:1 row_mask:0xf bank_mask:0xf bound_ctrl:0
    v_mov_b32_dpp v159, v159 row_shr:1 row_mask:0xf bank_mask:0xf bound_ctrl:0
    s_waitcnt lgkmcnt(0)
    v_mfma_f32_32x32x16_bf16 v[160:175], v[208:211], v[96:99], v[160:175]
    ds_read_b64 v[176:177], v14 offset:512
    ds_read_b64 v[178:179], v14 offset:520
    ds_read_b64 v[180:181], v14 offset:544
    ds_read_b64 v[182:183], v14 offset:552
    s_nop 0
    v_mfma_f32_32x32x16_bf16 v[160:175], v[212:215], v[100:103], v[160:175]
    ds_read_b64 v[184:185], v14 offset:576
    ds_read_b64 v[186:187], v14 offset:584
    ds_read_b64 v[188:189], v14 offset:608
    s_nop 1
    v_mfma_f32_32x32x16_bf16 v[160:175], v[216:219], v[104:107], v[160:175]
    ds_read_b64 v[190:191], v14 offset:616
    ds_read_b64 v[192:193], v14 offset:640
    ds_read_b64 v[194:195], v14 offset:648
    v_mov_b32_dpp v128, v128 row_shr:1 row_mask:0xf bank_mask:0xf bound_ctrl:0
    v_mov_b32_dpp v129, v129 row_shr:1 row_mask:0xf bank_mask:0xf bound_ctrl:0
    v_mov_b32_dpp v130, v130 row_shr:1 row_mask:0xf bank_mask:0xf bound_ctrl:0
    v_mfma_f32_32x32x16_bf16 v[160:175], v[220:223], v[108:111], v[160:175]
    ds_read_b64 v[196:197], v14 offset:672
    ds_read_b64 v[198:199], v14 offset:680
    ds_read_b64 v[200:201], v14 offset:704
    v_mov_b32_dpp v131, v131 row_shr:1 row_mask:0xf bank_mask:0xf bound_ctrl:0
    v_mov_b32_dpp v132, v132 row_shr:1 row_mask:0xf bank_mask:0xf bound_ctrl:0
    v_mov_b32_dpp v133, v133 row_shr:1 row_mask:0xf bank_mask:0xf bound_ctrl:0
    v_mfma_f32_32x32x16_bf16 v[160:175], v[224:227], v[112:115], v[160:175]
    ds_read_b64 v[202:203], v14 offset:712
    ds_read_b64 v[204:205], v14 offset:736
    ds_read_b64 v[206:207], v14 offset:744
    v_mov_b32_dpp v134, v134 row_shr:1 row_mask:0xf bank_mask:0xf bound_ctrl:0
    v_mov_b32_dpp v135, v135 row_shr:1 row_mask:0xf bank_mask:0xf bound_ctrl:0
    v_mov_b32_dpp v136, v136 row_shr:1 row_mask:0xf bank_mask:0xf bound_ctrl:0
    v_mfma_f32_32x32x16_bf16 v[160:175], v[228:231], v[116:119], v[160:175]
    v_mov_b32_dpp v137, v137 row_shr:1 row_mask:0xf bank_mask:0xf bound_ctrl:0
    v_mov_b32_dpp v138, v138 row_shr:1 row_mask:0xf bank_mask:0xf bound_ctrl:0
    v_mov_b32_dpp v139, v139 row_shr:1 row_mask:0xf bank_mask:0xf bound_ctrl:0
    v_mfma_f32_32x32x16_bf16 v[160:175], v[232:235], v[120:123], v[160:175]
    v_mov_b32_dpp v140, v140 row_shr:1 row_mask:0xf bank_mask:0xf bound_ctrl:0
    v_mov_b32_dpp v141, v141 row_shr:1 row_mask:0xf bank_mask:0xf bound_ctrl:0
    v_mfma_f32_32x32x16_bf16 v[160:175], v[236:239], v[124:127], v[160:175]
    v_mov_b32_dpp v142, v142 row_shr:1 row_mask:0xf bank_mask:0xf bound_ctrl:0
    v_mov_b32_dpp v143, v143 row_shr:1 row_mask:0xf bank_mask:0xf bound_ctrl:0
    s_waitcnt lgkmcnt(0)
    v_mfma_f32_32x32x16_bf16 v[144:159], v[176:179], v[64:67], v[144:159]
    ds_read_b64 v[208:209], v14 offset:2560
    ds_read_b64 v[210:211], v14 offset:2568
    s_nop 2
    v_mfma_f32_32x32x16_bf16 v[144:159], v[180:183], v[68:71], v[144:159]
    ds_read_b64 v[212:213], v14 offset:2592
    ds_read_b64 v[214:215], v14 offset:2600
    s_nop 2
    v_mfma_f32_32x32x16_bf16 v[144:159], v[184:187], v[72:75], v[144:159]
    ds_read_b64 v[216:217], v14 offset:2624
    ds_read_b64 v[218:219], v14 offset:2632
    v_and_b32_dpp v160, v160, v15 row_shr:1 row_mask:0xf bank_mask:0xf bound_ctrl:0
    v_and_b32_dpp v161, v161, v15 row_shr:1 row_mask:0xf bank_mask:0xf bound_ctrl:0
    v_and_b32_dpp v162, v162, v15 row_shr:1 row_mask:0xf bank_mask:0xf bound_ctrl:0
    v_mfma_f32_32x32x16_bf16 v[144:159], v[188:191], v[76:79], v[144:159]
    ds_read_b64 v[220:221], v14 offset:2656
    ds_read_b64 v[222:223], v14 offset:2664
    v_and_b32_dpp v163, v163, v15 row_shr:1 row_mask:0xf bank_mask:0xf bound_ctrl:0
    v_and_b32_dpp v164, v164, v15 row_shr:1 row_mask:0xf bank_mask:0xf bound_ctrl:0
    v_and_b32_dpp v165, v165, v15 row_shr:1 row_mask:0xf bank_mask:0xf bound_ctrl:0
    v_mfma_f32_32x32x16_bf16 v[144:159], v[192:195], v[80:83], v[144:159]
    ds_read_b64 v[224:225], v14 offset:2688
    ds_read_b64 v[226:227], v14 offset:2696
    v_and_b32_dpp v166, v166, v15 row_shr:1 row_mask:0xf bank_mask:0xf bound_ctrl:0
    v_and_b32_dpp v167, v167, v15 row_shr:1 row_mask:0xf bank_mask:0xf bound_ctrl:0
    v_and_b32_dpp v168, v168, v15 row_shr:1 row_mask:0xf bank_mask:0xf bound_ctrl:0
    v_mfma_f32_32x32x16_bf16 v[144:159], v[196:199], v[84:87], v[144:159]
    ds_read_b64 v[228:229], v14 offset:2720
    ds_read_b64 v[230:231], v14 offset:2728
    v_and_b32_dpp v169, v169, v15 row_shr:1 row_mask:0xf bank_mask:0xf bound_ctrl:0
    v_and_b32_dpp v170, v170, v15 row_shr:1 row_mask:0xf bank_mask:0xf bound_ctrl:0
    v_and_b32_dpp v171, v171, v15 row_shr:1 row_mask:0xf bank_mask:0xf bound_ctrl:0
    v_mfma_f32_32x32x16_bf16 v[144:159], v[200:203], v[88:91], v[144:159]
    ds_read_b64 v[232:233], v14 offset:2752
    ds_read_b64 v[234:235], v14 offset:2760
    v_and_b32_dpp v172, v172, v15 row_shr:1 row_mask:0xf bank_mask:0xf bound_ctrl:0
    v_and_b32_dpp v173, v173, v15 row_shr:1 row_mask:0xf bank_mask:0xf bound_ctrl:0
    v_mfma_f32_32x32x16_bf16 v[144:159], v[204:207], v[92:95], v[144:159]
    ds_read_b64 v[236:237], v14 offset:2784
    ds_read_b64 v[238:239], v14 offset:2792
    v_and_b32_dpp v174, v174, v15 row_shr:1 row_mask:0xf bank_mask:0xf bound_ctrl:0
    v_and_b32_dpp v175, v175, v15 row_shr:1 row_mask:0xf bank_mask:0xf bound_ctrl:0
    v_mfma_f32_32x32x16_bf16 v[128:143], v[176:179], v[32:35], v[128:143]
    s_nop 4
    v_mfma_f32_32x32x16_bf16 v[128:143], v[180:183], v[36:39], v[128:143]
    s_nop 4
    v_mfma_f32_32x32x16_bf16 v[128:143], v[184:187], v[40:43], v[128:143]
    v_mov_b32_dpp v144, v144 row_shr:1 row_mask:0xf bank_mask:0xf bound_ctrl:0
    v_mov_b32_dpp v145, v145 row_shr:1 row_mask:0xf bank_mask:0xf bound_ctrl:0
    v_mov_b32_dpp v146, v146 row_shr:1 row_mask:0xf bank_mask:0xf bound_ctrl:0
    v_mfma_f32_32x32x16_bf16 v[128:143], v[188:191], v[44:47], v[128:143]
    v_mov_b32_dpp v147, v147 row_shr:1 row_mask:0xf bank_mask:0xf bound_ctrl:0
    v_mov_b32_dpp v148, v148 row_shr:1 row_mask:0xf bank_mask:0xf bound_ctrl:0
    v_mov_b32_dpp v149, v149 row_shr:1 row_mask:0xf bank_mask:0xf bound_ctrl:0
    v_mfma_f32_32x32x16_bf16 v[128:143], v[192:195], v[48:51], v[128:143]
    v_mov_b32_dpp v150, v150 row_shr:1 row_mask:0xf bank_mask:0xf bound_ctrl:0
    v_mov_b32_dpp v151, v151 row_shr:1 row_mask:0xf bank_mask:0xf bound_ctrl:0
    v_mov_b32_dpp v152, v152 row_shr:1 row_mask:0xf bank_mask:0xf bound_ctrl:0
    v_mfma_f32_32x32x16_bf16 v[128:143], v[196:199], v[52:55], v[128:143]
    v_mov_b32_dpp v153, v153 row_shr:1 row_mask:0xf bank_mask:0xf bound_ctrl:0
    v_mov_b32_dpp v154, v154 row_shr:1 row_mask:0xf bank_mask:0xf bound_ctrl:0
    v_mov_b32_dpp v155, v155 row_shr:1 row_mask:0xf bank_mask:0xf bound_ctrl:0
    v_mfma_f32_32x32x16_bf16 v[128:143], v[200:203], v[56:59], v[128:143]
    v_mov_b32_dpp v156, v156 row_shr:1 row_mask:0xf bank_mask:0xf bound_ctrl:0
    v_mov_b32_dpp v157, v157 row_shr:1 row_mask:0xf bank_mask:0xf bound_ctrl:0
    v_mfma_f32_32x32x16_bf16 v[128:143], v[204:207], v[60:63], v[128:143]
    v_mov_b32_dpp v158, v158 row_shr:1 row_mask:0xf bank_mask:0xf bound_ctrl:0
    v_mov_b32_dpp v159, v159 row_shr:1 row_mask:0xf bank_mask:0xf bound_ctrl:0
    s_waitcnt lgkmcnt(0)
    v_mfma_f32_32x32x16_bf16 v[160:175], v[208:211], v[96:99], v[160:175]
    ds_read_b64 v[176:177], v14 offset:256
    ds_read_b64 v[178:179], v14 offset:264
    ds_read_b64 v[180:181], v14 offset:288
    ds_read_b64 v[182:183], v14 offset:296
    s_nop 0
    v_mfma_f32_32x32x16_bf16 v[160:175], v[212:215], v[100:103], v[160:175]
    ds_read_b64 v[184:185], v14 offset:320
    ds_read_b64 v[186:187], v14 offset:328
    ds_read_b64 v[188:189], v14 offset:352
    s_nop 1
    v_mfma_f32_32x32x16_bf16 v[160:175], v[216:219], v[104:107], v[160:175]
    ds_read_b64 v[190:191], v14 offset:360
    ds_read_b64 v[192:193], v14 offset:384
    ds_read_b64 v[194:195], v14 offset:392
    v_mov_b32_dpp v128, v128 row_shr:1 row_mask:0xf bank_mask:0xf bound_ctrl:0
    v_mov_b32_dpp v129, v129 row_shr:1 row_mask:0xf bank_mask:0xf bound_ctrl:0
    v_mov_b32_dpp v130, v130 row_shr:1 row_mask:0xf bank_mask:0xf bound_ctrl:0
    v_mfma_f32_32x32x16_bf16 v[160:175], v[220:223], v[108:111], v[160:175]
    ds_read_b64 v[196:197], v14 offset:416
    ds_read_b64 v[198:199], v14 offset:424
    ds_read_b64 v[200:201], v14 offset:448
    v_mov_b32_dpp v131, v131 row_shr:1 row_mask:0xf bank_mask:0xf bound_ctrl:0
    v_mov_b32_dpp v132, v132 row_shr:1 row_mask:0xf bank_mask:0xf bound_ctrl:0
    v_mov_b32_dpp v133, v133 row_shr:1 row_mask:0xf bank_mask:0xf bound_ctrl:0
    v_mfma_f32_32x32x16_bf16 v[160:175], v[224:227], v[112:115], v[160:175]
    ds_read_b64 v[202:203], v14 offset:456
    ds_read_b64 v[204:205], v14 offset:480
    ds_read_b64 v[206:207], v14 offset:488
    v_mov_b32_dpp v134, v134 row_shr:1 row_mask:0xf bank_mask:0xf bound_ctrl:0
    v_mov_b32_dpp v135, v135 row_shr:1 row_mask:0xf bank_mask:0xf bound_ctrl:0
    v_mov_b32_dpp v136, v136 row_shr:1 row_mask:0xf bank_mask:0xf bound_ctrl:0
    v_mfma_f32_32x32x16_bf16 v[160:175], v[228:231], v[116:119], v[160:175]
    v_mov_b32_dpp v137, v137 row_shr:1 row_mask:0xf bank_mask:0xf bound_ctrl:0
    v_mov_b32_dpp v138, v138 row_shr:1 row_mask:0xf bank_mask:0xf bound_ctrl:0
    v_mov_b32_dpp v139, v139 row_shr:1 row_mask:0xf bank_mask:0xf bound_ctrl:0
    v_mfma_f32_32x32x16_bf16 v[160:175], v[232:235], v[120:123], v[160:175]
    v_mov_b32_dpp v140, v140 row_shr:1 row_mask:0xf bank_mask:0xf bound_ctrl:0
    v_mov_b32_dpp v141, v141 row_shr:1 row_mask:0xf bank_mask:0xf bound_ctrl:0
    v_mfma_f32_32x32x16_bf16 v[160:175], v[236:239], v[124:127], v[160:175]
    v_mov_b32_dpp v142, v142 row_shr:1 row_mask:0xf bank_mask:0xf bound_ctrl:0
    v_mov_b32_dpp v143, v143 row_shr:1 row_mask:0xf bank_mask:0xf bound_ctrl:0
    s_waitcnt lgkmcnt(0)
    v_mfma_f32_32x32x16_bf16 v[144:159], v[176:179], v[64:67], v[144:159]
    ds_read_b64 v[208:209], v14 offset:2304
    ds_read_b64 v[210:211], v14 offset:2312
    s_nop 2
    v_mfma_f32_32x32x16_bf16 v[144:159], v[180:183], v[68:71], v[144:159]
    ds_read_b64 v[212:213], v14 offset:2336
    ds_read_b64 v[214:215], v14 offset:2344
    s_nop 2
    v_mfma_f32_32x32x16_bf16 v[144:159], v[184:187], v[72:75], v[144:159]
    ds_read_b64 v[216:217], v14 offset:2368
    ds_read_b64 v[218:219], v14 offset:2376
    v_and_b32_dpp v160, v160, v15 row_shr:1 row_mask:0xf bank_mask:0xf bound_ctrl:0
    v_and_b32_dpp v161, v161, v15 row_shr:1 row_mask:0xf bank_mask:0xf bound_ctrl:0
    v_and_b32_dpp v162, v162, v15 row_shr:1 row_mask:0xf bank_mask:0xf bound_ctrl:0
    v_mfma_f32_32x32x16_bf16 v[144:159], v[188:191], v[76:79], v[144:159]
    ds_read_b64 v[220:221], v14 offset:2400
    ds_read_b64 v[222:223], v14 offset:2408
    v_and_b32_dpp v163, v163, v15 row_shr:1 row_mask:0xf bank_mask:0xf bound_ctrl:0
    v_and_b32_dpp v164, v164, v15 row_shr:1 row_mask:0xf bank_mask:0xf bound_ctrl:0
    v_and_b32_dpp v165, v165, v15 row_shr:1 row_mask:0xf bank_mask:0xf bound_ctrl:0
    v_mfma_f32_32x32x16_bf16 v[144:159], v[192:195], v[80:83], v[144:159]
    ds_read_b64 v[224:225], v14 offset:2432
    ds_read_b64 v[226:227], v14 offset:2440
    v_and_b32_dpp v166, v166, v15 row_shr:1 row_mask:0xf bank_mask:0xf bound_ctrl:0
    v_and_b32_dpp v167, v167, v15 row_shr:1 row_mask:0xf bank_mask:0xf bound_ctrl:0
    v_and_b32_dpp v168, v168, v15 row_shr:1 row_mask:0xf bank_mask:0xf bound_ctrl:0
    v_mfma_f32_32x32x16_bf16 v[144:159], v[196:199], v[84:87], v[144:159]
    ds_read_b64 v[228:229], v14 offset:2464
    ds_read_b64 v[230:231], v14 offset:2472
    v_and_b32_dpp v169, v169, v15 row_shr:1 row_mask:0xf bank_mask:0xf bound_ctrl:0
    v_and_b32_dpp v170, v170, v15 row_shr:1 row_mask:0xf bank_mask:0xf bound_ctrl:0
    v_and_b32_dpp v171, v171, v15 row_shr:1 row_mask:0xf bank_mask:0xf bound_ctrl:0
    v_mfma_f32_32x32x16_bf16 v[144:159], v[200:203], v[88:91], v[144:159]
    ds_read_b64 v[232:233], v14 offset:2496
    ds_read_b64 v[234:235], v14 offset:2504
    v_and_b32_dpp v172, v172, v15 row_shr:1 row_mask:0xf bank_mask:0xf bound_ctrl:0
    v_and_b32_dpp v173, v173, v15 row_shr:1 row_mask:0xf bank_mask:0xf bound_ctrl:0
    v_mfma_f32_32x32x16_bf16 v[144:159], v[204:207], v[92:95], v[144:159]
    ds_read_b64 v[236:237], v14 offset:2528
    ds_read_b64 v[238:239], v14 offset:2536
    v_and_b32_dpp v174, v174, v15 row_shr:1 row_mask:0xf bank_mask:0xf bound_ctrl:0
    v_and_b32_dpp v175, v175, v15 row_shr:1 row_mask:0xf bank_mask:0xf bound_ctrl:0
    v_mfma_f32_32x32x16_bf16 v[128:143], v[176:179], v[32:35], v[128:143]
    s_nop 4
    v_mfma_f32_32x32x16_bf16 v[128:143], v[180:183], v[36:39], v[128:143]
    s_nop 4
    v_mfma_f32_32x32x16_bf16 v[128:143], v[184:187], v[40:43], v[128:143]
    v_mov_b32_dpp v144, v144 row_shr:1 row_mask:0xf bank_mask:0xf bound_ctrl:0
    v_mov_b32_dpp v145, v145 row_shr:1 row_mask:0xf bank_mask:0xf bound_ctrl:0
    v_mov_b32_dpp v146, v146 row_shr:1 row_mask:0xf bank_mask:0xf bound_ctrl:0
    v_mfma_f32_32x32x16_bf16 v[128:143], v[188:191], v[44:47], v[128:143]
    v_mov_b32_dpp v147, v147 row_shr:1 row_mask:0xf bank_mask:0xf bound_ctrl:0
    v_mov_b32_dpp v148, v148 row_shr:1 row_mask:0xf bank_mask:0xf bound_ctrl:0
    v_mov_b32_dpp v149, v149 row_shr:1 row_mask:0xf bank_mask:0xf bound_ctrl:0
    v_mfma_f32_32x32x16_bf16 v[128:143], v[192:195], v[48:51], v[128:143]
    v_mov_b32_dpp v150, v150 row_shr:1 row_mask:0xf bank_mask:0xf bound_ctrl:0
    v_mov_b32_dpp v151, v151 row_shr:1 row_mask:0xf bank_mask:0xf bound_ctrl:0
    v_mov_b32_dpp v152, v152 row_shr:1 row_mask:0xf bank_mask:0xf bound_ctrl:0
    v_mfma_f32_32x32x16_bf16 v[128:143], v[196:199], v[52:55], v[128:143]
    v_mov_b32_dpp v153, v153 row_shr:1 row_mask:0xf bank_mask:0xf bound_ctrl:0
    v_mov_b32_dpp v154, v154 row_shr:1 row_mask:0xf bank_mask:0xf bound_ctrl:0
    v_mov_b32_dpp v155, v155 row_shr:1 row_mask:0xf bank_mask:0xf bound_ctrl:0
    v_mfma_f32_32x32x16_bf16 v[128:143], v[200:203], v[56:59], v[128:143]
    v_mov_b32_dpp v156, v156 row_shr:1 row_mask:0xf bank_mask:0xf bound_ctrl:0
    v_mov_b32_dpp v157, v157 row_shr:1 row_mask:0xf bank_mask:0xf bound_ctrl:0
    v_mfma_f32_32x32x16_bf16 v[128:143], v[204:207], v[60:63], v[128:143]
    v_mov_b32_dpp v158, v158 row_shr:1 row_mask:0xf bank_mask:0xf bound_ctrl:0
    v_mov_b32_dpp v159, v159 row_shr:1 row_mask:0xf bank_mask:0xf bound_ctrl:0
    s_waitcnt lgkmcnt(0)
    v_mfma_f32_32x32x16_bf16 v[160:175], v[208:211], v[96:99], v[160:175]
    ds_read_b64 v[176:177], v14 offset:0
    ds_read_b64 v[178:179], v14 offset:8
    ds_read_b64 v[180:181], v14 offset:32
    ds_read_b64 v[182:183], v14 offset:40
    s_nop 0
    v_mfma_f32_32x32x16_bf16 v[160:175], v[212:215], v[100:103], v[160:175]
    ds_read_b64 v[184:185], v14 offset:64
    ds_read_b64 v[186:187], v14 offset:72
    ds_read_b64 v[188:189], v14 offset:96
    s_nop 1
    v_mfma_f32_32x32x16_bf16 v[160:175], v[216:219], v[104:107], v[160:175]
    ds_read_b64 v[190:191], v14 offset:104
    ds_read_b64 v[192:193], v14 offset:128
    ds_read_b64 v[194:195], v14 offset:136
    v_mov_b32_dpp v128, v128 row_shr:1 row_mask:0xf bank_mask:0xf bound_ctrl:0
    v_mov_b32_dpp v129, v129 row_shr:1 row_mask:0xf bank_mask:0xf bound_ctrl:0
    v_mov_b32_dpp v130, v130 row_shr:1 row_mask:0xf bank_mask:0xf bound_ctrl:0
    v_mfma_f32_32x32x16_bf16 v[160:175], v[220:223], v[108:111], v[160:175]
    ds_read_b64 v[196:197], v14 offset:160
    ds_read_b64 v[198:199], v14 offset:168
    ds_read_b64 v[200:201], v14 offset:192
    v_mov_b32_dpp v131, v131 row_shr:1 row_mask:0xf bank_mask:0xf bound_ctrl:0
    v_mov_b32_dpp v132, v132 row_shr:1 row_mask:0xf bank_mask:0xf bound_ctrl:0
    v_mov_b32_dpp v133, v133 row_shr:1 row_mask:0xf bank_mask:0xf bound_ctrl:0
    v_mfma_f32_32x32x16_bf16 v[160:175], v[224:227], v[112:115], v[160:175]
    ds_read_b64 v[202:203], v14 offset:200
    ds_read_b64 v[204:205], v14 offset:224
    ds_read_b64 v[206:207], v14 offset:232
    v_mov_b32_dpp v134, v134 row_shr:1 row_mask:0xf bank_mask:0xf bound_ctrl:0
    v_mov_b32_dpp v135, v135 row_shr:1 row_mask:0xf bank_mask:0xf bound_ctrl:0
    v_mov_b32_dpp v136, v136 row_shr:1 row_mask:0xf bank_mask:0xf bound_ctrl:0
    v_mfma_f32_32x32x16_bf16 v[160:175], v[228:231], v[116:119], v[160:175]
    v_mov_b32_dpp v137, v137 row_shr:1 row_mask:0xf bank_mask:0xf bound_ctrl:0
    v_mov_b32_dpp v138, v138 row_shr:1 row_mask:0xf bank_mask:0xf bound_ctrl:0
    v_mov_b32_dpp v139, v139 row_shr:1 row_mask:0xf bank_mask:0xf bound_ctrl:0
    v_mfma_f32_32x32x16_bf16 v[160:175], v[232:235], v[120:123], v[160:175]
    v_mov_b32_dpp v140, v140 row_shr:1 row_mask:0xf bank_mask:0xf bound_ctrl:0
    v_mov_b32_dpp v141, v141 row_shr:1 row_mask:0xf bank_mask:0xf bound_ctrl:0
    v_mfma_f32_32x32x16_bf16 v[160:175], v[236:239], v[124:127], v[160:175]
    v_mov_b32_dpp v142, v142 row_shr:1 row_mask:0xf bank_mask:0xf bound_ctrl:0
    v_mov_b32_dpp v143, v143 row_shr:1 row_mask:0xf bank_mask:0xf bound_ctrl:0
    s_waitcnt lgkmcnt(0)
    v_mfma_f32_32x32x16_bf16 v[144:159], v[176:179], v[64:67], v[144:159]
    ds_read_b64 v[208:209], v14 offset:2048
    ds_read_b64 v[210:211], v14 offset:2056
    s_nop 2
    v_mfma_f32_32x32x16_bf16 v[144:159], v[180:183], v[68:71], v[144:159]
    ds_read_b64 v[212:213], v14 offset:2080
    ds_read_b64 v[214:215], v14 offset:2088
    s_nop 2
    v_mfma_f32_32x32x16_bf16 v[144:159], v[184:187], v[72:75], v[144:159]
    ds_read_b64 v[216:217], v14 offset:2112
    ds_read_b64 v[218:219], v14 offset:2120
    v_and_b32_dpp v160, v160, v15 row_shr:1 row_mask:0xf bank_mask:0xf bound_ctrl:0
    v_and_b32_dpp v161, v161, v15 row_shr:1 row_mask:0xf bank_mask:0xf bound_ctrl:0
    v_and_b32_dpp v162, v162, v15 row_shr:1 row_mask:0xf bank_mask:0xf bound_ctrl:0
    v_mfma_f32_32x32x16_bf16 v[144:159], v[188:191], v[76:79], v[144:159]
    ds_read_b64 v[220:221], v14 offset:2144
    ds_read_b64 v[222:223], v14 offset:2152
    v_and_b32_dpp v163, v163, v15 row_shr:1 row_mask:0xf bank_mask:0xf bound_ctrl:0
    v_and_b32_dpp v164, v164, v15 row_shr:1 row_mask:0xf bank_mask:0xf bound_ctrl:0
    v_and_b32_dpp v165, v165, v15 row_shr:1 row_mask:0xf bank_mask:0xf bound_ctrl:0
    v_mfma_f32_32x32x16_bf16 v[144:159], v[192:195], v[80:83], v[144:159]
    ds_read_b64 v[224:225], v14 offset:2176
    ds_read_b64 v[226:227], v14 offset:2184
    v_and_b32_dpp v166, v166, v15 row_shr:1 row_mask:0xf bank_mask:0xf bound_ctrl:0
    v_and_b32_dpp v167, v167, v15 row_shr:1 row_mask:0xf bank_mask:0xf bound_ctrl:0
    v_and_b32_dpp v168, v168, v15 row_shr:1 row_mask:0xf bank_mask:0xf bound_ctrl:0
    v_mfma_f32_32x32x16_bf16 v[144:159], v[196:199], v[84:87], v[144:159]
    ds_read_b64 v[228:229], v14 offset:2208
    ds_read_b64 v[230:231], v14 offset:2216
    v_and_b32_dpp v169, v169, v15 row_shr:1 row_mask:0xf bank_mask:0xf bound_ctrl:0
    v_and_b32_dpp v170, v170, v15 row_shr:1 row_mask:0xf bank_mask:0xf bound_ctrl:0
    v_and_b32_dpp v171, v171, v15 row_shr:1 row_mask:0xf bank_mask:0xf bound_ctrl:0
    v_mfma_f32_32x32x16_bf16 v[144:159], v[200:203], v[88:91], v[144:159]
    ds_read_b64 v[232:233], v14 offset:2240
    ds_read_b64 v[234:235], v14 offset:2248
    v_and_b32_dpp v172, v172, v15 row_shr:1 row_mask:0xf bank_mask:0xf bound_ctrl:0
    v_and_b32_dpp v173, v173, v15 row_shr:1 row_mask:0xf bank_mask:0xf bound_ctrl:0
    v_mfma_f32_32x32x16_bf16 v[144:159], v[204:207], v[92:95], v[144:159]
    ds_read_b64 v[236:237], v14 offset:2272
    ds_read_b64 v[238:239], v14 offset:2280
    v_and_b32_dpp v174, v174, v15 row_shr:1 row_mask:0xf bank_mask:0xf bound_ctrl:0
    v_and_b32_dpp v175, v175, v15 row_shr:1 row_mask:0xf bank_mask:0xf bound_ctrl:0
    v_mfma_f32_32x32x16_bf16 v[128:143], v[176:179], v[32:35], v[128:143]
    v_mfma_f32_32x32x16_bf16 v[128:143], v[180:183], v[36:39], v[128:143]
    v_mfma_f32_32x32x16_bf16 v[128:143], v[184:187], v[40:43], v[128:143]
    v_mul_u32_u24 v16, 272, v7
    v_add_u32 v16, s34, v16
    v_add_u32 v16, 4388, v16
    v_lshlrev_b32 v17, 2, v8
    v_sub_u32 v16, v16, v17
    v_lshlrev_b32 v17, 5, v9
    v_sub_u32 v16, v16, v17
    v_mfma_f32_32x32x16_bf16 v[128:143], v[188:191], v[44:47], v[128:143]
    ds_read_b32 v64, v16 offset:216
    ds_read_b32 v65, v16 offset:208
    ds_read_b32 v66, v16 offset:200
    ds_read_b32 v67, v16 offset:192
    ds_read_b32 v68, v16 offset:152
    ds_read_b32 v69, v16 offset:144
    v_mfma_f32_32x32x16_bf16 v[128:143], v[192:195], v[48:51], v[128:143]
    ds_read_b32 v70, v16 offset:136
    ds_read_b32 v71, v16 offset:128
    ds_read_b32 v72, v16 offset:88
    ds_read_b32 v73, v16 offset:80
    ds_read_b32 v74, v16 offset:72
    ds_read_b32 v75, v16 offset:64
    v_mfma_f32_32x32x16_bf16 v[128:143], v[196:199], v[52:55], v[128:143]
    ds_read_b32 v76, v16 offset:24
    ds_read_b32 v77, v16 offset:16
    ds_read_b32 v78, v16 offset:8
    ds_read_b32 v79, v16 offset:0
    s_lshr_b32 s44, s20, 1
    s_and_b32 s45, s20, 1
    v_mfma_f32_32x32x16_bf16 v[128:143], v[200:203], v[56:59], v[128:143]
    s_cmp_eq_u32 s44, 1
    s_cselect_b32 s44, s33, s32
    s_lshl_b32 s46, s44, 16
    s_and_b32 s47, s44, 0xffff0000
    s_cmp_eq_u32 s45, 1
    s_cselect_b32 s44, s47, s46
    v_mfma_f32_32x32x16_bf16 v[128:143], v[204:207], v[60:63], v[128:143]
    v_mul_u32_u24 v18, 264, v7
    v_lshl_add_u32 v18, v9, 5, v18
    v_lshl_add_u32 v18, v8, 2, v18
    v_add_u32 v18, s34, v18
    v_mul_u32_u24 v17, 264, v2
    v_lshl_add_u32 v17, v1, 2, v17
    s_waitcnt lgkmcnt(0)
    v_mfma_f32_32x32x16_bf16 v[160:175], v[208:211], v[96:99], v[160:175]
    v_mfma_f32_32x32x16_bf16 v[160:175], v[212:215], v[100:103], v[160:175]
    v_mfma_f32_32x32x16_bf16 v[160:175], v[216:219], v[104:107], v[160:175]
    v_and_b32 v80, 0xffff0000, v64
    v_lshlrev_b32 v64, 16, v64
    v_and_b32 v81, 0xffff0000, v65
    v_lshlrev_b32 v65, 16, v65
    v_and_b32 v82, 0xffff0000, v66
    v_lshlrev_b32 v66, 16, v66
    v_mfma_f32_32x32x16_bf16 v[160:175], v[220:223], v[108:111], v[160:175]
    v_and_b32 v83, 0xffff0000, v67
    v_lshlrev_b32 v67, 16, v67
    v_and_b32 v84, 0xffff0000, v68
    v_lshlrev_b32 v68, 16, v68
    v_and_b32 v85, 0xffff0000, v69
    v_lshlrev_b32 v69, 16, v69
    v_mfma_f32_32x32x16_bf16 v[160:175], v[224:227], v[112:115], v[160:175]
    v_and_b32 v86, 0xffff0000, v70
    v_lshlrev_b32 v70, 16, v70
    v_and_b32 v87, 0xffff0000, v71
    v_lshlrev_b32 v71, 16, v71
    v_and_b32 v88, 0xffff0000, v72
    v_mfma_f32_32x32x16_bf16 v[160:175], v[228:231], v[116:119], v[160:175]
    v_lshlrev_b32 v72, 16, v72
    v_and_b32 v89, 0xffff0000, v73
    v_lshlrev_b32 v73, 16, v73
    v_and_b32 v90, 0xffff0000, v74
    v_lshlrev_b32 v74, 16, v74
    v_mfma_f32_32x32x16_bf16 v[160:175], v[232:235], v[120:123], v[160:175]
    v_and_b32 v91, 0xffff0000, v75
    v_lshlrev_b32 v75, 16, v75
    v_and_b32 v92, 0xffff0000, v76
    v_lshlrev_b32 v76, 16, v76
    v_and_b32 v93, 0xffff0000, v77
    v_mfma_f32_32x32x16_bf16 v[160:175], v[236:239], v[124:127], v[160:175]
    v_lshlrev_b32 v77, 16, v77
    v_and_b32 v94, 0xffff0000, v78
    v_lshlrev_b32 v78, 16, v78
    v_and_b32 v95, 0xffff0000, v79
    v_lshlrev_b32 v79, 16, v79
    s_mov_b32 s48, 0x05040100
    s_mov_b32 s49, 0x07060302
    s_nop 11
    v_add_f32_dpp v128, v160, v128 row_shr:8 row_mask:0xf bank_mask:0xf bound_ctrl:0
    v_add_f32_dpp v129, v161, v129 row_shr:8 row_mask:0xf bank_mask:0xf bound_ctrl:0
    v_add_f32_dpp v130, v162, v130 row_shr:8 row_mask:0xf bank_mask:0xf bound_ctrl:0
    v_add_f32_dpp v131, v163, v131 row_shr:8 row_mask:0xf bank_mask:0xf bound_ctrl:0
    v_add_f32_dpp v132, v164, v132 row_shr:8 row_mask:0xf bank_mask:0xf bound_ctrl:0
    v_add_f32_dpp v133, v165, v133 row_shr:8 row_mask:0xf bank_mask:0xf bound_ctrl:0
    v_add_f32_dpp v134, v166, v134 row_shr:8 row_mask:0xf bank_mask:0xf bound_ctrl:0
    v_add_f32_dpp v135, v167, v135 row_shr:8 row_mask:0xf bank_mask:0xf bound_ctrl:0
    v_add_f32_dpp v136, v168, v136 row_shr:8 row_mask:0xf bank_mask:0xf bound_ctrl:0
    v_add_f32_dpp v137, v169, v137 row_shr:8 row_mask:0xf bank_mask:0xf bound_ctrl:0
    v_add_f32_dpp v138, v170, v138 row_shr:8 row_mask:0xf bank_mask:0xf bound_ctrl:0
    v_add_f32_dpp v139, v171, v139 row_shr:8 row_mask:0xf bank_mask:0xf bound_ctrl:0
    v_add_f32_dpp v140, v172, v140 row_shr:8 row_mask:0xf bank_mask:0xf bound_ctrl:0
    v_add_f32_dpp v141, v173, v141 row_shr:8 row_mask:0xf bank_mask:0xf bound_ctrl:0
    v_add_f32_dpp v142, v174, v142 row_shr:8 row_mask:0xf bank_mask:0xf bound_ctrl:0
    v_add_f32_dpp v143, v175, v143 row_shr:8 row_mask:0xf bank_mask:0xf bound_ctrl:0
    s_mov_b32 s42, 0xff00ff00
    s_mov_b32 s43, 0xff00ff00
    s_mov_b64 exec, s[42:43]
    v_add_f32 v144, v160, v144
    v_add_f32 v145, v161, v145
    v_add_f32 v146, v162, v146
    v_add_f32 v147, v163, v147
    v_add_f32 v148, v164, v148
    v_add_f32 v149, v165, v149
    v_add_f32 v150, v166, v150
    v_add_f32 v151, v167, v151
    v_add_f32 v152, v168, v152
    v_add_f32 v153, v169, v153
    v_add_f32 v154, v170, v154
    v_add_f32 v155, v171, v155
    v_add_f32 v156, v172, v156
    v_add_f32 v157, v173, v157
    v_add_f32 v158, v174, v158
    v_add_f32 v159, v175, v159
    s_mov_b64 exec, -1
    v_fma_f32 v128, v80, s44, v128
    v_fma_f32 v144, v64, s44, v144
    v_fma_f32 v129, v81, s44, v129
    v_fma_f32 v145, v65, s44, v145
    v_fma_f32 v130, v82, s44, v130
    v_fma_f32 v146, v66, s44, v146
    v_fma_f32 v131, v83, s44, v131
    v_fma_f32 v147, v67, s44, v147
    v_fma_f32 v132, v84, s44, v132
    v_fma_f32 v148, v68, s44, v148
    v_fma_f32 v133, v85, s44, v133
    v_fma_f32 v149, v69, s44, v149
    v_fma_f32 v134, v86, s44, v134
    v_fma_f32 v150, v70, s44, v150
    v_fma_f32 v135, v87, s44, v135
    v_fma_f32 v151, v71, s44, v151
    v_fma_f32 v136, v88, s44, v136
    v_fma_f32 v152, v72, s44, v152
    v_fma_f32 v137, v89, s44, v137
    v_fma_f32 v153, v73, s44, v153
    v_fma_f32 v138, v90, s44, v138
    v_fma_f32 v154, v74, s44, v154
    v_fma_f32 v139, v91, s44, v139
    v_fma_f32 v155, v75, s44, v155
    v_fma_f32 v140, v92, s44, v140
    v_fma_f32 v156, v76, s44, v156
    v_fma_f32 v141, v93, s44, v141
    v_fma_f32 v157, v77, s44, v157
    v_fma_f32 v142, v94, s44, v142
    v_fma_f32 v158, v78, s44, v158
    v_fma_f32 v143, v95, s44, v143
    v_fma_f32 v159, v79, s44, v159
    v_cvt_pk_bf16_f32 v32, v128, v144
    v_cvt_pk_bf16_f32 v33, v129, v145
    v_cvt_pk_bf16_f32 v34, v130, v146
    v_cvt_pk_bf16_f32 v35, v131, v147
    v_cvt_pk_bf16_f32 v36, v132, v148
    v_cvt_pk_bf16_f32 v37, v133, v149
    v_cvt_pk_bf16_f32 v38, v134, v150
    v_cvt_pk_bf16_f32 v39, v135, v151
    v_cvt_pk_bf16_f32 v40, v136, v152
    v_cvt_pk_bf16_f32 v41, v137, v153
    v_cvt_pk_bf16_f32 v42, v138, v154
    v_cvt_pk_bf16_f32 v43, v139, v155
    v_cvt_pk_bf16_f32 v44, v140, v156
    v_cvt_pk_bf16_f32 v45, v141, v157
    v_cvt_pk_bf16_f32 v46, v142, v158
    v_cvt_pk_bf16_f32 v47, v143, v159
    ds_write_b32 v18, v32 offset:0
    ds_write_b32 v18, v33 offset:8
    ds_write_b32 v18, v34 offset:16
    ds_write_b32 v18, v35 offset:24
    ds_write_b32 v18, v36 offset:64
    ds_write_b32 v18, v37 offset:72
    ds_write_b32 v18, v38 offset:80
    ds_write_b32 v18, v39 offset:88
    ds_write_b32 v18, v40 offset:128
    ds_write_b32 v18, v41 offset:136
    ds_write_b32 v18, v42 offset:144
    ds_write_b32 v18, v43 offset:152
    ds_write_b32 v18, v44 offset:192
    ds_write_b32 v18, v45 offset:200
    ds_write_b32 v18, v46 offset:208
    ds_write_b32 v18, v47 offset:216
    s_waitcnt lgkmcnt(0)
    s_barrier
    ds_read_b32 v48, v17 offset:0
    ds_read_b32 v49, v17 offset:9472
    ds_read_b32 v50, v17 offset:18944
    ds_read_b32 v51, v17 offset:28416
    ds_read_b32 v52, v17 offset:1056
    ds_read_b32 v53, v17 offset:10528
    ds_read_b32 v54, v17 offset:20000
    ds_read_b32 v55, v17 offset:29472
    ds_read_b32 v56, v17 offset:2112
    ds_read_b32 v57, v17 offset:11584
    ds_read_b32 v58, v17 offset:21056
    ds_read_b32 v59, v17 offset:30528
    ds_read_b32 v60, v17 offset:3168
    ds_read_b32 v61, v17 offset:12640
    ds_read_b32 v62, v17 offset:22112
    ds_read_b32 v63, v17 offset:31584
    s_waitcnt lgkmcnt(0)
    v_perm_b32 v96, v49, v48, s48
    v_perm_b32 v98, v49, v48, s49
    v_perm_b32 v97, v51, v50, s48
    v_perm_b32 v99, v51, v50, s49
    v_perm_b32 v100, v53, v52, s48
    v_perm_b32 v102, v53, v52, s49
    v_perm_b32 v101, v55, v54, s48
    v_perm_b32 v103, v55, v54, s49
    v_perm_b32 v104, v57, v56, s48
    v_perm_b32 v106, v57, v56, s49
    v_perm_b32 v105, v59, v58, s48
    v_perm_b32 v107, v59, v58, s49
    v_perm_b32 v108, v61, v60, s48
    v_perm_b32 v110, v61, v60, s49
    v_perm_b32 v109, v63, v62, s48
    v_perm_b32 v111, v63, v62, s49
    v_lshrrev_b32 v20, 3, v0
    v_lshrrev_b32 v21, 4, v20
    v_and_b32 v22, 15, v20
    v_mul_u32_u24 v23, 20480, v20
    v_sub_u32 v23, v4, v23
    s_mov_b32 s40, 1601536
    v_mul_lo_u32 v24, v21, s40
    v_add_u32 v24, v24, v23
    v_add_u32 v25, 1, v22
    v_mul_u32_u24 v25, 20480, v25
    v_add_u32 v25, v25, v24
    v_cmp_eq_u32 s[42:43], 15, v22
    v_cmp_eq_u32 s[44:45], 0, v22
    v_add_u32 v26, 3203072, v24
    v_add_u32 v27, 348160, v24
    v_cndmask_b32 v26, v27, v26, s[42:43]
    v_cmp_ne_u32 vcc, 0, v20
    s_and_b64 s[46:47], s[44:45], vcc
    s_or_b64 s[46:47], s[46:47], s[42:43]
    v_cmp_ne_u32 vcc, 31, v20
    s_and_b64 s[52:53], s[42:43], vcc
    s_or_b64 s[52:53], s[52:53], s[44:45]
    s_or_b64 s[44:45], s[44:45], s[42:43]
    s_add_u32 s39, s38, 9060352
    buffer_store_dwordx4 v[96:99], v25, s[28:31], s39 offen sc1
    s_mov_b64 exec, s[46:47]
    s_cbranch_execz k1_kernel_halo9
    s_sub_u32 s41, s39, 1601536
    buffer_store_dwordx4 v[96:99], v26, s[28:31], s41 offen sc1
k1_kernel_halo9:
    s_mov_b64 exec, -1
    s_add_u32 s39, s39, 3203072
    buffer_store_dwordx4 v[100:103], v25, s[28:31], s39 offen sc1
    s_mov_b64 exec, s[44:45]
    s_cbranch_execz k1_kernel_halo10
    s_sub_u32 s41, s39, 1601536
    buffer_store_dwordx4 v[100:103], v26, s[28:31], s41 offen sc1
k1_kernel_halo10:
    s_mov_b64 exec, -1
    s_add_u32 s39, s39, 3203072
    buffer_store_dwordx4 v[104:107], v25, s[28:31], s39 offen sc1
    s_mov_b64 exec, s[44:45]
    s_cbranch_execz k1_kernel_halo11
    s_sub_u32 s41, s39, 1601536
    buffer_store_dwordx4 v[104:107], v26, s[28:31], s41 offen sc1
k1_kernel_halo11:
    s_mov_b64 exec, -1
    s_add_u32 s39, s39, 3203072
    buffer_store_dwordx4 v[108:111], v25, s[28:31], s39 offen sc1
    s_mov_b64 exec, s[52:53]
    s_cbranch_execz k1_kernel_halo12
    s_sub_u32 s41, s39, 1601536
    buffer_store_dwordx4 v[108:111], v26, s[28:31], s41 offen sc1
k1_kernel_halo12:
    s_mov_b64 exec, -1
    s_add_u32 s39, s39, 3203072
    s_waitcnt vmcnt(0)
    s_endpgm
k1_side:
    s_cmp_ge_u32 s54, 188
    s_cbranch_scc1 k1_end
    s_cmp_lt_u32 s54, 128
    s_cbranch_scc1 k1_kernel_sx13
    s_mov_b32 s61, s54
    s_cmp_lg_u32 s20, 0
    s_cbranch_scc1 k1_kernel_sw15
    s_and_b32 s55, s2, 7
    s_lshl_b32 s57, s55, 9
    s_add_u32 s57, s57, 9056256
    v_mov_b32 v250, 0
    v_and_b32 v248, 31, v0
    v_lshlrev_b32 v248, 2, v248
    s_waitcnt lgkmcnt(0)
    s_mov_b32 s28, s10
    s_mov_b32 s29, s11
    s_mov_b32 s30, 268435456
    s_mov_b32 s31, 0x00020000
    buffer_load_dword v251, v250, s[28:31], s57 offen sc1
    s_mov_b32 s23, 1
    s_waitcnt vmcnt(0)
    v_add_u32 v251, 1, v251
k1_kernel_sw14:
    buffer_load_dword v249, v248, s[28:31], s57 offen offset:256 sc1
    s_waitcnt vmcnt(0)
    v_cmp_eq_u32 vcc, v251, v249
    s_sub_u32 s23, s23, 1
    s_cmp_eq_u64 vcc, -1
    s_cbranch_scc1 k1_kernel_sw15
    s_sleep 16
    s_cmp_lg_u32 s23, 0
    s_cbranch_scc1 k1_kernel_sw14
k1_kernel_sw15:
    s_barrier
    s_mov_b32 s54, s61
k1_kernel_sx13:
    s_cmp_lt_u32 s54, 128
    s_cbranch_scc1 k1_pf
    s_branch k1_mod0
k1_side2:
    s_load_dwordx2 s[10:11], s[0:1], 120
    s_load_dwordx8 s[12:19], s[0:1], 56
    v_lshrrev_b32 v2, 6, v0
    v_and_b32 v1, 63, v0
    v_readfirstlane_b32 s20, v2
    s_waitcnt lgkmcnt(0)
    s_mov_b32 s28, s10
    s_mov_b32 s29, s11
    s_mov_b32 s30, 268435456
    s_mov_b32 s31, 0x00020000
    s_sub_u32 s21, s54, 0
    v_lshrrev_b32 v3, 3, v0
    v_and_b32 v4, 7, v0
    v_mul_u32_u24 v5, 144, v3
    v_lshl_add_u32 v5, v4, 4, v5
    v_and_b32 v6, 15, v1
    v_lshrrev_b32 v7, 4, v1
    v_lshrrev_b32 v8, 2, v6
    v_lshl_add_u32 v8, v7, 3, v8
    v_mul_u32_u24 v8, 144, v8
    v_and_b32 v9, 3, v6
    v_lshl_add_u32 v8, v9, 3, v8
    s_lshl_b32 s22, s20, 5
    v_add_u32 v8, s22, v8
    v_lshlrev_b32 v9, 4, v1
    s_cmp_lt_u32 s21, 10
    s_cbranch_scc1 k1_kernel_pk16
    s_cmp_lt_u32 s21, 20
    s_cbranch_scc1 k1_kernel_pk17
    s_cmp_lt_u32 s21, 48
    s_cbranch_scc1 k1_kernel_pk18
    s_cmp_lt_u32 s21, 78
    s_cbranch_scc1 k1_kernel_pk19
    s_branch k1_kernel_pke20
k1_kernel_pk16:
    s_mov_b32 s24, s12
    s_mov_b32 s25, s13
    s_mov_b32 s26, 819200
    s_mov_b32 s27, 0x00020000
    s_sub_u32 s32, s21, 0
    s_mul_i32 s33, s32, 52429
    s_lshr_b32 s33, s33, 18
    s_mul_i32 s34, s33, 5
    s_sub_u32 s34, s32, s34
    s_lshl_b32 s34, s34, 1
    v_mul_u32_u24 v10, 1280, v3
    v_lshl_add_u32 v10, v4, 4, v10
    s_mul_i32 s35, s33, 409600
    s_lshl_b32 s36, s34, 7
    s_add_u32 s35, s35, s36
    buffer_load_dwordx4 v[32:35], v10, s[24:27], s35 offen offset:0
    s_add_u32 s35, s35, 40960
    buffer_load_dwordx4 v[36:39], v10, s[24:27], s35 offen offset:0
    s_add_u32 s35, s35, 40960
    buffer_load_dwordx4 v[40:43], v10, s[24:27], s35 offen offset:0
    s_add_u32 s35, s35, 40960
    buffer_load_dwordx4 v[44:47], v10, s[24:27], s35 offen offset:0
    s_add_u32 s35, s35, 40960
    buffer_load_dwordx4 v[48:51], v10, s[24:27], s35 offen offset:0
    s_add_u32 s35, s35, 40960
    buffer_load_dwordx4 v[52:55], v10, s[24:27], s35 offen offset:0
    s_add_u32 s35, s35, 40960
    buffer_load_dwordx4 v[56:59], v10, s[24:27], s35 offen offset:0
    s_add_u32 s35, s35, 40960
    buffer_load_dwordx4 v[60:63], v10, s[24:27], s35 offen offset:0
    s_add_u32 s35, s35, 40960
    buffer_load_dwordx4 v[64:67], v10, s[24:27], s35 offen offset:0
    s_add_u32 s35, s35, 40960
    buffer_load_dwordx4 v[68:71], v10, s[24:27], s35 offen offset:0
    s_sub_u32 s35, s35, 368640
    buffer_load_dwordx4 v[72:75], v10, s[24:27], s35 offen offset:128
    s_add_u32 s35, s35, 40960
    buffer_load_dwordx4 v[76:79], v10, s[24:27], s35 offen offset:128
    s_add_u32 s35, s35, 40960
    buffer_load_dwordx4 v[80:83], v10, s[24:27], s35 offen offset:128
    s_add_u32 s35, s35, 40960
    buffer_load_dwordx4 v[84:87], v10, s[24:27], s35 offen offset:128
    s_add_u32 s35, s35, 40960
    buffer_load_dwordx4 v[88:91], v10, s[24:27], s35 offen offset:128
    s_add_u32 s35, s35, 40960
    buffer_load_dwordx4 v[92:95], v10, s[24:27], s35 offen offset:128
    s_add_u32 s35, s35, 40960
    buffer_load_dwordx4 v[96:99], v10, s[24:27], s35 offen offset:128
    s_add_u32 s35, s35, 40960
    buffer_load_dwordx4 v[100:103], v10, s[24:27], s35 offen offset:128
    s_add_u32 s35, s35, 40960
    buffer_load_dwordx4 v[104:107], v10, s[24:27], s35 offen offset:128
    s_add_u32 s35, s35, 40960
    buffer_load_dwordx4 v[108:111], v10, s[24:27], s35 offen offset:128
    s_lshl_b32 s36, s34, 2
    s_add_u32 s36, s36, s20
    s_mul_i32 s38, s36, 52429
    s_lshr_b32 s38, s38, 18
    s_mul_i32 s39, s38, 5
    s_sub_u32 s39, s36, s39
    s_mul_i32 s37, s38, 100
    s_mul_i32 s40, s33, 50
    s_add_u32 s37, s37, s40
    s_add_u32 s37, s37, s39
    s_lshl_b32 s37, s37, 10
    s_add_u32 s37, s37, 2764800
    s_waitcnt vmcnt(19)
    ds_write_b128 v5, v[32:35] offset:0
    s_waitcnt vmcnt(18)
    ds_write_b128 v5, v[36:39] offset:4608
    s_waitcnt vmcnt(17)
    ds_write_b128 v5, v[40:43] offset:9216
    s_waitcnt vmcnt(16)
    ds_write_b128 v5, v[44:47] offset:13824
    s_waitcnt vmcnt(15)
    ds_write_b128 v5, v[48:51] offset:18432
    s_waitcnt vmcnt(14)
    ds_write_b128 v5, v[52:55] offset:23040
    s_waitcnt vmcnt(13)
    ds_write_b128 v5, v[56:59] offset:27648
    s_waitcnt vmcnt(12)
    ds_write_b128 v5, v[60:63] offset:32256
    s_waitcnt vmcnt(11)
    ds_write_b128 v5, v[64:67] offset:36864
    s_waitcnt vmcnt(10)
    ds_write_b128 v5, v[68:71] offset:41472
    s_waitcnt lgkmcnt(0)
    s_barrier
    ds_read_b64_tr_b16 v[32:33], v8 offset:0
    ds_read_b64_tr_b16 v[34:35], v8 offset:576
    ds_read_b64_tr_b16 v[36:37], v8 offset:4608
    ds_read_b64_tr_b16 v[38:39], v8 offset:5184
    ds_read_b64_tr_b16 v[40:41], v8 offset:9216
    ds_read_b64_tr_b16 v[42:43], v8 offset:9792
    ds_read_b64_tr_b16 v[44:45], v8 offset:13824
    ds_read_b64_tr_b16 v[46:47], v8 offset:14400
    ds_read_b64_tr_b16 v[48:49], v8 offset:18432
    ds_read_b64_tr_b16 v[50:51], v8 offset:19008
    ds_read_b64_tr_b16 v[52:53], v8 offset:23040
    ds_read_b64_tr_b16 v[54:55], v8 offset:23616
    ds_read_b64_tr_b16 v[56:57], v8 offset:27648
    ds_read_b64_tr_b16 v[58:59], v8 offset:28224
    ds_read_b64_tr_b16 v[60:61], v8 offset:32256
    ds_read_b64_tr_b16 v[62:63], v8 offset:32832
    ds_read_b64_tr_b16 v[64:65], v8 offset:36864
    ds_read_b64_tr_b16 v[66:67], v8 offset:37440
    ds_read_b64_tr_b16 v[68:69], v8 offset:41472
    ds_read_b64_tr_b16 v[70:71], v8 offset:42048
    v_mov_b32 v12, 0
    v_mov_b32 v13, 0x3f803f80
    s_waitcnt lgkmcnt(15)
    s_add_u32 s38, s37, 0
    buffer_store_dwordx4 v[32:35], v9, s[28:31], s38 offen sc1
    v_dot2_f32_bf16 v12, v32, v13, v12
    v_dot2_f32_bf16 v12, v33, v13, v12
    v_dot2_f32_bf16 v12, v34, v13, v12
    v_dot2_f32_bf16 v12, v35, v13, v12
    s_waitcnt lgkmcnt(15)
    s_add_u32 s38, s37, 5120
    buffer_store_dwordx4 v[36:39], v9, s[28:31], s38 offen sc1
    v_dot2_f32_bf16 v12, v36, v13, v12
    v_dot2_f32_bf16 v12, v37, v13, v12
    v_dot2_f32_bf16 v12, v38, v13, v12
    v_dot2_f32_bf16 v12, v39, v13, v12
    s_waitcnt lgkmcnt(14)
    s_add_u32 s38, s37, 10240
    buffer_store_dwordx4 v[40:43], v9, s[28:31], s38 offen sc1
    v_dot2_f32_bf16 v12, v40, v13, v12
    v_dot2_f32_bf16 v12, v41, v13, v12
    v_dot2_f32_bf16 v12, v42, v13, v12
    v_dot2_f32_bf16 v12, v43, v13, v12
    s_waitcnt lgkmcnt(12)
    s_add_u32 s38, s37, 15360
    buffer_store_dwordx4 v[44:47], v9, s[28:31], s38 offen sc1
    v_dot2_f32_bf16 v12, v44, v13, v12
    v_dot2_f32_bf16 v12, v45, v13, v12
    v_dot2_f32_bf16 v12, v46, v13, v12
    v_dot2_f32_bf16 v12, v47, v13, v12
    s_waitcnt lgkmcnt(10)
    s_add_u32 s38, s37, 20480
    buffer_store_dwordx4 v[48:51], v9, s[28:31], s38 offen sc1
    v_dot2_f32_bf16 v12, v48, v13, v12
    v_dot2_f32_bf16 v12, v49, v13, v12
    v_dot2_f32_bf16 v12, v50, v13, v12
    v_dot2_f32_bf16 v12, v51, v13, v12
    s_waitcnt lgkmcnt(8)
    s_add_u32 s38, s37, 25600
    buffer_store_dwordx4 v[52:55], v9, s[28:31], s38 offen sc1
    v_dot2_f32_bf16 v12, v52, v13, v12
    v_dot2_f32_bf16 v12, v53, v13, v12
    v_dot2_f32_bf16 v12, v54, v13, v12
    v_dot2_f32_bf16 v12, v55, v13, v12
    s_waitcnt lgkmcnt(6)
    s_add_u32 s38, s37, 30720
    buffer_store_dwordx4 v[56:59], v9, s[28:31], s38 offen sc1
    v_dot2_f32_bf16 v12, v56, v13, v12
    v_dot2_f32_bf16 v12, v57, v13, v12
    v_dot2_f32_bf16 v12, v58, v13, v12
    v_dot2_f32_bf16 v12, v59, v13, v12
    s_waitcnt lgkmcnt(4)
    s_add_u32 s38, s37, 35840
    buffer_store_dwordx4 v[60:63], v9, s[28:31], s38 offen sc1
    v_dot2_f32_bf16 v12, v60, v13, v12
    v_dot2_f32_bf16 v12, v61, v13, v12
    v_dot2_f32_bf16 v12, v62, v13, v12
    v_dot2_f32_bf16 v12, v63, v13, v12
    s_waitcnt lgkmcnt(2)
    s_add_u32 s38, s37, 40960
    buffer_store_dwordx4 v[64:67], v9, s[28:31], s38 offen sc1
    v_dot2_f32_bf16 v12, v64, v13, v12
    v_dot2_f32_bf16 v12, v65, v13, v12
    v_dot2_f32_bf16 v12, v66, v13, v12
    v_dot2_f32_bf16 v12, v67, v13, v12
    s_waitcnt lgkmcnt(0)
    s_add_u32 s38, s37, 46080
    buffer_store_dwordx4 v[68:71], v9, s[28:31], s38 offen sc1
    v_dot2_f32_bf16 v12, v68, v13, v12
    v_dot2_f32_bf16 v12, v69, v13, v12
    v_dot2_f32_bf16 v12, v70, v13, v12
    v_dot2_f32_bf16 v12, v71, v13, v12
    s_nop 2
    v_mov_b32 v13, v12
    s_nop 1
    v_permlane32_swap_b32 v13, v12
    v_add_f32 v12, v12, v13
    v_mov_b32 v13, v12
    s_nop 1
    v_permlane16_swap_b32 v13, v12
    v_add_f32 v12, v12, v13
    s_mul_i32 s38, s33, 7168
    s_lshl_b32 s39, s36, 6
    s_add_u32 s38, s38, s39
    s_add_u32 s38, s38, 2748416
    v_lshlrev_b32 v14, 2, v1
    v_cmp_gt_u32 vcc, 16, v1
    s_and_saveexec_b64 s[40:41], vcc
    buffer_store_dword v12, v14, s[28:31], s38 offen sc1
    s_mov_b64 exec, -1
    s_add_u32 s34, s34, 1
    s_barrier
    s_lshl_b32 s36, s34, 2
    s_add_u32 s36, s36, s20
    s_mul_i32 s38, s36, 52429
    s_lshr_b32 s38, s38, 18
    s_mul_i32 s39, s38, 5
    s_sub_u32 s39, s36, s39
    s_mul_i32 s37, s38, 100
    s_mul_i32 s40, s33, 50
    s_add_u32 s37, s37, s40
    s_add_u32 s37, s37, s39
    s_lshl_b32 s37, s37, 10
    s_add_u32 s37, s37, 2764800
    s_waitcnt vmcnt(20)
    ds_write_b128 v5, v[72:75] offset:0
    s_waitcnt vmcnt(19)
    ds_write_b128 v5, v[76:79] offset:4608
    s_waitcnt vmcnt(18)
    ds_write_b128 v5, v[80:83] offset:9216
    s_waitcnt vmcnt(17)
    ds_write_b128 v5, v[84:87] offset:13824
    s_waitcnt vmcnt(16)
    ds_write_b128 v5, v[88:91] offset:18432
    s_waitcnt vmcnt(15)
    ds_write_b128 v5, v[92:95] offset:23040
    s_waitcnt vmcnt(14)
    ds_write_b128 v5, v[96:99] offset:27648
    s_waitcnt vmcnt(13)
    ds_write_b128 v5, v[100:103] offset:32256
    s_waitcnt vmcnt(12)
    ds_write_b128 v5, v[104:107] offset:36864
    s_waitcnt vmcnt(11)
    ds_write_b128 v5, v[108:111] offset:41472
    s_waitcnt lgkmcnt(0)
    s_barrier
    ds_read_b64_tr_b16 v[72:73], v8 offset:0
    ds_read_b64_tr_b16 v[74:75], v8 offset:576
    ds_read_b64_tr_b16 v[76:77], v8 offset:4608
    ds_read_b64_tr_b16 v[78:79], v8 offset:5184
    ds_read_b64_tr_b16 v[80:81], v8 offset:9216
    ds_read_b64_tr_b16 v[82:83], v8 offset:9792
    ds_read_b64_tr_b16 v[84:85], v8 offset:13824
    ds_read_b64_tr_b16 v[86:87], v8 offset:14400
    ds_read_b64_tr_b16 v[88:89], v8 offset:18432
    ds_read_b64_tr_b16 v[90:91], v8 offset:19008
    ds_read_b64_tr_b16 v[92:93], v8 offset:23040
    ds_read_b64_tr_b16 v[94:95], v8 offset:23616
    ds_read_b64_tr_b16 v[96:97], v8 offset:27648
    ds_read_b64_tr_b16 v[98:99], v8 offset:28224
    ds_read_b64_tr_b16 v[100:101], v8 offset:32256
    ds_read_b64_tr_b16 v[102:103], v8 offset:32832
    ds_read_b64_tr_b16 v[104:105], v8 offset:36864
    ds_read_b64_tr_b16 v[106:107], v8 offset:37440
    ds_read_b64_tr_b16 v[108:109], v8 offset:41472
    ds_read_b64_tr_b16 v[110:111], v8 offset:42048
    v_mov_b32 v12, 0
    v_mov_b32 v13, 0x3f803f80
    s_waitcnt lgkmcnt(15)
    s_add_u32 s38, s37, 0
    buffer_store_dwordx4 v[72:75], v9, s[28:31], s38 offen sc1
    v_dot2_f32_bf16 v12, v72, v13, v12
    v_dot2_f32_bf16 v12, v73, v13, v12
    v_dot2_f32_bf16 v12, v74, v13, v12
    v_dot2_f32_bf16 v12, v75, v13, v12
    s_waitcnt lgkmcnt(15)
    s_add_u32 s38, s37, 5120
    buffer_store_dwordx4 v[76:79], v9, s[28:31], s38 offen sc1
    v_dot2_f32_bf16 v12, v76, v13, v12
    v_dot2_f32_bf16 v12, v77, v13, v12
    v_dot2_f32_bf16 v12, v78, v13, v12
    v_dot2_f32_bf16 v12, v79, v13, v12
    s_waitcnt lgkmcnt(14)
    s_add_u32 s38, s37, 10240
    buffer_store_dwordx4 v[80:83], v9, s[28:31], s38 offen sc1
    v_dot2_f32_bf16 v12, v80, v13, v12
    v_dot2_f32_bf16 v12, v81, v13, v12
    v_dot2_f32_bf16 v12, v82, v13, v12
    v_dot2_f32_bf16 v12, v83, v13, v12
    s_waitcnt lgkmcnt(12)
    s_add_u32 s38, s37, 15360
    buffer_store_dwordx4 v[84:87], v9, s[28:31], s38 offen sc1
    v_dot2_f32_bf16 v12, v84, v13, v12
    v_dot2_f32_bf16 v12, v85, v13, v12
    v_dot2_f32_bf16 v12, v86, v13, v12
    v_dot2_f32_bf16 v12, v87, v13, v12
    s_waitcnt lgkmcnt(10)
    s_add_u32 s38, s37, 20480
    buffer_store_dwordx4 v[88:91], v9, s[28:31], s38 offen sc1
    v_dot2_f32_bf16 v12, v88, v13, v12
    v_dot2_f32_bf16 v12, v89, v13, v12
    v_dot2_f32_bf16 v12, v90, v13, v12
    v_dot2_f32_bf16 v12, v91, v13, v12
    s_waitcnt lgkmcnt(8)
    s_add_u32 s38, s37, 25600
    buffer_store_dwordx4 v[92:95], v9, s[28:31], s38 offen sc1
    v_dot2_f32_bf16 v12, v92, v13, v12
    v_dot2_f32_bf16 v12, v93, v13, v12
    v_dot2_f32_bf16 v12, v94, v13, v12
    v_dot2_f32_bf16 v12, v95, v13, v12
    s_waitcnt lgkmcnt(6)
    s_add_u32 s38, s37, 30720
    buffer_store_dwordx4 v[96:99], v9, s[28:31], s38 offen sc1
    v_dot2_f32_bf16 v12, v96, v13, v12
    v_dot2_f32_bf16 v12, v97, v13, v12
    v_dot2_f32_bf16 v12, v98, v13, v12
    v_dot2_f32_bf16 v12, v99, v13, v12
    s_waitcnt lgkmcnt(4)
    s_add_u32 s38, s37, 35840
    buffer_store_dwordx4 v[100:103], v9, s[28:31], s38 offen sc1
    v_dot2_f32_bf16 v12, v100, v13, v12
    v_dot2_f32_bf16 v12, v101, v13, v12
    v_dot2_f32_bf16 v12, v102, v13, v12
    v_dot2_f32_bf16 v12, v103, v13, v12
    s_waitcnt lgkmcnt(2)
    s_add_u32 s38, s37, 40960
    buffer_store_dwordx4 v[104:107], v9, s[28:31], s38 offen sc1
    v_dot2_f32_bf16 v12, v104, v13, v12
    v_dot2_f32_bf16 v12, v105, v13, v12
    v_dot2_f32_bf16 v12, v106, v13, v12
    v_dot2_f32_bf16 v12, v107, v13, v12
    s_waitcnt lgkmcnt(0)
    s_add_u32 s38, s37, 46080
    buffer_store_dwordx4 v[108:111], v9, s[28:31], s38 offen sc1
    v_dot2_f32_bf16 v12, v108, v13, v12
    v_dot2_f32_bf16 v12, v109, v13, v12
    v_dot2_f32_bf16 v12, v110, v13, v12
    v_dot2_f32_bf16 v12, v111, v13, v12
    s_nop 2
    v_mov_b32 v13, v12
    s_nop 1
    v_permlane32_swap_b32 v13, v12
    v_add_f32 v12, v12, v13
    v_mov_b32 v13, v12
    s_nop 1
    v_permlane16_swap_b32 v13, v12
    v_add_f32 v12, v12, v13
    s_mul_i32 s38, s33, 7168
    s_lshl_b32 s39, s36, 6
    s_add_u32 s38, s38, s39
    s_add_u32 s38, s38, 2748416
    v_lshlrev_b32 v14, 2, v1
    v_cmp_gt_u32 vcc, 16, v1
    s_and_saveexec_b64 s[40:41], vcc
    buffer_store_dword v12, v14, s[28:31], s38 offen sc1
    s_mov_b64 exec, -1
    s_endpgm
k1_kernel_pk17:
    s_mov_b32 s24, s14
    s_mov_b32 s25, s15
    s_mov_b32 s26, 819200
    s_mov_b32 s27, 0x00020000
    s_sub_u32 s32, s21, 10
    s_mul_i32 s33, s32, 52429
    s_lshr_b32 s33, s33, 18
    s_mul_i32 s34, s33, 5
    s_sub_u32 s34, s32, s34
    s_lshl_b32 s34, s34, 1
    v_mul_u32_u24 v10, 1280, v3
    v_lshl_add_u32 v10, v4, 4, v10
    s_mul_i32 s35, s33, 409600
    s_lshl_b32 s36, s34, 7
    s_add_u32 s35, s35, s36
    buffer_load_dwordx4 v[32:35], v10, s[24:27], s35 offen offset:0
    s_add_u32 s35, s35, 40960
    buffer_load_dwordx4 v[36:39], v10, s[24:27], s35 offen offset:0
    s_add_u32 s35, s35, 40960
    buffer_load_dwordx4 v[40:43], v10, s[24:27], s35 offen offset:0
    s_add_u32 s35, s35, 40960
    buffer_load_dwordx4 v[44:47], v10, s[24:27], s35 offen offset:0
    s_add_u32 s35, s35, 40960
    buffer_load_dwordx4 v[48:51], v10, s[24:27], s35 offen offset:0
    s_add_u32 s35, s35, 40960
    buffer_load_dwordx4 v[52:55], v10, s[24:27], s35 offen offset:0
    s_add_u32 s35, s35, 40960
    buffer_load_dwordx4 v[56:59], v10, s[24:27], s35 offen offset:0
    s_add_u32 s35, s35, 40960
    buffer_load_dwordx4 v[60:63], v10, s[24:27], s35 offen offset:0
    s_add_u32 s35, s35, 40960
    buffer_load_dwordx4 v[64:67], v10, s[24:27], s35 offen offset:0
    s_add_u32 s35, s35, 40960
    buffer_load_dwordx4 v[68:71], v10, s[24:27], s35 offen offset:0
    s_sub_u32 s35, s35, 368640
    buffer_load_dwordx4 v[72:75], v10, s[24:27], s35 offen offset:128
    s_add_u32 s35, s35, 40960
    buffer_load_dwordx4 v[76:79], v10, s[24:27], s35 offen offset:128
    s_add_u32 s35, s35, 40960
    buffer_load_dwordx4 v[80:83], v10, s[24:27], s35 offen offset:128
    s_add_u32 s35, s35, 40960
    buffer_load_dwordx4 v[84:87], v10, s[24:27], s35 offen offset:128
    s_add_u32 s35, s35, 40960
    buffer_load_dwordx4 v[88:91], v10, s[24:27], s35 offen offset:128
    s_add_u32 s35, s35, 40960
    buffer_load_dwordx4 v[92:95], v10, s[24:27], s35 offen offset:128
    s_add_u32 s35, s35, 40960
    buffer_load_dwordx4 v[96:99], v10, s[24:27], s35 offen offset:128
    s_add_u32 s35, s35, 40960
    buffer_load_dwordx4 v[100:103], v10, s[24:27], s35 offen offset:128
    s_add_u32 s35, s35, 40960
    buffer_load_dwordx4 v[104:107], v10, s[24:27], s35 offen offset:128
    s_add_u32 s35, s35, 40960
    buffer_load_dwordx4 v[108:111], v10, s[24:27], s35 offen offset:128
    s_lshl_b32 s36, s34, 2
    s_add_u32 s36, s36, s20
    s_mul_i32 s38, s36, 52429
    s_lshr_b32 s38, s38, 18
    s_mul_i32 s39, s38, 5
    s_sub_u32 s39, s36, s39
    s_mul_i32 s37, s38, 100
    s_mul_i32 s40, s33, 50
    s_add_u32 s37, s37, s40
    s_add_u32 s37, s37, s39
    s_lshl_b32 s37, s37, 10
    s_add_u32 s37, s37, 3584000
    s_waitcnt vmcnt(19)
    ds_write_b128 v5, v[32:35] offset:0
    s_waitcnt vmcnt(18)
    ds_write_b128 v5, v[36:39] offset:4608
    s_waitcnt vmcnt(17)
    ds_write_b128 v5, v[40:43] offset:9216
    s_waitcnt vmcnt(16)
    ds_write_b128 v5, v[44:47] offset:13824
    s_waitcnt vmcnt(15)
    ds_write_b128 v5, v[48:51] offset:18432
    s_waitcnt vmcnt(14)
    ds_write_b128 v5, v[52:55] offset:23040
    s_waitcnt vmcnt(13)
    ds_write_b128 v5, v[56:59] offset:27648
    s_waitcnt vmcnt(12)
    ds_write_b128 v5, v[60:63] offset:32256
    s_waitcnt vmcnt(11)
    ds_write_b128 v5, v[64:67] offset:36864
    s_waitcnt vmcnt(10)
    ds_write_b128 v5, v[68:71] offset:41472
    s_waitcnt lgkmcnt(0)
    s_barrier
    ds_read_b64_tr_b16 v[32:33], v8 offset:0
    ds_read_b64_tr_b16 v[34:35], v8 offset:576
    ds_read_b64_tr_b16 v[36:37], v8 offset:4608
    ds_read_b64_tr_b16 v[38:39], v8 offset:5184
    ds_read_b64_tr_b16 v[40:41], v8 offset:9216
    ds_read_b64_tr_b16 v[42:43], v8 offset:9792
    ds_read_b64_tr_b16 v[44:45], v8 offset:13824
    ds_read_b64_tr_b16 v[46:47], v8 offset:14400
    ds_read_b64_tr_b16 v[48:49], v8 offset:18432
    ds_read_b64_tr_b16 v[50:51], v8 offset:19008
    ds_read_b64_tr_b16 v[52:53], v8 offset:23040
    ds_read_b64_tr_b16 v[54:55], v8 offset:23616
    ds_read_b64_tr_b16 v[56:57], v8 offset:27648
    ds_read_b64_tr_b16 v[58:59], v8 offset:28224
    ds_read_b64_tr_b16 v[60:61], v8 offset:32256
    ds_read_b64_tr_b16 v[62:63], v8 offset:32832
    ds_read_b64_tr_b16 v[64:65], v8 offset:36864
    ds_read_b64_tr_b16 v[66:67], v8 offset:37440
    ds_read_b64_tr_b16 v[68:69], v8 offset:41472
    ds_read_b64_tr_b16 v[70:71], v8 offset:42048
    s_waitcnt lgkmcnt(15)
    s_add_u32 s38, s37, 0
    buffer_store_dwordx4 v[32:35], v9, s[28:31], s38 offen sc1
    s_waitcnt lgkmcnt(15)
    s_add_u32 s38, s37, 5120
    buffer_store_dwordx4 v[36:39], v9, s[28:31], s38 offen sc1
    s_waitcnt lgkmcnt(14)
    s_add_u32 s38, s37, 10240
    buffer_store_dwordx4 v[40:43], v9, s[28:31], s38 offen sc1
    s_waitcnt lgkmcnt(12)
    s_add_u32 s38, s37, 15360
    buffer_store_dwordx4 v[44:47], v9, s[28:31], s38 offen sc1
    s_waitcnt lgkmcnt(10)
    s_add_u32 s38, s37, 20480
    buffer_store_dwordx4 v[48:51], v9, s[28:31], s38 offen sc1
    s_waitcnt lgkmcnt(8)
    s_add_u32 s38, s37, 25600
    buffer_store_dwordx4 v[52:55], v9, s[28:31], s38 offen sc1
    s_waitcnt lgkmcnt(6)
    s_add_u32 s38, s37, 30720
    buffer_store_dwordx4 v[56:59], v9, s[28:31], s38 offen sc1
    s_waitcnt lgkmcnt(4)
    s_add_u32 s38, s37, 35840
    buffer_store_dwordx4 v[60:63], v9, s[28:31], s38 offen sc1
    s_waitcnt lgkmcnt(2)
    s_add_u32 s38, s37, 40960
    buffer_store_dwordx4 v[64:67], v9, s[28:31], s38 offen sc1
    s_waitcnt lgkmcnt(0)
    s_add_u32 s38, s37, 46080
    buffer_store_dwordx4 v[68:71], v9, s[28:31], s38 offen sc1
    s_add_u32 s34, s34, 1
    s_barrier
    s_lshl_b32 s36, s34, 2
    s_add_u32 s36, s36, s20
    s_mul_i32 s38, s36, 52429
    s_lshr_b32 s38, s38, 18
    s_mul_i32 s39, s38, 5
    s_sub_u32 s39, s36, s39
    s_mul_i32 s37, s38, 100
    s_mul_i32 s40, s33, 50
    s_add_u32 s37, s37, s40
    s_add_u32 s37, s37, s39
    s_lshl_b32 s37, s37, 10
    s_add_u32 s37, s37, 3584000
    s_waitcnt vmcnt(19)
    ds_write_b128 v5, v[72:75] offset:0
    s_waitcnt vmcnt(18)
    ds_write_b128 v5, v[76:79] offset:4608
    s_waitcnt vmcnt(17)
    ds_write_b128 v5, v[80:83] offset:9216
    s_waitcnt vmcnt(16)
    ds_write_b128 v5, v[84:87] offset:13824
    s_waitcnt vmcnt(15)
    ds_write_b128 v5, v[88:91] offset:18432
    s_waitcnt vmcnt(14)
    ds_write_b128 v5, v[92:95] offset:23040
    s_waitcnt vmcnt(13)
    ds_write_b128 v5, v[96:99] offset:27648
    s_waitcnt vmcnt(12)
    ds_write_b128 v5, v[100:103] offset:32256
    s_waitcnt vmcnt(11)
    ds_write_b128 v5, v[104:107] offset:36864
    s_waitcnt vmcnt(10)
    ds_write_b128 v5, v[108:111] offset:41472
    s_waitcnt lgkmcnt(0)
    s_barrier
    ds_read_b64_tr_b16 v[72:73], v8 offset:0
    ds_read_b64_tr_b16 v[74:75], v8 offset:576
    ds_read_b64_tr_b16 v[76:77], v8 offset:4608
    ds_read_b64_tr_b16 v[78:79], v8 offset:5184
    ds_read_b64_tr_b16 v[80:81], v8 offset:9216
    ds_read_b64_tr_b16 v[82:83], v8 offset:9792
    ds_read_b64_tr_b16 v[84:85], v8 offset:13824
    ds_read_b64_tr_b16 v[86:87], v8 offset:14400
    ds_read_b64_tr_b16 v[88:89], v8 offset:18432
    ds_read_b64_tr_b16 v[90:91], v8 offset:19008
    ds_read_b64_tr_b16 v[92:93], v8 offset:23040
    ds_read_b64_tr_b16 v[94:95], v8 offset:23616
    ds_read_b64_tr_b16 v[96:97], v8 offset:27648
    ds_read_b64_tr_b16 v[98:99], v8 offset:28224
    ds_read_b64_tr_b16 v[100:101], v8 offset:32256
    ds_read_b64_tr_b16 v[102:103], v8 offset:32832
    ds_read_b64_tr_b16 v[104:105], v8 offset:36864
    ds_read_b64_tr_b16 v[106:107], v8 offset:37440
    ds_read_b64_tr_b16 v[108:109], v8 offset:41472
    ds_read_b64_tr_b16 v[110:111], v8 offset:42048
    s_waitcnt lgkmcnt(15)
    s_add_u32 s38, s37, 0
    buffer_store_dwordx4 v[72:75], v9, s[28:31], s38 offen sc1
    s_waitcnt lgkmcnt(15)
    s_add_u32 s38, s37, 5120
    buffer_store_dwordx4 v[76:79], v9, s[28:31], s38 offen sc1
    s_waitcnt lgkmcnt(14)
    s_add_u32 s38, s37, 10240
    buffer_store_dwordx4 v[80:83], v9, s[28:31], s38 offen sc1
    s_waitcnt lgkmcnt(12)
    s_add_u32 s38, s37, 15360
    buffer_store_dwordx4 v[84:87], v9, s[28:31], s38 offen sc1
    s_waitcnt lgkmcnt(10)
    s_add_u32 s38, s37, 20480
    buffer_store_dwordx4 v[88:91], v9, s[28:31], s38 offen sc1
    s_waitcnt lgkmcnt(8)
    s_add_u32 s38, s37, 25600
    buffer_store_dwordx4 v[92:95], v9, s[28:31], s38 offen sc1
    s_waitcnt lgkmcnt(6)
    s_add_u32 s38, s37, 30720
    buffer_store_dwordx4 v[96:99], v9, s[28:31], s38 offen sc1
    s_waitcnt lgkmcnt(4)
    s_add_u32 s38, s37, 35840
    buffer_store_dwordx4 v[100:103], v9, s[28:31], s38 offen sc1
    s_waitcnt lgkmcnt(2)
    s_add_u32 s38, s37, 40960
    buffer_store_dwordx4 v[104:107], v9, s[28:31], s38 offen sc1
    s_waitcnt lgkmcnt(0)
    s_add_u32 s38, s37, 46080
    buffer_store_dwordx4 v[108:111], v9, s[28:31], s38 offen sc1
    s_endpgm
k1_kernel_pk18:
    s_mov_b32 s24, s16
    s_mov_b32 s25, s17
    s_mov_b32 s26, 2211840
    s_mov_b32 s27, 0x00020000
    s_sub_u32 s32, s21, 20
    s_mul_i32 s33, s32, 4682
    s_lshr_b32 s33, s33, 16
    s_mul_i32 s34, s33, 14
    s_sub_u32 s34, s32, s34
    s_lshl_b32 s34, s34, 1
    v_mul_u32_u24 v10, 3456, v3
    v_lshl_add_u32 v10, v4, 4, v10
    s_mul_i32 s35, s33, 1105920
    s_lshl_b32 s36, s34, 7
    s_add_u32 s35, s35, s36
    buffer_load_dwordx4 v[32:35], v10, s[24:27], s35 offen offset:0
    s_add_u32 s35, s35, 110592
    buffer_load_dwordx4 v[36:39], v10, s[24:27], s35 offen offset:0
    s_add_u32 s35, s35, 110592
    buffer_load_dwordx4 v[40:43], v10, s[24:27], s35 offen offset:0
    s_add_u32 s35, s35, 110592
    buffer_load_dwordx4 v[44:47], v10, s[24:27], s35 offen offset:0
    s_add_u32 s35, s35, 110592
    buffer_load_dwordx4 v[48:51], v10, s[24:27], s35 offen offset:0
    s_add_u32 s35, s35, 110592
    buffer_load_dwordx4 v[52:55], v10, s[24:27], s35 offen offset:0
    s_add_u32 s35, s35, 110592
    buffer_load_dwordx4 v[56:59], v10, s[24:27], s35 offen offset:0
    s_add_u32 s35, s35, 110592
    buffer_load_dwordx4 v[60:63], v10, s[24:27], s35 offen offset:0
    s_add_u32 s35, s35, 110592
    buffer_load_dwordx4 v[64:67], v10, s[24:27], s35 offen offset:0
    s_add_u32 s35, s35, 110592
    buffer_load_dwordx4 v[68:71], v10, s[24:27], s35 offen offset:0
    s_sub_u32 s35, s35, 995328
    buffer_load_dwordx4 v[72:75], v10, s[24:27], s35 offen offset:128
    s_add_u32 s35, s35, 110592
    buffer_load_dwordx4 v[76:79], v10, s[24:27], s35 offen offset:128
    s_add_u32 s35, s35, 110592
    buffer_load_dwordx4 v[80:83], v10, s[24:27], s35 offen offset:128
    s_add_u32 s35, s35, 110592
    buffer_load_dwordx4 v[84:87], v10, s[24:27], s35 offen offset:128
    s_add_u32 s35, s35, 110592
    buffer_load_dwordx4 v[88:91], v10, s[24:27], s35 offen offset:128
    s_add_u32 s35, s35, 110592
    buffer_load_dwordx4 v[92:95], v10, s[24:27], s35 offen offset:128
    s_add_u32 s35, s35, 110592
    buffer_load_dwordx4 v[96:99], v10, s[24:27], s35 offen offset:128
    s_add_u32 s35, s35, 110592
    buffer_load_dwordx4 v[100:103], v10, s[24:27], s35 offen offset:128
    s_add_u32 s35, s35, 110592
    buffer_load_dwordx4 v[104:107], v10, s[24:27], s35 offen offset:128
    s_add_u32 s35, s35, 110592
    buffer_load_dwordx4 v[108:111], v10, s[24:27], s35 offen offset:128
    s_lshl_b32 s36, s34, 2
    s_add_u32 s36, s36, s20
    s_mul_i32 s38, s36, 9363
    s_lshr_b32 s38, s38, 16
    s_mul_i32 s39, s38, 7
    s_sub_u32 s39, s36, s39
    s_mul_i32 s37, s38, 140
    s_mul_i32 s40, s33, 70
    s_add_u32 s37, s37, s40
    s_add_u32 s37, s37, s39
    s_lshl_b32 s37, s37, 10
    s_add_u32 s37, s37, 4403200
    s_waitcnt vmcnt(19)
    ds_write_b128 v5, v[32:35] offset:0
    s_waitcnt vmcnt(18)
    ds_write_b128 v5, v[36:39] offset:4608
    s_waitcnt vmcnt(17)
    ds_write_b128 v5, v[40:43] offset:9216
    s_waitcnt vmcnt(16)
    ds_write_b128 v5, v[44:47] offset:13824
    s_waitcnt vmcnt(15)
    ds_write_b128 v5, v[48:51] offset:18432
    s_waitcnt vmcnt(14)
    ds_write_b128 v5, v[52:55] offset:23040
    s_waitcnt vmcnt(13)
    ds_write_b128 v5, v[56:59] offset:27648
    s_waitcnt vmcnt(12)
    ds_write_b128 v5, v[60:63] offset:32256
    s_waitcnt vmcnt(11)
    ds_write_b128 v5, v[64:67] offset:36864
    s_waitcnt vmcnt(10)
    ds_write_b128 v5, v[68:71] offset:41472
    s_waitcnt lgkmcnt(0)
    s_barrier
    ds_read_b64_tr_b16 v[32:33], v8 offset:0
    ds_read_b64_tr_b16 v[34:35], v8 offset:576
    ds_read_b64_tr_b16 v[36:37], v8 offset:4608
    ds_read_b64_tr_b16 v[38:39], v8 offset:5184
    ds_read_b64_tr_b16 v[40:41], v8 offset:9216
    ds_read_b64_tr_b16 v[42:43], v8 offset:9792
    ds_read_b64_tr_b16 v[44:45], v8 offset:13824
    ds_read_b64_tr_b16 v[46:47], v8 offset:14400
    ds_read_b64_tr_b16 v[48:49], v8 offset:18432
    ds_read_b64_tr_b16 v[50:51], v8 offset:19008
    ds_read_b64_tr_b16 v[52:53], v8 offset:23040
    ds_read_b64_tr_b16 v[54:55], v8 offset:23616
    ds_read_b64_tr_b16 v[56:57], v8 offset:27648
    ds_read_b64_tr_b16 v[58:59], v8 offset:28224
    ds_read_b64_tr_b16 v[60:61], v8 offset:32256
    ds_read_b64_tr_b16 v[62:63], v8 offset:32832
    ds_read_b64_tr_b16 v[64:65], v8 offset:36864
    ds_read_b64_tr_b16 v[66:67], v8 offset:37440
    ds_read_b64_tr_b16 v[68:69], v8 offset:41472
    ds_read_b64_tr_b16 v[70:71], v8 offset:42048
    v_mov_b32 v12, 0
    v_mov_b32 v13, 0x3f803f80
    s_waitcnt lgkmcnt(15)
    s_add_u32 s38, s37, 0
    buffer_store_dwordx4 v[32:35], v9, s[28:31], s38 offen sc1
    v_dot2_f32_bf16 v12, v32, v13, v12
    v_dot2_f32_bf16 v12, v33, v13, v12
    v_dot2_f32_bf16 v12, v34, v13, v12
    v_dot2_f32_bf16 v12, v35, v13, v12
    s_waitcnt lgkmcnt(15)
    s_add_u32 s38, s37, 7168
    buffer_store_dwordx4 v[36:39], v9, s[28:31], s38 offen sc1
    v_dot2_f32_bf16 v12, v36, v13, v12
    v_dot2_f32_bf16 v12, v37, v13, v12
    v_dot2_f32_bf16 v12, v38, v13, v12
    v_dot2_f32_bf16 v12, v39, v13, v12
    s_waitcnt lgkmcnt(14)
    s_add_u32 s38, s37, 14336
    buffer_store_dwordx4 v[40:43], v9, s[28:31], s38 offen sc1
    v_dot2_f32_bf16 v12, v40, v13, v12
    v_dot2_f32_bf16 v12, v41, v13, v12
    v_dot2_f32_bf16 v12, v42, v13, v12
    v_dot2_f32_bf16 v12, v43, v13, v12
    s_waitcnt lgkmcnt(12)
    s_add_u32 s38, s37, 21504
    buffer_store_dwordx4 v[44:47], v9, s[28:31], s38 offen sc1
    v_dot2_f32_bf16 v12, v44, v13, v12
    v_dot2_f32_bf16 v12, v45, v13, v12
    v_dot2_f32_bf16 v12, v46, v13, v12
    v_dot2_f32_bf16 v12, v47, v13, v12
    s_waitcnt lgkmcnt(10)
    s_add_u32 s38, s37, 28672
    buffer_store_dwordx4 v[48:51], v9, s[28:31], s38 offen sc1
    v_dot2_f32_bf16 v12, v48, v13, v12
    v_dot2_f32_bf16 v12, v49, v13, v12
    v_dot2_f32_bf16 v12, v50, v13, v12
    v_dot2_f32_bf16 v12, v51, v13, v12
    s_waitcnt lgkmcnt(8)
    s_add_u32 s38, s37, 35840
    buffer_store_dwordx4 v[52:55], v9, s[28:31], s38 offen sc1
    v_dot2_f32_bf16 v12, v52, v13, v12
    v_dot2_f32_bf16 v12, v53, v13, v12
    v_dot2_f32_bf16 v12, v54, v13, v12
    v_dot2_f32_bf16 v12, v55, v13, v12
    s_waitcnt lgkmcnt(6)
    s_add_u32 s38, s37, 43008
    buffer_store_dwordx4 v[56:59], v9, s[28:31], s38 offen sc1
    v_dot2_f32_bf16 v12, v56, v13, v12
    v_dot2_f32_bf16 v12, v57, v13, v12
    v_dot2_f32_bf16 v12, v58, v13, v12
    v_dot2_f32_bf16 v12, v59, v13, v12
    s_waitcnt lgkmcnt(4)
    s_add_u32 s38, s37, 50176
    buffer_store_dwordx4 v[60:63], v9, s[28:31], s38 offen sc1
    v_dot2_f32_bf16 v12, v60, v13, v12
    v_dot2_f32_bf16 v12, v61, v13, v12
    v_dot2_f32_bf16 v12, v62, v13, v12
    v_dot2_f32_bf16 v12, v63, v13, v12
    s_waitcnt lgkmcnt(2)
    s_add_u32 s38, s37, 57344
    buffer_store_dwordx4 v[64:67], v9, s[28:31], s38 offen sc1
    v_dot2_f32_bf16 v12, v64, v13, v12
    v_dot2_f32_bf16 v12, v65, v13, v12
    v_dot2_f32_bf16 v12, v66, v13, v12
    v_dot2_f32_bf16 v12, v67, v13, v12
    s_waitcnt lgkmcnt(0)
    s_add_u32 s38, s37, 64512
    buffer_store_dwordx4 v[68:71], v9, s[28:31], s38 offen sc1
    v_dot2_f32_bf16 v12, v68, v13, v12
    v_dot2_f32_bf16 v12, v69, v13, v12
    v_dot2_f32_bf16 v12, v70, v13, v12
    v_dot2_f32_bf16 v12, v71, v13, v12
    s_nop 2
    v_mov_b32 v13, v12
    s_nop 1
    v_permlane32_swap_b32 v13, v12
    v_add_f32 v12, v12, v13
    v_mov_b32 v13, v12
    s_nop 1
    v_permlane16_swap_b32 v13, v12
    v_add_f32 v12, v12, v13
    s_mul_i32 s38, s33, 7168
    s_lshl_b32 s39, s36, 6
    s_add_u32 s38, s38, s39
    s_add_u32 s38, s38, 2732032
    v_lshlrev_b32 v14, 2, v1
    v_cmp_gt_u32 vcc, 16, v1
    s_and_saveexec_b64 s[40:41], vcc
    buffer_store_dword v12, v14, s[28:31], s38 offen sc1
    s_mov_b64 exec, -1
    s_add_u32 s34, s34, 1
    s_barrier
    s_lshl_b32 s36, s34, 2
    s_add_u32 s36, s36, s20
    s_mul_i32 s38, s36, 9363
    s_lshr_b32 s38, s38, 16
    s_mul_i32 s39, s38, 7
    s_sub_u32 s39, s36, s39
    s_mul_i32 s37, s38, 140
    s_mul_i32 s40, s33, 70
    s_add_u32 s37, s37, s40
    s_add_u32 s37, s37, s39
    s_lshl_b32 s37, s37, 10
    s_add_u32 s37, s37, 4403200
    s_waitcnt vmcnt(20)
    ds_write_b128 v5, v[72:75] offset:0
    s_waitcnt vmcnt(19)
    ds_write_b128 v5, v[76:79] offset:4608
    s_waitcnt vmcnt(18)
    ds_write_b128 v5, v[80:83] offset:9216
    s_waitcnt vmcnt(17)
    ds_write_b128 v5, v[84:87] offset:13824
    s_waitcnt vmcnt(16)
    ds_write_b128 v5, v[88:91] offset:18432
    s_waitcnt vmcnt(15)
    ds_write_b128 v5, v[92:95] offset:23040
    s_waitcnt vmcnt(14)
    ds_write_b128 v5, v[96:99] offset:27648
    s_waitcnt vmcnt(13)
    ds_write_b128 v5, v[100:103] offset:32256
    s_waitcnt vmcnt(12)
    ds_write_b128 v5, v[104:107] offset:36864
    s_waitcnt vmcnt(11)
    ds_write_b128 v5, v[108:111] offset:41472
    s_waitcnt lgkmcnt(0)
    s_barrier
    ds_read_b64_tr_b16 v[72:73], v8 offset:0
    ds_read_b64_tr_b16 v[74:75], v8 offset:576
    ds_read_b64_tr_b16 v[76:77], v8 offset:4608
    ds_read_b64_tr_b16 v[78:79], v8 offset:5184
    ds_read_b64_tr_b16 v[80:81], v8 offset:9216
    ds_read_b64_tr_b16 v[82:83], v8 offset:9792
    ds_read_b64_tr_b16 v[84:85], v8 offset:13824
    ds_read_b64_tr_b16 v[86:87], v8 offset:14400
    ds_read_b64_tr_b16 v[88:89], v8 offset:18432
    ds_read_b64_tr_b16 v[90:91], v8 offset:19008
    ds_read_b64_tr_b16 v[92:93], v8 offset:23040
    ds_read_b64_tr_b16 v[94:95], v8 offset:23616
    ds_read_b64_tr_b16 v[96:97], v8 offset:27648
    ds_read_b64_tr_b16 v[98:99], v8 offset:28224
    ds_read_b64_tr_b16 v[100:101], v8 offset:32256
    ds_read_b64_tr_b16 v[102:103], v8 offset:32832
    ds_read_b64_tr_b16 v[104:105], v8 offset:36864
    ds_read_b64_tr_b16 v[106:107], v8 offset:37440
    ds_read_b64_tr_b16 v[108:109], v8 offset:41472
    ds_read_b64_tr_b16 v[110:111], v8 offset:42048
    v_mov_b32 v12, 0
    v_mov_b32 v13, 0x3f803f80
    s_waitcnt lgkmcnt(15)
    s_add_u32 s38, s37, 0
    buffer_store_dwordx4 v[72:75], v9, s[28:31], s38 offen sc1
    v_dot2_f32_bf16 v12, v72, v13, v12
    v_dot2_f32_bf16 v12, v73, v13, v12
    v_dot2_f32_bf16 v12, v74, v13, v12
    v_dot2_f32_bf16 v12, v75, v13, v12
    s_waitcnt lgkmcnt(15)
    s_add_u32 s38, s37, 7168
    buffer_store_dwordx4 v[76:79], v9, s[28:31], s38 offen sc1
    v_dot2_f32_bf16 v12, v76, v13, v12
    v_dot2_f32_bf16 v12, v77, v13, v12
    v_dot2_f32_bf16 v12, v78, v13, v12
    v_dot2_f32_bf16 v12, v79, v13, v12
    s_waitcnt lgkmcnt(14)
    s_add_u32 s38, s37, 14336
    buffer_store_dwordx4 v[80:83], v9, s[28:31], s38 offen sc1
    v_dot2_f32_bf16 v12, v80, v13, v12
    v_dot2_f32_bf16 v12, v81, v13, v12
    v_dot2_f32_bf16 v12, v82, v13, v12
    v_dot2_f32_bf16 v12, v83, v13, v12
    s_waitcnt lgkmcnt(12)
    s_add_u32 s38, s37, 21504
    buffer_store_dwordx4 v[84:87], v9, s[28:31], s38 offen sc1
    v_dot2_f32_bf16 v12, v84, v13, v12
    v_dot2_f32_bf16 v12, v85, v13, v12
    v_dot2_f32_bf16 v12, v86, v13, v12
    v_dot2_f32_bf16 v12, v87, v13, v12
    s_waitcnt lgkmcnt(10)
    s_add_u32 s38, s37, 28672
    buffer_store_dwordx4 v[88:91], v9, s[28:31], s38 offen sc1
    v_dot2_f32_bf16 v12, v88, v13, v12
    v_dot2_f32_bf16 v12, v89, v13, v12
    v_dot2_f32_bf16 v12, v90, v13, v12
    v_dot2_f32_bf16 v12, v91, v13, v12
    s_waitcnt lgkmcnt(8)
    s_add_u32 s38, s37, 35840
    buffer_store_dwordx4 v[92:95], v9, s[28:31], s38 offen sc1
    v_dot2_f32_bf16 v12, v92, v13, v12
    v_dot2_f32_bf16 v12, v93, v13, v12
    v_dot2_f32_bf16 v12, v94, v13, v12
    v_dot2_f32_bf16 v12, v95, v13, v12
    s_waitcnt lgkmcnt(6)
    s_add_u32 s38, s37, 43008
    buffer_store_dwordx4 v[96:99], v9, s[28:31], s38 offen sc1
    v_dot2_f32_bf16 v12, v96, v13, v12
    v_dot2_f32_bf16 v12, v97, v13, v12
    v_dot2_f32_bf16 v12, v98, v13, v12
    v_dot2_f32_bf16 v12, v99, v13, v12
    s_waitcnt lgkmcnt(4)
    s_add_u32 s38, s37, 50176
    buffer_store_dwordx4 v[100:103], v9, s[28:31], s38 offen sc1
    v_dot2_f32_bf16 v12, v100, v13, v12
    v_dot2_f32_bf16 v12, v101, v13, v12
    v_dot2_f32_bf16 v12, v102, v13, v12
    v_dot2_f32_bf16 v12, v103, v13, v12
    s_waitcnt lgkmcnt(2)
    s_add_u32 s38, s37, 57344
    buffer_store_dwordx4 v[104:107], v9, s[28:31], s38 offen sc1
    v_dot2_f32_bf16 v12, v104, v13, v12
    v_dot2_f32_bf16 v12, v105, v13, v12
    v_dot2_f32_bf16 v12, v106, v13, v12
    v_dot2_f32_bf16 v12, v107, v13, v12
    s_waitcnt lgkmcnt(0)
    s_add_u32 s38, s37, 64512
    buffer_store_dwordx4 v[108:111], v9, s[28:31], s38 offen sc1
    v_dot2_f32_bf16 v12, v108, v13, v12
    v_dot2_f32_bf16 v12, v109, v13, v12
    v_dot2_f32_bf16 v12, v110, v13, v12
    v_dot2_f32_bf16 v12, v111, v13, v12
    s_nop 2
    v_mov_b32 v13, v12
    s_nop 1
    v_permlane32_swap_b32 v13, v12
    v_add_f32 v12, v12, v13
    v_mov_b32 v13, v12
    s_nop 1
    v_permlane16_swap_b32 v13, v12
    v_add_f32 v12, v12, v13
    s_mul_i32 s38, s33, 7168
    s_lshl_b32 s39, s36, 6
    s_add_u32 s38, s38, s39
    s_add_u32 s38, s38, 2732032
    v_lshlrev_b32 v14, 2, v1
    v_cmp_gt_u32 vcc, 16, v1
    s_and_saveexec_b64 s[40:41], vcc
    buffer_store_dword v12, v14, s[28:31], s38 offen sc1
    s_mov_b64 exec, -1
    s_endpgm
k1_kernel_pk19:
    s_mov_b32 s24, s18
    s_mov_b32 s25, s19
    s_mov_b32 s26, 2211840
    s_mov_b32 s27, 0x00020000
    s_sub_u32 s32, s21, 48
    s_mul_i32 s33, s32, 52429
    s_lshr_b32 s33, s33, 18
    s_mul_i32 s34, s33, 5
    s_sub_u32 s34, s32, s34
    s_lshl_b32 s34, s34, 1
    v_mul_u32_u24 v10, 1280, v3
    v_lshl_add_u32 v10, v4, 4, v10
    s_mul_i32 s35, s33, 368640
    s_lshl_b32 s36, s34, 7
    s_add_u32 s35, s35, s36
    buffer_load_dwordx4 v[32:35], v10, s[24:27], s35 offen offset:0
    s_add_u32 s35, s35, 40960
    buffer_load_dwordx4 v[36:39], v10, s[24:27], s35 offen offset:0
    s_add_u32 s35, s35, 40960
    buffer_load_dwordx4 v[40:43], v10, s[24:27], s35 offen offset:0
    s_add_u32 s35, s35, 40960
    buffer_load_dwordx4 v[44:47], v10, s[24:27], s35 offen offset:0
    s_add_u32 s35, s35, 40960
    buffer_load_dwordx4 v[48:51], v10, s[24:27], s35 offen offset:0
    s_add_u32 s35, s35, 40960
    buffer_load_dwordx4 v[52:55], v10, s[24:27], s35 offen offset:0
    s_add_u32 s35, s35, 40960
    buffer_load_dwordx4 v[56:59], v10, s[24:27], s35 offen offset:0
    s_add_u32 s35, s35, 40960
    buffer_load_dwordx4 v[60:63], v10, s[24:27], s35 offen offset:0
    s_add_u32 s35, s35, 40960
    buffer_load_dwordx4 v[64:67], v10, s[24:27], s35 offen offset:0
    s_sub_u32 s35, s35, 327680
    buffer_load_dwordx4 v[72:75], v10, s[24:27], s35 offen offset:128
    s_add_u32 s35, s35, 40960
    buffer_load_dwordx4 v[76:79], v10, s[24:27], s35 offen offset:128
    s_add_u32 s35, s35, 40960
    buffer_load_dwordx4 v[80:83], v10, s[24:27], s35 offen offset:128
    s_add_u32 s35, s35, 40960
    buffer_load_dwordx4 v[84:87], v10, s[24:27], s35 offen offset:128
    s_add_u32 s35, s35, 40960
    buffer_load_dwordx4 v[88:91], v10, s[24:27], s35 offen offset:128
    s_add_u32 s35, s35, 40960
    buffer_load_dwordx4 v[92:95], v10, s[24:27], s35 offen offset:128
    s_add_u32 s35, s35, 40960
    buffer_load_dwordx4 v[96:99], v10, s[24:27], s35 offen offset:128
    s_add_u32 s35, s35, 40960
    buffer_load_dwordx4 v[100:103], v10, s[24:27], s35 offen offset:128
    s_add_u32 s35, s35, 40960
    buffer_load_dwordx4 v[104:107], v10, s[24:27], s35 offen offset:128
    s_lshl_b32 s36, s34, 2
    s_add_u32 s36, s36, s20
    s_mul_i32 s38, s36, 52429
    s_lshr_b32 s38, s38, 18
    s_mul_i32 s39, s38, 5
    s_sub_u32 s39, s36, s39
    s_mul_i32 s37, s38, 280
    s_mul_i32 s40, s33, 45
    s_add_u32 s37, s37, s40
    s_add_u32 s37, s37, s39
    s_lshl_b32 s37, s37, 10
    s_add_u32 s37, s37, 6696960
    s_waitcnt vmcnt(17)
    ds_write_b128 v5, v[32:35] offset:0
    s_waitcnt vmcnt(16)
    ds_write_b128 v5, v[36:39] offset:4608
    s_waitcnt vmcnt(15)
    ds_write_b128 v5, v[40:43] offset:9216
    s_waitcnt vmcnt(14)
    ds_write_b128 v5, v[44:47] offset:13824
    s_waitcnt vmcnt(13)
    ds_write_b128 v5, v[48:51] offset:18432
    s_waitcnt vmcnt(12)
    ds_write_b128 v5, v[52:55] offset:23040
    s_waitcnt vmcnt(11)
    ds_write_b128 v5, v[56:59] offset:27648
    s_waitcnt vmcnt(10)
    ds_write_b128 v5, v[60:63] offset:32256
    s_waitcnt vmcnt(9)
    ds_write_b128 v5, v[64:67] offset:36864
    s_waitcnt lgkmcnt(0)
    s_barrier
    ds_read_b64_tr_b16 v[32:33], v8 offset:0
    ds_read_b64_tr_b16 v[34:35], v8 offset:576
    ds_read_b64_tr_b16 v[36:37], v8 offset:4608
    ds_read_b64_tr_b16 v[38:39], v8 offset:5184
    ds_read_b64_tr_b16 v[40:41], v8 offset:9216
    ds_read_b64_tr_b16 v[42:43], v8 offset:9792
    ds_read_b64_tr_b16 v[44:45], v8 offset:13824
    ds_read_b64_tr_b16 v[46:47], v8 offset:14400
    ds_read_b64_tr_b16 v[48:49], v8 offset:18432
    ds_read_b64_tr_b16 v[50:51], v8 offset:19008
    ds_read_b64_tr_b16 v[52:53], v8 offset:23040
    ds_read_b64_tr_b16 v[54:55], v8 offset:23616
    ds_read_b64_tr_b16 v[56:57], v8 offset:27648
    ds_read_b64_tr_b16 v[58:59], v8 offset:28224
    ds_read_b64_tr_b16 v[60:61], v8 offset:32256
    ds_read_b64_tr_b16 v[62:63], v8 offset:32832
    ds_read_b64_tr_b16 v[64:65], v8 offset:36864
    ds_read_b64_tr_b16 v[66:67], v8 offset:37440
    s_waitcnt lgkmcnt(15)
    s_add_u32 s38, s37, 0
    buffer_store_dwordx4 v[32:35], v9, s[28:31], s38 offen sc1
    s_waitcnt lgkmcnt(14)
    s_add_u32 s38, s37, 5120
    buffer_store_dwordx4 v[36:39], v9, s[28:31], s38 offen sc1
    s_waitcnt lgkmcnt(12)
    s_add_u32 s38, s37, 10240
    buffer_store_dwordx4 v[40:43], v9, s[28:31], s38 offen sc1
    s_waitcnt lgkmcnt(10)
    s_add_u32 s38, s37, 15360
    buffer_store_dwordx4 v[44:47], v9, s[28:31], s38 offen sc1
    s_waitcnt lgkmcnt(8)
    s_add_u32 s38, s37, 20480
    buffer_store_dwordx4 v[48:51], v9, s[28:31], s38 offen sc1
    s_waitcnt lgkmcnt(6)
    s_add_u32 s38, s37, 25600
    buffer_store_dwordx4 v[52:55], v9, s[28:31], s38 offen sc1
    s_waitcnt lgkmcnt(4)
    s_add_u32 s38, s37, 30720
    buffer_store_dwordx4 v[56:59], v9, s[28:31], s38 offen sc1
    s_waitcnt lgkmcnt(2)
    s_add_u32 s38, s37, 35840
    buffer_store_dwordx4 v[60:63], v9, s[28:31], s38 offen sc1
    s_waitcnt lgkmcnt(0)
    s_add_u32 s38, s37, 40960
    buffer_store_dwordx4 v[64:67], v9, s[28:31], s38 offen sc1
    s_add_u32 s34, s34, 1
    s_barrier
    s_lshl_b32 s36, s34, 2
    s_add_u32 s36, s36, s20
    s_mul_i32 s38, s36, 52429
    s_lshr_b32 s38, s38, 18
    s_mul_i32 s39, s38, 5
    s_sub_u32 s39, s36, s39
    s_mul_i32 s37, s38, 280
    s_mul_i32 s40, s33, 45
    s_add_u32 s37, s37, s40
    s_add_u32 s37, s37, s39
    s_lshl_b32 s37, s37, 10
    s_add_u32 s37, s37, 6696960
    s_waitcnt vmcnt(17)
    ds_write_b128 v5, v[72:75] offset:0
    s_waitcnt vmcnt(16)
    ds_write_b128 v5, v[76:79] offset:4608
    s_waitcnt vmcnt(15)
    ds_write_b128 v5, v[80:83] offset:9216
    s_waitcnt vmcnt(14)
    ds_write_b128 v5, v[84:87] offset:13824
    s_waitcnt vmcnt(13)
    ds_write_b128 v5, v[88:91] offset:18432
    s_waitcnt vmcnt(12)
    ds_write_b128 v5, v[92:95] offset:23040
    s_waitcnt vmcnt(11)
    ds_write_b128 v5, v[96:99] offset:27648
    s_waitcnt vmcnt(10)
    ds_write_b128 v5, v[100:103] offset:32256
    s_waitcnt vmcnt(9)
    ds_write_b128 v5, v[104:107] offset:36864
    s_waitcnt lgkmcnt(0)
    s_barrier
    ds_read_b64_tr_b16 v[72:73], v8 offset:0
    ds_read_b64_tr_b16 v[74:75], v8 offset:576
    ds_read_b64_tr_b16 v[76:77], v8 offset:4608
    ds_read_b64_tr_b16 v[78:79], v8 offset:5184
    ds_read_b64_tr_b16 v[80:81], v8 offset:9216
    ds_read_b64_tr_b16 v[82:83], v8 offset:9792
    ds_read_b64_tr_b16 v[84:85], v8 offset:13824
    ds_read_b64_tr_b16 v[86:87], v8 offset:14400
    ds_read_b64_tr_b16 v[88:89], v8 offset:18432
    ds_read_b64_tr_b16 v[90:91], v8 offset:19008
    ds_read_b64_tr_b16 v[92:93], v8 offset:23040
    ds_read_b64_tr_b16 v[94:95], v8 offset:23616
    ds_read_b64_tr_b16 v[96:97], v8 offset:27648
    ds_read_b64_tr_b16 v[98:99], v8 offset:28224
    ds_read_b64_tr_b16 v[100:101], v8 offset:32256
    ds_read_b64_tr_b16 v[102:103], v8 offset:32832
    ds_read_b64_tr_b16 v[104:105], v8 offset:36864
    ds_read_b64_tr_b16 v[106:107], v8 offset:37440
    s_waitcnt lgkmcnt(15)
    s_add_u32 s38, s37, 0
    buffer_store_dwordx4 v[72:75], v9, s[28:31], s38 offen sc1
    s_waitcnt lgkmcnt(14)
    s_add_u32 s38, s37, 5120
    buffer_store_dwordx4 v[76:79], v9, s[28:31], s38 offen sc1
    s_waitcnt lgkmcnt(12)
    s_add_u32 s38, s37, 10240
    buffer_store_dwordx4 v[80:83], v9, s[28:31], s38 offen sc1
    s_waitcnt lgkmcnt(10)
    s_add_u32 s38, s37, 15360
    buffer_store_dwordx4 v[84:87], v9, s[28:31], s38 offen sc1
    s_waitcnt lgkmcnt(8)
    s_add_u32 s38, s37, 20480
    buffer_store_dwordx4 v[88:91], v9, s[28:31], s38 offen sc1
    s_waitcnt lgkmcnt(6)
    s_add_u32 s38, s37, 25600
    buffer_store_dwordx4 v[92:95], v9, s[28:31], s38 offen sc1
    s_waitcnt lgkmcnt(4)
    s_add_u32 s38, s37, 30720
    buffer_store_dwordx4 v[96:99], v9, s[28:31], s38 offen sc1
    s_waitcnt lgkmcnt(2)
    s_add_u32 s38, s37, 35840
    buffer_store_dwordx4 v[100:103], v9, s[28:31], s38 offen sc1
    s_waitcnt lgkmcnt(0)
    s_add_u32 s38, s37, 40960
    buffer_store_dwordx4 v[104:107], v9, s[28:31], s38 offen sc1
    s_endpgm
k1_kernel_pke20:
    s_endpgm
k1_mod0:
    s_sub_u32 s54, s54, 128
    s_waitcnt lgkmcnt(0)
    s_mov_b32 s28, s10
    s_mov_b32 s29, s11
    s_mov_b32 s30, 268435456
    s_mov_b32 s31, 0x00020000
k1_modf:
    s_load_dwordx4 s[12:15], s[0:1], 88
    s_mov_b32 s32, s54
    v_and_b32 v3, 7, v0
    v_lshrrev_b32 v4, 3, v0
    v_lshlrev_b32 v5, 1, v4
    v_mul_u32_u24 v6, 7680, v4
    s_lshl_b32 s36, s32, 7
    v_lshl_add_u32 v7, v3, 4, s36
    v_add_u32 v6, v6, v7
    s_waitcnt lgkmcnt(0)
    s_mov_b32 s16, s12
    s_mov_b32 s17, s13
    s_mov_b32 s18, 1280
    s_mov_b32 s19, 0x00020000
    s_mov_b32 s20, s14
    s_mov_b32 s21, s15
    s_mov_b32 s22, 4915200
    s_mov_b32 s23, 0x00020000
    buffer_load_ushort v10, v5, s[16:19], 0 offen offset:0
    buffer_load_ushort v11, v5, s[16:19], 0 offen offset:64
    buffer_load_ushort v12, v5, s[16:19], 0 offen offset:128
    buffer_load_ushort v13, v5, s[16:19], 0 offen offset:192
    buffer_load_ushort v14, v5, s[16:19], 0 offen offset:256
    buffer_load_ushort v15, v5, s[16:19], 0 offen offset:320
    buffer_load_ushort v16, v5, s[16:19], 0 offen offset:384
    buffer_load_ushort v17, v5, s[16:19], 0 offen offset:448
    buffer_load_ushort v18, v5, s[16:19], 0 offen offset:512
    buffer_load_ushort v19, v5, s[16:19], 0 offen offset:576
    buffer_load_ushort v20, v5, s[16:19], 0 offen offset:640
    buffer_load_ushort v21, v5, s[16:19], 0 offen offset:704
    buffer_load_ushort v22, v5, s[16:19], 0 offen offset:768
    buffer_load_ushort v23, v5, s[16:19], 0 offen offset:832
    buffer_load_ushort v24, v5, s[16:19], 0 offen offset:896
    buffer_load_ushort v25, v5, s[16:19], 0 offen offset:960
    buffer_load_ushort v26, v5, s[16:19], 0 offen offset:1024
    buffer_load_ushort v27, v5, s[16:19], 0 offen offset:1088
    buffer_load_ushort v28, v5, s[16:19], 0 offen offset:1152
    buffer_load_ushort v29, v5, s[16:19], 0 offen offset:1216
    s_mov_b32 s37, 0
    buffer_load_dwordx4 v[32:35], v6, s[20:23], s37 offen
    s_mov_b32 s37, 245760
    buffer_load_dwordx4 v[36:39], v6, s[20:23], s37 offen
    s_mov_b32 s37, 491520
    buffer_load_dwordx4 v[40:43], v6, s[20:23], s37 offen
    s_mov_b32 s37, 737280
    buffer_load_dwordx4 v[44:47], v6, s[20:23], s37 offen
    s_mov_b32 s37, 983040
    buffer_load_dwordx4 v[48:51], v6, s[20:23], s37 offen
    s_mov_b32 s37, 1228800
    buffer_load_dwordx4 v[52:55], v6, s[20:23], s37 offen
    s_mov_b32 s37, 1474560
    buffer_load_dwordx4 v[56:59], v6, s[20:23], s37 offen
    s_mov_b32 s37, 1720320
    buffer_load_dwordx4 v[60:63], v6, s[20:23], s37 offen
    s_mov_b32 s37, 1966080
    buffer_load_dwordx4 v[64:67], v6, s[20:23], s37 offen
    s_mov_b32 s37, 2211840
    buffer_load_dwordx4 v[68:71], v6, s[20:23], s37 offen
    s_mov_b32 s37, 2457600
    buffer_load_dwordx4 v[72:75], v6, s[20:23], s37 offen
    s_mov_b32 s37, 2703360
    buffer_load_dwordx4 v[76:79], v6, s[20:23], s37 offen
    s_mov_b32 s37, 2949120
    buffer_load_dwordx4 v[80:83], v6, s[20:23], s37 offen
    s_mov_b32 s37, 3194880
    buffer_load_dwordx4 v[84:87], v6, s[20:23], s37 offen
    s_mov_b32 s37, 3440640
    buffer_load_dwordx4 v[88:91], v6, s[20:23], s37 offen
    s_mov_b32 s37, 3686400
    buffer_load_dwordx4 v[92:95], v6, s[20:23], s37 offen
    s_mov_b32 s37, 3932160
    buffer_load_dwordx4 v[96:99], v6, s[20:23], s37 offen
    s_mov_b32 s37, 4177920
    buffer_load_dwordx4 v[100:103], v6, s[20:23], s37 offen
    s_mov_b32 s37, 4423680
    buffer_load_dwordx4 v[104:107], v6, s[20:23], s37 offen
    s_mov_b32 s37, 4669440
    buffer_load_dwordx4 v[108:111], v6, s[20:23], s37 offen
    s_waitcnt vmcnt(20)
    v_lshlrev_b32 v10, 16, v10
    v_mul_f32 v120, 0xbfb8aa3b, v10
    v_exp_f32 v120, v120
    v_lshlrev_b32 v11, 16, v11
    v_mul_f32 v121, 0xbfb8aa3b, v11
    v_exp_f32 v121, v121
    v_lshlrev_b32 v12, 16, v12
    v_mul_f32 v122, 0xbfb8aa3b, v12
    v_exp_f32 v122, v122
    v_lshlrev_b32 v13, 16, v13
    v_mul_f32 v123, 0xbfb8aa3b, v13
    v_exp_f32 v123, v123
    v_lshlrev_b32 v14, 16, v14
    v_mul_f32 v124, 0xbfb8aa3b, v14
    v_exp_f32 v124, v124
    v_lshlrev_b32 v15, 16, v15
    v_mul_f32 v125, 0xbfb8aa3b, v15
    v_exp_f32 v125, v125
    v_lshlrev_b32 v16, 16, v16
    v_mul_f32 v126, 0xbfb8aa3b, v16
    v_exp_f32 v126, v126
    v_lshlrev_b32 v17, 16, v17
    v_mul_f32 v127, 0xbfb8aa3b, v17
    v_exp_f32 v127, v127
    v_lshlrev_b32 v18, 16, v18
    v_mul_f32 v128, 0xbfb8aa3b, v18
    v_exp_f32 v128, v128
    v_lshlrev_b32 v19, 16, v19
    v_mul_f32 v129, 0xbfb8aa3b, v19
    v_exp_f32 v129, v129
    v_lshlrev_b32 v20, 16, v20
    v_mul_f32 v130, 0xbfb8aa3b, v20
    v_exp_f32 v130, v130
    v_lshlrev_b32 v21, 16, v21
    v_mul_f32 v131, 0xbfb8aa3b, v21
    v_exp_f32 v131, v131
    v_lshlrev_b32 v22, 16, v22
    v_mul_f32 v132, 0xbfb8aa3b, v22
    v_exp_f32 v132, v132
    v_lshlrev_b32 v23, 16, v23
    v_mul_f32 v133, 0xbfb8aa3b, v23
    v_exp_f32 v133, v133
    v_lshlrev_b32 v24, 16, v24
    v_mul_f32 v134, 0xbfb8aa3b, v24
    v_exp_f32 v134, v134
    v_lshlrev_b32 v25, 16, v25
    v_mul_f32 v135, 0xbfb8aa3b, v25
    v_exp_f32 v135, v135
    v_lshlrev_b32 v26, 16, v26
    v_mul_f32 v136, 0xbfb8aa3b, v26
    v_exp_f32 v136, v136
    v_lshlrev_b32 v27, 16, v27
    v_mul_f32 v137, 0xbfb8aa3b, v27
    v_exp_f32 v137, v137
    v_lshlrev_b32 v28, 16, v28
    v_mul_f32 v138, 0xbfb8aa3b, v28
    v_exp_f32 v138, v138
    v_lshlrev_b32 v29, 16, v29
    v_mul_f32 v139, 0xbfb8aa3b, v29
    v_exp_f32 v139, v139
    v_add_f32 v120, 1.0, v120
    v_rcp_f32 v120, v120
    v_add_f32 v121, 1.0, v121
    v_rcp_f32 v121, v121
    v_add_f32 v122, 1.0, v122
    v_rcp_f32 v122, v122
    v_add_f32 v123, 1.0, v123
    v_rcp_f32 v123, v123
    v_add_f32 v124, 1.0, v124
    v_rcp_f32 v124, v124
    v_add_f32 v125, 1.0, v125
    v_rcp_f32 v125, v125
    v_add_f32 v126, 1.0, v126
    v_rcp_f32 v126, v126
    v_add_f32 v127, 1.0, v127
    v_rcp_f32 v127, v127
    v_add_f32 v128, 1.0, v128
    v_rcp_f32 v128, v128
    v_add_f32 v129, 1.0, v129
    v_rcp_f32 v129, v129
    v_add_f32 v130, 1.0, v130
    v_rcp_f32 v130, v130
    v_add_f32 v131, 1.0, v131
    v_rcp_f32 v131, v131
    v_add_f32 v132, 1.0, v132
    v_rcp_f32 v132, v132
    v_add_f32 v133, 1.0, v133
    v_rcp_f32 v133, v133
    v_add_f32 v134, 1.0, v134
    v_rcp_f32 v134, v134
    v_add_f32 v135, 1.0, v135
    v_rcp_f32 v135, v135
    v_add_f32 v136, 1.0, v136
    v_rcp_f32 v136, v136
    v_add_f32 v137, 1.0, v137
    v_rcp_f32 v137, v137
    v_add_f32 v138, 1.0, v138
    v_rcp_f32 v138, v138
    v_add_f32 v139, 1.0, v139
    v_rcp_f32 v139, v139
    s_nop 0
    v_mul_f32 v10, v10, v120
    v_mul_f32 v11, v11, v121
    v_mul_f32 v12, v12, v122
    v_mul_f32 v13, v13, v123
    v_mul_f32 v14, v14, v124
    v_mul_f32 v15, v15, v125
    v_mul_f32 v16, v16, v126
    v_mul_f32 v17, v17, v127
    v_mul_f32 v18, v18, v128
    v_mul_f32 v19, v19, v129
    v_mul_f32 v20, v20, v130
    v_mul_f32 v21, v21, v131
    v_mul_f32 v22, v22, v132
    v_mul_f32 v23, v23, v133
    v_mul_f32 v24, v24, v134
    v_mul_f32 v25, v25, v135
    v_mul_f32 v26, v26, v136
    v_mul_f32 v27, v27, v137
    v_mul_f32 v28, v28, v138
    v_mul_f32 v29, v29, v139
    v_cvt_pk_bf16_f32 v120, v10, v11
    v_lshlrev_b32 v10, 16, v120
    v_and_b32 v11, 0xffff0000, v120
    v_cvt_pk_bf16_f32 v120, v12, v13
    v_lshlrev_b32 v12, 16, v120
    v_and_b32 v13, 0xffff0000, v120
    v_cvt_pk_bf16_f32 v120, v14, v15
    v_lshlrev_b32 v14, 16, v120
    v_and_b32 v15, 0xffff0000, v120
    v_cvt_pk_bf16_f32 v120, v16, v17
    v_lshlrev_b32 v16, 16, v120
    v_and_b32 v17, 0xffff0000, v120
    v_cvt_pk_bf16_f32 v120, v18, v19
    v_lshlrev_b32 v18, 16, v120
    v_and_b32 v19, 0xffff0000, v120
    v_cvt_pk_bf16_f32 v120, v20, v21
    v_lshlrev_b32 v20, 16, v120
    v_and_b32 v21, 0xffff0000, v120
    v_cvt_pk_bf16_f32 v120, v22, v23
    v_lshlrev_b32 v22, 16, v120
    v_and_b32 v23, 0xffff0000, v120
    v_cvt_pk_bf16_f32 v120, v24, v25
    v_lshlrev_b32 v24, 16, v120
    v_and_b32 v25, 0xffff0000, v120
    v_cvt_pk_bf16_f32 v120, v26, v27
    v_lshlrev_b32 v26, 16, v120
    v_and_b32 v27, 0xffff0000, v120
    v_cvt_pk_bf16_f32 v120, v28, v29
    v_lshlrev_b32 v28, 16, v120
    v_and_b32 v29, 0xffff0000, v120
    v_mov_b32 v112, 0
    v_mov_b32 v113, 0
    v_mov_b32 v114, 0
    v_mov_b32 v115, 0
    v_mov_b32 v116, 0
    v_mov_b32 v117, 0
    v_mov_b32 v118, 0
    v_mov_b32 v119, 0
    s_waitcnt vmcnt(19)
    v_lshlrev_b32 v120, 16, v32
    v_and_b32 v121, 0xffff0000, v32
    v_lshlrev_b32 v122, 16, v33
    v_and_b32 v123, 0xffff0000, v33
    v_lshlrev_b32 v124, 16, v34
    v_and_b32 v125, 0xffff0000, v34
    v_lshlrev_b32 v126, 16, v35
    v_and_b32 v127, 0xffff0000, v35
    v_pk_fma_f32 v[112:113], v[120:121], v[10:11], v[112:113] op_sel:[0,0,0] op_sel_hi:[1,0,1]
    v_pk_fma_f32 v[114:115], v[122:123], v[10:11], v[114:115] op_sel:[0,0,0] op_sel_hi:[1,0,1]
    v_pk_fma_f32 v[116:117], v[124:125], v[10:11], v[116:117] op_sel:[0,0,0] op_sel_hi:[1,0,1]
    v_pk_fma_f32 v[118:119], v[126:127], v[10:11], v[118:119] op_sel:[0,0,0] op_sel_hi:[1,0,1]
    s_waitcnt vmcnt(18)
    v_lshlrev_b32 v120, 16, v36
    v_and_b32 v121, 0xffff0000, v36
    v_lshlrev_b32 v122, 16, v37
    v_and_b32 v123, 0xffff0000, v37
    v_lshlrev_b32 v124, 16, v38
    v_and_b32 v125, 0xffff0000, v38
    v_lshlrev_b32 v126, 16, v39
    v_and_b32 v127, 0xffff0000, v39
    v_pk_fma_f32 v[112:113], v[120:121], v[10:11], v[112:113] op_sel:[0,1,0] op_sel_hi:[1,1,1]
    v_pk_fma_f32 v[114:115], v[122:123], v[10:11], v[114:115] op_sel:[0,1,0] op_sel_hi:[1,1,1]
    v_pk_fma_f32 v[116:117], v[124:125], v[10:11], v[116:117] op_sel:[0,1,0] op_sel_hi:[1,1,1]
    v_pk_fma_f32 v[118:119], v[126:127], v[10:11], v[118:119] op_sel:[0,1,0] op_sel_hi:[1,1,1]
    s_waitcnt vmcnt(17)
    v_lshlrev_b32 v120, 16, v40
    v_and_b32 v121, 0xffff0000, v40
    v_lshlrev_b32 v122, 16, v41
    v_and_b32 v123, 0xffff0000, v41
    v_lshlrev_b32 v124, 16, v42
    v_and_b32 v125, 0xffff0000, v42
    v_lshlrev_b32 v126, 16, v43
    v_and_b32 v127, 0xffff0000, v43
    v_pk_fma_f32 v[112:113], v[120:121], v[12:13], v[112:113] op_sel:[0,0,0] op_sel_hi:[1,0,1]
    v_pk_fma_f32 v[114:115], v[122:123], v[12:13], v[114:115] op_sel:[0,0,0] op_sel_hi:[1,0,1]
    v_pk_fma_f32 v[116:117], v[124:125], v[12:13], v[116:117] op_sel:[0,0,0] op_sel_hi:[1,0,1]
    v_pk_fma_f32 v[118:119], v[126:127], v[12:13], v[118:119] op_sel:[0,0,0] op_sel_hi:[1,0,1]
    s_waitcnt vmcnt(16)
    v_lshlrev_b32 v120, 16, v44
    v_and_b32 v121, 0xffff0000, v44
    v_lshlrev_b32 v122, 16, v45
    v_and_b32 v123, 0xffff0000, v45
    v_lshlrev_b32 v124, 16, v46
    v_and_b32 v125, 0xffff0000, v46
    v_lshlrev_b32 v126, 16, v47
    v_and_b32 v127, 0xffff0000, v47
    v_pk_fma_f32 v[112:113], v[120:121], v[12:13], v[112:113] op_sel:[0,1,0] op_sel_hi:[1,1,1]
    v_pk_fma_f32 v[114:115], v[122:123], v[12:13], v[114:115] op_sel:[0,1,0] op_sel_hi:[1,1,1]
    v_pk_fma_f32 v[116:117], v[124:125], v[12:13], v[116:117] op_sel:[0,1,0] op_sel_hi:[1,1,1]
    v_pk_fma_f32 v[118:119], v[126:127], v[12:13], v[118:119] op_sel:[0,1,0] op_sel_hi:[1,1,1]
    s_waitcnt vmcnt(15)
    v_lshlrev_b32 v120, 16, v48
    v_and_b32 v121, 0xffff0000, v48
    v_lshlrev_b32 v122, 16, v49
    v_and_b32 v123, 0xffff0000, v49
    v_lshlrev_b32 v124, 16, v50
    v_and_b32 v125, 0xffff0000, v50
    v_lshlrev_b32 v126, 16, v51
    v_and_b32 v127, 0xffff0000, v51
    v_pk_fma_f32 v[112:113], v[120:121], v[14:15], v[112:113] op_sel:[0,0,0] op_sel_hi:[1,0,1]
    v_pk_fma_f32 v[114:115], v[122:123], v[14:15], v[114:115] op_sel:[0,0,0] op_sel_hi:[1,0,1]
    v_pk_fma_f32 v[116:117], v[124:125], v[14:15], v[116:117] op_sel:[0,0,0] op_sel_hi:[1,0,1]
    v_pk_fma_f32 v[118:119], v[126:127], v[14:15], v[118:119] op_sel:[0,0,0] op_sel_hi:[1,0,1]
    s_waitcnt vmcnt(14)
    v_lshlrev_b32 v120, 16, v52
    v_and_b32 v121, 0xffff0000, v52
    v_lshlrev_b32 v122, 16, v53
    v_and_b32 v123, 0xffff0000, v53
    v_lshlrev_b32 v124, 16, v54
    v_and_b32 v125, 0xffff0000, v54
    v_lshlrev_b32 v126, 16, v55
    v_and_b32 v127, 0xffff0000, v55
    v_pk_fma_f32 v[112:113], v[120:121], v[14:15], v[112:113] op_sel:[0,1,0] op_sel_hi:[1,1,1]
    v_pk_fma_f32 v[114:115], v[122:123], v[14:15], v[114:115] op_sel:[0,1,0] op_sel_hi:[1,1,1]
    v_pk_fma_f32 v[116:117], v[124:125], v[14:15], v[116:117] op_sel:[0,1,0] op_sel_hi:[1,1,1]
    v_pk_fma_f32 v[118:119], v[126:127], v[14:15], v[118:119] op_sel:[0,1,0] op_sel_hi:[1,1,1]
    s_waitcnt vmcnt(13)
    v_lshlrev_b32 v120, 16, v56
    v_and_b32 v121, 0xffff0000, v56
    v_lshlrev_b32 v122, 16, v57
    v_and_b32 v123, 0xffff0000, v57
    v_lshlrev_b32 v124, 16, v58
    v_and_b32 v125, 0xffff0000, v58
    v_lshlrev_b32 v126, 16, v59
    v_and_b32 v127, 0xffff0000, v59
    v_pk_fma_f32 v[112:113], v[120:121], v[16:17], v[112:113] op_sel:[0,0,0] op_sel_hi:[1,0,1]
    v_pk_fma_f32 v[114:115], v[122:123], v[16:17], v[114:115] op_sel:[0,0,0] op_sel_hi:[1,0,1]
    v_pk_fma_f32 v[116:117], v[124:125], v[16:17], v[116:117] op_sel:[0,0,0] op_sel_hi:[1,0,1]
    v_pk_fma_f32 v[118:119], v[126:127], v[16:17], v[118:119] op_sel:[0,0,0] op_sel_hi:[1,0,1]
    s_waitcnt vmcnt(12)
    v_lshlrev_b32 v120, 16, v60
    v_and_b32 v121, 0xffff0000, v60
    v_lshlrev_b32 v122, 16, v61
    v_and_b32 v123, 0xffff0000, v61
    v_lshlrev_b32 v124, 16, v62
    v_and_b32 v125, 0xffff0000, v62
    v_lshlrev_b32 v126, 16, v63
    v_and_b32 v127, 0xffff0000, v63
    v_pk_fma_f32 v[112:113], v[120:121], v[16:17], v[112:113] op_sel:[0,1,0] op_sel_hi:[1,1,1]
    v_pk_fma_f32 v[114:115], v[122:123], v[16:17], v[114:115] op_sel:[0,1,0] op_sel_hi:[1,1,1]
    v_pk_fma_f32 v[116:117], v[124:125], v[16:17], v[116:117] op_sel:[0,1,0] op_sel_hi:[1,1,1]
    v_pk_fma_f32 v[118:119], v[126:127], v[16:17], v[118:119] op_sel:[0,1,0] op_sel_hi:[1,1,1]
    s_waitcnt vmcnt(11)
    v_lshlrev_b32 v120, 16, v64
    v_and_b32 v121, 0xffff0000, v64
    v_lshlrev_b32 v122, 16, v65
    v_and_b32 v123, 0xffff0000, v65
    v_lshlrev_b32 v124, 16, v66
    v_and_b32 v125, 0xffff0000, v66
    v_lshlrev_b32 v126, 16, v67
    v_and_b32 v127, 0xffff0000, v67
    v_pk_fma_f32 v[112:113], v[120:121], v[18:19], v[112:113] op_sel:[0,0,0] op_sel_hi:[1,0,1]
    v_pk_fma_f32 v[114:115], v[122:123], v[18:19], v[114:115] op_sel:[0,0,0] op_sel_hi:[1,0,1]
    v_pk_fma_f32 v[116:117], v[124:125], v[18:19], v[116:117] op_sel:[0,0,0] op_sel_hi:[1,0,1]
    v_pk_fma_f32 v[118:119], v[126:127], v[18:19], v[118:119] op_sel:[0,0,0] op_sel_hi:[1,0,1]
    s_waitcnt vmcnt(10)
    v_lshlrev_b32 v120, 16, v68
    v_and_b32 v121, 0xffff0000, v68
    v_lshlrev_b32 v122, 16, v69
    v_and_b32 v123, 0xffff0000, v69
    v_lshlrev_b32 v124, 16, v70
    v_and_b32 v125, 0xffff0000, v70
    v_lshlrev_b32 v126, 16, v71
    v_and_b32 v127, 0xffff0000, v71
    v_pk_fma_f32 v[112:113], v[120:121], v[18:19], v[112:113] op_sel:[0,1,0] op_sel_hi:[1,1,1]
    v_pk_fma_f32 v[114:115], v[122:123], v[18:19], v[114:115] op_sel:[0,1,0] op_sel_hi:[1,1,1]
    v_pk_fma_f32 v[116:117], v[124:125], v[18:19], v[116:117] op_sel:[0,1,0] op_sel_hi:[1,1,1]
    v_pk_fma_f32 v[118:119], v[126:127], v[18:19], v[118:119] op_sel:[0,1,0] op_sel_hi:[1,1,1]
    s_waitcnt vmcnt(9)
    v_lshlrev_b32 v120, 16, v72
    v_and_b32 v121, 0xffff0000, v72
    v_lshlrev_b32 v122, 16, v73
    v_and_b32 v123, 0xffff0000, v73
    v_lshlrev_b32 v124, 16, v74
    v_and_b32 v125, 0xffff0000, v74
    v_lshlrev_b32 v126, 16, v75
    v_and_b32 v127, 0xffff0000, v75
    v_pk_fma_f32 v[112:113], v[120:121], v[20:21], v[112:113] op_sel:[0,0,0] op_sel_hi:[1,0,1]
    v_pk_fma_f32 v[114:115], v[122:123], v[20:21], v[114:115] op_sel:[0,0,0] op_sel_hi:[1,0,1]
    v_pk_fma_f32 v[116:117], v[124:125], v[20:21], v[116:117] op_sel:[0,0,0] op_sel_hi:[1,0,1]
    v_pk_fma_f32 v[118:119], v[126:127], v[20:21], v[118:119] op_sel:[0,0,0] op_sel_hi:[1,0,1]
    s_waitcnt vmcnt(8)
    v_lshlrev_b32 v120, 16, v76
    v_and_b32 v121, 0xffff0000, v76
    v_lshlrev_b32 v122, 16, v77
    v_and_b32 v123, 0xffff0000, v77
    v_lshlrev_b32 v124, 16, v78
    v_and_b32 v125, 0xffff0000, v78
    v_lshlrev_b32 v126, 16, v79
    v_and_b32 v127, 0xffff0000, v79
    v_pk_fma_f32 v[112:113], v[120:121], v[20:21], v[112:113] op_sel:[0,1,0] op_sel_hi:[1,1,1]
    v_pk_fma_f32 v[114:115], v[122:123], v[20:21], v[114:115] op_sel:[0,1,0] op_sel_hi:[1,1,1]
    v_pk_fma_f32 v[116:117], v[124:125], v[20:21], v[116:117] op_sel:[0,1,0] op_sel_hi:[1,1,1]
    v_pk_fma_f32 v[118:119], v[126:127], v[20:21], v[118:119] op_sel:[0,1,0] op_sel_hi:[1,1,1]
    s_waitcnt vmcnt(7)
    v_lshlrev_b32 v120, 16, v80
    v_and_b32 v121, 0xffff0000, v80
    v_lshlrev_b32 v122, 16, v81
    v_and_b32 v123, 0xffff0000, v81
    v_lshlrev_b32 v124, 16, v82
    v_and_b32 v125, 0xffff0000, v82
    v_lshlrev_b32 v126, 16, v83
    v_and_b32 v127, 0xffff0000, v83
    v_pk_fma_f32 v[112:113], v[120:121], v[22:23], v[112:113] op_sel:[0,0,0] op_sel_hi:[1,0,1]
    v_pk_fma_f32 v[114:115], v[122:123], v[22:23], v[114:115] op_sel:[0,0,0] op_sel_hi:[1,0,1]
    v_pk_fma_f32 v[116:117], v[124:125], v[22:23], v[116:117] op_sel:[0,0,0] op_sel_hi:[1,0,1]
    v_pk_fma_f32 v[118:119], v[126:127], v[22:23], v[118:119] op_sel:[0,0,0] op_sel_hi:[1,0,1]
    s_waitcnt vmcnt(6)
    v_lshlrev_b32 v120, 16, v84
    v_and_b32 v121, 0xffff0000, v84
    v_lshlrev_b32 v122, 16, v85
    v_and_b32 v123, 0xffff0000, v85
    v_lshlrev_b32 v124, 16, v86
    v_and_b32 v125, 0xffff0000, v86
    v_lshlrev_b32 v126, 16, v87
    v_and_b32 v127, 0xffff0000, v87
    v_pk_fma_f32 v[112:113], v[120:121], v[22:23], v[112:113] op_sel:[0,1,0] op_sel_hi:[1,1,1]
    v_pk_fma_f32 v[114:115], v[122:123], v[22:23], v[114:115] op_sel:[0,1,0] op_sel_hi:[1,1,1]
    v_pk_fma_f32 v[116:117], v[124:125], v[22:23], v[116:117] op_sel:[0,1,0] op_sel_hi:[1,1,1]
    v_pk_fma_f32 v[118:119], v[126:127], v[22:23], v[118:119] op_sel:[0,1,0] op_sel_hi:[1,1,1]
    s_waitcnt vmcnt(5)
    v_lshlrev_b32 v120, 16, v88
    v_and_b32 v121, 0xffff0000, v88
    v_lshlrev_b32 v122, 16, v89
    v_and_b32 v123, 0xffff0000, v89
    v_lshlrev_b32 v124, 16, v90
    v_and_b32 v125, 0xffff0000, v90
    v_lshlrev_b32 v126, 16, v91
    v_and_b32 v127, 0xffff0000, v91
    v_pk_fma_f32 v[112:113], v[120:121], v[24:25], v[112:113] op_sel:[0,0,0] op_sel_hi:[1,0,1]
    v_pk_fma_f32 v[114:115], v[122:123], v[24:25], v[114:115] op_sel:[0,0,0] op_sel_hi:[1,0,1]
    v_pk_fma_f32 v[116:117], v[124:125], v[24:25], v[116:117] op_sel:[0,0,0] op_sel_hi:[1,0,1]
    v_pk_fma_f32 v[118:119], v[126:127], v[24:25], v[118:119] op_sel:[0,0,0] op_sel_hi:[1,0,1]
    s_waitcnt vmcnt(4)
    v_lshlrev_b32 v120, 16, v92
    v_and_b32 v121, 0xffff0000, v92
    v_lshlrev_b32 v122, 16, v93
    v_and_b32 v123, 0xffff0000, v93
    v_lshlrev_b32 v124, 16, v94
    v_and_b32 v125, 0xffff0000, v94
    v_lshlrev_b32 v126, 16, v95
    v_and_b32 v127, 0xffff0000, v95
    v_pk_fma_f32 v[112:113], v[120:121], v[24:25], v[112:113] op_sel:[0,1,0] op_sel_hi:[1,1,1]
    v_pk_fma_f32 v[114:115], v[122:123], v[24:25], v[114:115] op_sel:[0,1,0] op_sel_hi:[1,1,1]
    v_pk_fma_f32 v[116:117], v[124:125], v[24:25], v[116:117] op_sel:[0,1,0] op_sel_hi:[1,1,1]
    v_pk_fma_f32 v[118:119], v[126:127], v[24:25], v[118:119] op_sel:[0,1,0] op_sel_hi:[1,1,1]
    s_waitcnt vmcnt(3)
    v_lshlrev_b32 v120, 16, v96
    v_and_b32 v121, 0xffff0000, v96
    v_lshlrev_b32 v122, 16, v97
    v_and_b32 v123, 0xffff0000, v97
    v_lshlrev_b32 v124, 16, v98
    v_and_b32 v125, 0xffff0000, v98
    v_lshlrev_b32 v126, 16, v99
    v_and_b32 v127, 0xffff0000, v99
    v_pk_fma_f32 v[112:113], v[120:121], v[26:27], v[112:113] op_sel:[0,0,0] op_sel_hi:[1,0,1]
    v_pk_fma_f32 v[114:115], v[122:123], v[26:27], v[114:115] op_sel:[0,0,0] op_sel_hi:[1,0,1]
    v_pk_fma_f32 v[116:117], v[124:125], v[26:27], v[116:117] op_sel:[0,0,0] op_sel_hi:[1,0,1]
    v_pk_fma_f32 v[118:119], v[126:127], v[26:27], v[118:119] op_sel:[0,0,0] op_sel_hi:[1,0,1]
    s_waitcnt vmcnt(2)
    v_lshlrev_b32 v120, 16, v100
    v_and_b32 v121, 0xffff0000, v100
    v_lshlrev_b32 v122, 16, v101
    v_and_b32 v123, 0xffff0000, v101
    v_lshlrev_b32 v124, 16, v102
    v_and_b32 v125, 0xffff0000, v102
    v_lshlrev_b32 v126, 16, v103
    v_and_b32 v127, 0xffff0000, v103
    v_pk_fma_f32 v[112:113], v[120:121], v[26:27], v[112:113] op_sel:[0,1,0] op_sel_hi:[1,1,1]
    v_pk_fma_f32 v[114:115], v[122:123], v[26:27], v[114:115] op_sel:[0,1,0] op_sel_hi:[1,1,1]
    v_pk_fma_f32 v[116:117], v[124:125], v[26:27], v[116:117] op_sel:[0,1,0] op_sel_hi:[1,1,1]
    v_pk_fma_f32 v[118:119], v[126:127], v[26:27], v[118:119] op_sel:[0,1,0] op_sel_hi:[1,1,1]
    s_waitcnt vmcnt(1)
    v_lshlrev_b32 v120, 16, v104
    v_and_b32 v121, 0xffff0000, v104
    v_lshlrev_b32 v122, 16, v105
    v_and_b32 v123, 0xffff0000, v105
    v_lshlrev_b32 v124, 16, v106
    v_and_b32 v125, 0xffff0000, v106
    v_lshlrev_b32 v126, 16, v107
    v_and_b32 v127, 0xffff0000, v107
    v_pk_fma_f32 v[112:113], v[120:121], v[28:29], v[112:113] op_sel:[0,0,0] op_sel_hi:[1,0,1]
    v_pk_fma_f32 v[114:115], v[122:123], v[28:29], v[114:115] op_sel:[0,0,0] op_sel_hi:[1,0,1]
    v_pk_fma_f32 v[116:117], v[124:125], v[28:29], v[116:117] op_sel:[0,0,0] op_sel_hi:[1,0,1]
    v_pk_fma_f32 v[118:119], v[126:127], v[28:29], v[118:119] op_sel:[0,0,0] op_sel_hi:[1,0,1]
    s_waitcnt vmcnt(0)
    v_lshlrev_b32 v120, 16, v108
    v_and_b32 v121, 0xffff0000, v108
    v_lshlrev_b32 v122, 16, v109
    v_and_b32 v123, 0xffff0000, v109
    v_lshlrev_b32 v124, 16, v110
    v_and_b32 v125, 0xffff0000, v110
    v_lshlrev_b32 v126, 16, v111
    v_and_b32 v127, 0xffff0000, v111
    v_pk_fma_f32 v[112:113], v[120:121], v[28:29], v[112:113] op_sel:[0,1,0] op_sel_hi:[1,1,1]
    v_pk_fma_f32 v[114:115], v[122:123], v[28:29], v[114:115] op_sel:[0,1,0] op_sel_hi:[1,1,1]
    v_pk_fma_f32 v[116:117], v[124:125], v[28:29], v[116:117] op_sel:[0,1,0] op_sel_hi:[1,1,1]
    v_pk_fma_f32 v[118:119], v[126:127], v[28:29], v[118:119] op_sel:[0,1,0] op_sel_hi:[1,1,1]
    v_lshlrev_b32 v7, 5, v0
    ds_write_b128 v7, v[112:115]
    ds_write_b128 v7, v[116:119] offset:16
    s_waitcnt lgkmcnt(0)
    s_barrier
    v_cmp_gt_u32 vcc, 64, v0
    s_and_saveexec_b64 s[42:43], vcc
    s_cbranch_execz k1_end
    v_lshlrev_b32 v7, 2, v0
    ds_read_b32 v32, v7 offset:0
    ds_read_b32 v33, v7 offset:256
    ds_read_b32 v34, v7 offset:512
    ds_read_b32 v35, v7 offset:768
    ds_read_b32 v36, v7 offset:1024
    ds_read_b32 v37, v7 offset:1280
    ds_read_b32 v38, v7 offset:1536
    ds_read_b32 v39, v7 offset:1792
    ds_read_b32 v40, v7 offset:2048
    ds_read_b32 v41, v7 offset:2304
    ds_read_b32 v42, v7 offset:2560
    ds_read_b32 v43, v7 offset:2816
    ds_read_b32 v44, v7 offset:3072
    ds_read_b32 v45, v7 offset:3328
    ds_read_b32 v46, v7 offset:3584
    ds_read_b32 v47, v7 offset:3840
    ds_read_b32 v48, v7 offset:4096
    ds_read_b32 v49, v7 offset:4352
    ds_read_b32 v50, v7 offset:4608
    ds_read_b32 v51, v7 offset:4864
    ds_read_b32 v52, v7 offset:5120
    ds_read_b32 v53, v7 offset:5376
    ds_read_b32 v54, v7 offset:5632
    ds_read_b32 v55, v7 offset:5888
    ds_read_b32 v56, v7 offset:6144
    ds_read_b32 v57, v7 offset:6400
    ds_read_b32 v58, v7 offset:6656
    ds_read_b32 v59, v7 offset:6912
    ds_read_b32 v60, v7 offset:7168
    ds_read_b32 v61, v7 offset:7424
    ds_read_b32 v62, v7 offset:7680
    ds_read_b32 v63, v7 offset:7936
    s_waitcnt lgkmcnt(0)
    v_add_f32 v32, v32, v48
    v_add_f32 v33, v33, v49
    v_add_f32 v34, v34, v50
    v_add_f32 v35, v35, v51
    v_add_f32 v36, v36, v52
    v_add_f32 v37, v37, v53
    v_add_f32 v38, v38, v54
    v_add_f32 v39, v39, v55
    v_add_f32 v40, v40, v56
    v_add_f32 v41, v41, v57
    v_add_f32 v42, v42, v58
    v_add_f32 v43, v43, v59
    v_add_f32 v44, v44, v60
    v_add_f32 v45, v45, v61
    v_add_f32 v46, v46, v62
    v_add_f32 v47, v47, v63
    v_add_f32 v32, v32, v40
    v_add_f32 v33, v33, v41
    v_add_f32 v34, v34, v42
    v_add_f32 v35, v35, v43
    v_add_f32 v36, v36, v44
    v_add_f32 v37, v37, v45
    v_add_f32 v38, v38, v46
    v_add_f32 v39, v39, v47
    v_add_f32 v32, v32, v36
    v_add_f32 v33, v33, v37
    v_add_f32 v34, v34, v38
    v_add_f32 v35, v35, v39
    v_add_f32 v32, v32, v34
    v_add_f32 v33, v33, v35
    v_add_f32 v32, v32, v33
    s_movk_i32 s22, 640
    v_cvt_pk_bf16_f32 v32, v32, v32
    v_lshlrev_b32 v32, 16, v32
    v_add_f32 v33, 1.0, v32
    v_cvt_pk_bf16_f32 v33, v33, v33
    v_lshlrev_b32 v33, 16, v33
    s_lshl_b32 s33, s32, 6
    v_add_u32 v34, s33, v0
    v_subrev_u32 v35, 640, v34
    v_cmp_gt_u32 vcc, 640, v35
    v_subrev_u32 v35, 2560, v34
    v_cmp_gt_u32 s[40:41], s22, v35
    s_or_b64 vcc, vcc, s[40:41]
    v_cndmask_b32 v32, v32, v33, vcc
    s_lshl_b32 s21, s32, 8
    s_add_u32 s21, s21, 2711552
    buffer_store_dword v32, v7, s[28:31], s21 offen sc1
k1_end:
    s_endpgm
k1_pf:
    s_waitcnt lgkmcnt(0)
    s_load_dwordx2 s[4:5], s[0:1], 0
    v_lshlrev_b32 v3, 7, v1
    v_lshlrev_b32 v1, 4, v1
    s_sub_u32 s24, s54, 96
    s_lshr_b32 s24, s24, 3
    s_lshl_b32 s24, s24, 2
    s_add_u32 s24, s24, s20
    s_and_b32 s22, s2, 7
    s_mul_i32 s21, s24, 20480
    s_mul_i32 s23, s22, 327680
    s_add_u32 s21, s21, s23
    s_waitcnt lgkmcnt(0)
    s_mov_b32 s16, s4
    s_mov_b32 s17, s5
    s_mov_b32 s18, 2621440
    s_mov_b32 s19, 0x00020000
    s_mov_b32 s28, s10
    s_mov_b32 s29, s11
    s_mov_b32 s30, 268435456
    s_mov_b32 s31, 0x00020000
    s_sub_u32 s36, s54, 96
    s_cmp_ge_u32 s36, 16
    s_cbranch_scc1 k1_kernel_zf21
    s_lshl_b32 s36, s36, 12
    s_add_u32 s36, s36, 8990720
    v_lshlrev_b32 v5, 4, v0
    v_mov_b32 v60, 0
    v_mov_b32 v61, 0
    v_mov_b32 v62, 0
    v_mov_b32 v63, 0
    buffer_store_dwordx4 v[60:63], v5, s[28:31], s36 offen sc1
k1_kernel_zf21:
    s_sub_u32 s36, s54, 96
    s_lshr_b32 s36, s36, 3
    s_mul_i32 s36, s36, 5120
    s_and_b32 s37, s2, 7
    s_mul_i32 s37, s37, 1601536
    s_add_u32 s36, s36, s37
    s_add_u32 s36, s36, 10641408
    v_lshlrev_b32 v5, 4, v0
    v_mov_b32 v60, 0
    v_mov_b32 v61, 0
    v_mov_b32 v62, 0
    v_mov_b32 v63, 0
    buffer_store_dwordx4 v[60:63], v5, s[28:31], s36 offen sc1
    s_add_u32 s36, s36, 4096
    s_cmp_lg_u32 s20, 0
    s_cbranch_scc1 k1_zst
    buffer_store_dwordx4 v[60:63], v5, s[28:31], s36 offen sc1
k1_zst:
    s_and_b32 s37, s2, 7
    s_cmp_eq_u32 s37, 0
    s_cselect_b32 s38, 9060352, 0
    s_cmp_eq_u32 s37, 7
    s_cselect_b32 s38, 20619264, s38
    s_cmp_eq_u32 s38, 0
    s_cbranch_scc1 k1_zht
    s_sub_u32 s36, s54, 96
    s_lshr_b32 s36, s36, 3
    s_mul_i32 s36, s36, 5120
    s_add_u32 s36, s36, s38
    buffer_store_dwordx4 v[60:63], v5, s[28:31], s36 offen sc1
    s_add_u32 s36, s36, 4096
    s_cmp_lg_u32 s20, 0
    s_cbranch_scc1 k1_zht
    buffer_store_dwordx4 v[60:63], v5, s[28:31], s36 offen sc1
k1_zht:
    s_getpc_b64 s[40:41]
k1_pcref:
    s_sub_u32 s40, s40, k1_pcref-k1_kernel
    s_subb_u32 s41, s41, 0
    s_lshl_b32 s42, s24, 12
    s_add_u32 s43, s42, 0
    s_min_u32 s43, s43, (CODE_END-k1_kernel-1020)&0xfffffff0
    v_add_u32 v6, s43, v1
    global_load_dwordx4 v[64:67], v6, s[40:41]
    s_add_u32 s43, s42, 1024
    s_min_u32 s43, s43, (CODE_END-k1_kernel-1020)&0xfffffff0
    v_add_u32 v6, s43, v1
    global_load_dwordx4 v[68:71], v6, s[40:41]
    s_add_u32 s43, s42, 2048
    s_min_u32 s43, s43, (CODE_END-k1_kernel-1020)&0xfffffff0
    v_add_u32 v6, s43, v1
    global_load_dwordx4 v[72:75], v6, s[40:41]
    s_add_u32 s43, s42, 3072
    s_min_u32 s43, s43, (CODE_END-k1_kernel-1020)&0xfffffff0
    v_add_u32 v6, s43, v1
    global_load_dwordx4 v[76:79], v6, s[40:41]
    s_mov_b32 s61, s21
    s_mov_b32 s62, s24
    s_waitcnt vmcnt(0)
    s_cmp_lg_u32 s20, 0
    s_cbranch_scc1 k1_kernel_sw23
    s_and_b32 s55, s2, 7
    s_lshl_b32 s57, s55, 9
    s_add_u32 s57, s57, 9056256
    v_mov_b32 v250, 0
    v_and_b32 v248, 31, v0
    v_lshlrev_b32 v248, 2, v248
    s_waitcnt lgkmcnt(0)
    s_mov_b32 s28, s10
    s_mov_b32 s29, s11
    s_mov_b32 s30, 268435456
    s_mov_b32 s31, 0x00020000
    buffer_load_dword v251, v250, s[28:31], s57 offen sc1
    s_mov_b32 s23, 1
    s_waitcnt vmcnt(0)
    v_add_u32 v251, 1, v251
k1_kernel_sw22:
    buffer_load_dword v249, v248, s[28:31], s57 offen offset:256 sc1
    s_waitcnt vmcnt(0)
    v_cmp_eq_u32 vcc, v251, v249
    s_sub_u32 s23, s23, 1
    s_cmp_eq_u64 vcc, -1
    s_cbranch_scc1 k1_kernel_sw23
    s_sleep 16
    s_cmp_lg_u32 s23, 0
    s_cbranch_scc1 k1_kernel_sw22
k1_kernel_sw23:
    s_barrier
    s_mov_b32 s21, s61
    s_mov_b32 s24, s62
    s_mov_b32 s28, s10
    s_mov_b32 s29, s11
    s_mov_b32 s30, 268435456
    s_mov_b32 s31, 0x00020000
    buffer_load_dwordx4 v[8:11], v1, s[16:19], s21 offen offset:0
    buffer_load_dwordx4 v[12:15], v1, s[16:19], s21 offen offset:1024
    buffer_load_dwordx4 v[16:19], v1, s[16:19], s21 offen offset:2048
    buffer_load_dwordx4 v[20:23], v1, s[16:19], s21 offen offset:3072
    s_add_u32 s21, s21, 4096
    buffer_load_dwordx4 v[24:27], v1, s[16:19], s21 offen offset:0
    buffer_load_dwordx4 v[28:31], v1, s[16:19], s21 offen offset:1024
    buffer_load_dwordx4 v[32:35], v1, s[16:19], s21 offen offset:2048
    buffer_load_dwordx4 v[36:39], v1, s[16:19], s21 offen offset:3072
    s_add_u32 s21, s21, 4096
    buffer_load_dwordx4 v[40:43], v1, s[16:19], s21 offen offset:0
    buffer_load_dwordx4 v[44:47], v1, s[16:19], s21 offen offset:1024
    buffer_load_dwordx4 v[8:11], v1, s[16:19], s21 offen offset:2048
    buffer_load_dwordx4 v[12:15], v1, s[16:19], s21 offen offset:3072
    s_add_u32 s21, s21, 4096
    buffer_load_dwordx4 v[16:19], v1, s[16:19], s21 offen offset:0
    buffer_load_dwordx4 v[20:23], v1, s[16:19], s21 offen offset:1024
    buffer_load_dwordx4 v[24:27], v1, s[16:19], s21 offen offset:2048
    buffer_load_dwordx4 v[28:31], v1, s[16:19], s21 offen offset:3072
    s_add_u32 s21, s21, 4096
    buffer_load_dwordx4 v[32:35], v1, s[16:19], s21 offen offset:0
    buffer_load_dwordx4 v[36:39], v1, s[16:19], s21 offen offset:1024
    buffer_load_dwordx4 v[40:43], v1, s[16:19], s21 offen offset:2048
    buffer_load_dwordx4 v[44:47], v1, s[16:19], s21 offen offset:3072
    s_add_u32 s21, s21, 4096
    s_mul_i32 s22, s22, 1601536
    s_add_u32 s22, s22, 9060352
    s_waitcnt vmcnt(0)
    s_endpgm
.globl k2_kernel
.p2align 8
.type k2_kernel,@function
k2_kernel:
    s_cmp_ge_u32 s2, 256
    s_cbranch_scc1 k2_end
    s_load_dwordx2 s[4:5], s[0:1], 0
    s_load_dwordx2 s[6:7], s[0:1], 104
    s_load_dwordx2 s[8:9], s[0:1], 120
    s_getreg_b32 s42, hwreg(HW_REG_XCC_ID, 0, 4)
    v_lshrrev_b32 v2, 6, v0
    v_and_b32 v1, 63, v0
    v_readfirstlane_b32 s30, v2
    s_and_b32 s28, s2, 7
    s_lshr_b32 s29, s2, 3
    s_lshr_b32 s32, s29, 3
    s_and_b32 s33, s29, 7
    s_lshr_b32 s34, s29, 4
    s_and_b32 s35, s29, 15
    s_mul_i32 s36, s28, 1601536
    s_add_u32 s36, s36, 9060352
    s_lshl_b32 s37, s28, 13
    s_add_u32 s37, s37, 8990720
    s_add_u32 s42, s42, 1
    s_mov_b32 s31, 0
    v_lshlrev_b32 v2, 4, v1
    v_lshrrev_b32 v3, 4, v1
    v_and_b32 v4, 15, v1
    v_lshrrev_b32 v8, 1, v3
    v_lshl_add_u32 v8, v8, 4, v4
    v_and_b32 v9, 1, v3
    v_lshl_add_u32 v8, v8, 1, v9
    v_lshlrev_b32 v8, 3, v8
    v_lshlrev_b32 v5, 7, v1
    v_and_b32 v9, 1, v3
    v_lshlrev_b32 v9, 1, v9
    v_lshrrev_b32 v10, 1, v3
    v_or_b32 v9, v9, v10
    v_lshlrev_b32 v9, 8, v9
    v_lshl_add_u32 v254, v4, 4, v9
    s_waitcnt lgkmcnt(0)
    s_mov_b32 s12, s8
    s_mov_b32 s13, s9
    s_mov_b32 s14, 268435456
    s_mov_b32 s15, 0x00020000
    s_mov_b32 s16, s4
    s_mov_b32 s17, s5
    s_mov_b32 s18, 2621440
    s_mov_b32 s19, 0x00020000
    s_mov_b32 s24, s6
    s_mov_b32 s25, s7
    s_mov_b32 s26, 2621440
    s_mov_b32 s27, 0x00020000
    s_cmp_lg_u32 s30, 0
    s_cbranch_scc1 k2_kernel_L1
    s_lshl_b32 s41, s29, 2
    s_add_u32 s41, s41, s37
    v_mov_b32 v9, s42
    v_mov_b32 v10, 7424
    s_mov_b64 exec, 1
    buffer_store_dword v9, v10, s[12:15], s41 offen sc1
    s_mov_b64 exec, -1
k2_kernel_L1:
    s_mul_i32 s44, s33, 102400
    s_mul_i32 s45, s35, 143360
    s_add_u32 s45, s45, 4403200
    s_mul_i32 s40, s33, 286720
    s_mul_i32 s41, s30, 71680
    s_add_u32 s40, s40, s41
    s_add_u32 s40, s40, 6696960
    s_lshl_b32 s46, s32, 2
    s_add_u32 s46, s46, s30
    s_mul_i32 s47, s46, 20480
    s_mul_i32 s41, s33, 2560
    s_add_u32 s47, s47, s41
    s_add_u32 s54, s47, s36
    s_lshl_b32 s55, s46, 7
    s_add_u32 s55, s55, s37
    s_mul_i32 s22, s28, 327680
    s_add_u32 s22, s22, s47
    s_add_u32 s22, s22, 0
    s_mul_i32 s38, s30, 25600
    s_add_u32 s39, s38, s44
    s_add_u32 s39, s39, 2764800
    s_add_u32 s38, s38, 0
    s_cmp_ge_u32 s29, 18
    s_cbranch_scc1 k2_kernel_nob02
    s_lshl_b32 s46, s28, 8
    s_lshl_b32 s47, s29, 4
    s_add_u32 s46, s46, s47
    s_sub_u32 s46, s46, 16
    s_lshl_b32 s47, s30, 2
    s_add_u32 s47, s47, s46
    v_add_u32 v11, s47, v3
    s_movk_i32 s48, 1280
    v_mul_lo_u32 v6, v11, s48
    v_lshl_add_u32 v6, v4, 4, v6
    buffer_load_dwordx4 v[16:19], v6, s[16:19], 0 offen offset:0
    buffer_load_dwordx4 v[20:23], v6, s[16:19], 0 offen offset:256
    buffer_load_dwordx4 v[24:27], v6, s[16:19], 0 offen offset:512
    buffer_load_dwordx4 v[28:31], v6, s[16:19], 0 offen offset:768
    buffer_load_dwordx4 v[32:35], v6, s[16:19], 0 offen offset:1024
    s_mul_i32 s47, s29, 20480
    s_mul_i32 s48, s30, 5120
    s_add_u32 s47, s47, s48
    s_add_u32 s47, s47, s36
    v_add_u32 v12, s47, v2
    s_add_u32 s48, s48, 135168
    s_mov_b32 m0, s48
    s_nop 0
    buffer_load_dwordx4 v12, s[12:15], 0 offen offset:0 lds
    buffer_load_dwordx4 v12, s[12:15], 0 offen offset:1024 lds
    buffer_load_dwordx4 v12, s[12:15], 0 offen offset:2048 lds
    buffer_load_dwordx4 v12, s[12:15], 0 offen offset:3072 lds
    s_add_u32 s48, s48, 4096
    s_mov_b32 m0, s48
    s_movk_i32 s47, 4096
    buffer_load_dwordx4 v12, s[12:15], s47 offen lds
    s_lshl_b32 s47, s30, 12
    s_add_u32 s48, s47, 118784
    s_add_u32 s41, s47, 0
    s_min_u32 s41, s41, 14336
    s_add_u32 s41, s41, 2711552
    s_add_u32 m0, s48, 0
    s_nop 0
    buffer_load_dwordx4 v2, s[12:15], s41 offen lds
    s_add_u32 s41, s47, 1024
    s_min_u32 s41, s41, 14336
    s_add_u32 s41, s41, 2711552
    s_add_u32 m0, s48, 1024
    s_nop 0
    buffer_load_dwordx4 v2, s[12:15], s41 offen lds
    s_add_u32 s41, s47, 2048
    s_min_u32 s41, s41, 14336
    s_add_u32 s41, s41, 2711552
    s_add_u32 m0, s48, 2048
    s_nop 0
    buffer_load_dwordx4 v2, s[12:15], s41 offen lds
    s_add_u32 s41, s47, 3072
    s_min_u32 s41, s41, 14336
    s_add_u32 s41, s41, 2711552
    s_add_u32 m0, s48, 3072
    s_nop 0
    buffer_load_dwordx4 v2, s[12:15], s41 offen lds
    v_lshl_add_u32 v15, s30, 2, v3
    v_lshrrev_b32 v7, 1, v15
    v_and_b32 v9, 7, v4
    v_xor_b32 v7, v7, v9
    v_and_b32 v9, 1, v15
    v_lshl_add_u32 v7, v7, 1, v9
    v_lshlrev_b32 v7, 3, v7
    v_lshl_add_u32 v7, v4, 8, v7
    v_add_u32 v7, 135168, v7
    v_lshlrev_b32 v10, 5, v4
    v_add_u32 v10, 118784, v10
    v_lshrrev_b32 v12, 2, v4
    v_and_b32 v13, 3, v4
    v_lshl_add_u32 v13, v13, 4, v15
    v_lshlrev_b32 v13, 4, v13
    v_lshl_add_u32 v6, v12, 10, v13
    s_movk_i32 s48, 2048
    v_cmp_gt_u32 s[50:51], s48, v11
    v_mov_b32 v120, 0
    v_mov_b32 v121, 0
    v_mov_b32 v124, 0
    v_mov_b32 v125, 0
    v_mov_b32 v126, 0x3f803f80
    s_waitcnt vmcnt(9)
    v_dot2_f32_bf16 v120, v16, v126, v120
    v_dot2_f32_bf16 v121, v16, v16, v121
    v_lshlrev_b32 v56, 16, v16
    v_and_b32 v57, 0xffff0000, v16
    v_dot2_f32_bf16 v120, v17, v126, v120
    v_dot2_f32_bf16 v121, v17, v17, v121
    v_lshlrev_b32 v58, 16, v17
    v_and_b32 v59, 0xffff0000, v17
    v_dot2_f32_bf16 v120, v18, v126, v120
    v_dot2_f32_bf16 v121, v18, v18, v121
    v_lshlrev_b32 v60, 16, v18
    v_and_b32 v61, 0xffff0000, v18
    s_cmp_eq_u32 s30, 1
    s_cbranch_scc1 k2_kernel_sm4
    s_cmp_ge_u32 s30, 2
    s_cbranch_scc1 k2_kernel_sm5
    s_mul_i32 s41, s33, 320
    s_add_u32 s41, s41, 2748416
    s_mov_b32 m0, 155648
    s_mov_b64 exec, 0xfffff
    buffer_load_dwordx4 v2, s[12:15], s41 offen lds
    s_add_u32 s41, s41, 7168
    s_mov_b32 m0, 156160
    s_nop 0
    buffer_load_dwordx4 v2, s[12:15], s41 offen lds
    s_branch k2_kernel_sm6
k2_kernel_sm4:
    s_mul_i32 s41, s35, 448
    s_add_u32 s41, s41, 2732032
    s_mov_b32 m0, 156672
    s_mov_b64 exec, 0xfffffff
    buffer_load_dwordx4 v2, s[12:15], s41 offen lds
    s_add_u32 s41, s41, 7168
    s_mov_b32 m0, 157184
    s_nop 0
    buffer_load_dwordx4 v2, s[12:15], s41 offen lds
    s_branch k2_kernel_sm6
k2_kernel_sm5:
    s_mul_i32 s41, s33, 320
    s_add_u32 s41, s41, 2724352
    s_mov_b32 m0, 157696
    s_mov_b64 exec, 0xfffff
    buffer_load_dwordx4 v2, s[12:15], s41 offen lds
k2_kernel_sm6:
    s_mov_b64 exec, -1
    v_dot2_f32_bf16 v120, v19, v126, v120
    v_dot2_f32_bf16 v121, v19, v19, v121
    v_lshlrev_b32 v62, 16, v19
    v_and_b32 v63, 0xffff0000, v19
    v_dot2_f32_bf16 v120, v20, v126, v120
    v_dot2_f32_bf16 v121, v20, v20, v121
    v_lshlrev_b32 v64, 16, v20
    v_and_b32 v65, 0xffff0000, v20
    s_mov_b32 m0, s38
    s_nop 0
    buffer_load_dwordx4 v2, s[12:15], s39 offen offset:0 lds
    v_dot2_f32_bf16 v120, v21, v126, v120
    v_dot2_f32_bf16 v121, v21, v21, v121
    v_lshlrev_b32 v66, 16, v21
    v_and_b32 v67, 0xffff0000, v21
    v_dot2_f32_bf16 v120, v22, v126, v120
    v_dot2_f32_bf16 v121, v22, v22, v121
    v_lshlrev_b32 v68, 16, v22
    v_and_b32 v69, 0xffff0000, v22
    s_mov_b32 m0, s38
    s_nop 0
    buffer_load_dwordx4 v2, s[12:15], s39 offen offset:1024 lds
    v_dot2_f32_bf16 v120, v23, v126, v120
    v_dot2_f32_bf16 v121, v23, v23, v121
    v_lshlrev_b32 v70, 16, v23
    v_and_b32 v71, 0xffff0000, v23
    v_dot2_f32_bf16 v120, v24, v126, v120
    v_dot2_f32_bf16 v121, v24, v24, v121
    v_lshlrev_b32 v72, 16, v24
    v_and_b32 v73, 0xffff0000, v24
    s_mov_b32 m0, s38
    s_nop 0
    buffer_load_dwordx4 v2, s[12:15], s39 offen offset:2048 lds
    v_dot2_f32_bf16 v120, v25, v126, v120
    v_dot2_f32_bf16 v121, v25, v25, v121
    v_lshlrev_b32 v74, 16, v25
    v_and_b32 v75, 0xffff0000, v25
    v_dot2_f32_bf16 v120, v26, v126, v120
    v_dot2_f32_bf16 v121, v26, v26, v121
    v_lshlrev_b32 v76, 16, v26
    v_and_b32 v77, 0xffff0000, v26
    s_mov_b32 m0, s38
    s_nop 0
    buffer_load_dwordx4 v2, s[12:15], s39 offen offset:3072 lds
    s_add_u32 s38, s38, 4096
    s_add_u32 s39, s39, 4096
    v_dot2_f32_bf16 v120, v27, v126, v120
    v_dot2_f32_bf16 v121, v27, v27, v121
    v_lshlrev_b32 v78, 16, v27
    v_and_b32 v79, 0xffff0000, v27
    v_dot2_f32_bf16 v120, v28, v126, v120
    v_dot2_f32_bf16 v121, v28, v28, v121
    v_lshlrev_b32 v80, 16, v28
    v_and_b32 v81, 0xffff0000, v28
    s_mov_b32 m0, s38
    s_nop 0
    buffer_load_dwordx4 v2, s[12:15], s39 offen offset:0 lds
    v_dot2_f32_bf16 v120, v29, v126, v120
    v_dot2_f32_bf16 v121, v29, v29, v121
    v_lshlrev_b32 v82, 16, v29
    v_and_b32 v83, 0xffff0000, v29
    v_dot2_f32_bf16 v120, v30, v126, v120
    v_dot2_f32_bf16 v121, v30, v30, v121
    v_lshlrev_b32 v84, 16, v30
    v_and_b32 v85, 0xffff0000, v30
    s_mov_b32 m0, s38
    s_nop 0
    buffer_load_dwordx4 v2, s[12:15], s39 offen offset:1024 lds
    v_dot2_f32_bf16 v120, v31, v126, v120
    v_dot2_f32_bf16 v121, v31, v31, v121
    v_lshlrev_b32 v86, 16, v31
    v_and_b32 v87, 0xffff0000, v31
    v_dot2_f32_bf16 v120, v32, v126, v120
    v_dot2_f32_bf16 v121, v32, v32, v121
    v_lshlrev_b32 v88, 16, v32
    v_and_b32 v89, 0xffff0000, v32
    s_mov_b32 m0, s38
    s_nop 0
    buffer_load_dwordx4 v2, s[12:15], s39 offen offset:2048 lds
    v_dot2_f32_bf16 v120, v33, v126, v120
    v_dot2_f32_bf16 v121, v33, v33, v121
    v_lshlrev_b32 v90, 16, v33
    v_and_b32 v91, 0xffff0000, v33
    v_dot2_f32_bf16 v120, v34, v126, v120
    v_dot2_f32_bf16 v121, v34, v34, v121
    v_lshlrev_b32 v92, 16, v34
    v_and_b32 v93, 0xffff0000, v34
    s_mov_b32 m0, s38
    s_nop 0
    buffer_load_dwordx4 v2, s[12:15], s39 offen offset:3072 lds
    s_add_u32 s38, s38, 4096
    s_add_u32 s39, s39, 4096
    v_dot2_f32_bf16 v120, v35, v126, v120
    v_dot2_f32_bf16 v121, v35, v35, v121
    v_lshlrev_b32 v94, 16, v35
    v_and_b32 v95, 0xffff0000, v35
    s_nop 1
    s_nop 0
    v_add_f32_dpp v120, v120, v120 quad_perm:[1,0,3,2] row_mask:0xf bank_mask:0xf
    v_add_f32_dpp v121, v121, v121 quad_perm:[1,0,3,2] row_mask:0xf bank_mask:0xf
    s_nop 0
    v_add_f32_dpp v120, v120, v120 quad_perm:[2,3,0,1] row_mask:0xf bank_mask:0xf
    v_add_f32_dpp v121, v121, v121 quad_perm:[2,3,0,1] row_mask:0xf bank_mask:0xf
    s_nop 0
    v_add_f32_dpp v120, v120, v120 row_half_mirror row_mask:0xf bank_mask:0xf
    v_add_f32_dpp v121, v121, v121 row_half_mirror row_mask:0xf bank_mask:0xf
    s_nop 0
    v_add_f32_dpp v120, v120, v120 row_mirror row_mask:0xf bank_mask:0xf
    v_add_f32_dpp v121, v121, v121 row_mirror row_mask:0xf bank_mask:0xf
    v_mul_f32 v120, 0x3acccccd, v120
    v_mul_f32 v121, 0x3acccccd, v121
    v_fma_f32 v121, -v120, v120, v121
    v_max_f32 v121, 0, v121
    v_cvt_pk_bf16_f32 v122, v120, v121
    v_lshlrev_b32 v120, 16, v122
    v_and_b32 v121, 0xffff0000, v122
    v_add_f32 v121, 0x3727c5ac, v121
    v_cvt_pk_bf16_f32 v122, v121, v121
    v_lshlrev_b32 v121, 16, v122
    v_sqrt_f32 v121, v121
    s_nop 0
    v_cvt_pk_bf16_f32 v122, v121, v121
    v_lshlrev_b32 v121, 16, v122
    v_rcp_f32 v121, v121
    s_nop 0
    v_mul_f32 v120, v120, v121
    v_sub_f32 v120, 0, v120
    s_waitcnt vmcnt(9)
    s_barrier
    ds_read_b64 v[36:37], v7 offset:0
    ds_read_b64 v[38:39], v7 offset:128
    ds_read_b64 v[40:41], v7 offset:4096
    ds_read_b64 v[42:43], v7 offset:4224
    ds_read_b64 v[44:45], v7 offset:8192
    ds_read_b64 v[46:47], v7 offset:8320
    ds_read_b64 v[48:49], v7 offset:12288
    ds_read_b64 v[50:51], v7 offset:12416
    ds_read_b64 v[52:53], v7 offset:16384
    ds_read_b64 v[54:55], v7 offset:16512
    ds_read_b128 v[96:99], v10 offset:2560
    ds_read_b128 v[100:103], v10 offset:2576
    ds_read_b128 v[104:107], v10 offset:0
    ds_read_b128 v[108:111], v10 offset:16
    ds_read_b128 v[112:115], v10 offset:5120
    ds_read_b128 v[116:119], v10 offset:5136
    ds_read_b128 v[160:163], v10 offset:3072
    ds_read_b128 v[164:167], v10 offset:3088
    ds_read_b128 v[168:171], v10 offset:512
    ds_read_b128 v[172:175], v10 offset:528
    ds_read_b128 v[176:179], v10 offset:5632
    ds_read_b128 v[180:183], v10 offset:5648
    s_waitcnt lgkmcnt(6)
    v_lshlrev_b32 v152, 16, v36
    v_and_b32 v153, 0xffff0000, v36
    v_lshlrev_b32 v154, 16, v37
    v_and_b32 v155, 0xffff0000, v37
    v_lshlrev_b32 v156, 16, v38
    v_and_b32 v157, 0xffff0000, v38
    v_lshlrev_b32 v158, 16, v39
    v_and_b32 v159, 0xffff0000, v39
    v_pk_fma_f32 v[144:145], v[56:57], v[120:121], v[120:121] op_sel:[0,1,0] op_sel_hi:[1,1,0]
    v_pk_fma_f32 v[146:147], v[58:59], v[120:121], v[120:121] op_sel:[0,1,0] op_sel_hi:[1,1,0]
    v_pk_fma_f32 v[148:149], v[60:61], v[120:121], v[120:121] op_sel:[0,1,0] op_sel_hi:[1,1,0]
    v_pk_fma_f32 v[150:151], v[62:63], v[120:121], v[120:121] op_sel:[0,1,0] op_sel_hi:[1,1,0]
    v_pk_fma_f32 v[144:145], v[144:145], v[96:97], v[104:105]
    v_pk_fma_f32 v[146:147], v[146:147], v[98:99], v[106:107]
    v_pk_fma_f32 v[148:149], v[148:149], v[100:101], v[108:109]
    v_pk_fma_f32 v[150:151], v[150:151], v[102:103], v[110:111]
    v_pk_mul_f32 v[144:145], v[144:145], v[152:153]
    v_pk_mul_f32 v[146:147], v[146:147], v[154:155]
    v_pk_mul_f32 v[148:149], v[148:149], v[156:157]
    v_pk_mul_f32 v[150:151], v[150:151], v[158:159]
    v_pk_fma_f32 v[56:57], v[112:113], v[144:145], v[56:57]
    v_pk_fma_f32 v[58:59], v[114:115], v[146:147], v[58:59]
    v_pk_fma_f32 v[60:61], v[116:117], v[148:149], v[60:61]
    v_pk_fma_f32 v[62:63], v[118:119], v[150:151], v[62:63]
    v_cvt_pk_bf16_f32 v16, v56, v57
    v_cvt_pk_bf16_f32 v17, v58, v59
    v_cvt_pk_bf16_f32 v18, v60, v61
    v_cvt_pk_bf16_f32 v19, v62, v63
    v_dot2_f32_bf16 v124, v16, v126, v124
    v_dot2_f32_bf16 v125, v16, v16, v125
    v_dot2_f32_bf16 v124, v17, v126, v124
    v_dot2_f32_bf16 v125, v17, v17, v125
    v_dot2_f32_bf16 v124, v18, v126, v124
    v_dot2_f32_bf16 v125, v18, v18, v125
    v_dot2_f32_bf16 v124, v19, v126, v124
    v_dot2_f32_bf16 v125, v19, v19, v125
    ds_read_b128 v[96:99], v10 offset:3584
    ds_read_b128 v[100:103], v10 offset:3600
    ds_read_b128 v[104:107], v10 offset:1024
    ds_read_b128 v[108:111], v10 offset:1040
    ds_read_b128 v[112:115], v10 offset:6144
    ds_read_b128 v[116:119], v10 offset:6160
    s_waitcnt lgkmcnt(6)
    v_lshlrev_b32 v152, 16, v40
    v_and_b32 v153, 0xffff0000, v40
    v_lshlrev_b32 v154, 16, v41
    v_and_b32 v155, 0xffff0000, v41
    v_lshlrev_b32 v156, 16, v42
    v_and_b32 v157, 0xffff0000, v42
    v_lshlrev_b32 v158, 16, v43
    v_and_b32 v159, 0xffff0000, v43
    v_pk_fma_f32 v[144:145], v[64:65], v[120:121], v[120:121] op_sel:[0,1,0] op_sel_hi:[1,1,0]
    v_pk_fma_f32 v[146:147], v[66:67], v[120:121], v[120:121] op_sel:[0,1,0] op_sel_hi:[1,1,0]
    v_pk_fma_f32 v[148:149], v[68:69], v[120:121], v[120:121] op_sel:[0,1,0] op_sel_hi:[1,1,0]
    v_pk_fma_f32 v[150:151], v[70:71], v[120:121], v[120:121] op_sel:[0,1,0] op_sel_hi:[1,1,0]
    v_pk_fma_f32 v[144:145], v[144:145], v[160:161], v[168:169]
    v_pk_fma_f32 v[146:147], v[146:147], v[162:163], v[170:171]
    v_pk_fma_f32 v[148:149], v[148:149], v[164:165], v[172:173]
    v_pk_fma_f32 v[150:151], v[150:151], v[166:167], v[174:175]
    v_pk_mul_f32 v[144:145], v[144:145], v[152:153]
    v_pk_mul_f32 v[146:147], v[146:147], v[154:155]
    v_pk_mul_f32 v[148:149], v[148:149], v[156:157]
    v_pk_mul_f32 v[150:151], v[150:151], v[158:159]
    v_pk_fma_f32 v[64:65], v[176:177], v[144:145], v[64:65]
    v_pk_fma_f32 v[66:67], v[178:179], v[146:147], v[66:67]
    v_pk_fma_f32 v[68:69], v[180:181], v[148:149], v[68:69]
    v_pk_fma_f32 v[70:71], v[182:183], v[150:151], v[70:71]
    v_cvt_pk_bf16_f32 v20, v64, v65
    v_cvt_pk_bf16_f32 v21, v66, v67
    v_cvt_pk_bf16_f32 v22, v68, v69
    v_cvt_pk_bf16_f32 v23, v70, v71
    v_dot2_f32_bf16 v124, v20, v126, v124
    v_dot2_f32_bf16 v125, v20, v20, v125
    v_dot2_f32_bf16 v124, v21, v126, v124
    v_dot2_f32_bf16 v125, v21, v21, v125
    v_dot2_f32_bf16 v124, v22, v126, v124
    v_dot2_f32_bf16 v125, v22, v22, v125
    v_dot2_f32_bf16 v124, v23, v126, v124
    v_dot2_f32_bf16 v125, v23, v23, v125
    ds_read_b128 v[160:163], v10 offset:4096
    ds_read_b128 v[164:167], v10 offset:4112
    ds_read_b128 v[168:171], v10 offset:1536
    ds_read_b128 v[172:175], v10 offset:1552
    ds_read_b128 v[176:179], v10 offset:6656
    ds_read_b128 v[180:183], v10 offset:6672
    s_waitcnt lgkmcnt(6)
    v_lshlrev_b32 v152, 16, v44
    v_and_b32 v153, 0xffff0000, v44
    v_lshlrev_b32 v154, 16, v45
    v_and_b32 v155, 0xffff0000, v45
    v_lshlrev_b32 v156, 16, v46
    v_and_b32 v157, 0xffff0000, v46
    v_lshlrev_b32 v158, 16, v47
    v_and_b32 v159, 0xffff0000, v47
    v_pk_fma_f32 v[144:145], v[72:73], v[120:121], v[120:121] op_sel:[0,1,0] op_sel_hi:[1,1,0]
    v_pk_fma_f32 v[146:147], v[74:75], v[120:121], v[120:121] op_sel:[0,1,0] op_sel_hi:[1,1,0]
    v_pk_fma_f32 v[148:149], v[76:77], v[120:121], v[120:121] op_sel:[0,1,0] op_sel_hi:[1,1,0]
    v_pk_fma_f32 v[150:151], v[78:79], v[120:121], v[120:121] op_sel:[0,1,0] op_sel_hi:[1,1,0]
    v_pk_fma_f32 v[144:145], v[144:145], v[96:97], v[104:105]
    v_pk_fma_f32 v[146:147], v[146:147], v[98:99], v[106:107]
    v_pk_fma_f32 v[148:149], v[148:149], v[100:101], v[108:109]
    v_pk_fma_f32 v[150:151], v[150:151], v[102:103], v[110:111]
    v_pk_mul_f32 v[144:145], v[144:145], v[152:153]
    v_pk_mul_f32 v[146:147], v[146:147], v[154:155]
    v_pk_mul_f32 v[148:149], v[148:149], v[156:157]
    v_pk_mul_f32 v[150:151], v[150:151], v[158:159]
    v_pk_fma_f32 v[72:73], v[112:113], v[144:145], v[72:73]
    v_pk_fma_f32 v[74:75], v[114:115], v[146:147], v[74:75]
    v_pk_fma_f32 v[76:77], v[116:117], v[148:149], v[76:77]
    v_pk_fma_f32 v[78:79], v[118:119], v[150:151], v[78:79]
    v_cvt_pk_bf16_f32 v24, v72, v73
    v_cvt_pk_bf16_f32 v25, v74, v75
    v_cvt_pk_bf16_f32 v26, v76, v77
    v_cvt_pk_bf16_f32 v27, v78, v79
    v_dot2_f32_bf16 v124, v24, v126, v124
    v_dot2_f32_bf16 v125, v24, v24, v125
    v_dot2_f32_bf16 v124, v25, v126, v124
    v_dot2_f32_bf16 v125, v25, v25, v125
    v_dot2_f32_bf16 v124, v26, v126, v124
    v_dot2_f32_bf16 v125, v26, v26, v125
    v_dot2_f32_bf16 v124, v27, v126, v124
    v_dot2_f32_bf16 v125, v27, v27, v125
    ds_read_b128 v[96:99], v10 offset:4608
    ds_read_b128 v[100:103], v10 offset:4624
    ds_read_b128 v[104:107], v10 offset:2048
    ds_read_b128 v[108:111], v10 offset:2064
    ds_read_b128 v[112:115], v10 offset:7168
    ds_read_b128 v[116:119], v10 offset:7184
    s_waitcnt lgkmcnt(6)
    v_lshlrev_b32 v152, 16, v48
    v_and_b32 v153, 0xffff0000, v48
    v_lshlrev_b32 v154, 16, v49
    v_and_b32 v155, 0xffff0000, v49
    v_lshlrev_b32 v156, 16, v50
    v_and_b32 v157, 0xffff0000, v50
    v_lshlrev_b32 v158, 16, v51
    v_and_b32 v159, 0xffff0000, v51
    v_pk_fma_f32 v[144:145], v[80:81], v[120:121], v[120:121] op_sel:[0,1,0] op_sel_hi:[1,1,0]
    v_pk_fma_f32 v[146:147], v[82:83], v[120:121], v[120:121] op_sel:[0,1,0] op_sel_hi:[1,1,0]
    v_pk_fma_f32 v[148:149], v[84:85], v[120:121], v[120:121] op_sel:[0,1,0] op_sel_hi:[1,1,0]
    v_pk_fma_f32 v[150:151], v[86:87], v[120:121], v[120:121] op_sel:[0,1,0] op_sel_hi:[1,1,0]
    v_pk_fma_f32 v[144:145], v[144:145], v[160:161], v[168:169]
    v_pk_fma_f32 v[146:147], v[146:147], v[162:163], v[170:171]
    v_pk_fma_f32 v[148:149], v[148:149], v[164:165], v[172:173]
    v_pk_fma_f32 v[150:151], v[150:151], v[166:167], v[174:175]
    v_pk_mul_f32 v[144:145], v[144:145], v[152:153]
    v_pk_mul_f32 v[146:147], v[146:147], v[154:155]
    v_pk_mul_f32 v[148:149], v[148:149], v[156:157]
    v_pk_mul_f32 v[150:151], v[150:151], v[158:159]
    v_pk_fma_f32 v[80:81], v[176:177], v[144:145], v[80:81]
    v_pk_fma_f32 v[82:83], v[178:179], v[146:147], v[82:83]
    v_pk_fma_f32 v[84:85], v[180:181], v[148:149], v[84:85]
    v_pk_fma_f32 v[86:87], v[182:183], v[150:151], v[86:87]
    v_cvt_pk_bf16_f32 v28, v80, v81
    v_cvt_pk_bf16_f32 v29, v82, v83
    v_cvt_pk_bf16_f32 v30, v84, v85
    v_cvt_pk_bf16_f32 v31, v86, v87
    v_dot2_f32_bf16 v124, v28, v126, v124
    v_dot2_f32_bf16 v125, v28, v28, v125
    v_dot2_f32_bf16 v124, v29, v126, v124
    v_dot2_f32_bf16 v125, v29, v29, v125
    v_dot2_f32_bf16 v124, v30, v126, v124
    v_dot2_f32_bf16 v125, v30, v30, v125
    v_dot2_f32_bf16 v124, v31, v126, v124
    v_dot2_f32_bf16 v125, v31, v31, v125
    s_waitcnt lgkmcnt(0)
    v_lshlrev_b32 v152, 16, v52
    v_and_b32 v153, 0xffff0000, v52
    v_lshlrev_b32 v154, 16, v53
    v_and_b32 v155, 0xffff0000, v53
    v_lshlrev_b32 v156, 16, v54
    v_and_b32 v157, 0xffff0000, v54
    v_lshlrev_b32 v158, 16, v55
    v_and_b32 v159, 0xffff0000, v55
    v_pk_fma_f32 v[144:145], v[88:89], v[120:121], v[120:121] op_sel:[0,1,0] op_sel_hi:[1,1,0]
    v_pk_fma_f32 v[146:147], v[90:91], v[120:121], v[120:121] op_sel:[0,1,0] op_sel_hi:[1,1,0]
    v_pk_fma_f32 v[148:149], v[92:93], v[120:121], v[120:121] op_sel:[0,1,0] op_sel_hi:[1,1,0]
    v_pk_fma_f32 v[150:151], v[94:95], v[120:121], v[120:121] op_sel:[0,1,0] op_sel_hi:[1,1,0]
    v_pk_fma_f32 v[144:145], v[144:145], v[96:97], v[104:105]
    v_pk_fma_f32 v[146:147], v[146:147], v[98:99], v[106:107]
    v_pk_fma_f32 v[148:149], v[148:149], v[100:101], v[108:109]
    v_pk_fma_f32 v[150:151], v[150:151], v[102:103], v[110:111]
    v_pk_mul_f32 v[144:145], v[144:145], v[152:153]
    v_pk_mul_f32 v[146:147], v[146:147], v[154:155]
    v_pk_mul_f32 v[148:149], v[148:149], v[156:157]
    v_pk_mul_f32 v[150:151], v[150:151], v[158:159]
    v_pk_fma_f32 v[88:89], v[112:113], v[144:145], v[88:89]
    v_pk_fma_f32 v[90:91], v[114:115], v[146:147], v[90:91]
    v_pk_fma_f32 v[92:93], v[116:117], v[148:149], v[92:93]
    v_pk_fma_f32 v[94:95], v[118:119], v[150:151], v[94:95]
    v_cvt_pk_bf16_f32 v32, v88, v89
    v_cvt_pk_bf16_f32 v33, v90, v91
    v_cvt_pk_bf16_f32 v34, v92, v93
    v_cvt_pk_bf16_f32 v35, v94, v95
    v_dot2_f32_bf16 v124, v32, v126, v124
    v_dot2_f32_bf16 v125, v32, v32, v125
    v_dot2_f32_bf16 v124, v33, v126, v124
    v_dot2_f32_bf16 v125, v33, v33, v125
    v_dot2_f32_bf16 v124, v34, v126, v124
    v_dot2_f32_bf16 v125, v34, v34, v125
    v_dot2_f32_bf16 v124, v35, v126, v124
    v_dot2_f32_bf16 v125, v35, v35, v125
    v_and_b32 v191, 31, v1
    v_lshlrev_b32 v191, 2, v191
    s_add_u32 s41, s37, 7424
    buffer_load_dword v190, v191, s[12:15], s41 offen sc1
    ds_read_b128 v[96:99], v10 offset:10240
    ds_read_b128 v[100:103], v10 offset:10256
    ds_read_b128 v[104:107], v10 offset:7680
    ds_read_b128 v[108:111], v10 offset:7696
    s_nop 1
    s_nop 0
    v_add_f32_dpp v124, v124, v124 quad_perm:[1,0,3,2] row_mask:0xf bank_mask:0xf
    v_add_f32_dpp v125, v125, v125 quad_perm:[1,0,3,2] row_mask:0xf bank_mask:0xf
    s_nop 0
    v_add_f32_dpp v124, v124, v124 quad_perm:[2,3,0,1] row_mask:0xf bank_mask:0xf
    v_add_f32_dpp v125, v125, v125 quad_perm:[2,3,0,1] row_mask:0xf bank_mask:0xf
    s_nop 0
    v_add_f32_dpp v124, v124, v124 row_half_mirror row_mask:0xf bank_mask:0xf
    v_add_f32_dpp v125, v125, v125 row_half_mirror row_mask:0xf bank_mask:0xf
    s_nop 0
    v_add_f32_dpp v124, v124, v124 row_mirror row_mask:0xf bank_mask:0xf
    v_add_f32_dpp v125, v125, v125 row_mirror row_mask:0xf bank_mask:0xf
    v_mul_f32 v124, 0x3acccccd, v124
    v_mul_f32 v125, 0x3acccccd, v125
    v_fma_f32 v125, -v124, v124, v125
    v_max_f32 v125, 0, v125
    v_cvt_pk_bf16_f32 v122, v124, v125
    v_lshlrev_b32 v124, 16, v122
    v_and_b32 v125, 0xffff0000, v122
    v_add_f32 v125, 0x3727c5ac, v125
    v_cvt_pk_bf16_f32 v122, v125, v125
    v_lshlrev_b32 v125, 16, v122
    v_sqrt_f32 v125, v125
    s_nop 0
    v_cvt_pk_bf16_f32 v122, v125, v125
    v_lshlrev_b32 v125, 16, v122
    v_rcp_f32 v125, v125
    s_nop 0
    v_mul_f32 v124, v124, v125
    v_sub_f32 v124, 0, v124
    v_mov_b32 v120, 0
    v_mov_b32 v121, 0
    ds_read_b128 v[160:163], v10 offset:10752
    ds_read_b128 v[164:167], v10 offset:10768
    ds_read_b128 v[168:171], v10 offset:8192
    ds_read_b128 v[172:175], v10 offset:8208
    s_waitcnt lgkmcnt(4)
    v_pk_fma_f32 v[56:57], v[56:57], v[124:125], v[124:125] op_sel:[0,1,0] op_sel_hi:[1,1,0]
    v_pk_fma_f32 v[58:59], v[58:59], v[124:125], v[124:125] op_sel:[0,1,0] op_sel_hi:[1,1,0]
    v_pk_fma_f32 v[60:61], v[60:61], v[124:125], v[124:125] op_sel:[0,1,0] op_sel_hi:[1,1,0]
    v_pk_fma_f32 v[62:63], v[62:63], v[124:125], v[124:125] op_sel:[0,1,0] op_sel_hi:[1,1,0]
    v_pk_fma_f32 v[56:57], v[56:57], v[96:97], v[104:105]
    v_pk_fma_f32 v[58:59], v[58:59], v[98:99], v[106:107]
    v_pk_fma_f32 v[60:61], v[60:61], v[100:101], v[108:109]
    v_pk_fma_f32 v[62:63], v[62:63], v[102:103], v[110:111]
    v_cvt_pk_bf16_f32 v36, v56, v57
    v_cvt_pk_bf16_f32 v37, v58, v59
    v_cvt_pk_bf16_f32 v38, v60, v61
    v_cvt_pk_bf16_f32 v39, v62, v63
    v_dot2_f32_bf16 v120, v36, v126, v120
    v_dot2_f32_bf16 v121, v36, v36, v121
    v_dot2_f32_bf16 v120, v37, v126, v120
    v_dot2_f32_bf16 v121, v37, v37, v121
    v_dot2_f32_bf16 v120, v38, v126, v120
    v_dot2_f32_bf16 v121, v38, v38, v121
    v_dot2_f32_bf16 v120, v39, v126, v120
    v_dot2_f32_bf16 v121, v39, v39, v121
    ds_read_b128 v[96:99], v10 offset:11264
    ds_read_b128 v[100:103], v10 offset:11280
    ds_read_b128 v[104:107], v10 offset:8704
    ds_read_b128 v[108:111], v10 offset:8720
    s_waitcnt lgkmcnt(4)
    v_pk_fma_f32 v[64:65], v[64:65], v[124:125], v[124:125] op_sel:[0,1,0] op_sel_hi:[1,1,0]
    v_pk_fma_f32 v[66:67], v[66:67], v[124:125], v[124:125] op_sel:[0,1,0] op_sel_hi:[1,1,0]
    v_pk_fma_f32 v[68:69], v[68:69], v[124:125], v[124:125] op_sel:[0,1,0] op_sel_hi:[1,1,0]
    v_pk_fma_f32 v[70:71], v[70:71], v[124:125], v[124:125] op_sel:[0,1,0] op_sel_hi:[1,1,0]
    v_pk_fma_f32 v[64:65], v[64:65], v[160:161], v[168:169]
    v_pk_fma_f32 v[66:67], v[66:67], v[162:163], v[170:171]
    v_pk_fma_f32 v[68:69], v[68:69], v[164:165], v[172:173]
    v_pk_fma_f32 v[70:71], v[70:71], v[166:167], v[174:175]
    v_cvt_pk_bf16_f32 v40, v64, v65
    v_cvt_pk_bf16_f32 v41, v66, v67
    v_cvt_pk_bf16_f32 v42, v68, v69
    v_cvt_pk_bf16_f32 v43, v70, v71
    v_dot2_f32_bf16 v120, v40, v126, v120
    v_dot2_f32_bf16 v121, v40, v40, v121
    v_dot2_f32_bf16 v120, v41, v126, v120
    v_dot2_f32_bf16 v121, v41, v41, v121
    v_dot2_f32_bf16 v120, v42, v126, v120
    v_dot2_f32_bf16 v121, v42, v42, v121
    v_dot2_f32_bf16 v120, v43, v126, v120
    v_dot2_f32_bf16 v121, v43, v43, v121
    ds_read_b128 v[160:163], v10 offset:11776
    ds_read_b128 v[164:167], v10 offset:11792
    ds_read_b128 v[168:171], v10 offset:9216
    ds_read_b128 v[172:175], v10 offset:9232
    s_waitcnt lgkmcnt(4)
    v_pk_fma_f32 v[72:73], v[72:73], v[124:125], v[124:125] op_sel:[0,1,0] op_sel_hi:[1,1,0]
    v_pk_fma_f32 v[74:75], v[74:75], v[124:125], v[124:125] op_sel:[0,1,0] op_sel_hi:[1,1,0]
    v_pk_fma_f32 v[76:77], v[76:77], v[124:125], v[124:125] op_sel:[0,1,0] op_sel_hi:[1,1,0]
    v_pk_fma_f32 v[78:79], v[78:79], v[124:125], v[124:125] op_sel:[0,1,0] op_sel_hi:[1,1,0]
    v_pk_fma_f32 v[72:73], v[72:73], v[96:97], v[104:105]
    v_pk_fma_f32 v[74:75], v[74:75], v[98:99], v[106:107]
    v_pk_fma_f32 v[76:77], v[76:77], v[100:101], v[108:109]
    v_pk_fma_f32 v[78:79], v[78:79], v[102:103], v[110:111]
    v_cvt_pk_bf16_f32 v44, v72, v73
    v_cvt_pk_bf16_f32 v45, v74, v75
    v_cvt_pk_bf16_f32 v46, v76, v77
    v_cvt_pk_bf16_f32 v47, v78, v79
    v_dot2_f32_bf16 v120, v44, v126, v120
    v_dot2_f32_bf16 v121, v44, v44, v121
    v_dot2_f32_bf16 v120, v45, v126, v120
    v_dot2_f32_bf16 v121, v45, v45, v121
    v_dot2_f32_bf16 v120, v46, v126, v120
    v_dot2_f32_bf16 v121, v46, v46, v121
    v_dot2_f32_bf16 v120, v47, v126, v120
    v_dot2_f32_bf16 v121, v47, v47, v121
    ds_read_b128 v[96:99], v10 offset:12288
    ds_read_b128 v[100:103], v10 offset:12304
    ds_read_b128 v[104:107], v10 offset:9728
    ds_read_b128 v[108:111], v10 offset:9744
    s_waitcnt lgkmcnt(4)
    v_pk_fma_f32 v[80:81], v[80:81], v[124:125], v[124:125] op_sel:[0,1,0] op_sel_hi:[1,1,0]
    v_pk_fma_f32 v[82:83], v[82:83], v[124:125], v[124:125] op_sel:[0,1,0] op_sel_hi:[1,1,0]
    v_pk_fma_f32 v[84:85], v[84:85], v[124:125], v[124:125] op_sel:[0,1,0] op_sel_hi:[1,1,0]
    v_pk_fma_f32 v[86:87], v[86:87], v[124:125], v[124:125] op_sel:[0,1,0] op_sel_hi:[1,1,0]
    v_pk_fma_f32 v[80:81], v[80:81], v[160:161], v[168:169]
    v_pk_fma_f32 v[82:83], v[82:83], v[162:163], v[170:171]
    v_pk_fma_f32 v[84:85], v[84:85], v[164:165], v[172:173]
    v_pk_fma_f32 v[86:87], v[86:87], v[166:167], v[174:175]
    v_cvt_pk_bf16_f32 v48, v80, v81
    v_cvt_pk_bf16_f32 v49, v82, v83
    v_cvt_pk_bf16_f32 v50, v84, v85
    v_cvt_pk_bf16_f32 v51, v86, v87
    v_dot2_f32_bf16 v120, v48, v126, v120
    v_dot2_f32_bf16 v121, v48, v48, v121
    v_dot2_f32_bf16 v120, v49, v126, v120
    v_dot2_f32_bf16 v121, v49, v49, v121
    v_dot2_f32_bf16 v120, v50, v126, v120
    v_dot2_f32_bf16 v121, v50, v50, v121
    v_dot2_f32_bf16 v120, v51, v126, v120
    v_dot2_f32_bf16 v121, v51, v51, v121
    s_waitcnt lgkmcnt(0)
    v_pk_fma_f32 v[88:89], v[88:89], v[124:125], v[124:125] op_sel:[0,1,0] op_sel_hi:[1,1,0]
    v_pk_fma_f32 v[90:91], v[90:91], v[124:125], v[124:125] op_sel:[0,1,0] op_sel_hi:[1,1,0]
    v_pk_fma_f32 v[92:93], v[92:93], v[124:125], v[124:125] op_sel:[0,1,0] op_sel_hi:[1,1,0]
    v_pk_fma_f32 v[94:95], v[94:95], v[124:125], v[124:125] op_sel:[0,1,0] op_sel_hi:[1,1,0]
    v_pk_fma_f32 v[88:89], v[88:89], v[96:97], v[104:105]
    v_pk_fma_f32 v[90:91], v[90:91], v[98:99], v[106:107]
    v_pk_fma_f32 v[92:93], v[92:93], v[100:101], v[108:109]
    v_pk_fma_f32 v[94:95], v[94:95], v[102:103], v[110:111]
    v_cvt_pk_bf16_f32 v52, v88, v89
    v_cvt_pk_bf16_f32 v53, v90, v91
    v_cvt_pk_bf16_f32 v54, v92, v93
    v_cvt_pk_bf16_f32 v55, v94, v95
    v_dot2_f32_bf16 v120, v52, v126, v120
    v_dot2_f32_bf16 v121, v52, v52, v121
    v_dot2_f32_bf16 v120, v53, v126, v120
    v_dot2_f32_bf16 v121, v53, v53, v121
    v_dot2_f32_bf16 v120, v54, v126, v120
    v_dot2_f32_bf16 v121, v54, v54, v121
    v_dot2_f32_bf16 v120, v55, v126, v120
    v_dot2_f32_bf16 v121, v55, v55, v121
    s_nop 1
    s_nop 0
    v_add_f32_dpp v120, v120, v120 quad_perm:[1,0,3,2] row_mask:0xf bank_mask:0xf
    v_add_f32_dpp v121, v121, v121 quad_perm:[1,0,3,2] row_mask:0xf bank_mask:0xf
    s_nop 0
    v_add_f32_dpp v120, v120, v120 quad_perm:[2,3,0,1] row_mask:0xf bank_mask:0xf
    v_add_f32_dpp v121, v121, v121 quad_perm:[2,3,0,1] row_mask:0xf bank_mask:0xf
    s_nop 0
    v_add_f32_dpp v120, v120, v120 row_half_mirror row_mask:0xf bank_mask:0xf
    v_add_f32_dpp v121, v121, v121 row_half_mirror row_mask:0xf bank_mask:0xf
    s_nop 0
    v_add_f32_dpp v120, v120, v120 row_mirror row_mask:0xf bank_mask:0xf
    v_add_f32_dpp v121, v121, v121 row_mirror row_mask:0xf bank_mask:0xf
    v_mul_f32 v120, 0x3acccccd, v120
    v_mul_f32 v121, 0x3acccccd, v121
    v_fma_f32 v121, -v120, v120, v121
    v_max_f32 v121, 0, v121
    v_cvt_pk_bf16_f32 v122, v120, v121
    v_lshlrev_b32 v120, 16, v122
    v_and_b32 v121, 0xffff0000, v122
    v_add_f32 v121, 0x3727c5ac, v121
    v_cvt_pk_bf16_f32 v122, v121, v121
    v_lshlrev_b32 v121, 16, v122
    v_sqrt_f32 v121, v121
    s_nop 0
    v_cvt_pk_bf16_f32 v122, v121, v121
    v_lshlrev_b32 v121, 16, v122
    v_rcp_f32 v121, v121
    s_nop 0
    v_mul_f32 v120, v120, v121
    v_sub_f32 v120, 0, v120
    v_cndmask_b32 v120, 0, v120, s[50:51]
    v_cndmask_b32 v121, 0, v121, s[50:51]
    s_mul_i32 s46, s29, 20480
    s_add_u32 s46, s46, s36
    s_add_u32 s47, s46, 348160
    s_lshl_b32 s48, s29, 7
    s_add_u32 s48, s48, s36
    s_add_u32 s48, s48, 1597440
    v_lshlrev_b32 v12, 3, v15
    s_lshl_b32 s49, s29, 7
    s_add_u32 s49, s49, s37
    s_lshl_b32 s41, s30, 2
    s_add_u32 s49, s49, s41
    s_waitcnt vmcnt(0)
    s_mov_b32 s43, 200000
k2_kernel_xp7:
    v_cmp_ne_u32 vcc, 0, v190
    s_sub_u32 s43, s43, 1
    s_cmp_eq_u64 vcc, -1
    s_cbranch_scc1 k2_kernel_xd8
    s_cmp_eq_u32 s43, 0
    s_cbranch_scc1 k2_kernel_xd8
    s_add_u32 s41, s37, 7424
    buffer_load_dword v190, v191, s[12:15], s41 offen sc1
    s_waitcnt vmcnt(0)
    s_branch k2_kernel_xp7
k2_kernel_xd8:
    v_cmp_eq_u32 vcc, s42, v190
    s_nop 1
    s_cmp_eq_u64 vcc, -1
    s_cselect_b32 s31, 1, 0
    s_barrier
    v_and_b32 v9, 7, v4
    v_xor_b32 v9, v15, v9
    v_and_b32 v10, 3, v4
    v_lshl_add_u32 v9, v10, 4, v9
    v_lshrrev_b32 v10, 2, v4
    v_lshl_add_u32 v9, v10, 6, v9
    v_lshlrev_b32 v9, 4, v9
    v_add_u32 v9, 114688, v9
    ds_write_b128 v9, v[36:39] offset:0
    ds_write_b128 v9, v[16:19] offset:20480
    ds_write_b128 v9, v[40:43] offset:4096
    ds_write_b128 v9, v[20:23] offset:24576
    ds_write_b128 v9, v[44:47] offset:8192
    ds_write_b128 v9, v[24:27] offset:28672
    ds_write_b128 v9, v[48:51] offset:12288
    ds_write_b128 v9, v[28:31] offset:32768
    ds_write_b128 v9, v[52:55] offset:16384
    ds_write_b128 v9, v[32:35] offset:36864
    v_xor_b32 v9, v4, v3
    v_xor_b32 v10, 4, v9
    v_lshl_add_u32 v9, v3, 4, v9
    v_lshl_add_u32 v10, v3, 4, v10
    s_mul_i32 s41, s30, 5120
    s_add_u32 s41, s41, 114688
    v_lshl_add_u32 v9, v9, 4, s41
    v_lshl_add_u32 v10, v10, 4, s41
    s_cmp_eq_u32 s30, 1
    s_cselect_b32 s41, 1, 0
    s_cmp_eq_u32 s30, 3
    s_cselect_b32 s41, 1, s41
    s_cmp_eq_u32 s41, 1
    v_mov_b32 v11, v9
    s_cbranch_scc0 k2_noswap
    v_mov_b32 v9, v10
    v_mov_b32 v10, v11
k2_noswap:
    s_mul_i32 s41, s30, 5120
    s_add_u32 s46, s46, s41
    s_add_u32 s47, s47, s41
    s_waitcnt lgkmcnt(0)
    s_barrier
    ds_read_b128 v[36:39], v9 offset:0
    ds_read_b128 v[40:43], v10 offset:1024
    ds_read_b128 v[44:47], v9 offset:2048
    ds_read_b128 v[48:51], v10 offset:3072
    ds_read_b128 v[52:55], v9 offset:4096
    ds_read_b128 v[220:223], v9 offset:20480
    ds_read_b128 v[224:227], v10 offset:21504
    ds_read_b128 v[228:231], v9 offset:22528
    ds_read_b128 v[232:235], v10 offset:23552
    ds_read_b128 v[236:239], v9 offset:24576
    s_add_u32 s52, s46, 4096
    s_sub_u32 s41, s29, 1
    s_cmp_lt_u32 s41, 16
    s_cselect_b32 s20, s47, 0x90000000
    s_cmp_eq_u32 s31, 0
    s_cbranch_scc1 k2_kernel_slow9
    s_waitcnt lgkmcnt(9)
    buffer_store_dwordx4 v[36:39], v2, s[12:15], s46 offen offset:0
    s_waitcnt lgkmcnt(8)
    buffer_store_dwordx4 v[40:43], v2, s[12:15], s46 offen offset:1024
    s_waitcnt lgkmcnt(7)
    buffer_store_dwordx4 v[44:47], v2, s[12:15], s46 offen offset:2048
    s_waitcnt lgkmcnt(6)
    buffer_store_dwordx4 v[48:51], v2, s[12:15], s46 offen offset:3072
    s_waitcnt lgkmcnt(5)
    buffer_store_dwordx4 v[52:55], v2, s[12:15], s52 offen offset:0
    v_cmp_eq_u32 vcc, 0, v4
    s_and_saveexec_b64 s[50:51], vcc
    buffer_store_dwordx2 v[120:121], v12, s[12:15], s48 offen
    s_mov_b64 exec, -1
    s_waitcnt vmcnt(0)
    v_mov_b32 v9, 1
    v_mov_b32 v10, 0
    s_mov_b64 exec, 1
    buffer_store_dword v9, v10, s[12:15], s49 offen
    s_mov_b64 exec, -1
    s_branch k2_kernel_sent10
k2_kernel_slow9:
    s_waitcnt lgkmcnt(9)
    buffer_store_dwordx4 v[36:39], v2, s[12:15], s46 offen offset:0 sc1
    s_waitcnt lgkmcnt(8)
    buffer_store_dwordx4 v[40:43], v2, s[12:15], s46 offen offset:1024 sc1
    s_waitcnt lgkmcnt(7)
    buffer_store_dwordx4 v[44:47], v2, s[12:15], s46 offen offset:2048 sc1
    s_waitcnt lgkmcnt(6)
    buffer_store_dwordx4 v[48:51], v2, s[12:15], s46 offen offset:3072 sc1
    s_waitcnt lgkmcnt(5)
    buffer_store_dwordx4 v[52:55], v2, s[12:15], s52 offen offset:0 sc1
    v_cmp_eq_u32 vcc, 0, v4
    s_and_saveexec_b64 s[50:51], vcc
    buffer_store_dwordx2 v[120:121], v12, s[12:15], s48 offen sc1
    s_mov_b64 exec, -1
    s_waitcnt vmcnt(0)
    v_mov_b32 v9, 1
    v_mov_b32 v10, 0
    s_mov_b64 exec, 1
    buffer_store_dword v9, v10, s[12:15], s49 offen sc1
    s_mov_b64 exec, -1
k2_kernel_sent10:
    s_mov_b32 s21, s49
    s_mov_b32 m0, s38
    s_nop 0
    buffer_load_dwordx4 v2, s[12:15], s39 offen offset:0 lds
    s_mov_b32 m0, s38
    s_nop 0
    buffer_load_dwordx4 v2, s[12:15], s39 offen offset:1024 lds
    s_mov_b32 m0, s38
    s_nop 0
    buffer_load_dwordx4 v2, s[12:15], s39 offen offset:2048 lds
    s_mov_b32 m0, s38
    s_nop 0
    buffer_load_dwordx4 v2, s[12:15], s39 offen offset:3072 lds
    s_add_u32 s38, s38, 4096
    s_add_u32 s39, s39, 4096
    s_mov_b32 m0, s38
    s_nop 0
    buffer_load_dwordx4 v2, s[12:15], s39 offen offset:0 lds
    s_mov_b32 m0, s38
    s_nop 0
    buffer_load_dwordx4 v2, s[12:15], s39 offen offset:1024 lds
    s_mov_b32 m0, s38
    s_nop 0
    buffer_load_dwordx4 v2, s[12:15], s39 offen offset:2048 lds
    s_mov_b32 m0, s38
    s_nop 0
    buffer_load_dwordx4 v2, s[12:15], s39 offen offset:3072 lds
    s_add_u32 s38, s38, 4096
    s_add_u32 s39, s39, 4096
    s_mov_b32 m0, s38
    s_nop 0
    buffer_load_dwordx4 v2, s[12:15], s39 offen offset:0 lds
    s_mov_b32 m0, s38
    s_nop 0
    buffer_load_dwordx4 v2, s[12:15], s39 offen offset:1024 lds
    s_mov_b32 m0, s38
    s_nop 0
    buffer_load_dwordx4 v2, s[12:15], s39 offen offset:2048 lds
    s_mov_b32 m0, s38
    s_nop 0
    buffer_load_dwordx4 v2, s[12:15], s39 offen offset:3072 lds
    s_add_u32 s38, s38, 4096
    s_add_u32 s39, s39, 4096
    s_mov_b32 m0, s38
    s_nop 0
    buffer_load_dwordx4 v2, s[12:15], s39 offen offset:0 lds
    s_mov_b32 m0, s38
    s_nop 0
    buffer_load_dwordx4 v2, s[12:15], s39 offen offset:1024 lds
    s_mov_b32 m0, s38
    s_nop 0
    buffer_load_dwordx4 v2, s[12:15], s39 offen offset:2048 lds
    s_mov_b32 m0, s38
    s_nop 0
    buffer_load_dwordx4 v2, s[12:15], s39 offen offset:3072 lds
    s_add_u32 s38, s38, 4096
    s_add_u32 s39, s39, 4096
    s_mov_b32 m0, s38
    s_nop 0
    buffer_load_dwordx4 v2, s[12:15], s39 offen offset:0 lds
    s_branch k2_kernel_join03
k2_kernel_nob02:
    s_mov_b32 s21, 0
    s_mov_b32 s20, 0x90000000
    s_mul_i32 s38, s30, 25600
    s_add_u32 s39, s38, s44
    s_add_u32 s39, s39, 2764800
    v_and_b32 v191, 31, v1
    v_lshlrev_b32 v191, 2, v191
    s_add_u32 s41, s37, 7424
    buffer_load_dword v190, v191, s[12:15], s41 offen sc1
    s_waitcnt vmcnt(0)
    s_mov_b32 s43, 200000
k2_kernel_xp11:
    v_cmp_ne_u32 vcc, 0, v190
    s_sub_u32 s43, s43, 1
    s_cmp_eq_u64 vcc, -1
    s_cbranch_scc1 k2_kernel_xd12
    s_cmp_eq_u32 s43, 0
    s_cbranch_scc1 k2_kernel_xd12
    s_add_u32 s41, s37, 7424
    buffer_load_dword v190, v191, s[12:15], s41 offen sc1
    s_waitcnt vmcnt(0)
    s_branch k2_kernel_xp11
k2_kernel_xd12:
    v_cmp_eq_u32 vcc, s42, v190
    s_nop 1
    s_cmp_eq_u64 vcc, -1
    s_cselect_b32 s31, 1, 0
    s_cmp_eq_u32 s30, 1
    s_cbranch_scc1 k2_kernel_sm13
    s_cmp_ge_u32 s30, 2
    s_cbranch_scc1 k2_kernel_sm14
    s_mul_i32 s41, s33, 320
    s_add_u32 s41, s41, 2748416
    s_mov_b32 m0, 155648
    s_mov_b64 exec, 0xfffff
    buffer_load_dwordx4 v2, s[12:15], s41 offen lds
    s_add_u32 s41, s41, 7168
    s_mov_b32 m0, 156160
    s_nop 0
    buffer_load_dwordx4 v2, s[12:15], s41 offen lds
    s_branch k2_kernel_sm15
k2_kernel_sm13:
    s_mul_i32 s41, s35, 448
    s_add_u32 s41, s41, 2732032
    s_mov_b32 m0, 156672
    s_mov_b64 exec, 0xfffffff
    buffer_load_dwordx4 v2, s[12:15], s41 offen lds
    s_add_u32 s41, s41, 7168
    s_mov_b32 m0, 157184
    s_nop 0
    buffer_load_dwordx4 v2, s[12:15], s41 offen lds
    s_branch k2_kernel_sm15
k2_kernel_sm14:
    s_mul_i32 s41, s33, 320
    s_add_u32 s41, s41, 2724352
    s_mov_b32 m0, 157696
    s_mov_b64 exec, 0xfffff
    buffer_load_dwordx4 v2, s[12:15], s41 offen lds
k2_kernel_sm15:
    s_mov_b64 exec, -1
    s_mov_b32 m0, s38
    s_nop 0
    buffer_load_dwordx4 v2, s[12:15], s39 offen offset:0 lds
    s_mov_b32 m0, s38
    s_nop 0
    buffer_load_dwordx4 v2, s[12:15], s39 offen offset:1024 lds
    s_mov_b32 m0, s38
    s_nop 0
    buffer_load_dwordx4 v2, s[12:15], s39 offen offset:2048 lds
    s_mov_b32 m0, s38
    s_nop 0
    buffer_load_dwordx4 v2, s[12:15], s39 offen offset:3072 lds
    s_add_u32 s38, s38, 4096
    s_add_u32 s39, s39, 4096
    s_mov_b32 m0, s38
    s_nop 0
    buffer_load_dwordx4 v2, s[12:15], s39 offen offset:0 lds
    s_mov_b32 m0, s38
    s_nop 0
    buffer_load_dwordx4 v2, s[12:15], s39 offen offset:1024 lds
    s_mov_b32 m0, s38
    s_nop 0
    buffer_load_dwordx4 v2, s[12:15], s39 offen offset:2048 lds
    s_mov_b32 m0, s38
    s_nop 0
    buffer_load_dwordx4 v2, s[12:15], s39 offen offset:3072 lds
    s_add_u32 s38, s38, 4096
    s_add_u32 s39, s39, 4096
    s_mov_b32 m0, s38
    s_nop 0
    buffer_load_dwordx4 v2, s[12:15], s39 offen offset:0 lds
    s_mov_b32 m0, s38
    s_nop 0
    buffer_load_dwordx4 v2, s[12:15], s39 offen offset:1024 lds
    s_mov_b32 m0, s38
    s_nop 0
    buffer_load_dwordx4 v2, s[12:15], s39 offen offset:2048 lds
    s_mov_b32 m0, s38
    s_nop 0
    buffer_load_dwordx4 v2, s[12:15], s39 offen offset:3072 lds
    s_add_u32 s38, s38, 4096
    s_add_u32 s39, s39, 4096
    s_mov_b32 m0, s38
    s_nop 0
    buffer_load_dwordx4 v2, s[12:15], s39 offen offset:0 lds
    s_mov_b32 m0, s38
    s_nop 0
    buffer_load_dwordx4 v2, s[12:15], s39 offen offset:1024 lds
    s_mov_b32 m0, s38
    s_nop 0
    buffer_load_dwordx4 v2, s[12:15], s39 offen offset:2048 lds
    s_mov_b32 m0, s38
    s_nop 0
    buffer_load_dwordx4 v2, s[12:15], s39 offen offset:3072 lds
    s_add_u32 s38, s38, 4096
    s_add_u32 s39, s39, 4096
    s_mov_b32 m0, s38
    s_nop 0
    buffer_load_dwordx4 v2, s[12:15], s39 offen offset:0 lds
    s_mov_b32 m0, s38
    s_nop 0
    buffer_load_dwordx4 v2, s[12:15], s39 offen offset:1024 lds
    s_mov_b32 m0, s38
    s_nop 0
    buffer_load_dwordx4 v2, s[12:15], s39 offen offset:2048 lds
    s_mov_b32 m0, s38
    s_nop 0
    buffer_load_dwordx4 v2, s[12:15], s39 offen offset:3072 lds
    s_add_u32 s38, s38, 4096
    s_add_u32 s39, s39, 4096
    s_mov_b32 m0, s38
    s_nop 0
    buffer_load_dwordx4 v2, s[12:15], s39 offen offset:0 lds
    s_mov_b32 m0, s38
    s_nop 0
    buffer_load_dwordx4 v2, s[12:15], s39 offen offset:1024 lds
    s_mov_b32 m0, s38
    s_nop 0
    buffer_load_dwordx4 v2, s[12:15], s39 offen offset:2048 lds
    s_mov_b32 m0, s38
    s_nop 0
    buffer_load_dwordx4 v2, s[12:15], s39 offen offset:3072 lds
    s_add_u32 s38, s38, 4096
    s_add_u32 s39, s39, 4096
    s_mov_b32 m0, s38
    s_nop 0
    buffer_load_dwordx4 v2, s[12:15], s39 offen offset:0 lds
    s_mul_i32 s47, s28, 327680
    s_lshl_b32 s48, s29, 13
    s_add_u32 s47, s47, s48
    v_mov_b32 v101, 0
    s_mov_b64 exec, 1
    buffer_load_dword v102, v101, s[24:27], s47 offen
    s_mov_b64 exec, -1
    s_cmp_eq_u32 s31, 0
    s_cbranch_scc1 k2_kernel_nt16
    s_sub_u32 s47, s29, 18
    s_lshl_b32 s47, s47, 2
    s_add_u32 s47, s47, s30
    s_mul_i32 s48, s47, 6144
    s_min_u32 s48, s48, 321536
    s_mul_i32 s49, s28, 327680
    s_add_u32 s48, s48, s49
    s_add_u32 s48, s48, 0
    buffer_load_dwordx4 v[64:67], v2, s[12:15], s48 offen offset:0
    buffer_load_dwordx4 v[68:71], v2, s[12:15], s48 offen offset:1024
    buffer_load_dwordx4 v[72:75], v2, s[12:15], s48 offen offset:2048
    buffer_load_dwordx4 v[76:79], v2, s[12:15], s48 offen offset:3072
    s_add_u32 s48, s48, 4096
    buffer_load_dwordx4 v[80:83], v2, s[12:15], s48 offen offset:0
    buffer_load_dwordx4 v[84:87], v2, s[12:15], s48 offen offset:1024
    s_mul_i32 s48, s47, 384
    s_min_u32 s48, s48, 20096
    s_add_u32 s48, s48, s36
    s_add_u32 s48, s48, 1581056
    s_mov_b64 exec, 7
    buffer_load_dword v100, v5, s[12:15], s48 offen
    s_mov_b64 exec, -1
k2_kernel_nt16:
k2_kernel_join03:
    s_lshl_b32 s46, s32, 2
    s_add_u32 s46, s46, s30
    s_lshr_b32 s47, s33, 1
    s_and_b32 s48, s47, 1
    s_lshr_b32 s47, s47, 1
    s_add_u32 s47, s47, 1
    s_sub_u32 s49, 0, s47
    s_cmp_eq_u32 s48, 1
    s_cselect_b32 s47, s47, s49
    s_lshl_b32 s49, s46, 4
    s_add_u32 s49, s49, 16
    s_add_u32 s49, s49, s47
    v_add_u32 v9, s49, v4
    v_lshrrev_b32 v10, 4, v9
    v_mul_u32_u24 v6, 20480, v10
    v_and_b32 v10, 15, v9
    v_lshl_add_u32 v10, v3, 4, v10
    v_lshl_add_u32 v6, v10, 4, v6
    v_lshlrev_b32 v13, 3, v9
    s_add_u32 s49, s46, s48
    s_lshl_b32 s49, s49, 7
    s_add_u32 s49, s49, s37
    v_bfe_u32 v7, v1, 2, 1
    v_lshlrev_b32 v7, 7, v7
    v_and_b32 v9, 3, v1
    v_lshl_add_u32 v7, v9, 2, v7
    s_mov_b32 s43, 200000
k2_kernel_poll17:
    buffer_load_dword v9, v7, s[12:15], s49 offen sc1
    s_waitcnt vmcnt(0)
    v_cmp_ne_u32 vcc, 0, v9
    s_sub_u32 s43, s43, 1
    s_cmp_eq_u64 vcc, -1
    s_cbranch_scc1 k2_kernel_go18
    s_cmp_lg_u32 s43, 0
    s_cbranch_scc1 k2_kernel_poll17
k2_kernel_go18:
    s_add_u32 s41, s36, 0
    buffer_load_dwordx4 v[16:19], v6, s[12:15], s41 offen offset:0 sc1
    s_add_u32 s41, s36, 0
    buffer_load_dwordx4 v[20:23], v6, s[12:15], s41 offen offset:1024 sc1
    s_add_u32 s41, s36, 0
    buffer_load_dwordx4 v[24:27], v6, s[12:15], s41 offen offset:2048 sc1
    s_add_u32 s41, s36, 0
    buffer_load_dwordx4 v[28:31], v6, s[12:15], s41 offen offset:3072 sc1
    s_add_u32 s41, s36, 1597440
    buffer_load_dwordx2 v[176:177], v13, s[12:15], s41 offen sc1
    v_mov_b32 v14, v2
    v_add_u32 v15, 0x10000, v2
    v_add_u32 v11, 0x20000, v2
    s_barrier
    s_mul_i32 s38, s30, 13312
    s_add_u32 s39, s38, s44
    s_add_u32 s39, s39, 3584000
    s_add_u32 s38, s38, 102400
    ds_read_b128 v[96:99], v14 offset:0
    ds_read_b128 v[100:103], v14 offset:1024
    ds_read_b128 v[104:107], v14 offset:2048
    ds_read_b128 v[108:111], v14 offset:3072
    ds_read_b128 v[112:115], v14 offset:4096
    ds_read_b128 v[116:119], v14 offset:5120
    ds_read_b128 v[120:123], v14 offset:6144
    ds_read_b128 v[124:127], v14 offset:7168
    ds_read_b128 v[128:131], v14 offset:8192
    ds_read_b128 v[132:135], v14 offset:9216
    s_waitcnt vmcnt(4)
    s_waitcnt lgkmcnt(5)
    v_mfma_f32_16x16x32_bf16 v[156:159], v[96:99], v[16:19], 0
    s_add_u32 s41, s36, 4096
    buffer_load_dwordx4 v[32:35], v6, s[12:15], s41 offen offset:0 sc1
    v_mfma_f32_16x16x32_bf16 v[160:163], v[100:103], v[16:19], 0
    ds_read_b128 v[136:139], v14 offset:10240
    v_mfma_f32_16x16x32_bf16 v[164:167], v[104:107], v[16:19], 0
    ds_read_b128 v[140:143], v14 offset:11264
    v_mfma_f32_16x16x32_bf16 v[168:171], v[108:111], v[16:19], 0
    ds_read_b128 v[144:147], v14 offset:12288
    s_add_u32 s41, s36, 4096
    buffer_load_dwordx4 v[36:39], v6, s[12:15], s41 offen offset:1024 sc1
    v_mfma_f32_16x16x32_bf16 v[172:175], v[112:115], v[16:19], 0
    ds_read_b128 v[148:151], v14 offset:13312
    ds_read_b128 v[152:155], v14 offset:14336
    s_waitcnt vmcnt(5)
    s_waitcnt lgkmcnt(5)
    v_mfma_f32_16x16x32_bf16 v[156:159], v[116:119], v[20:23], v[156:159]
    s_add_u32 s41, s36, 4096
    buffer_load_dwordx4 v[40:43], v6, s[12:15], s41 offen offset:2048 sc1
    v_mfma_f32_16x16x32_bf16 v[160:163], v[120:123], v[20:23], v[160:163]
    ds_read_b128 v[96:99], v14 offset:15360
    v_mfma_f32_16x16x32_bf16 v[164:167], v[124:127], v[20:23], v[164:167]
    ds_read_b128 v[100:103], v14 offset:16384
    v_mfma_f32_16x16x32_bf16 v[168:171], v[128:131], v[20:23], v[168:171]
    ds_read_b128 v[104:107], v14 offset:17408
    s_add_u32 s41, s36, 4096
    buffer_load_dwordx4 v[44:47], v6, s[12:15], s41 offen offset:3072 sc1
    v_mfma_f32_16x16x32_bf16 v[172:175], v[132:135], v[20:23], v[172:175]
    ds_read_b128 v[108:111], v14 offset:18432
    ds_read_b128 v[112:115], v14 offset:19456
    s_waitcnt vmcnt(6)
    s_waitcnt lgkmcnt(5)
    v_mfma_f32_16x16x32_bf16 v[156:159], v[136:139], v[24:27], v[156:159]
    s_add_u32 s41, s36, 8192
    buffer_load_dwordx4 v[48:51], v6, s[12:15], s41 offen offset:0 sc1
    v_mfma_f32_16x16x32_bf16 v[160:163], v[140:143], v[24:27], v[160:163]
    ds_read_b128 v[116:119], v14 offset:20480
    v_mfma_f32_16x16x32_bf16 v[164:167], v[144:147], v[24:27], v[164:167]
    ds_read_b128 v[120:123], v14 offset:21504
    v_mfma_f32_16x16x32_bf16 v[168:171], v[148:151], v[24:27], v[168:171]
    ds_read_b128 v[124:127], v14 offset:22528
    s_add_u32 s41, s36, 8192
    buffer_load_dwordx4 v[52:55], v6, s[12:15], s41 offen offset:1024 sc1
    v_mfma_f32_16x16x32_bf16 v[172:175], v[152:155], v[24:27], v[172:175]
    ds_read_b128 v[128:131], v14 offset:23552
    ds_read_b128 v[132:135], v14 offset:24576
    s_waitcnt vmcnt(7)
    s_waitcnt lgkmcnt(5)
    v_mfma_f32_16x16x32_bf16 v[156:159], v[96:99], v[28:31], v[156:159]
    s_add_u32 s41, s36, 8192
    buffer_load_dwordx4 v[56:59], v6, s[12:15], s41 offen offset:2048 sc1
    v_mfma_f32_16x16x32_bf16 v[160:163], v[100:103], v[28:31], v[160:163]
    ds_read_b128 v[136:139], v14 offset:25600
    v_mfma_f32_16x16x32_bf16 v[164:167], v[104:107], v[28:31], v[164:167]
    ds_read_b128 v[140:143], v14 offset:26624
    v_mfma_f32_16x16x32_bf16 v[168:171], v[108:111], v[28:31], v[168:171]
    ds_read_b128 v[144:147], v14 offset:27648
    s_add_u32 s41, s36, 8192
    buffer_load_dwordx4 v[60:63], v6, s[12:15], s41 offen offset:3072 sc1
    v_mfma_f32_16x16x32_bf16 v[172:175], v[112:115], v[28:31], v[172:175]
    ds_read_b128 v[148:151], v14 offset:28672
    ds_read_b128 v[152:155], v14 offset:29696
    s_waitcnt vmcnt(7)
    s_waitcnt lgkmcnt(5)
    v_mfma_f32_16x16x32_bf16 v[156:159], v[116:119], v[32:35], v[156:159]
    s_add_u32 s41, s36, 12288
    buffer_load_dwordx4 v[64:67], v6, s[12:15], s41 offen offset:0 sc1
    v_mfma_f32_16x16x32_bf16 v[160:163], v[120:123], v[32:35], v[160:163]
    ds_read_b128 v[96:99], v14 offset:30720
    v_mfma_f32_16x16x32_bf16 v[164:167], v[124:127], v[32:35], v[164:167]
    ds_read_b128 v[100:103], v14 offset:31744
    v_mfma_f32_16x16x32_bf16 v[168:171], v[128:131], v[32:35], v[168:171]
    ds_read_b128 v[104:107], v14 offset:32768
    s_add_u32 s41, s36, 12288
    buffer_load_dwordx4 v[68:71], v6, s[12:15], s41 offen offset:1024 sc1
    v_mfma_f32_16x16x32_bf16 v[172:175], v[132:135], v[32:35], v[172:175]
    ds_read_b128 v[108:111], v14 offset:33792
    ds_read_b128 v[112:115], v14 offset:34816
    s_waitcnt vmcnt(8)
    s_waitcnt lgkmcnt(5)
    v_mfma_f32_16x16x32_bf16 v[156:159], v[136:139], v[36:39], v[156:159]
    s_add_u32 s41, s36, 12288
    buffer_load_dwordx4 v[72:75], v6, s[12:15], s41 offen offset:2048 sc1
    v_mfma_f32_16x16x32_bf16 v[160:163], v[140:143], v[36:39], v[160:163]
    ds_read_b128 v[116:119], v14 offset:35840
    v_mfma_f32_16x16x32_bf16 v[164:167], v[144:147], v[36:39], v[164:167]
    ds_read_b128 v[120:123], v14 offset:36864
    v_mfma_f32_16x16x32_bf16 v[168:171], v[148:151], v[36:39], v[168:171]
    ds_read_b128 v[124:127], v14 offset:37888
    s_add_u32 s41, s36, 12288
    buffer_load_dwordx4 v[76:79], v6, s[12:15], s41 offen offset:3072 sc1
    v_mfma_f32_16x16x32_bf16 v[172:175], v[152:155], v[36:39], v[172:175]
    ds_read_b128 v[128:131], v14 offset:38912
    ds_read_b128 v[132:135], v14 offset:39936
    s_waitcnt vmcnt(9)
    s_waitcnt lgkmcnt(5)
    v_mfma_f32_16x16x32_bf16 v[156:159], v[96:99], v[40:43], v[156:159]
    s_add_u32 s41, s36, 16384
    buffer_load_dwordx4 v[80:83], v6, s[12:15], s41 offen offset:0 sc1
    v_mfma_f32_16x16x32_bf16 v[160:163], v[100:103], v[40:43], v[160:163]
    ds_read_b128 v[136:139], v14 offset:40960
    v_mfma_f32_16x16x32_bf16 v[164:167], v[104:107], v[40:43], v[164:167]
    ds_read_b128 v[140:143], v14 offset:41984
    v_mfma_f32_16x16x32_bf16 v[168:171], v[108:111], v[40:43], v[168:171]
    ds_read_b128 v[144:147], v14 offset:43008
    s_add_u32 s41, s36, 16384
    buffer_load_dwordx4 v[84:87], v6, s[12:15], s41 offen offset:1024 sc1
    v_mfma_f32_16x16x32_bf16 v[172:175], v[112:115], v[40:43], v[172:175]
    ds_read_b128 v[148:151], v14 offset:44032
    ds_read_b128 v[152:155], v14 offset:45056
    s_waitcnt vmcnt(10)
    s_waitcnt lgkmcnt(5)
    v_mfma_f32_16x16x32_bf16 v[156:159], v[116:119], v[44:47], v[156:159]
    s_add_u32 s41, s36, 16384
    buffer_load_dwordx4 v[88:91], v6, s[12:15], s41 offen offset:2048 sc1
    v_mfma_f32_16x16x32_bf16 v[160:163], v[120:123], v[44:47], v[160:163]
    ds_read_b128 v[96:99], v14 offset:46080
    v_mfma_f32_16x16x32_bf16 v[164:167], v[124:127], v[44:47], v[164:167]
    ds_read_b128 v[100:103], v14 offset:47104
    v_mfma_f32_16x16x32_bf16 v[168:171], v[128:131], v[44:47], v[168:171]
    ds_read_b128 v[104:107], v14 offset:48128
    s_add_u32 s41, s36, 16384
    buffer_load_dwordx4 v[92:95], v6, s[12:15], s41 offen offset:3072 sc1
    v_mfma_f32_16x16x32_bf16 v[172:175], v[132:135], v[44:47], v[172:175]
    ds_read_b128 v[108:111], v14 offset:49152
    ds_read_b128 v[112:115], v14 offset:50176
    s_waitcnt vmcnt(11)
    s_waitcnt lgkmcnt(5)
    v_mfma_f32_16x16x32_bf16 v[156:159], v[136:139], v[48:51], v[156:159]
    v_mfma_f32_16x16x32_bf16 v[160:163], v[140:143], v[48:51], v[160:163]
    ds_read_b128 v[116:119], v14 offset:51200
    s_mov_b32 m0, s38
    s_nop 0
    buffer_load_dwordx4 v2, s[12:15], s39 offen offset:0 lds
    v_mfma_f32_16x16x32_bf16 v[164:167], v[144:147], v[48:51], v[164:167]
    ds_read_b128 v[120:123], v14 offset:52224
    v_mfma_f32_16x16x32_bf16 v[168:171], v[148:151], v[48:51], v[168:171]
    ds_read_b128 v[124:127], v14 offset:53248
    v_mfma_f32_16x16x32_bf16 v[172:175], v[152:155], v[48:51], v[172:175]
    ds_read_b128 v[128:131], v14 offset:54272
    ds_read_b128 v[132:135], v14 offset:55296
    s_add_u32 s41, s20, 0
    buffer_store_dwordx4 v[220:223], v2, s[12:15], s41 offen sc1
    s_waitcnt vmcnt(12)
    s_waitcnt lgkmcnt(5)
    s_barrier
    v_mfma_f32_16x16x32_bf16 v[156:159], v[96:99], v[52:55], v[156:159]
    v_mfma_f32_16x16x32_bf16 v[160:163], v[100:103], v[52:55], v[160:163]
    ds_read_b128 v[136:139], v14 offset:56320
    s_mov_b32 m0, s38
    s_nop 0
    buffer_load_dwordx4 v2, s[12:15], s39 offen offset:1024 lds
    v_mfma_f32_16x16x32_bf16 v[164:167], v[104:107], v[52:55], v[164:167]
    ds_read_b128 v[140:143], v14 offset:57344
    v_mfma_f32_16x16x32_bf16 v[168:171], v[108:111], v[52:55], v[168:171]
    ds_read_b128 v[144:147], v14 offset:58368
    v_mfma_f32_16x16x32_bf16 v[172:175], v[112:115], v[52:55], v[172:175]
    ds_read_b128 v[148:151], v14 offset:59392
    ds_read_b128 v[152:155], v14 offset:60416
    s_add_u32 s41, s20, 1024
    buffer_store_dwordx4 v[224:227], v2, s[12:15], s41 offen sc1
    s_waitcnt vmcnt(13)
    s_waitcnt lgkmcnt(5)
    v_mfma_f32_16x16x32_bf16 v[156:159], v[116:119], v[56:59], v[156:159]
    v_mfma_f32_16x16x32_bf16 v[160:163], v[120:123], v[56:59], v[160:163]
    ds_read_b128 v[96:99], v14 offset:61440
    s_mov_b32 m0, s38
    s_nop 0
    buffer_load_dwordx4 v2, s[12:15], s39 offen offset:2048 lds
    v_mfma_f32_16x16x32_bf16 v[164:167], v[124:127], v[56:59], v[164:167]
    ds_read_b128 v[100:103], v14 offset:62464
    v_mfma_f32_16x16x32_bf16 v[168:171], v[128:131], v[56:59], v[168:171]
    ds_read_b128 v[104:107], v14 offset:63488
    v_mfma_f32_16x16x32_bf16 v[172:175], v[132:135], v[56:59], v[172:175]
    ds_read_b128 v[108:111], v14 offset:64512
    ds_read_b128 v[112:115], v15 offset:0
    s_add_u32 s41, s20, 2048
    buffer_store_dwordx4 v[228:231], v2, s[12:15], s41 offen sc1
    s_waitcnt vmcnt(14)
    s_waitcnt lgkmcnt(5)
    v_mfma_f32_16x16x32_bf16 v[156:159], v[136:139], v[60:63], v[156:159]
    v_mfma_f32_16x16x32_bf16 v[160:163], v[140:143], v[60:63], v[160:163]
    ds_read_b128 v[116:119], v15 offset:1024
    s_mov_b32 m0, s38
    s_nop 0
    buffer_load_dwordx4 v2, s[12:15], s39 offen offset:3072 lds
    s_add_u32 s38, s38, 4096
    s_add_u32 s39, s39, 4096
    v_mfma_f32_16x16x32_bf16 v[164:167], v[144:147], v[60:63], v[164:167]
    ds_read_b128 v[120:123], v15 offset:2048
    v_mfma_f32_16x16x32_bf16 v[168:171], v[148:151], v[60:63], v[168:171]
    ds_read_b128 v[124:127], v15 offset:3072
    v_mfma_f32_16x16x32_bf16 v[172:175], v[152:155], v[60:63], v[172:175]
    ds_read_b128 v[128:131], v15 offset:4096
    ds_read_b128 v[132:135], v15 offset:5120
    s_add_u32 s41, s20, 3072
    buffer_store_dwordx4 v[232:235], v2, s[12:15], s41 offen sc1
    s_waitcnt vmcnt(15)
    s_waitcnt lgkmcnt(5)
    v_mfma_f32_16x16x32_bf16 v[156:159], v[96:99], v[64:67], v[156:159]
    v_mfma_f32_16x16x32_bf16 v[160:163], v[100:103], v[64:67], v[160:163]
    ds_read_b128 v[136:139], v15 offset:6144
    s_mov_b32 m0, s38
    s_nop 0
    buffer_load_dwordx4 v2, s[12:15], s39 offen offset:0 lds
    v_mfma_f32_16x16x32_bf16 v[164:167], v[104:107], v[64:67], v[164:167]
    ds_read_b128 v[140:143], v15 offset:7168
    v_mfma_f32_16x16x32_bf16 v[168:171], v[108:111], v[64:67], v[168:171]
    ds_read_b128 v[144:147], v15 offset:8192
    v_mfma_f32_16x16x32_bf16 v[172:175], v[112:115], v[64:67], v[172:175]
    ds_read_b128 v[148:151], v15 offset:9216
    ds_read_b128 v[152:155], v15 offset:10240
    s_add_u32 s41, s20, 4096
    buffer_store_dwordx4 v[236:239], v2, s[12:15], s41 offen sc1
    s_waitcnt vmcnt(16)
    s_waitcnt lgkmcnt(5)
    v_mfma_f32_16x16x32_bf16 v[156:159], v[116:119], v[68:71], v[156:159]
    v_mfma_f32_16x16x32_bf16 v[160:163], v[120:123], v[68:71], v[160:163]
    ds_read_b128 v[96:99], v15 offset:11264
    s_mov_b32 m0, s38
    s_nop 0
    buffer_load_dwordx4 v2, s[12:15], s39 offen offset:1024 lds
    v_mfma_f32_16x16x32_bf16 v[164:167], v[124:127], v[68:71], v[164:167]
    ds_read_b128 v[100:103], v15 offset:12288
    v_mfma_f32_16x16x32_bf16 v[168:171], v[128:131], v[68:71], v[168:171]
    ds_read_b128 v[104:107], v15 offset:13312
    v_mfma_f32_16x16x32_bf16 v[172:175], v[132:135], v[68:71], v[172:175]
    ds_read_b128 v[108:111], v15 offset:14336
    ds_read_b128 v[112:115], v15 offset:15360
    s_mov_b32 m0, s38
    s_nop 0
    buffer_load_dwordx4 v2, s[12:15], s39 offen offset:2048 lds
    s_waitcnt vmcnt(17)
    s_waitcnt lgkmcnt(5)
    v_mfma_f32_16x16x32_bf16 v[156:159], v[136:139], v[72:75], v[156:159]
    v_mfma_f32_16x16x32_bf16 v[160:163], v[140:143], v[72:75], v[160:163]
    ds_read_b128 v[116:119], v15 offset:16384
    s_mov_b32 m0, s38
    s_nop 0
    buffer_load_dwordx4 v2, s[12:15], s39 offen offset:3072 lds
    s_add_u32 s38, s38, 4096
    s_add_u32 s39, s39, 4096
    v_mfma_f32_16x16x32_bf16 v[164:167], v[144:147], v[72:75], v[164:167]
    ds_read_b128 v[120:123], v15 offset:17408
    v_mfma_f32_16x16x32_bf16 v[168:171], v[148:151], v[72:75], v[168:171]
    ds_read_b128 v[124:127], v15 offset:18432
    v_mfma_f32_16x16x32_bf16 v[172:175], v[152:155], v[72:75], v[172:175]
    ds_read_b128 v[128:131], v15 offset:19456
    ds_read_b128 v[132:135], v15 offset:20480
    s_mov_b32 m0, s38
    s_nop 0
    buffer_load_dwordx4 v2, s[12:15], s39 offen offset:0 lds
    s_waitcnt vmcnt(18)
    s_waitcnt lgkmcnt(5)
    v_mfma_f32_16x16x32_bf16 v[156:159], v[96:99], v[76:79], v[156:159]
    v_mfma_f32_16x16x32_bf16 v[160:163], v[100:103], v[76:79], v[160:163]
    ds_read_b128 v[136:139], v15 offset:21504
    s_mov_b32 m0, s38
    s_nop 0
    buffer_load_dwordx4 v2, s[12:15], s39 offen offset:1024 lds
    v_mfma_f32_16x16x32_bf16 v[164:167], v[104:107], v[76:79], v[164:167]
    ds_read_b128 v[140:143], v15 offset:22528
    v_mfma_f32_16x16x32_bf16 v[168:171], v[108:111], v[76:79], v[168:171]
    ds_read_b128 v[144:147], v15 offset:23552
    v_mfma_f32_16x16x32_bf16 v[172:175], v[112:115], v[76:79], v[172:175]
    ds_read_b128 v[148:151], v15 offset:24576
    ds_read_b128 v[152:155], v15 offset:25600
    s_mov_b32 m0, s38
    s_nop 0
    buffer_load_dwordx4 v2, s[12:15], s39 offen offset:2048 lds
    s_waitcnt vmcnt(19)
    s_waitcnt lgkmcnt(5)
    v_mfma_f32_16x16x32_bf16 v[156:159], v[116:119], v[80:83], v[156:159]
    v_mfma_f32_16x16x32_bf16 v[160:163], v[120:123], v[80:83], v[160:163]
    ds_read_b128 v[96:99], v15 offset:26624
    s_mov_b32 m0, s38
    s_nop 0
    buffer_load_dwordx4 v2, s[12:15], s39 offen offset:3072 lds
    s_add_u32 s38, s38, 4096
    s_add_u32 s39, s39, 4096
    v_mfma_f32_16x16x32_bf16 v[164:167], v[124:127], v[80:83], v[164:167]
    ds_read_b128 v[100:103], v15 offset:27648
    v_mfma_f32_16x16x32_bf16 v[168:171], v[128:131], v[80:83], v[168:171]
    ds_read_b128 v[104:107], v15 offset:28672
    v_mfma_f32_16x16x32_bf16 v[172:175], v[132:135], v[80:83], v[172:175]
    ds_read_b128 v[108:111], v15 offset:29696
    ds_read_b128 v[112:115], v15 offset:30720
    s_mov_b32 m0, s38
    s_nop 0
    buffer_load_dwordx4 v2, s[12:15], s39 offen offset:0 lds
    s_waitcnt vmcnt(20)
    s_waitcnt lgkmcnt(5)
    v_mfma_f32_16x16x32_bf16 v[156:159], v[136:139], v[84:87], v[156:159]
    v_mfma_f32_16x16x32_bf16 v[160:163], v[140:143], v[84:87], v[160:163]
    ds_read_b128 v[116:119], v15 offset:31744
    s_mul_i32 s38, s30, 12288
    s_add_u32 s39, s38, s44
    s_add_u32 s39, s39, 3637248
    s_add_u32 s38, s38, 0
    s_mov_b32 m0, s38
    s_nop 0
    buffer_load_dwordx4 v2, s[12:15], s39 offen offset:0 lds
    v_mfma_f32_16x16x32_bf16 v[164:167], v[144:147], v[84:87], v[164:167]
    ds_read_b128 v[120:123], v15 offset:32768
    v_mfma_f32_16x16x32_bf16 v[168:171], v[148:151], v[84:87], v[168:171]
    ds_read_b128 v[124:127], v15 offset:33792
    v_mfma_f32_16x16x32_bf16 v[172:175], v[152:155], v[84:87], v[172:175]
    ds_read_b128 v[128:131], v15 offset:34816
    ds_read_b128 v[132:135], v15 offset:35840
    s_mov_b32 m0, s38
    s_nop 0
    buffer_load_dwordx4 v2, s[12:15], s39 offen offset:1024 lds
    s_waitcnt vmcnt(21)
    s_waitcnt lgkmcnt(5)
    v_mfma_f32_16x16x32_bf16 v[156:159], v[96:99], v[88:91], v[156:159]
    v_mfma_f32_16x16x32_bf16 v[160:163], v[100:103], v[88:91], v[160:163]
    s_mov_b32 m0, s38
    s_nop 0
    buffer_load_dwordx4 v2, s[12:15], s39 offen offset:2048 lds
    v_mfma_f32_16x16x32_bf16 v[164:167], v[104:107], v[88:91], v[164:167]
    v_mfma_f32_16x16x32_bf16 v[168:171], v[108:111], v[88:91], v[168:171]
    v_mfma_f32_16x16x32_bf16 v[172:175], v[112:115], v[88:91], v[172:175]
    s_mov_b32 m0, s38
    s_nop 0
    buffer_load_dwordx4 v2, s[12:15], s39 offen offset:3072 lds
    s_add_u32 s38, s38, 4096
    s_add_u32 s39, s39, 4096
    s_waitcnt vmcnt(22)
    s_waitcnt lgkmcnt(0)
    v_mfma_f32_16x16x32_bf16 v[156:159], v[116:119], v[92:95], v[156:159]
    v_mfma_f32_16x16x32_bf16 v[160:163], v[120:123], v[92:95], v[160:163]
    s_mov_b32 m0, s38
    s_nop 0
    buffer_load_dwordx4 v2, s[12:15], s39 offen offset:0 lds
    v_mfma_f32_16x16x32_bf16 v[164:167], v[124:127], v[92:95], v[164:167]
    v_mfma_f32_16x16x32_bf16 v[168:171], v[128:131], v[92:95], v[168:171]
    v_mfma_f32_16x16x32_bf16 v[172:175], v[132:135], v[92:95], v[172:175]
    s_mov_b32 m0, s38
    s_nop 0
    buffer_load_dwordx4 v2, s[12:15], s39 offen offset:1024 lds
    s_barrier
    s_mov_b32 m0, s38
    s_nop 0
    buffer_load_dwordx4 v2, s[12:15], s39 offen offset:2048 lds
    s_mov_b32 m0, s38
    s_nop 0
    buffer_load_dwordx4 v2, s[12:15], s39 offen offset:3072 lds
    s_add_u32 s38, s38, 4096
    s_add_u32 s39, s39, 4096
    s_mov_b32 m0, s38
    s_nop 0
    buffer_load_dwordx4 v2, s[12:15], s39 offen offset:0 lds
    s_mov_b32 m0, s38
    s_nop 0
    buffer_load_dwordx4 v2, s[12:15], s39 offen offset:1024 lds
    s_mov_b32 m0, s38
    s_nop 0
    buffer_load_dwordx4 v2, s[12:15], s39 offen offset:2048 lds
    s_mov_b32 m0, s38
    s_nop 0
    buffer_load_dwordx4 v2, s[12:15], s39 offen offset:3072 lds
    s_mul_i32 s38, s30, 13312
    s_add_u32 s39, s38, s45
    s_add_u32 s39, s39, 0
    s_add_u32 s38, s38, 49152
    s_mov_b32 m0, s38
    s_nop 0
    buffer_load_dwordx4 v2, s[12:15], s39 offen offset:0 lds
    s_mov_b32 m0, s38
    s_nop 0
    buffer_load_dwordx4 v2, s[12:15], s39 offen offset:1024 lds
    s_mov_b32 m0, s38
    s_nop 0
    buffer_load_dwordx4 v2, s[12:15], s39 offen offset:2048 lds
    s_mov_b32 m0, s38
    s_nop 0
    buffer_load_dwordx4 v2, s[12:15], s39 offen offset:3072 lds
    s_add_u32 s38, s38, 4096
    s_add_u32 s39, s39, 4096
    s_mov_b32 m0, s38
    s_nop 0
    buffer_load_dwordx4 v2, s[12:15], s39 offen offset:0 lds
    s_mov_b32 m0, s38
    s_nop 0
    buffer_load_dwordx4 v2, s[12:15], s39 offen offset:1024 lds
    s_mov_b32 m0, s38
    s_nop 0
    buffer_load_dwordx4 v2, s[12:15], s39 offen offset:2048 lds
    s_mov_b32 m0, s38
    s_nop 0
    buffer_load_dwordx4 v2, s[12:15], s39 offen offset:3072 lds
    s_add_u32 s38, s38, 4096
    s_add_u32 s39, s39, 4096
    s_mov_b32 m0, s38
    s_nop 0
    buffer_load_dwordx4 v2, s[12:15], s39 offen offset:0 lds
    s_mov_b32 m0, s38
    s_nop 0
    buffer_load_dwordx4 v2, s[12:15], s39 offen offset:1024 lds
    s_mov_b32 m0, s38
    s_nop 0
    buffer_load_dwordx4 v2, s[12:15], s39 offen offset:2048 lds
    s_mov_b32 m0, s38
    s_nop 0
    buffer_load_dwordx4 v2, s[12:15], s39 offen offset:3072 lds
    s_add_u32 s38, s38, 4096
    s_add_u32 s39, s39, 4096
    s_mov_b32 m0, s38
    s_nop 0
    buffer_load_dwordx4 v2, s[12:15], s39 offen offset:0 lds
    v_lshlrev_b32 v9, 4, v3
    v_add_u32 v9, 155648, v9
    v_mov_b32 v12, 0xbdd2d3e8
    v_mov_b32 v13, 0xc0135761
    ds_read_b128 v[180:183], v9 offset:0
    ds_read_b128 v[200:203], v9 offset:512
    ds_read_b128 v[184:187], v9 offset:64
    ds_read_b128 v[204:207], v9 offset:576
    ds_read_b128 v[188:191], v9 offset:128
    ds_read_b128 v[208:211], v9 offset:640
    ds_read_b128 v[192:195], v9 offset:192
    ds_read_b128 v[212:215], v9 offset:704
    ds_read_b128 v[196:199], v9 offset:256
    ds_read_b128 v[216:219], v9 offset:768
    s_waitcnt lgkmcnt(0)
    v_pk_add_f32 v[180:181], v[180:181], v[200:201]
    v_pk_add_f32 v[182:183], v[182:183], v[202:203]
    v_pk_add_f32 v[184:185], v[184:185], v[204:205]
    v_pk_add_f32 v[186:187], v[186:187], v[206:207]
    v_pk_add_f32 v[188:189], v[188:189], v[208:209]
    v_pk_add_f32 v[190:191], v[190:191], v[210:211]
    v_pk_add_f32 v[192:193], v[192:193], v[212:213]
    v_pk_add_f32 v[194:195], v[194:195], v[214:215]
    v_pk_add_f32 v[196:197], v[196:197], v[216:217]
    v_pk_add_f32 v[198:199], v[198:199], v[218:219]
    v_pk_mul_f32 v[200:201], v[180:181], v[176:177] op_sel_hi:[1,0]
    v_pk_mul_f32 v[202:203], v[182:183], v[176:177] op_sel_hi:[1,0]
    v_pk_mul_f32 v[204:205], v[184:185], v[176:177] op_sel_hi:[1,0]
    v_pk_mul_f32 v[206:207], v[186:187], v[176:177] op_sel_hi:[1,0]
    v_pk_mul_f32 v[208:209], v[188:189], v[176:177] op_sel_hi:[1,0]
    v_pk_mul_f32 v[210:211], v[190:191], v[176:177] op_sel_hi:[1,0]
    v_pk_mul_f32 v[212:213], v[192:193], v[176:177] op_sel_hi:[1,0]
    v_pk_mul_f32 v[214:215], v[194:195], v[176:177] op_sel_hi:[1,0]
    v_pk_mul_f32 v[216:217], v[196:197], v[176:177] op_sel_hi:[1,0]
    v_pk_mul_f32 v[218:219], v[198:199], v[176:177] op_sel_hi:[1,0]
    v_pk_fma_f32 v[156:157], v[156:157], v[176:177], v[200:201] op_sel:[0,1,0] op_sel_hi:[1,1,1]
    v_pk_fma_f32 v[158:159], v[158:159], v[176:177], v[202:203] op_sel:[0,1,0] op_sel_hi:[1,1,1]
    v_pk_fma_f32 v[160:161], v[160:161], v[176:177], v[204:205] op_sel:[0,1,0] op_sel_hi:[1,1,1]
    v_pk_fma_f32 v[162:163], v[162:163], v[176:177], v[206:207] op_sel:[0,1,0] op_sel_hi:[1,1,1]
    v_pk_fma_f32 v[164:165], v[164:165], v[176:177], v[208:209] op_sel:[0,1,0] op_sel_hi:[1,1,1]
    v_pk_fma_f32 v[166:167], v[166:167], v[176:177], v[210:211] op_sel:[0,1,0] op_sel_hi:[1,1,1]
    v_pk_fma_f32 v[168:169], v[168:169], v[176:177], v[212:213] op_sel:[0,1,0] op_sel_hi:[1,1,1]
    v_pk_fma_f32 v[170:171], v[170:171], v[176:177], v[214:215] op_sel:[0,1,0] op_sel_hi:[1,1,1]
    v_pk_fma_f32 v[172:173], v[172:173], v[176:177], v[216:217] op_sel:[0,1,0] op_sel_hi:[1,1,1]
    v_pk_fma_f32 v[174:175], v[174:175], v[176:177], v[218:219] op_sel:[0,1,0] op_sel_hi:[1,1,1]
    v_pk_mul_f32 v[200:201], v[156:157], v[156:157]
    v_pk_mul_f32 v[202:203], v[158:159], v[158:159]
    v_pk_mul_f32 v[204:205], v[160:161], v[160:161]
    v_pk_mul_f32 v[206:207], v[162:163], v[162:163]
    v_pk_mul_f32 v[208:209], v[164:165], v[164:165]
    v_pk_mul_f32 v[210:211], v[166:167], v[166:167]
    v_pk_mul_f32 v[212:213], v[168:169], v[168:169]
    v_pk_mul_f32 v[214:215], v[170:171], v[170:171]
    v_pk_mul_f32 v[216:217], v[172:173], v[172:173]
    v_pk_mul_f32 v[218:219], v[174:175], v[174:175]
    v_pk_fma_f32 v[200:201], v[200:201], v[12:13], v[12:13] op_sel:[0,0,1] op_sel_hi:[1,0,1]
    v_pk_fma_f32 v[202:203], v[202:203], v[12:13], v[12:13] op_sel:[0,0,1] op_sel_hi:[1,0,1]
    v_pk_fma_f32 v[204:205], v[204:205], v[12:13], v[12:13] op_sel:[0,0,1] op_sel_hi:[1,0,1]
    v_pk_fma_f32 v[206:207], v[206:207], v[12:13], v[12:13] op_sel:[0,0,1] op_sel_hi:[1,0,1]
    v_pk_fma_f32 v[208:209], v[208:209], v[12:13], v[12:13] op_sel:[0,0,1] op_sel_hi:[1,0,1]
    v_pk_fma_f32 v[210:211], v[210:211], v[12:13], v[12:13] op_sel:[0,0,1] op_sel_hi:[1,0,1]
    v_pk_fma_f32 v[212:213], v[212:213], v[12:13], v[12:13] op_sel:[0,0,1] op_sel_hi:[1,0,1]
    v_pk_fma_f32 v[214:215], v[214:215], v[12:13], v[12:13] op_sel:[0,0,1] op_sel_hi:[1,0,1]
    v_pk_fma_f32 v[216:217], v[216:217], v[12:13], v[12:13] op_sel:[0,0,1] op_sel_hi:[1,0,1]
    v_pk_fma_f32 v[218:219], v[218:219], v[12:13], v[12:13] op_sel:[0,0,1] op_sel_hi:[1,0,1]
    v_pk_mul_f32 v[200:201], v[200:201], v[156:157]
    v_pk_mul_f32 v[202:203], v[202:203], v[158:159]
    v_pk_mul_f32 v[204:205], v[204:205], v[160:161]
    v_pk_mul_f32 v[206:207], v[206:207], v[162:163]
    v_pk_mul_f32 v[208:209], v[208:209], v[164:165]
    v_pk_mul_f32 v[210:211], v[210:211], v[166:167]
    v_pk_mul_f32 v[212:213], v[212:213], v[168:169]
    v_pk_mul_f32 v[214:215], v[214:215], v[170:171]
    v_pk_mul_f32 v[216:217], v[216:217], v[172:173]
    v_pk_mul_f32 v[218:219], v[218:219], v[174:175]
    v_exp_f32 v200, v200
    v_exp_f32 v201, v201
    v_exp_f32 v202, v202
    v_exp_f32 v203, v203
    v_exp_f32 v204, v204
    v_exp_f32 v205, v205
    v_exp_f32 v206, v206
    v_exp_f32 v207, v207
    v_exp_f32 v208, v208
    v_exp_f32 v209, v209
    v_exp_f32 v210, v210
    v_exp_f32 v211, v211
    v_exp_f32 v212, v212
    v_exp_f32 v213, v213
    v_exp_f32 v214, v214
    v_exp_f32 v215, v215
    v_exp_f32 v216, v216
    v_exp_f32 v217, v217
    v_exp_f32 v218, v218
    v_exp_f32 v219, v219
    v_pk_add_f32 v[200:201], v[200:201], 1.0 op_sel_hi:[1,0]
    v_pk_add_f32 v[202:203], v[202:203], 1.0 op_sel_hi:[1,0]
    v_pk_add_f32 v[204:205], v[204:205], 1.0 op_sel_hi:[1,0]
    v_pk_add_f32 v[206:207], v[206:207], 1.0 op_sel_hi:[1,0]
    v_pk_add_f32 v[208:209], v[208:209], 1.0 op_sel_hi:[1,0]
    v_pk_add_f32 v[210:211], v[210:211], 1.0 op_sel_hi:[1,0]
    v_pk_add_f32 v[212:213], v[212:213], 1.0 op_sel_hi:[1,0]
    v_pk_add_f32 v[214:215], v[214:215], 1.0 op_sel_hi:[1,0]
    v_pk_add_f32 v[216:217], v[216:217], 1.0 op_sel_hi:[1,0]
    v_pk_add_f32 v[218:219], v[218:219], 1.0 op_sel_hi:[1,0]
    v_rcp_f32 v200, v200
    v_rcp_f32 v201, v201
    v_rcp_f32 v202, v202
    v_rcp_f32 v203, v203
    v_rcp_f32 v204, v204
    v_rcp_f32 v205, v205
    v_rcp_f32 v206, v206
    v_rcp_f32 v207, v207
    v_rcp_f32 v208, v208
    v_rcp_f32 v209, v209
    v_rcp_f32 v210, v210
    v_rcp_f32 v211, v211
    v_rcp_f32 v212, v212
    v_rcp_f32 v213, v213
    v_rcp_f32 v214, v214
    v_rcp_f32 v215, v215
    v_rcp_f32 v216, v216
    v_rcp_f32 v217, v217
    v_rcp_f32 v218, v218
    v_rcp_f32 v219, v219
    s_nop 0
    v_pk_mul_f32 v[156:157], v[156:157], v[200:201]
    v_pk_mul_f32 v[158:159], v[158:159], v[202:203]
    v_pk_mul_f32 v[160:161], v[160:161], v[204:205]
    v_pk_mul_f32 v[162:163], v[162:163], v[206:207]
    v_pk_mul_f32 v[164:165], v[164:165], v[208:209]
    v_pk_mul_f32 v[166:167], v[166:167], v[210:211]
    v_pk_mul_f32 v[168:169], v[168:169], v[212:213]
    v_pk_mul_f32 v[170:171], v[170:171], v[214:215]
    v_pk_mul_f32 v[172:173], v[172:173], v[216:217]
    v_pk_mul_f32 v[174:175], v[174:175], v[218:219]
    v_cvt_pk_bf16_f32 v156, v156, v157
    v_cvt_pk_bf16_f32 v157, v158, v159
    v_cvt_pk_bf16_f32 v158, v160, v161
    v_cvt_pk_bf16_f32 v159, v162, v163
    v_cvt_pk_bf16_f32 v164, v164, v165
    v_cvt_pk_bf16_f32 v165, v166, v167
    v_cvt_pk_bf16_f32 v166, v168, v169
    v_cvt_pk_bf16_f32 v167, v170, v171
    v_cvt_pk_bf16_f32 v172, v172, v173
    v_cvt_pk_bf16_f32 v173, v174, v175
    s_nop 1
    v_permlane16_swap_b32 v156, v158
    v_permlane16_swap_b32 v157, v159
    v_permlane16_swap_b32 v164, v166
    v_permlane16_swap_b32 v165, v167
    s_mov_b32 s46, s22
    s_lshl_b32 s41, s33, 2
    s_add_u32 s49, s55, s41
    s_cmp_eq_u32 s31, 0
    s_cbranch_scc1 k2_kernel_slow19
    buffer_store_dwordx4 v[156:159], v254, s[12:15], s46 offen offset:0
    buffer_store_dwordx4 v[164:167], v254, s[12:15], s46 offen offset:1024
    buffer_store_dwordx2 v[172:173], v8, s[12:15], s46 offen offset:2048
    s_waitcnt vmcnt(0)
    v_mov_b32 v9, 1
    v_mov_b32 v10, 2304
    s_mov_b64 exec, 1
    buffer_store_dword v9, v10, s[12:15], s49 offen
    s_mov_b64 exec, -1
    s_branch k2_kernel_sent20
k2_kernel_slow19:
    buffer_store_dwordx4 v[156:159], v254, s[12:15], s46 offen offset:0 sc1
    buffer_store_dwordx4 v[164:167], v254, s[12:15], s46 offen offset:1024 sc1
    buffer_store_dwordx2 v[172:173], v8, s[12:15], s46 offen offset:2048 sc1
    s_waitcnt vmcnt(0)
    v_mov_b32 v9, 1
    v_mov_b32 v10, 2304
    s_mov_b64 exec, 1
    buffer_store_dword v9, v10, s[12:15], s49 offen sc1
    s_mov_b64 exec, -1
k2_kernel_sent20:
    s_cmp_eq_u32 s21, 0
    s_cbranch_scc1 k2_kernel_xas23
    v_mov_b32 v9, 3
    v_mov_b32 v10, 0
    s_mov_b64 exec, 1
    s_cmp_eq_u32 s31, 0
    s_cbranch_scc1 k2_kernel_xas21
    buffer_store_dword v9, v10, s[12:15], s21 offen
    s_branch k2_kernel_xas22
k2_kernel_xas21:
    buffer_store_dword v9, v10, s[12:15], s21 offen sc1
k2_kernel_xas22:
    s_mov_b64 exec, -1
k2_kernel_xas23:
    s_sub_u32 s41, s55, s37
    s_lshr_b32 s41, s41, 7
    v_bfe_u32 v7, v1, 3, 2
    v_min_u32 v7, 2, v7
    v_add_u32 v7, s41, v7
    v_subrev_u32 v7, 1, v7
    v_max_i32 v7, 0, v7
    v_min_i32 v7, 15, v7
    v_lshlrev_b32 v7, 7, v7
    v_and_b32 v9, 7, v1
    v_lshl_add_u32 v7, v9, 2, v7
    s_add_u32 s49, s37, 2304
    s_mov_b32 s43, 200000
k2_kernel_poll24:
    buffer_load_dword v9, v7, s[12:15], s49 offen sc1
    s_waitcnt vmcnt(0)
    v_cmp_ne_u32 vcc, 0, v9
    s_sub_u32 s43, s43, 1
    s_cmp_eq_u64 vcc, -1
    s_cbranch_scc1 k2_kernel_go25
    s_cmp_lg_u32 s43, 0
    s_cbranch_scc1 k2_kernel_poll24
k2_kernel_go25:
    s_mul_i32 s41, s33, 2560
    s_sub_u32 s47, s22, s41
    s_mov_b32 s52, s47
    s_add_u32 s41, s52, 0
    buffer_load_dwordx4 v[16:19], v2, s[12:15], s41 offen offset:0 sc1
    s_add_u32 s41, s52, 0
    buffer_load_dwordx4 v[20:23], v2, s[12:15], s41 offen offset:1024 sc1
    s_add_u32 s41, s52, 0
    buffer_load_dwordx4 v[24:27], v2, s[12:15], s41 offen offset:2048 sc1
    s_add_u32 s41, s52, 0
    buffer_load_dwordx4 v[28:31], v2, s[12:15], s41 offen offset:3072 sc1
    s_add_u32 s41, s54, 20480
    s_mov_b32 s48, s41
    s_sub_u32 s41, s55, s37
    s_lshl_b32 s41, s41, 3
    s_add_u32 s46, s41, s36
    s_add_u32 s46, s46, 1581056
    s_barrier
    ds_read_b128 v[96:99], v15 offset:36864
    ds_read_b128 v[100:103], v15 offset:37888
    ds_read_b128 v[104:107], v15 offset:38912
    ds_read_b128 v[108:111], v15 offset:39936
    ds_read_b128 v[112:115], v15 offset:40960
    ds_read_b128 v[116:119], v15 offset:41984
    ds_read_b128 v[120:123], v15 offset:43008
    ds_read_b128 v[124:127], v15 offset:44032
    ds_read_b128 v[128:131], v15 offset:45056
    ds_read_b128 v[132:135], v15 offset:46080
    s_waitcnt vmcnt(3)
    s_waitcnt lgkmcnt(5)
    v_mfma_f32_16x16x32_bf16 v[156:159], v[96:99], v[16:19], 0
    s_add_u32 s41, s52, 4096
    buffer_load_dwordx4 v[32:35], v2, s[12:15], s41 offen offset:0 sc1
    v_mfma_f32_16x16x32_bf16 v[160:163], v[100:103], v[16:19], 0
    ds_read_b128 v[136:139], v15 offset:47104
    v_mfma_f32_16x16x32_bf16 v[164:167], v[104:107], v[16:19], 0
    ds_read_b128 v[140:143], v15 offset:48128
    v_mfma_f32_16x16x32_bf16 v[168:171], v[108:111], v[16:19], 0
    ds_read_b128 v[144:147], v15 offset:49152
    s_add_u32 s41, s52, 4096
    buffer_load_dwordx4 v[36:39], v2, s[12:15], s41 offen offset:1024 sc1
    v_mfma_f32_16x16x32_bf16 v[172:175], v[112:115], v[16:19], 0
    ds_read_b128 v[148:151], v15 offset:50176
    ds_read_b128 v[152:155], v15 offset:51200
    s_waitcnt vmcnt(4)
    s_waitcnt lgkmcnt(5)
    v_mfma_f32_16x16x32_bf16 v[156:159], v[116:119], v[20:23], v[156:159]
    s_add_u32 s41, s52, 4096
    buffer_load_dwordx4 v[40:43], v2, s[12:15], s41 offen offset:2048 sc1
    v_mfma_f32_16x16x32_bf16 v[160:163], v[120:123], v[20:23], v[160:163]
    ds_read_b128 v[96:99], v15 offset:52224
    v_mfma_f32_16x16x32_bf16 v[164:167], v[124:127], v[20:23], v[164:167]
    ds_read_b128 v[100:103], v15 offset:53248
    v_mfma_f32_16x16x32_bf16 v[168:171], v[128:131], v[20:23], v[168:171]
    ds_read_b128 v[104:107], v15 offset:54272
    s_add_u32 s41, s52, 4096
    buffer_load_dwordx4 v[44:47], v2, s[12:15], s41 offen offset:3072 sc1
    v_mfma_f32_16x16x32_bf16 v[172:175], v[132:135], v[20:23], v[172:175]
    ds_read_b128 v[108:111], v15 offset:55296
    ds_read_b128 v[112:115], v15 offset:56320
    s_waitcnt vmcnt(5)
    s_waitcnt lgkmcnt(5)
    v_mfma_f32_16x16x32_bf16 v[156:159], v[136:139], v[24:27], v[156:159]
    s_add_u32 s41, s52, 8192
    buffer_load_dwordx4 v[48:51], v2, s[12:15], s41 offen offset:0 sc1
    v_mfma_f32_16x16x32_bf16 v[160:163], v[140:143], v[24:27], v[160:163]
    ds_read_b128 v[116:119], v15 offset:57344
    v_mfma_f32_16x16x32_bf16 v[164:167], v[144:147], v[24:27], v[164:167]
    ds_read_b128 v[120:123], v15 offset:58368
    v_mfma_f32_16x16x32_bf16 v[168:171], v[148:151], v[24:27], v[168:171]
    ds_read_b128 v[124:127], v15 offset:59392
    s_add_u32 s41, s52, 8192
    buffer_load_dwordx4 v[52:55], v2, s[12:15], s41 offen offset:1024 sc1
    v_mfma_f32_16x16x32_bf16 v[172:175], v[152:155], v[24:27], v[172:175]
    ds_read_b128 v[128:131], v15 offset:60416
    ds_read_b128 v[132:135], v15 offset:61440
    s_waitcnt vmcnt(6)
    s_waitcnt lgkmcnt(5)
    v_mfma_f32_16x16x32_bf16 v[156:159], v[96:99], v[28:31], v[156:159]
    s_add_u32 s41, s52, 8192
    buffer_load_dwordx4 v[56:59], v2, s[12:15], s41 offen offset:2048 sc1
    v_mfma_f32_16x16x32_bf16 v[160:163], v[100:103], v[28:31], v[160:163]
    ds_read_b128 v[136:139], v15 offset:62464
    v_mfma_f32_16x16x32_bf16 v[164:167], v[104:107], v[28:31], v[164:167]
    ds_read_b128 v[140:143], v15 offset:63488
    v_mfma_f32_16x16x32_bf16 v[168:171], v[108:111], v[28:31], v[168:171]
    ds_read_b128 v[144:147], v15 offset:64512
    s_add_u32 s41, s52, 8192
    buffer_load_dwordx4 v[60:63], v2, s[12:15], s41 offen offset:3072 sc1
    v_mfma_f32_16x16x32_bf16 v[172:175], v[112:115], v[28:31], v[172:175]
    ds_read_b128 v[148:151], v11 offset:0
    ds_read_b128 v[152:155], v11 offset:1024
    s_waitcnt vmcnt(7)
    s_waitcnt lgkmcnt(5)
    v_mfma_f32_16x16x32_bf16 v[156:159], v[116:119], v[32:35], v[156:159]
    s_add_u32 s41, s52, 12288
    buffer_load_dwordx4 v[64:67], v2, s[12:15], s41 offen offset:0 sc1
    v_mfma_f32_16x16x32_bf16 v[160:163], v[120:123], v[32:35], v[160:163]
    ds_read_b128 v[96:99], v11 offset:2048
    v_mfma_f32_16x16x32_bf16 v[164:167], v[124:127], v[32:35], v[164:167]
    ds_read_b128 v[100:103], v11 offset:3072
    v_mfma_f32_16x16x32_bf16 v[168:171], v[128:131], v[32:35], v[168:171]
    ds_read_b128 v[104:107], v11 offset:4096
    s_add_u32 s41, s52, 12288
    buffer_load_dwordx4 v[68:71], v2, s[12:15], s41 offen offset:1024 sc1
    v_mfma_f32_16x16x32_bf16 v[172:175], v[132:135], v[32:35], v[172:175]
    ds_read_b128 v[108:111], v11 offset:5120
    ds_read_b128 v[112:115], v11 offset:6144
    s_waitcnt vmcnt(8)
    s_waitcnt lgkmcnt(5)
    v_mfma_f32_16x16x32_bf16 v[156:159], v[136:139], v[36:39], v[156:159]
    s_add_u32 s41, s52, 12288
    buffer_load_dwordx4 v[72:75], v2, s[12:15], s41 offen offset:2048 sc1
    v_mfma_f32_16x16x32_bf16 v[160:163], v[140:143], v[36:39], v[160:163]
    ds_read_b128 v[116:119], v11 offset:7168
    v_mfma_f32_16x16x32_bf16 v[164:167], v[144:147], v[36:39], v[164:167]
    ds_read_b128 v[120:123], v11 offset:8192
    v_mfma_f32_16x16x32_bf16 v[168:171], v[148:151], v[36:39], v[168:171]
    ds_read_b128 v[124:127], v11 offset:9216
    s_add_u32 s41, s52, 12288
    buffer_load_dwordx4 v[76:79], v2, s[12:15], s41 offen offset:3072 sc1
    v_mfma_f32_16x16x32_bf16 v[172:175], v[152:155], v[36:39], v[172:175]
    ds_read_b128 v[128:131], v11 offset:10240
    ds_read_b128 v[132:135], v11 offset:11264
    s_waitcnt vmcnt(9)
    s_waitcnt lgkmcnt(5)
    v_mfma_f32_16x16x32_bf16 v[156:159], v[96:99], v[40:43], v[156:159]
    s_add_u32 s41, s52, 16384
    buffer_load_dwordx4 v[80:83], v2, s[12:15], s41 offen offset:0 sc1
    v_mfma_f32_16x16x32_bf16 v[160:163], v[100:103], v[40:43], v[160:163]
    ds_read_b128 v[136:139], v11 offset:12288
    v_mfma_f32_16x16x32_bf16 v[164:167], v[104:107], v[40:43], v[164:167]
    ds_read_b128 v[140:143], v11 offset:13312
    v_mfma_f32_16x16x32_bf16 v[168:171], v[108:111], v[40:43], v[168:171]
    ds_read_b128 v[144:147], v11 offset:14336
    s_add_u32 s41, s52, 16384
    buffer_load_dwordx4 v[84:87], v2, s[12:15], s41 offen offset:1024 sc1
    v_mfma_f32_16x16x32_bf16 v[172:175], v[112:115], v[40:43], v[172:175]
    ds_read_b128 v[148:151], v11 offset:15360
    ds_read_b128 v[152:155], v11 offset:16384
    s_waitcnt vmcnt(10)
    s_waitcnt lgkmcnt(5)
    v_mfma_f32_16x16x32_bf16 v[156:159], v[116:119], v[44:47], v[156:159]
    s_add_u32 s41, s52, 16384
    buffer_load_dwordx4 v[88:91], v2, s[12:15], s41 offen offset:2048 sc1
    v_mfma_f32_16x16x32_bf16 v[160:163], v[120:123], v[44:47], v[160:163]
    ds_read_b128 v[96:99], v11 offset:17408
    v_mfma_f32_16x16x32_bf16 v[164:167], v[124:127], v[44:47], v[164:167]
    ds_read_b128 v[100:103], v11 offset:18432
    v_mfma_f32_16x16x32_bf16 v[168:171], v[128:131], v[44:47], v[168:171]
    ds_read_b128 v[104:107], v11 offset:19456
    s_add_u32 s41, s52, 16384
    buffer_load_dwordx4 v[92:95], v2, s[12:15], s41 offen offset:3072 sc1
    v_mfma_f32_16x16x32_bf16 v[172:175], v[132:135], v[44:47], v[172:175]
    ds_read_b128 v[108:111], v11 offset:20480
    ds_read_b128 v[112:115], v11 offset:21504
    s_waitcnt vmcnt(11)
    s_waitcnt lgkmcnt(5)
    v_mfma_f32_16x16x32_bf16 v[156:159], v[136:139], v[48:51], v[156:159]
    v_mfma_f32_16x16x32_bf16 v[160:163], v[140:143], v[48:51], v[160:163]
    ds_read_b128 v[116:119], v11 offset:22528
    buffer_load_dwordx4 v[176:179], v254, s[12:15], s48 offen sc1
    buffer_load_dwordx4 v[180:183], v254, s[12:15], s48 offen offset:1024 sc1
    buffer_load_dwordx2 v[184:185], v8, s[12:15], s48 offen offset:2048 sc1
    v_mfma_f32_16x16x32_bf16 v[164:167], v[144:147], v[48:51], v[164:167]
    ds_read_b128 v[120:123], v11 offset:23552
    v_mfma_f32_16x16x32_bf16 v[168:171], v[148:151], v[48:51], v[168:171]
    ds_read_b128 v[124:127], v14 offset:0
    v_mfma_f32_16x16x32_bf16 v[172:175], v[152:155], v[48:51], v[172:175]
    ds_read_b128 v[128:131], v14 offset:1024
    ds_read_b128 v[132:135], v14 offset:2048
    s_waitcnt vmcnt(13)
    s_waitcnt lgkmcnt(5)
    s_barrier
    v_mfma_f32_16x16x32_bf16 v[156:159], v[96:99], v[52:55], v[156:159]
    v_mfma_f32_16x16x32_bf16 v[160:163], v[100:103], v[52:55], v[160:163]
    ds_read_b128 v[136:139], v14 offset:3072
    v_mfma_f32_16x16x32_bf16 v[164:167], v[104:107], v[52:55], v[164:167]
    ds_read_b128 v[140:143], v14 offset:4096
    v_mfma_f32_16x16x32_bf16 v[168:171], v[108:111], v[52:55], v[168:171]
    ds_read_b128 v[144:147], v14 offset:5120
    v_mfma_f32_16x16x32_bf16 v[172:175], v[112:115], v[52:55], v[172:175]
    ds_read_b128 v[148:151], v14 offset:6144
    ds_read_b128 v[152:155], v14 offset:7168
    s_waitcnt vmcnt(12)
    s_waitcnt lgkmcnt(5)
    v_mfma_f32_16x16x32_bf16 v[156:159], v[116:119], v[56:59], v[156:159]
    v_mfma_f32_16x16x32_bf16 v[160:163], v[120:123], v[56:59], v[160:163]
    ds_read_b128 v[96:99], v14 offset:8192
    s_mul_i32 s38, s30, 12288
    s_add_u32 s39, s38, s45
    s_add_u32 s39, s39, 53248
    s_add_u32 s38, s38, 102400
    s_mov_b32 m0, s38
    s_nop 0
    buffer_load_dwordx4 v2, s[12:15], s39 offen offset:0 lds
    v_mfma_f32_16x16x32_bf16 v[164:167], v[124:127], v[56:59], v[164:167]
    ds_read_b128 v[100:103], v14 offset:9216
    v_mfma_f32_16x16x32_bf16 v[168:171], v[128:131], v[56:59], v[168:171]
    ds_read_b128 v[104:107], v14 offset:10240
    v_mfma_f32_16x16x32_bf16 v[172:175], v[132:135], v[56:59], v[172:175]
    ds_read_b128 v[108:111], v14 offset:11264
    ds_read_b128 v[112:115], v14 offset:12288
    s_mov_b32 m0, s38
    s_nop 0
    buffer_load_dwordx4 v2, s[12:15], s39 offen offset:1024 lds
    s_waitcnt vmcnt(13)
    s_waitcnt lgkmcnt(5)
    v_mfma_f32_16x16x32_bf16 v[156:159], v[136:139], v[60:63], v[156:159]
    v_mfma_f32_16x16x32_bf16 v[160:163], v[140:143], v[60:63], v[160:163]
    ds_read_b128 v[116:119], v14 offset:13312
    s_mov_b32 m0, s38
    s_nop 0
    buffer_load_dwordx4 v2, s[12:15], s39 offen offset:2048 lds
    v_mfma_f32_16x16x32_bf16 v[164:167], v[144:147], v[60:63], v[164:167]
    ds_read_b128 v[120:123], v14 offset:14336
    v_mfma_f32_16x16x32_bf16 v[168:171], v[148:151], v[60:63], v[168:171]
    ds_read_b128 v[124:127], v14 offset:15360
    v_mfma_f32_16x16x32_bf16 v[172:175], v[152:155], v[60:63], v[172:175]
    ds_read_b128 v[128:131], v14 offset:16384
    ds_read_b128 v[132:135], v14 offset:17408
    s_mov_b32 m0, s38
    s_nop 0
    buffer_load_dwordx4 v2, s[12:15], s39 offen offset:3072 lds
    s_add_u32 s38, s38, 4096
    s_add_u32 s39, s39, 4096
    s_waitcnt vmcnt(14)
    s_waitcnt lgkmcnt(5)
    v_mfma_f32_16x16x32_bf16 v[156:159], v[96:99], v[64:67], v[156:159]
    v_mfma_f32_16x16x32_bf16 v[160:163], v[100:103], v[64:67], v[160:163]
    ds_read_b128 v[136:139], v14 offset:18432
    s_mov_b32 m0, s38
    s_nop 0
    buffer_load_dwordx4 v2, s[12:15], s39 offen offset:0 lds
    v_mfma_f32_16x16x32_bf16 v[164:167], v[104:107], v[64:67], v[164:167]
    ds_read_b128 v[140:143], v14 offset:19456
    v_mfma_f32_16x16x32_bf16 v[168:171], v[108:111], v[64:67], v[168:171]
    ds_read_b128 v[144:147], v14 offset:20480
    v_mfma_f32_16x16x32_bf16 v[172:175], v[112:115], v[64:67], v[172:175]
    ds_read_b128 v[148:151], v14 offset:21504
    ds_read_b128 v[152:155], v14 offset:22528
    s_mov_b32 m0, s38
    s_nop 0
    buffer_load_dwordx4 v2, s[12:15], s39 offen offset:1024 lds
    s_waitcnt vmcnt(15)
    s_waitcnt lgkmcnt(5)
    v_mfma_f32_16x16x32_bf16 v[156:159], v[116:119], v[68:71], v[156:159]
    v_mfma_f32_16x16x32_bf16 v[160:163], v[120:123], v[68:71], v[160:163]
    ds_read_b128 v[96:99], v14 offset:23552
    s_mov_b32 m0, s38
    s_nop 0
    buffer_load_dwordx4 v2, s[12:15], s39 offen offset:2048 lds
    v_mfma_f32_16x16x32_bf16 v[164:167], v[124:127], v[68:71], v[164:167]
    ds_read_b128 v[100:103], v14 offset:24576
    v_mfma_f32_16x16x32_bf16 v[168:171], v[128:131], v[68:71], v[168:171]
    ds_read_b128 v[104:107], v14 offset:25600
    v_mfma_f32_16x16x32_bf16 v[172:175], v[132:135], v[68:71], v[172:175]
    ds_read_b128 v[108:111], v14 offset:26624
    ds_read_b128 v[112:115], v14 offset:27648
    s_mov_b32 m0, s38
    s_nop 0
    buffer_load_dwordx4 v2, s[12:15], s39 offen offset:3072 lds
    s_add_u32 s38, s38, 4096
    s_add_u32 s39, s39, 4096
    s_waitcnt vmcnt(16)
    s_waitcnt lgkmcnt(5)
    v_mfma_f32_16x16x32_bf16 v[156:159], v[136:139], v[72:75], v[156:159]
    v_mfma_f32_16x16x32_bf16 v[160:163], v[140:143], v[72:75], v[160:163]
    ds_read_b128 v[116:119], v14 offset:28672
    s_mov_b32 m0, s38
    s_nop 0
    buffer_load_dwordx4 v2, s[12:15], s39 offen offset:0 lds
    v_mfma_f32_16x16x32_bf16 v[164:167], v[144:147], v[72:75], v[164:167]
    ds_read_b128 v[120:123], v14 offset:29696
    v_mfma_f32_16x16x32_bf16 v[168:171], v[148:151], v[72:75], v[168:171]
    ds_read_b128 v[124:127], v14 offset:30720
    v_mfma_f32_16x16x32_bf16 v[172:175], v[152:155], v[72:75], v[172:175]
    ds_read_b128 v[128:131], v14 offset:31744
    ds_read_b128 v[132:135], v14 offset:32768
    s_mov_b32 m0, s38
    s_nop 0
    buffer_load_dwordx4 v2, s[12:15], s39 offen offset:1024 lds
    s_waitcnt vmcnt(17)
    s_waitcnt lgkmcnt(5)
    v_mfma_f32_16x16x32_bf16 v[156:159], v[96:99], v[76:79], v[156:159]
    v_mfma_f32_16x16x32_bf16 v[160:163], v[100:103], v[76:79], v[160:163]
    ds_read_b128 v[136:139], v14 offset:33792
    s_mov_b32 m0, s38
    s_nop 0
    buffer_load_dwordx4 v2, s[12:15], s39 offen offset:2048 lds
    v_mfma_f32_16x16x32_bf16 v[164:167], v[104:107], v[76:79], v[164:167]
    ds_read_b128 v[140:143], v14 offset:34816
    v_mfma_f32_16x16x32_bf16 v[168:171], v[108:111], v[76:79], v[168:171]
    ds_read_b128 v[144:147], v14 offset:35840
    v_mfma_f32_16x16x32_bf16 v[172:175], v[112:115], v[76:79], v[172:175]
    ds_read_b128 v[148:151], v14 offset:36864
    ds_read_b128 v[152:155], v14 offset:37888
    s_mov_b32 m0, s38
    s_nop 0
    buffer_load_dwordx4 v2, s[12:15], s39 offen offset:3072 lds
    s_waitcnt vmcnt(18)
    s_waitcnt lgkmcnt(5)
    v_mfma_f32_16x16x32_bf16 v[156:159], v[116:119], v[80:83], v[156:159]
    v_mfma_f32_16x16x32_bf16 v[160:163], v[120:123], v[80:83], v[160:163]
    ds_read_b128 v[96:99], v14 offset:38912
    v_mfma_f32_16x16x32_bf16 v[164:167], v[124:127], v[80:83], v[164:167]
    ds_read_b128 v[100:103], v14 offset:39936
    v_mfma_f32_16x16x32_bf16 v[168:171], v[128:131], v[80:83], v[168:171]
    ds_read_b128 v[104:107], v14 offset:40960
    v_mfma_f32_16x16x32_bf16 v[172:175], v[132:135], v[80:83], v[172:175]
    ds_read_b128 v[108:111], v14 offset:41984
    ds_read_b128 v[112:115], v14 offset:43008
    s_waitcnt vmcnt(17)
    s_waitcnt lgkmcnt(5)
    v_mfma_f32_16x16x32_bf16 v[156:159], v[136:139], v[84:87], v[156:159]
    v_mfma_f32_16x16x32_bf16 v[160:163], v[140:143], v[84:87], v[160:163]
    ds_read_b128 v[116:119], v14 offset:44032
    v_mfma_f32_16x16x32_bf16 v[164:167], v[144:147], v[84:87], v[164:167]
    ds_read_b128 v[120:123], v14 offset:45056
    v_mfma_f32_16x16x32_bf16 v[168:171], v[148:151], v[84:87], v[168:171]
    ds_read_b128 v[124:127], v14 offset:46080
    v_mfma_f32_16x16x32_bf16 v[172:175], v[152:155], v[84:87], v[172:175]
    ds_read_b128 v[128:131], v14 offset:47104
    ds_read_b128 v[132:135], v14 offset:48128
    s_waitcnt vmcnt(16)
    s_waitcnt lgkmcnt(5)
    v_mfma_f32_16x16x32_bf16 v[156:159], v[96:99], v[88:91], v[156:159]
    v_mfma_f32_16x16x32_bf16 v[160:163], v[100:103], v[88:91], v[160:163]
    v_mfma_f32_16x16x32_bf16 v[164:167], v[104:107], v[88:91], v[164:167]
    v_mfma_f32_16x16x32_bf16 v[168:171], v[108:111], v[88:91], v[168:171]
    v_mfma_f32_16x16x32_bf16 v[172:175], v[112:115], v[88:91], v[172:175]
    s_waitcnt vmcnt(15)
    s_waitcnt lgkmcnt(0)
    v_mfma_f32_16x16x32_bf16 v[156:159], v[116:119], v[92:95], v[156:159]
    v_mfma_f32_16x16x32_bf16 v[160:163], v[120:123], v[92:95], v[160:163]
    v_mfma_f32_16x16x32_bf16 v[164:167], v[124:127], v[92:95], v[164:167]
    v_mfma_f32_16x16x32_bf16 v[168:171], v[128:131], v[92:95], v[168:171]
    v_mfma_f32_16x16x32_bf16 v[172:175], v[132:135], v[92:95], v[172:175]
    s_barrier
    s_mul_i32 s38, s30, 1024
    s_add_u32 s39, s38, s45
    s_add_u32 s39, s39, 102400
    s_add_u32 s38, s38, 151552
    s_mov_b32 m0, s38
    s_nop 0
    buffer_load_dwordx4 v2, s[12:15], s39 offen offset:0 lds
    s_mul_i32 s38, s30, 9216
    s_add_u32 s39, s38, s45
    s_add_u32 s39, s39, 106496
    s_add_u32 s38, s38, 0
    s_mov_b32 m0, s38
    s_nop 0
    buffer_load_dwordx4 v2, s[12:15], s39 offen offset:0 lds
    s_mov_b32 m0, s38
    s_nop 0
    buffer_load_dwordx4 v2, s[12:15], s39 offen offset:1024 lds
    s_mov_b32 m0, s38
    s_nop 0
    buffer_load_dwordx4 v2, s[12:15], s39 offen offset:2048 lds
    s_mov_b32 m0, s38
    s_nop 0
    buffer_load_dwordx4 v2, s[12:15], s39 offen offset:3072 lds
    s_add_u32 s38, s38, 4096
    s_add_u32 s39, s39, 4096
    s_mov_b32 m0, s38
    s_nop 0
    buffer_load_dwordx4 v2, s[12:15], s39 offen offset:0 lds
    s_mov_b32 m0, s38
    s_nop 0
    buffer_load_dwordx4 v2, s[12:15], s39 offen offset:1024 lds
    s_mov_b32 m0, s38
    s_nop 0
    buffer_load_dwordx4 v2, s[12:15], s39 offen offset:2048 lds
    s_mov_b32 m0, s38
    s_nop 0
    buffer_load_dwordx4 v2, s[12:15], s39 offen offset:3072 lds
    s_add_u32 s38, s38, 4096
    s_add_u32 s39, s39, 4096
    s_mov_b32 m0, s38
    s_nop 0
    buffer_load_dwordx4 v2, s[12:15], s39 offen offset:0 lds
    v_mov_b32 v196, 0x3f803f80
    v_mov_b32 v198, 0
    v_mov_b32 v199, 0
    s_waitcnt vmcnt(22)
    s_nop 1
    v_permlane16_swap_b32 v176, v178
    v_permlane16_swap_b32 v177, v179
    v_permlane16_swap_b32 v180, v182
    v_permlane16_swap_b32 v181, v183
    s_nop 1
    v_lshlrev_b32 v200, 16, v176
    v_and_b32 v201, 0xffff0000, v176
    v_lshlrev_b32 v202, 16, v177
    v_and_b32 v203, 0xffff0000, v177
    v_lshlrev_b32 v204, 16, v178
    v_and_b32 v205, 0xffff0000, v178
    v_lshlrev_b32 v206, 16, v179
    v_and_b32 v207, 0xffff0000, v179
    v_lshlrev_b32 v208, 16, v180
    v_and_b32 v209, 0xffff0000, v180
    v_lshlrev_b32 v210, 16, v181
    v_and_b32 v211, 0xffff0000, v181
    v_lshlrev_b32 v212, 16, v182
    v_and_b32 v213, 0xffff0000, v182
    v_lshlrev_b32 v214, 16, v183
    v_and_b32 v215, 0xffff0000, v183
    v_lshlrev_b32 v216, 16, v184
    v_and_b32 v217, 0xffff0000, v184
    v_lshlrev_b32 v218, 16, v185
    v_and_b32 v219, 0xffff0000, v185
    v_pk_add_f32 v[156:157], v[156:157], v[200:201]
    v_pk_add_f32 v[158:159], v[158:159], v[202:203]
    v_pk_add_f32 v[160:161], v[160:161], v[204:205]
    v_pk_add_f32 v[162:163], v[162:163], v[206:207]
    v_pk_add_f32 v[164:165], v[164:165], v[208:209]
    v_pk_add_f32 v[166:167], v[166:167], v[210:211]
    v_pk_add_f32 v[168:169], v[168:169], v[212:213]
    v_pk_add_f32 v[170:171], v[170:171], v[214:215]
    v_pk_add_f32 v[172:173], v[172:173], v[216:217]
    v_pk_add_f32 v[174:175], v[174:175], v[218:219]
    v_cvt_pk_bf16_f32 v156, v156, v157
    v_cvt_pk_bf16_f32 v157, v158, v159
    v_cvt_pk_bf16_f32 v158, v160, v161
    v_cvt_pk_bf16_f32 v159, v162, v163
    v_cvt_pk_bf16_f32 v164, v164, v165
    v_cvt_pk_bf16_f32 v165, v166, v167
    v_cvt_pk_bf16_f32 v166, v168, v169
    v_cvt_pk_bf16_f32 v167, v170, v171
    v_cvt_pk_bf16_f32 v172, v172, v173
    v_cvt_pk_bf16_f32 v173, v174, v175
    v_dot2_f32_bf16 v198, v156, v196, v198
    v_dot2_f32_bf16 v199, v156, v156, v199
    v_dot2_f32_bf16 v198, v157, v196, v198
    v_dot2_f32_bf16 v199, v157, v157, v199
    v_dot2_f32_bf16 v198, v158, v196, v198
    v_dot2_f32_bf16 v199, v158, v158, v199
    v_dot2_f32_bf16 v198, v159, v196, v198
    v_dot2_f32_bf16 v199, v159, v159, v199
    v_dot2_f32_bf16 v198, v164, v196, v198
    v_dot2_f32_bf16 v199, v164, v164, v199
    v_dot2_f32_bf16 v198, v165, v196, v198
    v_dot2_f32_bf16 v199, v165, v165, v199
    v_dot2_f32_bf16 v198, v166, v196, v198
    v_dot2_f32_bf16 v199, v166, v166, v199
    v_dot2_f32_bf16 v198, v167, v196, v198
    v_dot2_f32_bf16 v199, v167, v167, v199
    v_dot2_f32_bf16 v198, v172, v196, v198
    v_dot2_f32_bf16 v199, v172, v172, v199
    v_dot2_f32_bf16 v198, v173, v196, v198
    v_dot2_f32_bf16 v199, v173, v173, v199
    s_nop 1
    s_nop 1
    v_permlane16_swap_b32 v156, v158
    v_permlane16_swap_b32 v157, v159
    v_permlane16_swap_b32 v164, v166
    v_permlane16_swap_b32 v165, v167
    s_nop 2
    v_mov_b32 v188, v198
    v_mov_b32 v189, v199
    s_nop 1
    v_permlane32_swap_b32 v188, v198
    v_permlane32_swap_b32 v189, v199
    s_nop 0
    v_add_f32 v198, v198, v188
    v_add_f32 v199, v199, v189
    v_mov_b32 v188, v198
    v_mov_b32 v189, v199
    s_nop 1
    v_permlane16_swap_b32 v188, v198
    v_permlane16_swap_b32 v189, v199
    s_nop 0
    v_add_f32 v198, v198, v188
    v_add_f32 v199, v199, v189
    s_add_u32 s47, s54, 20480
    v_lshlrev_b32 v9, 6, v4
    s_lshl_b32 s41, s33, 3
    s_add_u32 s46, s46, s41
    s_lshl_b32 s41, s33, 2
    s_add_u32 s49, s55, s41
    v_mov_b32 v11, v9
    s_cmp_eq_u32 s31, 0
    s_cbranch_scc1 k2_kernel_slow26
    buffer_store_dwordx4 v[156:159], v254, s[12:15], s47 offen offset:0
    buffer_store_dwordx4 v[164:167], v254, s[12:15], s47 offen offset:1024
    buffer_store_dwordx2 v[172:173], v8, s[12:15], s47 offen offset:2048
    s_mov_b64 exec, 0xffff
    buffer_store_dwordx2 v[198:199], v11, s[12:15], s46 offen
    s_mov_b64 exec, -1
    s_waitcnt vmcnt(0)
    v_mov_b32 v9, 1
    v_mov_b32 v10, 4352
    s_mov_b64 exec, 1
    buffer_store_dword v9, v10, s[12:15], s49 offen
    s_mov_b64 exec, -1
    s_branch k2_kernel_sent27
k2_kernel_slow26:
    buffer_store_dwordx4 v[156:159], v254, s[12:15], s47 offen offset:0 sc1
    buffer_store_dwordx4 v[164:167], v254, s[12:15], s47 offen offset:1024 sc1
    buffer_store_dwordx2 v[172:173], v8, s[12:15], s47 offen offset:2048 sc1
    s_mov_b64 exec, 0xffff
    buffer_store_dwordx2 v[198:199], v11, s[12:15], s46 offen sc1
    s_mov_b64 exec, -1
    s_waitcnt vmcnt(0)
    v_mov_b32 v9, 1
    v_mov_b32 v10, 4352
    s_mov_b64 exec, 1
    buffer_store_dword v9, v10, s[12:15], s49 offen sc1
    s_mov_b64 exec, -1
k2_kernel_sent27:
    s_lshl_b32 s46, s34, 3
    s_lshl_b32 s47, s30, 1
    s_add_u32 s46, s46, s47
    s_lshl_b32 s49, s46, 7
    s_add_u32 s49, s49, 4352
    v_bfe_u32 v7, v1, 3, 1
    v_lshlrev_b32 v7, 7, v7
    v_and_b32 v9, 7, v1
    v_lshl_add_u32 v7, v9, 2, v7
    v_add_u32 v7, s49, v7
    s_sub_u32 s49, s55, s37
    s_add_u32 s49, s49, 128
    v_and_b32 v9, 3, v1
    v_lshlrev_b32 v9, 2, v9
    v_add_u32 v9, s49, v9
    v_and_b32 v10, 16, v1
    v_cmp_ne_u32 vcc, 0, v10
    v_mov_b32 v11, 1
    v_mov_b32 v10, 3
    v_cndmask_b32 v7, v7, v9, vcc
    v_cndmask_b32 v10, v11, v10, vcc
    s_mov_b32 s43, 200000
k2_kernel_poll28:
    buffer_load_dword v9, v7, s[12:15], s37 offen sc1
    s_waitcnt vmcnt(0)
    v_cmp_le_u32 vcc, v10, v9
    s_sub_u32 s43, s43, 1
    s_cmp_eq_u64 vcc, -1
    s_cbranch_scc1 k2_kernel_go29
    s_cmp_lg_u32 s43, 0
    s_cbranch_scc1 k2_kernel_poll28
k2_kernel_go29:
    s_mul_i32 s47, s46, 20480
    s_add_u32 s47, s47, s36
    s_add_u32 s47, s47, 20480
    s_add_u32 s48, s47, 20480
    s_add_u32 s41, s47, 0
    buffer_load_dwordx4 v[72:75], v2, s[12:15], s41 offen offset:0 sc1
    s_add_u32 s41, s48, 0
    buffer_load_dwordx4 v[76:79], v2, s[12:15], s41 offen offset:0 sc1
    s_add_u32 s41, s47, 0
    buffer_load_dwordx4 v[80:83], v2, s[12:15], s41 offen offset:1024 sc1
    s_add_u32 s41, s48, 0
    buffer_load_dwordx4 v[84:87], v2, s[12:15], s41 offen offset:1024 sc1
    s_add_u32 s41, s47, 0
    buffer_load_dwordx4 v[88:91], v2, s[12:15], s41 offen offset:2048 sc1
    s_add_u32 s41, s48, 0
    buffer_load_dwordx4 v[92:95], v2, s[12:15], s41 offen offset:2048 sc1
    v_lshlrev_b32 v9, 6, v4
    v_lshl_add_u32 v9, v3, 4, v9
    s_lshl_b32 s41, s46, 10
    s_add_u32 s41, s41, s36
    s_add_u32 s41, s41, 1581056
    buffer_load_dwordx4 v[216:219], v9, s[12:15], s41 offen offset:0 sc1
    buffer_load_dwordx4 v[220:223], v9, s[12:15], s41 offen offset:1024 sc1
    s_mul_i32 s52, s46, 55296
    s_mul_i32 s41, s35, 3584
    s_add_u32 s52, s52, s41
    s_add_u32 s52, s52, s36
    s_add_u32 s52, s52, 696320
    s_add_u32 s53, s52, 55296
    s_barrier
    v_add_u32 v11, 0x20000, v2
    ds_read_b128 v[160:163], v14 offset:49152
    ds_read_b128 v[164:167], v14 offset:50176
    ds_read_b128 v[168:171], v14 offset:51200
    ds_read_b128 v[172:175], v14 offset:52224
    ds_read_b128 v[176:179], v14 offset:53248
    ds_read_b128 v[180:183], v14 offset:54272
    ds_read_b128 v[184:187], v14 offset:55296
    s_waitcnt vmcnt(6)
    s_waitcnt lgkmcnt(6)
    v_mfma_f32_16x16x32_bf16 v[16:19], v[160:163], v[72:75], 0
    v_mfma_f32_16x16x32_bf16 v[44:47], v[160:163], v[76:79], 0
    ds_read_b128 v[188:191], v14 offset:56320
    s_waitcnt lgkmcnt(6)
    v_mfma_f32_16x16x32_bf16 v[20:23], v[164:167], v[72:75], 0
    v_mfma_f32_16x16x32_bf16 v[48:51], v[164:167], v[76:79], 0
    ds_read_b128 v[192:195], v14 offset:57344
    s_add_u32 s41, s47, 0
    buffer_load_dwordx4 v[96:99], v2, s[12:15], s41 offen offset:3072 sc1
    s_add_u32 s41, s48, 0
    buffer_load_dwordx4 v[100:103], v2, s[12:15], s41 offen offset:3072 sc1
    s_waitcnt lgkmcnt(6)
    v_mfma_f32_16x16x32_bf16 v[24:27], v[168:171], v[72:75], 0
    v_mfma_f32_16x16x32_bf16 v[52:55], v[168:171], v[76:79], 0
    ds_read_b128 v[196:199], v14 offset:58368
    s_waitcnt lgkmcnt(6)
    v_mfma_f32_16x16x32_bf16 v[28:31], v[172:175], v[72:75], 0
    v_mfma_f32_16x16x32_bf16 v[56:59], v[172:175], v[76:79], 0
    ds_read_b128 v[200:203], v14 offset:59392
    s_waitcnt lgkmcnt(6)
    v_mfma_f32_16x16x32_bf16 v[32:35], v[176:179], v[72:75], 0
    v_mfma_f32_16x16x32_bf16 v[60:63], v[176:179], v[76:79], 0
    ds_read_b128 v[204:207], v14 offset:60416
    s_add_u32 s41, s47, 4096
    buffer_load_dwordx4 v[104:107], v2, s[12:15], s41 offen offset:0 sc1
    s_add_u32 s41, s48, 4096
    buffer_load_dwordx4 v[108:111], v2, s[12:15], s41 offen offset:0 sc1
    s_waitcnt lgkmcnt(6)
    v_mfma_f32_16x16x32_bf16 v[36:39], v[180:183], v[72:75], 0
    v_mfma_f32_16x16x32_bf16 v[64:67], v[180:183], v[76:79], 0
    ds_read_b128 v[208:211], v14 offset:61440
    s_waitcnt lgkmcnt(6)
    v_mfma_f32_16x16x32_bf16 v[40:43], v[184:187], v[72:75], 0
    v_mfma_f32_16x16x32_bf16 v[68:71], v[184:187], v[76:79], 0
    ds_read_b128 v[212:215], v14 offset:62464
    s_waitcnt vmcnt(8)
    s_waitcnt lgkmcnt(6)
    v_mfma_f32_16x16x32_bf16 v[16:19], v[188:191], v[80:83], v[16:19]
    v_mfma_f32_16x16x32_bf16 v[44:47], v[188:191], v[84:87], v[44:47]
    ds_read_b128 v[160:163], v14 offset:63488
    s_waitcnt lgkmcnt(6)
    v_mfma_f32_16x16x32_bf16 v[20:23], v[192:195], v[80:83], v[20:23]
    v_mfma_f32_16x16x32_bf16 v[48:51], v[192:195], v[84:87], v[48:51]
    ds_read_b128 v[164:167], v14 offset:64512
    s_add_u32 s41, s47, 4096
    buffer_load_dwordx4 v[112:115], v2, s[12:15], s41 offen offset:1024 sc1
    s_add_u32 s41, s48, 4096
    buffer_load_dwordx4 v[116:119], v2, s[12:15], s41 offen offset:1024 sc1
    s_waitcnt lgkmcnt(6)
    v_mfma_f32_16x16x32_bf16 v[24:27], v[196:199], v[80:83], v[24:27]
    v_mfma_f32_16x16x32_bf16 v[52:55], v[196:199], v[84:87], v[52:55]
    ds_read_b128 v[168:171], v15 offset:0
    buffer_load_dwordx4 a[0:3], v2, s[12:15], s40 offen offset:0
    s_waitcnt lgkmcnt(6)
    v_mfma_f32_16x16x32_bf16 v[28:31], v[200:203], v[80:83], v[28:31]
    v_mfma_f32_16x16x32_bf16 v[56:59], v[200:203], v[84:87], v[56:59]
    ds_read_b128 v[172:175], v15 offset:1024
    buffer_load_dwordx4 a[4:7], v2, s[12:15], s40 offen offset:1024
    s_waitcnt lgkmcnt(6)
    v_mfma_f32_16x16x32_bf16 v[32:35], v[204:207], v[80:83], v[32:35]
    v_mfma_f32_16x16x32_bf16 v[60:63], v[204:207], v[84:87], v[60:63]
    ds_read_b128 v[176:179], v15 offset:2048
    s_add_u32 s41, s47, 4096
    buffer_load_dwordx4 v[120:123], v2, s[12:15], s41 offen offset:2048 sc1
    s_add_u32 s41, s48, 4096
    buffer_load_dwordx4 v[124:127], v2, s[12:15], s41 offen offset:2048 sc1
    s_waitcnt lgkmcnt(6)
    v_mfma_f32_16x16x32_bf16 v[36:39], v[208:211], v[80:83], v[36:39]
    v_mfma_f32_16x16x32_bf16 v[64:67], v[208:211], v[84:87], v[64:67]
    ds_read_b128 v[180:183], v15 offset:3072
    buffer_load_dwordx4 a[8:11], v2, s[12:15], s40 offen offset:2048
    s_waitcnt lgkmcnt(6)
    v_mfma_f32_16x16x32_bf16 v[40:43], v[212:215], v[80:83], v[40:43]
    v_mfma_f32_16x16x32_bf16 v[68:71], v[212:215], v[84:87], v[68:71]
    ds_read_b128 v[184:187], v15 offset:4096
    s_waitcnt vmcnt(13)
    s_waitcnt lgkmcnt(6)
    v_mfma_f32_16x16x32_bf16 v[16:19], v[160:163], v[88:91], v[16:19]
    v_mfma_f32_16x16x32_bf16 v[44:47], v[160:163], v[92:95], v[44:47]
    ds_read_b128 v[188:191], v15 offset:5120
    s_waitcnt lgkmcnt(6)
    v_mfma_f32_16x16x32_bf16 v[20:23], v[164:167], v[88:91], v[20:23]
    v_mfma_f32_16x16x32_bf16 v[48:51], v[164:167], v[92:95], v[48:51]
    ds_read_b128 v[192:195], v15 offset:6144
    s_add_u32 s41, s47, 4096
    buffer_load_dwordx4 v[128:131], v2, s[12:15], s41 offen offset:3072 sc1
    s_add_u32 s41, s48, 4096
    buffer_load_dwordx4 v[132:135], v2, s[12:15], s41 offen offset:3072 sc1
    s_waitcnt lgkmcnt(6)
    v_mfma_f32_16x16x32_bf16 v[24:27], v[168:171], v[88:91], v[24:27]
    v_mfma_f32_16x16x32_bf16 v[52:55], v[168:171], v[92:95], v[52:55]
    ds_read_b128 v[196:199], v15 offset:7168
    buffer_load_dwordx4 a[12:15], v2, s[12:15], s40 offen offset:3072
    s_add_u32 s40, s40, 4096
    s_waitcnt lgkmcnt(6)
    v_mfma_f32_16x16x32_bf16 v[28:31], v[172:175], v[88:91], v[28:31]
    v_mfma_f32_16x16x32_bf16 v[56:59], v[172:175], v[92:95], v[56:59]
    ds_read_b128 v[200:203], v15 offset:8192
    buffer_load_dwordx4 a[16:19], v2, s[12:15], s40 offen offset:0
    s_waitcnt lgkmcnt(6)
    v_mfma_f32_16x16x32_bf16 v[32:35], v[176:179], v[88:91], v[32:35]
    v_mfma_f32_16x16x32_bf16 v[60:63], v[176:179], v[92:95], v[60:63]
    ds_read_b128 v[204:207], v15 offset:9216
    s_add_u32 s41, s47, 8192
    buffer_load_dwordx4 v[136:139], v2, s[12:15], s41 offen offset:0 sc1
    s_add_u32 s41, s48, 8192
    buffer_load_dwordx4 v[140:143], v2, s[12:15], s41 offen offset:0 sc1
    s_waitcnt lgkmcnt(6)
    v_mfma_f32_16x16x32_bf16 v[36:39], v[180:183], v[88:91], v[36:39]
    v_mfma_f32_16x16x32_bf16 v[64:67], v[180:183], v[92:95], v[64:67]
    ds_read_b128 v[208:211], v15 offset:10240
    buffer_load_dwordx4 a[20:23], v2, s[12:15], s40 offen offset:1024
    s_waitcnt lgkmcnt(6)
    v_mfma_f32_16x16x32_bf16 v[40:43], v[184:187], v[88:91], v[40:43]
    v_mfma_f32_16x16x32_bf16 v[68:71], v[184:187], v[92:95], v[68:71]
    ds_read_b128 v[212:215], v15 offset:11264
    s_waitcnt vmcnt(16)
    s_waitcnt lgkmcnt(6)
    v_mfma_f32_16x16x32_bf16 v[16:19], v[188:191], v[96:99], v[16:19]
    v_mfma_f32_16x16x32_bf16 v[44:47], v[188:191], v[100:103], v[44:47]
    ds_read_b128 v[160:163], v15 offset:12288
    s_waitcnt lgkmcnt(6)
    v_mfma_f32_16x16x32_bf16 v[20:23], v[192:195], v[96:99], v[20:23]
    v_mfma_f32_16x16x32_bf16 v[48:51], v[192:195], v[100:103], v[48:51]
    ds_read_b128 v[164:167], v15 offset:13312
    s_add_u32 s41, s47, 8192
    buffer_load_dwordx4 v[144:147], v2, s[12:15], s41 offen offset:1024 sc1
    s_add_u32 s41, s48, 8192
    buffer_load_dwordx4 v[148:151], v2, s[12:15], s41 offen offset:1024 sc1
    s_waitcnt lgkmcnt(6)
    v_mfma_f32_16x16x32_bf16 v[24:27], v[196:199], v[96:99], v[24:27]
    v_mfma_f32_16x16x32_bf16 v[52:55], v[196:199], v[100:103], v[52:55]
    ds_read_b128 v[168:171], v15 offset:14336
    buffer_load_dwordx4 a[24:27], v2, s[12:15], s40 offen offset:2048
    s_waitcnt lgkmcnt(6)
    v_mfma_f32_16x16x32_bf16 v[28:31], v[200:203], v[96:99], v[28:31]
    v_mfma_f32_16x16x32_bf16 v[56:59], v[200:203], v[100:103], v[56:59]
    ds_read_b128 v[172:175], v15 offset:15360
    buffer_load_dwordx4 a[28:31], v2, s[12:15], s40 offen offset:3072
    s_add_u32 s40, s40, 4096
    s_waitcnt lgkmcnt(6)
    v_mfma_f32_16x16x32_bf16 v[32:35], v[204:207], v[96:99], v[32:35]
    v_mfma_f32_16x16x32_bf16 v[60:63], v[204:207], v[100:103], v[60:63]
    ds_read_b128 v[176:179], v15 offset:16384
    s_waitcnt lgkmcnt(6)
    v_mfma_f32_16x16x32_bf16 v[36:39], v[208:211], v[96:99], v[36:39]
    v_mfma_f32_16x16x32_bf16 v[64:67], v[208:211], v[100:103], v[64:67]
    ds_read_b128 v[180:183], v15 offset:17408
    buffer_load_dwordx4 a[32:35], v2, s[12:15], s40 offen offset:0
    s_waitcnt lgkmcnt(6)
    v_mfma_f32_16x16x32_bf16 v[40:43], v[212:215], v[96:99], v[40:43]
    v_mfma_f32_16x16x32_bf16 v[68:71], v[212:215], v[100:103], v[68:71]
    ds_read_b128 v[184:187], v15 offset:18432
    s_waitcnt vmcnt(19)
    s_waitcnt lgkmcnt(6)
    v_mfma_f32_16x16x32_bf16 v[16:19], v[160:163], v[104:107], v[16:19]
    v_mfma_f32_16x16x32_bf16 v[44:47], v[160:163], v[108:111], v[44:47]
    ds_read_b128 v[188:191], v15 offset:19456
    s_waitcnt lgkmcnt(6)
    v_mfma_f32_16x16x32_bf16 v[20:23], v[164:167], v[104:107], v[20:23]
    v_mfma_f32_16x16x32_bf16 v[48:51], v[164:167], v[108:111], v[48:51]
    ds_read_b128 v[192:195], v15 offset:20480
    s_add_u32 s41, s47, 8192
    buffer_load_dwordx4 v[152:155], v2, s[12:15], s41 offen offset:2048 sc1
    s_add_u32 s41, s48, 8192
    buffer_load_dwordx4 v[156:159], v2, s[12:15], s41 offen offset:2048 sc1
    s_waitcnt lgkmcnt(6)
    v_mfma_f32_16x16x32_bf16 v[24:27], v[168:171], v[104:107], v[24:27]
    v_mfma_f32_16x16x32_bf16 v[52:55], v[168:171], v[108:111], v[52:55]
    ds_read_b128 v[196:199], v15 offset:21504
    buffer_load_dwordx4 a[36:39], v2, s[12:15], s40 offen offset:1024
    s_waitcnt lgkmcnt(6)
    v_mfma_f32_16x16x32_bf16 v[28:31], v[172:175], v[104:107], v[28:31]
    v_mfma_f32_16x16x32_bf16 v[56:59], v[172:175], v[108:111], v[56:59]
    ds_read_b128 v[200:203], v15 offset:22528
    buffer_load_dwordx4 a[40:43], v2, s[12:15], s40 offen offset:2048
    s_waitcnt lgkmcnt(6)
    v_mfma_f32_16x16x32_bf16 v[32:35], v[176:179], v[104:107], v[32:35]
    v_mfma_f32_16x16x32_bf16 v[60:63], v[176:179], v[108:111], v[60:63]
    ds_read_b128 v[204:207], v15 offset:23552
    s_waitcnt lgkmcnt(6)
    v_mfma_f32_16x16x32_bf16 v[36:39], v[180:183], v[104:107], v[36:39]
    v_mfma_f32_16x16x32_bf16 v[64:67], v[180:183], v[108:111], v[64:67]
    ds_read_b128 v[208:211], v15 offset:24576
    buffer_load_dwordx4 a[44:47], v2, s[12:15], s40 offen offset:3072
    s_add_u32 s40, s40, 4096
    s_waitcnt lgkmcnt(6)
    v_mfma_f32_16x16x32_bf16 v[40:43], v[184:187], v[104:107], v[40:43]
    v_mfma_f32_16x16x32_bf16 v[68:71], v[184:187], v[108:111], v[68:71]
    ds_read_b128 v[212:215], v15 offset:25600
    s_waitcnt vmcnt(22)
    s_waitcnt lgkmcnt(6)
    v_mfma_f32_16x16x32_bf16 v[16:19], v[188:191], v[112:115], v[16:19]
    v_mfma_f32_16x16x32_bf16 v[44:47], v[188:191], v[116:119], v[44:47]
    ds_read_b128 v[160:163], v15 offset:26624
    v_add_f32 v224, v216, v218
    v_add_f32 v225, v217, v219
    s_waitcnt lgkmcnt(6)
    v_mfma_f32_16x16x32_bf16 v[20:23], v[192:195], v[112:115], v[20:23]
    v_mfma_f32_16x16x32_bf16 v[48:51], v[192:195], v[116:119], v[48:51]
    ds_read_b128 v[164:167], v15 offset:27648
    s_add_u32 s41, s47, 8192
    buffer_load_dwordx4 v[72:75], v2, s[12:15], s41 offen offset:3072 sc1
    s_add_u32 s41, s48, 8192
    buffer_load_dwordx4 v[76:79], v2, s[12:15], s41 offen offset:3072 sc1
    v_mov_b32 v216, v224
    v_mov_b32 v217, v225
    s_waitcnt lgkmcnt(6)
    v_mfma_f32_16x16x32_bf16 v[24:27], v[196:199], v[112:115], v[24:27]
    v_mfma_f32_16x16x32_bf16 v[52:55], v[196:199], v[116:119], v[52:55]
    ds_read_b128 v[168:171], v15 offset:28672
    buffer_load_dwordx4 a[48:51], v2, s[12:15], s40 offen offset:0
    s_nop 1
    v_permlane32_swap_b32 v216, v224
    s_waitcnt lgkmcnt(6)
    v_mfma_f32_16x16x32_bf16 v[28:31], v[200:203], v[112:115], v[28:31]
    v_mfma_f32_16x16x32_bf16 v[56:59], v[200:203], v[116:119], v[56:59]
    ds_read_b128 v[172:175], v15 offset:29696
    buffer_load_dwordx4 a[52:55], v2, s[12:15], s40 offen offset:1024
    v_permlane32_swap_b32 v217, v225
    s_nop 0
    s_waitcnt lgkmcnt(6)
    v_mfma_f32_16x16x32_bf16 v[32:35], v[204:207], v[112:115], v[32:35]
    v_mfma_f32_16x16x32_bf16 v[60:63], v[204:207], v[116:119], v[60:63]
    ds_read_b128 v[176:179], v15 offset:30720
    v_add_f32 v224, v224, v216
    v_add_f32 v225, v225, v217
    s_waitcnt lgkmcnt(6)
    v_mfma_f32_16x16x32_bf16 v[36:39], v[208:211], v[112:115], v[36:39]
    v_mfma_f32_16x16x32_bf16 v[64:67], v[208:211], v[116:119], v[64:67]
    ds_read_b128 v[180:183], v15 offset:31744
    buffer_load_dwordx4 a[56:59], v2, s[12:15], s40 offen offset:2048
    v_mov_b32 v216, v224
    v_mov_b32 v217, v225
    s_waitcnt lgkmcnt(6)
    v_mfma_f32_16x16x32_bf16 v[40:43], v[212:215], v[112:115], v[40:43]
    v_mfma_f32_16x16x32_bf16 v[68:71], v[212:215], v[116:119], v[68:71]
    ds_read_b128 v[184:187], v15 offset:32768
    s_nop 1
    v_permlane16_swap_b32 v216, v224
    s_waitcnt vmcnt(23)
    s_waitcnt lgkmcnt(6)
    v_mfma_f32_16x16x32_bf16 v[16:19], v[160:163], v[120:123], v[16:19]
    v_mfma_f32_16x16x32_bf16 v[44:47], v[160:163], v[124:127], v[44:47]
    ds_read_b128 v[188:191], v15 offset:33792
    v_permlane16_swap_b32 v217, v225
    s_nop 0
    s_waitcnt lgkmcnt(6)
    v_mfma_f32_16x16x32_bf16 v[20:23], v[164:167], v[120:123], v[20:23]
    v_mfma_f32_16x16x32_bf16 v[48:51], v[164:167], v[124:127], v[48:51]
    ds_read_b128 v[192:195], v15 offset:34816
    s_add_u32 s41, s47, 12288
    buffer_load_dwordx4 v[80:83], v2, s[12:15], s41 offen offset:0 sc1
    s_add_u32 s41, s48, 12288
    buffer_load_dwordx4 v[84:87], v2, s[12:15], s41 offen offset:0 sc1
    v_add_f32 v224, v224, v216
    v_add_f32 v225, v225, v217
    s_waitcnt lgkmcnt(6)
    v_mfma_f32_16x16x32_bf16 v[24:27], v[168:171], v[120:123], v[24:27]
    v_mfma_f32_16x16x32_bf16 v[52:55], v[168:171], v[124:127], v[52:55]
    ds_read_b128 v[196:199], v15 offset:35840
    buffer_load_dwordx4 a[60:63], v2, s[12:15], s40 offen offset:3072
    s_add_u32 s40, s40, 4096
    v_mul_f32 v224, 0x3acccccd, v224
    v_mul_f32 v225, 0x3acccccd, v225
    s_waitcnt lgkmcnt(6)
    v_mfma_f32_16x16x32_bf16 v[28:31], v[172:175], v[120:123], v[28:31]
    v_mfma_f32_16x16x32_bf16 v[56:59], v[172:175], v[124:127], v[56:59]
    ds_read_b128 v[200:203], v15 offset:36864
    buffer_load_dwordx4 a[64:67], v2, s[12:15], s40 offen offset:0
    v_fma_f32 v225, -v224, v224, v225
    v_max_f32 v225, 0, v225
    s_waitcnt lgkmcnt(6)
    v_mfma_f32_16x16x32_bf16 v[32:35], v[176:179], v[120:123], v[32:35]
    v_mfma_f32_16x16x32_bf16 v[60:63], v[176:179], v[124:127], v[60:63]
    ds_read_b128 v[204:207], v15 offset:37888
    v_cvt_pk_bf16_f32 v216, v224, v225
    v_lshlrev_b32 v224, 16, v216
    s_waitcnt lgkmcnt(6)
    v_mfma_f32_16x16x32_bf16 v[36:39], v[180:183], v[120:123], v[36:39]
    v_mfma_f32_16x16x32_bf16 v[64:67], v[180:183], v[124:127], v[64:67]
    ds_read_b128 v[208:211], v15 offset:38912
    buffer_load_dwordx4 a[68:71], v2, s[12:15], s40 offen offset:1024
    v_and_b32 v225, 0xffff0000, v216
    v_add_f32 v225, 0x3727c5ac, v225
    s_waitcnt lgkmcnt(6)
    v_mfma_f32_16x16x32_bf16 v[40:43], v[184:187], v[120:123], v[40:43]
    v_mfma_f32_16x16x32_bf16 v[68:71], v[184:187], v[124:127], v[68:71]
    ds_read_b128 v[212:215], v15 offset:39936
    v_cvt_pk_bf16_f32 v216, v225, v225
    v_lshlrev_b32 v225, 16, v216
    s_waitcnt vmcnt(25)
    s_waitcnt lgkmcnt(6)
    v_mfma_f32_16x16x32_bf16 v[16:19], v[188:191], v[128:131], v[16:19]
    v_mfma_f32_16x16x32_bf16 v[44:47], v[188:191], v[132:135], v[44:47]
    ds_read_b128 v[160:163], v15 offset:40960
    v_sqrt_f32 v225, v225
    s_nop 0
    s_waitcnt lgkmcnt(6)
    v_mfma_f32_16x16x32_bf16 v[20:23], v[192:195], v[128:131], v[20:23]
    v_mfma_f32_16x16x32_bf16 v[48:51], v[192:195], v[132:135], v[48:51]
    ds_read_b128 v[164:167], v15 offset:41984
    s_add_u32 s41, s47, 12288
    buffer_load_dwordx4 v[88:91], v2, s[12:15], s41 offen offset:1024 sc1
    s_add_u32 s41, s48, 12288
    buffer_load_dwordx4 v[92:95], v2, s[12:15], s41 offen offset:1024 sc1
    v_cvt_pk_bf16_f32 v216, v225, v225
    v_lshlrev_b32 v225, 16, v216
    s_waitcnt lgkmcnt(6)
    v_mfma_f32_16x16x32_bf16 v[24:27], v[196:199], v[128:131], v[24:27]
    v_mfma_f32_16x16x32_bf16 v[52:55], v[196:199], v[132:135], v[52:55]
    ds_read_b128 v[168:171], v15 offset:43008
    buffer_load_dwordx4 a[72:75], v2, s[12:15], s40 offen offset:2048
    v_rcp_f32 v225, v225
    s_nop 0
    s_waitcnt lgkmcnt(6)
    v_mfma_f32_16x16x32_bf16 v[28:31], v[200:203], v[128:131], v[28:31]
    v_mfma_f32_16x16x32_bf16 v[56:59], v[200:203], v[132:135], v[56:59]
    ds_read_b128 v[172:175], v15 offset:44032
    buffer_load_dwordx4 a[76:79], v2, s[12:15], s40 offen offset:3072
    s_add_u32 s40, s40, 4096
    v_mul_f32 v224, v224, v225
    v_sub_f32 v224, 0, v224
    s_waitcnt lgkmcnt(6)
    v_mfma_f32_16x16x32_bf16 v[32:35], v[204:207], v[128:131], v[32:35]
    v_mfma_f32_16x16x32_bf16 v[60:63], v[204:207], v[132:135], v[60:63]
    ds_read_b128 v[176:179], v15 offset:45056
    v_add_f32 v226, v220, v222
    v_add_f32 v227, v221, v223
    s_waitcnt lgkmcnt(6)
    v_mfma_f32_16x16x32_bf16 v[36:39], v[208:211], v[128:131], v[36:39]
    v_mfma_f32_16x16x32_bf16 v[64:67], v[208:211], v[132:135], v[64:67]
    ds_read_b128 v[180:183], v15 offset:46080
    buffer_load_dwordx4 a[80:83], v2, s[12:15], s40 offen offset:0
    v_mov_b32 v216, v226
    v_mov_b32 v217, v227
    s_waitcnt lgkmcnt(6)
    v_mfma_f32_16x16x32_bf16 v[40:43], v[212:215], v[128:131], v[40:43]
    v_mfma_f32_16x16x32_bf16 v[68:71], v[212:215], v[132:135], v[68:71]
    ds_read_b128 v[184:187], v15 offset:47104
    s_nop 1
    v_permlane32_swap_b32 v216, v226
    s_waitcnt vmcnt(26)
    s_waitcnt lgkmcnt(6)
    v_mfma_f32_16x16x32_bf16 v[16:19], v[160:163], v[136:139], v[16:19]
    v_mfma_f32_16x16x32_bf16 v[44:47], v[160:163], v[140:143], v[44:47]
    ds_read_b128 v[188:191], v15 offset:48128
    v_permlane32_swap_b32 v217, v227
    s_nop 0
    s_waitcnt lgkmcnt(6)
    v_mfma_f32_16x16x32_bf16 v[20:23], v[164:167], v[136:139], v[20:23]
    v_mfma_f32_16x16x32_bf16 v[48:51], v[164:167], v[140:143], v[48:51]
    ds_read_b128 v[192:195], v15 offset:49152
    s_add_u32 s41, s47, 12288
    buffer_load_dwordx4 v[96:99], v2, s[12:15], s41 offen offset:2048 sc1
    s_add_u32 s41, s48, 12288
    buffer_load_dwordx4 v[100:103], v2, s[12:15], s41 offen offset:2048 sc1
    v_add_f32 v226, v226, v216
    v_add_f32 v227, v227, v217
    s_waitcnt lgkmcnt(6)
    v_mfma_f32_16x16x32_bf16 v[24:27], v[168:171], v[136:139], v[24:27]
    v_mfma_f32_16x16x32_bf16 v[52:55], v[168:171], v[140:143], v[52:55]
    ds_read_b128 v[196:199], v15 offset:50176
    buffer_load_dwordx4 a[84:87], v2, s[12:15], s40 offen offset:1024
    v_mov_b32 v216, v226
    v_mov_b32 v217, v227
    s_waitcnt lgkmcnt(6)
    v_mfma_f32_16x16x32_bf16 v[28:31], v[172:175], v[136:139], v[28:31]
    v_mfma_f32_16x16x32_bf16 v[56:59], v[172:175], v[140:143], v[56:59]
    ds_read_b128 v[200:203], v15 offset:51200
    buffer_load_dwordx4 a[88:91], v2, s[12:15], s40 offen offset:2048
    s_nop 1
    v_permlane16_swap_b32 v216, v226
    s_waitcnt lgkmcnt(6)
    v_mfma_f32_16x16x32_bf16 v[32:35], v[176:179], v[136:139], v[32:35]
    v_mfma_f32_16x16x32_bf16 v[60:63], v[176:179], v[140:143], v[60:63]
    ds_read_b128 v[204:207], v15 offset:52224
    v_permlane16_swap_b32 v217, v227
    s_nop 0
    s_waitcnt lgkmcnt(6)
    v_mfma_f32_16x16x32_bf16 v[36:39], v[180:183], v[136:139], v[36:39]
    v_mfma_f32_16x16x32_bf16 v[64:67], v[180:183], v[140:143], v[64:67]
    ds_read_b128 v[208:211], v15 offset:53248
    buffer_load_dwordx4 a[92:95], v2, s[12:15], s40 offen offset:3072
    s_add_u32 s40, s40, 4096
    v_add_f32 v226, v226, v216
    v_add_f32 v227, v227, v217
    s_waitcnt lgkmcnt(6)
    v_mfma_f32_16x16x32_bf16 v[40:43], v[184:187], v[136:139], v[40:43]
    v_mfma_f32_16x16x32_bf16 v[68:71], v[184:187], v[140:143], v[68:71]
    ds_read_b128 v[212:215], v15 offset:54272
    v_mul_f32 v226, 0x3acccccd, v226
    v_mul_f32 v227, 0x3acccccd, v227
    s_waitcnt vmcnt(28)
    s_waitcnt lgkmcnt(6)
    v_mfma_f32_16x16x32_bf16 v[16:19], v[188:191], v[144:147], v[16:19]
    v_mfma_f32_16x16x32_bf16 v[44:47], v[188:191], v[148:151], v[44:47]
    ds_read_b128 v[160:163], v15 offset:55296
    v_fma_f32 v227, -v226, v226, v227
    v_max_f32 v227, 0, v227
    s_waitcnt lgkmcnt(6)
    v_mfma_f32_16x16x32_bf16 v[20:23], v[192:195], v[144:147], v[20:23]
    v_mfma_f32_16x16x32_bf16 v[48:51], v[192:195], v[148:151], v[48:51]
    ds_read_b128 v[164:167], v15 offset:56320
    s_add_u32 s41, s47, 12288
    buffer_load_dwordx4 v[104:107], v2, s[12:15], s41 offen offset:3072 sc1
    s_add_u32 s41, s48, 12288
    buffer_load_dwordx4 v[108:111], v2, s[12:15], s41 offen offset:3072 sc1
    v_cvt_pk_bf16_f32 v216, v226, v227
    v_lshlrev_b32 v226, 16, v216
    s_waitcnt lgkmcnt(6)
    v_mfma_f32_16x16x32_bf16 v[24:27], v[196:199], v[144:147], v[24:27]
    v_mfma_f32_16x16x32_bf16 v[52:55], v[196:199], v[148:151], v[52:55]
    ds_read_b128 v[168:171], v15 offset:57344
    buffer_load_dwordx4 a[96:99], v2, s[12:15], s40 offen offset:0
    v_and_b32 v227, 0xffff0000, v216
    v_add_f32 v227, 0x3727c5ac, v227
    s_waitcnt lgkmcnt(6)
    v_mfma_f32_16x16x32_bf16 v[28:31], v[200:203], v[144:147], v[28:31]
    v_mfma_f32_16x16x32_bf16 v[56:59], v[200:203], v[148:151], v[56:59]
    ds_read_b128 v[172:175], v15 offset:58368
    buffer_load_dwordx4 a[100:103], v2, s[12:15], s40 offen offset:1024
    v_cvt_pk_bf16_f32 v216, v227, v227
    v_lshlrev_b32 v227, 16, v216
    s_waitcnt lgkmcnt(6)
    v_mfma_f32_16x16x32_bf16 v[32:35], v[204:207], v[144:147], v[32:35]
    v_mfma_f32_16x16x32_bf16 v[60:63], v[204:207], v[148:151], v[60:63]
    ds_read_b128 v[176:179], v15 offset:59392
    v_sqrt_f32 v227, v227
    s_nop 0
    s_waitcnt lgkmcnt(6)
    v_mfma_f32_16x16x32_bf16 v[36:39], v[208:211], v[144:147], v[36:39]
    v_mfma_f32_16x16x32_bf16 v[64:67], v[208:211], v[148:151], v[64:67]
    ds_read_b128 v[180:183], v15 offset:60416
    buffer_load_dwordx4 a[104:107], v2, s[12:15], s40 offen offset:2048
    v_cvt_pk_bf16_f32 v216, v227, v227
    v_lshlrev_b32 v227, 16, v216
    s_waitcnt lgkmcnt(6)
    v_mfma_f32_16x16x32_bf16 v[40:43], v[212:215], v[144:147], v[40:43]
    v_mfma_f32_16x16x32_bf16 v[68:71], v[212:215], v[148:151], v[68:71]
    ds_read_b128 v[184:187], v15 offset:61440
    v_rcp_f32 v227, v227
    s_nop 0
    s_waitcnt vmcnt(28)
    s_waitcnt lgkmcnt(6)
    v_mfma_f32_16x16x32_bf16 v[16:19], v[160:163], v[152:155], v[16:19]
    v_mfma_f32_16x16x32_bf16 v[44:47], v[160:163], v[156:159], v[44:47]
    ds_read_b128 v[188:191], v15 offset:62464
    v_mul_f32 v226, v226, v227
    v_sub_f32 v226, 0, v226
    s_waitcnt lgkmcnt(6)
    v_mfma_f32_16x16x32_bf16 v[20:23], v[164:167], v[152:155], v[20:23]
    v_mfma_f32_16x16x32_bf16 v[48:51], v[164:167], v[156:159], v[48:51]
    ds_read_b128 v[192:195], v15 offset:63488
    s_add_u32 s41, s47, 16384
    buffer_load_dwordx4 v[112:115], v2, s[12:15], s41 offen offset:0 sc1
    s_add_u32 s41, s48, 16384
    buffer_load_dwordx4 v[116:119], v2, s[12:15], s41 offen offset:0 sc1
    s_waitcnt lgkmcnt(6)
    v_mfma_f32_16x16x32_bf16 v[24:27], v[168:171], v[152:155], v[24:27]
    v_mfma_f32_16x16x32_bf16 v[52:55], v[168:171], v[156:159], v[52:55]
    ds_read_b128 v[196:199], v15 offset:64512
    buffer_load_dwordx4 a[108:111], v2, s[12:15], s40 offen offset:3072
    s_add_u32 s40, s40, 4096
    s_waitcnt lgkmcnt(6)
    v_mfma_f32_16x16x32_bf16 v[28:31], v[172:175], v[152:155], v[28:31]
    v_mfma_f32_16x16x32_bf16 v[56:59], v[172:175], v[156:159], v[56:59]
    ds_read_b128 v[200:203], v11 offset:0
    buffer_load_dwordx4 a[112:115], v2, s[12:15], s40 offen offset:0
    s_waitcnt lgkmcnt(6)
    v_mfma_f32_16x16x32_bf16 v[32:35], v[176:179], v[152:155], v[32:35]
    v_mfma_f32_16x16x32_bf16 v[60:63], v[176:179], v[156:159], v[60:63]
    ds_read_b128 v[204:207], v11 offset:1024
    s_waitcnt lgkmcnt(6)
    v_mfma_f32_16x16x32_bf16 v[36:39], v[180:183], v[152:155], v[36:39]
    v_mfma_f32_16x16x32_bf16 v[64:67], v[180:183], v[156:159], v[64:67]
    ds_read_b128 v[208:211], v11 offset:2048
    buffer_load_dwordx4 a[116:119], v2, s[12:15], s40 offen offset:1024
    s_waitcnt lgkmcnt(6)
    v_mfma_f32_16x16x32_bf16 v[40:43], v[184:187], v[152:155], v[40:43]
    v_mfma_f32_16x16x32_bf16 v[68:71], v[184:187], v[156:159], v[68:71]
    ds_read_b128 v[212:215], v11 offset:3072
    s_waitcnt vmcnt(28)
    s_waitcnt lgkmcnt(6)
    v_mfma_f32_16x16x32_bf16 v[16:19], v[188:191], v[72:75], v[16:19]
    v_mfma_f32_16x16x32_bf16 v[44:47], v[188:191], v[76:79], v[44:47]
    ds_read_b128 v[160:163], v11 offset:4096
    s_waitcnt lgkmcnt(6)
    v_mfma_f32_16x16x32_bf16 v[20:23], v[192:195], v[72:75], v[20:23]
    v_mfma_f32_16x16x32_bf16 v[48:51], v[192:195], v[76:79], v[48:51]
    ds_read_b128 v[164:167], v11 offset:5120
    s_add_u32 s41, s47, 16384
    buffer_load_dwordx4 v[120:123], v2, s[12:15], s41 offen offset:1024 sc1
    s_add_u32 s41, s48, 16384
    buffer_load_dwordx4 v[124:127], v2, s[12:15], s41 offen offset:1024 sc1
    s_waitcnt lgkmcnt(6)
    v_mfma_f32_16x16x32_bf16 v[24:27], v[196:199], v[72:75], v[24:27]
    v_mfma_f32_16x16x32_bf16 v[52:55], v[196:199], v[76:79], v[52:55]
    ds_read_b128 v[168:171], v11 offset:6144
    buffer_load_dwordx4 a[120:123], v2, s[12:15], s40 offen offset:2048
    s_waitcnt lgkmcnt(6)
    v_mfma_f32_16x16x32_bf16 v[28:31], v[200:203], v[72:75], v[28:31]
    v_mfma_f32_16x16x32_bf16 v[56:59], v[200:203], v[76:79], v[56:59]
    ds_read_b128 v[172:175], v11 offset:7168
    buffer_load_dwordx4 a[124:127], v2, s[12:15], s40 offen offset:3072
    s_add_u32 s40, s40, 4096
    s_waitcnt lgkmcnt(6)
    v_mfma_f32_16x16x32_bf16 v[32:35], v[204:207], v[72:75], v[32:35]
    v_mfma_f32_16x16x32_bf16 v[60:63], v[204:207], v[76:79], v[60:63]
    ds_read_b128 v[176:179], v11 offset:8192
    s_waitcnt lgkmcnt(6)
    v_mfma_f32_16x16x32_bf16 v[36:39], v[208:211], v[72:75], v[36:39]
    v_mfma_f32_16x16x32_bf16 v[64:67], v[208:211], v[76:79], v[64:67]
    ds_read_b128 v[180:183], v11 offset:9216
    buffer_load_dwordx4 a[128:131], v2, s[12:15], s40 offen offset:0
    s_waitcnt lgkmcnt(6)
    v_mfma_f32_16x16x32_bf16 v[40:43], v[212:215], v[72:75], v[40:43]
    v_mfma_f32_16x16x32_bf16 v[68:71], v[212:215], v[76:79], v[68:71]
    ds_read_b128 v[184:187], v11 offset:10240
    s_waitcnt vmcnt(28)
    s_waitcnt lgkmcnt(6)
    v_mfma_f32_16x16x32_bf16 v[16:19], v[160:163], v[80:83], v[16:19]
    v_mfma_f32_16x16x32_bf16 v[44:47], v[160:163], v[84:87], v[44:47]
    ds_read_b128 v[188:191], v11 offset:11264
    s_waitcnt lgkmcnt(6)
    v_mfma_f32_16x16x32_bf16 v[20:23], v[164:167], v[80:83], v[20:23]
    v_mfma_f32_16x16x32_bf16 v[48:51], v[164:167], v[84:87], v[48:51]
    ds_read_b128 v[192:195], v11 offset:12288
    s_add_u32 s41, s47, 16384
    buffer_load_dwordx4 v[128:131], v2, s[12:15], s41 offen offset:2048 sc1
    s_add_u32 s41, s48, 16384
    buffer_load_dwordx4 v[132:135], v2, s[12:15], s41 offen offset:2048 sc1
    s_waitcnt lgkmcnt(6)
    v_mfma_f32_16x16x32_bf16 v[24:27], v[168:171], v[80:83], v[24:27]
    v_mfma_f32_16x16x32_bf16 v[52:55], v[168:171], v[84:87], v[52:55]
    ds_read_b128 v[196:199], v11 offset:13312
    buffer_load_dwordx4 a[132:135], v2, s[12:15], s40 offen offset:1024
    s_waitcnt lgkmcnt(6)
    v_mfma_f32_16x16x32_bf16 v[28:31], v[172:175], v[80:83], v[28:31]
    v_mfma_f32_16x16x32_bf16 v[56:59], v[172:175], v[84:87], v[56:59]
    ds_read_b128 v[200:203], v11 offset:14336
    buffer_load_dwordx4 a[136:139], v2, s[12:15], s40 offen offset:2048
    s_waitcnt lgkmcnt(6)
    v_mfma_f32_16x16x32_bf16 v[32:35], v[176:179], v[80:83], v[32:35]
    v_mfma_f32_16x16x32_bf16 v[60:63], v[176:179], v[84:87], v[60:63]
    ds_read_b128 v[204:207], v11 offset:15360
    s_waitcnt lgkmcnt(6)
    v_mfma_f32_16x16x32_bf16 v[36:39], v[180:183], v[80:83], v[36:39]
    v_mfma_f32_16x16x32_bf16 v[64:67], v[180:183], v[84:87], v[64:67]
    ds_read_b128 v[208:211], v11 offset:16384
    buffer_load_dwordx4 a[140:143], v2, s[12:15], s40 offen offset:3072
    s_add_u32 s40, s40, 4096
    s_waitcnt lgkmcnt(6)
    v_mfma_f32_16x16x32_bf16 v[40:43], v[184:187], v[80:83], v[40:43]
    v_mfma_f32_16x16x32_bf16 v[68:71], v[184:187], v[84:87], v[68:71]
    ds_read_b128 v[212:215], v11 offset:17408
    buffer_load_dwordx4 a[144:147], v2, s[12:15], s40 offen offset:0
    s_waitcnt vmcnt(29)
    s_waitcnt lgkmcnt(6)
    v_mfma_f32_16x16x32_bf16 v[16:19], v[188:191], v[88:91], v[16:19]
    v_mfma_f32_16x16x32_bf16 v[44:47], v[188:191], v[92:95], v[44:47]
    ds_read_b128 v[160:163], v11 offset:18432
    s_waitcnt lgkmcnt(6)
    v_mfma_f32_16x16x32_bf16 v[20:23], v[192:195], v[88:91], v[20:23]
    v_mfma_f32_16x16x32_bf16 v[48:51], v[192:195], v[92:95], v[48:51]
    ds_read_b128 v[164:167], v11 offset:19456
    s_add_u32 s41, s47, 16384
    buffer_load_dwordx4 v[136:139], v2, s[12:15], s41 offen offset:3072 sc1
    s_add_u32 s41, s48, 16384
    buffer_load_dwordx4 v[140:143], v2, s[12:15], s41 offen offset:3072 sc1
    s_waitcnt lgkmcnt(6)
    v_mfma_f32_16x16x32_bf16 v[24:27], v[196:199], v[88:91], v[24:27]
    v_mfma_f32_16x16x32_bf16 v[52:55], v[196:199], v[92:95], v[52:55]
    ds_read_b128 v[168:171], v11 offset:20480
    buffer_load_dwordx4 a[148:151], v2, s[12:15], s40 offen offset:1024
    s_waitcnt lgkmcnt(6)
    v_mfma_f32_16x16x32_bf16 v[28:31], v[200:203], v[88:91], v[28:31]
    v_mfma_f32_16x16x32_bf16 v[56:59], v[200:203], v[92:95], v[56:59]
    ds_read_b128 v[172:175], v11 offset:21504
    buffer_load_dwordx4 a[152:155], v2, s[12:15], s40 offen offset:2048
    s_waitcnt lgkmcnt(6)
    v_mfma_f32_16x16x32_bf16 v[32:35], v[204:207], v[88:91], v[32:35]
    v_mfma_f32_16x16x32_bf16 v[60:63], v[204:207], v[92:95], v[60:63]
    ds_read_b128 v[176:179], v11 offset:22528
    s_waitcnt lgkmcnt(6)
    v_mfma_f32_16x16x32_bf16 v[36:39], v[208:211], v[88:91], v[36:39]
    v_mfma_f32_16x16x32_bf16 v[64:67], v[208:211], v[92:95], v[64:67]
    ds_read_b128 v[180:183], v11 offset:23552
    buffer_load_dwordx4 a[156:159], v2, s[12:15], s40 offen offset:3072
    s_add_u32 s40, s40, 4096
    s_waitcnt lgkmcnt(6)
    v_mfma_f32_16x16x32_bf16 v[40:43], v[212:215], v[88:91], v[40:43]
    v_mfma_f32_16x16x32_bf16 v[68:71], v[212:215], v[92:95], v[68:71]
    ds_read_b128 v[184:187], v14 offset:0
    buffer_load_dwordx4 a[160:163], v2, s[12:15], s40 offen offset:0
    s_add_u32 s48, s54, 368640
    buffer_load_dwordx4 v[228:231], v254, s[12:15], s48 offen sc1
    buffer_load_dwordx4 v[232:235], v254, s[12:15], s48 offen offset:1024 sc1
    buffer_load_dwordx2 v[236:237], v8, s[12:15], s48 offen offset:2048 sc1
    s_waitcnt vmcnt(33)
    s_waitcnt lgkmcnt(6)
    v_mfma_f32_16x16x32_bf16 v[16:19], v[160:163], v[96:99], v[16:19]
    v_mfma_f32_16x16x32_bf16 v[44:47], v[160:163], v[100:103], v[44:47]
    ds_read_b128 v[188:191], v14 offset:1024
    s_waitcnt lgkmcnt(6)
    v_mfma_f32_16x16x32_bf16 v[20:23], v[164:167], v[96:99], v[20:23]
    v_mfma_f32_16x16x32_bf16 v[48:51], v[164:167], v[100:103], v[48:51]
    ds_read_b128 v[192:195], v14 offset:2048
    s_waitcnt lgkmcnt(6)
    v_mfma_f32_16x16x32_bf16 v[24:27], v[168:171], v[96:99], v[24:27]
    v_mfma_f32_16x16x32_bf16 v[52:55], v[168:171], v[100:103], v[52:55]
    ds_read_b128 v[196:199], v14 offset:3072
    buffer_load_dwordx4 a[164:167], v2, s[12:15], s40 offen offset:1024
    s_waitcnt lgkmcnt(6)
    v_mfma_f32_16x16x32_bf16 v[28:31], v[172:175], v[96:99], v[28:31]
    v_mfma_f32_16x16x32_bf16 v[56:59], v[172:175], v[100:103], v[56:59]
    ds_read_b128 v[200:203], v14 offset:4096
    buffer_load_dwordx4 a[168:171], v2, s[12:15], s40 offen offset:2048
    s_waitcnt lgkmcnt(6)
    v_mfma_f32_16x16x32_bf16 v[32:35], v[176:179], v[96:99], v[32:35]
    v_mfma_f32_16x16x32_bf16 v[60:63], v[176:179], v[100:103], v[60:63]
    ds_read_b128 v[204:207], v14 offset:5120
    s_waitcnt lgkmcnt(6)
    v_mfma_f32_16x16x32_bf16 v[36:39], v[180:183], v[96:99], v[36:39]
    v_mfma_f32_16x16x32_bf16 v[64:67], v[180:183], v[100:103], v[64:67]
    ds_read_b128 v[208:211], v14 offset:6144
    buffer_load_dwordx4 a[172:175], v2, s[12:15], s40 offen offset:3072
    s_add_u32 s40, s40, 4096
    s_waitcnt lgkmcnt(6)
    v_mfma_f32_16x16x32_bf16 v[40:43], v[184:187], v[96:99], v[40:43]
    v_mfma_f32_16x16x32_bf16 v[68:71], v[184:187], v[100:103], v[68:71]
    ds_read_b128 v[212:215], v14 offset:7168
    buffer_load_dwordx4 a[176:179], v2, s[12:15], s40 offen offset:0
    s_add_u32 s48, s54, 20480
    buffer_load_dwordx4 v[238:241], v254, s[12:15], s48 offen sc1
    buffer_load_dwordx4 v[242:245], v254, s[12:15], s48 offen offset:1024 sc1
    buffer_load_dwordx2 v[246:247], v8, s[12:15], s48 offen offset:2048 sc1
    s_waitcnt vmcnt(35)
    s_waitcnt lgkmcnt(6)
    v_mfma_f32_16x16x32_bf16 v[16:19], v[188:191], v[104:107], v[16:19]
    v_mfma_f32_16x16x32_bf16 v[44:47], v[188:191], v[108:111], v[44:47]
    ds_read_b128 v[160:163], v14 offset:8192
    s_waitcnt lgkmcnt(6)
    v_mfma_f32_16x16x32_bf16 v[20:23], v[192:195], v[104:107], v[20:23]
    v_mfma_f32_16x16x32_bf16 v[48:51], v[192:195], v[108:111], v[48:51]
    ds_read_b128 v[164:167], v14 offset:9216
    s_waitcnt lgkmcnt(6)
    v_mfma_f32_16x16x32_bf16 v[24:27], v[196:199], v[104:107], v[24:27]
    v_mfma_f32_16x16x32_bf16 v[52:55], v[196:199], v[108:111], v[52:55]
    ds_read_b128 v[168:171], v14 offset:10240
    buffer_load_dwordx4 a[180:183], v2, s[12:15], s40 offen offset:1024
    s_waitcnt lgkmcnt(6)
    v_mfma_f32_16x16x32_bf16 v[28:31], v[200:203], v[104:107], v[28:31]
    v_mfma_f32_16x16x32_bf16 v[56:59], v[200:203], v[108:111], v[56:59]
    ds_read_b128 v[172:175], v14 offset:11264
    buffer_load_dwordx4 a[184:187], v2, s[12:15], s40 offen offset:2048
    s_waitcnt lgkmcnt(6)
    v_mfma_f32_16x16x32_bf16 v[32:35], v[204:207], v[104:107], v[32:35]
    v_mfma_f32_16x16x32_bf16 v[60:63], v[204:207], v[108:111], v[60:63]
    ds_read_b128 v[176:179], v14 offset:12288
    s_waitcnt lgkmcnt(6)
    v_mfma_f32_16x16x32_bf16 v[36:39], v[208:211], v[104:107], v[36:39]
    v_mfma_f32_16x16x32_bf16 v[64:67], v[208:211], v[108:111], v[64:67]
    ds_read_b128 v[180:183], v14 offset:13312
    buffer_load_dwordx4 a[188:191], v2, s[12:15], s40 offen offset:3072
    s_add_u32 s40, s40, 4096
    s_waitcnt lgkmcnt(6)
    v_mfma_f32_16x16x32_bf16 v[40:43], v[212:215], v[104:107], v[40:43]
    v_mfma_f32_16x16x32_bf16 v[68:71], v[212:215], v[108:111], v[68:71]
    ds_read_b128 v[184:187], v14 offset:14336
    buffer_load_dwordx4 a[192:195], v2, s[12:15], s40 offen offset:0
    s_waitcnt vmcnt(34)
    s_waitcnt lgkmcnt(6)
    v_mfma_f32_16x16x32_bf16 v[16:19], v[160:163], v[112:115], v[16:19]
    v_mfma_f32_16x16x32_bf16 v[44:47], v[160:163], v[116:119], v[44:47]
    ds_read_b128 v[188:191], v14 offset:15360
    s_waitcnt lgkmcnt(6)
    v_mfma_f32_16x16x32_bf16 v[20:23], v[164:167], v[112:115], v[20:23]
    v_mfma_f32_16x16x32_bf16 v[48:51], v[164:167], v[116:119], v[48:51]
    ds_read_b128 v[192:195], v14 offset:16384
    s_waitcnt lgkmcnt(6)
    v_mfma_f32_16x16x32_bf16 v[24:27], v[168:171], v[112:115], v[24:27]
    v_mfma_f32_16x16x32_bf16 v[52:55], v[168:171], v[116:119], v[52:55]
    ds_read_b128 v[196:199], v14 offset:17408
    buffer_load_dwordx4 a[196:199], v2, s[12:15], s40 offen offset:1024
    s_waitcnt lgkmcnt(6)
    v_mfma_f32_16x16x32_bf16 v[28:31], v[172:175], v[112:115], v[28:31]
    v_mfma_f32_16x16x32_bf16 v[56:59], v[172:175], v[116:119], v[56:59]
    ds_read_b128 v[200:203], v14 offset:18432
    buffer_load_dwordx4 a[200:203], v2, s[12:15], s40 offen offset:2048
    s_waitcnt lgkmcnt(6)
    v_mfma_f32_16x16x32_bf16 v[32:35], v[176:179], v[112:115], v[32:35]
    v_mfma_f32_16x16x32_bf16 v[60:63], v[176:179], v[116:119], v[60:63]
    ds_read_b128 v[204:207], v14 offset:19456
    s_waitcnt lgkmcnt(6)
    v_mfma_f32_16x16x32_bf16 v[36:39], v[180:183], v[112:115], v[36:39]
    v_mfma_f32_16x16x32_bf16 v[64:67], v[180:183], v[116:119], v[64:67]
    ds_read_b128 v[208:211], v14 offset:20480
    buffer_load_dwordx4 a[204:207], v2, s[12:15], s40 offen offset:3072
    s_add_u32 s40, s40, 4096
    s_waitcnt lgkmcnt(6)
    v_mfma_f32_16x16x32_bf16 v[40:43], v[184:187], v[112:115], v[40:43]
    v_mfma_f32_16x16x32_bf16 v[68:71], v[184:187], v[116:119], v[68:71]
    ds_read_b128 v[212:215], v14 offset:21504
    buffer_load_dwordx4 a[208:211], v2, s[12:15], s40 offen offset:0
    s_waitcnt vmcnt(33)
    s_waitcnt lgkmcnt(6)
    v_mfma_f32_16x16x32_bf16 v[16:19], v[188:191], v[120:123], v[16:19]
    v_mfma_f32_16x16x32_bf16 v[44:47], v[188:191], v[124:127], v[44:47]
    ds_read_b128 v[160:163], v14 offset:22528
    s_waitcnt lgkmcnt(6)
    v_mfma_f32_16x16x32_bf16 v[20:23], v[192:195], v[120:123], v[20:23]
    v_mfma_f32_16x16x32_bf16 v[48:51], v[192:195], v[124:127], v[48:51]
    ds_read_b128 v[164:167], v14 offset:23552
    s_waitcnt lgkmcnt(6)
    v_mfma_f32_16x16x32_bf16 v[24:27], v[196:199], v[120:123], v[24:27]
    v_mfma_f32_16x16x32_bf16 v[52:55], v[196:199], v[124:127], v[52:55]
    ds_read_b128 v[168:171], v14 offset:24576
    buffer_load_dwordx4 a[212:215], v2, s[12:15], s40 offen offset:1024
    s_waitcnt lgkmcnt(6)
    v_mfma_f32_16x16x32_bf16 v[28:31], v[200:203], v[120:123], v[28:31]
    v_mfma_f32_16x16x32_bf16 v[56:59], v[200:203], v[124:127], v[56:59]
    ds_read_b128 v[172:175], v14 offset:25600
    buffer_load_dwordx4 a[216:219], v2, s[12:15], s40 offen offset:2048
    s_waitcnt lgkmcnt(6)
    v_mfma_f32_16x16x32_bf16 v[32:35], v[204:207], v[120:123], v[32:35]
    v_mfma_f32_16x16x32_bf16 v[60:63], v[204:207], v[124:127], v[60:63]
    ds_read_b128 v[176:179], v14 offset:26624
    s_waitcnt lgkmcnt(6)
    v_mfma_f32_16x16x32_bf16 v[36:39], v[208:211], v[120:123], v[36:39]
    v_mfma_f32_16x16x32_bf16 v[64:67], v[208:211], v[124:127], v[64:67]
    ds_read_b128 v[180:183], v14 offset:27648
    buffer_load_dwordx4 a[220:223], v2, s[12:15], s40 offen offset:3072
    s_add_u32 s40, s40, 4096
    s_waitcnt lgkmcnt(6)
    v_mfma_f32_16x16x32_bf16 v[40:43], v[212:215], v[120:123], v[40:43]
    v_mfma_f32_16x16x32_bf16 v[68:71], v[212:215], v[124:127], v[68:71]
    ds_read_b128 v[184:187], v14 offset:28672
    buffer_load_dwordx4 a[224:227], v2, s[12:15], s40 offen offset:0
    s_waitcnt vmcnt(32)
    s_waitcnt lgkmcnt(6)
    v_mfma_f32_16x16x32_bf16 v[16:19], v[160:163], v[128:131], v[16:19]
    v_mfma_f32_16x16x32_bf16 v[44:47], v[160:163], v[132:135], v[44:47]
    ds_read_b128 v[188:191], v14 offset:29696
    s_waitcnt lgkmcnt(6)
    v_mfma_f32_16x16x32_bf16 v[20:23], v[164:167], v[128:131], v[20:23]
    v_mfma_f32_16x16x32_bf16 v[48:51], v[164:167], v[132:135], v[48:51]
    ds_read_b128 v[192:195], v14 offset:30720
    s_waitcnt lgkmcnt(6)
    v_mfma_f32_16x16x32_bf16 v[24:27], v[168:171], v[128:131], v[24:27]
    v_mfma_f32_16x16x32_bf16 v[52:55], v[168:171], v[132:135], v[52:55]
    ds_read_b128 v[196:199], v14 offset:31744
    buffer_load_dwordx4 a[228:231], v2, s[12:15], s40 offen offset:1024
    s_waitcnt lgkmcnt(6)
    v_mfma_f32_16x16x32_bf16 v[28:31], v[172:175], v[128:131], v[28:31]
    v_mfma_f32_16x16x32_bf16 v[56:59], v[172:175], v[132:135], v[56:59]
    ds_read_b128 v[200:203], v14 offset:32768
    buffer_load_dwordx4 a[232:235], v2, s[12:15], s40 offen offset:2048
    s_waitcnt lgkmcnt(6)
    v_mfma_f32_16x16x32_bf16 v[32:35], v[176:179], v[128:131], v[32:35]
    v_mfma_f32_16x16x32_bf16 v[60:63], v[176:179], v[132:135], v[60:63]
    ds_read_b128 v[204:207], v14 offset:33792
    s_waitcnt lgkmcnt(6)
    v_mfma_f32_16x16x32_bf16 v[36:39], v[180:183], v[128:131], v[36:39]
    v_mfma_f32_16x16x32_bf16 v[64:67], v[180:183], v[132:135], v[64:67]
    ds_read_b128 v[208:211], v14 offset:34816
    buffer_load_dwordx4 a[236:239], v2, s[12:15], s40 offen offset:3072
    s_add_u32 s40, s40, 4096
    s_cmp_eq_u32 s30, 3
    s_cselect_b32 s41, 61440, 0
    s_sub_u32 s40, s40, s41
    s_waitcnt lgkmcnt(6)
    v_mfma_f32_16x16x32_bf16 v[40:43], v[184:187], v[128:131], v[40:43]
    v_mfma_f32_16x16x32_bf16 v[68:71], v[184:187], v[132:135], v[68:71]
    ds_read_b128 v[212:215], v14 offset:35840
    buffer_load_dwordx4 a[240:243], v2, s[12:15], s40 offen offset:0
    s_waitcnt vmcnt(30)
    s_waitcnt lgkmcnt(6)
    v_mfma_f32_16x16x32_bf16 v[16:19], v[188:191], v[136:139], v[16:19]
    v_mfma_f32_16x16x32_bf16 v[44:47], v[188:191], v[140:143], v[44:47]
    s_waitcnt lgkmcnt(5)
    v_mfma_f32_16x16x32_bf16 v[20:23], v[192:195], v[136:139], v[20:23]
    v_mfma_f32_16x16x32_bf16 v[48:51], v[192:195], v[140:143], v[48:51]
    s_waitcnt lgkmcnt(4)
    v_mfma_f32_16x16x32_bf16 v[24:27], v[196:199], v[136:139], v[24:27]
    v_mfma_f32_16x16x32_bf16 v[52:55], v[196:199], v[140:143], v[52:55]
    buffer_load_dwordx4 a[244:247], v2, s[12:15], s40 offen offset:1024
    s_waitcnt lgkmcnt(3)
    v_mfma_f32_16x16x32_bf16 v[28:31], v[200:203], v[136:139], v[28:31]
    v_mfma_f32_16x16x32_bf16 v[56:59], v[200:203], v[140:143], v[56:59]
    buffer_load_dwordx4 a[248:251], v2, s[12:15], s40 offen offset:2048
    s_waitcnt lgkmcnt(2)
    v_mfma_f32_16x16x32_bf16 v[32:35], v[204:207], v[136:139], v[32:35]
    v_mfma_f32_16x16x32_bf16 v[60:63], v[204:207], v[140:143], v[60:63]
    s_waitcnt lgkmcnt(1)
    v_mfma_f32_16x16x32_bf16 v[36:39], v[208:211], v[136:139], v[36:39]
    v_mfma_f32_16x16x32_bf16 v[64:67], v[208:211], v[140:143], v[64:67]
    buffer_load_dwordx4 a[252:255], v2, s[12:15], s40 offen offset:3072
    s_add_u32 s40, s40, 4096
    s_waitcnt lgkmcnt(0)
    v_mfma_f32_16x16x32_bf16 v[40:43], v[212:215], v[136:139], v[40:43]
    v_mfma_f32_16x16x32_bf16 v[68:71], v[212:215], v[140:143], v[68:71]
    v_lshlrev_b32 v9, 4, v3
    v_add_u32 v9, 156672, v9
    v_mov_b32 v12, 0xbdd2d3e8
    v_mov_b32 v13, 0xc0135761
    ds_read_b128 v[72:75], v9 offset:0
    ds_read_b128 v[100:103], v9 offset:512
    ds_read_b128 v[76:79], v9 offset:64
    ds_read_b128 v[104:107], v9 offset:576
    ds_read_b128 v[80:83], v9 offset:128
    ds_read_b128 v[108:111], v9 offset:640
    ds_read_b128 v[84:87], v9 offset:192
    ds_read_b128 v[112:115], v9 offset:704
    ds_read_b128 v[88:91], v9 offset:256
    ds_read_b128 v[116:119], v9 offset:768
    ds_read_b128 v[92:95], v9 offset:320
    ds_read_b128 v[120:123], v9 offset:832
    ds_read_b128 v[96:99], v9 offset:384
    ds_read_b128 v[124:127], v9 offset:896
    s_waitcnt lgkmcnt(0)
    v_pk_add_f32 v[72:73], v[72:73], v[100:101]
    v_pk_add_f32 v[74:75], v[74:75], v[102:103]
    v_pk_add_f32 v[76:77], v[76:77], v[104:105]
    v_pk_add_f32 v[78:79], v[78:79], v[106:107]
    v_pk_add_f32 v[80:81], v[80:81], v[108:109]
    v_pk_add_f32 v[82:83], v[82:83], v[110:111]
    v_pk_add_f32 v[84:85], v[84:85], v[112:113]
    v_pk_add_f32 v[86:87], v[86:87], v[114:115]
    v_pk_add_f32 v[88:89], v[88:89], v[116:117]
    v_pk_add_f32 v[90:91], v[90:91], v[118:119]
    v_pk_add_f32 v[92:93], v[92:93], v[120:121]
    v_pk_add_f32 v[94:95], v[94:95], v[122:123]
    v_pk_add_f32 v[96:97], v[96:97], v[124:125]
    v_pk_add_f32 v[98:99], v[98:99], v[126:127]
    s_lshl_b32 s49, s34, 2
    s_add_u32 s49, s49, s30
    s_lshl_b32 s49, s49, 7
    s_add_u32 s49, s49, s37
    s_lshl_b32 s41, s35, 2
    s_add_u32 s49, s49, s41
    v_pk_mul_f32 v[160:161], v[72:73], v[224:225] op_sel_hi:[1,0]
    v_pk_mul_f32 v[162:163], v[74:75], v[224:225] op_sel_hi:[1,0]
    v_pk_mul_f32 v[164:165], v[72:73], v[226:227] op_sel_hi:[1,0]
    v_pk_mul_f32 v[166:167], v[74:75], v[226:227] op_sel_hi:[1,0]
    v_pk_mul_f32 v[168:169], v[76:77], v[224:225] op_sel_hi:[1,0]
    v_pk_mul_f32 v[170:171], v[78:79], v[224:225] op_sel_hi:[1,0]
    v_pk_mul_f32 v[172:173], v[76:77], v[226:227] op_sel_hi:[1,0]
    v_pk_mul_f32 v[174:175], v[78:79], v[226:227] op_sel_hi:[1,0]
    v_pk_fma_f32 v[16:17], v[16:17], v[224:225], v[160:161] op_sel:[0,1,0] op_sel_hi:[1,1,1]
    v_pk_fma_f32 v[18:19], v[18:19], v[224:225], v[162:163] op_sel:[0,1,0] op_sel_hi:[1,1,1]
    v_pk_fma_f32 v[44:45], v[44:45], v[226:227], v[164:165] op_sel:[0,1,0] op_sel_hi:[1,1,1]
    v_pk_fma_f32 v[46:47], v[46:47], v[226:227], v[166:167] op_sel:[0,1,0] op_sel_hi:[1,1,1]
    v_pk_fma_f32 v[20:21], v[20:21], v[224:225], v[168:169] op_sel:[0,1,0] op_sel_hi:[1,1,1]
    v_pk_fma_f32 v[22:23], v[22:23], v[224:225], v[170:171] op_sel:[0,1,0] op_sel_hi:[1,1,1]
    v_pk_fma_f32 v[48:49], v[48:49], v[226:227], v[172:173] op_sel:[0,1,0] op_sel_hi:[1,1,1]
    v_pk_fma_f32 v[50:51], v[50:51], v[226:227], v[174:175] op_sel:[0,1,0] op_sel_hi:[1,1,1]
    v_pk_mul_f32 v[160:161], v[16:17], v[16:17]
    v_pk_mul_f32 v[162:163], v[18:19], v[18:19]
    v_pk_mul_f32 v[164:165], v[44:45], v[44:45]
    v_pk_mul_f32 v[166:167], v[46:47], v[46:47]
    v_pk_mul_f32 v[168:169], v[20:21], v[20:21]
    v_pk_mul_f32 v[170:171], v[22:23], v[22:23]
    v_pk_mul_f32 v[172:173], v[48:49], v[48:49]
    v_pk_mul_f32 v[174:175], v[50:51], v[50:51]
    v_pk_fma_f32 v[160:161], v[160:161], v[12:13], v[12:13] op_sel:[0,0,1] op_sel_hi:[1,0,1]
    v_pk_fma_f32 v[162:163], v[162:163], v[12:13], v[12:13] op_sel:[0,0,1] op_sel_hi:[1,0,1]
    v_pk_fma_f32 v[164:165], v[164:165], v[12:13], v[12:13] op_sel:[0,0,1] op_sel_hi:[1,0,1]
    v_pk_fma_f32 v[166:167], v[166:167], v[12:13], v[12:13] op_sel:[0,0,1] op_sel_hi:[1,0,1]
    v_pk_fma_f32 v[168:169], v[168:169], v[12:13], v[12:13] op_sel:[0,0,1] op_sel_hi:[1,0,1]
    v_pk_fma_f32 v[170:171], v[170:171], v[12:13], v[12:13] op_sel:[0,0,1] op_sel_hi:[1,0,1]
    v_pk_fma_f32 v[172:173], v[172:173], v[12:13], v[12:13] op_sel:[0,0,1] op_sel_hi:[1,0,1]
    v_pk_fma_f32 v[174:175], v[174:175], v[12:13], v[12:13] op_sel:[0,0,1] op_sel_hi:[1,0,1]
    v_pk_mul_f32 v[160:161], v[160:161], v[16:17]
    v_pk_mul_f32 v[162:163], v[162:163], v[18:19]
    v_pk_mul_f32 v[164:165], v[164:165], v[44:45]
    v_pk_mul_f32 v[166:167], v[166:167], v[46:47]
    v_pk_mul_f32 v[168:169], v[168:169], v[20:21]
    v_pk_mul_f32 v[170:171], v[170:171], v[22:23]
    v_pk_mul_f32 v[172:173], v[172:173], v[48:49]
    v_pk_mul_f32 v[174:175], v[174:175], v[50:51]
    v_exp_f32 v160, v160
    v_exp_f32 v161, v161
    v_exp_f32 v162, v162
    v_exp_f32 v163, v163
    v_exp_f32 v164, v164
    v_exp_f32 v165, v165
    v_exp_f32 v166, v166
    v_exp_f32 v167, v167
    v_exp_f32 v168, v168
    v_exp_f32 v169, v169
    v_exp_f32 v170, v170
    v_exp_f32 v171, v171
    v_exp_f32 v172, v172
    v_exp_f32 v173, v173
    v_exp_f32 v174, v174
    v_exp_f32 v175, v175
    v_pk_add_f32 v[160:161], v[160:161], 1.0 op_sel_hi:[1,0]
    v_pk_add_f32 v[162:163], v[162:163], 1.0 op_sel_hi:[1,0]
    v_pk_add_f32 v[164:165], v[164:165], 1.0 op_sel_hi:[1,0]
    v_pk_add_f32 v[166:167], v[166:167], 1.0 op_sel_hi:[1,0]
    v_pk_add_f32 v[168:169], v[168:169], 1.0 op_sel_hi:[1,0]
    v_pk_add_f32 v[170:171], v[170:171], 1.0 op_sel_hi:[1,0]
    v_pk_add_f32 v[172:173], v[172:173], 1.0 op_sel_hi:[1,0]
    v_pk_add_f32 v[174:175], v[174:175], 1.0 op_sel_hi:[1,0]
    v_rcp_f32 v160, v160
    v_rcp_f32 v161, v161
    v_rcp_f32 v162, v162
    v_rcp_f32 v163, v163
    v_rcp_f32 v164, v164
    v_rcp_f32 v165, v165
    v_rcp_f32 v166, v166
    v_rcp_f32 v167, v167
    v_rcp_f32 v168, v168
    v_rcp_f32 v169, v169
    v_rcp_f32 v170, v170
    v_rcp_f32 v171, v171
    v_rcp_f32 v172, v172
    v_rcp_f32 v173, v173
    v_rcp_f32 v174, v174
    v_rcp_f32 v175, v175
    s_nop 0
    v_pk_mul_f32 v[16:17], v[16:17], v[160:161]
    v_pk_mul_f32 v[18:19], v[18:19], v[162:163]
    v_pk_mul_f32 v[44:45], v[44:45], v[164:165]
    v_pk_mul_f32 v[46:47], v[46:47], v[166:167]
    v_pk_mul_f32 v[20:21], v[20:21], v[168:169]
    v_pk_mul_f32 v[22:23], v[22:23], v[170:171]
    v_pk_mul_f32 v[48:49], v[48:49], v[172:173]
    v_pk_mul_f32 v[50:51], v[50:51], v[174:175]
    v_cvt_pk_bf16_f32 v16, v16, v17
    v_cvt_pk_bf16_f32 v17, v18, v19
    v_cvt_pk_bf16_f32 v18, v20, v21
    v_cvt_pk_bf16_f32 v19, v22, v23
    v_cvt_pk_bf16_f32 v44, v44, v45
    v_cvt_pk_bf16_f32 v45, v46, v47
    v_cvt_pk_bf16_f32 v46, v48, v49
    v_cvt_pk_bf16_f32 v47, v50, v51
    s_nop 1
    v_permlane16_swap_b32 v16, v18
    v_permlane16_swap_b32 v17, v19
    v_permlane16_swap_b32 v44, v46
    v_permlane16_swap_b32 v45, v47
    buffer_store_dwordx4 v[16:19], v254, s[12:15], s52 offen offset:0 sc1
    buffer_store_dwordx4 v[44:47], v254, s[12:15], s53 offen offset:0 sc1
k2_kernel_gs30:
    v_pk_mul_f32 v[160:161], v[80:81], v[224:225] op_sel_hi:[1,0]
    v_pk_mul_f32 v[162:163], v[82:83], v[224:225] op_sel_hi:[1,0]
    v_pk_mul_f32 v[164:165], v[80:81], v[226:227] op_sel_hi:[1,0]
    v_pk_mul_f32 v[166:167], v[82:83], v[226:227] op_sel_hi:[1,0]
    v_pk_mul_f32 v[168:169], v[84:85], v[224:225] op_sel_hi:[1,0]
    v_pk_mul_f32 v[170:171], v[86:87], v[224:225] op_sel_hi:[1,0]
    v_pk_mul_f32 v[172:173], v[84:85], v[226:227] op_sel_hi:[1,0]
    v_pk_mul_f32 v[174:175], v[86:87], v[226:227] op_sel_hi:[1,0]
    v_pk_fma_f32 v[24:25], v[24:25], v[224:225], v[160:161] op_sel:[0,1,0] op_sel_hi:[1,1,1]
    v_pk_fma_f32 v[26:27], v[26:27], v[224:225], v[162:163] op_sel:[0,1,0] op_sel_hi:[1,1,1]
    v_pk_fma_f32 v[52:53], v[52:53], v[226:227], v[164:165] op_sel:[0,1,0] op_sel_hi:[1,1,1]
    v_pk_fma_f32 v[54:55], v[54:55], v[226:227], v[166:167] op_sel:[0,1,0] op_sel_hi:[1,1,1]
    v_pk_fma_f32 v[28:29], v[28:29], v[224:225], v[168:169] op_sel:[0,1,0] op_sel_hi:[1,1,1]
    v_pk_fma_f32 v[30:31], v[30:31], v[224:225], v[170:171] op_sel:[0,1,0] op_sel_hi:[1,1,1]
    v_pk_fma_f32 v[56:57], v[56:57], v[226:227], v[172:173] op_sel:[0,1,0] op_sel_hi:[1,1,1]
    v_pk_fma_f32 v[58:59], v[58:59], v[226:227], v[174:175] op_sel:[0,1,0] op_sel_hi:[1,1,1]
    v_pk_mul_f32 v[160:161], v[24:25], v[24:25]
    v_pk_mul_f32 v[162:163], v[26:27], v[26:27]
    v_pk_mul_f32 v[164:165], v[52:53], v[52:53]
    v_pk_mul_f32 v[166:167], v[54:55], v[54:55]
    v_pk_mul_f32 v[168:169], v[28:29], v[28:29]
    v_pk_mul_f32 v[170:171], v[30:31], v[30:31]
    v_pk_mul_f32 v[172:173], v[56:57], v[56:57]
    v_pk_mul_f32 v[174:175], v[58:59], v[58:59]
    v_pk_fma_f32 v[160:161], v[160:161], v[12:13], v[12:13] op_sel:[0,0,1] op_sel_hi:[1,0,1]
    v_pk_fma_f32 v[162:163], v[162:163], v[12:13], v[12:13] op_sel:[0,0,1] op_sel_hi:[1,0,1]
    v_pk_fma_f32 v[164:165], v[164:165], v[12:13], v[12:13] op_sel:[0,0,1] op_sel_hi:[1,0,1]
    v_pk_fma_f32 v[166:167], v[166:167], v[12:13], v[12:13] op_sel:[0,0,1] op_sel_hi:[1,0,1]
    v_pk_fma_f32 v[168:169], v[168:169], v[12:13], v[12:13] op_sel:[0,0,1] op_sel_hi:[1,0,1]
    v_pk_fma_f32 v[170:171], v[170:171], v[12:13], v[12:13] op_sel:[0,0,1] op_sel_hi:[1,0,1]
    v_pk_fma_f32 v[172:173], v[172:173], v[12:13], v[12:13] op_sel:[0,0,1] op_sel_hi:[1,0,1]
    v_pk_fma_f32 v[174:175], v[174:175], v[12:13], v[12:13] op_sel:[0,0,1] op_sel_hi:[1,0,1]
    v_pk_mul_f32 v[160:161], v[160:161], v[24:25]
    v_pk_mul_f32 v[162:163], v[162:163], v[26:27]
    v_pk_mul_f32 v[164:165], v[164:165], v[52:53]
    v_pk_mul_f32 v[166:167], v[166:167], v[54:55]
    v_pk_mul_f32 v[168:169], v[168:169], v[28:29]
    v_pk_mul_f32 v[170:171], v[170:171], v[30:31]
    v_pk_mul_f32 v[172:173], v[172:173], v[56:57]
    v_pk_mul_f32 v[174:175], v[174:175], v[58:59]
    v_exp_f32 v160, v160
    v_exp_f32 v161, v161
    v_exp_f32 v162, v162
    v_exp_f32 v163, v163
    v_exp_f32 v164, v164
    v_exp_f32 v165, v165
    v_exp_f32 v166, v166
    v_exp_f32 v167, v167
    v_exp_f32 v168, v168
    v_exp_f32 v169, v169
    v_exp_f32 v170, v170
    v_exp_f32 v171, v171
    v_exp_f32 v172, v172
    v_exp_f32 v173, v173
    v_exp_f32 v174, v174
    v_exp_f32 v175, v175
    v_pk_add_f32 v[160:161], v[160:161], 1.0 op_sel_hi:[1,0]
    v_pk_add_f32 v[162:163], v[162:163], 1.0 op_sel_hi:[1,0]
    v_pk_add_f32 v[164:165], v[164:165], 1.0 op_sel_hi:[1,0]
    v_pk_add_f32 v[166:167], v[166:167], 1.0 op_sel_hi:[1,0]
    v_pk_add_f32 v[168:169], v[168:169], 1.0 op_sel_hi:[1,0]
    v_pk_add_f32 v[170:171], v[170:171], 1.0 op_sel_hi:[1,0]
    v_pk_add_f32 v[172:173], v[172:173], 1.0 op_sel_hi:[1,0]
    v_pk_add_f32 v[174:175], v[174:175], 1.0 op_sel_hi:[1,0]
    v_rcp_f32 v160, v160
    v_rcp_f32 v161, v161
    v_rcp_f32 v162, v162
    v_rcp_f32 v163, v163
    v_rcp_f32 v164, v164
    v_rcp_f32 v165, v165
    v_rcp_f32 v166, v166
    v_rcp_f32 v167, v167
    v_rcp_f32 v168, v168
    v_rcp_f32 v169, v169
    v_rcp_f32 v170, v170
    v_rcp_f32 v171, v171
    v_rcp_f32 v172, v172
    v_rcp_f32 v173, v173
    v_rcp_f32 v174, v174
    v_rcp_f32 v175, v175
    s_nop 0
    v_pk_mul_f32 v[24:25], v[24:25], v[160:161]
    v_pk_mul_f32 v[26:27], v[26:27], v[162:163]
    v_pk_mul_f32 v[52:53], v[52:53], v[164:165]
    v_pk_mul_f32 v[54:55], v[54:55], v[166:167]
    v_pk_mul_f32 v[28:29], v[28:29], v[168:169]
    v_pk_mul_f32 v[30:31], v[30:31], v[170:171]
    v_pk_mul_f32 v[56:57], v[56:57], v[172:173]
    v_pk_mul_f32 v[58:59], v[58:59], v[174:175]
    v_cvt_pk_bf16_f32 v24, v24, v25
    v_cvt_pk_bf16_f32 v25, v26, v27
    v_cvt_pk_bf16_f32 v26, v28, v29
    v_cvt_pk_bf16_f32 v27, v30, v31
    v_cvt_pk_bf16_f32 v52, v52, v53
    v_cvt_pk_bf16_f32 v53, v54, v55
    v_cvt_pk_bf16_f32 v54, v56, v57
    v_cvt_pk_bf16_f32 v55, v58, v59
    s_nop 1
    v_permlane16_swap_b32 v24, v26
    v_permlane16_swap_b32 v25, v27
    v_permlane16_swap_b32 v52, v54
    v_permlane16_swap_b32 v53, v55
    s_cmp_eq_u32 s35, 15
    s_cselect_b32 s46, 0xffff, -1
    s_mov_b32 exec_lo, s46
    s_mov_b32 exec_hi, s46
    buffer_store_dwordx4 v[24:27], v254, s[12:15], s52 offen offset:1024 sc1
    buffer_store_dwordx4 v[52:55], v254, s[12:15], s53 offen offset:1024 sc1
    s_mov_b64 exec, -1
k2_kernel_gs31:
    v_pk_mul_f32 v[160:161], v[88:89], v[224:225] op_sel_hi:[1,0]
    v_pk_mul_f32 v[162:163], v[90:91], v[224:225] op_sel_hi:[1,0]
    v_pk_mul_f32 v[164:165], v[88:89], v[226:227] op_sel_hi:[1,0]
    v_pk_mul_f32 v[166:167], v[90:91], v[226:227] op_sel_hi:[1,0]
    v_pk_mul_f32 v[168:169], v[92:93], v[224:225] op_sel_hi:[1,0]
    v_pk_mul_f32 v[170:171], v[94:95], v[224:225] op_sel_hi:[1,0]
    v_pk_mul_f32 v[172:173], v[92:93], v[226:227] op_sel_hi:[1,0]
    v_pk_mul_f32 v[174:175], v[94:95], v[226:227] op_sel_hi:[1,0]
    v_pk_fma_f32 v[32:33], v[32:33], v[224:225], v[160:161] op_sel:[0,1,0] op_sel_hi:[1,1,1]
    v_pk_fma_f32 v[34:35], v[34:35], v[224:225], v[162:163] op_sel:[0,1,0] op_sel_hi:[1,1,1]
    v_pk_fma_f32 v[60:61], v[60:61], v[226:227], v[164:165] op_sel:[0,1,0] op_sel_hi:[1,1,1]
    v_pk_fma_f32 v[62:63], v[62:63], v[226:227], v[166:167] op_sel:[0,1,0] op_sel_hi:[1,1,1]
    v_pk_fma_f32 v[36:37], v[36:37], v[224:225], v[168:169] op_sel:[0,1,0] op_sel_hi:[1,1,1]
    v_pk_fma_f32 v[38:39], v[38:39], v[224:225], v[170:171] op_sel:[0,1,0] op_sel_hi:[1,1,1]
    v_pk_fma_f32 v[64:65], v[64:65], v[226:227], v[172:173] op_sel:[0,1,0] op_sel_hi:[1,1,1]
    v_pk_fma_f32 v[66:67], v[66:67], v[226:227], v[174:175] op_sel:[0,1,0] op_sel_hi:[1,1,1]
    v_pk_mul_f32 v[160:161], v[32:33], v[32:33]
    v_pk_mul_f32 v[162:163], v[34:35], v[34:35]
    v_pk_mul_f32 v[164:165], v[60:61], v[60:61]
    v_pk_mul_f32 v[166:167], v[62:63], v[62:63]
    v_pk_mul_f32 v[168:169], v[36:37], v[36:37]
    v_pk_mul_f32 v[170:171], v[38:39], v[38:39]
    v_pk_mul_f32 v[172:173], v[64:65], v[64:65]
    v_pk_mul_f32 v[174:175], v[66:67], v[66:67]
    v_pk_fma_f32 v[160:161], v[160:161], v[12:13], v[12:13] op_sel:[0,0,1] op_sel_hi:[1,0,1]
    v_pk_fma_f32 v[162:163], v[162:163], v[12:13], v[12:13] op_sel:[0,0,1] op_sel_hi:[1,0,1]
    v_pk_fma_f32 v[164:165], v[164:165], v[12:13], v[12:13] op_sel:[0,0,1] op_sel_hi:[1,0,1]
    v_pk_fma_f32 v[166:167], v[166:167], v[12:13], v[12:13] op_sel:[0,0,1] op_sel_hi:[1,0,1]
    v_pk_fma_f32 v[168:169], v[168:169], v[12:13], v[12:13] op_sel:[0,0,1] op_sel_hi:[1,0,1]
    v_pk_fma_f32 v[170:171], v[170:171], v[12:13], v[12:13] op_sel:[0,0,1] op_sel_hi:[1,0,1]
    v_pk_fma_f32 v[172:173], v[172:173], v[12:13], v[12:13] op_sel:[0,0,1] op_sel_hi:[1,0,1]
    v_pk_fma_f32 v[174:175], v[174:175], v[12:13], v[12:13] op_sel:[0,0,1] op_sel_hi:[1,0,1]
    v_pk_mul_f32 v[160:161], v[160:161], v[32:33]
    v_pk_mul_f32 v[162:163], v[162:163], v[34:35]
    v_pk_mul_f32 v[164:165], v[164:165], v[60:61]
    v_pk_mul_f32 v[166:167], v[166:167], v[62:63]
    v_pk_mul_f32 v[168:169], v[168:169], v[36:37]
    v_pk_mul_f32 v[170:171], v[170:171], v[38:39]
    v_pk_mul_f32 v[172:173], v[172:173], v[64:65]
    v_pk_mul_f32 v[174:175], v[174:175], v[66:67]
    v_exp_f32 v160, v160
    v_exp_f32 v161, v161
    v_exp_f32 v162, v162
    v_exp_f32 v163, v163
    v_exp_f32 v164, v164
    v_exp_f32 v165, v165
    v_exp_f32 v166, v166
    v_exp_f32 v167, v167
    v_exp_f32 v168, v168
    v_exp_f32 v169, v169
    v_exp_f32 v170, v170
    v_exp_f32 v171, v171
    v_exp_f32 v172, v172
    v_exp_f32 v173, v173
    v_exp_f32 v174, v174
    v_exp_f32 v175, v175
    v_pk_add_f32 v[160:161], v[160:161], 1.0 op_sel_hi:[1,0]
    v_pk_add_f32 v[162:163], v[162:163], 1.0 op_sel_hi:[1,0]
    v_pk_add_f32 v[164:165], v[164:165], 1.0 op_sel_hi:[1,0]
    v_pk_add_f32 v[166:167], v[166:167], 1.0 op_sel_hi:[1,0]
    v_pk_add_f32 v[168:169], v[168:169], 1.0 op_sel_hi:[1,0]
    v_pk_add_f32 v[170:171], v[170:171], 1.0 op_sel_hi:[1,0]
    v_pk_add_f32 v[172:173], v[172:173], 1.0 op_sel_hi:[1,0]
    v_pk_add_f32 v[174:175], v[174:175], 1.0 op_sel_hi:[1,0]
    v_rcp_f32 v160, v160
    v_rcp_f32 v161, v161
    v_rcp_f32 v162, v162
    v_rcp_f32 v163, v163
    v_rcp_f32 v164, v164
    v_rcp_f32 v165, v165
    v_rcp_f32 v166, v166
    v_rcp_f32 v167, v167
    v_rcp_f32 v168, v168
    v_rcp_f32 v169, v169
    v_rcp_f32 v170, v170
    v_rcp_f32 v171, v171
    v_rcp_f32 v172, v172
    v_rcp_f32 v173, v173
    v_rcp_f32 v174, v174
    v_rcp_f32 v175, v175
    s_nop 0
    v_pk_mul_f32 v[32:33], v[32:33], v[160:161]
    v_pk_mul_f32 v[34:35], v[34:35], v[162:163]
    v_pk_mul_f32 v[60:61], v[60:61], v[164:165]
    v_pk_mul_f32 v[62:63], v[62:63], v[166:167]
    v_pk_mul_f32 v[36:37], v[36:37], v[168:169]
    v_pk_mul_f32 v[38:39], v[38:39], v[170:171]
    v_pk_mul_f32 v[64:65], v[64:65], v[172:173]
    v_pk_mul_f32 v[66:67], v[66:67], v[174:175]
    v_cvt_pk_bf16_f32 v32, v32, v33
    v_cvt_pk_bf16_f32 v33, v34, v35
    v_cvt_pk_bf16_f32 v34, v36, v37
    v_cvt_pk_bf16_f32 v35, v38, v39
    v_cvt_pk_bf16_f32 v60, v60, v61
    v_cvt_pk_bf16_f32 v61, v62, v63
    v_cvt_pk_bf16_f32 v62, v64, v65
    v_cvt_pk_bf16_f32 v63, v66, v67
    s_nop 1
    v_permlane16_swap_b32 v32, v34
    v_permlane16_swap_b32 v33, v35
    v_permlane16_swap_b32 v60, v62
    v_permlane16_swap_b32 v61, v63
    s_cmp_eq_u32 s35, 15
    s_cbranch_scc1 k2_kernel_gs32
    buffer_store_dwordx4 v[32:35], v254, s[12:15], s52 offen offset:2048 sc1
    buffer_store_dwordx4 v[60:63], v254, s[12:15], s53 offen offset:2048 sc1
k2_kernel_gs32:
    v_pk_mul_f32 v[160:161], v[96:97], v[224:225] op_sel_hi:[1,0]
    v_pk_mul_f32 v[162:163], v[98:99], v[224:225] op_sel_hi:[1,0]
    v_pk_mul_f32 v[164:165], v[96:97], v[226:227] op_sel_hi:[1,0]
    v_pk_mul_f32 v[166:167], v[98:99], v[226:227] op_sel_hi:[1,0]
    v_pk_fma_f32 v[40:41], v[40:41], v[224:225], v[160:161] op_sel:[0,1,0] op_sel_hi:[1,1,1]
    v_pk_fma_f32 v[42:43], v[42:43], v[224:225], v[162:163] op_sel:[0,1,0] op_sel_hi:[1,1,1]
    v_pk_fma_f32 v[68:69], v[68:69], v[226:227], v[164:165] op_sel:[0,1,0] op_sel_hi:[1,1,1]
    v_pk_fma_f32 v[70:71], v[70:71], v[226:227], v[166:167] op_sel:[0,1,0] op_sel_hi:[1,1,1]
    v_pk_mul_f32 v[160:161], v[40:41], v[40:41]
    v_pk_mul_f32 v[162:163], v[42:43], v[42:43]
    v_pk_mul_f32 v[164:165], v[68:69], v[68:69]
    v_pk_mul_f32 v[166:167], v[70:71], v[70:71]
    v_pk_fma_f32 v[160:161], v[160:161], v[12:13], v[12:13] op_sel:[0,0,1] op_sel_hi:[1,0,1]
    v_pk_fma_f32 v[162:163], v[162:163], v[12:13], v[12:13] op_sel:[0,0,1] op_sel_hi:[1,0,1]
    v_pk_fma_f32 v[164:165], v[164:165], v[12:13], v[12:13] op_sel:[0,0,1] op_sel_hi:[1,0,1]
    v_pk_fma_f32 v[166:167], v[166:167], v[12:13], v[12:13] op_sel:[0,0,1] op_sel_hi:[1,0,1]
    v_pk_mul_f32 v[160:161], v[160:161], v[40:41]
    v_pk_mul_f32 v[162:163], v[162:163], v[42:43]
    v_pk_mul_f32 v[164:165], v[164:165], v[68:69]
    v_pk_mul_f32 v[166:167], v[166:167], v[70:71]
    v_exp_f32 v160, v160
    v_exp_f32 v161, v161
    v_exp_f32 v162, v162
    v_exp_f32 v163, v163
    v_exp_f32 v164, v164
    v_exp_f32 v165, v165
    v_exp_f32 v166, v166
    v_exp_f32 v167, v167
    v_pk_add_f32 v[160:161], v[160:161], 1.0 op_sel_hi:[1,0]
    v_pk_add_f32 v[162:163], v[162:163], 1.0 op_sel_hi:[1,0]
    v_pk_add_f32 v[164:165], v[164:165], 1.0 op_sel_hi:[1,0]
    v_pk_add_f32 v[166:167], v[166:167], 1.0 op_sel_hi:[1,0]
    v_rcp_f32 v160, v160
    v_rcp_f32 v161, v161
    v_rcp_f32 v162, v162
    v_rcp_f32 v163, v163
    v_rcp_f32 v164, v164
    v_rcp_f32 v165, v165
    v_rcp_f32 v166, v166
    v_rcp_f32 v167, v167
    s_nop 0
    v_pk_mul_f32 v[40:41], v[40:41], v[160:161]
    v_pk_mul_f32 v[42:43], v[42:43], v[162:163]
    v_pk_mul_f32 v[68:69], v[68:69], v[164:165]
    v_pk_mul_f32 v[70:71], v[70:71], v[166:167]
    v_cvt_pk_bf16_f32 v40, v40, v41
    v_cvt_pk_bf16_f32 v41, v42, v43
    v_cvt_pk_bf16_f32 v68, v68, v69
    v_cvt_pk_bf16_f32 v69, v70, v71
    s_cmp_eq_u32 s35, 15
    s_cbranch_scc1 k2_kernel_gs33
    buffer_store_dwordx2 v[40:41], v8, s[12:15], s52 offen offset:3072 sc1
    buffer_store_dwordx2 v[68:69], v8, s[12:15], s53 offen offset:3072 sc1
k2_kernel_gs33:
    s_waitcnt vmcnt(0)
    v_mov_b32 v9, 1
    v_mov_b32 v10, 6400
    s_mov_b64 exec, 1
    s_cmp_eq_u32 s31, 0
    s_cbranch_scc1 k2_kernel_slow34
    buffer_store_dword v9, v10, s[12:15], s49 offen
    s_branch k2_kernel_sent35
k2_kernel_slow34:
    buffer_store_dword v9, v10, s[12:15], s49 offen sc1
k2_kernel_sent35:
    s_mov_b64 exec, -1
    buffer_load_dwordx4 v[192:195], v2, s[12:15], s40 offen offset:0
    buffer_load_dwordx4 v[196:199], v2, s[12:15], s40 offen offset:1024
    buffer_load_dwordx4 v[200:203], v2, s[12:15], s40 offen offset:2048
    buffer_load_dwordx4 v[204:207], v2, s[12:15], s40 offen offset:3072
    s_add_u32 s40, s40, 4096
    buffer_load_dwordx4 v[208:211], v2, s[12:15], s40 offen offset:0
    buffer_load_dwordx4 v[212:215], v2, s[12:15], s40 offen offset:1024
    s_and_b32 s41, s32, 1
    s_lshl_b32 s41, s41, 1
    s_lshl_b32 s49, s34, 2
    s_add_u32 s49, s49, s41
    s_lshl_b32 s49, s49, 7
    s_add_u32 s49, s49, s37
    s_lshl_b32 s41, s30, 4
    s_add_u32 s49, s49, s41
    s_add_u32 s49, s49, 6400
    v_bfe_u32 v7, v1, 2, 1
    v_lshlrev_b32 v7, 7, v7
    v_and_b32 v9, 3, v1
    v_lshl_add_u32 v7, v9, 2, v7
    s_add_u32 s41, s30, 0
    s_and_b32 s41, s41, 3
    s_lshl_b32 s46, s32, 2
    s_add_u32 s41, s41, s46
    s_mul_i32 s41, s41, 55296
    s_mul_i32 s46, s30, 14336
    s_add_u32 s41, s41, s46
    s_add_u32 s41, s41, s36
    s_add_u32 s50, s41, 696320
    s_add_u32 s41, s30, 1
    s_and_b32 s41, s41, 3
    s_lshl_b32 s46, s32, 2
    s_add_u32 s41, s41, s46
    s_mul_i32 s41, s41, 55296
    s_mul_i32 s46, s30, 14336
    s_add_u32 s41, s41, s46
    s_add_u32 s41, s41, s36
    s_add_u32 s51, s41, 696320
    s_add_u32 s41, s30, 2
    s_and_b32 s41, s41, 3
    s_lshl_b32 s46, s32, 2
    s_add_u32 s41, s41, s46
    s_mul_i32 s41, s41, 55296
    s_mul_i32 s46, s30, 14336
    s_add_u32 s41, s41, s46
    s_add_u32 s41, s41, s36
    s_add_u32 s52, s41, 696320
    s_add_u32 s41, s30, 3
    s_and_b32 s41, s41, 3
    s_lshl_b32 s46, s32, 2
    s_add_u32 s41, s41, s46
    s_mul_i32 s41, s41, 55296
    s_mul_i32 s46, s30, 14336
    s_add_u32 s41, s41, s46
    s_add_u32 s41, s41, s36
    s_add_u32 s53, s41, 696320
    s_mov_b32 s43, 200000
k2_kernel_poll36:
    buffer_load_dword v9, v7, s[12:15], s49 offen sc1
    s_waitcnt vmcnt(0)
    v_cmp_ne_u32 vcc, 0, v9
    s_sub_u32 s43, s43, 1
    s_cmp_eq_u64 vcc, -1
    s_cbranch_scc1 k2_kernel_go37
    s_cmp_lg_u32 s43, 0
    s_cbranch_scc1 k2_kernel_poll36
k2_kernel_go37:
    s_add_u32 s41, s50, 0
    buffer_load_dwordx4 v[96:99], v2, s[12:15], s41 offen offset:0 sc1
    s_add_u32 s41, s51, 0
    buffer_load_dwordx4 v[100:103], v2, s[12:15], s41 offen offset:0 sc1
    s_add_u32 s41, s52, 0
    buffer_load_dwordx4 v[104:107], v2, s[12:15], s41 offen offset:0 sc1
    s_add_u32 s41, s53, 0
    buffer_load_dwordx4 v[108:111], v2, s[12:15], s41 offen offset:0 sc1
    s_add_u32 s41, s50, 0
    buffer_load_dwordx4 v[112:115], v2, s[12:15], s41 offen offset:1024 sc1
    s_add_u32 s41, s51, 0
    buffer_load_dwordx4 v[116:119], v2, s[12:15], s41 offen offset:1024 sc1
    s_add_u32 s41, s52, 0
    buffer_load_dwordx4 v[120:123], v2, s[12:15], s41 offen offset:1024 sc1
    s_add_u32 s41, s53, 0
    buffer_load_dwordx4 v[124:127], v2, s[12:15], s41 offen offset:1024 sc1
    s_waitcnt vmcnt(4)
    v_mfma_f32_16x16x32_bf16 v[16:19], a[0:3], v[96:99], 0
    v_mfma_f32_16x16x32_bf16 v[36:39], a[0:3], v[100:103], 0
    v_mfma_f32_16x16x32_bf16 v[56:59], a[0:3], v[104:107], 0
    v_mfma_f32_16x16x32_bf16 v[76:79], a[0:3], v[108:111], 0
    s_add_u32 s41, s50, 0
    buffer_load_dwordx4 v[128:131], v2, s[12:15], s41 offen offset:2048 sc1
    v_mfma_f32_16x16x32_bf16 v[20:23], a[4:7], v[96:99], 0
    v_mfma_f32_16x16x32_bf16 v[40:43], a[4:7], v[100:103], 0
    v_mfma_f32_16x16x32_bf16 v[60:63], a[4:7], v[104:107], 0
    v_mfma_f32_16x16x32_bf16 v[80:83], a[4:7], v[108:111], 0
    s_add_u32 s41, s51, 0
    buffer_load_dwordx4 v[132:135], v2, s[12:15], s41 offen offset:2048 sc1
    s_add_u32 s41, s52, 0
    buffer_load_dwordx4 v[136:139], v2, s[12:15], s41 offen offset:2048 sc1
    v_mfma_f32_16x16x32_bf16 v[24:27], a[8:11], v[96:99], 0
    v_mfma_f32_16x16x32_bf16 v[44:47], a[8:11], v[100:103], 0
    v_mfma_f32_16x16x32_bf16 v[64:67], a[8:11], v[104:107], 0
    v_mfma_f32_16x16x32_bf16 v[84:87], a[8:11], v[108:111], 0
    s_add_u32 s41, s53, 0
    buffer_load_dwordx4 v[140:143], v2, s[12:15], s41 offen offset:2048 sc1
    v_mfma_f32_16x16x32_bf16 v[28:31], a[12:15], v[96:99], 0
    v_mfma_f32_16x16x32_bf16 v[48:51], a[12:15], v[100:103], 0
    v_mfma_f32_16x16x32_bf16 v[68:71], a[12:15], v[104:107], 0
    v_mfma_f32_16x16x32_bf16 v[88:91], a[12:15], v[108:111], 0
    s_add_u32 s41, s50, 0
    buffer_load_dwordx4 v[144:147], v2, s[12:15], s41 offen offset:3072 sc1
    s_add_u32 s41, s51, 0
    buffer_load_dwordx4 v[148:151], v2, s[12:15], s41 offen offset:3072 sc1
    v_mfma_f32_16x16x32_bf16 v[32:35], a[16:19], v[96:99], 0
    v_mfma_f32_16x16x32_bf16 v[52:55], a[16:19], v[100:103], 0
    v_mfma_f32_16x16x32_bf16 v[72:75], a[16:19], v[104:107], 0
    v_mfma_f32_16x16x32_bf16 v[92:95], a[16:19], v[108:111], 0
    s_add_u32 s41, s52, 0
    buffer_load_dwordx4 v[152:155], v2, s[12:15], s41 offen offset:3072 sc1
    s_waitcnt vmcnt(7)
    v_mfma_f32_16x16x32_bf16 v[16:19], a[20:23], v[112:115], v[16:19]
    v_mfma_f32_16x16x32_bf16 v[36:39], a[20:23], v[116:119], v[36:39]
    v_mfma_f32_16x16x32_bf16 v[56:59], a[20:23], v[120:123], v[56:59]
    v_mfma_f32_16x16x32_bf16 v[76:79], a[20:23], v[124:127], v[76:79]
    s_add_u32 s41, s53, 0
    buffer_load_dwordx4 v[156:159], v2, s[12:15], s41 offen offset:3072 sc1
    v_mfma_f32_16x16x32_bf16 v[20:23], a[24:27], v[112:115], v[20:23]
    v_mfma_f32_16x16x32_bf16 v[40:43], a[24:27], v[116:119], v[40:43]
    v_mfma_f32_16x16x32_bf16 v[60:63], a[24:27], v[120:123], v[60:63]
    v_mfma_f32_16x16x32_bf16 v[80:83], a[24:27], v[124:127], v[80:83]
    s_add_u32 s41, s50, 4096
    buffer_load_dwordx4 v[160:163], v2, s[12:15], s41 offen offset:0 sc1
    s_add_u32 s41, s51, 4096
    buffer_load_dwordx4 v[164:167], v2, s[12:15], s41 offen offset:0 sc1
    v_mfma_f32_16x16x32_bf16 v[24:27], a[28:31], v[112:115], v[24:27]
    v_mfma_f32_16x16x32_bf16 v[44:47], a[28:31], v[116:119], v[44:47]
    v_mfma_f32_16x16x32_bf16 v[64:67], a[28:31], v[120:123], v[64:67]
    v_mfma_f32_16x16x32_bf16 v[84:87], a[28:31], v[124:127], v[84:87]
    s_add_u32 s41, s52, 4096
    buffer_load_dwordx4 v[168:171], v2, s[12:15], s41 offen offset:0 sc1
    v_mfma_f32_16x16x32_bf16 v[28:31], a[32:35], v[112:115], v[28:31]
    v_mfma_f32_16x16x32_bf16 v[48:51], a[32:35], v[116:119], v[48:51]
    v_mfma_f32_16x16x32_bf16 v[68:71], a[32:35], v[120:123], v[68:71]
    v_mfma_f32_16x16x32_bf16 v[88:91], a[32:35], v[124:127], v[88:91]
    s_add_u32 s41, s53, 4096
    buffer_load_dwordx4 v[172:175], v2, s[12:15], s41 offen offset:0 sc1
    s_add_u32 s41, s50, 4096
    buffer_load_dwordx4 v[176:179], v2, s[12:15], s41 offen offset:1024 sc1
    v_mfma_f32_16x16x32_bf16 v[32:35], a[36:39], v[112:115], v[32:35]
    v_mfma_f32_16x16x32_bf16 v[52:55], a[36:39], v[116:119], v[52:55]
    v_mfma_f32_16x16x32_bf16 v[72:75], a[36:39], v[120:123], v[72:75]
    v_mfma_f32_16x16x32_bf16 v[92:95], a[36:39], v[124:127], v[92:95]
    s_add_u32 s41, s51, 4096
    buffer_load_dwordx4 v[180:183], v2, s[12:15], s41 offen offset:1024 sc1
    s_waitcnt vmcnt(10)
    v_mfma_f32_16x16x32_bf16 v[16:19], a[40:43], v[128:131], v[16:19]
    v_mfma_f32_16x16x32_bf16 v[36:39], a[40:43], v[132:135], v[36:39]
    v_mfma_f32_16x16x32_bf16 v[56:59], a[40:43], v[136:139], v[56:59]
    v_mfma_f32_16x16x32_bf16 v[76:79], a[40:43], v[140:143], v[76:79]
    s_add_u32 s41, s52, 4096
    buffer_load_dwordx4 v[184:187], v2, s[12:15], s41 offen offset:1024 sc1
    v_mfma_f32_16x16x32_bf16 v[20:23], a[44:47], v[128:131], v[20:23]
    v_mfma_f32_16x16x32_bf16 v[40:43], a[44:47], v[132:135], v[40:43]
    v_mfma_f32_16x16x32_bf16 v[60:63], a[44:47], v[136:139], v[60:63]
    v_mfma_f32_16x16x32_bf16 v[80:83], a[44:47], v[140:143], v[80:83]
    s_add_u32 s41, s53, 4096
    buffer_load_dwordx4 v[188:191], v2, s[12:15], s41 offen offset:1024 sc1
    s_add_u32 s41, s50, 4096
    buffer_load_dwordx4 v[96:99], v2, s[12:15], s41 offen offset:2048 sc1
    v_mfma_f32_16x16x32_bf16 v[24:27], a[48:51], v[128:131], v[24:27]
    v_mfma_f32_16x16x32_bf16 v[44:47], a[48:51], v[132:135], v[44:47]
    v_mfma_f32_16x16x32_bf16 v[64:67], a[48:51], v[136:139], v[64:67]
    v_mfma_f32_16x16x32_bf16 v[84:87], a[48:51], v[140:143], v[84:87]
    s_add_u32 s41, s51, 4096
    buffer_load_dwordx4 v[100:103], v2, s[12:15], s41 offen offset:2048 sc1
    v_mfma_f32_16x16x32_bf16 v[28:31], a[52:55], v[128:131], v[28:31]
    v_mfma_f32_16x16x32_bf16 v[48:51], a[52:55], v[132:135], v[48:51]
    v_mfma_f32_16x16x32_bf16 v[68:71], a[52:55], v[136:139], v[68:71]
    v_mfma_f32_16x16x32_bf16 v[88:91], a[52:55], v[140:143], v[88:91]
    s_add_u32 s41, s52, 4096
    buffer_load_dwordx4 v[104:107], v2, s[12:15], s41 offen offset:2048 sc1
    v_mfma_f32_16x16x32_bf16 v[32:35], a[56:59], v[128:131], v[32:35]
    v_mfma_f32_16x16x32_bf16 v[52:55], a[56:59], v[132:135], v[52:55]
    v_mfma_f32_16x16x32_bf16 v[72:75], a[56:59], v[136:139], v[72:75]
    v_mfma_f32_16x16x32_bf16 v[92:95], a[56:59], v[140:143], v[92:95]
    s_add_u32 s41, s53, 4096
    buffer_load_dwordx4 v[108:111], v2, s[12:15], s41 offen offset:2048 sc1
    s_waitcnt vmcnt(12)
    v_mfma_f32_16x16x32_bf16 v[16:19], a[60:63], v[144:147], v[16:19]
    v_mfma_f32_16x16x32_bf16 v[36:39], a[60:63], v[148:151], v[36:39]
    v_mfma_f32_16x16x32_bf16 v[56:59], a[60:63], v[152:155], v[56:59]
    v_mfma_f32_16x16x32_bf16 v[76:79], a[60:63], v[156:159], v[76:79]
    s_add_u32 s41, s50, 4096
    buffer_load_dwordx4 v[112:115], v2, s[12:15], s41 offen offset:3072 sc1
    v_mfma_f32_16x16x32_bf16 v[20:23], a[64:67], v[144:147], v[20:23]
    v_mfma_f32_16x16x32_bf16 v[40:43], a[64:67], v[148:151], v[40:43]
    v_mfma_f32_16x16x32_bf16 v[60:63], a[64:67], v[152:155], v[60:63]
    v_mfma_f32_16x16x32_bf16 v[80:83], a[64:67], v[156:159], v[80:83]
    s_add_u32 s41, s51, 4096
    buffer_load_dwordx4 v[116:119], v2, s[12:15], s41 offen offset:3072 sc1
    v_mfma_f32_16x16x32_bf16 v[24:27], a[68:71], v[144:147], v[24:27]
    v_mfma_f32_16x16x32_bf16 v[44:47], a[68:71], v[148:151], v[44:47]
    v_mfma_f32_16x16x32_bf16 v[64:67], a[68:71], v[152:155], v[64:67]
    v_mfma_f32_16x16x32_bf16 v[84:87], a[68:71], v[156:159], v[84:87]
    s_add_u32 s41, s52, 4096
    buffer_load_dwordx4 v[120:123], v2, s[12:15], s41 offen offset:3072 sc1
    v_mfma_f32_16x16x32_bf16 v[28:31], a[72:75], v[144:147], v[28:31]
    v_mfma_f32_16x16x32_bf16 v[48:51], a[72:75], v[148:151], v[48:51]
    v_mfma_f32_16x16x32_bf16 v[68:71], a[72:75], v[152:155], v[68:71]
    v_mfma_f32_16x16x32_bf16 v[88:91], a[72:75], v[156:159], v[88:91]
    s_add_u32 s41, s53, 4096
    buffer_load_dwordx4 v[124:127], v2, s[12:15], s41 offen offset:3072 sc1
    v_mfma_f32_16x16x32_bf16 v[32:35], a[76:79], v[144:147], v[32:35]
    v_mfma_f32_16x16x32_bf16 v[52:55], a[76:79], v[148:151], v[52:55]
    v_mfma_f32_16x16x32_bf16 v[72:75], a[76:79], v[152:155], v[72:75]
    v_mfma_f32_16x16x32_bf16 v[92:95], a[76:79], v[156:159], v[92:95]
    s_add_u32 s41, s50, 8192
    buffer_load_dwordx4 v[128:131], v2, s[12:15], s41 offen offset:0 sc1
    s_waitcnt vmcnt(13)
    v_mfma_f32_16x16x32_bf16 v[16:19], a[80:83], v[160:163], v[16:19]
    v_mfma_f32_16x16x32_bf16 v[36:39], a[80:83], v[164:167], v[36:39]
    v_mfma_f32_16x16x32_bf16 v[56:59], a[80:83], v[168:171], v[56:59]
    v_mfma_f32_16x16x32_bf16 v[76:79], a[80:83], v[172:175], v[76:79]
    s_add_u32 s41, s51, 8192
    buffer_load_dwordx4 v[132:135], v2, s[12:15], s41 offen offset:0 sc1
    v_mfma_f32_16x16x32_bf16 v[20:23], a[84:87], v[160:163], v[20:23]
    v_mfma_f32_16x16x32_bf16 v[40:43], a[84:87], v[164:167], v[40:43]
    v_mfma_f32_16x16x32_bf16 v[60:63], a[84:87], v[168:171], v[60:63]
    v_mfma_f32_16x16x32_bf16 v[80:83], a[84:87], v[172:175], v[80:83]
    s_add_u32 s41, s52, 8192
    buffer_load_dwordx4 v[136:139], v2, s[12:15], s41 offen offset:0 sc1
    v_mfma_f32_16x16x32_bf16 v[24:27], a[88:91], v[160:163], v[24:27]
    v_mfma_f32_16x16x32_bf16 v[44:47], a[88:91], v[164:167], v[44:47]
    v_mfma_f32_16x16x32_bf16 v[64:67], a[88:91], v[168:171], v[64:67]
    v_mfma_f32_16x16x32_bf16 v[84:87], a[88:91], v[172:175], v[84:87]
    s_add_u32 s41, s53, 8192
    buffer_load_dwordx4 v[140:143], v2, s[12:15], s41 offen offset:0 sc1
    v_mfma_f32_16x16x32_bf16 v[28:31], a[92:95], v[160:163], v[28:31]
    v_mfma_f32_16x16x32_bf16 v[48:51], a[92:95], v[164:167], v[48:51]
    v_mfma_f32_16x16x32_bf16 v[68:71], a[92:95], v[168:171], v[68:71]
    v_mfma_f32_16x16x32_bf16 v[88:91], a[92:95], v[172:175], v[88:91]
    s_add_u32 s41, s50, 8192
    buffer_load_dwordx4 v[144:147], v2, s[12:15], s41 offen offset:1024 sc1
    v_mfma_f32_16x16x32_bf16 v[32:35], a[96:99], v[160:163], v[32:35]
    v_mfma_f32_16x16x32_bf16 v[52:55], a[96:99], v[164:167], v[52:55]
    v_mfma_f32_16x16x32_bf16 v[72:75], a[96:99], v[168:171], v[72:75]
    v_mfma_f32_16x16x32_bf16 v[92:95], a[96:99], v[172:175], v[92:95]
    s_add_u32 s41, s51, 8192
    buffer_load_dwordx4 v[148:151], v2, s[12:15], s41 offen offset:1024 sc1
    s_waitcnt vmcnt(14)
    v_mfma_f32_16x16x32_bf16 v[16:19], a[100:103], v[176:179], v[16:19]
    v_mfma_f32_16x16x32_bf16 v[36:39], a[100:103], v[180:183], v[36:39]
    v_mfma_f32_16x16x32_bf16 v[56:59], a[100:103], v[184:187], v[56:59]
    v_mfma_f32_16x16x32_bf16 v[76:79], a[100:103], v[188:191], v[76:79]
    s_add_u32 s41, s52, 8192
    buffer_load_dwordx4 v[152:155], v2, s[12:15], s41 offen offset:1024 sc1
    v_mfma_f32_16x16x32_bf16 v[20:23], a[104:107], v[176:179], v[20:23]
    v_mfma_f32_16x16x32_bf16 v[40:43], a[104:107], v[180:183], v[40:43]
    v_mfma_f32_16x16x32_bf16 v[60:63], a[104:107], v[184:187], v[60:63]
    v_mfma_f32_16x16x32_bf16 v[80:83], a[104:107], v[188:191], v[80:83]
    s_add_u32 s41, s53, 8192
    buffer_load_dwordx4 v[156:159], v2, s[12:15], s41 offen offset:1024 sc1
    v_mfma_f32_16x16x32_bf16 v[24:27], a[108:111], v[176:179], v[24:27]
    v_mfma_f32_16x16x32_bf16 v[44:47], a[108:111], v[180:183], v[44:47]
    v_mfma_f32_16x16x32_bf16 v[64:67], a[108:111], v[184:187], v[64:67]
    v_mfma_f32_16x16x32_bf16 v[84:87], a[108:111], v[188:191], v[84:87]
    s_add_u32 s41, s50, 8192
    buffer_load_dwordx4 v[160:163], v2, s[12:15], s41 offen offset:2048 sc1
    v_mfma_f32_16x16x32_bf16 v[28:31], a[112:115], v[176:179], v[28:31]
    v_mfma_f32_16x16x32_bf16 v[48:51], a[112:115], v[180:183], v[48:51]
    v_mfma_f32_16x16x32_bf16 v[68:71], a[112:115], v[184:187], v[68:71]
    v_mfma_f32_16x16x32_bf16 v[88:91], a[112:115], v[188:191], v[88:91]
    s_add_u32 s41, s51, 8192
    buffer_load_dwordx4 v[164:167], v2, s[12:15], s41 offen offset:2048 sc1
    v_mfma_f32_16x16x32_bf16 v[32:35], a[116:119], v[176:179], v[32:35]
    v_mfma_f32_16x16x32_bf16 v[52:55], a[116:119], v[180:183], v[52:55]
    v_mfma_f32_16x16x32_bf16 v[72:75], a[116:119], v[184:187], v[72:75]
    v_mfma_f32_16x16x32_bf16 v[92:95], a[116:119], v[188:191], v[92:95]
    s_add_u32 s41, s52, 8192
    buffer_load_dwordx4 v[168:171], v2, s[12:15], s41 offen offset:2048 sc1
    s_waitcnt vmcnt(15)
    v_mfma_f32_16x16x32_bf16 v[16:19], a[120:123], v[96:99], v[16:19]
    v_mfma_f32_16x16x32_bf16 v[36:39], a[120:123], v[100:103], v[36:39]
    v_mfma_f32_16x16x32_bf16 v[56:59], a[120:123], v[104:107], v[56:59]
    v_mfma_f32_16x16x32_bf16 v[76:79], a[120:123], v[108:111], v[76:79]
    s_add_u32 s41, s53, 8192
    buffer_load_dwordx4 v[172:175], v2, s[12:15], s41 offen offset:2048 sc1
    v_mfma_f32_16x16x32_bf16 v[20:23], a[124:127], v[96:99], v[20:23]
    v_mfma_f32_16x16x32_bf16 v[40:43], a[124:127], v[100:103], v[40:43]
    v_mfma_f32_16x16x32_bf16 v[60:63], a[124:127], v[104:107], v[60:63]
    v_mfma_f32_16x16x32_bf16 v[80:83], a[124:127], v[108:111], v[80:83]
    s_add_u32 s41, s50, 8192
    buffer_load_dwordx4 v[176:179], v2, s[12:15], s41 offen offset:3072 sc1
    v_mfma_f32_16x16x32_bf16 v[24:27], a[128:131], v[96:99], v[24:27]
    v_mfma_f32_16x16x32_bf16 v[44:47], a[128:131], v[100:103], v[44:47]
    v_mfma_f32_16x16x32_bf16 v[64:67], a[128:131], v[104:107], v[64:67]
    v_mfma_f32_16x16x32_bf16 v[84:87], a[128:131], v[108:111], v[84:87]
    s_add_u32 s41, s51, 8192
    buffer_load_dwordx4 v[180:183], v2, s[12:15], s41 offen offset:3072 sc1
    v_mfma_f32_16x16x32_bf16 v[28:31], a[132:135], v[96:99], v[28:31]
    v_mfma_f32_16x16x32_bf16 v[48:51], a[132:135], v[100:103], v[48:51]
    v_mfma_f32_16x16x32_bf16 v[68:71], a[132:135], v[104:107], v[68:71]
    v_mfma_f32_16x16x32_bf16 v[88:91], a[132:135], v[108:111], v[88:91]
    s_add_u32 s41, s52, 8192
    buffer_load_dwordx4 v[184:187], v2, s[12:15], s41 offen offset:3072 sc1
    v_mfma_f32_16x16x32_bf16 v[32:35], a[136:139], v[96:99], v[32:35]
    v_mfma_f32_16x16x32_bf16 v[52:55], a[136:139], v[100:103], v[52:55]
    v_mfma_f32_16x16x32_bf16 v[72:75], a[136:139], v[104:107], v[72:75]
    v_mfma_f32_16x16x32_bf16 v[92:95], a[136:139], v[108:111], v[92:95]
    s_add_u32 s41, s53, 8192
    buffer_load_dwordx4 v[188:191], v2, s[12:15], s41 offen offset:3072 sc1
    s_waitcnt vmcnt(16)
    v_mfma_f32_16x16x32_bf16 v[16:19], a[140:143], v[112:115], v[16:19]
    v_mfma_f32_16x16x32_bf16 v[36:39], a[140:143], v[116:119], v[36:39]
    v_mfma_f32_16x16x32_bf16 v[56:59], a[140:143], v[120:123], v[56:59]
    v_mfma_f32_16x16x32_bf16 v[76:79], a[140:143], v[124:127], v[76:79]
    v_mfma_f32_16x16x32_bf16 v[20:23], a[144:147], v[112:115], v[20:23]
    v_mfma_f32_16x16x32_bf16 v[40:43], a[144:147], v[116:119], v[40:43]
    v_mfma_f32_16x16x32_bf16 v[60:63], a[144:147], v[120:123], v[60:63]
    v_mfma_f32_16x16x32_bf16 v[80:83], a[144:147], v[124:127], v[80:83]
    s_add_u32 s41, s50, 12288
    buffer_load_dwordx4 v[96:99], v2, s[12:15], s41 offen offset:0 sc1
    v_mfma_f32_16x16x32_bf16 v[24:27], a[148:151], v[112:115], v[24:27]
    v_mfma_f32_16x16x32_bf16 v[44:47], a[148:151], v[116:119], v[44:47]
    v_mfma_f32_16x16x32_bf16 v[64:67], a[148:151], v[120:123], v[64:67]
    v_mfma_f32_16x16x32_bf16 v[84:87], a[148:151], v[124:127], v[84:87]
    s_add_u32 s41, s51, 12288
    buffer_load_dwordx4 v[100:103], v2, s[12:15], s41 offen offset:0 sc1
    v_mfma_f32_16x16x32_bf16 v[28:31], a[152:155], v[112:115], v[28:31]
    v_mfma_f32_16x16x32_bf16 v[48:51], a[152:155], v[116:119], v[48:51]
    v_mfma_f32_16x16x32_bf16 v[68:71], a[152:155], v[120:123], v[68:71]
    v_mfma_f32_16x16x32_bf16 v[88:91], a[152:155], v[124:127], v[88:91]
    s_add_u32 s41, s52, 12288
    buffer_load_dwordx4 v[104:107], v2, s[12:15], s41 offen offset:0 sc1
    v_mfma_f32_16x16x32_bf16 v[32:35], a[156:159], v[112:115], v[32:35]
    v_mfma_f32_16x16x32_bf16 v[52:55], a[156:159], v[116:119], v[52:55]
    v_mfma_f32_16x16x32_bf16 v[72:75], a[156:159], v[120:123], v[72:75]
    v_mfma_f32_16x16x32_bf16 v[92:95], a[156:159], v[124:127], v[92:95]
    s_add_u32 s41, s53, 12288
    buffer_load_dwordx4 v[108:111], v2, s[12:15], s41 offen offset:0 sc1
    s_waitcnt vmcnt(16)
    v_mfma_f32_16x16x32_bf16 v[16:19], a[160:163], v[128:131], v[16:19]
    v_mfma_f32_16x16x32_bf16 v[36:39], a[160:163], v[132:135], v[36:39]
    v_mfma_f32_16x16x32_bf16 v[56:59], a[160:163], v[136:139], v[56:59]
    v_mfma_f32_16x16x32_bf16 v[76:79], a[160:163], v[140:143], v[76:79]
    v_mfma_f32_16x16x32_bf16 v[20:23], a[164:167], v[128:131], v[20:23]
    v_mfma_f32_16x16x32_bf16 v[40:43], a[164:167], v[132:135], v[40:43]
    v_mfma_f32_16x16x32_bf16 v[60:63], a[164:167], v[136:139], v[60:63]
    v_mfma_f32_16x16x32_bf16 v[80:83], a[164:167], v[140:143], v[80:83]
    s_add_u32 s41, s50, 12288
    buffer_load_dwordx4 v[112:115], v2, s[12:15], s41 offen offset:1024 sc1
    v_mfma_f32_16x16x32_bf16 v[24:27], a[168:171], v[128:131], v[24:27]
    v_mfma_f32_16x16x32_bf16 v[44:47], a[168:171], v[132:135], v[44:47]
    v_mfma_f32_16x16x32_bf16 v[64:67], a[168:171], v[136:139], v[64:67]
    v_mfma_f32_16x16x32_bf16 v[84:87], a[168:171], v[140:143], v[84:87]
    s_add_u32 s41, s51, 12288
    buffer_load_dwordx4 v[116:119], v2, s[12:15], s41 offen offset:1024 sc1
    v_mfma_f32_16x16x32_bf16 v[28:31], a[172:175], v[128:131], v[28:31]
    v_mfma_f32_16x16x32_bf16 v[48:51], a[172:175], v[132:135], v[48:51]
    v_mfma_f32_16x16x32_bf16 v[68:71], a[172:175], v[136:139], v[68:71]
    v_mfma_f32_16x16x32_bf16 v[88:91], a[172:175], v[140:143], v[88:91]
    s_add_u32 s41, s52, 12288
    buffer_load_dwordx4 v[120:123], v2, s[12:15], s41 offen offset:1024 sc1
    v_mfma_f32_16x16x32_bf16 v[32:35], a[176:179], v[128:131], v[32:35]
    v_mfma_f32_16x16x32_bf16 v[52:55], a[176:179], v[132:135], v[52:55]
    v_mfma_f32_16x16x32_bf16 v[72:75], a[176:179], v[136:139], v[72:75]
    v_mfma_f32_16x16x32_bf16 v[92:95], a[176:179], v[140:143], v[92:95]
    s_add_u32 s41, s53, 12288
    buffer_load_dwordx4 v[124:127], v2, s[12:15], s41 offen offset:1024 sc1
    s_waitcnt vmcnt(16)
    v_mfma_f32_16x16x32_bf16 v[16:19], a[180:183], v[144:147], v[16:19]
    v_mfma_f32_16x16x32_bf16 v[36:39], a[180:183], v[148:151], v[36:39]
    v_mfma_f32_16x16x32_bf16 v[56:59], a[180:183], v[152:155], v[56:59]
    v_mfma_f32_16x16x32_bf16 v[76:79], a[180:183], v[156:159], v[76:79]
    v_mfma_f32_16x16x32_bf16 v[20:23], a[184:187], v[144:147], v[20:23]
    v_mfma_f32_16x16x32_bf16 v[40:43], a[184:187], v[148:151], v[40:43]
    v_mfma_f32_16x16x32_bf16 v[60:63], a[184:187], v[152:155], v[60:63]
    v_mfma_f32_16x16x32_bf16 v[80:83], a[184:187], v[156:159], v[80:83]
    v_mfma_f32_16x16x32_bf16 v[24:27], a[188:191], v[144:147], v[24:27]
    v_mfma_f32_16x16x32_bf16 v[44:47], a[188:191], v[148:151], v[44:47]
    v_mfma_f32_16x16x32_bf16 v[64:67], a[188:191], v[152:155], v[64:67]
    v_mfma_f32_16x16x32_bf16 v[84:87], a[188:191], v[156:159], v[84:87]
    v_mfma_f32_16x16x32_bf16 v[28:31], a[192:195], v[144:147], v[28:31]
    v_mfma_f32_16x16x32_bf16 v[48:51], a[192:195], v[148:151], v[48:51]
    v_mfma_f32_16x16x32_bf16 v[68:71], a[192:195], v[152:155], v[68:71]
    v_mfma_f32_16x16x32_bf16 v[88:91], a[192:195], v[156:159], v[88:91]
    v_mfma_f32_16x16x32_bf16 v[32:35], a[196:199], v[144:147], v[32:35]
    v_mfma_f32_16x16x32_bf16 v[52:55], a[196:199], v[148:151], v[52:55]
    v_mfma_f32_16x16x32_bf16 v[72:75], a[196:199], v[152:155], v[72:75]
    v_mfma_f32_16x16x32_bf16 v[92:95], a[196:199], v[156:159], v[92:95]
    s_waitcnt vmcnt(12)
    v_mfma_f32_16x16x32_bf16 v[16:19], a[200:203], v[160:163], v[16:19]
    v_mfma_f32_16x16x32_bf16 v[36:39], a[200:203], v[164:167], v[36:39]
    v_mfma_f32_16x16x32_bf16 v[56:59], a[200:203], v[168:171], v[56:59]
    v_mfma_f32_16x16x32_bf16 v[76:79], a[200:203], v[172:175], v[76:79]
    v_mfma_f32_16x16x32_bf16 v[20:23], a[204:207], v[160:163], v[20:23]
    v_mfma_f32_16x16x32_bf16 v[40:43], a[204:207], v[164:167], v[40:43]
    v_mfma_f32_16x16x32_bf16 v[60:63], a[204:207], v[168:171], v[60:63]
    v_mfma_f32_16x16x32_bf16 v[80:83], a[204:207], v[172:175], v[80:83]
    v_mfma_f32_16x16x32_bf16 v[24:27], a[208:211], v[160:163], v[24:27]
    v_mfma_f32_16x16x32_bf16 v[44:47], a[208:211], v[164:167], v[44:47]
    v_mfma_f32_16x16x32_bf16 v[64:67], a[208:211], v[168:171], v[64:67]
    v_mfma_f32_16x16x32_bf16 v[84:87], a[208:211], v[172:175], v[84:87]
    v_mfma_f32_16x16x32_bf16 v[28:31], a[212:215], v[160:163], v[28:31]
    v_mfma_f32_16x16x32_bf16 v[48:51], a[212:215], v[164:167], v[48:51]
    v_mfma_f32_16x16x32_bf16 v[68:71], a[212:215], v[168:171], v[68:71]
    v_mfma_f32_16x16x32_bf16 v[88:91], a[212:215], v[172:175], v[88:91]
    v_mfma_f32_16x16x32_bf16 v[32:35], a[216:219], v[160:163], v[32:35]
    v_mfma_f32_16x16x32_bf16 v[52:55], a[216:219], v[164:167], v[52:55]
    v_mfma_f32_16x16x32_bf16 v[72:75], a[216:219], v[168:171], v[72:75]
    v_mfma_f32_16x16x32_bf16 v[92:95], a[216:219], v[172:175], v[92:95]
    s_waitcnt vmcnt(8)
    v_mfma_f32_16x16x32_bf16 v[16:19], a[220:223], v[176:179], v[16:19]
    v_mfma_f32_16x16x32_bf16 v[36:39], a[220:223], v[180:183], v[36:39]
    v_mfma_f32_16x16x32_bf16 v[56:59], a[220:223], v[184:187], v[56:59]
    v_mfma_f32_16x16x32_bf16 v[76:79], a[220:223], v[188:191], v[76:79]
    v_mfma_f32_16x16x32_bf16 v[20:23], a[224:227], v[176:179], v[20:23]
    v_mfma_f32_16x16x32_bf16 v[40:43], a[224:227], v[180:183], v[40:43]
    v_mfma_f32_16x16x32_bf16 v[60:63], a[224:227], v[184:187], v[60:63]
    v_mfma_f32_16x16x32_bf16 v[80:83], a[224:227], v[188:191], v[80:83]
    v_mfma_f32_16x16x32_bf16 v[24:27], a[228:231], v[176:179], v[24:27]
    v_mfma_f32_16x16x32_bf16 v[44:47], a[228:231], v[180:183], v[44:47]
    v_mfma_f32_16x16x32_bf16 v[64:67], a[228:231], v[184:187], v[64:67]
    v_mfma_f32_16x16x32_bf16 v[84:87], a[228:231], v[188:191], v[84:87]
    v_mfma_f32_16x16x32_bf16 v[28:31], a[232:235], v[176:179], v[28:31]
    v_mfma_f32_16x16x32_bf16 v[48:51], a[232:235], v[180:183], v[48:51]
    v_mfma_f32_16x16x32_bf16 v[68:71], a[232:235], v[184:187], v[68:71]
    v_mfma_f32_16x16x32_bf16 v[88:91], a[232:235], v[188:191], v[88:91]
    v_mfma_f32_16x16x32_bf16 v[32:35], a[236:239], v[176:179], v[32:35]
    v_mfma_f32_16x16x32_bf16 v[52:55], a[236:239], v[180:183], v[52:55]
    v_mfma_f32_16x16x32_bf16 v[72:75], a[236:239], v[184:187], v[72:75]
    v_mfma_f32_16x16x32_bf16 v[92:95], a[236:239], v[188:191], v[92:95]
    s_cmp_eq_u32 s30, 3
    s_cbranch_scc1 k2_kernel_k4skip38
    s_waitcnt vmcnt(4)
    v_mfma_f32_16x16x32_bf16 v[16:19], a[240:243], v[96:99], v[16:19]
    v_mfma_f32_16x16x32_bf16 v[36:39], a[240:243], v[100:103], v[36:39]
    v_mfma_f32_16x16x32_bf16 v[56:59], a[240:243], v[104:107], v[56:59]
    v_mfma_f32_16x16x32_bf16 v[76:79], a[240:243], v[108:111], v[76:79]
    v_mfma_f32_16x16x32_bf16 v[20:23], a[244:247], v[96:99], v[20:23]
    v_mfma_f32_16x16x32_bf16 v[40:43], a[244:247], v[100:103], v[40:43]
    v_mfma_f32_16x16x32_bf16 v[60:63], a[244:247], v[104:107], v[60:63]
    v_mfma_f32_16x16x32_bf16 v[80:83], a[244:247], v[108:111], v[80:83]
    v_mfma_f32_16x16x32_bf16 v[24:27], a[248:251], v[96:99], v[24:27]
    v_mfma_f32_16x16x32_bf16 v[44:47], a[248:251], v[100:103], v[44:47]
    v_mfma_f32_16x16x32_bf16 v[64:67], a[248:251], v[104:107], v[64:67]
    v_mfma_f32_16x16x32_bf16 v[84:87], a[248:251], v[108:111], v[84:87]
    v_mfma_f32_16x16x32_bf16 v[28:31], a[252:255], v[96:99], v[28:31]
    v_mfma_f32_16x16x32_bf16 v[48:51], a[252:255], v[100:103], v[48:51]
    v_mfma_f32_16x16x32_bf16 v[68:71], a[252:255], v[104:107], v[68:71]
    v_mfma_f32_16x16x32_bf16 v[88:91], a[252:255], v[108:111], v[88:91]
    v_mfma_f32_16x16x32_bf16 v[32:35], v[192:195], v[96:99], v[32:35]
    v_mfma_f32_16x16x32_bf16 v[52:55], v[192:195], v[100:103], v[52:55]
    v_mfma_f32_16x16x32_bf16 v[72:75], v[192:195], v[104:107], v[72:75]
    v_mfma_f32_16x16x32_bf16 v[92:95], v[192:195], v[108:111], v[92:95]
    s_waitcnt vmcnt(0)
    v_mfma_f32_16x16x32_bf16 v[16:19], v[196:199], v[112:115], v[16:19]
    v_mfma_f32_16x16x32_bf16 v[36:39], v[196:199], v[116:119], v[36:39]
    v_mfma_f32_16x16x32_bf16 v[56:59], v[196:199], v[120:123], v[56:59]
    v_mfma_f32_16x16x32_bf16 v[76:79], v[196:199], v[124:127], v[76:79]
    v_mfma_f32_16x16x32_bf16 v[20:23], v[200:203], v[112:115], v[20:23]
    v_mfma_f32_16x16x32_bf16 v[40:43], v[200:203], v[116:119], v[40:43]
    v_mfma_f32_16x16x32_bf16 v[60:63], v[200:203], v[120:123], v[60:63]
    v_mfma_f32_16x16x32_bf16 v[80:83], v[200:203], v[124:127], v[80:83]
    v_mfma_f32_16x16x32_bf16 v[24:27], v[204:207], v[112:115], v[24:27]
    v_mfma_f32_16x16x32_bf16 v[44:47], v[204:207], v[116:119], v[44:47]
    v_mfma_f32_16x16x32_bf16 v[64:67], v[204:207], v[120:123], v[64:67]
    v_mfma_f32_16x16x32_bf16 v[84:87], v[204:207], v[124:127], v[84:87]
    v_mfma_f32_16x16x32_bf16 v[28:31], v[208:211], v[112:115], v[28:31]
    v_mfma_f32_16x16x32_bf16 v[48:51], v[208:211], v[116:119], v[48:51]
    v_mfma_f32_16x16x32_bf16 v[68:71], v[208:211], v[120:123], v[68:71]
    v_mfma_f32_16x16x32_bf16 v[88:91], v[208:211], v[124:127], v[88:91]
    v_mfma_f32_16x16x32_bf16 v[32:35], v[212:215], v[112:115], v[32:35]
    v_mfma_f32_16x16x32_bf16 v[52:55], v[212:215], v[116:119], v[52:55]
    v_mfma_f32_16x16x32_bf16 v[72:75], v[212:215], v[120:123], v[72:75]
    v_mfma_f32_16x16x32_bf16 v[92:95], v[212:215], v[124:127], v[92:95]
k2_kernel_k4skip38:
    s_waitcnt vmcnt(0)
    s_barrier
    s_add_u32 s41, s30, 1
    s_and_b32 s41, s41, 3
    s_mul_i32 s41, s41, 15360
    s_add_u32 s41, s41, 0
    v_add_u32 v9, s41, v2
    ds_write_b128 v9, v[36:39] offset:0
    ds_write_b128 v9, v[40:43] offset:1024
    ds_write_b128 v9, v[44:47] offset:2048
    ds_write_b128 v9, v[48:51] offset:3072
    ds_write_b128 v9, v[52:55] offset:4096
    s_add_u32 s41, s30, 2
    s_and_b32 s41, s41, 3
    s_mul_i32 s41, s41, 15360
    s_add_u32 s41, s41, 5120
    v_add_u32 v9, s41, v2
    ds_write_b128 v9, v[56:59] offset:0
    ds_write_b128 v9, v[60:63] offset:1024
    ds_write_b128 v9, v[64:67] offset:2048
    ds_write_b128 v9, v[68:71] offset:3072
    ds_write_b128 v9, v[72:75] offset:4096
    s_add_u32 s41, s30, 3
    s_and_b32 s41, s41, 3
    s_mul_i32 s41, s41, 15360
    s_add_u32 s41, s41, 10240
    v_add_u32 v9, s41, v2
    ds_write_b128 v9, v[76:79] offset:0
    ds_write_b128 v9, v[80:83] offset:1024
    ds_write_b128 v9, v[84:87] offset:2048
    ds_write_b128 v9, v[88:91] offset:3072
    ds_write_b128 v9, v[92:95] offset:4096
    v_lshlrev_b32 v10, 4, v3
    v_add_u32 v10, 157696, v10
    ds_read_b128 v[96:99], v10 offset:0
    ds_read_b128 v[100:103], v10 offset:64
    ds_read_b128 v[104:107], v10 offset:128
    ds_read_b128 v[108:111], v10 offset:192
    ds_read_b128 v[112:115], v10 offset:256
    s_mul_i32 s41, s30, 15360
    v_add_u32 v9, s41, v2
    s_waitcnt lgkmcnt(0)
    s_barrier
    ds_read_b128 v[116:119], v9 offset:0
    ds_read_b128 v[120:123], v9 offset:1024
    ds_read_b128 v[124:127], v9 offset:2048
    ds_read_b128 v[128:131], v9 offset:3072
    ds_read_b128 v[132:135], v9 offset:4096
    ds_read_b128 v[136:139], v9 offset:5120
    ds_read_b128 v[140:143], v9 offset:6144
    ds_read_b128 v[144:147], v9 offset:7168
    ds_read_b128 v[148:151], v9 offset:8192
    ds_read_b128 v[152:155], v9 offset:9216
    ds_read_b128 v[156:159], v9 offset:10240
    ds_read_b128 v[160:163], v9 offset:11264
    ds_read_b128 v[164:167], v9 offset:12288
    ds_read_b128 v[168:171], v9 offset:13312
    ds_read_b128 v[172:175], v9 offset:14336
    s_lshl_b32 s46, s32, 2
    s_add_u32 s46, s46, s30
    s_lshl_b32 s46, s46, 4
    s_lshl_b32 s47, s28, 8
    s_add_u32 s46, s46, s47
    v_add_u32 v10, s46, v4
    v_mul_u32_u24 v10, 1280, v10
    v_lshl_add_u32 v10, v3, 3, v10
    s_mul_i32 s47, s33, 160
    s_nop 1
    v_permlane16_swap_b32 v228, v230
    v_permlane16_swap_b32 v229, v231
    v_permlane16_swap_b32 v232, v234
    v_permlane16_swap_b32 v233, v235
    v_permlane16_swap_b32 v238, v240
    v_permlane16_swap_b32 v239, v241
    v_permlane16_swap_b32 v242, v244
    v_permlane16_swap_b32 v243, v245
    s_waitcnt lgkmcnt(0)
    v_pk_add_f32 v[16:17], v[16:17], v[116:117]
    v_pk_add_f32 v[18:19], v[18:19], v[118:119]
    v_pk_add_f32 v[20:21], v[20:21], v[120:121]
    v_pk_add_f32 v[22:23], v[22:23], v[122:123]
    v_pk_add_f32 v[24:25], v[24:25], v[124:125]
    v_pk_add_f32 v[26:27], v[26:27], v[126:127]
    v_pk_add_f32 v[28:29], v[28:29], v[128:129]
    v_pk_add_f32 v[30:31], v[30:31], v[130:131]
    v_pk_add_f32 v[32:33], v[32:33], v[132:133]
    v_pk_add_f32 v[34:35], v[34:35], v[134:135]
    v_pk_add_f32 v[16:17], v[16:17], v[136:137]
    v_pk_add_f32 v[18:19], v[18:19], v[138:139]
    v_pk_add_f32 v[20:21], v[20:21], v[140:141]
    v_pk_add_f32 v[22:23], v[22:23], v[142:143]
    v_pk_add_f32 v[24:25], v[24:25], v[144:145]
    v_pk_add_f32 v[26:27], v[26:27], v[146:147]
    v_pk_add_f32 v[28:29], v[28:29], v[148:149]
    v_pk_add_f32 v[30:31], v[30:31], v[150:151]
    v_pk_add_f32 v[32:33], v[32:33], v[152:153]
    v_pk_add_f32 v[34:35], v[34:35], v[154:155]
    v_pk_add_f32 v[16:17], v[16:17], v[156:157]
    v_pk_add_f32 v[18:19], v[18:19], v[158:159]
    v_pk_add_f32 v[20:21], v[20:21], v[160:161]
    v_pk_add_f32 v[22:23], v[22:23], v[162:163]
    v_pk_add_f32 v[24:25], v[24:25], v[164:165]
    v_pk_add_f32 v[26:27], v[26:27], v[166:167]
    v_pk_add_f32 v[28:29], v[28:29], v[168:169]
    v_pk_add_f32 v[30:31], v[30:31], v[170:171]
    v_pk_add_f32 v[32:33], v[32:33], v[172:173]
    v_pk_add_f32 v[34:35], v[34:35], v[174:175]
    v_lshlrev_b32 v116, 16, v238
    v_and_b32 v117, 0xffff0000, v238
    v_lshlrev_b32 v118, 16, v239
    v_and_b32 v119, 0xffff0000, v239
    v_lshlrev_b32 v136, 16, v228
    v_and_b32 v137, 0xffff0000, v228
    v_lshlrev_b32 v138, 16, v229
    v_and_b32 v139, 0xffff0000, v229
    v_lshlrev_b32 v120, 16, v240
    v_and_b32 v121, 0xffff0000, v240
    v_lshlrev_b32 v122, 16, v241
    v_and_b32 v123, 0xffff0000, v241
    v_lshlrev_b32 v140, 16, v230
    v_and_b32 v141, 0xffff0000, v230
    v_lshlrev_b32 v142, 16, v231
    v_and_b32 v143, 0xffff0000, v231
    v_lshlrev_b32 v124, 16, v242
    v_and_b32 v125, 0xffff0000, v242
    v_lshlrev_b32 v126, 16, v243
    v_and_b32 v127, 0xffff0000, v243
    v_lshlrev_b32 v144, 16, v232
    v_and_b32 v145, 0xffff0000, v232
    v_lshlrev_b32 v146, 16, v233
    v_and_b32 v147, 0xffff0000, v233
    v_lshlrev_b32 v128, 16, v244
    v_and_b32 v129, 0xffff0000, v244
    v_lshlrev_b32 v130, 16, v245
    v_and_b32 v131, 0xffff0000, v245
    v_lshlrev_b32 v148, 16, v234
    v_and_b32 v149, 0xffff0000, v234
    v_lshlrev_b32 v150, 16, v235
    v_and_b32 v151, 0xffff0000, v235
    v_lshlrev_b32 v132, 16, v246
    v_and_b32 v133, 0xffff0000, v246
    v_lshlrev_b32 v134, 16, v247
    v_and_b32 v135, 0xffff0000, v247
    v_lshlrev_b32 v152, 16, v236
    v_and_b32 v153, 0xffff0000, v236
    v_lshlrev_b32 v154, 16, v237
    v_and_b32 v155, 0xffff0000, v237
    v_pk_add_f32 v[16:17], v[16:17], v[116:117]
    v_pk_add_f32 v[18:19], v[18:19], v[118:119]
    v_pk_add_f32 v[20:21], v[20:21], v[120:121]
    v_pk_add_f32 v[22:23], v[22:23], v[122:123]
    v_pk_add_f32 v[24:25], v[24:25], v[124:125]
    v_pk_add_f32 v[26:27], v[26:27], v[126:127]
    v_pk_add_f32 v[28:29], v[28:29], v[128:129]
    v_pk_add_f32 v[30:31], v[30:31], v[130:131]
    v_pk_add_f32 v[32:33], v[32:33], v[132:133]
    v_pk_add_f32 v[34:35], v[34:35], v[134:135]
    v_pk_fma_f32 v[16:17], v[16:17], v[96:97], v[136:137]
    v_pk_fma_f32 v[18:19], v[18:19], v[98:99], v[138:139]
    v_pk_fma_f32 v[20:21], v[20:21], v[100:101], v[140:141]
    v_pk_fma_f32 v[22:23], v[22:23], v[102:103], v[142:143]
    v_pk_fma_f32 v[24:25], v[24:25], v[104:105], v[144:145]
    v_pk_fma_f32 v[26:27], v[26:27], v[106:107], v[146:147]
    v_pk_fma_f32 v[28:29], v[28:29], v[108:109], v[148:149]
    v_pk_fma_f32 v[30:31], v[30:31], v[110:111], v[150:151]
    v_pk_fma_f32 v[32:33], v[32:33], v[112:113], v[152:153]
    v_pk_fma_f32 v[34:35], v[34:35], v[114:115], v[154:155]
    v_cvt_pk_bf16_f32 v16, v16, v17
    v_cvt_pk_bf16_f32 v17, v18, v19
    v_cvt_pk_bf16_f32 v18, v20, v21
    v_cvt_pk_bf16_f32 v19, v22, v23
    v_cvt_pk_bf16_f32 v24, v24, v25
    v_cvt_pk_bf16_f32 v25, v26, v27
    v_cvt_pk_bf16_f32 v26, v28, v29
    v_cvt_pk_bf16_f32 v27, v30, v31
    v_cvt_pk_bf16_f32 v32, v32, v33
    v_cvt_pk_bf16_f32 v33, v34, v35
    s_nop 1
    v_permlane16_swap_b32 v16, v18
    v_permlane16_swap_b32 v17, v19
    v_permlane16_swap_b32 v24, v26
    v_permlane16_swap_b32 v25, v27
    v_and_b32 v9, 1, v3
    v_lshlrev_b32 v9, 5, v9
    v_lshrrev_b32 v11, 1, v3
    v_lshl_add_u32 v9, v11, 4, v9
    v_lshlrev_b32 v11, 3, v3
    v_sub_u32 v11, v10, v11
    v_add_u32 v11, v11, v9
    buffer_store_dwordx4 v[16:19], v11, s[24:27], s47 offen offset:0
    buffer_store_dwordx4 v[24:27], v11, s[24:27], s47 offen offset:64
    buffer_store_dwordx2 v[32:33], v10, s[24:27], s47 offen offset:128
    s_waitcnt vmcnt(0) lgkmcnt(0)
    s_endpgm
k2_end:
    s_endpgm
CODE_END:
    s_endpgm
.section .rodata,"a"
.p2align 6
.amdhsa_kernel k1_kernel
  .amdhsa_next_free_vgpr 256
  .amdhsa_next_free_sgpr 72
  .amdhsa_accum_offset 256
  .amdhsa_group_segment_fixed_size 0
  .amdhsa_kernarg_size 128
  .amdhsa_user_sgpr_count 2
  .amdhsa_user_sgpr_kernarg_segment_ptr 1
  .amdhsa_system_sgpr_workgroup_id_x 1
  .amdhsa_float_denorm_mode_32 3
.end_amdhsa_kernel
.p2align 6
.amdhsa_kernel k2_kernel
  .amdhsa_next_free_vgpr 512
  .amdhsa_next_free_sgpr 102
  .amdhsa_accum_offset 256
  .amdhsa_group_segment_fixed_size 0
  .amdhsa_kernarg_size 128
  .amdhsa_user_sgpr_count 2
  .amdhsa_user_sgpr_kernarg_segment_ptr 1
  .amdhsa_system_sgpr_workgroup_id_x 1
  .amdhsa_float_denorm_mode_32 3
.end_amdhsa_kernel
```

```asm
; @launch kernel=k1_kernel grid=(352,1,1) block=(256,1,1) lds=48128
; @launch kernel=k2_kernel grid=(256,1,1) block=(256,1,1) lds=163840
.amdgcn_target "amdgcn-amd-amdhsa--gfx950"
.text
.globl k1_kernel
.p2align 8
.type k1_kernel,@function
k1_kernel:
    s_cmp_ge_u32 s2, 352
    s_cbranch_scc1 k1_end
    s_load_dwordx4 s[4:7], s[0:1], 32
    s_load_dwordx2 s[10:11], s[0:1], 120
    s_load_dwordx4 s[12:15], s[0:1], 8
    s_load_dwordx2 s[8:9], s[0:1], 24
    v_lshrrev_b32 v2, 6, v0
    v_and_b32 v1, 63, v0
    v_readfirstlane_b32 s20, v2
    s_sub_u32 s54, s2, 160
    s_cmp_ge_u32 s2, 256
    s_cbranch_scc1 k1_side
    s_and_b32 s55, s2, 7
    s_lshr_b32 s56, s2, 3
    s_lshl_b32 s57, s55, 9
    s_add_u32 s57, s57, 9056256
    v_mov_b32 v250, 0
    s_waitcnt lgkmcnt(0)
    s_mov_b32 s28, s10
    s_mov_b32 s29, s11
    s_mov_b32 s30, 268435456
    s_mov_b32 s31, 0x00020000
    s_mov_b32 s16, s12
    s_mov_b32 s17, s13
    s_mov_b32 s18, 2621440
    s_mov_b32 s19, 0x00020000
    s_mov_b32 s40, s14
    s_mov_b32 s41, s15
    s_mov_b32 s42, 2621440
    s_mov_b32 s43, 0x00020000
    s_mov_b32 s44, s8
    s_mov_b32 s45, s9
    s_mov_b32 s46, 5120
    s_mov_b32 s47, 0x00020000
    v_mul_u32_u24 v4, 3277, v0
    v_lshrrev_b32 v4, 16, v4
    v_mul_u32_u24 v5, 20, v4
    v_sub_u32 v5, v0, v5
    s_lshl_b32 s21, s56, 6
    v_lshl_add_u32 v6, v4, 3, s21
    v_mul_u32_u24 v6, 1280, v6
    s_mul_i32 s22, s55, 160
    v_lshl_add_u32 v7, v5, 3, s22
    v_add_u32 v6, v6, v7
    v_subrev_u32 v8, 3840, v6
    v_add_u32 v9, 5120, v6
    s_movk_i32 s23, 160
    v_cmp_gt_u32 vcc, s23, v0
    s_and_saveexec_b64 s[60:61], vcc
    s_cbranch_execz k1_kvld
    buffer_load_dwordx2 v[10:11], v8, s[16:19], 0 offen offset:0
    buffer_load_dwordx2 v[12:13], v8, s[16:19], 0 offen offset:1280
    buffer_load_dwordx2 v[14:15], v8, s[16:19], 0 offen offset:2560
    buffer_load_dwordx2 v[16:17], v6, s[16:19], 0 offen offset:0
    buffer_load_dwordx2 v[18:19], v6, s[16:19], 0 offen offset:1280
    buffer_load_dwordx2 v[20:21], v6, s[16:19], 0 offen offset:2560
    buffer_load_dwordx2 v[22:23], v6, s[16:19], 0 offen offset:3840
    buffer_load_dwordx2 v[24:25], v9, s[16:19], 0 offen offset:0
    buffer_load_dwordx2 v[26:27], v9, s[16:19], 0 offen offset:1280
    buffer_load_dwordx2 v[28:29], v9, s[16:19], 0 offen offset:2560
    buffer_load_dwordx2 v[30:31], v9, s[16:19], 0 offen offset:3840
    v_lshlrev_b32 v150, 2, v7
    buffer_load_dwordx4 v[48:51], v150, s[44:47], 0 offen
    buffer_load_dwordx4 v[52:55], v150, s[44:47], 0 offen offset:16
    buffer_load_dwordx2 v[32:33], v6, s[40:43], 0 offen offset:0
    buffer_load_dwordx2 v[34:35], v6, s[40:43], 0 offen offset:1280
    buffer_load_dwordx2 v[36:37], v6, s[40:43], 0 offen offset:2560
    buffer_load_dwordx2 v[38:39], v6, s[40:43], 0 offen offset:3840
    buffer_load_dwordx2 v[40:41], v9, s[40:43], 0 offen offset:0
    buffer_load_dwordx2 v[42:43], v9, s[40:43], 0 offen offset:1280
    buffer_load_dwordx2 v[44:45], v9, s[40:43], 0 offen offset:2560
    buffer_load_dwordx2 v[46:47], v9, s[40:43], 0 offen offset:3840
k1_kvld:
    s_mov_b64 exec, -1
    buffer_load_dword v251, v250, s[28:31], s57 offen sc1
    v_and_b32 v249, 31, v1
    v_lshlrev_b32 v249, 2, v249
    buffer_load_dword v249, v249, s[28:31], s57 offen offset:256 sc1
    s_getpc_b64 s[62:63]
    s_lshl_b32 s64, s20, 10
    s_add_u32 s65, s64, 0
    v_lshlrev_b32 v247, 4, v1
    v_add_u32 v247, s65, v247
    global_load_dwordx4 v[240:243], v247, s[62:63]
    s_add_u32 s65, s64, 4096
    v_lshlrev_b32 v247, 4, v1
    v_add_u32 v247, s65, v247
    global_load_dwordx4 v[240:243], v247, s[62:63]
    s_mov_b32 s24, s4
    s_mov_b32 s25, s5
    s_mov_b32 s26, 2621440
    s_mov_b32 s27, 0x00020000
    s_cmp_lt_u32 s56, 12
    s_cbranch_scc1 k1_kernel_nc1
    s_mul_i32 s58, s55, 20
    s_add_u32 s58, s58, s56
    s_sub_u32 s58, s58, 12
    s_lshl_b32 s21, s58, 3
    s_add_u32 s22, s6, s21
    s_addc_u32 s23, s7, 0
    s_load_dwordx2 s[32:33], s[22:23], 0
    s_lshl_b32 s21, s58, 2
    s_add_u32 s21, s21, s20
    s_mul_i32 s34, s20, 9472
    v_lshlrev_b32 v3, 4, v1
    s_lshl_b32 s35, s21, 12
    s_add_u32 s36, s34, 256
    s_mov_b32 m0, s36
    s_nop 0
    buffer_load_dwordx4 v3, s[24:27], s35 offen offset:0 lds
    buffer_load_dwordx4 v3, s[24:27], s35 offen offset:1024 lds
    buffer_load_dwordx4 v3, s[24:27], s35 offen offset:2048 lds
    buffer_load_dwordx4 v3, s[24:27], s35 offen offset:3072 lds
k1_kernel_nc1:
    s_mov_b64 exec, s[60:61]
    s_movk_i32 s23, 160
    v_cmp_gt_u32 vcc, s23, v0
    s_and_b64 exec, exec, vcc
    s_cbranch_execz k1_kvskip
    v_sub_u32 v150, 7, v4
    v_and_b32 v151, 7, v5
    v_xor_b32 v150, v150, v151
    v_lshlrev_b32 v150, 4, v150
    v_lshl_add_u32 v150, v5, 9, v150
    v_add_u32 v150, 37888, v150
    s_cmp_lt_u32 s56, 12
    s_cbranch_scc1 k1_w8
    s_waitcnt vmcnt(16)
    s_branch k1_w9
k1_w8:
    s_waitcnt vmcnt(12)
k1_w9:
    v_lshlrev_b32 v56, 16, v48
    v_and_b32 v60, 0xffff0000, v48
    v_lshlrev_b32 v64, 16, v49
    v_and_b32 v68, 0xffff0000, v49
    v_lshlrev_b32 v57, 16, v50
    v_and_b32 v61, 0xffff0000, v50
    v_lshlrev_b32 v65, 16, v51
    v_and_b32 v69, 0xffff0000, v51
    v_lshlrev_b32 v58, 16, v52
    v_and_b32 v62, 0xffff0000, v52
    v_lshlrev_b32 v66, 16, v53
    v_and_b32 v70, 0xffff0000, v53
    v_lshlrev_b32 v59, 16, v54
    v_and_b32 v63, 0xffff0000, v54
    v_lshlrev_b32 v67, 16, v55
    v_and_b32 v71, 0xffff0000, v55
    v_lshlrev_b32 v72, 16, v10
    v_and_b32 v73, 0xffff0000, v10
    v_lshlrev_b32 v74, 16, v11
    v_and_b32 v75, 0xffff0000, v11
    v_lshlrev_b32 v76, 16, v12
    v_and_b32 v77, 0xffff0000, v12
    v_lshlrev_b32 v78, 16, v13
    v_and_b32 v79, 0xffff0000, v13
    v_lshlrev_b32 v80, 16, v14
    v_and_b32 v81, 0xffff0000, v14
    v_lshlrev_b32 v82, 16, v15
    v_and_b32 v83, 0xffff0000, v15
    v_lshlrev_b32 v84, 16, v16
    v_and_b32 v85, 0xffff0000, v16
    v_lshlrev_b32 v86, 16, v17
    v_and_b32 v87, 0xffff0000, v17
    v_lshlrev_b32 v88, 16, v18
    v_and_b32 v89, 0xffff0000, v18
    v_lshlrev_b32 v90, 16, v19
    v_and_b32 v91, 0xffff0000, v19
    v_lshlrev_b32 v92, 16, v20
    v_and_b32 v93, 0xffff0000, v20
    v_lshlrev_b32 v94, 16, v21
    v_and_b32 v95, 0xffff0000, v21
    v_lshlrev_b32 v96, 16, v22
    v_and_b32 v97, 0xffff0000, v22
    v_lshlrev_b32 v98, 16, v23
    v_and_b32 v99, 0xffff0000, v23
    v_lshlrev_b32 v100, 16, v24
    v_and_b32 v101, 0xffff0000, v24
    v_lshlrev_b32 v102, 16, v25
    v_and_b32 v103, 0xffff0000, v25
    v_lshlrev_b32 v104, 16, v26
    v_and_b32 v105, 0xffff0000, v26
    v_lshlrev_b32 v106, 16, v27
    v_and_b32 v107, 0xffff0000, v27
    v_lshlrev_b32 v108, 16, v28
    v_and_b32 v109, 0xffff0000, v28
    v_lshlrev_b32 v110, 16, v29
    v_and_b32 v111, 0xffff0000, v29
    v_lshlrev_b32 v112, 16, v30
    v_and_b32 v113, 0xffff0000, v30
    v_lshlrev_b32 v114, 16, v31
    v_and_b32 v115, 0xffff0000, v31
    v_pk_mul_f32 v[116:117], v[72:73], v[68:69]
    v_pk_mul_f32 v[120:121], v[76:77], v[68:69]
    v_pk_mul_f32 v[124:125], v[80:81], v[68:69]
    v_pk_mul_f32 v[128:129], v[84:85], v[68:69]
    v_pk_mul_f32 v[132:133], v[88:89], v[68:69]
    v_pk_mul_f32 v[136:137], v[92:93], v[68:69]
    v_pk_mul_f32 v[140:141], v[96:97], v[68:69]
    v_pk_mul_f32 v[144:145], v[100:101], v[68:69]
    v_pk_fma_f32 v[116:117], v[76:77], v[64:65], v[116:117]
    v_pk_fma_f32 v[120:121], v[80:81], v[64:65], v[120:121]
    v_pk_fma_f32 v[124:125], v[84:85], v[64:65], v[124:125]
    v_pk_fma_f32 v[128:129], v[88:89], v[64:65], v[128:129]
    v_pk_fma_f32 v[132:133], v[92:93], v[64:65], v[132:133]
    v_pk_fma_f32 v[136:137], v[96:97], v[64:65], v[136:137]
    v_pk_fma_f32 v[140:141], v[100:101], v[64:65], v[140:141]
    v_pk_fma_f32 v[144:145], v[104:105], v[64:65], v[144:145]
    v_pk_fma_f32 v[116:117], v[80:81], v[60:61], v[116:117]
    v_pk_fma_f32 v[120:121], v[84:85], v[60:61], v[120:121]
    v_pk_fma_f32 v[124:125], v[88:89], v[60:61], v[124:125]
    v_pk_fma_f32 v[128:129], v[92:93], v[60:61], v[128:129]
    v_pk_fma_f32 v[132:133], v[96:97], v[60:61], v[132:133]
    v_pk_fma_f32 v[136:137], v[100:101], v[60:61], v[136:137]
    v_pk_fma_f32 v[140:141], v[104:105], v[60:61], v[140:141]
    v_pk_fma_f32 v[144:145], v[108:109], v[60:61], v[144:145]
    v_pk_fma_f32 v[116:117], v[84:85], v[56:57], v[116:117]
    v_pk_fma_f32 v[120:121], v[88:89], v[56:57], v[120:121]
    v_pk_fma_f32 v[124:125], v[92:93], v[56:57], v[124:125]
    v_pk_fma_f32 v[128:129], v[96:97], v[56:57], v[128:129]
    v_pk_fma_f32 v[132:133], v[100:101], v[56:57], v[132:133]
    v_pk_fma_f32 v[136:137], v[104:105], v[56:57], v[136:137]
    v_pk_fma_f32 v[140:141], v[108:109], v[56:57], v[140:141]
    v_pk_fma_f32 v[144:145], v[112:113], v[56:57], v[144:145]
    v_pk_mul_f32 v[118:119], v[74:75], v[70:71]
    v_pk_mul_f32 v[122:123], v[78:79], v[70:71]
    v_pk_mul_f32 v[126:127], v[82:83], v[70:71]
    v_pk_mul_f32 v[130:131], v[86:87], v[70:71]
    v_pk_mul_f32 v[134:135], v[90:91], v[70:71]
    v_pk_mul_f32 v[138:139], v[94:95], v[70:71]
    v_pk_mul_f32 v[142:143], v[98:99], v[70:71]
    v_pk_mul_f32 v[146:147], v[102:103], v[70:71]
    v_pk_fma_f32 v[118:119], v[78:79], v[66:67], v[118:119]
    v_pk_fma_f32 v[122:123], v[82:83], v[66:67], v[122:123]
    v_pk_fma_f32 v[126:127], v[86:87], v[66:67], v[126:127]
    v_pk_fma_f32 v[130:131], v[90:91], v[66:67], v[130:131]
    v_pk_fma_f32 v[134:135], v[94:95], v[66:67], v[134:135]
    v_pk_fma_f32 v[138:139], v[98:99], v[66:67], v[138:139]
    v_pk_fma_f32 v[142:143], v[102:103], v[66:67], v[142:143]
    v_pk_fma_f32 v[146:147], v[106:107], v[66:67], v[146:147]
    v_pk_fma_f32 v[118:119], v[82:83], v[62:63], v[118:119]
    v_pk_fma_f32 v[122:123], v[86:87], v[62:63], v[122:123]
    v_pk_fma_f32 v[126:127], v[90:91], v[62:63], v[126:127]
    v_pk_fma_f32 v[130:131], v[94:95], v[62:63], v[130:131]
    v_pk_fma_f32 v[134:135], v[98:99], v[62:63], v[134:135]
    v_pk_fma_f32 v[138:139], v[102:103], v[62:63], v[138:139]
    v_pk_fma_f32 v[142:143], v[106:107], v[62:63], v[142:143]
    v_pk_fma_f32 v[146:147], v[110:111], v[62:63], v[146:147]
    v_pk_fma_f32 v[118:119], v[86:87], v[58:59], v[118:119]
    v_pk_fma_f32 v[122:123], v[90:91], v[58:59], v[122:123]
    v_pk_fma_f32 v[126:127], v[94:95], v[58:59], v[126:127]
    v_pk_fma_f32 v[130:131], v[98:99], v[58:59], v[130:131]
    v_pk_fma_f32 v[134:135], v[102:103], v[58:59], v[134:135]
    v_pk_fma_f32 v[138:139], v[106:107], v[58:59], v[138:139]
    v_pk_fma_f32 v[142:143], v[110:111], v[58:59], v[142:143]
    v_pk_fma_f32 v[146:147], v[114:115], v[58:59], v[146:147]
    v_cvt_pk_bf16_f32 v154, v116, v117
    v_lshlrev_b32 v116, 16, v154
    v_and_b32 v117, 0xffff0000, v154
    v_cvt_pk_bf16_f32 v155, v118, v119
    v_lshlrev_b32 v118, 16, v155
    v_and_b32 v119, 0xffff0000, v155
    v_cvt_pk_bf16_f32 v156, v120, v121
    v_lshlrev_b32 v120, 16, v156
    v_and_b32 v121, 0xffff0000, v156
    v_cvt_pk_bf16_f32 v157, v122, v123
    v_lshlrev_b32 v122, 16, v157
    v_and_b32 v123, 0xffff0000, v157
    v_cvt_pk_bf16_f32 v158, v124, v125
    v_lshlrev_b32 v124, 16, v158
    v_and_b32 v125, 0xffff0000, v158
    v_cvt_pk_bf16_f32 v159, v126, v127
    v_lshlrev_b32 v126, 16, v159
    v_and_b32 v127, 0xffff0000, v159
    v_cvt_pk_bf16_f32 v160, v128, v129
    v_lshlrev_b32 v128, 16, v160
    v_and_b32 v129, 0xffff0000, v160
    v_cvt_pk_bf16_f32 v161, v130, v131
    v_lshlrev_b32 v130, 16, v161
    v_and_b32 v131, 0xffff0000, v161
    v_cvt_pk_bf16_f32 v154, v132, v133
    v_lshlrev_b32 v132, 16, v154
    v_and_b32 v133, 0xffff0000, v154
    v_cvt_pk_bf16_f32 v155, v134, v135
    v_lshlrev_b32 v134, 16, v155
    v_and_b32 v135, 0xffff0000, v155
    v_cvt_pk_bf16_f32 v156, v136, v137
    v_lshlrev_b32 v136, 16, v156
    v_and_b32 v137, 0xffff0000, v156
    v_cvt_pk_bf16_f32 v157, v138, v139
    v_lshlrev_b32 v138, 16, v157
    v_and_b32 v139, 0xffff0000, v157
    v_cvt_pk_bf16_f32 v158, v140, v141
    v_lshlrev_b32 v140, 16, v158
    v_and_b32 v141, 0xffff0000, v158
    v_cvt_pk_bf16_f32 v159, v142, v143
    v_lshlrev_b32 v142, 16, v159
    v_and_b32 v143, 0xffff0000, v159
    v_cvt_pk_bf16_f32 v160, v144, v145
    v_lshlrev_b32 v144, 16, v160
    v_and_b32 v145, 0xffff0000, v160
    v_cvt_pk_bf16_f32 v161, v146, v147
    v_lshlrev_b32 v146, 16, v161
    v_and_b32 v147, 0xffff0000, v161
    s_cmp_lt_u32 s56, 12
    s_cbranch_scc1 k1_w0
    s_waitcnt vmcnt(8)
    s_branch k1_w1
k1_w0:
    s_waitcnt vmcnt(4)
k1_w1:
    v_lshlrev_b32 v72, 16, v32
    v_and_b32 v73, 0xffff0000, v32
    v_lshlrev_b32 v74, 16, v33
    v_and_b32 v75, 0xffff0000, v33
    v_lshlrev_b32 v76, 16, v34
    v_and_b32 v77, 0xffff0000, v34
    v_lshlrev_b32 v78, 16, v35
    v_and_b32 v79, 0xffff0000, v35
    v_lshlrev_b32 v80, 16, v36
    v_and_b32 v81, 0xffff0000, v36
    v_lshlrev_b32 v82, 16, v37
    v_and_b32 v83, 0xffff0000, v37
    v_lshlrev_b32 v84, 16, v38
    v_and_b32 v85, 0xffff0000, v38
    v_lshlrev_b32 v86, 16, v39
    v_and_b32 v87, 0xffff0000, v39
    v_lshlrev_b32 v88, 16, v40
    v_and_b32 v89, 0xffff0000, v40
    v_lshlrev_b32 v90, 16, v41
    v_and_b32 v91, 0xffff0000, v41
    v_lshlrev_b32 v92, 16, v42
    v_and_b32 v93, 0xffff0000, v42
    v_lshlrev_b32 v94, 16, v43
    v_and_b32 v95, 0xffff0000, v43
    v_lshlrev_b32 v96, 16, v44
    v_and_b32 v97, 0xffff0000, v44
    v_lshlrev_b32 v98, 16, v45
    v_and_b32 v99, 0xffff0000, v45
    v_lshlrev_b32 v100, 16, v46
    v_and_b32 v101, 0xffff0000, v46
    v_lshlrev_b32 v102, 16, v47
    v_and_b32 v103, 0xffff0000, v47
    v_pk_mul_f32 v[116:117], v[116:117], v[72:73]
    v_pk_mul_f32 v[118:119], v[118:119], v[74:75]
    v_pk_mul_f32 v[120:121], v[120:121], v[76:77]
    v_pk_mul_f32 v[122:123], v[122:123], v[78:79]
    v_pk_mul_f32 v[124:125], v[124:125], v[80:81]
    v_pk_mul_f32 v[126:127], v[126:127], v[82:83]
    v_pk_mul_f32 v[128:129], v[128:129], v[84:85]
    v_pk_mul_f32 v[130:131], v[130:131], v[86:87]
    v_pk_mul_f32 v[132:133], v[132:133], v[88:89]
    v_pk_mul_f32 v[134:135], v[134:135], v[90:91]
    v_pk_mul_f32 v[136:137], v[136:137], v[92:93]
    v_pk_mul_f32 v[138:139], v[138:139], v[94:95]
    v_pk_mul_f32 v[140:141], v[140:141], v[96:97]
    v_pk_mul_f32 v[142:143], v[142:143], v[98:99]
    v_pk_mul_f32 v[144:145], v[144:145], v[100:101]
    v_pk_mul_f32 v[146:147], v[146:147], v[102:103]
    v_cvt_pk_bf16_f32 v10, v144, v140
    v_cvt_pk_bf16_f32 v11, v136, v132
    v_cvt_pk_bf16_f32 v12, v128, v124
    v_cvt_pk_bf16_f32 v13, v120, v116
    v_cvt_pk_bf16_f32 v14, v145, v141
    v_cvt_pk_bf16_f32 v15, v137, v133
    v_cvt_pk_bf16_f32 v16, v129, v125
    v_cvt_pk_bf16_f32 v17, v121, v117
    v_cvt_pk_bf16_f32 v18, v146, v142
    v_cvt_pk_bf16_f32 v19, v138, v134
    v_cvt_pk_bf16_f32 v20, v130, v126
    v_cvt_pk_bf16_f32 v21, v122, v118
    v_cvt_pk_bf16_f32 v22, v147, v143
    v_cvt_pk_bf16_f32 v23, v139, v135
    v_cvt_pk_bf16_f32 v24, v131, v127
    v_cvt_pk_bf16_f32 v25, v123, v119
    ds_write_b128 v150, v[10:13] offset:0
    ds_write_b128 v150, v[14:17] offset:128
    ds_write_b128 v150, v[18:21] offset:256
    ds_write_b128 v150, v[22:25] offset:384
k1_kvskip:
    s_mov_b64 exec, -1
    v_lshrrev_b32 v151, 3, v0
    v_and_b32 v152, 7, v0
    v_lshrrev_b32 v153, 2, v151
    v_and_b32 v153, 7, v153
    v_xor_b32 v153, v153, v152
    v_lshlrev_b32 v153, 4, v153
    v_lshl_add_u32 v153, v151, 7, v153
    v_add_u32 v153, 37888, v153
    v_mul_u32_u24 v151, 4224, v151
    v_lshl_add_u32 v154, v152, 4, v151
    s_mul_i32 s36, s55, 337920
    s_add_u32 s36, s36, 0
    s_lshl_b32 s37, s56, 7
    s_sub_u32 s38, 3968, s37
    s_add_u32 s38, s38, s36
    s_waitcnt lgkmcnt(0)
    s_barrier
    ds_read_b128 v[32:35], v153 offset:0
    ds_read_b128 v[36:39], v153 offset:4096
    ds_read_b128 v[40:43], v153 offset:8192
    s_waitcnt lgkmcnt(2)
    buffer_store_dwordx4 v[32:35], v154, s[28:31], s38 offen sc1
    s_add_u32 s38, s38, 135168
    s_waitcnt lgkmcnt(1)
    buffer_store_dwordx4 v[36:39], v154, s[28:31], s38 offen sc1
    s_add_u32 s38, s38, 135168
    s_movk_i32 s23, 128
    v_cmp_gt_u32 vcc, s23, v0
    s_and_saveexec_b64 s[60:61], vcc
    s_cbranch_execz k1_st2skip
    s_waitcnt lgkmcnt(0)
    buffer_store_dwordx4 v[40:43], v154, s[28:31], s38 offen sc1
    s_add_u32 s38, s38, 135168
k1_st2skip:
    s_mov_b64 exec, -1
    s_cmp_lg_u32 s56, 0
    s_cbranch_scc1 k1_kernel_L2
    v_mov_b32 v44, 0
    v_mov_b32 v45, 0
    v_mov_b32 v46, 0
    v_mov_b32 v47, 0
    s_add_u32 s36, s36, 4096
    buffer_store_dwordx4 v[44:47], v154, s[28:31], s36 offen sc1
    s_add_u32 s36, s36, 135168
    buffer_store_dwordx4 v[44:47], v154, s[28:31], s36 offen sc1
    s_add_u32 s36, s36, 135168
    s_movk_i32 s23, 128
    v_cmp_gt_u32 vcc, s23, v0
    s_and_b64 exec, exec, vcc
    s_cbranch_execz k1_kernel_L2
    buffer_store_dwordx4 v[44:47], v154, s[28:31], s36 offen sc1
    s_add_u32 s36, s36, 135168
k1_kernel_L2:
    s_mov_b64 exec, -1
    s_waitcnt vmcnt(0)
    v_add_u32 v251, 1, v251
    s_barrier
    s_cmp_lg_u32 s20, 0
    s_cbranch_scc1 k1_kernel_kf3
    s_lshl_b32 s23, s56, 2
    s_add_u32 s23, s23, s57
    s_mov_b64 exec, 1
    buffer_store_dword v251, v250, s[28:31], s23 offen offset:256
    buffer_store_dword v251, v250, s[28:31], s23 offen offset:128 sc1
    s_mov_b64 exec, -1
k1_kernel_kf3:
    s_lshl_b32 s54, s56, 3
    s_add_u32 s54, s54, s55
    s_cmp_lt_u32 s56, 12
    s_cbranch_scc1 k1_side2
    s_mov_b32 s2, s58
    s_setprio 3
    s_lshl_b32 s21, s2, 2
    s_add_u32 s21, s21, s20
    s_mul_i32 s34, s20, 9472
    v_lshlrev_b32 v3, 4, v1
    s_mul_i32 s37, s21, 4224
    s_add_u32 s37, s37, 0
    v_lshrrev_b32 v4, 3, v0
    v_mul_u32_u24 v4, 20480, v4
    s_lshr_b32 s38, s2, 1
    s_and_b32 s38, s38, 7
    v_and_b32 v5, 7, v0
    v_xor_b32 v5, s38, v5
    v_lshl_add_u32 v4, v5, 4, v4
    s_lshl_b32 s38, s2, 7
    v_add_u32 v20, 0, v1
    v_mul_u32_u24 v21, 3856, v20
    v_lshrrev_b32 v21, 16, v21
    v_mul_u32_u24 v22, 17, v21
    v_sub_u32 v22, v20, v22
    v_lshlrev_b32 v22, 4, v22
    v_lshlrev_b32 v21, 8, v21
    v_sub_u32 v22, v22, v21
    v_add_u32 v23, 3840, v22
    v_add_u32 v20, 64, v1
    v_mul_u32_u24 v21, 3856, v20
    v_lshrrev_b32 v21, 16, v21
    v_mul_u32_u24 v22, 17, v21
    v_sub_u32 v22, v20, v22
    v_lshlrev_b32 v22, 4, v22
    v_lshlrev_b32 v21, 8, v21
    v_sub_u32 v22, v22, v21
    v_add_u32 v24, 3840, v22
    v_add_u32 v20, 128, v1
    v_mul_u32_u24 v21, 3856, v20
    v_lshrrev_b32 v21, 16, v21
    v_mul_u32_u24 v22, 17, v21
    v_sub_u32 v22, v20, v22
    v_lshlrev_b32 v22, 4, v22
    v_lshlrev_b32 v21, 8, v21
    v_sub_u32 v22, v22, v21
    v_add_u32 v25, 3840, v22
    v_add_u32 v20, 192, v1
    v_mul_u32_u24 v21, 3856, v20
    v_lshrrev_b32 v21, 16, v21
    v_mul_u32_u24 v22, 17, v21
    v_sub_u32 v22, v20, v22
    v_lshlrev_b32 v22, 4, v22
    v_lshlrev_b32 v21, 8, v21
    v_sub_u32 v22, v22, v21
    v_add_u32 v26, 3840, v22
    v_add_u32 v20, 256, v1
    v_mul_u32_u24 v21, 3856, v20
    v_lshrrev_b32 v21, 16, v21
    v_mul_u32_u24 v22, 17, v21
    v_sub_u32 v22, v20, v22
    v_lshlrev_b32 v22, 4, v22
    v_lshlrev_b32 v21, 8, v21
    v_sub_u32 v22, v22, v21
    v_add_u32 v27, 3840, v22
    v_lshl_add_u32 v5, v1, 2, s34
    v_mov_b32 v6, 0
    ds_write_b32 v5, v6
    v_and_b32 v7, 15, v1
    v_bfe_u32 v8, v1, 4, 1
    v_lshrrev_b32 v9, 5, v1
    v_mul_u32_u24 v10, 272, v7
    v_lshl_add_u32 v10, v9, 4, v10
    v_add_u32 v10, s34, v10
    v_add_u32 v10, 4356, v10
    v_lshlrev_b32 v11, 2, v8
    v_sub_u32 v10, v10, v11
    v_and_b32 v12, 7, v1
    v_mul_u32_u24 v13, 272, v12
    v_lshl_add_u32 v13, v9, 4, v13
    v_add_u32 v13, s34, v13
    v_add_u32 v13, 4356, v13
    v_sub_u32 v13, v13, v11
    v_bfe_u32 v11, v1, 3, 1
    v_lshlrev_b32 v11, 4, v11
    v_sub_u32 v11, 16, v11
    v_and_b32 v14, 31, v1
    v_lshlrev_b32 v14, 3, v14
    v_lshl_add_u32 v14, v9, 4, v14
    v_add_u32 v14, s34, v14
    v_add_u32 v14, 8, v14
    v_cmp_ne_u32 vcc, 0, v12
    v_mov_b32 v16, 0
    s_nop 1
    v_cndmask_b32 v15, v16, -1, vcc
    s_waitcnt lgkmcnt(0)
    ds_read_b64 v[176:177], v14 offset:1792
    ds_read_b64 v[178:179], v14 offset:1800
    ds_read_b64 v[180:181], v14 offset:1824
    ds_read_b64 v[182:183], v14 offset:1832
    ds_read_b64 v[184:185], v14 offset:1856
    ds_read_b64 v[186:187], v14 offset:1864
    ds_read_b64 v[188:189], v14 offset:1888
    ds_read_b64 v[190:191], v14 offset:1896
    ds_read_b64 v[192:193], v14 offset:1920
    ds_read_b64 v[194:195], v14 offset:1928
    ds_read_b64 v[196:197], v14 offset:1952
    ds_read_b64 v[198:199], v14 offset:1960
    ds_read_b64 v[200:201], v14 offset:1984
    ds_read_b64 v[202:203], v14 offset:1992
    ds_read_b64 v[204:205], v14 offset:2016
    ds_read_b64 v[206:207], v14 offset:2024
    s_cmp_lg_u32 s20, 0
    s_cbranch_scc1 k1_kernel_kw4
    v_and_b32 v40, 31, v1
    v_lshlrev_b32 v40, 2, v40
    s_mov_b32 s23, 200000
    s_mov_b64 s[60:61], 0
k1_kernel_kp5:
    buffer_load_dword v41, v40, s[28:31], s57 offen offset:256 sc1
    s_waitcnt vmcnt(0)
    v_cmp_eq_u32 vcc, v251, v41
    s_sub_u32 s23, s23, 1
    s_or_b64 s[60:61], s[60:61], vcc
    s_cmp_eq_u64 s[60:61], -1
    s_cbranch_scc1 k1_kernel_kd6
    s_and_b32 s21, s23, 3
    s_cmp_lg_u32 s21, 0
    s_cbranch_scc1 k1_kernel_kq8
    buffer_load_dword v41, v40, s[28:31], s57 offen offset:128 sc1
    s_waitcnt vmcnt(0)
    v_cmp_eq_u32 vcc, v251, v41
    s_nop 1
    s_or_b64 s[60:61], s[60:61], vcc
    s_cmp_eq_u64 s[60:61], -1
    s_cbranch_scc1 k1_kernel_kd6
k1_kernel_kq8:
    s_sleep 2
    s_cmp_lg_u32 s23, 0
    s_cbranch_scc1 k1_kernel_kp5
k1_kernel_kd6:
    s_cmp_lg_u32 s56, 12
    s_cbranch_scc1 k1_kernel_kw4
    s_mov_b64 exec, 1
    buffer_store_dword v251, v250, s[28:31], s57 offen sc1
    s_mov_b64 exec, -1
k1_kernel_kw4:
    s_barrier
    s_add_u32 s36, s34, 4352
    s_mov_b32 m0, s36
    s_nop 0
    buffer_load_dwordx4 v23, s[28:31], s37 offen sc1 lds
    s_add_u32 s36, s34, 5376
    s_mov_b32 m0, s36
    s_nop 0
    buffer_load_dwordx4 v24, s[28:31], s37 offen sc1 lds
    s_add_u32 s36, s34, 6400
    s_mov_b32 m0, s36
    s_nop 0
    buffer_load_dwordx4 v25, s[28:31], s37 offen sc1 lds
    s_add_u32 s36, s34, 7424
    s_mov_b32 m0, s36
    s_nop 0
    buffer_load_dwordx4 v26, s[28:31], s37 offen sc1 lds
    s_add_u32 s36, s34, 8448
    s_mov_b32 m0, s36
    s_mov_b64 exec, 0xffff
    buffer_load_dwordx4 v27, s[28:31], s37 offen sc1 lds
    s_mov_b64 exec, -1
    s_waitcnt vmcnt(0) lgkmcnt(0)
    ds_read2_b32 v[64:65], v10 offset0:0 offset1:1
    ds_read2_b32 v[66:67], v10 offset0:2 offset1:3
    ds_read2_b32 v[68:69], v10 offset0:8 offset1:9
    ds_read2_b32 v[70:71], v10 offset0:10 offset1:11
    ds_read2_b32 v[72:73], v10 offset0:16 offset1:17
    ds_read2_b32 v[74:75], v10 offset0:18 offset1:19
    ds_read2_b32 v[76:77], v10 offset0:24 offset1:25
    ds_read2_b32 v[78:79], v10 offset0:26 offset1:27
    ds_read2_b32 v[80:81], v10 offset0:32 offset1:33
    ds_read2_b32 v[82:83], v10 offset0:34 offset1:35
    ds_read2_b32 v[84:85], v10 offset0:40 offset1:41
    ds_read2_b32 v[86:87], v10 offset0:42 offset1:43
    ds_read2_b32 v[88:89], v10 offset0:48 offset1:49
    ds_read2_b32 v[90:91], v10 offset0:50 offset1:51
    ds_read2_b32 v[92:93], v10 offset0:56 offset1:57
    ds_read2_b32 v[94:95], v10 offset0:58 offset1:59
    s_waitcnt lgkmcnt(0)
    v_mfma_f32_32x32x16_bf16 v[144:159], v[176:179], v[64:67], 0
    ds_read_b32 v16, v10 offset:16
    ds_read_b32 v17, v10 offset:48
    ds_read_b32 v18, v10 offset:80
    ds_read_b32 v19, v10 offset:112
    ds_read_b32 v20, v10 offset:144
    ds_read_b32 v21, v10 offset:176
    ds_read_b32 v22, v10 offset:208
    ds_read_b32 v23, v10 offset:240
    ds_read2_b32 v[96:97], v13 offset0:0 offset1:1
    ds_read2_b32 v[98:99], v13 offset0:2 offset1:3
    ds_read_b32 v24, v13 offset:16
    ds_read2_b32 v[100:101], v13 offset0:8 offset1:9
    ds_read2_b32 v[102:103], v13 offset0:10 offset1:11
    ds_read_b32 v25, v13 offset:48
    ds_read2_b32 v[104:105], v13 offset0:16 offset1:17
    ds_read2_b32 v[106:107], v13 offset0:18 offset1:19
    v_mfma_f32_32x32x16_bf16 v[144:159], v[180:183], v[68:71], v[144:159]
    ds_read_b32 v26, v13 offset:80
    ds_read2_b32 v[108:109], v13 offset0:24 offset1:25
    ds_read2_b32 v[110:111], v13 offset0:26 offset1:27
    ds_read_b32 v27, v13 offset:112
    ds_read2_b32 v[112:113], v13 offset0:32 offset1:33
    ds_read2_b32 v[114:115], v13 offset0:34 offset1:35
    ds_read_b32 v28, v13 offset:144
    ds_read2_b32 v[116:117], v13 offset0:40 offset1:41
    ds_read2_b32 v[118:119], v13 offset0:42 offset1:43
    ds_read_b32 v29, v13 offset:176
    ds_read2_b32 v[120:121], v13 offset0:48 offset1:49
    ds_read2_b32 v[122:123], v13 offset0:50 offset1:51
    ds_read_b32 v30, v13 offset:208
    ds_read2_b32 v[124:125], v13 offset0:56 offset1:57
    ds_read2_b32 v[126:127], v13 offset0:58 offset1:59
    ds_read_b32 v31, v13 offset:240
    v_mfma_f32_32x32x16_bf16 v[144:159], v[184:187], v[72:75], v[144:159]
    s_waitcnt lgkmcnt(15)
    s_waitcnt lgkmcnt(0)
    v_alignbit_b32 v32, v65, v64, 16
    v_alignbit_b32 v33, v66, v65, 16
    v_alignbit_b32 v34, v67, v66, 16
    v_alignbit_b32 v35, v16, v67, 16
    v_mfma_f32_32x32x16_bf16 v[144:159], v[188:191], v[76:79], v[144:159]
    v_alignbit_b32 v36, v69, v68, 16
    v_alignbit_b32 v37, v70, v69, 16
    v_alignbit_b32 v38, v71, v70, 16
    v_alignbit_b32 v39, v17, v71, 16
    v_alignbit_b32 v40, v73, v72, 16
    v_alignbit_b32 v41, v74, v73, 16
    v_mfma_f32_32x32x16_bf16 v[144:159], v[192:195], v[80:83], v[144:159]
    v_alignbit_b32 v42, v75, v74, 16
    v_alignbit_b32 v43, v18, v75, 16
    v_alignbit_b32 v44, v77, v76, 16
    v_alignbit_b32 v45, v78, v77, 16
    v_alignbit_b32 v46, v79, v78, 16
    v_alignbit_b32 v47, v19, v79, 16
    v_mfma_f32_32x32x16_bf16 v[144:159], v[196:199], v[84:87], v[144:159]
    v_alignbit_b32 v48, v81, v80, 16
    v_alignbit_b32 v49, v82, v81, 16
    v_alignbit_b32 v50, v83, v82, 16
    v_alignbit_b32 v51, v20, v83, 16
    v_alignbit_b32 v52, v85, v84, 16
    v_alignbit_b32 v53, v86, v85, 16
    v_mfma_f32_32x32x16_bf16 v[144:159], v[200:203], v[88:91], v[144:159]
    v_alignbit_b32 v54, v87, v86, 16
    v_alignbit_b32 v55, v21, v87, 16
    v_alignbit_b32 v56, v89, v88, 16
    v_alignbit_b32 v57, v90, v89, 16
    v_alignbit_b32 v58, v91, v90, 16
    v_alignbit_b32 v59, v22, v91, 16
    v_mfma_f32_32x32x16_bf16 v[144:159], v[204:207], v[92:95], v[144:159]
    v_alignbit_b32 v60, v93, v92, 16
    v_alignbit_b32 v61, v94, v93, 16
    v_alignbit_b32 v62, v95, v94, 16
    v_alignbit_b32 v63, v23, v95, 16
    s_nop 0
    v_mfma_f32_32x32x16_bf16 v[128:143], v[176:179], v[32:35], 0
    ds_read_b64 v[208:209], v14 offset:3840
    ds_read_b64 v[210:211], v14 offset:3848
    s_nop 2
    v_mfma_f32_32x32x16_bf16 v[128:143], v[180:183], v[36:39], v[128:143]
    ds_read_b64 v[212:213], v14 offset:3872
    ds_read_b64 v[214:215], v14 offset:3880
    s_nop 2
    v_mfma_f32_32x32x16_bf16 v[128:143], v[184:187], v[40:43], v[128:143]
    ds_read_b64 v[216:217], v14 offset:3904
    ds_read_b64 v[218:219], v14 offset:3912
    v_alignbit_b32 v96, v97, v96, v11
    v_alignbit_b32 v97, v98, v97, v11
    v_alignbit_b32 v98, v99, v98, v11
    v_alignbit_b32 v99, v24, v99, v11
    v_alignbit_b32 v100, v101, v100, v11
    v_alignbit_b32 v101, v102, v101, v11
    v_alignbit_b32 v102, v103, v102, v11
    v_alignbit_b32 v103, v25, v103, v11
    v_alignbit_b32 v104, v105, v104, v11
    v_mfma_f32_32x32x16_bf16 v[128:143], v[188:191], v[44:47], v[128:143]
    ds_read_b64 v[220:221], v14 offset:3936
    ds_read_b64 v[222:223], v14 offset:3944
    v_alignbit_b32 v105, v106, v105, v11
    v_alignbit_b32 v106, v107, v106, v11
    v_alignbit_b32 v107, v26, v107, v11
    v_alignbit_b32 v108, v109, v108, v11
    v_alignbit_b32 v109, v110, v109, v11
    v_alignbit_b32 v110, v111, v110, v11
    v_alignbit_b32 v111, v27, v111, v11
    v_mov_b32_dpp v144, v144 row_shr:1 row_mask:0xf bank_mask:0xf bound_ctrl:0
    v_mfma_f32_32x32x16_bf16 v[128:143], v[192:195], v[48:51], v[128:143]
    ds_read_b64 v[224:225], v14 offset:3968
    ds_read_b64 v[226:227], v14 offset:3976
    v_mov_b32_dpp v145, v145 row_shr:1 row_mask:0xf bank_mask:0xf bound_ctrl:0
    v_mov_b32_dpp v146, v146 row_shr:1 row_mask:0xf bank_mask:0xf bound_ctrl:0
    v_mov_b32_dpp v147, v147 row_shr:1 row_mask:0xf bank_mask:0xf bound_ctrl:0
    v_mov_b32_dpp v148, v148 row_shr:1 row_mask:0xf bank_mask:0xf bound_ctrl:0
    v_mov_b32_dpp v149, v149 row_shr:1 row_mask:0xf bank_mask:0xf bound_ctrl:0
    v_mov_b32_dpp v150, v150 row_shr:1 row_mask:0xf bank_mask:0xf bound_ctrl:0
    v_mov_b32_dpp v151, v151 row_shr:1 row_mask:0xf bank_mask:0xf bound_ctrl:0
    v_mov_b32_dpp v152, v152 row_shr:1 row_mask:0xf bank_mask:0xf bound_ctrl:0
    v_mfma_f32_32x32x16_bf16 v[128:143], v[196:199], v[52:55], v[128:143]
    ds_read_b64 v[228:229], v14 offset:4000
    ds_read_b64 v[230:231], v14 offset:4008
    v_mov_b32_dpp v153, v153 row_shr:1 row_mask:0xf bank_mask:0xf bound_ctrl:0
    v_mov_b32_dpp v154, v154 row_shr:1 row_mask:0xf bank_mask:0xf bound_ctrl:0
    v_mov_b32_dpp v155, v155 row_shr:1 row_mask:0xf bank_mask:0xf bound_ctrl:0
    v_mov_b32_dpp v156, v156 row_shr:1 row_mask:0xf bank_mask:0xf bound_ctrl:0
    v_mov_b32_dpp v157, v157 row_shr:1 row_mask:0xf bank_mask:0xf bound_ctrl:0
    v_mov_b32_dpp v158, v158 row_shr:1 row_mask:0xf bank_mask:0xf bound_ctrl:0
    v_mov_b32_dpp v159, v159 row_shr:1 row_mask:0xf bank_mask:0xf bound_ctrl:0
    v_alignbit_b32 v112, v113, v112, v11
    v_mfma_f32_32x32x16_bf16 v[128:143], v[200:203], v[56:59], v[128:143]
    ds_read_b64 v[232:233], v14 offset:4032
    ds_read_b64 v[234:235], v14 offset:4040
    v_alignbit_b32 v113, v114, v113, v11
    v_alignbit_b32 v114, v115, v114, v11
    v_alignbit_b32 v115, v28, v115, v11
    v_alignbit_b32 v116, v117, v116, v11
    v_alignbit_b32 v117, v118, v117, v11
    v_alignbit_b32 v118, v119, v118, v11
    v_alignbit_b32 v119, v29, v119, v11
    v_alignbit_b32 v120, v121, v120, v11
    v_mfma_f32_32x32x16_bf16 v[128:143], v[204:207], v[60:63], v[128:143]
    ds_read_b64 v[236:237], v14 offset:4064
    ds_read_b64 v[238:239], v14 offset:4072
    v_alignbit_b32 v121, v122, v121, v11
    v_alignbit_b32 v122, v123, v122, v11
    v_alignbit_b32 v123, v30, v123, v11
    v_alignbit_b32 v124, v125, v124, v11
    v_alignbit_b32 v125, v126, v125, v11
    v_alignbit_b32 v126, v127, v126, v11
    v_alignbit_b32 v127, v31, v127, v11
    s_nop 0
    s_waitcnt lgkmcnt(0)
    v_mfma_f32_32x32x16_bf16 v[160:175], v[208:211], v[96:99], 0
    ds_read_b64 v[176:177], v14 offset:1536
    ds_read_b64 v[178:179], v14 offset:1544
    ds_read_b64 v[180:181], v14 offset:1568
    ds_read_b64 v[182:183], v14 offset:1576
    s_nop 0
    v_mfma_f32_32x32x16_bf16 v[160:175], v[212:215], v[100:103], v[160:175]
    ds_read_b64 v[184:185], v14 offset:1600
    ds_read_b64 v[186:187], v14 offset:1608
    ds_read_b64 v[188:189], v14 offset:1632
    s_nop 1
    v_mfma_f32_32x32x16_bf16 v[160:175], v[216:219], v[104:107], v[160:175]
    ds_read_b64 v[190:191], v14 offset:1640
    ds_read_b64 v[192:193], v14 offset:1664
    ds_read_b64 v[194:195], v14 offset:1672
    v_mov_b32_dpp v128, v128 row_shr:1 row_mask:0xf bank_mask:0xf bound_ctrl:0
    v_mov_b32_dpp v129, v129 row_shr:1 row_mask:0xf bank_mask:0xf bound_ctrl:0
    v_mov_b32_dpp v130, v130 row_shr:1 row_mask:0xf bank_mask:0xf bound_ctrl:0
    v_mfma_f32_32x32x16_bf16 v[160:175], v[220:223], v[108:111], v[160:175]
    ds_read_b64 v[196:197], v14 offset:1696
    ds_read_b64 v[198:199], v14 offset:1704
    ds_read_b64 v[200:201], v14 offset:1728
    v_mov_b32_dpp v131, v131 row_shr:1 row_mask:0xf bank_mask:0xf bound_ctrl:0
    v_mov_b32_dpp v132, v132 row_shr:1 row_mask:0xf bank_mask:0xf bound_ctrl:0
    v_mov_b32_dpp v133, v133 row_shr:1 row_mask:0xf bank_mask:0xf bound_ctrl:0
    v_mfma_f32_32x32x16_bf16 v[160:175], v[224:227], v[112:115], v[160:175]
    ds_read_b64 v[202:203], v14 offset:1736
    ds_read_b64 v[204:205], v14 offset:1760
    ds_read_b64 v[206:207], v14 offset:1768
    v_mov_b32_dpp v134, v134 row_shr:1 row_mask:0xf bank_mask:0xf bound_ctrl:0
    v_mov_b32_dpp v135, v135 row_shr:1 row_mask:0xf bank_mask:0xf bound_ctrl:0
    v_mov_b32_dpp v136, v136 row_shr:1 row_mask:0xf bank_mask:0xf bound_ctrl:0
    v_mfma_f32_32x32x16_bf16 v[160:175], v[228:231], v[116:119], v[160:175]
    v_mov_b32_dpp v137, v137 row_shr:1 row_mask:0xf bank_mask:0xf bound_ctrl:0
    v_mov_b32_dpp v138, v138 row_shr:1 row_mask:0xf bank_mask:0xf bound_ctrl:0
    v_mov_b32_dpp v139, v139 row_shr:1 row_mask:0xf bank_mask:0xf bound_ctrl:0
    v_mfma_f32_32x32x16_bf16 v[160:175], v[232:235], v[120:123], v[160:175]
    v_mov_b32_dpp v140, v140 row_shr:1 row_mask:0xf bank_mask:0xf bound_ctrl:0
    v_mov_b32_dpp v141, v141 row_shr:1 row_mask:0xf bank_mask:0xf bound_ctrl:0
    v_mfma_f32_32x32x16_bf16 v[160:175], v[236:239], v[124:127], v[160:175]
    v_mov_b32_dpp v142, v142 row_shr:1 row_mask:0xf bank_mask:0xf bound_ctrl:0
    v_mov_b32_dpp v143, v143 row_shr:1 row_mask:0xf bank_mask:0xf bound_ctrl:0
    s_waitcnt lgkmcnt(0)
    v_mfma_f32_32x32x16_bf16 v[144:159], v[176:179], v[64:67], v[144:159]
    ds_read_b64 v[208:209], v14 offset:3584
    ds_read_b64 v[210:211], v14 offset:3592
    s_nop 2
    v_mfma_f32_32x32x16_bf16 v[144:159], v[180:183], v[68:71], v[144:159]
    ds_read_b64 v[212:213], v14 offset:3616
    ds_read_b64 v[214:215], v14 offset:3624
    s_nop 2
    v_mfma_f32_32x32x16_bf16 v[144:159], v[184:187], v[72:75], v[144:159]
    ds_read_b64 v[216:217], v14 offset:3648
    ds_read_b64 v[218:219], v14 offset:3656
    v_and_b32_dpp v160, v160, v15 row_shr:1 row_mask:0xf bank_mask:0xf bound_ctrl:0
    v_and_b32_dpp v161, v161, v15 row_shr:1 row_mask:0xf bank_mask:0xf bound_ctrl:0
    v_and_b32_dpp v162, v162, v15 row_shr:1 row_mask:0xf bank_mask:0xf bound_ctrl:0
    v_mfma_f32_32x32x16_bf16 v[144:159], v[188:191], v[76:79], v[144:159]
    ds_read_b64 v[220:221], v14 offset:3680
    ds_read_b64 v[222:223], v14 offset:3688
    v_and_b32_dpp v163, v163, v15 row_shr:1 row_mask:0xf bank_mask:0xf bound_ctrl:0
    v_and_b32_dpp v164, v164, v15 row_shr:1 row_mask:0xf bank_mask:0xf bound_ctrl:0
    v_and_b32_dpp v165, v165, v15 row_shr:1 row_mask:0xf bank_mask:0xf bound_ctrl:0
    v_mfma_f32_32x32x16_bf16 v[144:159], v[192:195], v[80:83], v[144:159]
    ds_read_b64 v[224:225], v14 offset:3712
    ds_read_b64 v[226:227], v14 offset:3720
    v_and_b32_dpp v166, v166, v15 row_shr:1 row_mask:0xf bank_mask:0xf bound_ctrl:0
    v_and_b32_dpp v167, v167, v15 row_shr:1 row_mask:0xf bank_mask:0xf bound_ctrl:0
    v_and_b32_dpp v168, v168, v15 row_shr:1 row_mask:0xf bank_mask:0xf bound_ctrl:0
    v_mfma_f32_32x32x16_bf16 v[144:159], v[196:199], v[84:87], v[144:159]
    ds_read_b64 v[228:229], v14 offset:3744
    ds_read_b64 v[230:231], v14 offset:3752
    v_and_b32_dpp v169, v169, v15 row_shr:1 row_mask:0xf bank_mask:0xf bound_ctrl:0
    v_and_b32_dpp v170, v170, v15 row_shr:1 row_mask:0xf bank_mask:0xf bound_ctrl:0
    v_and_b32_dpp v171, v171, v15 row_shr:1 row_mask:0xf bank_mask:0xf bound_ctrl:0
    v_mfma_f32_32x32x16_bf16 v[144:159], v[200:203], v[88:91], v[144:159]
    ds_read_b64 v[232:233], v14 offset:3776
    ds_read_b64 v[234:235], v14 offset:3784
    v_and_b32_dpp v172, v172, v15 row_shr:1 row_mask:0xf bank_mask:0xf bound_ctrl:0
    v_and_b32_dpp v173, v173, v15 row_shr:1 row_mask:0xf bank_mask:0xf bound_ctrl:0
    v_mfma_f32_32x32x16_bf16 v[144:159], v[204:207], v[92:95], v[144:159]
    ds_read_b64 v[236:237], v14 offset:3808
    ds_read_b64 v[238:239], v14 offset:3816
    v_and_b32_dpp v174, v174, v15 row_shr:1 row_mask:0xf bank_mask:0xf bound_ctrl:0
    v_and_b32_dpp v175, v175, v15 row_shr:1 row_mask:0xf bank_mask:0xf bound_ctrl:0
    v_mfma_f32_32x32x16_bf16 v[128:143], v[176:179], v[32:35], v[128:143]
    s_nop 4
    v_mfma_f32_32x32x16_bf16 v[128:143], v[180:183], v[36:39], v[128:143]
    s_nop 4
    v_mfma_f32_32x32x16_bf16 v[128:143], v[184:187], v[40:43], v[128:143]
    v_mov_b32_dpp v144, v144 row_shr:1 row_mask:0xf bank_mask:0xf bound_ctrl:0
    v_mov_b32_dpp v145, v145 row_shr:1 row_mask:0xf bank_mask:0xf bound_ctrl:0
    v_mov_b32_dpp v146, v146 row_shr:1 row_mask:0xf bank_mask:0xf bound_ctrl:0
    v_mfma_f32_32x32x16_bf16 v[128:143], v[188:191], v[44:47], v[128:143]
    v_mov_b32_dpp v147, v147 row_shr:1 row_mask:0xf bank_mask:0xf bound_ctrl:0
    v_mov_b32_dpp v148, v148 row_shr:1 row_mask:0xf bank_mask:0xf bound_ctrl:0
    v_mov_b32_dpp v149, v149 row_shr:1 row_mask:0xf bank_mask:0xf bound_ctrl:0
    v_mfma_f32_32x32x16_bf16 v[128:143], v[192:195], v[48:51], v[128:143]
    v_mov_b32_dpp v150, v150 row_shr:1 row_mask:0xf bank_mask:0xf bound_ctrl:0
    v_mov_b32_dpp v151, v151 row_shr:1 row_mask:0xf bank_mask:0xf bound_ctrl:0
    v_mov_b32_dpp v152, v152 row_shr:1 row_mask:0xf bank_mask:0xf bound_ctrl:0
    v_mfma_f32_32x32x16_bf16 v[128:143], v[196:199], v[52:55], v[128:143]
    v_mov_b32_dpp v153, v153 row_shr:1 row_mask:0xf bank_mask:0xf bound_ctrl:0
    v_mov_b32_dpp v154, v154 row_shr:1 row_mask:0xf bank_mask:0xf bound_ctrl:0
    v_mov_b32_dpp v155, v155 row_shr:1 row_mask:0xf bank_mask:0xf bound_ctrl:0
    v_mfma_f32_32x32x16_bf16 v[128:143], v[200:203], v[56:59], v[128:143]
    v_mov_b32_dpp v156, v156 row_shr:1 row_mask:0xf bank_mask:0xf bound_ctrl:0
    v_mov_b32_dpp v157, v157 row_shr:1 row_mask:0xf bank_mask:0xf bound_ctrl:0
    v_mfma_f32_32x32x16_bf16 v[128:143], v[204:207], v[60:63], v[128:143]
    v_mov_b32_dpp v158, v158 row_shr:1 row_mask:0xf bank_mask:0xf bound_ctrl:0
    v_mov_b32_dpp v159, v159 row_shr:1 row_mask:0xf bank_mask:0xf bound_ctrl:0
    s_waitcnt lgkmcnt(0)
    v_mfma_f32_32x32x16_bf16 v[160:175], v[208:211], v[96:99], v[160:175]
    ds_read_b64 v[176:177], v14 offset:1280
    ds_read_b64 v[178:179], v14 offset:1288
    ds_read_b64 v[180:181], v14 offset:1312
    ds_read_b64 v[182:183], v14 offset:1320
    s_nop 0
    v_mfma_f32_32x32x16_bf16 v[160:175], v[212:215], v[100:103], v[160:175]
    ds_read_b64 v[184:185], v14 offset:1344
    ds_read_b64 v[186:187], v14 offset:1352
    ds_read_b64 v[188:189], v14 offset:1376
    s_nop 1
    v_mfma_f32_32x32x16_bf16 v[160:175], v[216:219], v[104:107], v[160:175]
    ds_read_b64 v[190:191], v14 offset:1384
    ds_read_b64 v[192:193], v14 offset:1408
    ds_read_b64 v[194:195], v14 offset:1416
    v_mov_b32_dpp v128, v128 row_shr:1 row_mask:0xf bank_mask:0xf bound_ctrl:0
    v_mov_b32_dpp v129, v129 row_shr:1 row_mask:0xf bank_mask:0xf bound_ctrl:0
    v_mov_b32_dpp v130, v130 row_shr:1 row_mask:0xf bank_mask:0xf bound_ctrl:0
    v_mfma_f32_32x32x16_bf16 v[160:175], v[220:223], v[108:111], v[160:175]
    ds_read_b64 v[196:197], v14 offset:1440
    ds_read_b64 v[198:199], v14 offset:1448
    ds_read_b64 v[200:201], v14 offset:1472
    v_mov_b32_dpp v131, v131 row_shr:1 row_mask:0xf bank_mask:0xf bound_ctrl:0
    v_mov_b32_dpp v132, v132 row_shr:1 row_mask:0xf bank_mask:0xf bound_ctrl:0
    v_mov_b32_dpp v133, v133 row_shr:1 row_mask:0xf bank_mask:0xf bound_ctrl:0
    v_mfma_f32_32x32x16_bf16 v[160:175], v[224:227], v[112:115], v[160:175]
    ds_read_b64 v[202:203], v14 offset:1480
    ds_read_b64 v[204:205], v14 offset:1504
    ds_read_b64 v[206:207], v14 offset:1512
    v_mov_b32_dpp v134, v134 row_shr:1 row_mask:0xf bank_mask:0xf bound_ctrl:0
    v_mov_b32_dpp v135, v135 row_shr:1 row_mask:0xf bank_mask:0xf bound_ctrl:0
    v_mov_b32_dpp v136, v136 row_shr:1 row_mask:0xf bank_mask:0xf bound_ctrl:0
    v_mfma_f32_32x32x16_bf16 v[160:175], v[228:231], v[116:119], v[160:175]
    v_mov_b32_dpp v137, v137 row_shr:1 row_mask:0xf bank_mask:0xf bound_ctrl:0
    v_mov_b32_dpp v138, v138 row_shr:1 row_mask:0xf bank_mask:0xf bound_ctrl:0
    v_mov_b32_dpp v139, v139 row_shr:1 row_mask:0xf bank_mask:0xf bound_ctrl:0
    v_mfma_f32_32x32x16_bf16 v[160:175], v[232:235], v[120:123], v[160:175]
    v_mov_b32_dpp v140, v140 row_shr:1 row_mask:0xf bank_mask:0xf bound_ctrl:0
    v_mov_b32_dpp v141, v141 row_shr:1 row_mask:0xf bank_mask:0xf bound_ctrl:0
    v_mfma_f32_32x32x16_bf16 v[160:175], v[236:239], v[124:127], v[160:175]
    v_mov_b32_dpp v142, v142 row_shr:1 row_mask:0xf bank_mask:0xf bound_ctrl:0
    v_mov_b32_dpp v143, v143 row_shr:1 row_mask:0xf bank_mask:0xf bound_ctrl:0
    s_waitcnt lgkmcnt(0)
    v_mfma_f32_32x32x16_bf16 v[144:159], v[176:179], v[64:67], v[144:159]
    ds_read_b64 v[208:209], v14 offset:3328
    ds_read_b64 v[210:211], v14 offset:3336
    s_nop 2
    v_mfma_f32_32x32x16_bf16 v[144:159], v[180:183], v[68:71], v[144:159]
    ds_read_b64 v[212:213], v14 offset:3360
    ds_read_b64 v[214:215], v14 offset:3368
    s_nop 2
    v_mfma_f32_32x32x16_bf16 v[144:159], v[184:187], v[72:75], v[144:159]
    ds_read_b64 v[216:217], v14 offset:3392
    ds_read_b64 v[218:219], v14 offset:3400
    v_and_b32_dpp v160, v160, v15 row_shr:1 row_mask:0xf bank_mask:0xf bound_ctrl:0
    v_and_b32_dpp v161, v161, v15 row_shr:1 row_mask:0xf bank_mask:0xf bound_ctrl:0
    v_and_b32_dpp v162, v162, v15 row_shr:1 row_mask:0xf bank_mask:0xf bound_ctrl:0
    v_mfma_f32_32x32x16_bf16 v[144:159], v[188:191], v[76:79], v[144:159]
    ds_read_b64 v[220:221], v14 offset:3424
    ds_read_b64 v[222:223], v14 offset:3432
    v_and_b32_dpp v163, v163, v15 row_shr:1 row_mask:0xf bank_mask:0xf bound_ctrl:0
    v_and_b32_dpp v164, v164, v15 row_shr:1 row_mask:0xf bank_mask:0xf bound_ctrl:0
    v_and_b32_dpp v165, v165, v15 row_shr:1 row_mask:0xf bank_mask:0xf bound_ctrl:0
    v_mfma_f32_32x32x16_bf16 v[144:159], v[192:195], v[80:83], v[144:159]
    ds_read_b64 v[224:225], v14 offset:3456
    ds_read_b64 v[226:227], v14 offset:3464
    v_and_b32_dpp v166, v166, v15 row_shr:1 row_mask:0xf bank_mask:0xf bound_ctrl:0
    v_and_b32_dpp v167, v167, v15 row_shr:1 row_mask:0xf bank_mask:0xf bound_ctrl:0
    v_and_b32_dpp v168, v168, v15 row_shr:1 row_mask:0xf bank_mask:0xf bound_ctrl:0
    v_mfma_f32_32x32x16_bf16 v[144:159], v[196:199], v[84:87], v[144:159]
    ds_read_b64 v[228:229], v14 offset:3488
    ds_read_b64 v[230:231], v14 offset:3496
    v_and_b32_dpp v169, v169, v15 row_shr:1 row_mask:0xf bank_mask:0xf bound_ctrl:0
    v_and_b32_dpp v170, v170, v15 row_shr:1 row_mask:0xf bank_mask:0xf bound_ctrl:0
    v_and_b32_dpp v171, v171, v15 row_shr:1 row_mask:0xf bank_mask:0xf bound_ctrl:0
    v_mfma_f32_32x32x16_bf16 v[144:159], v[200:203], v[88:91], v[144:159]
    ds_read_b64 v[232:233], v14 offset:3520
    ds_read_b64 v[234:235], v14 offset:3528
    v_and_b32_dpp v172, v172, v15 row_shr:1 row_mask:0xf bank_mask:0xf bound_ctrl:0
    v_and_b32_dpp v173, v173, v15 row_shr:1 row_mask:0xf bank_mask:0xf bound_ctrl:0
    v_mfma_f32_32x32x16_bf16 v[144:159], v[204:207], v[92:95], v[144:159]
    ds_read_b64 v[236:237], v14 offset:3552
    ds_read_b64 v[238:239], v14 offset:3560
    v_and_b32_dpp v174, v174, v15 row_shr:1 row_mask:0xf bank_mask:0xf bound_ctrl:0
    v_and_b32_dpp v175, v175, v15 row_shr:1 row_mask:0xf bank_mask:0xf bound_ctrl:0
    v_mfma_f32_32x32x16_bf16 v[128:143], v[176:179], v[32:35], v[128:143]
    v_and_b32 v19, 31, v1
    s_nop 3
    v_mfma_f32_32x32x16_bf16 v[128:143], v[180:183], v[36:39], v[128:143]
    s_mov_b32 s50, 400384
    s_nop 3
    v_mfma_f32_32x32x16_bf16 v[128:143], v[184:187], v[40:43], v[128:143]
    v_mul_lo_u32 v19, v19, s50
    v_mov_b32_dpp v144, v144 row_shr:1 row_mask:0xf bank_mask:0xf bound_ctrl:0
    v_mov_b32_dpp v145, v145 row_shr:1 row_mask:0xf bank_mask:0xf bound_ctrl:0
    v_mov_b32_dpp v146, v146 row_shr:1 row_mask:0xf bank_mask:0xf bound_ctrl:0
    v_mfma_f32_32x32x16_bf16 v[128:143], v[188:191], v[44:47], v[128:143]
    s_mov_b32 s50, 9060352
    v_mov_b32_dpp v147, v147 row_shr:1 row_mask:0xf bank_mask:0xf bound_ctrl:0
    v_mov_b32_dpp v148, v148 row_shr:1 row_mask:0xf bank_mask:0xf bound_ctrl:0
    v_mov_b32_dpp v149, v149 row_shr:1 row_mask:0xf bank_mask:0xf bound_ctrl:0
    v_mfma_f32_32x32x16_bf16 v[128:143], v[192:195], v[48:51], v[128:143]
    buffer_load_dword v28, v19, s[28:31], s50 offen
    v_mov_b32_dpp v150, v150 row_shr:1 row_mask:0xf bank_mask:0xf bound_ctrl:0
    v_mov_b32_dpp v151, v151 row_shr:1 row_mask:0xf bank_mask:0xf bound_ctrl:0
    v_mov_b32_dpp v152, v152 row_shr:1 row_mask:0xf bank_mask:0xf bound_ctrl:0
    v_mfma_f32_32x32x16_bf16 v[128:143], v[196:199], v[52:55], v[128:143]
    v_mov_b32_dpp v153, v153 row_shr:1 row_mask:0xf bank_mask:0xf bound_ctrl:0
    v_mov_b32_dpp v154, v154 row_shr:1 row_mask:0xf bank_mask:0xf bound_ctrl:0
    v_mov_b32_dpp v155, v155 row_shr:1 row_mask:0xf bank_mask:0xf bound_ctrl:0
    v_mfma_f32_32x32x16_bf16 v[128:143], v[200:203], v[56:59], v[128:143]
    v_mov_b32_dpp v156, v156 row_shr:1 row_mask:0xf bank_mask:0xf bound_ctrl:0
    v_mov_b32_dpp v157, v157 row_shr:1 row_mask:0xf bank_mask:0xf bound_ctrl:0
    v_mfma_f32_32x32x16_bf16 v[128:143], v[204:207], v[60:63], v[128:143]
    v_mov_b32_dpp v158, v158 row_shr:1 row_mask:0xf bank_mask:0xf bound_ctrl:0
    v_mov_b32_dpp v159, v159 row_shr:1 row_mask:0xf bank_mask:0xf bound_ctrl:0
    s_waitcnt lgkmcnt(0)
    v_mfma_f32_32x32x16_bf16 v[160:175], v[208:211], v[96:99], v[160:175]
    ds_read_b64 v[176:177], v14 offset:1024
    ds_read_b64 v[178:179], v14 offset:1032
    ds_read_b64 v[180:181], v14 offset:1056
    ds_read_b64 v[182:183], v14 offset:1064
    s_nop 0
    v_mfma_f32_32x32x16_bf16 v[160:175], v[212:215], v[100:103], v[160:175]
    ds_read_b64 v[184:185], v14 offset:1088
    ds_read_b64 v[186:187], v14 offset:1096
    ds_read_b64 v[188:189], v14 offset:1120
    s_nop 1
    v_mfma_f32_32x32x16_bf16 v[160:175], v[216:219], v[104:107], v[160:175]
    ds_read_b64 v[190:191], v14 offset:1128
    ds_read_b64 v[192:193], v14 offset:1152
    ds_read_b64 v[194:195], v14 offset:1160
    v_mov_b32_dpp v128, v128 row_shr:1 row_mask:0xf bank_mask:0xf bound_ctrl:0
    v_mov_b32_dpp v129, v129 row_shr:1 row_mask:0xf bank_mask:0xf bound_ctrl:0
    v_mov_b32_dpp v130, v130 row_shr:1 row_mask:0xf bank_mask:0xf bound_ctrl:0
    v_mfma_f32_32x32x16_bf16 v[160:175], v[220:223], v[108:111], v[160:175]
    ds_read_b64 v[196:197], v14 offset:1184
    ds_read_b64 v[198:199], v14 offset:1192
    ds_read_b64 v[200:201], v14 offset:1216
    v_mov_b32_dpp v131, v131 row_shr:1 row_mask:0xf bank_mask:0xf bound_ctrl:0
    v_mov_b32_dpp v132, v132 row_shr:1 row_mask:0xf bank_mask:0xf bound_ctrl:0
    v_mov_b32_dpp v133, v133 row_shr:1 row_mask:0xf bank_mask:0xf bound_ctrl:0
    v_mfma_f32_32x32x16_bf16 v[160:175], v[224:227], v[112:115], v[160:175]
    ds_read_b64 v[202:203], v14 offset:1224
    ds_read_b64 v[204:205], v14 offset:1248
    ds_read_b64 v[206:207], v14 offset:1256
    v_mov_b32_dpp v134, v134 row_shr:1 row_mask:0xf bank_mask:0xf bound_ctrl:0
    v_mov_b32_dpp v135, v135 row_shr:1 row_mask:0xf bank_mask:0xf bound_ctrl:0
    v_mov_b32_dpp v136, v136 row_shr:1 row_mask:0xf bank_mask:0xf bound_ctrl:0
    v_mfma_f32_32x32x16_bf16 v[160:175], v[228:231], v[116:119], v[160:175]
    v_mov_b32_dpp v137, v137 row_shr:1 row_mask:0xf bank_mask:0xf bound_ctrl:0
    v_mov_b32_dpp v138, v138 row_shr:1 row_mask:0xf bank_mask:0xf bound_ctrl:0
    v_mov_b32_dpp v139, v139 row_shr:1 row_mask:0xf bank_mask:0xf bound_ctrl:0
    v_mfma_f32_32x32x16_bf16 v[160:175], v[232:235], v[120:123], v[160:175]
    v_mov_b32_dpp v140, v140 row_shr:1 row_mask:0xf bank_mask:0xf bound_ctrl:0
    v_mov_b32_dpp v141, v141 row_shr:1 row_mask:0xf bank_mask:0xf bound_ctrl:0
    v_mfma_f32_32x32x16_bf16 v[160:175], v[236:239], v[124:127], v[160:175]
    v_mov_b32_dpp v142, v142 row_shr:1 row_mask:0xf bank_mask:0xf bound_ctrl:0
    v_mov_b32_dpp v143, v143 row_shr:1 row_mask:0xf bank_mask:0xf bound_ctrl:0
    s_waitcnt lgkmcnt(0)
    v_mfma_f32_32x32x16_bf16 v[144:159], v[176:179], v[64:67], v[144:159]
    ds_read_b64 v[208:209], v14 offset:3072
    ds_read_b64 v[210:211], v14 offset:3080
    s_nop 2
    v_mfma_f32_32x32x16_bf16 v[144:159], v[180:183], v[68:71], v[144:159]
    ds_read_b64 v[212:213], v14 offset:3104
    ds_read_b64 v[214:215], v14 offset:3112
    s_nop 2
    v_mfma_f32_32x32x16_bf16 v[144:159], v[184:187], v[72:75], v[144:159]
    ds_read_b64 v[216:217], v14 offset:3136
    ds_read_b64 v[218:219], v14 offset:3144
    v_and_b32_dpp v160, v160, v15 row_shr:1 row_mask:0xf bank_mask:0xf bound_ctrl:0
    v_and_b32_dpp v161, v161, v15 row_shr:1 row_mask:0xf bank_mask:0xf bound_ctrl:0
    v_and_b32_dpp v162, v162, v15 row_shr:1 row_mask:0xf bank_mask:0xf bound_ctrl:0
    v_mfma_f32_32x32x16_bf16 v[144:159], v[188:191], v[76:79], v[144:159]
    ds_read_b64 v[220:221], v14 offset:3168
    ds_read_b64 v[222:223], v14 offset:3176
    v_and_b32_dpp v163, v163, v15 row_shr:1 row_mask:0xf bank_mask:0xf bound_ctrl:0
    v_and_b32_dpp v164, v164, v15 row_shr:1 row_mask:0xf bank_mask:0xf bound_ctrl:0
    v_and_b32_dpp v165, v165, v15 row_shr:1 row_mask:0xf bank_mask:0xf bound_ctrl:0
    v_mfma_f32_32x32x16_bf16 v[144:159], v[192:195], v[80:83], v[144:159]
    ds_read_b64 v[224:225], v14 offset:3200
    ds_read_b64 v[226:227], v14 offset:3208
    v_and_b32_dpp v166, v166, v15 row_shr:1 row_mask:0xf bank_mask:0xf bound_ctrl:0
    v_and_b32_dpp v167, v167, v15 row_shr:1 row_mask:0xf bank_mask:0xf bound_ctrl:0
    v_and_b32_dpp v168, v168, v15 row_shr:1 row_mask:0xf bank_mask:0xf bound_ctrl:0
    v_mfma_f32_32x32x16_bf16 v[144:159], v[196:199], v[84:87], v[144:159]
    ds_read_b64 v[228:229], v14 offset:3232
    ds_read_b64 v[230:231], v14 offset:3240
    v_and_b32_dpp v169, v169, v15 row_shr:1 row_mask:0xf bank_mask:0xf bound_ctrl:0
    v_and_b32_dpp v170, v170, v15 row_shr:1 row_mask:0xf bank_mask:0xf bound_ctrl:0
    v_and_b32_dpp v171, v171, v15 row_shr:1 row_mask:0xf bank_mask:0xf bound_ctrl:0
    v_mfma_f32_32x32x16_bf16 v[144:159], v[200:203], v[88:91], v[144:159]
    ds_read_b64 v[232:233], v14 offset:3264
    ds_read_b64 v[234:235], v14 offset:3272
    v_and_b32_dpp v172, v172, v15 row_shr:1 row_mask:0xf bank_mask:0xf bound_ctrl:0
    v_and_b32_dpp v173, v173, v15 row_shr:1 row_mask:0xf bank_mask:0xf bound_ctrl:0
    v_mfma_f32_32x32x16_bf16 v[144:159], v[204:207], v[92:95], v[144:159]
    ds_read_b64 v[236:237], v14 offset:3296
    ds_read_b64 v[238:239], v14 offset:3304
    v_and_b32_dpp v174, v174, v15 row_shr:1 row_mask:0xf bank_mask:0xf bound_ctrl:0
    v_and_b32_dpp v175, v175, v15 row_shr:1 row_mask:0xf bank_mask:0xf bound_ctrl:0
    v_mfma_f32_32x32x16_bf16 v[128:143], v[176:179], v[32:35], v[128:143]
    s_nop 4
    v_mfma_f32_32x32x16_bf16 v[128:143], v[180:183], v[36:39], v[128:143]
    s_nop 4
    v_mfma_f32_32x32x16_bf16 v[128:143], v[184:187], v[40:43], v[128:143]
    v_mov_b32_dpp v144, v144 row_shr:1 row_mask:0xf bank_mask:0xf bound_ctrl:0
    v_mov_b32_dpp v145, v145 row_shr:1 row_mask:0xf bank_mask:0xf bound_ctrl:0
    v_mov_b32_dpp v146, v146 row_shr:1 row_mask:0xf bank_mask:0xf bound_ctrl:0
    v_mfma_f32_32x32x16_bf16 v[128:143], v[188:191], v[44:47], v[128:143]
    v_mov_b32_dpp v147, v147 row_shr:1 row_mask:0xf bank_mask:0xf bound_ctrl:0
    v_mov_b32_dpp v148, v148 row_shr:1 row_mask:0xf bank_mask:0xf bound_ctrl:0
    v_mov_b32_dpp v149, v149 row_shr:1 row_mask:0xf bank_mask:0xf bound_ctrl:0
    v_mfma_f32_32x32x16_bf16 v[128:143], v[192:195], v[48:51], v[128:143]
    v_mov_b32_dpp v150, v150 row_shr:1 row_mask:0xf bank_mask:0xf bound_ctrl:0
    v_mov_b32_dpp v151, v151 row_shr:1 row_mask:0xf bank_mask:0xf bound_ctrl:0
    v_mov_b32_dpp v152, v152 row_shr:1 row_mask:0xf bank_mask:0xf bound_ctrl:0
    v_mfma_f32_32x32x16_bf16 v[128:143], v[196:199], v[52:55], v[128:143]
    v_mov_b32_dpp v153, v153 row_shr:1 row_mask:0xf bank_mask:0xf bound_ctrl:0
    v_mov_b32_dpp v154, v154 row_shr:1 row_mask:0xf bank_mask:0xf bound_ctrl:0
    v_mov_b32_dpp v155, v155 row_shr:1 row_mask:0xf bank_mask:0xf bound_ctrl:0
    v_mfma_f32_32x32x16_bf16 v[128:143], v[200:203], v[56:59], v[128:143]
    v_mov_b32_dpp v156, v156 row_shr:1 row_mask:0xf bank_mask:0xf bound_ctrl:0
    v_mov_b32_dpp v157, v157 row_shr:1 row_mask:0xf bank_mask:0xf bound_ctrl:0
    v_mfma_f32_32x32x16_bf16 v[128:143], v[204:207], v[60:63], v[128:143]
    v_mov_b32_dpp v158, v158 row_shr:1 row_mask:0xf bank_mask:0xf bound_ctrl:0
    v_mov_b32_dpp v159, v159 row_shr:1 row_mask:0xf bank_mask:0xf bound_ctrl:0
    s_waitcnt lgkmcnt(0)
    v_mfma_f32_32x32x16_bf16 v[160:175], v[208:211], v[96:99], v[160:175]
    ds_read_b64 v[176:177], v14 offset:768
    ds_read_b64 v[178:179], v14 offset:776
    ds_read_b64 v[180:181], v14 offset:800
    ds_read_b64 v[182:183], v14 offset:808
    s_nop 0
    v_mfma_f32_32x32x16_bf16 v[160:175], v[212:215], v[100:103], v[160:175]
    ds_read_b64 v[184:185], v14 offset:832
    ds_read_b64 v[186:187], v14 offset:840
    ds_read_b64 v[188:189], v14 offset:864
    s_nop 1
    v_mfma_f32_32x32x16_bf16 v[160:175], v[216:219], v[104:107], v[160:175]
    ds_read_b64 v[190:191], v14 offset:872
    ds_read_b64 v[192:193], v14 offset:896
    ds_read_b64 v[194:195], v14 offset:904
    v_mov_b32_dpp v128, v128 row_shr:1 row_mask:0xf bank_mask:0xf bound_ctrl:0
    v_mov_b32_dpp v129, v129 row_shr:1 row_mask:0xf bank_mask:0xf bound_ctrl:0
    v_mov_b32_dpp v130, v130 row_shr:1 row_mask:0xf bank_mask:0xf bound_ctrl:0
    v_mfma_f32_32x32x16_bf16 v[160:175], v[220:223], v[108:111], v[160:175]
    ds_read_b64 v[196:197], v14 offset:928
    ds_read_b64 v[198:199], v14 offset:936
    ds_read_b64 v[200:201], v14 offset:960
    v_mov_b32_dpp v131, v131 row_shr:1 row_mask:0xf bank_mask:0xf bound_ctrl:0
    v_mov_b32_dpp v132, v132 row_shr:1 row_mask:0xf bank_mask:0xf bound_ctrl:0
    v_mov_b32_dpp v133, v133 row_shr:1 row_mask:0xf bank_mask:0xf bound_ctrl:0
    v_mfma_f32_32x32x16_bf16 v[160:175], v[224:227], v[112:115], v[160:175]
    ds_read_b64 v[202:203], v14 offset:968
    ds_read_b64 v[204:205], v14 offset:992
    ds_read_b64 v[206:207], v14 offset:1000
    v_mov_b32_dpp v134, v134 row_shr:1 row_mask:0xf bank_mask:0xf bound_ctrl:0
    v_mov_b32_dpp v135, v135 row_shr:1 row_mask:0xf bank_mask:0xf bound_ctrl:0
    v_mov_b32_dpp v136, v136 row_shr:1 row_mask:0xf bank_mask:0xf bound_ctrl:0
    v_mfma_f32_32x32x16_bf16 v[160:175], v[228:231], v[116:119], v[160:175]
    v_mov_b32_dpp v137, v137 row_shr:1 row_mask:0xf bank_mask:0xf bound_ctrl:0
    v_mov_b32_dpp v138, v138 row_shr:1 row_mask:0xf bank_mask:0xf bound_ctrl:0
    v_mov_b32_dpp v139, v139 row_shr:1 row_mask:0xf bank_mask:0xf bound_ctrl:0
    v_mfma_f32_32x32x16_bf16 v[160:175], v[232:235], v[120:123], v[160:175]
    v_mov_b32_dpp v140, v140 row_shr:1 row_mask:0xf bank_mask:0xf bound_ctrl:0
    v_mov_b32_dpp v141, v141 row_shr:1 row_mask:0xf bank_mask:0xf bound_ctrl:0
    v_mfma_f32_32x32x16_bf16 v[160:175], v[236:239], v[124:127], v[160:175]
    v_mov_b32_dpp v142, v142 row_shr:1 row_mask:0xf bank_mask:0xf bound_ctrl:0
    v_mov_b32_dpp v143, v143 row_shr:1 row_mask:0xf bank_mask:0xf bound_ctrl:0
    s_waitcnt lgkmcnt(0)
    v_mfma_f32_32x32x16_bf16 v[144:159], v[176:179], v[64:67], v[144:159]
    ds_read_b64 v[208:209], v14 offset:2816
    ds_read_b64 v[210:211], v14 offset:2824
    s_nop 2
    v_mfma_f32_32x32x16_bf16 v[144:159], v[180:183], v[68:71], v[144:159]
    ds_read_b64 v[212:213], v14 offset:2848
    ds_read_b64 v[214:215], v14 offset:2856
    s_nop 2
    v_mfma_f32_32x32x16_bf16 v[144:159], v[184:187], v[72:75], v[144:159]
    ds_read_b64 v[216:217], v14 offset:2880
    ds_read_b64 v[218:219], v14 offset:2888
    v_and_b32_dpp v160, v160, v15 row_shr:1 row_mask:0xf bank_mask:0xf bound_ctrl:0
    v_and_b32_dpp v161, v161, v15 row_shr:1 row_mask:0xf bank_mask:0xf bound_ctrl:0
    v_and_b32_dpp v162, v162, v15 row_shr:1 row_mask:0xf bank_mask:0xf bound_ctrl:0
    v_mfma_f32_32x32x16_bf16 v[144:159], v[188:191], v[76:79], v[144:159]
    ds_read_b64 v[220:221], v14 offset:2912
    ds_read_b64 v[222:223], v14 offset:2920
    v_and_b32_dpp v163, v163, v15 row_shr:1 row_mask:0xf bank_mask:0xf bound_ctrl:0
    v_and_b32_dpp v164, v164, v15 row_shr:1 row_mask:0xf bank_mask:0xf bound_ctrl:0
    v_and_b32_dpp v165, v165, v15 row_shr:1 row_mask:0xf bank_mask:0xf bound_ctrl:0
    v_mfma_f32_32x32x16_bf16 v[144:159], v[192:195], v[80:83], v[144:159]
    ds_read_b64 v[224:225], v14 offset:2944
    ds_read_b64 v[226:227], v14 offset:2952
    v_and_b32_dpp v166, v166, v15 row_shr:1 row_mask:0xf bank_mask:0xf bound_ctrl:0
    v_and_b32_dpp v167, v167, v15 row_shr:1 row_mask:0xf bank_mask:0xf bound_ctrl:0
    v_and_b32_dpp v168, v168, v15 row_shr:1 row_mask:0xf bank_mask:0xf bound_ctrl:0
    v_mfma_f32_32x32x16_bf16 v[144:159], v[196:199], v[84:87], v[144:159]
    ds_read_b64 v[228:229], v14 offset:2976
    ds_read_b64 v[230:231], v14 offset:2984
    v_and_b32_dpp v169, v169, v15 row_shr:1 row_mask:0xf bank_mask:0xf bound_ctrl:0
    v_and_b32_dpp v170, v170, v15 row_shr:1 row_mask:0xf bank_mask:0xf bound_ctrl:0
    v_and_b32_dpp v171, v171, v15 row_shr:1 row_mask:0xf bank_mask:0xf bound_ctrl:0
    v_mfma_f32_32x32x16_bf16 v[144:159], v[200:203], v[88:91], v[144:159]
    ds_read_b64 v[232:233], v14 offset:3008
    ds_read_b64 v[234:235], v14 offset:3016
    v_and_b32_dpp v172, v172, v15 row_shr:1 row_mask:0xf bank_mask:0xf bound_ctrl:0
    v_and_b32_dpp v173, v173, v15 row_shr:1 row_mask:0xf bank_mask:0xf bound_ctrl:0
    v_mfma_f32_32x32x16_bf16 v[144:159], v[204:207], v[92:95], v[144:159]
    ds_read_b64 v[236:237], v14 offset:3040
    ds_read_b64 v[238:239], v14 offset:3048
    v_and_b32_dpp v174, v174, v15 row_shr:1 row_mask:0xf bank_mask:0xf bound_ctrl:0
    v_and_b32_dpp v175, v175, v15 row_shr:1 row_mask:0xf bank_mask:0xf bound_ctrl:0
    v_mfma_f32_32x32x16_bf16 v[128:143], v[176:179], v[32:35], v[128:143]
    s_nop 4
    v_mfma_f32_32x32x16_bf16 v[128:143], v[180:183], v[36:39], v[128:143]
    s_nop 4
    v_mfma_f32_32x32x16_bf16 v[128:143], v[184:187], v[40:43], v[128:143]
    v_mov_b32_dpp v144, v144 row_shr:1 row_mask:0xf bank_mask:0xf bound_ctrl:0
    v_mov_b32_dpp v145, v145 row_shr:1 row_mask:0xf bank_mask:0xf bound_ctrl:0
    v_mov_b32_dpp v146, v146 row_shr:1 row_mask:0xf bank_mask:0xf bound_ctrl:0
    v_mfma_f32_32x32x16_bf16 v[128:143], v[188:191], v[44:47], v[128:143]
    v_mov_b32_dpp v147, v147 row_shr:1 row_mask:0xf bank_mask:0xf bound_ctrl:0
    v_mov_b32_dpp v148, v148 row_shr:1 row_mask:0xf bank_mask:0xf bound_ctrl:0
    v_mov_b32_dpp v149, v149 row_shr:1 row_mask:0xf bank_mask:0xf bound_ctrl:0
    v_mfma_f32_32x32x16_bf16 v[128:143], v[192:195], v[48:51], v[128:143]
    v_mov_b32_dpp v150, v150 row_shr:1 row_mask:0xf bank_mask:0xf bound_ctrl:0
    v_mov_b32_dpp v151, v151 row_shr:1 row_mask:0xf bank_mask:0xf bound_ctrl:0
    v_mov_b32_dpp v152, v152 row_shr:1 row_mask:0xf bank_mask:0xf bound_ctrl:0
    v_mfma_f32_32x32x16_bf16 v[128:143], v[196:199], v[52:55], v[128:143]
    v_mov_b32_dpp v153, v153 row_shr:1 row_mask:0xf bank_mask:0xf bound_ctrl:0
    v_mov_b32_dpp v154, v154 row_shr:1 row_mask:0xf bank_mask:0xf bound_ctrl:0
    v_mov_b32_dpp v155, v155 row_shr:1 row_mask:0xf bank_mask:0xf bound_ctrl:0
    v_mfma_f32_32x32x16_bf16 v[128:143], v[200:203], v[56:59], v[128:143]
    v_mov_b32_dpp v156, v156 row_shr:1 row_mask:0xf bank_mask:0xf bound_ctrl:0
    v_mov_b32_dpp v157, v157 row_shr:1 row_mask:0xf bank_mask:0xf bound_ctrl:0
    v_mfma_f32_32x32x16_bf16 v[128:143], v[204:207], v[60:63], v[128:143]
    v_mov_b32_dpp v158, v158 row_shr:1 row_mask:0xf bank_mask:0xf bound_ctrl:0
    v_mov_b32_dpp v159, v159 row_shr:1 row_mask:0xf bank_mask:0xf bound_ctrl:0
    s_waitcnt lgkmcnt(0)
    v_mfma_f32_32x32x16_bf16 v[160:175], v[208:211], v[96:99], v[160:175]
    ds_read_b64 v[176:177], v14 offset:512
    ds_read_b64 v[178:179], v14 offset:520
    ds_read_b64 v[180:181], v14 offset:544
    ds_read_b64 v[182:183], v14 offset:552
    s_nop 0
    v_mfma_f32_32x32x16_bf16 v[160:175], v[212:215], v[100:103], v[160:175]
    ds_read_b64 v[184:185], v14 offset:576
    ds_read_b64 v[186:187], v14 offset:584
    ds_read_b64 v[188:189], v14 offset:608
    s_nop 1
    v_mfma_f32_32x32x16_bf16 v[160:175], v[216:219], v[104:107], v[160:175]
    ds_read_b64 v[190:191], v14 offset:616
    ds_read_b64 v[192:193], v14 offset:640
    ds_read_b64 v[194:195], v14 offset:648
    v_mov_b32_dpp v128, v128 row_shr:1 row_mask:0xf bank_mask:0xf bound_ctrl:0
    v_mov_b32_dpp v129, v129 row_shr:1 row_mask:0xf bank_mask:0xf bound_ctrl:0
    v_mov_b32_dpp v130, v130 row_shr:1 row_mask:0xf bank_mask:0xf bound_ctrl:0
    v_mfma_f32_32x32x16_bf16 v[160:175], v[220:223], v[108:111], v[160:175]
    ds_read_b64 v[196:197], v14 offset:672
    ds_read_b64 v[198:199], v14 offset:680
    ds_read_b64 v[200:201], v14 offset:704
    v_mov_b32_dpp v131, v131 row_shr:1 row_mask:0xf bank_mask:0xf bound_ctrl:0
    v_mov_b32_dpp v132, v132 row_shr:1 row_mask:0xf bank_mask:0xf bound_ctrl:0
    v_mov_b32_dpp v133, v133 row_shr:1 row_mask:0xf bank_mask:0xf bound_ctrl:0
    v_mfma_f32_32x32x16_bf16 v[160:175], v[224:227], v[112:115], v[160:175]
    ds_read_b64 v[202:203], v14 offset:712
    ds_read_b64 v[204:205], v14 offset:736
    ds_read_b64 v[206:207], v14 offset:744
    v_mov_b32_dpp v134, v134 row_shr:1 row_mask:0xf bank_mask:0xf bound_ctrl:0
    v_mov_b32_dpp v135, v135 row_shr:1 row_mask:0xf bank_mask:0xf bound_ctrl:0
    v_mov_b32_dpp v136, v136 row_shr:1 row_mask:0xf bank_mask:0xf bound_ctrl:0
    v_mfma_f32_32x32x16_bf16 v[160:175], v[228:231], v[116:119], v[160:175]
    v_mov_b32_dpp v137, v137 row_shr:1 row_mask:0xf bank_mask:0xf bound_ctrl:0
    v_mov_b32_dpp v138, v138 row_shr:1 row_mask:0xf bank_mask:0xf bound_ctrl:0
    v_mov_b32_dpp v139, v139 row_shr:1 row_mask:0xf bank_mask:0xf bound_ctrl:0
    v_mfma_f32_32x32x16_bf16 v[160:175], v[232:235], v[120:123], v[160:175]
    v_mov_b32_dpp v140, v140 row_shr:1 row_mask:0xf bank_mask:0xf bound_ctrl:0
    v_mov_b32_dpp v141, v141 row_shr:1 row_mask:0xf bank_mask:0xf bound_ctrl:0
    v_mfma_f32_32x32x16_bf16 v[160:175], v[236:239], v[124:127], v[160:175]
    v_mov_b32_dpp v142, v142 row_shr:1 row_mask:0xf bank_mask:0xf bound_ctrl:0
    v_mov_b32_dpp v143, v143 row_shr:1 row_mask:0xf bank_mask:0xf bound_ctrl:0
    s_waitcnt lgkmcnt(0)
    v_mfma_f32_32x32x16_bf16 v[144:159], v[176:179], v[64:67], v[144:159]
    ds_read_b64 v[208:209], v14 offset:2560
    ds_read_b64 v[210:211], v14 offset:2568
    s_nop 2
    v_mfma_f32_32x32x16_bf16 v[144:159], v[180:183], v[68:71], v[144:159]
    ds_read_b64 v[212:213], v14 offset:2592
    ds_read_b64 v[214:215], v14 offset:2600
    s_nop 2
    v_mfma_f32_32x32x16_bf16 v[144:159], v[184:187], v[72:75], v[144:159]
    ds_read_b64 v[216:217], v14 offset:2624
    ds_read_b64 v[218:219], v14 offset:2632
    v_and_b32_dpp v160, v160, v15 row_shr:1 row_mask:0xf bank_mask:0xf bound_ctrl:0
    v_and_b32_dpp v161, v161, v15 row_shr:1 row_mask:0xf bank_mask:0xf bound_ctrl:0
    v_and_b32_dpp v162, v162, v15 row_shr:1 row_mask:0xf bank_mask:0xf bound_ctrl:0
    v_mfma_f32_32x32x16_bf16 v[144:159], v[188:191], v[76:79], v[144:159]
    ds_read_b64 v[220:221], v14 offset:2656
    ds_read_b64 v[222:223], v14 offset:2664
    v_and_b32_dpp v163, v163, v15 row_shr:1 row_mask:0xf bank_mask:0xf bound_ctrl:0
    v_and_b32_dpp v164, v164, v15 row_shr:1 row_mask:0xf bank_mask:0xf bound_ctrl:0
    v_and_b32_dpp v165, v165, v15 row_shr:1 row_mask:0xf bank_mask:0xf bound_ctrl:0
    v_mfma_f32_32x32x16_bf16 v[144:159], v[192:195], v[80:83], v[144:159]
    ds_read_b64 v[224:225], v14 offset:2688
    ds_read_b64 v[226:227], v14 offset:2696
    v_and_b32_dpp v166, v166, v15 row_shr:1 row_mask:0xf bank_mask:0xf bound_ctrl:0
    v_and_b32_dpp v167, v167, v15 row_shr:1 row_mask:0xf bank_mask:0xf bound_ctrl:0
    v_and_b32_dpp v168, v168, v15 row_shr:1 row_mask:0xf bank_mask:0xf bound_ctrl:0
    v_mfma_f32_32x32x16_bf16 v[144:159], v[196:199], v[84:87], v[144:159]
    ds_read_b64 v[228:229], v14 offset:2720
    ds_read_b64 v[230:231], v14 offset:2728
    v_and_b32_dpp v169, v169, v15 row_shr:1 row_mask:0xf bank_mask:0xf bound_ctrl:0
    v_and_b32_dpp v170, v170, v15 row_shr:1 row_mask:0xf bank_mask:0xf bound_ctrl:0
    v_and_b32_dpp v171, v171, v15 row_shr:1 row_mask:0xf bank_mask:0xf bound_ctrl:0
    v_mfma_f32_32x32x16_bf16 v[144:159], v[200:203], v[88:91], v[144:159]
    ds_read_b64 v[232:233], v14 offset:2752
    ds_read_b64 v[234:235], v14 offset:2760
    v_and_b32_dpp v172, v172, v15 row_shr:1 row_mask:0xf bank_mask:0xf bound_ctrl:0
    v_and_b32_dpp v173, v173, v15 row_shr:1 row_mask:0xf bank_mask:0xf bound_ctrl:0
    v_mfma_f32_32x32x16_bf16 v[144:159], v[204:207], v[92:95], v[144:159]
    ds_read_b64 v[236:237], v14 offset:2784
    ds_read_b64 v[238:239], v14 offset:2792
    v_and_b32_dpp v174, v174, v15 row_shr:1 row_mask:0xf bank_mask:0xf bound_ctrl:0
    v_and_b32_dpp v175, v175, v15 row_shr:1 row_mask:0xf bank_mask:0xf bound_ctrl:0
    v_mfma_f32_32x32x16_bf16 v[128:143], v[176:179], v[32:35], v[128:143]
    s_nop 4
    v_mfma_f32_32x32x16_bf16 v[128:143], v[180:183], v[36:39], v[128:143]
    s_nop 4
    v_mfma_f32_32x32x16_bf16 v[128:143], v[184:187], v[40:43], v[128:143]
    v_mov_b32_dpp v144, v144 row_shr:1 row_mask:0xf bank_mask:0xf bound_ctrl:0
    v_mov_b32_dpp v145, v145 row_shr:1 row_mask:0xf bank_mask:0xf bound_ctrl:0
    v_mov_b32_dpp v146, v146 row_shr:1 row_mask:0xf bank_mask:0xf bound_ctrl:0
    v_mfma_f32_32x32x16_bf16 v[128:143], v[188:191], v[44:47], v[128:143]
    v_mov_b32_dpp v147, v147 row_shr:1 row_mask:0xf bank_mask:0xf bound_ctrl:0
    v_mov_b32_dpp v148, v148 row_shr:1 row_mask:0xf bank_mask:0xf bound_ctrl:0
    v_mov_b32_dpp v149, v149 row_shr:1 row_mask:0xf bank_mask:0xf bound_ctrl:0
    v_mfma_f32_32x32x16_bf16 v[128:143], v[192:195], v[48:51], v[128:143]
    v_mov_b32_dpp v150, v150 row_shr:1 row_mask:0xf bank_mask:0xf bound_ctrl:0
    v_mov_b32_dpp v151, v151 row_shr:1 row_mask:0xf bank_mask:0xf bound_ctrl:0
    v_mov_b32_dpp v152, v152 row_shr:1 row_mask:0xf bank_mask:0xf bound_ctrl:0
    v_mfma_f32_32x32x16_bf16 v[128:143], v[196:199], v[52:55], v[128:143]
    v_mov_b32_dpp v153, v153 row_shr:1 row_mask:0xf bank_mask:0xf bound_ctrl:0
    v_mov_b32_dpp v154, v154 row_shr:1 row_mask:0xf bank_mask:0xf bound_ctrl:0
    v_mov_b32_dpp v155, v155 row_shr:1 row_mask:0xf bank_mask:0xf bound_ctrl:0
    v_mfma_f32_32x32x16_bf16 v[128:143], v[200:203], v[56:59], v[128:143]
    v_mov_b32_dpp v156, v156 row_shr:1 row_mask:0xf bank_mask:0xf bound_ctrl:0
    v_mov_b32_dpp v157, v157 row_shr:1 row_mask:0xf bank_mask:0xf bound_ctrl:0
    v_mfma_f32_32x32x16_bf16 v[128:143], v[204:207], v[60:63], v[128:143]
    v_mov_b32_dpp v158, v158 row_shr:1 row_mask:0xf bank_mask:0xf bound_ctrl:0
    v_mov_b32_dpp v159, v159 row_shr:1 row_mask:0xf bank_mask:0xf bound_ctrl:0
    s_waitcnt lgkmcnt(0)
    v_mfma_f32_32x32x16_bf16 v[160:175], v[208:211], v[96:99], v[160:175]
    ds_read_b64 v[176:177], v14 offset:256
    ds_read_b64 v[178:179], v14 offset:264
    ds_read_b64 v[180:181], v14 offset:288
    ds_read_b64 v[182:183], v14 offset:296
    s_nop 0
    v_mfma_f32_32x32x16_bf16 v[160:175], v[212:215], v[100:103], v[160:175]
    ds_read_b64 v[184:185], v14 offset:320
    ds_read_b64 v[186:187], v14 offset:328
    ds_read_b64 v[188:189], v14 offset:352
    s_nop 1
    v_mfma_f32_32x32x16_bf16 v[160:175], v[216:219], v[104:107], v[160:175]
    ds_read_b64 v[190:191], v14 offset:360
    ds_read_b64 v[192:193], v14 offset:384
    ds_read_b64 v[194:195], v14 offset:392
    v_mov_b32_dpp v128, v128 row_shr:1 row_mask:0xf bank_mask:0xf bound_ctrl:0
    v_mov_b32_dpp v129, v129 row_shr:1 row_mask:0xf bank_mask:0xf bound_ctrl:0
    v_mov_b32_dpp v130, v130 row_shr:1 row_mask:0xf bank_mask:0xf bound_ctrl:0
    v_mfma_f32_32x32x16_bf16 v[160:175], v[220:223], v[108:111], v[160:175]
    ds_read_b64 v[196:197], v14 offset:416
    ds_read_b64 v[198:199], v14 offset:424
    ds_read_b64 v[200:201], v14 offset:448
    v_mov_b32_dpp v131, v131 row_shr:1 row_mask:0xf bank_mask:0xf bound_ctrl:0
    v_mov_b32_dpp v132, v132 row_shr:1 row_mask:0xf bank_mask:0xf bound_ctrl:0
    v_mov_b32_dpp v133, v133 row_shr:1 row_mask:0xf bank_mask:0xf bound_ctrl:0
    v_mfma_f32_32x32x16_bf16 v[160:175], v[224:227], v[112:115], v[160:175]
    ds_read_b64 v[202:203], v14 offset:456
    ds_read_b64 v[204:205], v14 offset:480
    ds_read_b64 v[206:207], v14 offset:488
    v_mov_b32_dpp v134, v134 row_shr:1 row_mask:0xf bank_mask:0xf bound_ctrl:0
    v_mov_b32_dpp v135, v135 row_shr:1 row_mask:0xf bank_mask:0xf bound_ctrl:0
    v_mov_b32_dpp v136, v136 row_shr:1 row_mask:0xf bank_mask:0xf bound_ctrl:0
    v_mfma_f32_32x32x16_bf16 v[160:175], v[228:231], v[116:119], v[160:175]
    v_mov_b32_dpp v137, v137 row_shr:1 row_mask:0xf bank_mask:0xf bound_ctrl:0
    v_mov_b32_dpp v138, v138 row_shr:1 row_mask:0xf bank_mask:0xf bound_ctrl:0
    v_mov_b32_dpp v139, v139 row_shr:1 row_mask:0xf bank_mask:0xf bound_ctrl:0
    v_mfma_f32_32x32x16_bf16 v[160:175], v[232:235], v[120:123], v[160:175]
    v_mov_b32_dpp v140, v140 row_shr:1 row_mask:0xf bank_mask:0xf bound_ctrl:0
    v_mov_b32_dpp v141, v141 row_shr:1 row_mask:0xf bank_mask:0xf bound_ctrl:0
    v_mfma_f32_32x32x16_bf16 v[160:175], v[236:239], v[124:127], v[160:175]
    v_mov_b32_dpp v142, v142 row_shr:1 row_mask:0xf bank_mask:0xf bound_ctrl:0
    v_mov_b32_dpp v143, v143 row_shr:1 row_mask:0xf bank_mask:0xf bound_ctrl:0
    s_waitcnt lgkmcnt(0)
    v_mfma_f32_32x32x16_bf16 v[144:159], v[176:179], v[64:67], v[144:159]
    ds_read_b64 v[208:209], v14 offset:2304
    ds_read_b64 v[210:211], v14 offset:2312
    s_nop 2
    v_mfma_f32_32x32x16_bf16 v[144:159], v[180:183], v[68:71], v[144:159]
    ds_read_b64 v[212:213], v14 offset:2336
    ds_read_b64 v[214:215], v14 offset:2344
    s_nop 2
    v_mfma_f32_32x32x16_bf16 v[144:159], v[184:187], v[72:75], v[144:159]
    ds_read_b64 v[216:217], v14 offset:2368
    ds_read_b64 v[218:219], v14 offset:2376
    v_and_b32_dpp v160, v160, v15 row_shr:1 row_mask:0xf bank_mask:0xf bound_ctrl:0
    v_and_b32_dpp v161, v161, v15 row_shr:1 row_mask:0xf bank_mask:0xf bound_ctrl:0
    v_and_b32_dpp v162, v162, v15 row_shr:1 row_mask:0xf bank_mask:0xf bound_ctrl:0
    v_mfma_f32_32x32x16_bf16 v[144:159], v[188:191], v[76:79], v[144:159]
    ds_read_b64 v[220:221], v14 offset:2400
    ds_read_b64 v[222:223], v14 offset:2408
    v_and_b32_dpp v163, v163, v15 row_shr:1 row_mask:0xf bank_mask:0xf bound_ctrl:0
    v_and_b32_dpp v164, v164, v15 row_shr:1 row_mask:0xf bank_mask:0xf bound_ctrl:0
    v_and_b32_dpp v165, v165, v15 row_shr:1 row_mask:0xf bank_mask:0xf bound_ctrl:0
    v_mfma_f32_32x32x16_bf16 v[144:159], v[192:195], v[80:83], v[144:159]
    ds_read_b64 v[224:225], v14 offset:2432
    ds_read_b64 v[226:227], v14 offset:2440
    v_and_b32_dpp v166, v166, v15 row_shr:1 row_mask:0xf bank_mask:0xf bound_ctrl:0
    v_and_b32_dpp v167, v167, v15 row_shr:1 row_mask:0xf bank_mask:0xf bound_ctrl:0
    v_and_b32_dpp v168, v168, v15 row_shr:1 row_mask:0xf bank_mask:0xf bound_ctrl:0
    v_mfma_f32_32x32x16_bf16 v[144:159], v[196:199], v[84:87], v[144:159]
    ds_read_b64 v[228:229], v14 offset:2464
    ds_read_b64 v[230:231], v14 offset:2472
    v_and_b32_dpp v169, v169, v15 row_shr:1 row_mask:0xf bank_mask:0xf bound_ctrl:0
    v_and_b32_dpp v170, v170, v15 row_shr:1 row_mask:0xf bank_mask:0xf bound_ctrl:0
    v_and_b32_dpp v171, v171, v15 row_shr:1 row_mask:0xf bank_mask:0xf bound_ctrl:0
    v_mfma_f32_32x32x16_bf16 v[144:159], v[200:203], v[88:91], v[144:159]
    ds_read_b64 v[232:233], v14 offset:2496
    ds_read_b64 v[234:235], v14 offset:2504
    v_and_b32_dpp v172, v172, v15 row_shr:1 row_mask:0xf bank_mask:0xf bound_ctrl:0
    v_and_b32_dpp v173, v173, v15 row_shr:1 row_mask:0xf bank_mask:0xf bound_ctrl:0
    v_mfma_f32_32x32x16_bf16 v[144:159], v[204:207], v[92:95], v[144:159]
    ds_read_b64 v[236:237], v14 offset:2528
    ds_read_b64 v[238:239], v14 offset:2536
    v_and_b32_dpp v174, v174, v15 row_shr:1 row_mask:0xf bank_mask:0xf bound_ctrl:0
    v_and_b32_dpp v175, v175, v15 row_shr:1 row_mask:0xf bank_mask:0xf bound_ctrl:0
    v_mfma_f32_32x32x16_bf16 v[128:143], v[176:179], v[32:35], v[128:143]
    s_nop 4
    v_mfma_f32_32x32x16_bf16 v[128:143], v[180:183], v[36:39], v[128:143]
    s_nop 4
    v_mfma_f32_32x32x16_bf16 v[128:143], v[184:187], v[40:43], v[128:143]
    v_mov_b32_dpp v144, v144 row_shr:1 row_mask:0xf bank_mask:0xf bound_ctrl:0
    v_mov_b32_dpp v145, v145 row_shr:1 row_mask:0xf bank_mask:0xf bound_ctrl:0
    v_mov_b32_dpp v146, v146 row_shr:1 row_mask:0xf bank_mask:0xf bound_ctrl:0
    v_mfma_f32_32x32x16_bf16 v[128:143], v[188:191], v[44:47], v[128:143]
    v_mov_b32_dpp v147, v147 row_shr:1 row_mask:0xf bank_mask:0xf bound_ctrl:0
    v_mov_b32_dpp v148, v148 row_shr:1 row_mask:0xf bank_mask:0xf bound_ctrl:0
    v_mov_b32_dpp v149, v149 row_shr:1 row_mask:0xf bank_mask:0xf bound_ctrl:0
    v_mfma_f32_32x32x16_bf16 v[128:143], v[192:195], v[48:51], v[128:143]
    v_mov_b32_dpp v150, v150 row_shr:1 row_mask:0xf bank_mask:0xf bound_ctrl:0
    v_mov_b32_dpp v151, v151 row_shr:1 row_mask:0xf bank_mask:0xf bound_ctrl:0
    v_mov_b32_dpp v152, v152 row_shr:1 row_mask:0xf bank_mask:0xf bound_ctrl:0
    v_mfma_f32_32x32x16_bf16 v[128:143], v[196:199], v[52:55], v[128:143]
    v_mov_b32_dpp v153, v153 row_shr:1 row_mask:0xf bank_mask:0xf bound_ctrl:0
    v_mov_b32_dpp v154, v154 row_shr:1 row_mask:0xf bank_mask:0xf bound_ctrl:0
    v_mov_b32_dpp v155, v155 row_shr:1 row_mask:0xf bank_mask:0xf bound_ctrl:0
    v_mfma_f32_32x32x16_bf16 v[128:143], v[200:203], v[56:59], v[128:143]
    v_mov_b32_dpp v156, v156 row_shr:1 row_mask:0xf bank_mask:0xf bound_ctrl:0
    v_mov_b32_dpp v157, v157 row_shr:1 row_mask:0xf bank_mask:0xf bound_ctrl:0
    v_mfma_f32_32x32x16_bf16 v[128:143], v[204:207], v[60:63], v[128:143]
    v_mov_b32_dpp v158, v158 row_shr:1 row_mask:0xf bank_mask:0xf bound_ctrl:0
    v_mov_b32_dpp v159, v159 row_shr:1 row_mask:0xf bank_mask:0xf bound_ctrl:0
    s_waitcnt lgkmcnt(0)
    v_mfma_f32_32x32x16_bf16 v[160:175], v[208:211], v[96:99], v[160:175]
    ds_read_b64 v[176:177], v14 offset:0
    ds_read_b64 v[178:179], v14 offset:8
    ds_read_b64 v[180:181], v14 offset:32
    ds_read_b64 v[182:183], v14 offset:40
    s_nop 0
    v_mfma_f32_32x32x16_bf16 v[160:175], v[212:215], v[100:103], v[160:175]
    ds_read_b64 v[184:185], v14 offset:64
    ds_read_b64 v[186:187], v14 offset:72
    ds_read_b64 v[188:189], v14 offset:96
    s_nop 1
    v_mfma_f32_32x32x16_bf16 v[160:175], v[216:219], v[104:107], v[160:175]
    ds_read_b64 v[190:191], v14 offset:104
    ds_read_b64 v[192:193], v14 offset:128
    ds_read_b64 v[194:195], v14 offset:136
    v_mov_b32_dpp v128, v128 row_shr:1 row_mask:0xf bank_mask:0xf bound_ctrl:0
    v_mov_b32_dpp v129, v129 row_shr:1 row_mask:0xf bank_mask:0xf bound_ctrl:0
    v_mov_b32_dpp v130, v130 row_shr:1 row_mask:0xf bank_mask:0xf bound_ctrl:0
    v_mfma_f32_32x32x16_bf16 v[160:175], v[220:223], v[108:111], v[160:175]
    ds_read_b64 v[196:197], v14 offset:160
    ds_read_b64 v[198:199], v14 offset:168
    ds_read_b64 v[200:201], v14 offset:192
    v_mov_b32_dpp v131, v131 row_shr:1 row_mask:0xf bank_mask:0xf bound_ctrl:0
    v_mov_b32_dpp v132, v132 row_shr:1 row_mask:0xf bank_mask:0xf bound_ctrl:0
    v_mov_b32_dpp v133, v133 row_shr:1 row_mask:0xf bank_mask:0xf bound_ctrl:0
    v_mfma_f32_32x32x16_bf16 v[160:175], v[224:227], v[112:115], v[160:175]
    ds_read_b64 v[202:203], v14 offset:200
    ds_read_b64 v[204:205], v14 offset:224
    ds_read_b64 v[206:207], v14 offset:232
    v_mov_b32_dpp v134, v134 row_shr:1 row_mask:0xf bank_mask:0xf bound_ctrl:0
    v_mov_b32_dpp v135, v135 row_shr:1 row_mask:0xf bank_mask:0xf bound_ctrl:0
    v_mov_b32_dpp v136, v136 row_shr:1 row_mask:0xf bank_mask:0xf bound_ctrl:0
    v_mfma_f32_32x32x16_bf16 v[160:175], v[228:231], v[116:119], v[160:175]
    v_mov_b32_dpp v137, v137 row_shr:1 row_mask:0xf bank_mask:0xf bound_ctrl:0
    v_mov_b32_dpp v138, v138 row_shr:1 row_mask:0xf bank_mask:0xf bound_ctrl:0
    v_mov_b32_dpp v139, v139 row_shr:1 row_mask:0xf bank_mask:0xf bound_ctrl:0
    v_mfma_f32_32x32x16_bf16 v[160:175], v[232:235], v[120:123], v[160:175]
    v_mov_b32_dpp v140, v140 row_shr:1 row_mask:0xf bank_mask:0xf bound_ctrl:0
    v_mov_b32_dpp v141, v141 row_shr:1 row_mask:0xf bank_mask:0xf bound_ctrl:0
    v_mfma_f32_32x32x16_bf16 v[160:175], v[236:239], v[124:127], v[160:175]
    v_mov_b32_dpp v142, v142 row_shr:1 row_mask:0xf bank_mask:0xf bound_ctrl:0
    v_mov_b32_dpp v143, v143 row_shr:1 row_mask:0xf bank_mask:0xf bound_ctrl:0
    s_waitcnt lgkmcnt(0)
    v_mfma_f32_32x32x16_bf16 v[144:159], v[176:179], v[64:67], v[144:159]
    ds_read_b64 v[208:209], v14 offset:2048
    ds_read_b64 v[210:211], v14 offset:2056
    s_nop 2
    v_mfma_f32_32x32x16_bf16 v[144:159], v[180:183], v[68:71], v[144:159]
    ds_read_b64 v[212:213], v14 offset:2080
    ds_read_b64 v[214:215], v14 offset:2088
    s_nop 2
    v_mfma_f32_32x32x16_bf16 v[144:159], v[184:187], v[72:75], v[144:159]
    ds_read_b64 v[216:217], v14 offset:2112
    ds_read_b64 v[218:219], v14 offset:2120
    v_and_b32_dpp v160, v160, v15 row_shr:1 row_mask:0xf bank_mask:0xf bound_ctrl:0
    v_and_b32_dpp v161, v161, v15 row_shr:1 row_mask:0xf bank_mask:0xf bound_ctrl:0
    v_and_b32_dpp v162, v162, v15 row_shr:1 row_mask:0xf bank_mask:0xf bound_ctrl:0
    v_mfma_f32_32x32x16_bf16 v[144:159], v[188:191], v[76:79], v[144:159]
    ds_read_b64 v[220:221], v14 offset:2144
    ds_read_b64 v[222:223], v14 offset:2152
    v_and_b32_dpp v163, v163, v15 row_shr:1 row_mask:0xf bank_mask:0xf bound_ctrl:0
    v_and_b32_dpp v164, v164, v15 row_shr:1 row_mask:0xf bank_mask:0xf bound_ctrl:0
    v_and_b32_dpp v165, v165, v15 row_shr:1 row_mask:0xf bank_mask:0xf bound_ctrl:0
    v_mfma_f32_32x32x16_bf16 v[144:159], v[192:195], v[80:83], v[144:159]
    ds_read_b64 v[224:225], v14 offset:2176
    ds_read_b64 v[226:227], v14 offset:2184
    v_and_b32_dpp v166, v166, v15 row_shr:1 row_mask:0xf bank_mask:0xf bound_ctrl:0
    v_and_b32_dpp v167, v167, v15 row_shr:1 row_mask:0xf bank_mask:0xf bound_ctrl:0
    v_and_b32_dpp v168, v168, v15 row_shr:1 row_mask:0xf bank_mask:0xf bound_ctrl:0
    v_mfma_f32_32x32x16_bf16 v[144:159], v[196:199], v[84:87], v[144:159]
    ds_read_b64 v[228:229], v14 offset:2208
    ds_read_b64 v[230:231], v14 offset:2216
    v_and_b32_dpp v169, v169, v15 row_shr:1 row_mask:0xf bank_mask:0xf bound_ctrl:0
    v_and_b32_dpp v170, v170, v15 row_shr:1 row_mask:0xf bank_mask:0xf bound_ctrl:0
    v_and_b32_dpp v171, v171, v15 row_shr:1 row_mask:0xf bank_mask:0xf bound_ctrl:0
    v_mfma_f32_32x32x16_bf16 v[144:159], v[200:203], v[88:91], v[144:159]
    ds_read_b64 v[232:233], v14 offset:2240
    ds_read_b64 v[234:235], v14 offset:2248
    v_and_b32_dpp v172, v172, v15 row_shr:1 row_mask:0xf bank_mask:0xf bound_ctrl:0
    v_and_b32_dpp v173, v173, v15 row_shr:1 row_mask:0xf bank_mask:0xf bound_ctrl:0
    v_mfma_f32_32x32x16_bf16 v[144:159], v[204:207], v[92:95], v[144:159]
    ds_read_b64 v[236:237], v14 offset:2272
    ds_read_b64 v[238:239], v14 offset:2280
    v_and_b32_dpp v174, v174, v15 row_shr:1 row_mask:0xf bank_mask:0xf bound_ctrl:0
    v_and_b32_dpp v175, v175, v15 row_shr:1 row_mask:0xf bank_mask:0xf bound_ctrl:0
    v_mfma_f32_32x32x16_bf16 v[128:143], v[176:179], v[32:35], v[128:143]
    v_mfma_f32_32x32x16_bf16 v[128:143], v[180:183], v[36:39], v[128:143]
    v_mfma_f32_32x32x16_bf16 v[128:143], v[184:187], v[40:43], v[128:143]
    v_mul_u32_u24 v16, 272, v7
    v_add_u32 v16, s34, v16
    v_add_u32 v16, 4388, v16
    v_lshlrev_b32 v17, 2, v8
    v_sub_u32 v16, v16, v17
    v_lshlrev_b32 v17, 5, v9
    v_sub_u32 v16, v16, v17
    v_mfma_f32_32x32x16_bf16 v[128:143], v[188:191], v[44:47], v[128:143]
    ds_read_b32 v64, v16 offset:216
    ds_read_b32 v65, v16 offset:208
    ds_read_b32 v66, v16 offset:200
    ds_read_b32 v67, v16 offset:192
    ds_read_b32 v68, v16 offset:152
    ds_read_b32 v69, v16 offset:144
    v_mfma_f32_32x32x16_bf16 v[128:143], v[192:195], v[48:51], v[128:143]
    ds_read_b32 v70, v16 offset:136
    ds_read_b32 v71, v16 offset:128
    ds_read_b32 v72, v16 offset:88
    ds_read_b32 v73, v16 offset:80
    ds_read_b32 v74, v16 offset:72
    ds_read_b32 v75, v16 offset:64
    v_mfma_f32_32x32x16_bf16 v[128:143], v[196:199], v[52:55], v[128:143]
    ds_read_b32 v76, v16 offset:24
    ds_read_b32 v77, v16 offset:16
    ds_read_b32 v78, v16 offset:8
    ds_read_b32 v79, v16 offset:0
    s_lshr_b32 s44, s20, 1
    s_and_b32 s45, s20, 1
    v_mfma_f32_32x32x16_bf16 v[128:143], v[200:203], v[56:59], v[128:143]
    s_cmp_eq_u32 s44, 1
    s_cselect_b32 s44, s33, s32
    s_lshl_b32 s46, s44, 16
    s_and_b32 s47, s44, 0xffff0000
    s_cmp_eq_u32 s45, 1
    s_cselect_b32 s44, s47, s46
    v_mfma_f32_32x32x16_bf16 v[128:143], v[204:207], v[60:63], v[128:143]
    v_mul_u32_u24 v18, 264, v7
    v_lshl_add_u32 v18, v9, 5, v18
    v_lshl_add_u32 v18, v8, 2, v18
    v_add_u32 v18, s34, v18
    v_mul_u32_u24 v17, 264, v2
    v_lshl_add_u32 v17, v1, 2, v17
    s_waitcnt lgkmcnt(0)
    v_mfma_f32_32x32x16_bf16 v[160:175], v[208:211], v[96:99], v[160:175]
    v_mfma_f32_32x32x16_bf16 v[160:175], v[212:215], v[100:103], v[160:175]
    v_mfma_f32_32x32x16_bf16 v[160:175], v[216:219], v[104:107], v[160:175]
    v_and_b32 v80, 0xffff0000, v64
    v_lshlrev_b32 v64, 16, v64
    v_and_b32 v81, 0xffff0000, v65
    v_lshlrev_b32 v65, 16, v65
    v_and_b32 v82, 0xffff0000, v66
    v_lshlrev_b32 v66, 16, v66
    v_mfma_f32_32x32x16_bf16 v[160:175], v[220:223], v[108:111], v[160:175]
    v_and_b32 v83, 0xffff0000, v67
    v_lshlrev_b32 v67, 16, v67
    v_and_b32 v84, 0xffff0000, v68
    v_lshlrev_b32 v68, 16, v68
    v_and_b32 v85, 0xffff0000, v69
    v_lshlrev_b32 v69, 16, v69
    v_mfma_f32_32x32x16_bf16 v[160:175], v[224:227], v[112:115], v[160:175]
    v_and_b32 v86, 0xffff0000, v70
    v_lshlrev_b32 v70, 16, v70
    v_and_b32 v87, 0xffff0000, v71
    v_lshlrev_b32 v71, 16, v71
    v_and_b32 v88, 0xffff0000, v72
    v_mfma_f32_32x32x16_bf16 v[160:175], v[228:231], v[116:119], v[160:175]
    v_lshlrev_b32 v72, 16, v72
    v_and_b32 v89, 0xffff0000, v73
    v_lshlrev_b32 v73, 16, v73
    v_and_b32 v90, 0xffff0000, v74
    v_lshlrev_b32 v74, 16, v74
    v_mfma_f32_32x32x16_bf16 v[160:175], v[232:235], v[120:123], v[160:175]
    v_and_b32 v91, 0xffff0000, v75
    v_lshlrev_b32 v75, 16, v75
    v_and_b32 v92, 0xffff0000, v76
    v_lshlrev_b32 v76, 16, v76
    v_and_b32 v93, 0xffff0000, v77
    v_mfma_f32_32x32x16_bf16 v[160:175], v[236:239], v[124:127], v[160:175]
    v_lshlrev_b32 v77, 16, v77
    v_and_b32 v94, 0xffff0000, v78
    v_lshlrev_b32 v78, 16, v78
    v_and_b32 v95, 0xffff0000, v79
    v_lshlrev_b32 v79, 16, v79
    s_mov_b32 s48, 0x05040100
    s_mov_b32 s49, 0x07060302
    s_nop 11
    v_add_f32_dpp v128, v160, v128 row_shr:8 row_mask:0xf bank_mask:0xf bound_ctrl:0
    v_add_f32_dpp v129, v161, v129 row_shr:8 row_mask:0xf bank_mask:0xf bound_ctrl:0
    v_add_f32_dpp v130, v162, v130 row_shr:8 row_mask:0xf bank_mask:0xf bound_ctrl:0
    v_add_f32_dpp v131, v163, v131 row_shr:8 row_mask:0xf bank_mask:0xf bound_ctrl:0
    v_add_f32_dpp v132, v164, v132 row_shr:8 row_mask:0xf bank_mask:0xf bound_ctrl:0
    v_add_f32_dpp v133, v165, v133 row_shr:8 row_mask:0xf bank_mask:0xf bound_ctrl:0
    v_add_f32_dpp v134, v166, v134 row_shr:8 row_mask:0xf bank_mask:0xf bound_ctrl:0
    v_add_f32_dpp v135, v167, v135 row_shr:8 row_mask:0xf bank_mask:0xf bound_ctrl:0
    v_add_f32_dpp v136, v168, v136 row_shr:8 row_mask:0xf bank_mask:0xf bound_ctrl:0
    v_add_f32_dpp v137, v169, v137 row_shr:8 row_mask:0xf bank_mask:0xf bound_ctrl:0
    v_add_f32_dpp v138, v170, v138 row_shr:8 row_mask:0xf bank_mask:0xf bound_ctrl:0
    v_add_f32_dpp v139, v171, v139 row_shr:8 row_mask:0xf bank_mask:0xf bound_ctrl:0
    v_add_f32_dpp v140, v172, v140 row_shr:8 row_mask:0xf bank_mask:0xf bound_ctrl:0
    v_add_f32_dpp v141, v173, v141 row_shr:8 row_mask:0xf bank_mask:0xf bound_ctrl:0
    v_add_f32_dpp v142, v174, v142 row_shr:8 row_mask:0xf bank_mask:0xf bound_ctrl:0
    v_add_f32_dpp v143, v175, v143 row_shr:8 row_mask:0xf bank_mask:0xf bound_ctrl:0
    s_mov_b32 s42, 0xff00ff00
    s_mov_b32 s43, 0xff00ff00
    s_mov_b64 exec, s[42:43]
    v_add_f32 v144, v160, v144
    v_add_f32 v145, v161, v145
    v_add_f32 v146, v162, v146
    v_add_f32 v147, v163, v147
    v_add_f32 v148, v164, v148
    v_add_f32 v149, v165, v149
    v_add_f32 v150, v166, v150
    v_add_f32 v151, v167, v151
    v_add_f32 v152, v168, v152
    v_add_f32 v153, v169, v153
    v_add_f32 v154, v170, v154
    v_add_f32 v155, v171, v155
    v_add_f32 v156, v172, v156
    v_add_f32 v157, v173, v157
    v_add_f32 v158, v174, v158
    v_add_f32 v159, v175, v159
    s_mov_b64 exec, -1
    v_fma_f32 v128, v80, s44, v128
    v_fma_f32 v144, v64, s44, v144
    v_fma_f32 v129, v81, s44, v129
    v_fma_f32 v145, v65, s44, v145
    v_fma_f32 v130, v82, s44, v130
    v_fma_f32 v146, v66, s44, v146
    v_fma_f32 v131, v83, s44, v131
    v_fma_f32 v147, v67, s44, v147
    v_fma_f32 v132, v84, s44, v132
    v_fma_f32 v148, v68, s44, v148
    v_fma_f32 v133, v85, s44, v133
    v_fma_f32 v149, v69, s44, v149
    v_fma_f32 v134, v86, s44, v134
    v_fma_f32 v150, v70, s44, v150
    v_fma_f32 v135, v87, s44, v135
    v_fma_f32 v151, v71, s44, v151
    v_fma_f32 v136, v88, s44, v136
    v_fma_f32 v152, v72, s44, v152
    v_fma_f32 v137, v89, s44, v137
    v_fma_f32 v153, v73, s44, v153
    v_fma_f32 v138, v90, s44, v138
    v_fma_f32 v154, v74, s44, v154
    v_fma_f32 v139, v91, s44, v139
    v_fma_f32 v155, v75, s44, v155
    v_fma_f32 v140, v92, s44, v140
    v_fma_f32 v156, v76, s44, v156
    v_fma_f32 v141, v93, s44, v141
    v_fma_f32 v157, v77, s44, v157
    v_fma_f32 v142, v94, s44, v142
    v_fma_f32 v158, v78, s44, v158
    v_fma_f32 v143, v95, s44, v143
    v_fma_f32 v159, v79, s44, v159
    v_cvt_pk_bf16_f32 v32, v128, v144
    v_cvt_pk_bf16_f32 v33, v129, v145
    v_cvt_pk_bf16_f32 v34, v130, v146
    v_cvt_pk_bf16_f32 v35, v131, v147
    v_cvt_pk_bf16_f32 v36, v132, v148
    v_cvt_pk_bf16_f32 v37, v133, v149
    v_cvt_pk_bf16_f32 v38, v134, v150
    v_cvt_pk_bf16_f32 v39, v135, v151
    v_cvt_pk_bf16_f32 v40, v136, v152
    v_cvt_pk_bf16_f32 v41, v137, v153
    v_cvt_pk_bf16_f32 v42, v138, v154
    v_cvt_pk_bf16_f32 v43, v139, v155
    v_cvt_pk_bf16_f32 v44, v140, v156
    v_cvt_pk_bf16_f32 v45, v141, v157
    v_cvt_pk_bf16_f32 v46, v142, v158
    v_cvt_pk_bf16_f32 v47, v143, v159
    ds_write_b32 v18, v32 offset:0
    ds_write_b32 v18, v33 offset:8
    ds_write_b32 v18, v34 offset:16
    ds_write_b32 v18, v35 offset:24
    ds_write_b32 v18, v36 offset:64
    ds_write_b32 v18, v37 offset:72
    ds_write_b32 v18, v38 offset:80
    ds_write_b32 v18, v39 offset:88
    ds_write_b32 v18, v40 offset:128
    ds_write_b32 v18, v41 offset:136
    ds_write_b32 v18, v42 offset:144
    ds_write_b32 v18, v43 offset:152
    ds_write_b32 v18, v44 offset:192
    ds_write_b32 v18, v45 offset:200
    ds_write_b32 v18, v46 offset:208
    ds_write_b32 v18, v47 offset:216
    s_waitcnt lgkmcnt(0)
    s_barrier
    ds_read_b32 v48, v17 offset:0
    ds_read_b32 v49, v17 offset:9472
    ds_read_b32 v50, v17 offset:18944
    ds_read_b32 v51, v17 offset:28416
    ds_read_b32 v52, v17 offset:1056
    ds_read_b32 v53, v17 offset:10528
    ds_read_b32 v54, v17 offset:20000
    ds_read_b32 v55, v17 offset:29472
    ds_read_b32 v56, v17 offset:2112
    ds_read_b32 v57, v17 offset:11584
    ds_read_b32 v58, v17 offset:21056
    ds_read_b32 v59, v17 offset:30528
    ds_read_b32 v60, v17 offset:3168
    ds_read_b32 v61, v17 offset:12640
    ds_read_b32 v62, v17 offset:22112
    ds_read_b32 v63, v17 offset:31584
    s_waitcnt lgkmcnt(0)
    v_perm_b32 v96, v49, v48, s48
    v_perm_b32 v98, v49, v48, s49
    v_perm_b32 v97, v51, v50, s48
    v_perm_b32 v99, v51, v50, s49
    v_perm_b32 v100, v53, v52, s48
    v_perm_b32 v102, v53, v52, s49
    v_perm_b32 v101, v55, v54, s48
    v_perm_b32 v103, v55, v54, s49
    v_perm_b32 v104, v57, v56, s48
    v_perm_b32 v106, v57, v56, s49
    v_perm_b32 v105, v59, v58, s48
    v_perm_b32 v107, v59, v58, s49
    v_perm_b32 v108, v61, v60, s48
    v_perm_b32 v110, v61, v60, s49
    v_perm_b32 v109, v63, v62, s48
    v_perm_b32 v111, v63, v62, s49
    v_lshrrev_b32 v20, 3, v0
    v_lshrrev_b32 v21, 4, v20
    v_and_b32 v22, 15, v20
    v_mul_u32_u24 v23, 20480, v20
    v_sub_u32 v23, v4, v23
    s_mov_b32 s40, 1601536
    v_mul_lo_u32 v24, v21, s40
    v_add_u32 v24, v24, v23
    v_add_u32 v25, 1, v22
    v_mul_u32_u24 v25, 20480, v25
    v_add_u32 v25, v25, v24
    v_cmp_eq_u32 s[42:43], 15, v22
    v_cmp_eq_u32 s[44:45], 0, v22
    v_add_u32 v26, 3203072, v24
    v_add_u32 v27, 348160, v24
    v_cndmask_b32 v26, v27, v26, s[42:43]
    v_cmp_ne_u32 vcc, 0, v20
    s_and_b64 s[46:47], s[44:45], vcc
    s_or_b64 s[46:47], s[46:47], s[42:43]
    v_cmp_ne_u32 vcc, 31, v20
    s_and_b64 s[52:53], s[42:43], vcc
    s_or_b64 s[52:53], s[52:53], s[44:45]
    s_or_b64 s[44:45], s[44:45], s[42:43]
    s_add_u32 s39, s38, 9060352
    buffer_store_dwordx4 v[96:99], v25, s[28:31], s39 offen sc1
    s_mov_b64 exec, s[46:47]
    s_cbranch_execz k1_kernel_halo9
    s_sub_u32 s41, s39, 1601536
    buffer_store_dwordx4 v[96:99], v26, s[28:31], s41 offen sc1
k1_kernel_halo9:
    s_mov_b64 exec, -1
    s_add_u32 s39, s39, 3203072
    buffer_store_dwordx4 v[100:103], v25, s[28:31], s39 offen sc1
    s_mov_b64 exec, s[44:45]
    s_cbranch_execz k1_kernel_halo10
    s_sub_u32 s41, s39, 1601536
    buffer_store_dwordx4 v[100:103], v26, s[28:31], s41 offen sc1
k1_kernel_halo10:
    s_mov_b64 exec, -1
    s_add_u32 s39, s39, 3203072
    buffer_store_dwordx4 v[104:107], v25, s[28:31], s39 offen sc1
    s_mov_b64 exec, s[44:45]
    s_cbranch_execz k1_kernel_halo11
    s_sub_u32 s41, s39, 1601536
    buffer_store_dwordx4 v[104:107], v26, s[28:31], s41 offen sc1
k1_kernel_halo11:
    s_mov_b64 exec, -1
    s_add_u32 s39, s39, 3203072
    buffer_store_dwordx4 v[108:111], v25, s[28:31], s39 offen sc1
    s_mov_b64 exec, s[52:53]
    s_cbranch_execz k1_kernel_halo12
    s_sub_u32 s41, s39, 1601536
    buffer_store_dwordx4 v[108:111], v26, s[28:31], s41 offen sc1
k1_kernel_halo12:
    s_mov_b64 exec, -1
    s_add_u32 s39, s39, 3203072
    s_waitcnt vmcnt(0)
    s_endpgm
k1_side:
    s_cmp_ge_u32 s54, 188
    s_cbranch_scc1 k1_end
    s_cmp_lt_u32 s54, 128
    s_cbranch_scc1 k1_kernel_sx13
    s_mov_b32 s61, s54
    s_cmp_lg_u32 s20, 0
    s_cbranch_scc1 k1_kernel_sw15
    s_and_b32 s55, s2, 7
    s_lshl_b32 s57, s55, 9
    s_add_u32 s57, s57, 9056256
    v_mov_b32 v250, 0
    v_and_b32 v248, 31, v0
    v_lshlrev_b32 v248, 2, v248
    s_waitcnt lgkmcnt(0)
    s_mov_b32 s28, s10
    s_mov_b32 s29, s11
    s_mov_b32 s30, 268435456
    s_mov_b32 s31, 0x00020000
    buffer_load_dword v251, v250, s[28:31], s57 offen sc1
    s_mov_b32 s23, 1
    s_waitcnt vmcnt(0)
    v_add_u32 v251, 1, v251
k1_kernel_sw14:
    buffer_load_dword v249, v248, s[28:31], s57 offen offset:256 sc1
    s_waitcnt vmcnt(0)
    v_cmp_eq_u32 vcc, v251, v249
    s_sub_u32 s23, s23, 1
    s_cmp_eq_u64 vcc, -1
    s_cbranch_scc1 k1_kernel_sw15
    s_sleep 16
    s_cmp_lg_u32 s23, 0
    s_cbranch_scc1 k1_kernel_sw14
k1_kernel_sw15:
    s_barrier
    s_mov_b32 s54, s61
k1_kernel_sx13:
    s_cmp_lt_u32 s54, 128
    s_cbranch_scc1 k1_pf
    s_branch k1_mod0
k1_side2:
    s_load_dwordx2 s[10:11], s[0:1], 120
    s_load_dwordx8 s[12:19], s[0:1], 56
    v_lshrrev_b32 v2, 6, v0
    v_and_b32 v1, 63, v0
    v_readfirstlane_b32 s20, v2
    s_waitcnt lgkmcnt(0)
    s_mov_b32 s28, s10
    s_mov_b32 s29, s11
    s_mov_b32 s30, 268435456
    s_mov_b32 s31, 0x00020000
    s_sub_u32 s21, s54, 0
    v_lshrrev_b32 v3, 3, v0
    v_and_b32 v4, 7, v0
    v_mul_u32_u24 v5, 144, v3
    v_lshl_add_u32 v5, v4, 4, v5
    v_and_b32 v6, 15, v1
    v_lshrrev_b32 v7, 4, v1
    v_lshrrev_b32 v8, 2, v6
    v_lshl_add_u32 v8, v7, 3, v8
    v_mul_u32_u24 v8, 144, v8
    v_and_b32 v9, 3, v6
    v_lshl_add_u32 v8, v9, 3, v8
    s_lshl_b32 s22, s20, 5
    v_add_u32 v8, s22, v8
    v_lshlrev_b32 v9, 4, v1
    s_cmp_lt_u32 s21, 10
    s_cbranch_scc1 k1_kernel_pk16
    s_cmp_lt_u32 s21, 20
    s_cbranch_scc1 k1_kernel_pk17
    s_cmp_lt_u32 s21, 48
    s_cbranch_scc1 k1_kernel_pk18
    s_cmp_lt_u32 s21, 78
    s_cbranch_scc1 k1_kernel_pk19
    s_branch k1_kernel_pke20
k1_kernel_pk16:
    s_mov_b32 s24, s12
    s_mov_b32 s25, s13
    s_mov_b32 s26, 819200
    s_mov_b32 s27, 0x00020000
    s_sub_u32 s32, s21, 0
    s_mul_i32 s33, s32, 52429
    s_lshr_b32 s33, s33, 18
    s_mul_i32 s34, s33, 5
    s_sub_u32 s34, s32, s34
    s_lshl_b32 s34, s34, 1
    v_mul_u32_u24 v10, 1280, v3
    v_lshl_add_u32 v10, v4, 4, v10
    s_mul_i32 s35, s33, 409600
    s_lshl_b32 s36, s34, 7
    s_add_u32 s35, s35, s36
    buffer_load_dwordx4 v[32:35], v10, s[24:27], s35 offen offset:0
    s_add_u32 s35, s35, 40960
    buffer_load_dwordx4 v[36:39], v10, s[24:27], s35 offen offset:0
    s_add_u32 s35, s35, 40960
    buffer_load_dwordx4 v[40:43], v10, s[24:27], s35 offen offset:0
    s_add_u32 s35, s35, 40960
    buffer_load_dwordx4 v[44:47], v10, s[24:27], s35 offen offset:0
    s_add_u32 s35, s35, 40960
    buffer_load_dwordx4 v[48:51], v10, s[24:27], s35 offen offset:0
    s_add_u32 s35, s35, 40960
    buffer_load_dwordx4 v[52:55], v10, s[24:27], s35 offen offset:0
    s_add_u32 s35, s35, 40960
    buffer_load_dwordx4 v[56:59], v10, s[24:27], s35 offen offset:0
    s_add_u32 s35, s35, 40960
    buffer_load_dwordx4 v[60:63], v10, s[24:27], s35 offen offset:0
    s_add_u32 s35, s35, 40960
    buffer_load_dwordx4 v[64:67], v10, s[24:27], s35 offen offset:0
    s_add_u32 s35, s35, 40960
    buffer_load_dwordx4 v[68:71], v10, s[24:27], s35 offen offset:0
    s_sub_u32 s35, s35, 368640
    buffer_load_dwordx4 v[72:75], v10, s[24:27], s35 offen offset:128
    s_add_u32 s35, s35, 40960
    buffer_load_dwordx4 v[76:79], v10, s[24:27], s35 offen offset:128
    s_add_u32 s35, s35, 40960
    buffer_load_dwordx4 v[80:83], v10, s[24:27], s35 offen offset:128
    s_add_u32 s35, s35, 40960
    buffer_load_dwordx4 v[84:87], v10, s[24:27], s35 offen offset:128
    s_add_u32 s35, s35, 40960
    buffer_load_dwordx4 v[88:91], v10, s[24:27], s35 offen offset:128
    s_add_u32 s35, s35, 40960
    buffer_load_dwordx4 v[92:95], v10, s[24:27], s35 offen offset:128
    s_add_u32 s35, s35, 40960
    buffer_load_dwordx4 v[96:99], v10, s[24:27], s35 offen offset:128
    s_add_u32 s35, s35, 40960
    buffer_load_dwordx4 v[100:103], v10, s[24:27], s35 offen offset:128
    s_add_u32 s35, s35, 40960
    buffer_load_dwordx4 v[104:107], v10, s[24:27], s35 offen offset:128
    s_add_u32 s35, s35, 40960
    buffer_load_dwordx4 v[108:111], v10, s[24:27], s35 offen offset:128
    s_lshl_b32 s36, s34, 2
    s_add_u32 s36, s36, s20
    s_mul_i32 s38, s36, 52429
    s_lshr_b32 s38, s38, 18
    s_mul_i32 s39, s38, 5
    s_sub_u32 s39, s36, s39
    s_mul_i32 s37, s38, 100
    s_mul_i32 s40, s33, 50
    s_add_u32 s37, s37, s40
    s_add_u32 s37, s37, s39
    s_lshl_b32 s37, s37, 10
    s_add_u32 s37, s37, 2764800
    s_waitcnt vmcnt(19)
    ds_write_b128 v5, v[32:35] offset:0
    s_waitcnt vmcnt(18)
    ds_write_b128 v5, v[36:39] offset:4608
    s_waitcnt vmcnt(17)
    ds_write_b128 v5, v[40:43] offset:9216
    s_waitcnt vmcnt(16)
    ds_write_b128 v5, v[44:47] offset:13824
    s_waitcnt vmcnt(15)
    ds_write_b128 v5, v[48:51] offset:18432
    s_waitcnt vmcnt(14)
    ds_write_b128 v5, v[52:55] offset:23040
    s_waitcnt vmcnt(13)
    ds_write_b128 v5, v[56:59] offset:27648
    s_waitcnt vmcnt(12)
    ds_write_b128 v5, v[60:63] offset:32256
    s_waitcnt vmcnt(11)
    ds_write_b128 v5, v[64:67] offset:36864
    s_waitcnt vmcnt(10)
    ds_write_b128 v5, v[68:71] offset:41472
    s_waitcnt lgkmcnt(0)
    s_barrier
    ds_read_b64_tr_b16 v[32:33], v8 offset:0
    ds_read_b64_tr_b16 v[34:35], v8 offset:576
    ds_read_b64_tr_b16 v[36:37], v8 offset:4608
    ds_read_b64_tr_b16 v[38:39], v8 offset:5184
    ds_read_b64_tr_b16 v[40:41], v8 offset:9216
    ds_read_b64_tr_b16 v[42:43], v8 offset:9792
    ds_read_b64_tr_b16 v[44:45], v8 offset:13824
    ds_read_b64_tr_b16 v[46:47], v8 offset:14400
    ds_read_b64_tr_b16 v[48:49], v8 offset:18432
    ds_read_b64_tr_b16 v[50:51], v8 offset:19008
    ds_read_b64_tr_b16 v[52:53], v8 offset:23040
    ds_read_b64_tr_b16 v[54:55], v8 offset:23616
    ds_read_b64_tr_b16 v[56:57], v8 offset:27648
    ds_read_b64_tr_b16 v[58:59], v8 offset:28224
    ds_read_b64_tr_b16 v[60:61], v8 offset:32256
    ds_read_b64_tr_b16 v[62:63], v8 offset:32832
    ds_read_b64_tr_b16 v[64:65], v8 offset:36864
    ds_read_b64_tr_b16 v[66:67], v8 offset:37440
    ds_read_b64_tr_b16 v[68:69], v8 offset:41472
    ds_read_b64_tr_b16 v[70:71], v8 offset:42048
    v_mov_b32 v12, 0
    v_mov_b32 v13, 0x3f803f80
    s_waitcnt lgkmcnt(15)
    s_add_u32 s38, s37, 0
    buffer_store_dwordx4 v[32:35], v9, s[28:31], s38 offen sc1
    v_dot2_f32_bf16 v12, v32, v13, v12
    v_dot2_f32_bf16 v12, v33, v13, v12
    v_dot2_f32_bf16 v12, v34, v13, v12
    v_dot2_f32_bf16 v12, v35, v13, v12
    s_waitcnt lgkmcnt(15)
    s_add_u32 s38, s37, 5120
    buffer_store_dwordx4 v[36:39], v9, s[28:31], s38 offen sc1
    v_dot2_f32_bf16 v12, v36, v13, v12
    v_dot2_f32_bf16 v12, v37, v13, v12
    v_dot2_f32_bf16 v12, v38, v13, v12
    v_dot2_f32_bf16 v12, v39, v13, v12
    s_waitcnt lgkmcnt(14)
    s_add_u32 s38, s37, 10240
    buffer_store_dwordx4 v[40:43], v9, s[28:31], s38 offen sc1
    v_dot2_f32_bf16 v12, v40, v13, v12
    v_dot2_f32_bf16 v12, v41, v13, v12
    v_dot2_f32_bf16 v12, v42, v13, v12
    v_dot2_f32_bf16 v12, v43, v13, v12
    s_waitcnt lgkmcnt(12)
    s_add_u32 s38, s37, 15360
    buffer_store_dwordx4 v[44:47], v9, s[28:31], s38 offen sc1
    v_dot2_f32_bf16 v12, v44, v13, v12
    v_dot2_f32_bf16 v12, v45, v13, v12
    v_dot2_f32_bf16 v12, v46, v13, v12
    v_dot2_f32_bf16 v12, v47, v13, v12
    s_waitcnt lgkmcnt(10)
    s_add_u32 s38, s37, 20480
    buffer_store_dwordx4 v[48:51], v9, s[28:31], s38 offen sc1
    v_dot2_f32_bf16 v12, v48, v13, v12
    v_dot2_f32_bf16 v12, v49, v13, v12
    v_dot2_f32_bf16 v12, v50, v13, v12
    v_dot2_f32_bf16 v12, v51, v13, v12
    s_waitcnt lgkmcnt(8)
    s_add_u32 s38, s37, 25600
    buffer_store_dwordx4 v[52:55], v9, s[28:31], s38 offen sc1
    v_dot2_f32_bf16 v12, v52, v13, v12
    v_dot2_f32_bf16 v12, v53, v13, v12
    v_dot2_f32_bf16 v12, v54, v13, v12
    v_dot2_f32_bf16 v12, v55, v13, v12
    s_waitcnt lgkmcnt(6)
    s_add_u32 s38, s37, 30720
    buffer_store_dwordx4 v[56:59], v9, s[28:31], s38 offen sc1
    v_dot2_f32_bf16 v12, v56, v13, v12
    v_dot2_f32_bf16 v12, v57, v13, v12
    v_dot2_f32_bf16 v12, v58, v13, v12
    v_dot2_f32_bf16 v12, v59, v13, v12
    s_waitcnt lgkmcnt(4)
    s_add_u32 s38, s37, 35840
    buffer_store_dwordx4 v[60:63], v9, s[28:31], s38 offen sc1
    v_dot2_f32_bf16 v12, v60, v13, v12
    v_dot2_f32_bf16 v12, v61, v13, v12
    v_dot2_f32_bf16 v12, v62, v13, v12
    v_dot2_f32_bf16 v12, v63, v13, v12
    s_waitcnt lgkmcnt(2)
    s_add_u32 s38, s37, 40960
    buffer_store_dwordx4 v[64:67], v9, s[28:31], s38 offen sc1
    v_dot2_f32_bf16 v12, v64, v13, v12
    v_dot2_f32_bf16 v12, v65, v13, v12
    v_dot2_f32_bf16 v12, v66, v13, v12
    v_dot2_f32_bf16 v12, v67, v13, v12
    s_waitcnt lgkmcnt(0)
    s_add_u32 s38, s37, 46080
    buffer_store_dwordx4 v[68:71], v9, s[28:31], s38 offen sc1
    v_dot2_f32_bf16 v12, v68, v13, v12
    v_dot2_f32_bf16 v12, v69, v13, v12
    v_dot2_f32_bf16 v12, v70, v13, v12
    v_dot2_f32_bf16 v12, v71, v13, v12
    s_nop 2
    v_mov_b32 v13, v12
    s_nop 1
    v_permlane32_swap_b32 v13, v12
    v_add_f32 v12, v12, v13
    v_mov_b32 v13, v12
    s_nop 1
    v_permlane16_swap_b32 v13, v12
    v_add_f32 v12, v12, v13
    s_mul_i32 s38, s33, 7168
    s_lshl_b32 s39, s36, 6
    s_add_u32 s38, s38, s39
    s_add_u32 s38, s38, 2748416
    v_lshlrev_b32 v14, 2, v1
    v_cmp_gt_u32 vcc, 16, v1
    s_and_saveexec_b64 s[40:41], vcc
    buffer_store_dword v12, v14, s[28:31], s38 offen sc1
    s_mov_b64 exec, -1
    s_add_u32 s34, s34, 1
    s_barrier
    s_lshl_b32 s36, s34, 2
    s_add_u32 s36, s36, s20
    s_mul_i32 s38, s36, 52429
    s_lshr_b32 s38, s38, 18
    s_mul_i32 s39, s38, 5
    s_sub_u32 s39, s36, s39
    s_mul_i32 s37, s38, 100
    s_mul_i32 s40, s33, 50
    s_add_u32 s37, s37, s40
    s_add_u32 s37, s37, s39
    s_lshl_b32 s37, s37, 10
    s_add_u32 s37, s37, 2764800
    s_waitcnt vmcnt(20)
    ds_write_b128 v5, v[72:75] offset:0
    s_waitcnt vmcnt(19)
    ds_write_b128 v5, v[76:79] offset:4608
    s_waitcnt vmcnt(18)
    ds_write_b128 v5, v[80:83] offset:9216
    s_waitcnt vmcnt(17)
    ds_write_b128 v5, v[84:87] offset:13824
    s_waitcnt vmcnt(16)
    ds_write_b128 v5, v[88:91] offset:18432
    s_waitcnt vmcnt(15)
    ds_write_b128 v5, v[92:95] offset:23040
    s_waitcnt vmcnt(14)
    ds_write_b128 v5, v[96:99] offset:27648
    s_waitcnt vmcnt(13)
    ds_write_b128 v5, v[100:103] offset:32256
    s_waitcnt vmcnt(12)
    ds_write_b128 v5, v[104:107] offset:36864
    s_waitcnt vmcnt(11)
    ds_write_b128 v5, v[108:111] offset:41472
    s_waitcnt lgkmcnt(0)
    s_barrier
    ds_read_b64_tr_b16 v[72:73], v8 offset:0
    ds_read_b64_tr_b16 v[74:75], v8 offset:576
    ds_read_b64_tr_b16 v[76:77], v8 offset:4608
    ds_read_b64_tr_b16 v[78:79], v8 offset:5184
    ds_read_b64_tr_b16 v[80:81], v8 offset:9216
    ds_read_b64_tr_b16 v[82:83], v8 offset:9792
    ds_read_b64_tr_b16 v[84:85], v8 offset:13824
    ds_read_b64_tr_b16 v[86:87], v8 offset:14400
    ds_read_b64_tr_b16 v[88:89], v8 offset:18432
    ds_read_b64_tr_b16 v[90:91], v8 offset:19008
    ds_read_b64_tr_b16 v[92:93], v8 offset:23040
    ds_read_b64_tr_b16 v[94:95], v8 offset:23616
    ds_read_b64_tr_b16 v[96:97], v8 offset:27648
    ds_read_b64_tr_b16 v[98:99], v8 offset:28224
    ds_read_b64_tr_b16 v[100:101], v8 offset:32256
    ds_read_b64_tr_b16 v[102:103], v8 offset:32832
    ds_read_b64_tr_b16 v[104:105], v8 offset:36864
    ds_read_b64_tr_b16 v[106:107], v8 offset:37440
    ds_read_b64_tr_b16 v[108:109], v8 offset:41472
    ds_read_b64_tr_b16 v[110:111], v8 offset:42048
    v_mov_b32 v12, 0
    v_mov_b32 v13, 0x3f803f80
    s_waitcnt lgkmcnt(15)
    s_add_u32 s38, s37, 0
    buffer_store_dwordx4 v[72:75], v9, s[28:31], s38 offen sc1
    v_dot2_f32_bf16 v12, v72, v13, v12
    v_dot2_f32_bf16 v12, v73, v13, v12
    v_dot2_f32_bf16 v12, v74, v13, v12
    v_dot2_f32_bf16 v12, v75, v13, v12
    s_waitcnt lgkmcnt(15)
    s_add_u32 s38, s37, 5120
    buffer_store_dwordx4 v[76:79], v9, s[28:31], s38 offen sc1
    v_dot2_f32_bf16 v12, v76, v13, v12
    v_dot2_f32_bf16 v12, v77, v13, v12
    v_dot2_f32_bf16 v12, v78, v13, v12
    v_dot2_f32_bf16 v12, v79, v13, v12
    s_waitcnt lgkmcnt(14)
    s_add_u32 s38, s37, 10240
    buffer_store_dwordx4 v[80:83], v9, s[28:31], s38 offen sc1
    v_dot2_f32_bf16 v12, v80, v13, v12
    v_dot2_f32_bf16 v12, v81, v13, v12
    v_dot2_f32_bf16 v12, v82, v13, v12
    v_dot2_f32_bf16 v12, v83, v13, v12
    s_waitcnt lgkmcnt(12)
    s_add_u32 s38, s37, 15360
    buffer_store_dwordx4 v[84:87], v9, s[28:31], s38 offen sc1
    v_dot2_f32_bf16 v12, v84, v13, v12
    v_dot2_f32_bf16 v12, v85, v13, v12
    v_dot2_f32_bf16 v12, v86, v13, v12
    v_dot2_f32_bf16 v12, v87, v13, v12
    s_waitcnt lgkmcnt(10)
    s_add_u32 s38, s37, 20480
    buffer_store_dwordx4 v[88:91], v9, s[28:31], s38 offen sc1
    v_dot2_f32_bf16 v12, v88, v13, v12
    v_dot2_f32_bf16 v12, v89, v13, v12
    v_dot2_f32_bf16 v12, v90, v13, v12
    v_dot2_f32_bf16 v12, v91, v13, v12
    s_waitcnt lgkmcnt(8)
    s_add_u32 s38, s37, 25600
    buffer_store_dwordx4 v[92:95], v9, s[28:31], s38 offen sc1
    v_dot2_f32_bf16 v12, v92, v13, v12
    v_dot2_f32_bf16 v12, v93, v13, v12
    v_dot2_f32_bf16 v12, v94, v13, v12
    v_dot2_f32_bf16 v12, v95, v13, v12
    s_waitcnt lgkmcnt(6)
    s_add_u32 s38, s37, 30720
    buffer_store_dwordx4 v[96:99], v9, s[28:31], s38 offen sc1
    v_dot2_f32_bf16 v12, v96, v13, v12
    v_dot2_f32_bf16 v12, v97, v13, v12
    v_dot2_f32_bf16 v12, v98, v13, v12
    v_dot2_f32_bf16 v12, v99, v13, v12
    s_waitcnt lgkmcnt(4)
    s_add_u32 s38, s37, 35840
    buffer_store_dwordx4 v[100:103], v9, s[28:31], s38 offen sc1
    v_dot2_f32_bf16 v12, v100, v13, v12
    v_dot2_f32_bf16 v12, v101, v13, v12
    v_dot2_f32_bf16 v12, v102, v13, v12
    v_dot2_f32_bf16 v12, v103, v13, v12
    s_waitcnt lgkmcnt(2)
    s_add_u32 s38, s37, 40960
    buffer_store_dwordx4 v[104:107], v9, s[28:31], s38 offen sc1
    v_dot2_f32_bf16 v12, v104, v13, v12
    v_dot2_f32_bf16 v12, v105, v13, v12
    v_dot2_f32_bf16 v12, v106, v13, v12
    v_dot2_f32_bf16 v12, v107, v13, v12
    s_waitcnt lgkmcnt(0)
    s_add_u32 s38, s37, 46080
    buffer_store_dwordx4 v[108:111], v9, s[28:31], s38 offen sc1
    v_dot2_f32_bf16 v12, v108, v13, v12
    v_dot2_f32_bf16 v12, v109, v13, v12
    v_dot2_f32_bf16 v12, v110, v13, v12
    v_dot2_f32_bf16 v12, v111, v13, v12
    s_nop 2
    v_mov_b32 v13, v12
    s_nop 1
    v_permlane32_swap_b32 v13, v12
    v_add_f32 v12, v12, v13
    v_mov_b32 v13, v12
    s_nop 1
    v_permlane16_swap_b32 v13, v12
    v_add_f32 v12, v12, v13
    s_mul_i32 s38, s33, 7168
    s_lshl_b32 s39, s36, 6
    s_add_u32 s38, s38, s39
    s_add_u32 s38, s38, 2748416
    v_lshlrev_b32 v14, 2, v1
    v_cmp_gt_u32 vcc, 16, v1
    s_and_saveexec_b64 s[40:41], vcc
    buffer_store_dword v12, v14, s[28:31], s38 offen sc1
    s_mov_b64 exec, -1
    s_endpgm
k1_kernel_pk17:
    s_mov_b32 s24, s14
    s_mov_b32 s25, s15
    s_mov_b32 s26, 819200
    s_mov_b32 s27, 0x00020000
    s_sub_u32 s32, s21, 10
    s_mul_i32 s33, s32, 52429
    s_lshr_b32 s33, s33, 18
    s_mul_i32 s34, s33, 5
    s_sub_u32 s34, s32, s34
    s_lshl_b32 s34, s34, 1
    v_mul_u32_u24 v10, 1280, v3
    v_lshl_add_u32 v10, v4, 4, v10
    s_mul_i32 s35, s33, 409600
    s_lshl_b32 s36, s34, 7
    s_add_u32 s35, s35, s36
    buffer_load_dwordx4 v[32:35], v10, s[24:27], s35 offen offset:0
    s_add_u32 s35, s35, 40960
    buffer_load_dwordx4 v[36:39], v10, s[24:27], s35 offen offset:0
    s_add_u32 s35, s35, 40960
    buffer_load_dwordx4 v[40:43], v10, s[24:27], s35 offen offset:0
    s_add_u32 s35, s35, 40960
    buffer_load_dwordx4 v[44:47], v10, s[24:27], s35 offen offset:0
    s_add_u32 s35, s35, 40960
    buffer_load_dwordx4 v[48:51], v10, s[24:27], s35 offen offset:0
    s_add_u32 s35, s35, 40960
    buffer_load_dwordx4 v[52:55], v10, s[24:27], s35 offen offset:0
    s_add_u32 s35, s35, 40960
    buffer_load_dwordx4 v[56:59], v10, s[24:27], s35 offen offset:0
    s_add_u32 s35, s35, 40960
    buffer_load_dwordx4 v[60:63], v10, s[24:27], s35 offen offset:0
    s_add_u32 s35, s35, 40960
    buffer_load_dwordx4 v[64:67], v10, s[24:27], s35 offen offset:0
    s_add_u32 s35, s35, 40960
    buffer_load_dwordx4 v[68:71], v10, s[24:27], s35 offen offset:0
    s_sub_u32 s35, s35, 368640
    buffer_load_dwordx4 v[72:75], v10, s[24:27], s35 offen offset:128
    s_add_u32 s35, s35, 40960
    buffer_load_dwordx4 v[76:79], v10, s[24:27], s35 offen offset:128
    s_add_u32 s35, s35, 40960
    buffer_load_dwordx4 v[80:83], v10, s[24:27], s35 offen offset:128
    s_add_u32 s35, s35, 40960
    buffer_load_dwordx4 v[84:87], v10, s[24:27], s35 offen offset:128
    s_add_u32 s35, s35, 40960
    buffer_load_dwordx4 v[88:91], v10, s[24:27], s35 offen offset:128
    s_add_u32 s35, s35, 40960
    buffer_load_dwordx4 v[92:95], v10, s[24:27], s35 offen offset:128
    s_add_u32 s35, s35, 40960
    buffer_load_dwordx4 v[96:99], v10, s[24:27], s35 offen offset:128
    s_add_u32 s35, s35, 40960
    buffer_load_dwordx4 v[100:103], v10, s[24:27], s35 offen offset:128
    s_add_u32 s35, s35, 40960
    buffer_load_dwordx4 v[104:107], v10, s[24:27], s35 offen offset:128
    s_add_u32 s35, s35, 40960
    buffer_load_dwordx4 v[108:111], v10, s[24:27], s35 offen offset:128
    s_lshl_b32 s36, s34, 2
    s_add_u32 s36, s36, s20
    s_mul_i32 s38, s36, 52429
    s_lshr_b32 s38, s38, 18
    s_mul_i32 s39, s38, 5
    s_sub_u32 s39, s36, s39
    s_mul_i32 s37, s38, 100
    s_mul_i32 s40, s33, 50
    s_add_u32 s37, s37, s40
    s_add_u32 s37, s37, s39
    s_lshl_b32 s37, s37, 10
    s_add_u32 s37, s37, 3584000
    s_waitcnt vmcnt(19)
    ds_write_b128 v5, v[32:35] offset:0
    s_waitcnt vmcnt(18)
    ds_write_b128 v5, v[36:39] offset:4608
    s_waitcnt vmcnt(17)
    ds_write_b128 v5, v[40:43] offset:9216
    s_waitcnt vmcnt(16)
    ds_write_b128 v5, v[44:47] offset:13824
    s_waitcnt vmcnt(15)
    ds_write_b128 v5, v[48:51] offset:18432
    s_waitcnt vmcnt(14)
    ds_write_b128 v5, v[52:55] offset:23040
    s_waitcnt vmcnt(13)
    ds_write_b128 v5, v[56:59] offset:27648
    s_waitcnt vmcnt(12)
    ds_write_b128 v5, v[60:63] offset:32256
    s_waitcnt vmcnt(11)
    ds_write_b128 v5, v[64:67] offset:36864
    s_waitcnt vmcnt(10)
    ds_write_b128 v5, v[68:71] offset:41472
    s_waitcnt lgkmcnt(0)
    s_barrier
    ds_read_b64_tr_b16 v[32:33], v8 offset:0
    ds_read_b64_tr_b16 v[34:35], v8 offset:576
    ds_read_b64_tr_b16 v[36:37], v8 offset:4608
    ds_read_b64_tr_b16 v[38:39], v8 offset:5184
    ds_read_b64_tr_b16 v[40:41], v8 offset:9216
    ds_read_b64_tr_b16 v[42:43], v8 offset:9792
    ds_read_b64_tr_b16 v[44:45], v8 offset:13824
    ds_read_b64_tr_b16 v[46:47], v8 offset:14400
    ds_read_b64_tr_b16 v[48:49], v8 offset:18432
    ds_read_b64_tr_b16 v[50:51], v8 offset:19008
    ds_read_b64_tr_b16 v[52:53], v8 offset:23040
    ds_read_b64_tr_b16 v[54:55], v8 offset:23616
    ds_read_b64_tr_b16 v[56:57], v8 offset:27648
    ds_read_b64_tr_b16 v[58:59], v8 offset:28224
    ds_read_b64_tr_b16 v[60:61], v8 offset:32256
    ds_read_b64_tr_b16 v[62:63], v8 offset:32832
    ds_read_b64_tr_b16 v[64:65], v8 offset:36864
    ds_read_b64_tr_b16 v[66:67], v8 offset:37440
    ds_read_b64_tr_b16 v[68:69], v8 offset:41472
    ds_read_b64_tr_b16 v[70:71], v8 offset:42048
    s_waitcnt lgkmcnt(15)
    s_add_u32 s38, s37, 0
    buffer_store_dwordx4 v[32:35], v9, s[28:31], s38 offen sc1
    s_waitcnt lgkmcnt(15)
    s_add_u32 s38, s37, 5120
    buffer_store_dwordx4 v[36:39], v9, s[28:31], s38 offen sc1
    s_waitcnt lgkmcnt(14)
    s_add_u32 s38, s37, 10240
    buffer_store_dwordx4 v[40:43], v9, s[28:31], s38 offen sc1
    s_waitcnt lgkmcnt(12)
    s_add_u32 s38, s37, 15360
    buffer_store_dwordx4 v[44:47], v9, s[28:31], s38 offen sc1
    s_waitcnt lgkmcnt(10)
    s_add_u32 s38, s37, 20480
    buffer_store_dwordx4 v[48:51], v9, s[28:31], s38 offen sc1
    s_waitcnt lgkmcnt(8)
    s_add_u32 s38, s37, 25600
    buffer_store_dwordx4 v[52:55], v9, s[28:31], s38 offen sc1
    s_waitcnt lgkmcnt(6)
    s_add_u32 s38, s37, 30720
    buffer_store_dwordx4 v[56:59], v9, s[28:31], s38 offen sc1
    s_waitcnt lgkmcnt(4)
    s_add_u32 s38, s37, 35840
    buffer_store_dwordx4 v[60:63], v9, s[28:31], s38 offen sc1
    s_waitcnt lgkmcnt(2)
    s_add_u32 s38, s37, 40960
    buffer_store_dwordx4 v[64:67], v9, s[28:31], s38 offen sc1
    s_waitcnt lgkmcnt(0)
    s_add_u32 s38, s37, 46080
    buffer_store_dwordx4 v[68:71], v9, s[28:31], s38 offen sc1
    s_add_u32 s34, s34, 1
    s_barrier
    s_lshl_b32 s36, s34, 2
    s_add_u32 s36, s36, s20
    s_mul_i32 s38, s36, 52429
    s_lshr_b32 s38, s38, 18
    s_mul_i32 s39, s38, 5
    s_sub_u32 s39, s36, s39
    s_mul_i32 s37, s38, 100
    s_mul_i32 s40, s33, 50
    s_add_u32 s37, s37, s40
    s_add_u32 s37, s37, s39
    s_lshl_b32 s37, s37, 10
    s_add_u32 s37, s37, 3584000
    s_waitcnt vmcnt(19)
    ds_write_b128 v5, v[72:75] offset:0
    s_waitcnt vmcnt(18)
    ds_write_b128 v5, v[76:79] offset:4608
    s_waitcnt vmcnt(17)
    ds_write_b128 v5, v[80:83] offset:9216
    s_waitcnt vmcnt(16)
    ds_write_b128 v5, v[84:87] offset:13824
    s_waitcnt vmcnt(15)
    ds_write_b128 v5, v[88:91] offset:18432
    s_waitcnt vmcnt(14)
    ds_write_b128 v5, v[92:95] offset:23040
    s_waitcnt vmcnt(13)
    ds_write_b128 v5, v[96:99] offset:27648
    s_waitcnt vmcnt(12)
    ds_write_b128 v5, v[100:103] offset:32256
    s_waitcnt vmcnt(11)
    ds_write_b128 v5, v[104:107] offset:36864
    s_waitcnt vmcnt(10)
    ds_write_b128 v5, v[108:111] offset:41472
    s_waitcnt lgkmcnt(0)
    s_barrier
    ds_read_b64_tr_b16 v[72:73], v8 offset:0
    ds_read_b64_tr_b16 v[74:75], v8 offset:576
    ds_read_b64_tr_b16 v[76:77], v8 offset:4608
    ds_read_b64_tr_b16 v[78:79], v8 offset:5184
    ds_read_b64_tr_b16 v[80:81], v8 offset:9216
    ds_read_b64_tr_b16 v[82:83], v8 offset:9792
    ds_read_b64_tr_b16 v[84:85], v8 offset:13824
    ds_read_b64_tr_b16 v[86:87], v8 offset:14400
    ds_read_b64_tr_b16 v[88:89], v8 offset:18432
    ds_read_b64_tr_b16 v[90:91], v8 offset:19008
    ds_read_b64_tr_b16 v[92:93], v8 offset:23040
    ds_read_b64_tr_b16 v[94:95], v8 offset:23616
    ds_read_b64_tr_b16 v[96:97], v8 offset:27648
    ds_read_b64_tr_b16 v[98:99], v8 offset:28224
    ds_read_b64_tr_b16 v[100:101], v8 offset:32256
    ds_read_b64_tr_b16 v[102:103], v8 offset:32832
    ds_read_b64_tr_b16 v[104:105], v8 offset:36864
    ds_read_b64_tr_b16 v[106:107], v8 offset:37440
    ds_read_b64_tr_b16 v[108:109], v8 offset:41472
    ds_read_b64_tr_b16 v[110:111], v8 offset:42048
    s_waitcnt lgkmcnt(15)
    s_add_u32 s38, s37, 0
    buffer_store_dwordx4 v[72:75], v9, s[28:31], s38 offen sc1
    s_waitcnt lgkmcnt(15)
    s_add_u32 s38, s37, 5120
    buffer_store_dwordx4 v[76:79], v9, s[28:31], s38 offen sc1
    s_waitcnt lgkmcnt(14)
    s_add_u32 s38, s37, 10240
    buffer_store_dwordx4 v[80:83], v9, s[28:31], s38 offen sc1
    s_waitcnt lgkmcnt(12)
    s_add_u32 s38, s37, 15360
    buffer_store_dwordx4 v[84:87], v9, s[28:31], s38 offen sc1
    s_waitcnt lgkmcnt(10)
    s_add_u32 s38, s37, 20480
    buffer_store_dwordx4 v[88:91], v9, s[28:31], s38 offen sc1
    s_waitcnt lgkmcnt(8)
    s_add_u32 s38, s37, 25600
    buffer_store_dwordx4 v[92:95], v9, s[28:31], s38 offen sc1
    s_waitcnt lgkmcnt(6)
    s_add_u32 s38, s37, 30720
    buffer_store_dwordx4 v[96:99], v9, s[28:31], s38 offen sc1
    s_waitcnt lgkmcnt(4)
    s_add_u32 s38, s37, 35840
    buffer_store_dwordx4 v[100:103], v9, s[28:31], s38 offen sc1
    s_waitcnt lgkmcnt(2)
    s_add_u32 s38, s37, 40960
    buffer_store_dwordx4 v[104:107], v9, s[28:31], s38 offen sc1
    s_waitcnt lgkmcnt(0)
    s_add_u32 s38, s37, 46080
    buffer_store_dwordx4 v[108:111], v9, s[28:31], s38 offen sc1
    s_endpgm
k1_kernel_pk18:
    s_mov_b32 s24, s16
    s_mov_b32 s25, s17
    s_mov_b32 s26, 2211840
    s_mov_b32 s27, 0x00020000
    s_sub_u32 s32, s21, 20
    s_mul_i32 s33, s32, 4682
    s_lshr_b32 s33, s33, 16
    s_mul_i32 s34, s33, 14
    s_sub_u32 s34, s32, s34
    s_lshl_b32 s34, s34, 1
    v_mul_u32_u24 v10, 3456, v3
    v_lshl_add_u32 v10, v4, 4, v10
    s_mul_i32 s35, s33, 1105920
    s_lshl_b32 s36, s34, 7
    s_add_u32 s35, s35, s36
    buffer_load_dwordx4 v[32:35], v10, s[24:27], s35 offen offset:0
    s_add_u32 s35, s35, 110592
    buffer_load_dwordx4 v[36:39], v10, s[24:27], s35 offen offset:0
    s_add_u32 s35, s35, 110592
    buffer_load_dwordx4 v[40:43], v10, s[24:27], s35 offen offset:0
    s_add_u32 s35, s35, 110592
    buffer_load_dwordx4 v[44:47], v10, s[24:27], s35 offen offset:0
    s_add_u32 s35, s35, 110592
    buffer_load_dwordx4 v[48:51], v10, s[24:27], s35 offen offset:0
    s_add_u32 s35, s35, 110592
    buffer_load_dwordx4 v[52:55], v10, s[24:27], s35 offen offset:0
    s_add_u32 s35, s35, 110592
    buffer_load_dwordx4 v[56:59], v10, s[24:27], s35 offen offset:0
    s_add_u32 s35, s35, 110592
    buffer_load_dwordx4 v[60:63], v10, s[24:27], s35 offen offset:0
    s_add_u32 s35, s35, 110592
    buffer_load_dwordx4 v[64:67], v10, s[24:27], s35 offen offset:0
    s_add_u32 s35, s35, 110592
    buffer_load_dwordx4 v[68:71], v10, s[24:27], s35 offen offset:0
    s_sub_u32 s35, s35, 995328
    buffer_load_dwordx4 v[72:75], v10, s[24:27], s35 offen offset:128
    s_add_u32 s35, s35, 110592
    buffer_load_dwordx4 v[76:79], v10, s[24:27], s35 offen offset:128
    s_add_u32 s35, s35, 110592
    buffer_load_dwordx4 v[80:83], v10, s[24:27], s35 offen offset:128
    s_add_u32 s35, s35, 110592
    buffer_load_dwordx4 v[84:87], v10, s[24:27], s35 offen offset:128
    s_add_u32 s35, s35, 110592
    buffer_load_dwordx4 v[88:91], v10, s[24:27], s35 offen offset:128
    s_add_u32 s35, s35, 110592
    buffer_load_dwordx4 v[92:95], v10, s[24:27], s35 offen offset:128
    s_add_u32 s35, s35, 110592
    buffer_load_dwordx4 v[96:99], v10, s[24:27], s35 offen offset:128
    s_add_u32 s35, s35, 110592
    buffer_load_dwordx4 v[100:103], v10, s[24:27], s35 offen offset:128
    s_add_u32 s35, s35, 110592
    buffer_load_dwordx4 v[104:107], v10, s[24:27], s35 offen offset:128
    s_add_u32 s35, s35, 110592
    buffer_load_dwordx4 v[108:111], v10, s[24:27], s35 offen offset:128
    s_lshl_b32 s36, s34, 2
    s_add_u32 s36, s36, s20
    s_mul_i32 s38, s36, 9363
    s_lshr_b32 s38, s38, 16
    s_mul_i32 s39, s38, 7
    s_sub_u32 s39, s36, s39
    s_mul_i32 s37, s38, 140
    s_mul_i32 s40, s33, 70
    s_add_u32 s37, s37, s40
    s_add_u32 s37, s37, s39
    s_lshl_b32 s37, s37, 10
    s_add_u32 s37, s37, 4403200
    s_waitcnt vmcnt(19)
    ds_write_b128 v5, v[32:35] offset:0
    s_waitcnt vmcnt(18)
    ds_write_b128 v5, v[36:39] offset:4608
    s_waitcnt vmcnt(17)
    ds_write_b128 v5, v[40:43] offset:9216
    s_waitcnt vmcnt(16)
    ds_write_b128 v5, v[44:47] offset:13824
    s_waitcnt vmcnt(15)
    ds_write_b128 v5, v[48:51] offset:18432
    s_waitcnt vmcnt(14)
    ds_write_b128 v5, v[52:55] offset:23040
    s_waitcnt vmcnt(13)
    ds_write_b128 v5, v[56:59] offset:27648
    s_waitcnt vmcnt(12)
    ds_write_b128 v5, v[60:63] offset:32256
    s_waitcnt vmcnt(11)
    ds_write_b128 v5, v[64:67] offset:36864
    s_waitcnt vmcnt(10)
    ds_write_b128 v5, v[68:71] offset:41472
    s_waitcnt lgkmcnt(0)
    s_barrier
    ds_read_b64_tr_b16 v[32:33], v8 offset:0
    ds_read_b64_tr_b16 v[34:35], v8 offset:576
    ds_read_b64_tr_b16 v[36:37], v8 offset:4608
    ds_read_b64_tr_b16 v[38:39], v8 offset:5184
    ds_read_b64_tr_b16 v[40:41], v8 offset:9216
    ds_read_b64_tr_b16 v[42:43], v8 offset:9792
    ds_read_b64_tr_b16 v[44:45], v8 offset:13824
    ds_read_b64_tr_b16 v[46:47], v8 offset:14400
    ds_read_b64_tr_b16 v[48:49], v8 offset:18432
    ds_read_b64_tr_b16 v[50:51], v8 offset:19008
    ds_read_b64_tr_b16 v[52:53], v8 offset:23040
    ds_read_b64_tr_b16 v[54:55], v8 offset:23616
    ds_read_b64_tr_b16 v[56:57], v8 offset:27648
    ds_read_b64_tr_b16 v[58:59], v8 offset:28224
    ds_read_b64_tr_b16 v[60:61], v8 offset:32256
    ds_read_b64_tr_b16 v[62:63], v8 offset:32832
    ds_read_b64_tr_b16 v[64:65], v8 offset:36864
    ds_read_b64_tr_b16 v[66:67], v8 offset:37440
    ds_read_b64_tr_b16 v[68:69], v8 offset:41472
    ds_read_b64_tr_b16 v[70:71], v8 offset:42048
    v_mov_b32 v12, 0
    v_mov_b32 v13, 0x3f803f80
    s_waitcnt lgkmcnt(15)
    s_add_u32 s38, s37, 0
    buffer_store_dwordx4 v[32:35], v9, s[28:31], s38 offen sc1
    v_dot2_f32_bf16 v12, v32, v13, v12
    v_dot2_f32_bf16 v12, v33, v13, v12
    v_dot2_f32_bf16 v12, v34, v13, v12
    v_dot2_f32_bf16 v12, v35, v13, v12
    s_waitcnt lgkmcnt(15)
    s_add_u32 s38, s37, 7168
    buffer_store_dwordx4 v[36:39], v9, s[28:31], s38 offen sc1
    v_dot2_f32_bf16 v12, v36, v13, v12
    v_dot2_f32_bf16 v12, v37, v13, v12
    v_dot2_f32_bf16 v12, v38, v13, v12
    v_dot2_f32_bf16 v12, v39, v13, v12
    s_waitcnt lgkmcnt(14)
    s_add_u32 s38, s37, 14336
    buffer_store_dwordx4 v[40:43], v9, s[28:31], s38 offen sc1
    v_dot2_f32_bf16 v12, v40, v13, v12
    v_dot2_f32_bf16 v12, v41, v13, v12
    v_dot2_f32_bf16 v12, v42, v13, v12
    v_dot2_f32_bf16 v12, v43, v13, v12
    s_waitcnt lgkmcnt(12)
    s_add_u32 s38, s37, 21504
    buffer_store_dwordx4 v[44:47], v9, s[28:31], s38 offen sc1
    v_dot2_f32_bf16 v12, v44, v13, v12
    v_dot2_f32_bf16 v12, v45, v13, v12
    v_dot2_f32_bf16 v12, v46, v13, v12
    v_dot2_f32_bf16 v12, v47, v13, v12
    s_waitcnt lgkmcnt(10)
    s_add_u32 s38, s37, 28672
    buffer_store_dwordx4 v[48:51], v9, s[28:31], s38 offen sc1
    v_dot2_f32_bf16 v12, v48, v13, v12
    v_dot2_f32_bf16 v12, v49, v13, v12
    v_dot2_f32_bf16 v12, v50, v13, v12
    v_dot2_f32_bf16 v12, v51, v13, v12
    s_waitcnt lgkmcnt(8)
    s_add_u32 s38, s37, 35840
    buffer_store_dwordx4 v[52:55], v9, s[28:31], s38 offen sc1
    v_dot2_f32_bf16 v12, v52, v13, v12
    v_dot2_f32_bf16 v12, v53, v13, v12
    v_dot2_f32_bf16 v12, v54, v13, v12
    v_dot2_f32_bf16 v12, v55, v13, v12
    s_waitcnt lgkmcnt(6)
    s_add_u32 s38, s37, 43008
    buffer_store_dwordx4 v[56:59], v9, s[28:31], s38 offen sc1
    v_dot2_f32_bf16 v12, v56, v13, v12
    v_dot2_f32_bf16 v12, v57, v13, v12
    v_dot2_f32_bf16 v12, v58, v13, v12
    v_dot2_f32_bf16 v12, v59, v13, v12
    s_waitcnt lgkmcnt(4)
    s_add_u32 s38, s37, 50176
    buffer_store_dwordx4 v[60:63], v9, s[28:31], s38 offen sc1
    v_dot2_f32_bf16 v12, v60, v13, v12
    v_dot2_f32_bf16 v12, v61, v13, v12
    v_dot2_f32_bf16 v12, v62, v13, v12
    v_dot2_f32_bf16 v12, v63, v13, v12
    s_waitcnt lgkmcnt(2)
    s_add_u32 s38, s37, 57344
    buffer_store_dwordx4 v[64:67], v9, s[28:31], s38 offen sc1
    v_dot2_f32_bf16 v12, v64, v13, v12
    v_dot2_f32_bf16 v12, v65, v13, v12
    v_dot2_f32_bf16 v12, v66, v13, v12
    v_dot2_f32_bf16 v12, v67, v13, v12
    s_waitcnt lgkmcnt(0)
    s_add_u32 s38, s37, 64512
    buffer_store_dwordx4 v[68:71], v9, s[28:31], s38 offen sc1
    v_dot2_f32_bf16 v12, v68, v13, v12
    v_dot2_f32_bf16 v12, v69, v13, v12
    v_dot2_f32_bf16 v12, v70, v13, v12
    v_dot2_f32_bf16 v12, v71, v13, v12
    s_nop 2
    v_mov_b32 v13, v12
    s_nop 1
    v_permlane32_swap_b32 v13, v12
    v_add_f32 v12, v12, v13
    v_mov_b32 v13, v12
    s_nop 1
    v_permlane16_swap_b32 v13, v12
    v_add_f32 v12, v12, v13
    s_mul_i32 s38, s33, 7168
    s_lshl_b32 s39, s36, 6
    s_add_u32 s38, s38, s39
    s_add_u32 s38, s38, 2732032
    v_lshlrev_b32 v14, 2, v1
    v_cmp_gt_u32 vcc, 16, v1
    s_and_saveexec_b64 s[40:41], vcc
    buffer_store_dword v12, v14, s[28:31], s38 offen sc1
    s_mov_b64 exec, -1
    s_add_u32 s34, s34, 1
    s_barrier
    s_lshl_b32 s36, s34, 2
    s_add_u32 s36, s36, s20
    s_mul_i32 s38, s36, 9363
    s_lshr_b32 s38, s38, 16
    s_mul_i32 s39, s38, 7
    s_sub_u32 s39, s36, s39
    s_mul_i32 s37, s38, 140
    s_mul_i32 s40, s33, 70
    s_add_u32 s37, s37, s40
    s_add_u32 s37, s37, s39
    s_lshl_b32 s37, s37, 10
    s_add_u32 s37, s37, 4403200
    s_waitcnt vmcnt(20)
    ds_write_b128 v5, v[72:75] offset:0
    s_waitcnt vmcnt(19)
    ds_write_b128 v5, v[76:79] offset:4608
    s_waitcnt vmcnt(18)
    ds_write_b128 v5, v[80:83] offset:9216
    s_waitcnt vmcnt(17)
    ds_write_b128 v5, v[84:87] offset:13824
    s_waitcnt vmcnt(16)
    ds_write_b128 v5, v[88:91] offset:18432
    s_waitcnt vmcnt(15)
    ds_write_b128 v5, v[92:95] offset:23040
    s_waitcnt vmcnt(14)
    ds_write_b128 v5, v[96:99] offset:27648
    s_waitcnt vmcnt(13)
    ds_write_b128 v5, v[100:103] offset:32256
    s_waitcnt vmcnt(12)
    ds_write_b128 v5, v[104:107] offset:36864
    s_waitcnt vmcnt(11)
    ds_write_b128 v5, v[108:111] offset:41472
    s_waitcnt lgkmcnt(0)
    s_barrier
    ds_read_b64_tr_b16 v[72:73], v8 offset:0
    ds_read_b64_tr_b16 v[74:75], v8 offset:576
    ds_read_b64_tr_b16 v[76:77], v8 offset:4608
    ds_read_b64_tr_b16 v[78:79], v8 offset:5184
    ds_read_b64_tr_b16 v[80:81], v8 offset:9216
    ds_read_b64_tr_b16 v[82:83], v8 offset:9792
    ds_read_b64_tr_b16 v[84:85], v8 offset:13824
    ds_read_b64_tr_b16 v[86:87], v8 offset:14400
    ds_read_b64_tr_b16 v[88:89], v8 offset:18432
    ds_read_b64_tr_b16 v[90:91], v8 offset:19008
    ds_read_b64_tr_b16 v[92:93], v8 offset:23040
    ds_read_b64_tr_b16 v[94:95], v8 offset:23616
    ds_read_b64_tr_b16 v[96:97], v8 offset:27648
    ds_read_b64_tr_b16 v[98:99], v8 offset:28224
    ds_read_b64_tr_b16 v[100:101], v8 offset:32256
    ds_read_b64_tr_b16 v[102:103], v8 offset:32832
    ds_read_b64_tr_b16 v[104:105], v8 offset:36864
    ds_read_b64_tr_b16 v[106:107], v8 offset:37440
    ds_read_b64_tr_b16 v[108:109], v8 offset:41472
    ds_read_b64_tr_b16 v[110:111], v8 offset:42048
    v_mov_b32 v12, 0
    v_mov_b32 v13, 0x3f803f80
    s_waitcnt lgkmcnt(15)
    s_add_u32 s38, s37, 0
    buffer_store_dwordx4 v[72:75], v9, s[28:31], s38 offen sc1
    v_dot2_f32_bf16 v12, v72, v13, v12
    v_dot2_f32_bf16 v12, v73, v13, v12
    v_dot2_f32_bf16 v12, v74, v13, v12
    v_dot2_f32_bf16 v12, v75, v13, v12
    s_waitcnt lgkmcnt(15)
    s_add_u32 s38, s37, 7168
    buffer_store_dwordx4 v[76:79], v9, s[28:31], s38 offen sc1
    v_dot2_f32_bf16 v12, v76, v13, v12
    v_dot2_f32_bf16 v12, v77, v13, v12
    v_dot2_f32_bf16 v12, v78, v13, v12
    v_dot2_f32_bf16 v12, v79, v13, v12
    s_waitcnt lgkmcnt(14)
    s_add_u32 s38, s37, 14336
    buffer_store_dwordx4 v[80:83], v9, s[28:31], s38 offen sc1
    v_dot2_f32_bf16 v12, v80, v13, v12
    v_dot2_f32_bf16 v12, v81, v13, v12
    v_dot2_f32_bf16 v12, v82, v13, v12
    v_dot2_f32_bf16 v12, v83, v13, v12
    s_waitcnt lgkmcnt(12)
    s_add_u32 s38, s37, 21504
    buffer_store_dwordx4 v[84:87], v9, s[28:31], s38 offen sc1
    v_dot2_f32_bf16 v12, v84, v13, v12
    v_dot2_f32_bf16 v12, v85, v13, v12
    v_dot2_f32_bf16 v12, v86, v13, v12
    v_dot2_f32_bf16 v12, v87, v13, v12
    s_waitcnt lgkmcnt(10)
    s_add_u32 s38, s37, 28672
    buffer_store_dwordx4 v[88:91], v9, s[28:31], s38 offen sc1
    v_dot2_f32_bf16 v12, v88, v13, v12
    v_dot2_f32_bf16 v12, v89, v13, v12
    v_dot2_f32_bf16 v12, v90, v13, v12
    v_dot2_f32_bf16 v12, v91, v13, v12
    s_waitcnt lgkmcnt(8)
    s_add_u32 s38, s37, 35840
    buffer_store_dwordx4 v[92:95], v9, s[28:31], s38 offen sc1
    v_dot2_f32_bf16 v12, v92, v13, v12
    v_dot2_f32_bf16 v12, v93, v13, v12
    v_dot2_f32_bf16 v12, v94, v13, v12
    v_dot2_f32_bf16 v12, v95, v13, v12
    s_waitcnt lgkmcnt(6)
    s_add_u32 s38, s37, 43008
    buffer_store_dwordx4 v[96:99], v9, s[28:31], s38 offen sc1
    v_dot2_f32_bf16 v12, v96, v13, v12
    v_dot2_f32_bf16 v12, v97, v13, v12
    v_dot2_f32_bf16 v12, v98, v13, v12
    v_dot2_f32_bf16 v12, v99, v13, v12
    s_waitcnt lgkmcnt(4)
    s_add_u32 s38, s37, 50176
    buffer_store_dwordx4 v[100:103], v9, s[28:31], s38 offen sc1
    v_dot2_f32_bf16 v12, v100, v13, v12
    v_dot2_f32_bf16 v12, v101, v13, v12
    v_dot2_f32_bf16 v12, v102, v13, v12
    v_dot2_f32_bf16 v12, v103, v13, v12
    s_waitcnt lgkmcnt(2)
    s_add_u32 s38, s37, 57344
    buffer_store_dwordx4 v[104:107], v9, s[28:31], s38 offen sc1
    v_dot2_f32_bf16 v12, v104, v13, v12
    v_dot2_f32_bf16 v12, v105, v13, v12
    v_dot2_f32_bf16 v12, v106, v13, v12
    v_dot2_f32_bf16 v12, v107, v13, v12
    s_waitcnt lgkmcnt(0)
    s_add_u32 s38, s37, 64512
    buffer_store_dwordx4 v[108:111], v9, s[28:31], s38 offen sc1
    v_dot2_f32_bf16 v12, v108, v13, v12
    v_dot2_f32_bf16 v12, v109, v13, v12
    v_dot2_f32_bf16 v12, v110, v13, v12
    v_dot2_f32_bf16 v12, v111, v13, v12
    s_nop 2
    v_mov_b32 v13, v12
    s_nop 1
    v_permlane32_swap_b32 v13, v12
    v_add_f32 v12, v12, v13
    v_mov_b32 v13, v12
    s_nop 1
    v_permlane16_swap_b32 v13, v12
    v_add_f32 v12, v12, v13
    s_mul_i32 s38, s33, 7168
    s_lshl_b32 s39, s36, 6
    s_add_u32 s38, s38, s39
    s_add_u32 s38, s38, 2732032
    v_lshlrev_b32 v14, 2, v1
    v_cmp_gt_u32 vcc, 16, v1
    s_and_saveexec_b64 s[40:41], vcc
    buffer_store_dword v12, v14, s[28:31], s38 offen sc1
    s_mov_b64 exec, -1
    s_endpgm
k1_kernel_pk19:
    s_mov_b32 s24, s18
    s_mov_b32 s25, s19
    s_mov_b32 s26, 2211840
    s_mov_b32 s27, 0x00020000
    s_sub_u32 s32, s21, 48
    s_mul_i32 s33, s32, 52429
    s_lshr_b32 s33, s33, 18
    s_mul_i32 s34, s33, 5
    s_sub_u32 s34, s32, s34
    s_lshl_b32 s34, s34, 1
    v_mul_u32_u24 v10, 1280, v3
    v_lshl_add_u32 v10, v4, 4, v10
    s_mul_i32 s35, s33, 368640
    s_lshl_b32 s36, s34, 7
    s_add_u32 s35, s35, s36
    buffer_load_dwordx4 v[32:35], v10, s[24:27], s35 offen offset:0
    s_add_u32 s35, s35, 40960
    buffer_load_dwordx4 v[36:39], v10, s[24:27], s35 offen offset:0
    s_add_u32 s35, s35, 40960
    buffer_load_dwordx4 v[40:43], v10, s[24:27], s35 offen offset:0
    s_add_u32 s35, s35, 40960
    buffer_load_dwordx4 v[44:47], v10, s[24:27], s35 offen offset:0
    s_add_u32 s35, s35, 40960
    buffer_load_dwordx4 v[48:51], v10, s[24:27], s35 offen offset:0
    s_add_u32 s35, s35, 40960
    buffer_load_dwordx4 v[52:55], v10, s[24:27], s35 offen offset:0
    s_add_u32 s35, s35, 40960
    buffer_load_dwordx4 v[56:59], v10, s[24:27], s35 offen offset:0
    s_add_u32 s35, s35, 40960
    buffer_load_dwordx4 v[60:63], v10, s[24:27], s35 offen offset:0
    s_add_u32 s35, s35, 40960
    buffer_load_dwordx4 v[64:67], v10, s[24:27], s35 offen offset:0
    s_sub_u32 s35, s35, 327680
    buffer_load_dwordx4 v[72:75], v10, s[24:27], s35 offen offset:128
    s_add_u32 s35, s35, 40960
    buffer_load_dwordx4 v[76:79], v10, s[24:27], s35 offen offset:128
    s_add_u32 s35, s35, 40960
    buffer_load_dwordx4 v[80:83], v10, s[24:27], s35 offen offset:128
    s_add_u32 s35, s35, 40960
    buffer_load_dwordx4 v[84:87], v10, s[24:27], s35 offen offset:128
    s_add_u32 s35, s35, 40960
    buffer_load_dwordx4 v[88:91], v10, s[24:27], s35 offen offset:128
    s_add_u32 s35, s35, 40960
    buffer_load_dwordx4 v[92:95], v10, s[24:27], s35 offen offset:128
    s_add_u32 s35, s35, 40960
    buffer_load_dwordx4 v[96:99], v10, s[24:27], s35 offen offset:128
    s_add_u32 s35, s35, 40960
    buffer_load_dwordx4 v[100:103], v10, s[24:27], s35 offen offset:128
    s_add_u32 s35, s35, 40960
    buffer_load_dwordx4 v[104:107], v10, s[24:27], s35 offen offset:128
    s_lshl_b32 s36, s34, 2
    s_add_u32 s36, s36, s20
    s_mul_i32 s38, s36, 52429
    s_lshr_b32 s38, s38, 18
    s_mul_i32 s39, s38, 5
    s_sub_u32 s39, s36, s39
    s_mul_i32 s37, s38, 280
    s_mul_i32 s40, s33, 45
    s_add_u32 s37, s37, s40
    s_add_u32 s37, s37, s39
    s_lshl_b32 s37, s37, 10
    s_add_u32 s37, s37, 6696960
    s_waitcnt vmcnt(17)
    ds_write_b128 v5, v[32:35] offset:0
    s_waitcnt vmcnt(16)
    ds_write_b128 v5, v[36:39] offset:4608
    s_waitcnt vmcnt(15)
    ds_write_b128 v5, v[40:43] offset:9216
    s_waitcnt vmcnt(14)
    ds_write_b128 v5, v[44:47] offset:13824
    s_waitcnt vmcnt(13)
    ds_write_b128 v5, v[48:51] offset:18432
    s_waitcnt vmcnt(12)
    ds_write_b128 v5, v[52:55] offset:23040
    s_waitcnt vmcnt(11)
    ds_write_b128 v5, v[56:59] offset:27648
    s_waitcnt vmcnt(10)
    ds_write_b128 v5, v[60:63] offset:32256
    s_waitcnt vmcnt(9)
    ds_write_b128 v5, v[64:67] offset:36864
    s_waitcnt lgkmcnt(0)
    s_barrier
    ds_read_b64_tr_b16 v[32:33], v8 offset:0
    ds_read_b64_tr_b16 v[34:35], v8 offset:576
    ds_read_b64_tr_b16 v[36:37], v8 offset:4608
    ds_read_b64_tr_b16 v[38:39], v8 offset:5184
    ds_read_b64_tr_b16 v[40:41], v8 offset:9216
    ds_read_b64_tr_b16 v[42:43], v8 offset:9792
    ds_read_b64_tr_b16 v[44:45], v8 offset:13824
    ds_read_b64_tr_b16 v[46:47], v8 offset:14400
    ds_read_b64_tr_b16 v[48:49], v8 offset:18432
    ds_read_b64_tr_b16 v[50:51], v8 offset:19008
    ds_read_b64_tr_b16 v[52:53], v8 offset:23040
    ds_read_b64_tr_b16 v[54:55], v8 offset:23616
    ds_read_b64_tr_b16 v[56:57], v8 offset:27648
    ds_read_b64_tr_b16 v[58:59], v8 offset:28224
    ds_read_b64_tr_b16 v[60:61], v8 offset:32256
    ds_read_b64_tr_b16 v[62:63], v8 offset:32832
    ds_read_b64_tr_b16 v[64:65], v8 offset:36864
    ds_read_b64_tr_b16 v[66:67], v8 offset:37440
    s_waitcnt lgkmcnt(15)
    s_add_u32 s38, s37, 0
    buffer_store_dwordx4 v[32:35], v9, s[28:31], s38 offen sc1
    s_waitcnt lgkmcnt(14)
    s_add_u32 s38, s37, 5120
    buffer_store_dwordx4 v[36:39], v9, s[28:31], s38 offen sc1
    s_waitcnt lgkmcnt(12)
    s_add_u32 s38, s37, 10240
    buffer_store_dwordx4 v[40:43], v9, s[28:31], s38 offen sc1
    s_waitcnt lgkmcnt(10)
    s_add_u32 s38, s37, 15360
    buffer_store_dwordx4 v[44:47], v9, s[28:31], s38 offen sc1
    s_waitcnt lgkmcnt(8)
    s_add_u32 s38, s37, 20480
    buffer_store_dwordx4 v[48:51], v9, s[28:31], s38 offen sc1
    s_waitcnt lgkmcnt(6)
    s_add_u32 s38, s37, 25600
    buffer_store_dwordx4 v[52:55], v9, s[28:31], s38 offen sc1
    s_waitcnt lgkmcnt(4)
    s_add_u32 s38, s37, 30720
    buffer_store_dwordx4 v[56:59], v9, s[28:31], s38 offen sc1
    s_waitcnt lgkmcnt(2)
    s_add_u32 s38, s37, 35840
    buffer_store_dwordx4 v[60:63], v9, s[28:31], s38 offen sc1
    s_waitcnt lgkmcnt(0)
    s_add_u32 s38, s37, 40960
    buffer_store_dwordx4 v[64:67], v9, s[28:31], s38 offen sc1
    s_add_u32 s34, s34, 1
    s_barrier
    s_lshl_b32 s36, s34, 2
    s_add_u32 s36, s36, s20
    s_mul_i32 s38, s36, 52429
    s_lshr_b32 s38, s38, 18
    s_mul_i32 s39, s38, 5
    s_sub_u32 s39, s36, s39
    s_mul_i32 s37, s38, 280
    s_mul_i32 s40, s33, 45
    s_add_u32 s37, s37, s40
    s_add_u32 s37, s37, s39
    s_lshl_b32 s37, s37, 10
    s_add_u32 s37, s37, 6696960
    s_waitcnt vmcnt(17)
    ds_write_b128 v5, v[72:75] offset:0
    s_waitcnt vmcnt(16)
    ds_write_b128 v5, v[76:79] offset:4608
    s_waitcnt vmcnt(15)
    ds_write_b128 v5, v[80:83] offset:9216
    s_waitcnt vmcnt(14)
    ds_write_b128 v5, v[84:87] offset:13824
    s_waitcnt vmcnt(13)
    ds_write_b128 v5, v[88:91] offset:18432
    s_waitcnt vmcnt(12)
    ds_write_b128 v5, v[92:95] offset:23040
    s_waitcnt vmcnt(11)
    ds_write_b128 v5, v[96:99] offset:27648
    s_waitcnt vmcnt(10)
    ds_write_b128 v5, v[100:103] offset:32256
    s_waitcnt vmcnt(9)
    ds_write_b128 v5, v[104:107] offset:36864
    s_waitcnt lgkmcnt(0)
    s_barrier
    ds_read_b64_tr_b16 v[72:73], v8 offset:0
    ds_read_b64_tr_b16 v[74:75], v8 offset:576
    ds_read_b64_tr_b16 v[76:77], v8 offset:4608
    ds_read_b64_tr_b16 v[78:79], v8 offset:5184
    ds_read_b64_tr_b16 v[80:81], v8 offset:9216
    ds_read_b64_tr_b16 v[82:83], v8 offset:9792
    ds_read_b64_tr_b16 v[84:85], v8 offset:13824
    ds_read_b64_tr_b16 v[86:87], v8 offset:14400
    ds_read_b64_tr_b16 v[88:89], v8 offset:18432
    ds_read_b64_tr_b16 v[90:91], v8 offset:19008
    ds_read_b64_tr_b16 v[92:93], v8 offset:23040
    ds_read_b64_tr_b16 v[94:95], v8 offset:23616
    ds_read_b64_tr_b16 v[96:97], v8 offset:27648
    ds_read_b64_tr_b16 v[98:99], v8 offset:28224
    ds_read_b64_tr_b16 v[100:101], v8 offset:32256
    ds_read_b64_tr_b16 v[102:103], v8 offset:32832
    ds_read_b64_tr_b16 v[104:105], v8 offset:36864
    ds_read_b64_tr_b16 v[106:107], v8 offset:37440
    s_waitcnt lgkmcnt(15)
    s_add_u32 s38, s37, 0
    buffer_store_dwordx4 v[72:75], v9, s[28:31], s38 offen sc1
    s_waitcnt lgkmcnt(14)
    s_add_u32 s38, s37, 5120
    buffer_store_dwordx4 v[76:79], v9, s[28:31], s38 offen sc1
    s_waitcnt lgkmcnt(12)
    s_add_u32 s38, s37, 10240
    buffer_store_dwordx4 v[80:83], v9, s[28:31], s38 offen sc1
    s_waitcnt lgkmcnt(10)
    s_add_u32 s38, s37, 15360
    buffer_store_dwordx4 v[84:87], v9, s[28:31], s38 offen sc1
    s_waitcnt lgkmcnt(8)
    s_add_u32 s38, s37, 20480
    buffer_store_dwordx4 v[88:91], v9, s[28:31], s38 offen sc1
    s_waitcnt lgkmcnt(6)
    s_add_u32 s38, s37, 25600
    buffer_store_dwordx4 v[92:95], v9, s[28:31], s38 offen sc1
    s_waitcnt lgkmcnt(4)
    s_add_u32 s38, s37, 30720
    buffer_store_dwordx4 v[96:99], v9, s[28:31], s38 offen sc1
    s_waitcnt lgkmcnt(2)
    s_add_u32 s38, s37, 35840
    buffer_store_dwordx4 v[100:103], v9, s[28:31], s38 offen sc1
    s_waitcnt lgkmcnt(0)
    s_add_u32 s38, s37, 40960
    buffer_store_dwordx4 v[104:107], v9, s[28:31], s38 offen sc1
    s_endpgm
k1_kernel_pke20:
    s_endpgm
k1_mod0:
    s_sub_u32 s54, s54, 128
    s_waitcnt lgkmcnt(0)
    s_mov_b32 s28, s10
    s_mov_b32 s29, s11
    s_mov_b32 s30, 268435456
    s_mov_b32 s31, 0x00020000
k1_modf:
    s_load_dwordx4 s[12:15], s[0:1], 88
    s_mov_b32 s32, s54
    v_and_b32 v3, 7, v0
    v_lshrrev_b32 v4, 3, v0
    v_lshlrev_b32 v5, 1, v4
    v_mul_u32_u24 v6, 7680, v4
    s_lshl_b32 s36, s32, 7
    v_lshl_add_u32 v7, v3, 4, s36
    v_add_u32 v6, v6, v7
    s_waitcnt lgkmcnt(0)
    s_mov_b32 s16, s12
    s_mov_b32 s17, s13
    s_mov_b32 s18, 1280
    s_mov_b32 s19, 0x00020000
    s_mov_b32 s20, s14
    s_mov_b32 s21, s15
    s_mov_b32 s22, 4915200
    s_mov_b32 s23, 0x00020000
    buffer_load_ushort v10, v5, s[16:19], 0 offen offset:0
    buffer_load_ushort v11, v5, s[16:19], 0 offen offset:64
    buffer_load_ushort v12, v5, s[16:19], 0 offen offset:128
    buffer_load_ushort v13, v5, s[16:19], 0 offen offset:192
    buffer_load_ushort v14, v5, s[16:19], 0 offen offset:256
    buffer_load_ushort v15, v5, s[16:19], 0 offen offset:320
    buffer_load_ushort v16, v5, s[16:19], 0 offen offset:384
    buffer_load_ushort v17, v5, s[16:19], 0 offen offset:448
    buffer_load_ushort v18, v5, s[16:19], 0 offen offset:512
    buffer_load_ushort v19, v5, s[16:19], 0 offen offset:576
    buffer_load_ushort v20, v5, s[16:19], 0 offen offset:640
    buffer_load_ushort v21, v5, s[16:19], 0 offen offset:704
    buffer_load_ushort v22, v5, s[16:19], 0 offen offset:768
    buffer_load_ushort v23, v5, s[16:19], 0 offen offset:832
    buffer_load_ushort v24, v5, s[16:19], 0 offen offset:896
    buffer_load_ushort v25, v5, s[16:19], 0 offen offset:960
    buffer_load_ushort v26, v5, s[16:19], 0 offen offset:1024
    buffer_load_ushort v27, v5, s[16:19], 0 offen offset:1088
    buffer_load_ushort v28, v5, s[16:19], 0 offen offset:1152
    buffer_load_ushort v29, v5, s[16:19], 0 offen offset:1216
    s_mov_b32 s37, 0
    buffer_load_dwordx4 v[32:35], v6, s[20:23], s37 offen
    s_mov_b32 s37, 245760
    buffer_load_dwordx4 v[36:39], v6, s[20:23], s37 offen
    s_mov_b32 s37, 491520
    buffer_load_dwordx4 v[40:43], v6, s[20:23], s37 offen
    s_mov_b32 s37, 737280
    buffer_load_dwordx4 v[44:47], v6, s[20:23], s37 offen
    s_mov_b32 s37, 983040
    buffer_load_dwordx4 v[48:51], v6, s[20:23], s37 offen
    s_mov_b32 s37, 1228800
    buffer_load_dwordx4 v[52:55], v6, s[20:23], s37 offen
    s_mov_b32 s37, 1474560
    buffer_load_dwordx4 v[56:59], v6, s[20:23], s37 offen
    s_mov_b32 s37, 1720320
    buffer_load_dwordx4 v[60:63], v6, s[20:23], s37 offen
    s_mov_b32 s37, 1966080
    buffer_load_dwordx4 v[64:67], v6, s[20:23], s37 offen
    s_mov_b32 s37, 2211840
    buffer_load_dwordx4 v[68:71], v6, s[20:23], s37 offen
    s_mov_b32 s37, 2457600
    buffer_load_dwordx4 v[72:75], v6, s[20:23], s37 offen
    s_mov_b32 s37, 2703360
    buffer_load_dwordx4 v[76:79], v6, s[20:23], s37 offen
    s_mov_b32 s37, 2949120
    buffer_load_dwordx4 v[80:83], v6, s[20:23], s37 offen
    s_mov_b32 s37, 3194880
    buffer_load_dwordx4 v[84:87], v6, s[20:23], s37 offen
    s_mov_b32 s37, 3440640
    buffer_load_dwordx4 v[88:91], v6, s[20:23], s37 offen
    s_mov_b32 s37, 3686400
    buffer_load_dwordx4 v[92:95], v6, s[20:23], s37 offen
    s_mov_b32 s37, 3932160
    buffer_load_dwordx4 v[96:99], v6, s[20:23], s37 offen
    s_mov_b32 s37, 4177920
    buffer_load_dwordx4 v[100:103], v6, s[20:23], s37 offen
    s_mov_b32 s37, 4423680
    buffer_load_dwordx4 v[104:107], v6, s[20:23], s37 offen
    s_mov_b32 s37, 4669440
    buffer_load_dwordx4 v[108:111], v6, s[20:23], s37 offen
    s_waitcnt vmcnt(20)
    v_lshlrev_b32 v10, 16, v10
    v_mul_f32 v120, 0xbfb8aa3b, v10
    v_exp_f32 v120, v120
    v_lshlrev_b32 v11, 16, v11
    v_mul_f32 v121, 0xbfb8aa3b, v11
    v_exp_f32 v121, v121
    v_lshlrev_b32 v12, 16, v12
    v_mul_f32 v122, 0xbfb8aa3b, v12
    v_exp_f32 v122, v122
    v_lshlrev_b32 v13, 16, v13
    v_mul_f32 v123, 0xbfb8aa3b, v13
    v_exp_f32 v123, v123
    v_lshlrev_b32 v14, 16, v14
    v_mul_f32 v124, 0xbfb8aa3b, v14
    v_exp_f32 v124, v124
    v_lshlrev_b32 v15, 16, v15
    v_mul_f32 v125, 0xbfb8aa3b, v15
    v_exp_f32 v125, v125
    v_lshlrev_b32 v16, 16, v16
    v_mul_f32 v126, 0xbfb8aa3b, v16
    v_exp_f32 v126, v126
    v_lshlrev_b32 v17, 16, v17
    v_mul_f32 v127, 0xbfb8aa3b, v17
    v_exp_f32 v127, v127
    v_lshlrev_b32 v18, 16, v18
    v_mul_f32 v128, 0xbfb8aa3b, v18
    v_exp_f32 v128, v128
    v_lshlrev_b32 v19, 16, v19
    v_mul_f32 v129, 0xbfb8aa3b, v19
    v_exp_f32 v129, v129
    v_lshlrev_b32 v20, 16, v20
    v_mul_f32 v130, 0xbfb8aa3b, v20
    v_exp_f32 v130, v130
    v_lshlrev_b32 v21, 16, v21
    v_mul_f32 v131, 0xbfb8aa3b, v21
    v_exp_f32 v131, v131
    v_lshlrev_b32 v22, 16, v22
    v_mul_f32 v132, 0xbfb8aa3b, v22
    v_exp_f32 v132, v132
    v_lshlrev_b32 v23, 16, v23
    v_mul_f32 v133, 0xbfb8aa3b, v23
    v_exp_f32 v133, v133
    v_lshlrev_b32 v24, 16, v24
    v_mul_f32 v134, 0xbfb8aa3b, v24
    v_exp_f32 v134, v134
    v_lshlrev_b32 v25, 16, v25
    v_mul_f32 v135, 0xbfb8aa3b, v25
    v_exp_f32 v135, v135
    v_lshlrev_b32 v26, 16, v26
    v_mul_f32 v136, 0xbfb8aa3b, v26
    v_exp_f32 v136, v136
    v_lshlrev_b32 v27, 16, v27
    v_mul_f32 v137, 0xbfb8aa3b, v27
    v_exp_f32 v137, v137
    v_lshlrev_b32 v28, 16, v28
    v_mul_f32 v138, 0xbfb8aa3b, v28
    v_exp_f32 v138, v138
    v_lshlrev_b32 v29, 16, v29
    v_mul_f32 v139, 0xbfb8aa3b, v29
    v_exp_f32 v139, v139
    v_add_f32 v120, 1.0, v120
    v_rcp_f32 v120, v120
    v_add_f32 v121, 1.0, v121
    v_rcp_f32 v121, v121
    v_add_f32 v122, 1.0, v122
    v_rcp_f32 v122, v122
    v_add_f32 v123, 1.0, v123
    v_rcp_f32 v123, v123
    v_add_f32 v124, 1.0, v124
    v_rcp_f32 v124, v124
    v_add_f32 v125, 1.0, v125
    v_rcp_f32 v125, v125
    v_add_f32 v126, 1.0, v126
    v_rcp_f32 v126, v126
    v_add_f32 v127, 1.0, v127
    v_rcp_f32 v127, v127
    v_add_f32 v128, 1.0, v128
    v_rcp_f32 v128, v128
    v_add_f32 v129, 1.0, v129
    v_rcp_f32 v129, v129
    v_add_f32 v130, 1.0, v130
    v_rcp_f32 v130, v130
    v_add_f32 v131, 1.0, v131
    v_rcp_f32 v131, v131
    v_add_f32 v132, 1.0, v132
    v_rcp_f32 v132, v132
    v_add_f32 v133, 1.0, v133
    v_rcp_f32 v133, v133
    v_add_f32 v134, 1.0, v134
    v_rcp_f32 v134, v134
    v_add_f32 v135, 1.0, v135
    v_rcp_f32 v135, v135
    v_add_f32 v136, 1.0, v136
    v_rcp_f32 v136, v136
    v_add_f32 v137, 1.0, v137
    v_rcp_f32 v137, v137
    v_add_f32 v138, 1.0, v138
    v_rcp_f32 v138, v138
    v_add_f32 v139, 1.0, v139
    v_rcp_f32 v139, v139
    s_nop 0
    v_mul_f32 v10, v10, v120
    v_mul_f32 v11, v11, v121
    v_mul_f32 v12, v12, v122
    v_mul_f32 v13, v13, v123
    v_mul_f32 v14, v14, v124
    v_mul_f32 v15, v15, v125
    v_mul_f32 v16, v16, v126
    v_mul_f32 v17, v17, v127
    v_mul_f32 v18, v18, v128
    v_mul_f32 v19, v19, v129
    v_mul_f32 v20, v20, v130
    v_mul_f32 v21, v21, v131
    v_mul_f32 v22, v22, v132
    v_mul_f32 v23, v23, v133
    v_mul_f32 v24, v24, v134
    v_mul_f32 v25, v25, v135
    v_mul_f32 v26, v26, v136
    v_mul_f32 v27, v27, v137
    v_mul_f32 v28, v28, v138
    v_mul_f32 v29, v29, v139
    v_cvt_pk_bf16_f32 v120, v10, v11
    v_lshlrev_b32 v10, 16, v120
    v_and_b32 v11, 0xffff0000, v120
    v_cvt_pk_bf16_f32 v120, v12, v13
    v_lshlrev_b32 v12, 16, v120
    v_and_b32 v13, 0xffff0000, v120
    v_cvt_pk_bf16_f32 v120, v14, v15
    v_lshlrev_b32 v14, 16, v120
    v_and_b32 v15, 0xffff0000, v120
    v_cvt_pk_bf16_f32 v120, v16, v17
    v_lshlrev_b32 v16, 16, v120
    v_and_b32 v17, 0xffff0000, v120
    v_cvt_pk_bf16_f32 v120, v18, v19
    v_lshlrev_b32 v18, 16, v120
    v_and_b32 v19, 0xffff0000, v120
    v_cvt_pk_bf16_f32 v120, v20, v21
    v_lshlrev_b32 v20, 16, v120
    v_and_b32 v21, 0xffff0000, v120
    v_cvt_pk_bf16_f32 v120, v22, v23
    v_lshlrev_b32 v22, 16, v120
    v_and_b32 v23, 0xffff0000, v120
    v_cvt_pk_bf16_f32 v120, v24, v25
    v_lshlrev_b32 v24, 16, v120
    v_and_b32 v25, 0xffff0000, v120
    v_cvt_pk_bf16_f32 v120, v26, v27
    v_lshlrev_b32 v26, 16, v120
    v_and_b32 v27, 0xffff0000, v120
    v_cvt_pk_bf16_f32 v120, v28, v29
    v_lshlrev_b32 v28, 16, v120
    v_and_b32 v29, 0xffff0000, v120
    v_mov_b32 v112, 0
    v_mov_b32 v113, 0
    v_mov_b32 v114, 0
    v_mov_b32 v115, 0
    v_mov_b32 v116, 0
    v_mov_b32 v117, 0
    v_mov_b32 v118, 0
    v_mov_b32 v119, 0
    s_waitcnt vmcnt(19)
    v_lshlrev_b32 v120, 16, v32
    v_and_b32 v121, 0xffff0000, v32
    v_lshlrev_b32 v122, 16, v33
    v_and_b32 v123, 0xffff0000, v33
    v_lshlrev_b32 v124, 16, v34
    v_and_b32 v125, 0xffff0000, v34
    v_lshlrev_b32 v126, 16, v35
    v_and_b32 v127, 0xffff0000, v35
    v_pk_fma_f32 v[112:113], v[120:121], v[10:11], v[112:113] op_sel:[0,0,0] op_sel_hi:[1,0,1]
    v_pk_fma_f32 v[114:115], v[122:123], v[10:11], v[114:115] op_sel:[0,0,0] op_sel_hi:[1,0,1]
    v_pk_fma_f32 v[116:117], v[124:125], v[10:11], v[116:117] op_sel:[0,0,0] op_sel_hi:[1,0,1]
    v_pk_fma_f32 v[118:119], v[126:127], v[10:11], v[118:119] op_sel:[0,0,0] op_sel_hi:[1,0,1]
    s_waitcnt vmcnt(18)
    v_lshlrev_b32 v120, 16, v36
    v_and_b32 v121, 0xffff0000, v36
    v_lshlrev_b32 v122, 16, v37
    v_and_b32 v123, 0xffff0000, v37
    v_lshlrev_b32 v124, 16, v38
    v_and_b32 v125, 0xffff0000, v38
    v_lshlrev_b32 v126, 16, v39
    v_and_b32 v127, 0xffff0000, v39
    v_pk_fma_f32 v[112:113], v[120:121], v[10:11], v[112:113] op_sel:[0,1,0] op_sel_hi:[1,1,1]
    v_pk_fma_f32 v[114:115], v[122:123], v[10:11], v[114:115] op_sel:[0,1,0] op_sel_hi:[1,1,1]
    v_pk_fma_f32 v[116:117], v[124:125], v[10:11], v[116:117] op_sel:[0,1,0] op_sel_hi:[1,1,1]
    v_pk_fma_f32 v[118:119], v[126:127], v[10:11], v[118:119] op_sel:[0,1,0] op_sel_hi:[1,1,1]
    s_waitcnt vmcnt(17)
    v_lshlrev_b32 v120, 16, v40
    v_and_b32 v121, 0xffff0000, v40
    v_lshlrev_b32 v122, 16, v41
    v_and_b32 v123, 0xffff0000, v41
    v_lshlrev_b32 v124, 16, v42
    v_and_b32 v125, 0xffff0000, v42
    v_lshlrev_b32 v126, 16, v43
    v_and_b32 v127, 0xffff0000, v43
    v_pk_fma_f32 v[112:113], v[120:121], v[12:13], v[112:113] op_sel:[0,0,0] op_sel_hi:[1,0,1]
    v_pk_fma_f32 v[114:115], v[122:123], v[12:13], v[114:115] op_sel:[0,0,0] op_sel_hi:[1,0,1]
    v_pk_fma_f32 v[116:117], v[124:125], v[12:13], v[116:117] op_sel:[0,0,0] op_sel_hi:[1,0,1]
    v_pk_fma_f32 v[118:119], v[126:127], v[12:13], v[118:119] op_sel:[0,0,0] op_sel_hi:[1,0,1]
    s_waitcnt vmcnt(16)
    v_lshlrev_b32 v120, 16, v44
    v_and_b32 v121, 0xffff0000, v44
    v_lshlrev_b32 v122, 16, v45
    v_and_b32 v123, 0xffff0000, v45
    v_lshlrev_b32 v124, 16, v46
    v_and_b32 v125, 0xffff0000, v46
    v_lshlrev_b32 v126, 16, v47
    v_and_b32 v127, 0xffff0000, v47
    v_pk_fma_f32 v[112:113], v[120:121], v[12:13], v[112:113] op_sel:[0,1,0] op_sel_hi:[1,1,1]
    v_pk_fma_f32 v[114:115], v[122:123], v[12:13], v[114:115] op_sel:[0,1,0] op_sel_hi:[1,1,1]
    v_pk_fma_f32 v[116:117], v[124:125], v[12:13], v[116:117] op_sel:[0,1,0] op_sel_hi:[1,1,1]
    v_pk_fma_f32 v[118:119], v[126:127], v[12:13], v[118:119] op_sel:[0,1,0] op_sel_hi:[1,1,1]
    s_waitcnt vmcnt(15)
    v_lshlrev_b32 v120, 16, v48
    v_and_b32 v121, 0xffff0000, v48
    v_lshlrev_b32 v122, 16, v49
    v_and_b32 v123, 0xffff0000, v49
    v_lshlrev_b32 v124, 16, v50
    v_and_b32 v125, 0xffff0000, v50
    v_lshlrev_b32 v126, 16, v51
    v_and_b32 v127, 0xffff0000, v51
    v_pk_fma_f32 v[112:113], v[120:121], v[14:15], v[112:113] op_sel:[0,0,0] op_sel_hi:[1,0,1]
    v_pk_fma_f32 v[114:115], v[122:123], v[14:15], v[114:115] op_sel:[0,0,0] op_sel_hi:[1,0,1]
    v_pk_fma_f32 v[116:117], v[124:125], v[14:15], v[116:117] op_sel:[0,0,0] op_sel_hi:[1,0,1]
    v_pk_fma_f32 v[118:119], v[126:127], v[14:15], v[118:119] op_sel:[0,0,0] op_sel_hi:[1,0,1]
    s_waitcnt vmcnt(14)
    v_lshlrev_b32 v120, 16, v52
    v_and_b32 v121, 0xffff0000, v52
    v_lshlrev_b32 v122, 16, v53
    v_and_b32 v123, 0xffff0000, v53
    v_lshlrev_b32 v124, 16, v54
    v_and_b32 v125, 0xffff0000, v54
    v_lshlrev_b32 v126, 16, v55
    v_and_b32 v127, 0xffff0000, v55
    v_pk_fma_f32 v[112:113], v[120:121], v[14:15], v[112:113] op_sel:[0,1,0] op_sel_hi:[1,1,1]
    v_pk_fma_f32 v[114:115], v[122:123], v[14:15], v[114:115] op_sel:[0,1,0] op_sel_hi:[1,1,1]
    v_pk_fma_f32 v[116:117], v[124:125], v[14:15], v[116:117] op_sel:[0,1,0] op_sel_hi:[1,1,1]
    v_pk_fma_f32 v[118:119], v[126:127], v[14:15], v[118:119] op_sel:[0,1,0] op_sel_hi:[1,1,1]
    s_waitcnt vmcnt(13)
    v_lshlrev_b32 v120, 16, v56
    v_and_b32 v121, 0xffff0000, v56
    v_lshlrev_b32 v122, 16, v57
    v_and_b32 v123, 0xffff0000, v57
    v_lshlrev_b32 v124, 16, v58
    v_and_b32 v125, 0xffff0000, v58
    v_lshlrev_b32 v126, 16, v59
    v_and_b32 v127, 0xffff0000, v59
    v_pk_fma_f32 v[112:113], v[120:121], v[16:17], v[112:113] op_sel:[0,0,0] op_sel_hi:[1,0,1]
    v_pk_fma_f32 v[114:115], v[122:123], v[16:17], v[114:115] op_sel:[0,0,0] op_sel_hi:[1,0,1]
    v_pk_fma_f32 v[116:117], v[124:125], v[16:17], v[116:117] op_sel:[0,0,0] op_sel_hi:[1,0,1]
    v_pk_fma_f32 v[118:119], v[126:127], v[16:17], v[118:119] op_sel:[0,0,0] op_sel_hi:[1,0,1]
    s_waitcnt vmcnt(12)
    v_lshlrev_b32 v120, 16, v60
    v_and_b32 v121, 0xffff0000, v60
    v_lshlrev_b32 v122, 16, v61
    v_and_b32 v123, 0xffff0000, v61
    v_lshlrev_b32 v124, 16, v62
    v_and_b32 v125, 0xffff0000, v62
    v_lshlrev_b32 v126, 16, v63
    v_and_b32 v127, 0xffff0000, v63
    v_pk_fma_f32 v[112:113], v[120:121], v[16:17], v[112:113] op_sel:[0,1,0] op_sel_hi:[1,1,1]
    v_pk_fma_f32 v[114:115], v[122:123], v[16:17], v[114:115] op_sel:[0,1,0] op_sel_hi:[1,1,1]
    v_pk_fma_f32 v[116:117], v[124:125], v[16:17], v[116:117] op_sel:[0,1,0] op_sel_hi:[1,1,1]
    v_pk_fma_f32 v[118:119], v[126:127], v[16:17], v[118:119] op_sel:[0,1,0] op_sel_hi:[1,1,1]
    s_waitcnt vmcnt(11)
    v_lshlrev_b32 v120, 16, v64
    v_and_b32 v121, 0xffff0000, v64
    v_lshlrev_b32 v122, 16, v65
    v_and_b32 v123, 0xffff0000, v65
    v_lshlrev_b32 v124, 16, v66
    v_and_b32 v125, 0xffff0000, v66
    v_lshlrev_b32 v126, 16, v67
    v_and_b32 v127, 0xffff0000, v67
    v_pk_fma_f32 v[112:113], v[120:121], v[18:19], v[112:113] op_sel:[0,0,0] op_sel_hi:[1,0,1]
    v_pk_fma_f32 v[114:115], v[122:123], v[18:19], v[114:115] op_sel:[0,0,0] op_sel_hi:[1,0,1]
    v_pk_fma_f32 v[116:117], v[124:125], v[18:19], v[116:117] op_sel:[0,0,0] op_sel_hi:[1,0,1]
    v_pk_fma_f32 v[118:119], v[126:127], v[18:19], v[118:119] op_sel:[0,0,0] op_sel_hi:[1,0,1]
    s_waitcnt vmcnt(10)
    v_lshlrev_b32 v120, 16, v68
    v_and_b32 v121, 0xffff0000, v68
    v_lshlrev_b32 v122, 16, v69
    v_and_b32 v123, 0xffff0000, v69
    v_lshlrev_b32 v124, 16, v70
    v_and_b32 v125, 0xffff0000, v70
    v_lshlrev_b32 v126, 16, v71
    v_and_b32 v127, 0xffff0000, v71
    v_pk_fma_f32 v[112:113], v[120:121], v[18:19], v[112:113] op_sel:[0,1,0] op_sel_hi:[1,1,1]
    v_pk_fma_f32 v[114:115], v[122:123], v[18:19], v[114:115] op_sel:[0,1,0] op_sel_hi:[1,1,1]
    v_pk_fma_f32 v[116:117], v[124:125], v[18:19], v[116:117] op_sel:[0,1,0] op_sel_hi:[1,1,1]
    v_pk_fma_f32 v[118:119], v[126:127], v[18:19], v[118:119] op_sel:[0,1,0] op_sel_hi:[1,1,1]
    s_waitcnt vmcnt(9)
    v_lshlrev_b32 v120, 16, v72
    v_and_b32 v121, 0xffff0000, v72
    v_lshlrev_b32 v122, 16, v73
    v_and_b32 v123, 0xffff0000, v73
    v_lshlrev_b32 v124, 16, v74
    v_and_b32 v125, 0xffff0000, v74
    v_lshlrev_b32 v126, 16, v75
    v_and_b32 v127, 0xffff0000, v75
    v_pk_fma_f32 v[112:113], v[120:121], v[20:21], v[112:113] op_sel:[0,0,0] op_sel_hi:[1,0,1]
    v_pk_fma_f32 v[114:115], v[122:123], v[20:21], v[114:115] op_sel:[0,0,0] op_sel_hi:[1,0,1]
    v_pk_fma_f32 v[116:117], v[124:125], v[20:21], v[116:117] op_sel:[0,0,0] op_sel_hi:[1,0,1]
    v_pk_fma_f32 v[118:119], v[126:127], v[20:21], v[118:119] op_sel:[0,0,0] op_sel_hi:[1,0,1]
    s_waitcnt vmcnt(8)
    v_lshlrev_b32 v120, 16, v76
    v_and_b32 v121, 0xffff0000, v76
    v_lshlrev_b32 v122, 16, v77
    v_and_b32 v123, 0xffff0000, v77
    v_lshlrev_b32 v124, 16, v78
    v_and_b32 v125, 0xffff0000, v78
    v_lshlrev_b32 v126, 16, v79
    v_and_b32 v127, 0xffff0000, v79
    v_pk_fma_f32 v[112:113], v[120:121], v[20:21], v[112:113] op_sel:[0,1,0] op_sel_hi:[1,1,1]
    v_pk_fma_f32 v[114:115], v[122:123], v[20:21], v[114:115] op_sel:[0,1,0] op_sel_hi:[1,1,1]
    v_pk_fma_f32 v[116:117], v[124:125], v[20:21], v[116:117] op_sel:[0,1,0] op_sel_hi:[1,1,1]
    v_pk_fma_f32 v[118:119], v[126:127], v[20:21], v[118:119] op_sel:[0,1,0] op_sel_hi:[1,1,1]
    s_waitcnt vmcnt(7)
    v_lshlrev_b32 v120, 16, v80
    v_and_b32 v121, 0xffff0000, v80
    v_lshlrev_b32 v122, 16, v81
    v_and_b32 v123, 0xffff0000, v81
    v_lshlrev_b32 v124, 16, v82
    v_and_b32 v125, 0xffff0000, v82
    v_lshlrev_b32 v126, 16, v83
    v_and_b32 v127, 0xffff0000, v83
    v_pk_fma_f32 v[112:113], v[120:121], v[22:23], v[112:113] op_sel:[0,0,0] op_sel_hi:[1,0,1]
    v_pk_fma_f32 v[114:115], v[122:123], v[22:23], v[114:115] op_sel:[0,0,0] op_sel_hi:[1,0,1]
    v_pk_fma_f32 v[116:117], v[124:125], v[22:23], v[116:117] op_sel:[0,0,0] op_sel_hi:[1,0,1]
    v_pk_fma_f32 v[118:119], v[126:127], v[22:23], v[118:119] op_sel:[0,0,0] op_sel_hi:[1,0,1]
    s_waitcnt vmcnt(6)
    v_lshlrev_b32 v120, 16, v84
    v_and_b32 v121, 0xffff0000, v84
    v_lshlrev_b32 v122, 16, v85
    v_and_b32 v123, 0xffff0000, v85
    v_lshlrev_b32 v124, 16, v86
    v_and_b32 v125, 0xffff0000, v86
    v_lshlrev_b32 v126, 16, v87
    v_and_b32 v127, 0xffff0000, v87
    v_pk_fma_f32 v[112:113], v[120:121], v[22:23], v[112:113] op_sel:[0,1,0] op_sel_hi:[1,1,1]
    v_pk_fma_f32 v[114:115], v[122:123], v[22:23], v[114:115] op_sel:[0,1,0] op_sel_hi:[1,1,1]
    v_pk_fma_f32 v[116:117], v[124:125], v[22:23], v[116:117] op_sel:[0,1,0] op_sel_hi:[1,1,1]
    v_pk_fma_f32 v[118:119], v[126:127], v[22:23], v[118:119] op_sel:[0,1,0] op_sel_hi:[1,1,1]
    s_waitcnt vmcnt(5)
    v_lshlrev_b32 v120, 16, v88
    v_and_b32 v121, 0xffff0000, v88
    v_lshlrev_b32 v122, 16, v89
    v_and_b32 v123, 0xffff0000, v89
    v_lshlrev_b32 v124, 16, v90
    v_and_b32 v125, 0xffff0000, v90
    v_lshlrev_b32 v126, 16, v91
    v_and_b32 v127, 0xffff0000, v91
    v_pk_fma_f32 v[112:113], v[120:121], v[24:25], v[112:113] op_sel:[0,0,0] op_sel_hi:[1,0,1]
    v_pk_fma_f32 v[114:115], v[122:123], v[24:25], v[114:115] op_sel:[0,0,0] op_sel_hi:[1,0,1]
    v_pk_fma_f32 v[116:117], v[124:125], v[24:25], v[116:117] op_sel:[0,0,0] op_sel_hi:[1,0,1]
    v_pk_fma_f32 v[118:119], v[126:127], v[24:25], v[118:119] op_sel:[0,0,0] op_sel_hi:[1,0,1]
    s_waitcnt vmcnt(4)
    v_lshlrev_b32 v120, 16, v92
    v_and_b32 v121, 0xffff0000, v92
    v_lshlrev_b32 v122, 16, v93
    v_and_b32 v123, 0xffff0000, v93
    v_lshlrev_b32 v124, 16, v94
    v_and_b32 v125, 0xffff0000, v94
    v_lshlrev_b32 v126, 16, v95
    v_and_b32 v127, 0xffff0000, v95
    v_pk_fma_f32 v[112:113], v[120:121], v[24:25], v[112:113] op_sel:[0,1,0] op_sel_hi:[1,1,1]
    v_pk_fma_f32 v[114:115], v[122:123], v[24:25], v[114:115] op_sel:[0,1,0] op_sel_hi:[1,1,1]
    v_pk_fma_f32 v[116:117], v[124:125], v[24:25], v[116:117] op_sel:[0,1,0] op_sel_hi:[1,1,1]
    v_pk_fma_f32 v[118:119], v[126:127], v[24:25], v[118:119] op_sel:[0,1,0] op_sel_hi:[1,1,1]
    s_waitcnt vmcnt(3)
    v_lshlrev_b32 v120, 16, v96
    v_and_b32 v121, 0xffff0000, v96
    v_lshlrev_b32 v122, 16, v97
    v_and_b32 v123, 0xffff0000, v97
    v_lshlrev_b32 v124, 16, v98
    v_and_b32 v125, 0xffff0000, v98
    v_lshlrev_b32 v126, 16, v99
    v_and_b32 v127, 0xffff0000, v99
    v_pk_fma_f32 v[112:113], v[120:121], v[26:27], v[112:113] op_sel:[0,0,0] op_sel_hi:[1,0,1]
    v_pk_fma_f32 v[114:115], v[122:123], v[26:27], v[114:115] op_sel:[0,0,0] op_sel_hi:[1,0,1]
    v_pk_fma_f32 v[116:117], v[124:125], v[26:27], v[116:117] op_sel:[0,0,0] op_sel_hi:[1,0,1]
    v_pk_fma_f32 v[118:119], v[126:127], v[26:27], v[118:119] op_sel:[0,0,0] op_sel_hi:[1,0,1]
    s_waitcnt vmcnt(2)
    v_lshlrev_b32 v120, 16, v100
    v_and_b32 v121, 0xffff0000, v100
    v_lshlrev_b32 v122, 16, v101
    v_and_b32 v123, 0xffff0000, v101
    v_lshlrev_b32 v124, 16, v102
    v_and_b32 v125, 0xffff0000, v102
    v_lshlrev_b32 v126, 16, v103
    v_and_b32 v127, 0xffff0000, v103
    v_pk_fma_f32 v[112:113], v[120:121], v[26:27], v[112:113] op_sel:[0,1,0] op_sel_hi:[1,1,1]
    v_pk_fma_f32 v[114:115], v[122:123], v[26:27], v[114:115] op_sel:[0,1,0] op_sel_hi:[1,1,1]
    v_pk_fma_f32 v[116:117], v[124:125], v[26:27], v[116:117] op_sel:[0,1,0] op_sel_hi:[1,1,1]
    v_pk_fma_f32 v[118:119], v[126:127], v[26:27], v[118:119] op_sel:[0,1,0] op_sel_hi:[1,1,1]
    s_waitcnt vmcnt(1)
    v_lshlrev_b32 v120, 16, v104
    v_and_b32 v121, 0xffff0000, v104
    v_lshlrev_b32 v122, 16, v105
    v_and_b32 v123, 0xffff0000, v105
    v_lshlrev_b32 v124, 16, v106
    v_and_b32 v125, 0xffff0000, v106
    v_lshlrev_b32 v126, 16, v107
    v_and_b32 v127, 0xffff0000, v107
    v_pk_fma_f32 v[112:113], v[120:121], v[28:29], v[112:113] op_sel:[0,0,0] op_sel_hi:[1,0,1]
    v_pk_fma_f32 v[114:115], v[122:123], v[28:29], v[114:115] op_sel:[0,0,0] op_sel_hi:[1,0,1]
    v_pk_fma_f32 v[116:117], v[124:125], v[28:29], v[116:117] op_sel:[0,0,0] op_sel_hi:[1,0,1]
    v_pk_fma_f32 v[118:119], v[126:127], v[28:29], v[118:119] op_sel:[0,0,0] op_sel_hi:[1,0,1]
    s_waitcnt vmcnt(0)
    v_lshlrev_b32 v120, 16, v108
    v_and_b32 v121, 0xffff0000, v108
    v_lshlrev_b32 v122, 16, v109
    v_and_b32 v123, 0xffff0000, v109
    v_lshlrev_b32 v124, 16, v110
    v_and_b32 v125, 0xffff0000, v110
    v_lshlrev_b32 v126, 16, v111
    v_and_b32 v127, 0xffff0000, v111
    v_pk_fma_f32 v[112:113], v[120:121], v[28:29], v[112:113] op_sel:[0,1,0] op_sel_hi:[1,1,1]
    v_pk_fma_f32 v[114:115], v[122:123], v[28:29], v[114:115] op_sel:[0,1,0] op_sel_hi:[1,1,1]
    v_pk_fma_f32 v[116:117], v[124:125], v[28:29], v[116:117] op_sel:[0,1,0] op_sel_hi:[1,1,1]
    v_pk_fma_f32 v[118:119], v[126:127], v[28:29], v[118:119] op_sel:[0,1,0] op_sel_hi:[1,1,1]
    v_lshlrev_b32 v7, 5, v0
    ds_write_b128 v7, v[112:115]
    ds_write_b128 v7, v[116:119] offset:16
    s_waitcnt lgkmcnt(0)
    s_barrier
    v_cmp_gt_u32 vcc, 64, v0
    s_and_saveexec_b64 s[42:43], vcc
    s_cbranch_execz k1_end
    v_lshlrev_b32 v7, 2, v0
    ds_read_b32 v32, v7 offset:0
    ds_read_b32 v33, v7 offset:256
    ds_read_b32 v34, v7 offset:512
    ds_read_b32 v35, v7 offset:768
    ds_read_b32 v36, v7 offset:1024
    ds_read_b32 v37, v7 offset:1280
    ds_read_b32 v38, v7 offset:1536
    ds_read_b32 v39, v7 offset:1792
    ds_read_b32 v40, v7 offset:2048
    ds_read_b32 v41, v7 offset:2304
    ds_read_b32 v42, v7 offset:2560
    ds_read_b32 v43, v7 offset:2816
    ds_read_b32 v44, v7 offset:3072
    ds_read_b32 v45, v7 offset:3328
    ds_read_b32 v46, v7 offset:3584
    ds_read_b32 v47, v7 offset:3840
    ds_read_b32 v48, v7 offset:4096
    ds_read_b32 v49, v7 offset:4352
    ds_read_b32 v50, v7 offset:4608
    ds_read_b32 v51, v7 offset:4864
    ds_read_b32 v52, v7 offset:5120
    ds_read_b32 v53, v7 offset:5376
    ds_read_b32 v54, v7 offset:5632
    ds_read_b32 v55, v7 offset:5888
    ds_read_b32 v56, v7 offset:6144
    ds_read_b32 v57, v7 offset:6400
    ds_read_b32 v58, v7 offset:6656
    ds_read_b32 v59, v7 offset:6912
    ds_read_b32 v60, v7 offset:7168
    ds_read_b32 v61, v7 offset:7424
    ds_read_b32 v62, v7 offset:7680
    ds_read_b32 v63, v7 offset:7936
    s_waitcnt lgkmcnt(0)
    v_add_f32 v32, v32, v48
    v_add_f32 v33, v33, v49
    v_add_f32 v34, v34, v50
    v_add_f32 v35, v35, v51
    v_add_f32 v36, v36, v52
    v_add_f32 v37, v37, v53
    v_add_f32 v38, v38, v54
    v_add_f32 v39, v39, v55
    v_add_f32 v40, v40, v56
    v_add_f32 v41, v41, v57
    v_add_f32 v42, v42, v58
    v_add_f32 v43, v43, v59
    v_add_f32 v44, v44, v60
    v_add_f32 v45, v45, v61
    v_add_f32 v46, v46, v62
    v_add_f32 v47, v47, v63
    v_add_f32 v32, v32, v40
    v_add_f32 v33, v33, v41
    v_add_f32 v34, v34, v42
    v_add_f32 v35, v35, v43
    v_add_f32 v36, v36, v44
    v_add_f32 v37, v37, v45
    v_add_f32 v38, v38, v46
    v_add_f32 v39, v39, v47
    v_add_f32 v32, v32, v36
    v_add_f32 v33, v33, v37
    v_add_f32 v34, v34, v38
    v_add_f32 v35, v35, v39
    v_add_f32 v32, v32, v34
    v_add_f32 v33, v33, v35
    v_add_f32 v32, v32, v33
    s_movk_i32 s22, 640
    v_cvt_pk_bf16_f32 v32, v32, v32
    v_lshlrev_b32 v32, 16, v32
    v_add_f32 v33, 1.0, v32
    v_cvt_pk_bf16_f32 v33, v33, v33
    v_lshlrev_b32 v33, 16, v33
    s_lshl_b32 s33, s32, 6
    v_add_u32 v34, s33, v0
    v_subrev_u32 v35, 640, v34
    v_cmp_gt_u32 vcc, 640, v35
    v_subrev_u32 v35, 2560, v34
    v_cmp_gt_u32 s[40:41], s22, v35
    s_or_b64 vcc, vcc, s[40:41]
    v_cndmask_b32 v32, v32, v33, vcc
    s_lshl_b32 s21, s32, 8
    s_add_u32 s21, s21, 2711552
    buffer_store_dword v32, v7, s[28:31], s21 offen sc1
k1_end:
    s_endpgm
k1_pf:
    s_waitcnt lgkmcnt(0)
    s_load_dwordx2 s[4:5], s[0:1], 0
    v_lshlrev_b32 v3, 7, v1
    v_lshlrev_b32 v1, 4, v1
    s_sub_u32 s24, s54, 96
    s_lshr_b32 s24, s24, 3
    s_lshl_b32 s24, s24, 2
    s_add_u32 s24, s24, s20
    s_and_b32 s22, s2, 7
    s_mul_i32 s21, s24, 20480
    s_mul_i32 s23, s22, 327680
    s_add_u32 s21, s21, s23
    s_waitcnt lgkmcnt(0)
    s_mov_b32 s16, s4
    s_mov_b32 s17, s5
    s_mov_b32 s18, 2621440
    s_mov_b32 s19, 0x00020000
    s_mov_b32 s28, s10
    s_mov_b32 s29, s11
    s_mov_b32 s30, 268435456
    s_mov_b32 s31, 0x00020000
    s_sub_u32 s36, s54, 96
    s_cmp_ge_u32 s36, 16
    s_cbranch_scc1 k1_kernel_zf21
    s_lshl_b32 s36, s36, 12
    s_add_u32 s36, s36, 8990720
    v_lshlrev_b32 v5, 4, v0
    v_mov_b32 v60, 0
    v_mov_b32 v61, 0
    v_mov_b32 v62, 0
    v_mov_b32 v63, 0
    buffer_store_dwordx4 v[60:63], v5, s[28:31], s36 offen sc1
k1_kernel_zf21:
    s_sub_u32 s36, s54, 96
    s_lshr_b32 s36, s36, 3
    s_mul_i32 s36, s36, 5120
    s_and_b32 s37, s2, 7
    s_mul_i32 s37, s37, 1601536
    s_add_u32 s36, s36, s37
    s_add_u32 s36, s36, 10641408
    v_lshlrev_b32 v5, 4, v0
    v_mov_b32 v60, 0
    v_mov_b32 v61, 0
    v_mov_b32 v62, 0
    v_mov_b32 v63, 0
    buffer_store_dwordx4 v[60:63], v5, s[28:31], s36 offen sc1
    s_add_u32 s36, s36, 4096
    s_cmp_lg_u32 s20, 0
    s_cbranch_scc1 k1_zst
    buffer_store_dwordx4 v[60:63], v5, s[28:31], s36 offen sc1
k1_zst:
    s_and_b32 s37, s2, 7
    s_cmp_eq_u32 s37, 0
    s_cselect_b32 s38, 9060352, 0
    s_cmp_eq_u32 s37, 7
    s_cselect_b32 s38, 20619264, s38
    s_cmp_eq_u32 s38, 0
    s_cbranch_scc1 k1_zht
    s_sub_u32 s36, s54, 96
    s_lshr_b32 s36, s36, 3
    s_mul_i32 s36, s36, 5120
    s_add_u32 s36, s36, s38
    buffer_store_dwordx4 v[60:63], v5, s[28:31], s36 offen sc1
    s_add_u32 s36, s36, 4096
    s_cmp_lg_u32 s20, 0
    s_cbranch_scc1 k1_zht
    buffer_store_dwordx4 v[60:63], v5, s[28:31], s36 offen sc1
k1_zht:
    s_getpc_b64 s[40:41]
k1_pcref:
    s_sub_u32 s40, s40, k1_pcref-k1_kernel
    s_subb_u32 s41, s41, 0
    s_lshl_b32 s42, s24, 12
    s_add_u32 s43, s42, 0
    s_min_u32 s43, s43, (CODE_END-k1_kernel-1020)&0xfffffff0
    v_add_u32 v6, s43, v1
    global_load_dwordx4 v[64:67], v6, s[40:41]
    s_add_u32 s43, s42, 1024
    s_min_u32 s43, s43, (CODE_END-k1_kernel-1020)&0xfffffff0
    v_add_u32 v6, s43, v1
    global_load_dwordx4 v[68:71], v6, s[40:41]
    s_add_u32 s43, s42, 2048
    s_min_u32 s43, s43, (CODE_END-k1_kernel-1020)&0xfffffff0
    v_add_u32 v6, s43, v1
    global_load_dwordx4 v[72:75], v6, s[40:41]
    s_add_u32 s43, s42, 3072
    s_min_u32 s43, s43, (CODE_END-k1_kernel-1020)&0xfffffff0
    v_add_u32 v6, s43, v1
    global_load_dwordx4 v[76:79], v6, s[40:41]
    s_mov_b32 s61, s21
    s_mov_b32 s62, s24
    s_waitcnt vmcnt(0)
    s_cmp_lg_u32 s20, 0
    s_cbranch_scc1 k1_kernel_sw23
    s_and_b32 s55, s2, 7
    s_lshl_b32 s57, s55, 9
    s_add_u32 s57, s57, 9056256
    v_mov_b32 v250, 0
    v_and_b32 v248, 31, v0
    v_lshlrev_b32 v248, 2, v248
    s_waitcnt lgkmcnt(0)
    s_mov_b32 s28, s10
    s_mov_b32 s29, s11
    s_mov_b32 s30, 268435456
    s_mov_b32 s31, 0x00020000
    buffer_load_dword v251, v250, s[28:31], s57 offen sc1
    s_mov_b32 s23, 1
    s_waitcnt vmcnt(0)
    v_add_u32 v251, 1, v251
k1_kernel_sw22:
    buffer_load_dword v249, v248, s[28:31], s57 offen offset:256 sc1
    s_waitcnt vmcnt(0)
    v_cmp_eq_u32 vcc, v251, v249
    s_sub_u32 s23, s23, 1
    s_cmp_eq_u64 vcc, -1
    s_cbranch_scc1 k1_kernel_sw23
    s_sleep 16
    s_cmp_lg_u32 s23, 0
    s_cbranch_scc1 k1_kernel_sw22
k1_kernel_sw23:
    s_barrier
    s_mov_b32 s21, s61
    s_mov_b32 s24, s62
    s_mov_b32 s28, s10
    s_mov_b32 s29, s11
    s_mov_b32 s30, 268435456
    s_mov_b32 s31, 0x00020000
    buffer_load_dwordx4 v[8:11], v1, s[16:19], s21 offen offset:0
    buffer_load_dwordx4 v[12:15], v1, s[16:19], s21 offen offset:1024
    buffer_load_dwordx4 v[16:19], v1, s[16:19], s21 offen offset:2048
    buffer_load_dwordx4 v[20:23], v1, s[16:19], s21 offen offset:3072
    s_add_u32 s21, s21, 4096
    buffer_load_dwordx4 v[24:27], v1, s[16:19], s21 offen offset:0
    buffer_load_dwordx4 v[28:31], v1, s[16:19], s21 offen offset:1024
    buffer_load_dwordx4 v[32:35], v1, s[16:19], s21 offen offset:2048
    buffer_load_dwordx4 v[36:39], v1, s[16:19], s21 offen offset:3072
    s_add_u32 s21, s21, 4096
    buffer_load_dwordx4 v[40:43], v1, s[16:19], s21 offen offset:0
    buffer_load_dwordx4 v[44:47], v1, s[16:19], s21 offen offset:1024
    buffer_load_dwordx4 v[8:11], v1, s[16:19], s21 offen offset:2048
    buffer_load_dwordx4 v[12:15], v1, s[16:19], s21 offen offset:3072
    s_add_u32 s21, s21, 4096
    buffer_load_dwordx4 v[16:19], v1, s[16:19], s21 offen offset:0
    buffer_load_dwordx4 v[20:23], v1, s[16:19], s21 offen offset:1024
    buffer_load_dwordx4 v[24:27], v1, s[16:19], s21 offen offset:2048
    buffer_load_dwordx4 v[28:31], v1, s[16:19], s21 offen offset:3072
    s_add_u32 s21, s21, 4096
    buffer_load_dwordx4 v[32:35], v1, s[16:19], s21 offen offset:0
    buffer_load_dwordx4 v[36:39], v1, s[16:19], s21 offen offset:1024
    buffer_load_dwordx4 v[40:43], v1, s[16:19], s21 offen offset:2048
    buffer_load_dwordx4 v[44:47], v1, s[16:19], s21 offen offset:3072
    s_add_u32 s21, s21, 4096
    s_mul_i32 s22, s22, 1601536
    s_add_u32 s22, s22, 9060352
    s_waitcnt vmcnt(0)
    s_endpgm
.globl k2_kernel
.p2align 8
.type k2_kernel,@function
k2_kernel:
    s_cmp_ge_u32 s2, 256
    s_cbranch_scc1 k2_end
    s_load_dwordx2 s[4:5], s[0:1], 0
    s_load_dwordx2 s[6:7], s[0:1], 104
    s_load_dwordx2 s[8:9], s[0:1], 120
    s_getreg_b32 s42, hwreg(HW_REG_XCC_ID, 0, 4)
    v_lshrrev_b32 v2, 6, v0
    v_and_b32 v1, 63, v0
    v_readfirstlane_b32 s30, v2
    s_and_b32 s28, s2, 7
    s_lshr_b32 s29, s2, 3
    s_lshr_b32 s32, s29, 3
    s_and_b32 s33, s29, 7
    s_lshr_b32 s34, s29, 4
    s_and_b32 s35, s29, 15
    s_mul_i32 s36, s28, 1601536
    s_add_u32 s36, s36, 9060352
    s_lshl_b32 s37, s28, 13
    s_add_u32 s37, s37, 8990720
    s_add_u32 s42, s42, 1
    s_mov_b32 s31, 0
    v_lshlrev_b32 v2, 4, v1
    v_lshrrev_b32 v3, 4, v1
    v_and_b32 v4, 15, v1
    v_lshrrev_b32 v8, 1, v3
    v_lshl_add_u32 v8, v8, 4, v4
    v_and_b32 v9, 1, v3
    v_lshl_add_u32 v8, v8, 1, v9
    v_lshlrev_b32 v8, 3, v8
    v_lshlrev_b32 v5, 7, v1
    v_and_b32 v9, 1, v3
    v_lshlrev_b32 v9, 1, v9
    v_lshrrev_b32 v10, 1, v3
    v_or_b32 v9, v9, v10
    v_lshlrev_b32 v9, 8, v9
    v_lshl_add_u32 v254, v4, 4, v9
    s_waitcnt lgkmcnt(0)
    s_mov_b32 s12, s8
    s_mov_b32 s13, s9
    s_mov_b32 s14, 268435456
    s_mov_b32 s15, 0x00020000
    s_mov_b32 s16, s4
    s_mov_b32 s17, s5
    s_mov_b32 s18, 2621440
    s_mov_b32 s19, 0x00020000
    s_mov_b32 s24, s6
    s_mov_b32 s25, s7
    s_mov_b32 s26, 2621440
    s_mov_b32 s27, 0x00020000
    s_cmp_lg_u32 s30, 0
    s_cbranch_scc1 k2_kernel_L1
    s_lshl_b32 s41, s29, 2
    s_add_u32 s41, s41, s37
    v_mov_b32 v9, s42
    v_mov_b32 v10, 7424
    s_mov_b64 exec, 1
    buffer_store_dword v9, v10, s[12:15], s41 offen sc1
    s_mov_b64 exec, -1
k2_kernel_L1:
    s_mul_i32 s44, s33, 102400
    s_mul_i32 s45, s35, 143360
    s_add_u32 s45, s45, 4403200
    s_mul_i32 s40, s33, 286720
    s_mul_i32 s41, s30, 71680
    s_add_u32 s40, s40, s41
    s_add_u32 s40, s40, 6696960
    s_lshl_b32 s46, s32, 2
    s_add_u32 s46, s46, s30
    s_mul_i32 s47, s46, 20480
    s_mul_i32 s41, s33, 2560
    s_add_u32 s47, s47, s41
    s_add_u32 s54, s47, s36
    s_lshl_b32 s55, s46, 7
    s_add_u32 s55, s55, s37
    s_mul_i32 s22, s28, 327680
    s_add_u32 s22, s22, s47
    s_add_u32 s22, s22, 0
    s_mul_i32 s38, s30, 25600
    s_add_u32 s39, s38, s44
    s_add_u32 s39, s39, 2764800
    s_add_u32 s38, s38, 0
    s_cmp_ge_u32 s29, 18
    s_cbranch_scc1 k2_kernel_nob02
    s_lshl_b32 s46, s28, 8
    s_lshl_b32 s47, s29, 4
    s_add_u32 s46, s46, s47
    s_sub_u32 s46, s46, 16
    s_lshl_b32 s47, s30, 2
    s_add_u32 s47, s47, s46
    v_add_u32 v11, s47, v3
    s_movk_i32 s48, 1280
    v_mul_lo_u32 v6, v11, s48
    v_lshl_add_u32 v6, v4, 4, v6
    buffer_load_dwordx4 v[16:19], v6, s[16:19], 0 offen offset:0
    buffer_load_dwordx4 v[20:23], v6, s[16:19], 0 offen offset:256
    buffer_load_dwordx4 v[24:27], v6, s[16:19], 0 offen offset:512
    buffer_load_dwordx4 v[28:31], v6, s[16:19], 0 offen offset:768
    buffer_load_dwordx4 v[32:35], v6, s[16:19], 0 offen offset:1024
    s_mul_i32 s47, s29, 20480
    s_mul_i32 s48, s30, 5120
    s_add_u32 s47, s47, s48
    s_add_u32 s47, s47, s36
    v_add_u32 v12, s47, v2
    s_add_u32 s48, s48, 135168
    s_mov_b32 m0, s48
    s_nop 0
    buffer_load_dwordx4 v12, s[12:15], 0 offen offset:0 lds
    buffer_load_dwordx4 v12, s[12:15], 0 offen offset:1024 lds
    buffer_load_dwordx4 v12, s[12:15], 0 offen offset:2048 lds
    buffer_load_dwordx4 v12, s[12:15], 0 offen offset:3072 lds
    s_add_u32 s48, s48, 4096
    s_mov_b32 m0, s48
    s_movk_i32 s47, 4096
    buffer_load_dwordx4 v12, s[12:15], s47 offen lds
    s_lshl_b32 s47, s30, 12
    s_add_u32 s48, s47, 118784
    s_add_u32 s41, s47, 0
    s_min_u32 s41, s41, 14336
    s_add_u32 s41, s41, 2711552
    s_add_u32 m0, s48, 0
    s_nop 0
    buffer_load_dwordx4 v2, s[12:15], s41 offen lds
    s_add_u32 s41, s47, 1024
    s_min_u32 s41, s41, 14336
    s_add_u32 s41, s41, 2711552
    s_add_u32 m0, s48, 1024
    s_nop 0
    buffer_load_dwordx4 v2, s[12:15], s41 offen lds
    s_add_u32 s41, s47, 2048
    s_min_u32 s41, s41, 14336
    s_add_u32 s41, s41, 2711552
    s_add_u32 m0, s48, 2048
    s_nop 0
    buffer_load_dwordx4 v2, s[12:15], s41 offen lds
    s_add_u32 s41, s47, 3072
    s_min_u32 s41, s41, 14336
    s_add_u32 s41, s41, 2711552
    s_add_u32 m0, s48, 3072
    s_nop 0
    buffer_load_dwordx4 v2, s[12:15], s41 offen lds
    v_lshl_add_u32 v15, s30, 2, v3
    v_lshrrev_b32 v7, 1, v15
    v_and_b32 v9, 7, v4
    v_xor_b32 v7, v7, v9
    v_and_b32 v9, 1, v15
    v_lshl_add_u32 v7, v7, 1, v9
    v_lshlrev_b32 v7, 3, v7
    v_lshl_add_u32 v7, v4, 8, v7
    v_add_u32 v7, 135168, v7
    v_lshlrev_b32 v10, 5, v4
    v_add_u32 v10, 118784, v10
    v_lshrrev_b32 v12, 2, v4
    v_and_b32 v13, 3, v4
    v_lshl_add_u32 v13, v13, 4, v15
    v_lshlrev_b32 v13, 4, v13
    v_lshl_add_u32 v6, v12, 10, v13
    s_movk_i32 s48, 2048
    v_cmp_gt_u32 s[50:51], s48, v11
    v_mov_b32 v120, 0
    v_mov_b32 v121, 0
    v_mov_b32 v124, 0
    v_mov_b32 v125, 0
    v_mov_b32 v126, 0x3f803f80
    s_waitcnt vmcnt(9)
    v_dot2_f32_bf16 v120, v16, v126, v120
    v_dot2_f32_bf16 v121, v16, v16, v121
    v_lshlrev_b32 v56, 16, v16
    v_and_b32 v57, 0xffff0000, v16
    v_dot2_f32_bf16 v120, v17, v126, v120
    v_dot2_f32_bf16 v121, v17, v17, v121
    v_lshlrev_b32 v58, 16, v17
    v_and_b32 v59, 0xffff0000, v17
    v_dot2_f32_bf16 v120, v18, v126, v120
    v_dot2_f32_bf16 v121, v18, v18, v121
    v_lshlrev_b32 v60, 16, v18
    v_and_b32 v61, 0xffff0000, v18
    s_cmp_eq_u32 s30, 1
    s_cbranch_scc1 k2_kernel_sm4
    s_cmp_ge_u32 s30, 2
    s_cbranch_scc1 k2_kernel_sm5
    s_mul_i32 s41, s33, 320
    s_add_u32 s41, s41, 2748416
    s_mov_b32 m0, 155648
    s_mov_b64 exec, 0xfffff
    buffer_load_dwordx4 v2, s[12:15], s41 offen lds
    s_add_u32 s41, s41, 7168
    s_mov_b32 m0, 156160
    s_nop 0
    buffer_load_dwordx4 v2, s[12:15], s41 offen lds
    s_branch k2_kernel_sm6
k2_kernel_sm4:
    s_mul_i32 s41, s35, 448
    s_add_u32 s41, s41, 2732032
    s_mov_b32 m0, 156672
    s_mov_b64 exec, 0xfffffff
    buffer_load_dwordx4 v2, s[12:15], s41 offen lds
    s_add_u32 s41, s41, 7168
    s_mov_b32 m0, 157184
    s_nop 0
    buffer_load_dwordx4 v2, s[12:15], s41 offen lds
    s_branch k2_kernel_sm6
k2_kernel_sm5:
    s_mul_i32 s41, s33, 320
    s_add_u32 s41, s41, 2724352
    s_mov_b32 m0, 157696
    s_mov_b64 exec, 0xfffff
    buffer_load_dwordx4 v2, s[12:15], s41 offen lds
k2_kernel_sm6:
    s_mov_b64 exec, -1
    v_dot2_f32_bf16 v120, v19, v126, v120
    v_dot2_f32_bf16 v121, v19, v19, v121
    v_lshlrev_b32 v62, 16, v19
    v_and_b32 v63, 0xffff0000, v19
    v_dot2_f32_bf16 v120, v20, v126, v120
    v_dot2_f32_bf16 v121, v20, v20, v121
    v_lshlrev_b32 v64, 16, v20
    v_and_b32 v65, 0xffff0000, v20
    s_mov_b32 m0, s38
    s_nop 0
    buffer_load_dwordx4 v2, s[12:15], s39 offen offset:0 lds
    v_dot2_f32_bf16 v120, v21, v126, v120
    v_dot2_f32_bf16 v121, v21, v21, v121
    v_lshlrev_b32 v66, 16, v21
    v_and_b32 v67, 0xffff0000, v21
    v_dot2_f32_bf16 v120, v22, v126, v120
    v_dot2_f32_bf16 v121, v22, v22, v121
    v_lshlrev_b32 v68, 16, v22
    v_and_b32 v69, 0xffff0000, v22
    s_mov_b32 m0, s38
    s_nop 0
    buffer_load_dwordx4 v2, s[12:15], s39 offen offset:1024 lds
    v_dot2_f32_bf16 v120, v23, v126, v120
    v_dot2_f32_bf16 v121, v23, v23, v121
    v_lshlrev_b32 v70, 16, v23
    v_and_b32 v71, 0xffff0000, v23
    v_dot2_f32_bf16 v120, v24, v126, v120
    v_dot2_f32_bf16 v121, v24, v24, v121
    v_lshlrev_b32 v72, 16, v24
    v_and_b32 v73, 0xffff0000, v24
    s_mov_b32 m0, s38
    s_nop 0
    buffer_load_dwordx4 v2, s[12:15], s39 offen offset:2048 lds
    v_dot2_f32_bf16 v120, v25, v126, v120
    v_dot2_f32_bf16 v121, v25, v25, v121
    v_lshlrev_b32 v74, 16, v25
    v_and_b32 v75, 0xffff0000, v25
    v_dot2_f32_bf16 v120, v26, v126, v120
    v_dot2_f32_bf16 v121, v26, v26, v121
    v_lshlrev_b32 v76, 16, v26
    v_and_b32 v77, 0xffff0000, v26
    s_mov_b32 m0, s38
    s_nop 0
    buffer_load_dwordx4 v2, s[12:15], s39 offen offset:3072 lds
    s_add_u32 s38, s38, 4096
    s_add_u32 s39, s39, 4096
    v_dot2_f32_bf16 v120, v27, v126, v120
    v_dot2_f32_bf16 v121, v27, v27, v121
    v_lshlrev_b32 v78, 16, v27
    v_and_b32 v79, 0xffff0000, v27
    v_dot2_f32_bf16 v120, v28, v126, v120
    v_dot2_f32_bf16 v121, v28, v28, v121
    v_lshlrev_b32 v80, 16, v28
    v_and_b32 v81, 0xffff0000, v28
    s_mov_b32 m0, s38
    s_nop 0
    buffer_load_dwordx4 v2, s[12:15], s39 offen offset:0 lds
    v_dot2_f32_bf16 v120, v29, v126, v120
    v_dot2_f32_bf16 v121, v29, v29, v121
    v_lshlrev_b32 v82, 16, v29
    v_and_b32 v83, 0xffff0000, v29
    v_dot2_f32_bf16 v120, v30, v126, v120
    v_dot2_f32_bf16 v121, v30, v30, v121
    v_lshlrev_b32 v84, 16, v30
    v_and_b32 v85, 0xffff0000, v30
    s_mov_b32 m0, s38
    s_nop 0
    buffer_load_dwordx4 v2, s[12:15], s39 offen offset:1024 lds
    v_dot2_f32_bf16 v120, v31, v126, v120
    v_dot2_f32_bf16 v121, v31, v31, v121
    v_lshlrev_b32 v86, 16, v31
    v_and_b32 v87, 0xffff0000, v31
    v_dot2_f32_bf16 v120, v32, v126, v120
    v_dot2_f32_bf16 v121, v32, v32, v121
    v_lshlrev_b32 v88, 16, v32
    v_and_b32 v89, 0xffff0000, v32
    s_mov_b32 m0, s38
    s_nop 0
    buffer_load_dwordx4 v2, s[12:15], s39 offen offset:2048 lds
    v_dot2_f32_bf16 v120, v33, v126, v120
    v_dot2_f32_bf16 v121, v33, v33, v121
    v_lshlrev_b32 v90, 16, v33
    v_and_b32 v91, 0xffff0000, v33
    v_dot2_f32_bf16 v120, v34, v126, v120
    v_dot2_f32_bf16 v121, v34, v34, v121
    v_lshlrev_b32 v92, 16, v34
    v_and_b32 v93, 0xffff0000, v34
    s_mov_b32 m0, s38
    s_nop 0
    buffer_load_dwordx4 v2, s[12:15], s39 offen offset:3072 lds
    s_add_u32 s38, s38, 4096
    s_add_u32 s39, s39, 4096
    v_dot2_f32_bf16 v120, v35, v126, v120
    v_dot2_f32_bf16 v121, v35, v35, v121
    v_lshlrev_b32 v94, 16, v35
    v_and_b32 v95, 0xffff0000, v35
    s_nop 1
    s_nop 0
    v_add_f32_dpp v120, v120, v120 quad_perm:[1,0,3,2] row_mask:0xf bank_mask:0xf
    v_add_f32_dpp v121, v121, v121 quad_perm:[1,0,3,2] row_mask:0xf bank_mask:0xf
    s_nop 0
    v_add_f32_dpp v120, v120, v120 quad_perm:[2,3,0,1] row_mask:0xf bank_mask:0xf
    v_add_f32_dpp v121, v121, v121 quad_perm:[2,3,0,1] row_mask:0xf bank_mask:0xf
    s_nop 0
    v_add_f32_dpp v120, v120, v120 row_half_mirror row_mask:0xf bank_mask:0xf
    v_add_f32_dpp v121, v121, v121 row_half_mirror row_mask:0xf bank_mask:0xf
    s_nop 0
    v_add_f32_dpp v120, v120, v120 row_mirror row_mask:0xf bank_mask:0xf
    v_add_f32_dpp v121, v121, v121 row_mirror row_mask:0xf bank_mask:0xf
    v_mul_f32 v120, 0x3acccccd, v120
    v_mul_f32 v121, 0x3acccccd, v121
    v_fma_f32 v121, -v120, v120, v121
    v_max_f32 v121, 0, v121
    v_cvt_pk_bf16_f32 v122, v120, v121
    v_lshlrev_b32 v120, 16, v122
    v_and_b32 v121, 0xffff0000, v122
    v_add_f32 v121, 0x3727c5ac, v121
    v_cvt_pk_bf16_f32 v122, v121, v121
    v_lshlrev_b32 v121, 16, v122
    v_sqrt_f32 v121, v121
    s_nop 0
    v_cvt_pk_bf16_f32 v122, v121, v121
    v_lshlrev_b32 v121, 16, v122
    v_rcp_f32 v121, v121
    s_nop 0
    v_mul_f32 v120, v120, v121
    v_sub_f32 v120, 0, v120
    s_waitcnt vmcnt(9)
    s_barrier
    ds_read_b64 v[36:37], v7 offset:0
    ds_read_b64 v[38:39], v7 offset:128
    ds_read_b64 v[40:41], v7 offset:4096
    ds_read_b64 v[42:43], v7 offset:4224
    ds_read_b64 v[44:45], v7 offset:8192
    ds_read_b64 v[46:47], v7 offset:8320
    ds_read_b64 v[48:49], v7 offset:12288
    ds_read_b64 v[50:51], v7 offset:12416
    ds_read_b64 v[52:53], v7 offset:16384
    ds_read_b64 v[54:55], v7 offset:16512
    ds_read_b128 v[96:99], v10 offset:2560
    ds_read_b128 v[100:103], v10 offset:2576
    ds_read_b128 v[104:107], v10 offset:0
    ds_read_b128 v[108:111], v10 offset:16
    ds_read_b128 v[112:115], v10 offset:5120
    ds_read_b128 v[116:119], v10 offset:5136
    ds_read_b128 v[160:163], v10 offset:3072
    ds_read_b128 v[164:167], v10 offset:3088
    ds_read_b128 v[168:171], v10 offset:512
    ds_read_b128 v[172:175], v10 offset:528
    ds_read_b128 v[176:179], v10 offset:5632
    ds_read_b128 v[180:183], v10 offset:5648
    s_waitcnt lgkmcnt(6)
    v_lshlrev_b32 v152, 16, v36
    v_and_b32 v153, 0xffff0000, v36
    v_lshlrev_b32 v154, 16, v37
    v_and_b32 v155, 0xffff0000, v37
    v_lshlrev_b32 v156, 16, v38
    v_and_b32 v157, 0xffff0000, v38
    v_lshlrev_b32 v158, 16, v39
    v_and_b32 v159, 0xffff0000, v39
    v_pk_fma_f32 v[144:145], v[56:57], v[120:121], v[120:121] op_sel:[0,1,0] op_sel_hi:[1,1,0]
    v_pk_fma_f32 v[146:147], v[58:59], v[120:121], v[120:121] op_sel:[0,1,0] op_sel_hi:[1,1,0]
    v_pk_fma_f32 v[148:149], v[60:61], v[120:121], v[120:121] op_sel:[0,1,0] op_sel_hi:[1,1,0]
    v_pk_fma_f32 v[150:151], v[62:63], v[120:121], v[120:121] op_sel:[0,1,0] op_sel_hi:[1,1,0]
    v_pk_fma_f32 v[144:145], v[144:145], v[96:97], v[104:105]
    v_pk_fma_f32 v[146:147], v[146:147], v[98:99], v[106:107]
    v_pk_fma_f32 v[148:149], v[148:149], v[100:101], v[108:109]
    v_pk_fma_f32 v[150:151], v[150:151], v[102:103], v[110:111]
    v_pk_mul_f32 v[144:145], v[144:145], v[152:153]
    v_pk_mul_f32 v[146:147], v[146:147], v[154:155]
    v_pk_mul_f32 v[148:149], v[148:149], v[156:157]
    v_pk_mul_f32 v[150:151], v[150:151], v[158:159]
    v_pk_fma_f32 v[56:57], v[112:113], v[144:145], v[56:57]
    v_pk_fma_f32 v[58:59], v[114:115], v[146:147], v[58:59]
    v_pk_fma_f32 v[60:61], v[116:117], v[148:149], v[60:61]
    v_pk_fma_f32 v[62:63], v[118:119], v[150:151], v[62:63]
    v_cvt_pk_bf16_f32 v16, v56, v57
    v_cvt_pk_bf16_f32 v17, v58, v59
    v_cvt_pk_bf16_f32 v18, v60, v61
    v_cvt_pk_bf16_f32 v19, v62, v63
    v_dot2_f32_bf16 v124, v16, v126, v124
    v_dot2_f32_bf16 v125, v16, v16, v125
    v_dot2_f32_bf16 v124, v17, v126, v124
    v_dot2_f32_bf16 v125, v17, v17, v125
    v_dot2_f32_bf16 v124, v18, v126, v124
    v_dot2_f32_bf16 v125, v18, v18, v125
    v_dot2_f32_bf16 v124, v19, v126, v124
    v_dot2_f32_bf16 v125, v19, v19, v125
    ds_read_b128 v[96:99], v10 offset:3584
    ds_read_b128 v[100:103], v10 offset:3600
    ds_read_b128 v[104:107], v10 offset:1024
    ds_read_b128 v[108:111], v10 offset:1040
    ds_read_b128 v[112:115], v10 offset:6144
    ds_read_b128 v[116:119], v10 offset:6160
    s_waitcnt lgkmcnt(6)
    v_lshlrev_b32 v152, 16, v40
    v_and_b32 v153, 0xffff0000, v40
    v_lshlrev_b32 v154, 16, v41
    v_and_b32 v155, 0xffff0000, v41
    v_lshlrev_b32 v156, 16, v42
    v_and_b32 v157, 0xffff0000, v42
    v_lshlrev_b32 v158, 16, v43
    v_and_b32 v159, 0xffff0000, v43
    v_pk_fma_f32 v[144:145], v[64:65], v[120:121], v[120:121] op_sel:[0,1,0] op_sel_hi:[1,1,0]
    v_pk_fma_f32 v[146:147], v[66:67], v[120:121], v[120:121] op_sel:[0,1,0] op_sel_hi:[1,1,0]
    v_pk_fma_f32 v[148:149], v[68:69], v[120:121], v[120:121] op_sel:[0,1,0] op_sel_hi:[1,1,0]
    v_pk_fma_f32 v[150:151], v[70:71], v[120:121], v[120:121] op_sel:[0,1,0] op_sel_hi:[1,1,0]
    v_pk_fma_f32 v[144:145], v[144:145], v[160:161], v[168:169]
    v_pk_fma_f32 v[146:147], v[146:147], v[162:163], v[170:171]
    v_pk_fma_f32 v[148:149], v[148:149], v[164:165], v[172:173]
    v_pk_fma_f32 v[150:151], v[150:151], v[166:167], v[174:175]
    v_pk_mul_f32 v[144:145], v[144:145], v[152:153]
    v_pk_mul_f32 v[146:147], v[146:147], v[154:155]
    v_pk_mul_f32 v[148:149], v[148:149], v[156:157]
    v_pk_mul_f32 v[150:151], v[150:151], v[158:159]
    v_pk_fma_f32 v[64:65], v[176:177], v[144:145], v[64:65]
    v_pk_fma_f32 v[66:67], v[178:179], v[146:147], v[66:67]
    v_pk_fma_f32 v[68:69], v[180:181], v[148:149], v[68:69]
    v_pk_fma_f32 v[70:71], v[182:183], v[150:151], v[70:71]
    v_cvt_pk_bf16_f32 v20, v64, v65
    v_cvt_pk_bf16_f32 v21, v66, v67
    v_cvt_pk_bf16_f32 v22, v68, v69
    v_cvt_pk_bf16_f32 v23, v70, v71
    v_dot2_f32_bf16 v124, v20, v126, v124
    v_dot2_f32_bf16 v125, v20, v20, v125
    v_dot2_f32_bf16 v124, v21, v126, v124
    v_dot2_f32_bf16 v125, v21, v21, v125
    v_dot2_f32_bf16 v124, v22, v126, v124
    v_dot2_f32_bf16 v125, v22, v22, v125
    v_dot2_f32_bf16 v124, v23, v126, v124
    v_dot2_f32_bf16 v125, v23, v23, v125
    ds_read_b128 v[160:163], v10 offset:4096
    ds_read_b128 v[164:167], v10 offset:4112
    ds_read_b128 v[168:171], v10 offset:1536
    ds_read_b128 v[172:175], v10 offset:1552
    ds_read_b128 v[176:179], v10 offset:6656
    ds_read_b128 v[180:183], v10 offset:6672
    s_waitcnt lgkmcnt(6)
    v_lshlrev_b32 v152, 16, v44
    v_and_b32 v153, 0xffff0000, v44
    v_lshlrev_b32 v154, 16, v45
    v_and_b32 v155, 0xffff0000, v45
    v_lshlrev_b32 v156, 16, v46
    v_and_b32 v157, 0xffff0000, v46
    v_lshlrev_b32 v158, 16, v47
    v_and_b32 v159, 0xffff0000, v47
    v_pk_fma_f32 v[144:145], v[72:73], v[120:121], v[120:121] op_sel:[0,1,0] op_sel_hi:[1,1,0]
    v_pk_fma_f32 v[146:147], v[74:75], v[120:121], v[120:121] op_sel:[0,1,0] op_sel_hi:[1,1,0]
    v_pk_fma_f32 v[148:149], v[76:77], v[120:121], v[120:121] op_sel:[0,1,0] op_sel_hi:[1,1,0]
    v_pk_fma_f32 v[150:151], v[78:79], v[120:121], v[120:121] op_sel:[0,1,0] op_sel_hi:[1,1,0]
    v_pk_fma_f32 v[144:145], v[144:145], v[96:97], v[104:105]
    v_pk_fma_f32 v[146:147], v[146:147], v[98:99], v[106:107]
    v_pk_fma_f32 v[148:149], v[148:149], v[100:101], v[108:109]
    v_pk_fma_f32 v[150:151], v[150:151], v[102:103], v[110:111]
    v_pk_mul_f32 v[144:145], v[144:145], v[152:153]
    v_pk_mul_f32 v[146:147], v[146:147], v[154:155]
    v_pk_mul_f32 v[148:149], v[148:149], v[156:157]
    v_pk_mul_f32 v[150:151], v[150:151], v[158:159]
    v_pk_fma_f32 v[72:73], v[112:113], v[144:145], v[72:73]
    v_pk_fma_f32 v[74:75], v[114:115], v[146:147], v[74:75]
    v_pk_fma_f32 v[76:77], v[116:117], v[148:149], v[76:77]
    v_pk_fma_f32 v[78:79], v[118:119], v[150:151], v[78:79]
    v_cvt_pk_bf16_f32 v24, v72, v73
    v_cvt_pk_bf16_f32 v25, v74, v75
    v_cvt_pk_bf16_f32 v26, v76, v77
    v_cvt_pk_bf16_f32 v27, v78, v79
    v_dot2_f32_bf16 v124, v24, v126, v124
    v_dot2_f32_bf16 v125, v24, v24, v125
    v_dot2_f32_bf16 v124, v25, v126, v124
    v_dot2_f32_bf16 v125, v25, v25, v125
    v_dot2_f32_bf16 v124, v26, v126, v124
    v_dot2_f32_bf16 v125, v26, v26, v125
    v_dot2_f32_bf16 v124, v27, v126, v124
    v_dot2_f32_bf16 v125, v27, v27, v125
    ds_read_b128 v[96:99], v10 offset:4608
    ds_read_b128 v[100:103], v10 offset:4624
    ds_read_b128 v[104:107], v10 offset:2048
    ds_read_b128 v[108:111], v10 offset:2064
    ds_read_b128 v[112:115], v10 offset:7168
    ds_read_b128 v[116:119], v10 offset:7184
    s_waitcnt lgkmcnt(6)
    v_lshlrev_b32 v152, 16, v48
    v_and_b32 v153, 0xffff0000, v48
    v_lshlrev_b32 v154, 16, v49
    v_and_b32 v155, 0xffff0000, v49
    v_lshlrev_b32 v156, 16, v50
    v_and_b32 v157, 0xffff0000, v50
    v_lshlrev_b32 v158, 16, v51
    v_and_b32 v159, 0xffff0000, v51
    v_pk_fma_f32 v[144:145], v[80:81], v[120:121], v[120:121] op_sel:[0,1,0] op_sel_hi:[1,1,0]
    v_pk_fma_f32 v[146:147], v[82:83], v[120:121], v[120:121] op_sel:[0,1,0] op_sel_hi:[1,1,0]
    v_pk_fma_f32 v[148:149], v[84:85], v[120:121], v[120:121] op_sel:[0,1,0] op_sel_hi:[1,1,0]
    v_pk_fma_f32 v[150:151], v[86:87], v[120:121], v[120:121] op_sel:[0,1,0] op_sel_hi:[1,1,0]
    v_pk_fma_f32 v[144:145], v[144:145], v[160:161], v[168:169]
    v_pk_fma_f32 v[146:147], v[146:147], v[162:163], v[170:171]
    v_pk_fma_f32 v[148:149], v[148:149], v[164:165], v[172:173]
    v_pk_fma_f32 v[150:151], v[150:151], v[166:167], v[174:175]
    v_pk_mul_f32 v[144:145], v[144:145], v[152:153]
    v_pk_mul_f32 v[146:147], v[146:147], v[154:155]
    v_pk_mul_f32 v[148:149], v[148:149], v[156:157]
    v_pk_mul_f32 v[150:151], v[150:151], v[158:159]
    v_pk_fma_f32 v[80:81], v[176:177], v[144:145], v[80:81]
    v_pk_fma_f32 v[82:83], v[178:179], v[146:147], v[82:83]
    v_pk_fma_f32 v[84:85], v[180:181], v[148:149], v[84:85]
    v_pk_fma_f32 v[86:87], v[182:183], v[150:151], v[86:87]
    v_cvt_pk_bf16_f32 v28, v80, v81
    v_cvt_pk_bf16_f32 v29, v82, v83
    v_cvt_pk_bf16_f32 v30, v84, v85
    v_cvt_pk_bf16_f32 v31, v86, v87
    v_dot2_f32_bf16 v124, v28, v126, v124
    v_dot2_f32_bf16 v125, v28, v28, v125
    v_dot2_f32_bf16 v124, v29, v126, v124
    v_dot2_f32_bf16 v125, v29, v29, v125
    v_dot2_f32_bf16 v124, v30, v126, v124
    v_dot2_f32_bf16 v125, v30, v30, v125
    v_dot2_f32_bf16 v124, v31, v126, v124
    v_dot2_f32_bf16 v125, v31, v31, v125
    s_waitcnt lgkmcnt(0)
    v_lshlrev_b32 v152, 16, v52
    v_and_b32 v153, 0xffff0000, v52
    v_lshlrev_b32 v154, 16, v53
    v_and_b32 v155, 0xffff0000, v53
    v_lshlrev_b32 v156, 16, v54
    v_and_b32 v157, 0xffff0000, v54
    v_lshlrev_b32 v158, 16, v55
    v_and_b32 v159, 0xffff0000, v55
    v_pk_fma_f32 v[144:145], v[88:89], v[120:121], v[120:121] op_sel:[0,1,0] op_sel_hi:[1,1,0]
    v_pk_fma_f32 v[146:147], v[90:91], v[120:121], v[120:121] op_sel:[0,1,0] op_sel_hi:[1,1,0]
    v_pk_fma_f32 v[148:149], v[92:93], v[120:121], v[120:121] op_sel:[0,1,0] op_sel_hi:[1,1,0]
    v_pk_fma_f32 v[150:151], v[94:95], v[120:121], v[120:121] op_sel:[0,1,0] op_sel_hi:[1,1,0]
    v_pk_fma_f32 v[144:145], v[144:145], v[96:97], v[104:105]
    v_pk_fma_f32 v[146:147], v[146:147], v[98:99], v[106:107]
    v_pk_fma_f32 v[148:149], v[148:149], v[100:101], v[108:109]
    v_pk_fma_f32 v[150:151], v[150:151], v[102:103], v[110:111]
    v_pk_mul_f32 v[144:145], v[144:145], v[152:153]
    v_pk_mul_f32 v[146:147], v[146:147], v[154:155]
    v_pk_mul_f32 v[148:149], v[148:149], v[156:157]
    v_pk_mul_f32 v[150:151], v[150:151], v[158:159]
    v_pk_fma_f32 v[88:89], v[112:113], v[144:145], v[88:89]
    v_pk_fma_f32 v[90:91], v[114:115], v[146:147], v[90:91]
    v_pk_fma_f32 v[92:93], v[116:117], v[148:149], v[92:93]
    v_pk_fma_f32 v[94:95], v[118:119], v[150:151], v[94:95]
    v_cvt_pk_bf16_f32 v32, v88, v89
    v_cvt_pk_bf16_f32 v33, v90, v91
    v_cvt_pk_bf16_f32 v34, v92, v93
    v_cvt_pk_bf16_f32 v35, v94, v95
    v_dot2_f32_bf16 v124, v32, v126, v124
    v_dot2_f32_bf16 v125, v32, v32, v125
    v_dot2_f32_bf16 v124, v33, v126, v124
    v_dot2_f32_bf16 v125, v33, v33, v125
    v_dot2_f32_bf16 v124, v34, v126, v124
    v_dot2_f32_bf16 v125, v34, v34, v125
    v_dot2_f32_bf16 v124, v35, v126, v124
    v_dot2_f32_bf16 v125, v35, v35, v125
    v_and_b32 v191, 31, v1
    v_lshlrev_b32 v191, 2, v191
    s_add_u32 s41, s37, 7424
    buffer_load_dword v190, v191, s[12:15], s41 offen sc1
    ds_read_b128 v[96:99], v10 offset:10240
    ds_read_b128 v[100:103], v10 offset:10256
    ds_read_b128 v[104:107], v10 offset:7680
    ds_read_b128 v[108:111], v10 offset:7696
    s_nop 1
    s_nop 0
    v_add_f32_dpp v124, v124, v124 quad_perm:[1,0,3,2] row_mask:0xf bank_mask:0xf
    v_add_f32_dpp v125, v125, v125 quad_perm:[1,0,3,2] row_mask:0xf bank_mask:0xf
    s_nop 0
    v_add_f32_dpp v124, v124, v124 quad_perm:[2,3,0,1] row_mask:0xf bank_mask:0xf
    v_add_f32_dpp v125, v125, v125 quad_perm:[2,3,0,1] row_mask:0xf bank_mask:0xf
    s_nop 0
    v_add_f32_dpp v124, v124, v124 row_half_mirror row_mask:0xf bank_mask:0xf
    v_add_f32_dpp v125, v125, v125 row_half_mirror row_mask:0xf bank_mask:0xf
    s_nop 0
    v_add_f32_dpp v124, v124, v124 row_mirror row_mask:0xf bank_mask:0xf
    v_add_f32_dpp v125, v125, v125 row_mirror row_mask:0xf bank_mask:0xf
    v_mul_f32 v124, 0x3acccccd, v124
    v_mul_f32 v125, 0x3acccccd, v125
    v_fma_f32 v125, -v124, v124, v125
    v_max_f32 v125, 0, v125
    v_cvt_pk_bf16_f32 v122, v124, v125
    v_lshlrev_b32 v124, 16, v122
    v_and_b32 v125, 0xffff0000, v122
    v_add_f32 v125, 0x3727c5ac, v125
    v_cvt_pk_bf16_f32 v122, v125, v125
    v_lshlrev_b32 v125, 16, v122
    v_sqrt_f32 v125, v125
    s_nop 0
    v_cvt_pk_bf16_f32 v122, v125, v125
    v_lshlrev_b32 v125, 16, v122
    v_rcp_f32 v125, v125
    s_nop 0
    v_mul_f32 v124, v124, v125
    v_sub_f32 v124, 0, v124
    v_mov_b32 v120, 0
    v_mov_b32 v121, 0
    ds_read_b128 v[160:163], v10 offset:10752
    ds_read_b128 v[164:167], v10 offset:10768
    ds_read_b128 v[168:171], v10 offset:8192
    ds_read_b128 v[172:175], v10 offset:8208
    s_waitcnt lgkmcnt(4)
    v_pk_fma_f32 v[56:57], v[56:57], v[124:125], v[124:125] op_sel:[0,1,0] op_sel_hi:[1,1,0]
    v_pk_fma_f32 v[58:59], v[58:59], v[124:125], v[124:125] op_sel:[0,1,0] op_sel_hi:[1,1,0]
    v_pk_fma_f32 v[60:61], v[60:61], v[124:125], v[124:125] op_sel:[0,1,0] op_sel_hi:[1,1,0]
    v_pk_fma_f32 v[62:63], v[62:63], v[124:125], v[124:125] op_sel:[0,1,0] op_sel_hi:[1,1,0]
    v_pk_fma_f32 v[56:57], v[56:57], v[96:97], v[104:105]
    v_pk_fma_f32 v[58:59], v[58:59], v[98:99], v[106:107]
    v_pk_fma_f32 v[60:61], v[60:61], v[100:101], v[108:109]
    v_pk_fma_f32 v[62:63], v[62:63], v[102:103], v[110:111]
    v_cvt_pk_bf16_f32 v36, v56, v57
    v_cvt_pk_bf16_f32 v37, v58, v59
    v_cvt_pk_bf16_f32 v38, v60, v61
    v_cvt_pk_bf16_f32 v39, v62, v63
    v_dot2_f32_bf16 v120, v36, v126, v120
    v_dot2_f32_bf16 v121, v36, v36, v121
    v_dot2_f32_bf16 v120, v37, v126, v120
    v_dot2_f32_bf16 v121, v37, v37, v121
    v_dot2_f32_bf16 v120, v38, v126, v120
    v_dot2_f32_bf16 v121, v38, v38, v121
    v_dot2_f32_bf16 v120, v39, v126, v120
    v_dot2_f32_bf16 v121, v39, v39, v121
    ds_read_b128 v[96:99], v10 offset:11264
    ds_read_b128 v[100:103], v10 offset:11280
    ds_read_b128 v[104:107], v10 offset:8704
    ds_read_b128 v[108:111], v10 offset:8720
    s_waitcnt lgkmcnt(4)
    v_pk_fma_f32 v[64:65], v[64:65], v[124:125], v[124:125] op_sel:[0,1,0] op_sel_hi:[1,1,0]
    v_pk_fma_f32 v[66:67], v[66:67], v[124:125], v[124:125] op_sel:[0,1,0] op_sel_hi:[1,1,0]
    v_pk_fma_f32 v[68:69], v[68:69], v[124:125], v[124:125] op_sel:[0,1,0] op_sel_hi:[1,1,0]
    v_pk_fma_f32 v[70:71], v[70:71], v[124:125], v[124:125] op_sel:[0,1,0] op_sel_hi:[1,1,0]
    v_pk_fma_f32 v[64:65], v[64:65], v[160:161], v[168:169]
    v_pk_fma_f32 v[66:67], v[66:67], v[162:163], v[170:171]
    v_pk_fma_f32 v[68:69], v[68:69], v[164:165], v[172:173]
    v_pk_fma_f32 v[70:71], v[70:71], v[166:167], v[174:175]
    v_cvt_pk_bf16_f32 v40, v64, v65
    v_cvt_pk_bf16_f32 v41, v66, v67
    v_cvt_pk_bf16_f32 v42, v68, v69
    v_cvt_pk_bf16_f32 v43, v70, v71
    v_dot2_f32_bf16 v120, v40, v126, v120
    v_dot2_f32_bf16 v121, v40, v40, v121
    v_dot2_f32_bf16 v120, v41, v126, v120
    v_dot2_f32_bf16 v121, v41, v41, v121
    v_dot2_f32_bf16 v120, v42, v126, v120
    v_dot2_f32_bf16 v121, v42, v42, v121
    v_dot2_f32_bf16 v120, v43, v126, v120
    v_dot2_f32_bf16 v121, v43, v43, v121
    ds_read_b128 v[160:163], v10 offset:11776
    ds_read_b128 v[164:167], v10 offset:11792
    ds_read_b128 v[168:171], v10 offset:9216
    ds_read_b128 v[172:175], v10 offset:9232
    s_waitcnt lgkmcnt(4)
    v_pk_fma_f32 v[72:73], v[72:73], v[124:125], v[124:125] op_sel:[0,1,0] op_sel_hi:[1,1,0]
    v_pk_fma_f32 v[74:75], v[74:75], v[124:125], v[124:125] op_sel:[0,1,0] op_sel_hi:[1,1,0]
    v_pk_fma_f32 v[76:77], v[76:77], v[124:125], v[124:125] op_sel:[0,1,0] op_sel_hi:[1,1,0]
    v_pk_fma_f32 v[78:79], v[78:79], v[124:125], v[124:125] op_sel:[0,1,0] op_sel_hi:[1,1,0]
    v_pk_fma_f32 v[72:73], v[72:73], v[96:97], v[104:105]
    v_pk_fma_f32 v[74:75], v[74:75], v[98:99], v[106:107]
    v_pk_fma_f32 v[76:77], v[76:77], v[100:101], v[108:109]
    v_pk_fma_f32 v[78:79], v[78:79], v[102:103], v[110:111]
    v_cvt_pk_bf16_f32 v44, v72, v73
    v_cvt_pk_bf16_f32 v45, v74, v75
    v_cvt_pk_bf16_f32 v46, v76, v77
    v_cvt_pk_bf16_f32 v47, v78, v79
    v_dot2_f32_bf16 v120, v44, v126, v120
    v_dot2_f32_bf16 v121, v44, v44, v121
    v_dot2_f32_bf16 v120, v45, v126, v120
    v_dot2_f32_bf16 v121, v45, v45, v121
    v_dot2_f32_bf16 v120, v46, v126, v120
    v_dot2_f32_bf16 v121, v46, v46, v121
    v_dot2_f32_bf16 v120, v47, v126, v120
    v_dot2_f32_bf16 v121, v47, v47, v121
    ds_read_b128 v[96:99], v10 offset:12288
    ds_read_b128 v[100:103], v10 offset:12304
    ds_read_b128 v[104:107], v10 offset:9728
    ds_read_b128 v[108:111], v10 offset:9744
    s_waitcnt lgkmcnt(4)
    v_pk_fma_f32 v[80:81], v[80:81], v[124:125], v[124:125] op_sel:[0,1,0] op_sel_hi:[1,1,0]
    v_pk_fma_f32 v[82:83], v[82:83], v[124:125], v[124:125] op_sel:[0,1,0] op_sel_hi:[1,1,0]
    v_pk_fma_f32 v[84:85], v[84:85], v[124:125], v[124:125] op_sel:[0,1,0] op_sel_hi:[1,1,0]
    v_pk_fma_f32 v[86:87], v[86:87], v[124:125], v[124:125] op_sel:[0,1,0] op_sel_hi:[1,1,0]
    v_pk_fma_f32 v[80:81], v[80:81], v[160:161], v[168:169]
    v_pk_fma_f32 v[82:83], v[82:83], v[162:163], v[170:171]
    v_pk_fma_f32 v[84:85], v[84:85], v[164:165], v[172:173]
    v_pk_fma_f32 v[86:87], v[86:87], v[166:167], v[174:175]
    v_cvt_pk_bf16_f32 v48, v80, v81
    v_cvt_pk_bf16_f32 v49, v82, v83
    v_cvt_pk_bf16_f32 v50, v84, v85
    v_cvt_pk_bf16_f32 v51, v86, v87
    v_dot2_f32_bf16 v120, v48, v126, v120
    v_dot2_f32_bf16 v121, v48, v48, v121
    v_dot2_f32_bf16 v120, v49, v126, v120
    v_dot2_f32_bf16 v121, v49, v49, v121
    v_dot2_f32_bf16 v120, v50, v126, v120
    v_dot2_f32_bf16 v121, v50, v50, v121
    v_dot2_f32_bf16 v120, v51, v126, v120
    v_dot2_f32_bf16 v121, v51, v51, v121
    s_waitcnt lgkmcnt(0)
    v_pk_fma_f32 v[88:89], v[88:89], v[124:125], v[124:125] op_sel:[0,1,0] op_sel_hi:[1,1,0]
    v_pk_fma_f32 v[90:91], v[90:91], v[124:125], v[124:125] op_sel:[0,1,0] op_sel_hi:[1,1,0]
    v_pk_fma_f32 v[92:93], v[92:93], v[124:125], v[124:125] op_sel:[0,1,0] op_sel_hi:[1,1,0]
    v_pk_fma_f32 v[94:95], v[94:95], v[124:125], v[124:125] op_sel:[0,1,0] op_sel_hi:[1,1,0]
    v_pk_fma_f32 v[88:89], v[88:89], v[96:97], v[104:105]
    v_pk_fma_f32 v[90:91], v[90:91], v[98:99], v[106:107]
    v_pk_fma_f32 v[92:93], v[92:93], v[100:101], v[108:109]
    v_pk_fma_f32 v[94:95], v[94:95], v[102:103], v[110:111]
    v_cvt_pk_bf16_f32 v52, v88, v89
    v_cvt_pk_bf16_f32 v53, v90, v91
    v_cvt_pk_bf16_f32 v54, v92, v93
    v_cvt_pk_bf16_f32 v55, v94, v95
    v_dot2_f32_bf16 v120, v52, v126, v120
    v_dot2_f32_bf16 v121, v52, v52, v121
    v_dot2_f32_bf16 v120, v53, v126, v120
    v_dot2_f32_bf16 v121, v53, v53, v121
    v_dot2_f32_bf16 v120, v54, v126, v120
    v_dot2_f32_bf16 v121, v54, v54, v121
    v_dot2_f32_bf16 v120, v55, v126, v120
    v_dot2_f32_bf16 v121, v55, v55, v121
    s_nop 1
    s_nop 0
    v_add_f32_dpp v120, v120, v120 quad_perm:[1,0,3,2] row_mask:0xf bank_mask:0xf
    v_add_f32_dpp v121, v121, v121 quad_perm:[1,0,3,2] row_mask:0xf bank_mask:0xf
    s_nop 0
    v_add_f32_dpp v120, v120, v120 quad_perm:[2,3,0,1] row_mask:0xf bank_mask:0xf
    v_add_f32_dpp v121, v121, v121 quad_perm:[2,3,0,1] row_mask:0xf bank_mask:0xf
    s_nop 0
    v_add_f32_dpp v120, v120, v120 row_half_mirror row_mask:0xf bank_mask:0xf
    v_add_f32_dpp v121, v121, v121 row_half_mirror row_mask:0xf bank_mask:0xf
    s_nop 0
    v_add_f32_dpp v120, v120, v120 row_mirror row_mask:0xf bank_mask:0xf
    v_add_f32_dpp v121, v121, v121 row_mirror row_mask:0xf bank_mask:0xf
    v_mul_f32 v120, 0x3acccccd, v120
    v_mul_f32 v121, 0x3acccccd, v121
    v_fma_f32 v121, -v120, v120, v121
    v_max_f32 v121, 0, v121
    v_cvt_pk_bf16_f32 v122, v120, v121
    v_lshlrev_b32 v120, 16, v122
    v_and_b32 v121, 0xffff0000, v122
    v_add_f32 v121, 0x3727c5ac, v121
    v_cvt_pk_bf16_f32 v122, v121, v121
    v_lshlrev_b32 v121, 16, v122
    v_sqrt_f32 v121, v121
    s_nop 0
    v_cvt_pk_bf16_f32 v122, v121, v121
    v_lshlrev_b32 v121, 16, v122
    v_rcp_f32 v121, v121
    s_nop 0
    v_mul_f32 v120, v120, v121
    v_sub_f32 v120, 0, v120
    v_cndmask_b32 v120, 0, v120, s[50:51]
    v_cndmask_b32 v121, 0, v121, s[50:51]
    s_mul_i32 s46, s29, 20480
    s_add_u32 s46, s46, s36
    s_add_u32 s47, s46, 348160
    s_lshl_b32 s48, s29, 7
    s_add_u32 s48, s48, s36
    s_add_u32 s48, s48, 1597440
    v_lshlrev_b32 v12, 3, v15
    s_lshl_b32 s49, s29, 7
    s_add_u32 s49, s49, s37
    s_lshl_b32 s41, s30, 2
    s_add_u32 s49, s49, s41
    s_waitcnt vmcnt(0)
    s_mov_b32 s43, 200000
k2_kernel_xp7:
    v_cmp_ne_u32 vcc, 0, v190
    s_sub_u32 s43, s43, 1
    s_cmp_eq_u64 vcc, -1
    s_cbranch_scc1 k2_kernel_xd8
    s_cmp_eq_u32 s43, 0
    s_cbranch_scc1 k2_kernel_xd8
    s_add_u32 s41, s37, 7424
    buffer_load_dword v190, v191, s[12:15], s41 offen sc1
    s_waitcnt vmcnt(0)
    s_branch k2_kernel_xp7
k2_kernel_xd8:
    v_cmp_eq_u32 vcc, s42, v190
    s_nop 1
    s_cmp_eq_u64 vcc, -1
    s_cselect_b32 s31, 1, 0
    s_barrier
    v_and_b32 v9, 7, v4
    v_xor_b32 v9, v15, v9
    v_and_b32 v10, 3, v4
    v_lshl_add_u32 v9, v10, 4, v9
    v_lshrrev_b32 v10, 2, v4
    v_lshl_add_u32 v9, v10, 6, v9
    v_lshlrev_b32 v9, 4, v9
    v_add_u32 v9, 114688, v9
    ds_write_b128 v9, v[36:39] offset:0
    ds_write_b128 v9, v[16:19] offset:20480
    ds_write_b128 v9, v[40:43] offset:4096
    ds_write_b128 v9, v[20:23] offset:24576
    ds_write_b128 v9, v[44:47] offset:8192
    ds_write_b128 v9, v[24:27] offset:28672
    ds_write_b128 v9, v[48:51] offset:12288
    ds_write_b128 v9, v[28:31] offset:32768
    ds_write_b128 v9, v[52:55] offset:16384
    ds_write_b128 v9, v[32:35] offset:36864
    v_xor_b32 v9, v4, v3
    v_xor_b32 v10, 4, v9
    v_lshl_add_u32 v9, v3, 4, v9
    v_lshl_add_u32 v10, v3, 4, v10
    s_mul_i32 s41, s30, 5120
    s_add_u32 s41, s41, 114688
    v_lshl_add_u32 v9, v9, 4, s41
    v_lshl_add_u32 v10, v10, 4, s41
    s_cmp_eq_u32 s30, 1
    s_cselect_b32 s41, 1, 0
    s_cmp_eq_u32 s30, 3
    s_cselect_b32 s41, 1, s41
    s_cmp_eq_u32 s41, 1
    v_mov_b32 v11, v9
    s_cbranch_scc0 k2_noswap
    v_mov_b32 v9, v10
    v_mov_b32 v10, v11
k2_noswap:
    s_mul_i32 s41, s30, 5120
    s_add_u32 s46, s46, s41
    s_add_u32 s47, s47, s41
    s_waitcnt lgkmcnt(0)
    s_barrier
    ds_read_b128 v[36:39], v9 offset:0
    ds_read_b128 v[40:43], v10 offset:1024
    ds_read_b128 v[44:47], v9 offset:2048
    ds_read_b128 v[48:51], v10 offset:3072
    ds_read_b128 v[52:55], v9 offset:4096
    ds_read_b128 v[220:223], v9 offset:20480
    ds_read_b128 v[224:227], v10 offset:21504
    ds_read_b128 v[228:231], v9 offset:22528
    ds_read_b128 v[232:235], v10 offset:23552
    ds_read_b128 v[236:239], v9 offset:24576
    s_add_u32 s52, s46, 4096
    s_sub_u32 s41, s29, 1
    s_cmp_lt_u32 s41, 16
    s_cselect_b32 s20, s47, 0x90000000
    s_cmp_eq_u32 s31, 0
    s_cbranch_scc1 k2_kernel_slow9
    s_waitcnt lgkmcnt(9)
    buffer_store_dwordx4 v[36:39], v2, s[12:15], s46 offen offset:0
    s_waitcnt lgkmcnt(8)
    buffer_store_dwordx4 v[40:43], v2, s[12:15], s46 offen offset:1024
    s_waitcnt lgkmcnt(7)
    buffer_store_dwordx4 v[44:47], v2, s[12:15], s46 offen offset:2048
    s_waitcnt lgkmcnt(6)
    buffer_store_dwordx4 v[48:51], v2, s[12:15], s46 offen offset:3072
    s_waitcnt lgkmcnt(5)
    buffer_store_dwordx4 v[52:55], v2, s[12:15], s52 offen offset:0
    v_cmp_eq_u32 vcc, 0, v4
    s_and_saveexec_b64 s[50:51], vcc
    buffer_store_dwordx2 v[120:121], v12, s[12:15], s48 offen
    s_mov_b64 exec, -1
    s_waitcnt vmcnt(0)
    v_mov_b32 v9, 1
    v_mov_b32 v10, 0
    s_mov_b64 exec, 1
    buffer_store_dword v9, v10, s[12:15], s49 offen
    s_mov_b64 exec, -1
    s_branch k2_kernel_sent10
k2_kernel_slow9:
    s_waitcnt lgkmcnt(9)
    buffer_store_dwordx4 v[36:39], v2, s[12:15], s46 offen offset:0 sc1
    s_waitcnt lgkmcnt(8)
    buffer_store_dwordx4 v[40:43], v2, s[12:15], s46 offen offset:1024 sc1
    s_waitcnt lgkmcnt(7)
    buffer_store_dwordx4 v[44:47], v2, s[12:15], s46 offen offset:2048 sc1
    s_waitcnt lgkmcnt(6)
    buffer_store_dwordx4 v[48:51], v2, s[12:15], s46 offen offset:3072 sc1
    s_waitcnt lgkmcnt(5)
    buffer_store_dwordx4 v[52:55], v2, s[12:15], s52 offen offset:0 sc1
    v_cmp_eq_u32 vcc, 0, v4
    s_and_saveexec_b64 s[50:51], vcc
    buffer_store_dwordx2 v[120:121], v12, s[12:15], s48 offen sc1
    s_mov_b64 exec, -1
    s_waitcnt vmcnt(0)
    v_mov_b32 v9, 1
    v_mov_b32 v10, 0
    s_mov_b64 exec, 1
    buffer_store_dword v9, v10, s[12:15], s49 offen sc1
    s_mov_b64 exec, -1
k2_kernel_sent10:
    s_mov_b32 s21, s49
    s_mov_b32 m0, s38
    s_nop 0
    buffer_load_dwordx4 v2, s[12:15], s39 offen offset:0 lds
    s_mov_b32 m0, s38
    s_nop 0
    buffer_load_dwordx4 v2, s[12:15], s39 offen offset:1024 lds
    s_mov_b32 m0, s38
    s_nop 0
    buffer_load_dwordx4 v2, s[12:15], s39 offen offset:2048 lds
    s_mov_b32 m0, s38
    s_nop 0
    buffer_load_dwordx4 v2, s[12:15], s39 offen offset:3072 lds
    s_add_u32 s38, s38, 4096
    s_add_u32 s39, s39, 4096
    s_mov_b32 m0, s38
    s_nop 0
    buffer_load_dwordx4 v2, s[12:15], s39 offen offset:0 lds
    s_mov_b32 m0, s38
    s_nop 0
    buffer_load_dwordx4 v2, s[12:15], s39 offen offset:1024 lds
    s_mov_b32 m0, s38
    s_nop 0
    buffer_load_dwordx4 v2, s[12:15], s39 offen offset:2048 lds
    s_mov_b32 m0, s38
    s_nop 0
    buffer_load_dwordx4 v2, s[12:15], s39 offen offset:3072 lds
    s_add_u32 s38, s38, 4096
    s_add_u32 s39, s39, 4096
    s_mov_b32 m0, s38
    s_nop 0
    buffer_load_dwordx4 v2, s[12:15], s39 offen offset:0 lds
    s_mov_b32 m0, s38
    s_nop 0
    buffer_load_dwordx4 v2, s[12:15], s39 offen offset:1024 lds
    s_mov_b32 m0, s38
    s_nop 0
    buffer_load_dwordx4 v2, s[12:15], s39 offen offset:2048 lds
    s_mov_b32 m0, s38
    s_nop 0
    buffer_load_dwordx4 v2, s[12:15], s39 offen offset:3072 lds
    s_add_u32 s38, s38, 4096
    s_add_u32 s39, s39, 4096
    s_mov_b32 m0, s38
    s_nop 0
    buffer_load_dwordx4 v2, s[12:15], s39 offen offset:0 lds
    s_mov_b32 m0, s38
    s_nop 0
    buffer_load_dwordx4 v2, s[12:15], s39 offen offset:1024 lds
    s_mov_b32 m0, s38
    s_nop 0
    buffer_load_dwordx4 v2, s[12:15], s39 offen offset:2048 lds
    s_mov_b32 m0, s38
    s_nop 0
    buffer_load_dwordx4 v2, s[12:15], s39 offen offset:3072 lds
    s_add_u32 s38, s38, 4096
    s_add_u32 s39, s39, 4096
    s_mov_b32 m0, s38
    s_nop 0
    buffer_load_dwordx4 v2, s[12:15], s39 offen offset:0 lds
    s_branch k2_kernel_join03
k2_kernel_nob02:
    s_getpc_b64 s[46:47]
k2_pcref:
    s_sub_u32 s46, s46, k2_pcref-k2_kernel
    s_subb_u32 s47, s47, 0
    s_sub_u32 s48, s29, 18
    s_lshl_b32 s48, s48, 2
    s_add_u32 s48, s48, s30
    s_lshl_b32 s48, s48, 10
    s_min_u32 s48, s48, (CODE_END-k2_kernel-1020)&0xfffffff0
    v_add_u32 v104, s48, v2
    global_load_dwordx4 v[108:111], v104, s[46:47]
    s_mov_b32 s21, 0
    s_mov_b32 s20, 0x90000000
    s_mul_i32 s38, s30, 25600
    s_add_u32 s39, s38, s44
    s_add_u32 s39, s39, 2764800
    v_and_b32 v191, 31, v1
    v_lshlrev_b32 v191, 2, v191
    s_add_u32 s41, s37, 7424
    buffer_load_dword v190, v191, s[12:15], s41 offen sc1
    s_waitcnt vmcnt(0)
    s_mov_b32 s43, 200000
k2_kernel_xp11:
    v_cmp_ne_u32 vcc, 0, v190
    s_sub_u32 s43, s43, 1
    s_cmp_eq_u64 vcc, -1
    s_cbranch_scc1 k2_kernel_xd12
    s_cmp_eq_u32 s43, 0
    s_cbranch_scc1 k2_kernel_xd12
    s_add_u32 s41, s37, 7424
    buffer_load_dword v190, v191, s[12:15], s41 offen sc1
    s_waitcnt vmcnt(0)
    s_branch k2_kernel_xp11
k2_kernel_xd12:
    v_cmp_eq_u32 vcc, s42, v190
    s_nop 1
    s_cmp_eq_u64 vcc, -1
    s_cselect_b32 s31, 1, 0
    s_cmp_eq_u32 s30, 1
    s_cbranch_scc1 k2_kernel_sm13
    s_cmp_ge_u32 s30, 2
    s_cbranch_scc1 k2_kernel_sm14
    s_mul_i32 s41, s33, 320
    s_add_u32 s41, s41, 2748416
    s_mov_b32 m0, 155648
    s_mov_b64 exec, 0xfffff
    buffer_load_dwordx4 v2, s[12:15], s41 offen lds
    s_add_u32 s41, s41, 7168
    s_mov_b32 m0, 156160
    s_nop 0
    buffer_load_dwordx4 v2, s[12:15], s41 offen lds
    s_branch k2_kernel_sm15
k2_kernel_sm13:
    s_mul_i32 s41, s35, 448
    s_add_u32 s41, s41, 2732032
    s_mov_b32 m0, 156672
    s_mov_b64 exec, 0xfffffff
    buffer_load_dwordx4 v2, s[12:15], s41 offen lds
    s_add_u32 s41, s41, 7168
    s_mov_b32 m0, 157184
    s_nop 0
    buffer_load_dwordx4 v2, s[12:15], s41 offen lds
    s_branch k2_kernel_sm15
k2_kernel_sm14:
    s_mul_i32 s41, s33, 320
    s_add_u32 s41, s41, 2724352
    s_mov_b32 m0, 157696
    s_mov_b64 exec, 0xfffff
    buffer_load_dwordx4 v2, s[12:15], s41 offen lds
k2_kernel_sm15:
    s_mov_b64 exec, -1
    s_mov_b32 m0, s38
    s_nop 0
    buffer_load_dwordx4 v2, s[12:15], s39 offen offset:0 lds
    s_mov_b32 m0, s38
    s_nop 0
    buffer_load_dwordx4 v2, s[12:15], s39 offen offset:1024 lds
    s_mov_b32 m0, s38
    s_nop 0
    buffer_load_dwordx4 v2, s[12:15], s39 offen offset:2048 lds
    s_mov_b32 m0, s38
    s_nop 0
    buffer_load_dwordx4 v2, s[12:15], s39 offen offset:3072 lds
    s_add_u32 s38, s38, 4096
    s_add_u32 s39, s39, 4096
    s_mov_b32 m0, s38
    s_nop 0
    buffer_load_dwordx4 v2, s[12:15], s39 offen offset:0 lds
    s_mov_b32 m0, s38
    s_nop 0
    buffer_load_dwordx4 v2, s[12:15], s39 offen offset:1024 lds
    s_mov_b32 m0, s38
    s_nop 0
    buffer_load_dwordx4 v2, s[12:15], s39 offen offset:2048 lds
    s_mov_b32 m0, s38
    s_nop 0
    buffer_load_dwordx4 v2, s[12:15], s39 offen offset:3072 lds
    s_add_u32 s38, s38, 4096
    s_add_u32 s39, s39, 4096
    s_mov_b32 m0, s38
    s_nop 0
    buffer_load_dwordx4 v2, s[12:15], s39 offen offset:0 lds
    s_mov_b32 m0, s38
    s_nop 0
    buffer_load_dwordx4 v2, s[12:15], s39 offen offset:1024 lds
    s_mov_b32 m0, s38
    s_nop 0
    buffer_load_dwordx4 v2, s[12:15], s39 offen offset:2048 lds
    s_mov_b32 m0, s38
    s_nop 0
    buffer_load_dwordx4 v2, s[12:15], s39 offen offset:3072 lds
    s_add_u32 s38, s38, 4096
    s_add_u32 s39, s39, 4096
    s_mov_b32 m0, s38
    s_nop 0
    buffer_load_dwordx4 v2, s[12:15], s39 offen offset:0 lds
    s_mov_b32 m0, s38
    s_nop 0
    buffer_load_dwordx4 v2, s[12:15], s39 offen offset:1024 lds
    s_mov_b32 m0, s38
    s_nop 0
    buffer_load_dwordx4 v2, s[12:15], s39 offen offset:2048 lds
    s_mov_b32 m0, s38
    s_nop 0
    buffer_load_dwordx4 v2, s[12:15], s39 offen offset:3072 lds
    s_add_u32 s38, s38, 4096
    s_add_u32 s39, s39, 4096
    s_mov_b32 m0, s38
    s_nop 0
    buffer_load_dwordx4 v2, s[12:15], s39 offen offset:0 lds
    s_mov_b32 m0, s38
    s_nop 0
    buffer_load_dwordx4 v2, s[12:15], s39 offen offset:1024 lds
    s_mov_b32 m0, s38
    s_nop 0
    buffer_load_dwordx4 v2, s[12:15], s39 offen offset:2048 lds
    s_mov_b32 m0, s38
    s_nop 0
    buffer_load_dwordx4 v2, s[12:15], s39 offen offset:3072 lds
    s_add_u32 s38, s38, 4096
    s_add_u32 s39, s39, 4096
    s_mov_b32 m0, s38
    s_nop 0
    buffer_load_dwordx4 v2, s[12:15], s39 offen offset:0 lds
    s_mov_b32 m0, s38
    s_nop 0
    buffer_load_dwordx4 v2, s[12:15], s39 offen offset:1024 lds
    s_mov_b32 m0, s38
    s_nop 0
    buffer_load_dwordx4 v2, s[12:15], s39 offen offset:2048 lds
    s_mov_b32 m0, s38
    s_nop 0
    buffer_load_dwordx4 v2, s[12:15], s39 offen offset:3072 lds
    s_add_u32 s38, s38, 4096
    s_add_u32 s39, s39, 4096
    s_mov_b32 m0, s38
    s_nop 0
    buffer_load_dwordx4 v2, s[12:15], s39 offen offset:0 lds
    s_mul_i32 s47, s28, 327680
    s_lshl_b32 s48, s29, 13
    s_add_u32 s47, s47, s48
    v_mov_b32 v101, 0
    s_mov_b64 exec, 1
    buffer_load_dword v102, v101, s[24:27], s47 offen
    s_mov_b64 exec, -1
    s_cmp_eq_u32 s31, 0
    s_cbranch_scc1 k2_kernel_nt16
    s_sub_u32 s47, s29, 18
    s_lshl_b32 s47, s47, 2
    s_add_u32 s47, s47, s30
    s_mul_i32 s48, s47, 6144
    s_min_u32 s48, s48, 321536
    s_mul_i32 s49, s28, 327680
    s_add_u32 s48, s48, s49
    s_add_u32 s48, s48, 0
    buffer_load_dwordx4 v[64:67], v2, s[12:15], s48 offen offset:0
    buffer_load_dwordx4 v[68:71], v2, s[12:15], s48 offen offset:1024
    buffer_load_dwordx4 v[72:75], v2, s[12:15], s48 offen offset:2048
    buffer_load_dwordx4 v[76:79], v2, s[12:15], s48 offen offset:3072
    s_add_u32 s48, s48, 4096
    buffer_load_dwordx4 v[80:83], v2, s[12:15], s48 offen offset:0
    buffer_load_dwordx4 v[84:87], v2, s[12:15], s48 offen offset:1024
    s_mul_i32 s48, s47, 384
    s_min_u32 s48, s48, 20096
    s_add_u32 s48, s48, s36
    s_add_u32 s48, s48, 1581056
    s_mov_b64 exec, 7
    buffer_load_dword v100, v5, s[12:15], s48 offen
    s_mov_b64 exec, -1
k2_kernel_nt16:
k2_kernel_join03:
    s_lshl_b32 s46, s32, 2
    s_add_u32 s46, s46, s30
    s_lshr_b32 s47, s33, 1
    s_and_b32 s48, s47, 1
    s_lshr_b32 s47, s47, 1
    s_add_u32 s47, s47, 1
    s_sub_u32 s49, 0, s47
    s_cmp_eq_u32 s48, 1
    s_cselect_b32 s47, s47, s49
    s_lshl_b32 s49, s46, 4
    s_add_u32 s49, s49, 16
    s_add_u32 s49, s49, s47
    v_add_u32 v9, s49, v4
    v_lshrrev_b32 v10, 4, v9
    v_mul_u32_u24 v6, 20480, v10
    v_and_b32 v10, 15, v9
    v_lshl_add_u32 v10, v3, 4, v10
    v_lshl_add_u32 v6, v10, 4, v6
    v_lshlrev_b32 v13, 3, v9
    s_add_u32 s49, s46, s48
    s_lshl_b32 s49, s49, 7
    s_add_u32 s49, s49, s37
    v_bfe_u32 v7, v1, 2, 1
    v_lshlrev_b32 v7, 7, v7
    v_and_b32 v9, 3, v1
    v_lshl_add_u32 v7, v9, 2, v7
    s_mov_b32 s43, 200000
k2_kernel_poll17:
    buffer_load_dword v9, v7, s[12:15], s49 offen sc1
    s_waitcnt vmcnt(0)
    v_cmp_ne_u32 vcc, 0, v9
    s_sub_u32 s43, s43, 1
    s_cmp_eq_u64 vcc, -1
    s_cbranch_scc1 k2_kernel_go18
    s_cmp_lg_u32 s43, 0
    s_cbranch_scc1 k2_kernel_poll17
k2_kernel_go18:
    s_add_u32 s41, s36, 0
    buffer_load_dwordx4 v[16:19], v6, s[12:15], s41 offen offset:0 sc1
    s_add_u32 s41, s36, 0
    buffer_load_dwordx4 v[20:23], v6, s[12:15], s41 offen offset:1024 sc1
    s_add_u32 s41, s36, 0
    buffer_load_dwordx4 v[24:27], v6, s[12:15], s41 offen offset:2048 sc1
    s_add_u32 s41, s36, 0
    buffer_load_dwordx4 v[28:31], v6, s[12:15], s41 offen offset:3072 sc1
    s_add_u32 s41, s36, 1597440
    buffer_load_dwordx2 v[176:177], v13, s[12:15], s41 offen sc1
    v_mov_b32 v14, v2
    v_add_u32 v15, 0x10000, v2
    v_add_u32 v11, 0x20000, v2
    s_barrier
    s_mul_i32 s38, s30, 13312
    s_add_u32 s39, s38, s44
    s_add_u32 s39, s39, 3584000
    s_add_u32 s38, s38, 102400
    ds_read_b128 v[96:99], v14 offset:0
    ds_read_b128 v[100:103], v14 offset:1024
    ds_read_b128 v[104:107], v14 offset:2048
    ds_read_b128 v[108:111], v14 offset:3072
    ds_read_b128 v[112:115], v14 offset:4096
    ds_read_b128 v[116:119], v14 offset:5120
    ds_read_b128 v[120:123], v14 offset:6144
    ds_read_b128 v[124:127], v14 offset:7168
    ds_read_b128 v[128:131], v14 offset:8192
    ds_read_b128 v[132:135], v14 offset:9216
    s_waitcnt vmcnt(4)
    s_waitcnt lgkmcnt(5)
    v_mfma_f32_16x16x32_bf16 v[156:159], v[96:99], v[16:19], 0
    s_add_u32 s41, s36, 4096
    buffer_load_dwordx4 v[32:35], v6, s[12:15], s41 offen offset:0 sc1
    v_mfma_f32_16x16x32_bf16 v[160:163], v[100:103], v[16:19], 0
    ds_read_b128 v[136:139], v14 offset:10240
    v_mfma_f32_16x16x32_bf16 v[164:167], v[104:107], v[16:19], 0
    ds_read_b128 v[140:143], v14 offset:11264
    v_mfma_f32_16x16x32_bf16 v[168:171], v[108:111], v[16:19], 0
    ds_read_b128 v[144:147], v14 offset:12288
    s_add_u32 s41, s36, 4096
    buffer_load_dwordx4 v[36:39], v6, s[12:15], s41 offen offset:1024 sc1
    v_mfma_f32_16x16x32_bf16 v[172:175], v[112:115], v[16:19], 0
    ds_read_b128 v[148:151], v14 offset:13312
    ds_read_b128 v[152:155], v14 offset:14336
    s_waitcnt vmcnt(5)
    s_waitcnt lgkmcnt(5)
    v_mfma_f32_16x16x32_bf16 v[156:159], v[116:119], v[20:23], v[156:159]
    s_add_u32 s41, s36, 4096
    buffer_load_dwordx4 v[40:43], v6, s[12:15], s41 offen offset:2048 sc1
    v_mfma_f32_16x16x32_bf16 v[160:163], v[120:123], v[20:23], v[160:163]
    ds_read_b128 v[96:99], v14 offset:15360
    v_mfma_f32_16x16x32_bf16 v[164:167], v[124:127], v[20:23], v[164:167]
    ds_read_b128 v[100:103], v14 offset:16384
    v_mfma_f32_16x16x32_bf16 v[168:171], v[128:131], v[20:23], v[168:171]
    ds_read_b128 v[104:107], v14 offset:17408
    s_add_u32 s41, s36, 4096
    buffer_load_dwordx4 v[44:47], v6, s[12:15], s41 offen offset:3072 sc1
    v_mfma_f32_16x16x32_bf16 v[172:175], v[132:135], v[20:23], v[172:175]
    ds_read_b128 v[108:111], v14 offset:18432
    ds_read_b128 v[112:115], v14 offset:19456
    s_waitcnt vmcnt(6)
    s_waitcnt lgkmcnt(5)
    v_mfma_f32_16x16x32_bf16 v[156:159], v[136:139], v[24:27], v[156:159]
    s_add_u32 s41, s36, 8192
    buffer_load_dwordx4 v[48:51], v6, s[12:15], s41 offen offset:0 sc1
    v_mfma_f32_16x16x32_bf16 v[160:163], v[140:143], v[24:27], v[160:163]
    ds_read_b128 v[116:119], v14 offset:20480
    v_mfma_f32_16x16x32_bf16 v[164:167], v[144:147], v[24:27], v[164:167]
    ds_read_b128 v[120:123], v14 offset:21504
    v_mfma_f32_16x16x32_bf16 v[168:171], v[148:151], v[24:27], v[168:171]
    ds_read_b128 v[124:127], v14 offset:22528
    s_add_u32 s41, s36, 8192
    buffer_load_dwordx4 v[52:55], v6, s[12:15], s41 offen offset:1024 sc1
    v_mfma_f32_16x16x32_bf16 v[172:175], v[152:155], v[24:27], v[172:175]
    ds_read_b128 v[128:131], v14 offset:23552
    ds_read_b128 v[132:135], v14 offset:24576
    s_waitcnt vmcnt(7)
    s_waitcnt lgkmcnt(5)
    v_mfma_f32_16x16x32_bf16 v[156:159], v[96:99], v[28:31], v[156:159]
    s_add_u32 s41, s36, 8192
    buffer_load_dwordx4 v[56:59], v6, s[12:15], s41 offen offset:2048 sc1
    v_mfma_f32_16x16x32_bf16 v[160:163], v[100:103], v[28:31], v[160:163]
    ds_read_b128 v[136:139], v14 offset:25600
    v_mfma_f32_16x16x32_bf16 v[164:167], v[104:107], v[28:31], v[164:167]
    ds_read_b128 v[140:143], v14 offset:26624
    v_mfma_f32_16x16x32_bf16 v[168:171], v[108:111], v[28:31], v[168:171]
    ds_read_b128 v[144:147], v14 offset:27648
    s_add_u32 s41, s36, 8192
    buffer_load_dwordx4 v[60:63], v6, s[12:15], s41 offen offset:3072 sc1
    v_mfma_f32_16x16x32_bf16 v[172:175], v[112:115], v[28:31], v[172:175]
    ds_read_b128 v[148:151], v14 offset:28672
    ds_read_b128 v[152:155], v14 offset:29696
    s_waitcnt vmcnt(7)
    s_waitcnt lgkmcnt(5)
    v_mfma_f32_16x16x32_bf16 v[156:159], v[116:119], v[32:35], v[156:159]
    s_add_u32 s41, s36, 12288
    buffer_load_dwordx4 v[64:67], v6, s[12:15], s41 offen offset:0 sc1
    v_mfma_f32_16x16x32_bf16 v[160:163], v[120:123], v[32:35], v[160:163]
    ds_read_b128 v[96:99], v14 offset:30720
    v_mfma_f32_16x16x32_bf16 v[164:167], v[124:127], v[32:35], v[164:167]
    ds_read_b128 v[100:103], v14 offset:31744
    v_mfma_f32_16x16x32_bf16 v[168:171], v[128:131], v[32:35], v[168:171]
    ds_read_b128 v[104:107], v14 offset:32768
    s_add_u32 s41, s36, 12288
    buffer_load_dwordx4 v[68:71], v6, s[12:15], s41 offen offset:1024 sc1
    v_mfma_f32_16x16x32_bf16 v[172:175], v[132:135], v[32:35], v[172:175]
    ds_read_b128 v[108:111], v14 offset:33792
    ds_read_b128 v[112:115], v14 offset:34816
    s_waitcnt vmcnt(8)
    s_waitcnt lgkmcnt(5)
    v_mfma_f32_16x16x32_bf16 v[156:159], v[136:139], v[36:39], v[156:159]
    s_add_u32 s41, s36, 12288
    buffer_load_dwordx4 v[72:75], v6, s[12:15], s41 offen offset:2048 sc1
    v_mfma_f32_16x16x32_bf16 v[160:163], v[140:143], v[36:39], v[160:163]
    ds_read_b128 v[116:119], v14 offset:35840
    v_mfma_f32_16x16x32_bf16 v[164:167], v[144:147], v[36:39], v[164:167]
    ds_read_b128 v[120:123], v14 offset:36864
    v_mfma_f32_16x16x32_bf16 v[168:171], v[148:151], v[36:39], v[168:171]
    ds_read_b128 v[124:127], v14 offset:37888
    s_add_u32 s41, s36, 12288
    buffer_load_dwordx4 v[76:79], v6, s[12:15], s41 offen offset:3072 sc1
    v_mfma_f32_16x16x32_bf16 v[172:175], v[152:155], v[36:39], v[172:175]
    ds_read_b128 v[128:131], v14 offset:38912
    ds_read_b128 v[132:135], v14 offset:39936
    s_waitcnt vmcnt(9)
    s_waitcnt lgkmcnt(5)
    v_mfma_f32_16x16x32_bf16 v[156:159], v[96:99], v[40:43], v[156:159]
    s_add_u32 s41, s36, 16384
    buffer_load_dwordx4 v[80:83], v6, s[12:15], s41 offen offset:0 sc1
    v_mfma_f32_16x16x32_bf16 v[160:163], v[100:103], v[40:43], v[160:163]
    ds_read_b128 v[136:139], v14 offset:40960
    v_mfma_f32_16x16x32_bf16 v[164:167], v[104:107], v[40:43], v[164:167]
    ds_read_b128 v[140:143], v14 offset:41984
    v_mfma_f32_16x16x32_bf16 v[168:171], v[108:111], v[40:43], v[168:171]
    ds_read_b128 v[144:147], v14 offset:43008
    s_add_u32 s41, s36, 16384
    buffer_load_dwordx4 v[84:87], v6, s[12:15], s41 offen offset:1024 sc1
    v_mfma_f32_16x16x32_bf16 v[172:175], v[112:115], v[40:43], v[172:175]
    ds_read_b128 v[148:151], v14 offset:44032
    ds_read_b128 v[152:155], v14 offset:45056
    s_waitcnt vmcnt(10)
    s_waitcnt lgkmcnt(5)
    v_mfma_f32_16x16x32_bf16 v[156:159], v[116:119], v[44:47], v[156:159]
    s_add_u32 s41, s36, 16384
    buffer_load_dwordx4 v[88:91], v6, s[12:15], s41 offen offset:2048 sc1
    v_mfma_f32_16x16x32_bf16 v[160:163], v[120:123], v[44:47], v[160:163]
    ds_read_b128 v[96:99], v14 offset:46080
    v_mfma_f32_16x16x32_bf16 v[164:167], v[124:127], v[44:47], v[164:167]
    ds_read_b128 v[100:103], v14 offset:47104
    v_mfma_f32_16x16x32_bf16 v[168:171], v[128:131], v[44:47], v[168:171]
    ds_read_b128 v[104:107], v14 offset:48128
    s_add_u32 s41, s36, 16384
    buffer_load_dwordx4 v[92:95], v6, s[12:15], s41 offen offset:3072 sc1
    v_mfma_f32_16x16x32_bf16 v[172:175], v[132:135], v[44:47], v[172:175]
    ds_read_b128 v[108:111], v14 offset:49152
    ds_read_b128 v[112:115], v14 offset:50176
    s_waitcnt vmcnt(11)
    s_waitcnt lgkmcnt(5)
    v_mfma_f32_16x16x32_bf16 v[156:159], v[136:139], v[48:51], v[156:159]
    v_mfma_f32_16x16x32_bf16 v[160:163], v[140:143], v[48:51], v[160:163]
    ds_read_b128 v[116:119], v14 offset:51200
    s_mov_b32 m0, s38
    s_nop 0
    buffer_load_dwordx4 v2, s[12:15], s39 offen offset:0 lds
    v_mfma_f32_16x16x32_bf16 v[164:167], v[144:147], v[48:51], v[164:167]
    ds_read_b128 v[120:123], v14 offset:52224
    v_mfma_f32_16x16x32_bf16 v[168:171], v[148:151], v[48:51], v[168:171]
    ds_read_b128 v[124:127], v14 offset:53248
    v_mfma_f32_16x16x32_bf16 v[172:175], v[152:155], v[48:51], v[172:175]
    ds_read_b128 v[128:131], v14 offset:54272
    ds_read_b128 v[132:135], v14 offset:55296
    s_add_u32 s41, s20, 0
    buffer_store_dwordx4 v[220:223], v2, s[12:15], s41 offen sc1
    s_waitcnt vmcnt(12)
    s_waitcnt lgkmcnt(5)
    s_barrier
    v_mfma_f32_16x16x32_bf16 v[156:159], v[96:99], v[52:55], v[156:159]
    v_mfma_f32_16x16x32_bf16 v[160:163], v[100:103], v[52:55], v[160:163]
    ds_read_b128 v[136:139], v14 offset:56320
    s_mov_b32 m0, s38
    s_nop 0
    buffer_load_dwordx4 v2, s[12:15], s39 offen offset:1024 lds
    v_mfma_f32_16x16x32_bf16 v[164:167], v[104:107], v[52:55], v[164:167]
    ds_read_b128 v[140:143], v14 offset:57344
    v_mfma_f32_16x16x32_bf16 v[168:171], v[108:111], v[52:55], v[168:171]
    ds_read_b128 v[144:147], v14 offset:58368
    v_mfma_f32_16x16x32_bf16 v[172:175], v[112:115], v[52:55], v[172:175]
    ds_read_b128 v[148:151], v14 offset:59392
    ds_read_b128 v[152:155], v14 offset:60416
    s_add_u32 s41, s20, 1024
    buffer_store_dwordx4 v[224:227], v2, s[12:15], s41 offen sc1
    s_waitcnt vmcnt(13)
    s_waitcnt lgkmcnt(5)
    v_mfma_f32_16x16x32_bf16 v[156:159], v[116:119], v[56:59], v[156:159]
    v_mfma_f32_16x16x32_bf16 v[160:163], v[120:123], v[56:59], v[160:163]
    ds_read_b128 v[96:99], v14 offset:61440
    s_mov_b32 m0, s38
    s_nop 0
    buffer_load_dwordx4 v2, s[12:15], s39 offen offset:2048 lds
    v_mfma_f32_16x16x32_bf16 v[164:167], v[124:127], v[56:59], v[164:167]
    ds_read_b128 v[100:103], v14 offset:62464
    v_mfma_f32_16x16x32_bf16 v[168:171], v[128:131], v[56:59], v[168:171]
    ds_read_b128 v[104:107], v14 offset:63488
    v_mfma_f32_16x16x32_bf16 v[172:175], v[132:135], v[56:59], v[172:175]
    ds_read_b128 v[108:111], v14 offset:64512
    ds_read_b128 v[112:115], v15 offset:0
    s_add_u32 s41, s20, 2048
    buffer_store_dwordx4 v[228:231], v2, s[12:15], s41 offen sc1
    s_waitcnt vmcnt(14)
    s_waitcnt lgkmcnt(5)
    v_mfma_f32_16x16x32_bf16 v[156:159], v[136:139], v[60:63], v[156:159]
    v_mfma_f32_16x16x32_bf16 v[160:163], v[140:143], v[60:63], v[160:163]
    ds_read_b128 v[116:119], v15 offset:1024
    s_mov_b32 m0, s38
    s_nop 0
    buffer_load_dwordx4 v2, s[12:15], s39 offen offset:3072 lds
    s_add_u32 s38, s38, 4096
    s_add_u32 s39, s39, 4096
    v_mfma_f32_16x16x32_bf16 v[164:167], v[144:147], v[60:63], v[164:167]
    ds_read_b128 v[120:123], v15 offset:2048
    v_mfma_f32_16x16x32_bf16 v[168:171], v[148:151], v[60:63], v[168:171]
    ds_read_b128 v[124:127], v15 offset:3072
    v_mfma_f32_16x16x32_bf16 v[172:175], v[152:155], v[60:63], v[172:175]
    ds_read_b128 v[128:131], v15 offset:4096
    ds_read_b128 v[132:135], v15 offset:5120
    s_add_u32 s41, s20, 3072
    buffer_store_dwordx4 v[232:235], v2, s[12:15], s41 offen sc1
    s_waitcnt vmcnt(15)
    s_waitcnt lgkmcnt(5)
    v_mfma_f32_16x16x32_bf16 v[156:159], v[96:99], v[64:67], v[156:159]
    v_mfma_f32_16x16x32_bf16 v[160:163], v[100:103], v[64:67], v[160:163]
    ds_read_b128 v[136:139], v15 offset:6144
    s_mov_b32 m0, s38
    s_nop 0
    buffer_load_dwordx4 v2, s[12:15], s39 offen offset:0 lds
    v_mfma_f32_16x16x32_bf16 v[164:167], v[104:107], v[64:67], v[164:167]
    ds_read_b128 v[140:143], v15 offset:7168
    v_mfma_f32_16x16x32_bf16 v[168:171], v[108:111], v[64:67], v[168:171]
    ds_read_b128 v[144:147], v15 offset:8192
    v_mfma_f32_16x16x32_bf16 v[172:175], v[112:115], v[64:67], v[172:175]
    ds_read_b128 v[148:151], v15 offset:9216
    ds_read_b128 v[152:155], v15 offset:10240
    s_add_u32 s41, s20, 4096
    buffer_store_dwordx4 v[236:239], v2, s[12:15], s41 offen sc1
    s_waitcnt vmcnt(16)
    s_waitcnt lgkmcnt(5)
    v_mfma_f32_16x16x32_bf16 v[156:159], v[116:119], v[68:71], v[156:159]
    v_mfma_f32_16x16x32_bf16 v[160:163], v[120:123], v[68:71], v[160:163]
    ds_read_b128 v[96:99], v15 offset:11264
    s_mov_b32 m0, s38
    s_nop 0
    buffer_load_dwordx4 v2, s[12:15], s39 offen offset:1024 lds
    v_mfma_f32_16x16x32_bf16 v[164:167], v[124:127], v[68:71], v[164:167]
    ds_read_b128 v[100:103], v15 offset:12288
    v_mfma_f32_16x16x32_bf16 v[168:171], v[128:131], v[68:71], v[168:171]
    ds_read_b128 v[104:107], v15 offset:13312
    v_mfma_f32_16x16x32_bf16 v[172:175], v[132:135], v[68:71], v[172:175]
    ds_read_b128 v[108:111], v15 offset:14336
    ds_read_b128 v[112:115], v15 offset:15360
    s_mov_b32 m0, s38
    s_nop 0
    buffer_load_dwordx4 v2, s[12:15], s39 offen offset:2048 lds
    s_waitcnt vmcnt(17)
    s_waitcnt lgkmcnt(5)
    v_mfma_f32_16x16x32_bf16 v[156:159], v[136:139], v[72:75], v[156:159]
    v_mfma_f32_16x16x32_bf16 v[160:163], v[140:143], v[72:75], v[160:163]
    ds_read_b128 v[116:119], v15 offset:16384
    s_mov_b32 m0, s38
    s_nop 0
    buffer_load_dwordx4 v2, s[12:15], s39 offen offset:3072 lds
    s_add_u32 s38, s38, 4096
    s_add_u32 s39, s39, 4096
    v_mfma_f32_16x16x32_bf16 v[164:167], v[144:147], v[72:75], v[164:167]
    ds_read_b128 v[120:123], v15 offset:17408
    v_mfma_f32_16x16x32_bf16 v[168:171], v[148:151], v[72:75], v[168:171]
    ds_read_b128 v[124:127], v15 offset:18432
    v_mfma_f32_16x16x32_bf16 v[172:175], v[152:155], v[72:75], v[172:175]
    ds_read_b128 v[128:131], v15 offset:19456
    ds_read_b128 v[132:135], v15 offset:20480
    s_mov_b32 m0, s38
    s_nop 0
    buffer_load_dwordx4 v2, s[12:15], s39 offen offset:0 lds
    s_waitcnt vmcnt(18)
    s_waitcnt lgkmcnt(5)
    v_mfma_f32_16x16x32_bf16 v[156:159], v[96:99], v[76:79], v[156:159]
    v_mfma_f32_16x16x32_bf16 v[160:163], v[100:103], v[76:79], v[160:163]
    ds_read_b128 v[136:139], v15 offset:21504
    s_mov_b32 m0, s38
    s_nop 0
    buffer_load_dwordx4 v2, s[12:15], s39 offen offset:1024 lds
    v_mfma_f32_16x16x32_bf16 v[164:167], v[104:107], v[76:79], v[164:167]
    ds_read_b128 v[140:143], v15 offset:22528
    v_mfma_f32_16x16x32_bf16 v[168:171], v[108:111], v[76:79], v[168:171]
    ds_read_b128 v[144:147], v15 offset:23552
    v_mfma_f32_16x16x32_bf16 v[172:175], v[112:115], v[76:79], v[172:175]
    ds_read_b128 v[148:151], v15 offset:24576
    ds_read_b128 v[152:155], v15 offset:25600
    s_mov_b32 m0, s38
    s_nop 0
    buffer_load_dwordx4 v2, s[12:15], s39 offen offset:2048 lds
    s_waitcnt vmcnt(19)
    s_waitcnt lgkmcnt(5)
    v_mfma_f32_16x16x32_bf16 v[156:159], v[116:119], v[80:83], v[156:159]
    v_mfma_f32_16x16x32_bf16 v[160:163], v[120:123], v[80:83], v[160:163]
    ds_read_b128 v[96:99], v15 offset:26624
    s_mov_b32 m0, s38
    s_nop 0
    buffer_load_dwordx4 v2, s[12:15], s39 offen offset:3072 lds
    s_add_u32 s38, s38, 4096
    s_add_u32 s39, s39, 4096
    v_mfma_f32_16x16x32_bf16 v[164:167], v[124:127], v[80:83], v[164:167]
    ds_read_b128 v[100:103], v15 offset:27648
    v_mfma_f32_16x16x32_bf16 v[168:171], v[128:131], v[80:83], v[168:171]
    ds_read_b128 v[104:107], v15 offset:28672
    v_mfma_f32_16x16x32_bf16 v[172:175], v[132:135], v[80:83], v[172:175]
    ds_read_b128 v[108:111], v15 offset:29696
    ds_read_b128 v[112:115], v15 offset:30720
    s_mov_b32 m0, s38
    s_nop 0
    buffer_load_dwordx4 v2, s[12:15], s39 offen offset:0 lds
    s_waitcnt vmcnt(20)
    s_waitcnt lgkmcnt(5)
    v_mfma_f32_16x16x32_bf16 v[156:159], v[136:139], v[84:87], v[156:159]
    v_mfma_f32_16x16x32_bf16 v[160:163], v[140:143], v[84:87], v[160:163]
    ds_read_b128 v[116:119], v15 offset:31744
    s_mul_i32 s38, s30, 12288
    s_add_u32 s39, s38, s44
    s_add_u32 s39, s39, 3637248
    s_add_u32 s38, s38, 0
    s_mov_b32 m0, s38
    s_nop 0
    buffer_load_dwordx4 v2, s[12:15], s39 offen offset:0 lds
    v_mfma_f32_16x16x32_bf16 v[164:167], v[144:147], v[84:87], v[164:167]
    ds_read_b128 v[120:123], v15 offset:32768
    v_mfma_f32_16x16x32_bf16 v[168:171], v[148:151], v[84:87], v[168:171]
    ds_read_b128 v[124:127], v15 offset:33792
    v_mfma_f32_16x16x32_bf16 v[172:175], v[152:155], v[84:87], v[172:175]
    ds_read_b128 v[128:131], v15 offset:34816
    ds_read_b128 v[132:135], v15 offset:35840
    s_mov_b32 m0, s38
    s_nop 0
    buffer_load_dwordx4 v2, s[12:15], s39 offen offset:1024 lds
    s_waitcnt vmcnt(21)
    s_waitcnt lgkmcnt(5)
    v_mfma_f32_16x16x32_bf16 v[156:159], v[96:99], v[88:91], v[156:159]
    v_mfma_f32_16x16x32_bf16 v[160:163], v[100:103], v[88:91], v[160:163]
    s_mov_b32 m0, s38
    s_nop 0
    buffer_load_dwordx4 v2, s[12:15], s39 offen offset:2048 lds
    v_mfma_f32_16x16x32_bf16 v[164:167], v[104:107], v[88:91], v[164:167]
    v_mfma_f32_16x16x32_bf16 v[168:171], v[108:111], v[88:91], v[168:171]
    v_mfma_f32_16x16x32_bf16 v[172:175], v[112:115], v[88:91], v[172:175]
    s_mov_b32 m0, s38
    s_nop 0
    buffer_load_dwordx4 v2, s[12:15], s39 offen offset:3072 lds
    s_add_u32 s38, s38, 4096
    s_add_u32 s39, s39, 4096
    s_waitcnt vmcnt(22)
    s_waitcnt lgkmcnt(0)
    v_mfma_f32_16x16x32_bf16 v[156:159], v[116:119], v[92:95], v[156:159]
    v_mfma_f32_16x16x32_bf16 v[160:163], v[120:123], v[92:95], v[160:163]
    s_mov_b32 m0, s38
    s_nop 0
    buffer_load_dwordx4 v2, s[12:15], s39 offen offset:0 lds
    v_mfma_f32_16x16x32_bf16 v[164:167], v[124:127], v[92:95], v[164:167]
    v_mfma_f32_16x16x32_bf16 v[168:171], v[128:131], v[92:95], v[168:171]
    v_mfma_f32_16x16x32_bf16 v[172:175], v[132:135], v[92:95], v[172:175]
    s_mov_b32 m0, s38
    s_nop 0
    buffer_load_dwordx4 v2, s[12:15], s39 offen offset:1024 lds
    s_barrier
    s_mov_b32 m0, s38
    s_nop 0
    buffer_load_dwordx4 v2, s[12:15], s39 offen offset:2048 lds
    s_mov_b32 m0, s38
    s_nop 0
    buffer_load_dwordx4 v2, s[12:15], s39 offen offset:3072 lds
    s_add_u32 s38, s38, 4096
    s_add_u32 s39, s39, 4096
    s_mov_b32 m0, s38
    s_nop 0
    buffer_load_dwordx4 v2, s[12:15], s39 offen offset:0 lds
    s_mov_b32 m0, s38
    s_nop 0
    buffer_load_dwordx4 v2, s[12:15], s39 offen offset:1024 lds
    s_mov_b32 m0, s38
    s_nop 0
    buffer_load_dwordx4 v2, s[12:15], s39 offen offset:2048 lds
    s_mov_b32 m0, s38
    s_nop 0
    buffer_load_dwordx4 v2, s[12:15], s39 offen offset:3072 lds
    s_mul_i32 s38, s30, 13312
    s_add_u32 s39, s38, s45
    s_add_u32 s39, s39, 0
    s_add_u32 s38, s38, 49152
    s_mov_b32 m0, s38
    s_nop 0
    buffer_load_dwordx4 v2, s[12:15], s39 offen offset:0 lds
    s_mov_b32 m0, s38
    s_nop 0
    buffer_load_dwordx4 v2, s[12:15], s39 offen offset:1024 lds
    s_mov_b32 m0, s38
    s_nop 0
    buffer_load_dwordx4 v2, s[12:15], s39 offen offset:2048 lds
    s_mov_b32 m0, s38
    s_nop 0
    buffer_load_dwordx4 v2, s[12:15], s39 offen offset:3072 lds
    s_add_u32 s38, s38, 4096
    s_add_u32 s39, s39, 4096
    s_mov_b32 m0, s38
    s_nop 0
    buffer_load_dwordx4 v2, s[12:15], s39 offen offset:0 lds
    s_mov_b32 m0, s38
    s_nop 0
    buffer_load_dwordx4 v2, s[12:15], s39 offen offset:1024 lds
    s_mov_b32 m0, s38
    s_nop 0
    buffer_load_dwordx4 v2, s[12:15], s39 offen offset:2048 lds
    s_mov_b32 m0, s38
    s_nop 0
    buffer_load_dwordx4 v2, s[12:15], s39 offen offset:3072 lds
    s_add_u32 s38, s38, 4096
    s_add_u32 s39, s39, 4096
    s_mov_b32 m0, s38
    s_nop 0
    buffer_load_dwordx4 v2, s[12:15], s39 offen offset:0 lds
    s_mov_b32 m0, s38
    s_nop 0
    buffer_load_dwordx4 v2, s[12:15], s39 offen offset:1024 lds
    s_mov_b32 m0, s38
    s_nop 0
    buffer_load_dwordx4 v2, s[12:15], s39 offen offset:2048 lds
    s_mov_b32 m0, s38
    s_nop 0
    buffer_load_dwordx4 v2, s[12:15], s39 offen offset:3072 lds
    s_add_u32 s38, s38, 4096
    s_add_u32 s39, s39, 4096
    s_mov_b32 m0, s38
    s_nop 0
    buffer_load_dwordx4 v2, s[12:15], s39 offen offset:0 lds
    v_lshlrev_b32 v9, 4, v3
    v_add_u32 v9, 155648, v9
    v_mov_b32 v12, 0xbdd2d3e8
    v_mov_b32 v13, 0xc0135761
    ds_read_b128 v[180:183], v9 offset:0
    ds_read_b128 v[200:203], v9 offset:512
    ds_read_b128 v[184:187], v9 offset:64
    ds_read_b128 v[204:207], v9 offset:576
    ds_read_b128 v[188:191], v9 offset:128
    ds_read_b128 v[208:211], v9 offset:640
    ds_read_b128 v[192:195], v9 offset:192
    ds_read_b128 v[212:215], v9 offset:704
    ds_read_b128 v[196:199], v9 offset:256
    ds_read_b128 v[216:219], v9 offset:768
    s_waitcnt lgkmcnt(0)
    v_pk_add_f32 v[180:181], v[180:181], v[200:201]
    v_pk_add_f32 v[182:183], v[182:183], v[202:203]
    v_pk_add_f32 v[184:185], v[184:185], v[204:205]
    v_pk_add_f32 v[186:187], v[186:187], v[206:207]
    v_pk_add_f32 v[188:189], v[188:189], v[208:209]
    v_pk_add_f32 v[190:191], v[190:191], v[210:211]
    v_pk_add_f32 v[192:193], v[192:193], v[212:213]
    v_pk_add_f32 v[194:195], v[194:195], v[214:215]
    v_pk_add_f32 v[196:197], v[196:197], v[216:217]
    v_pk_add_f32 v[198:199], v[198:199], v[218:219]
    v_pk_mul_f32 v[200:201], v[180:181], v[176:177] op_sel_hi:[1,0]
    v_pk_mul_f32 v[202:203], v[182:183], v[176:177] op_sel_hi:[1,0]
    v_pk_mul_f32 v[204:205], v[184:185], v[176:177] op_sel_hi:[1,0]
    v_pk_mul_f32 v[206:207], v[186:187], v[176:177] op_sel_hi:[1,0]
    v_pk_mul_f32 v[208:209], v[188:189], v[176:177] op_sel_hi:[1,0]
    v_pk_mul_f32 v[210:211], v[190:191], v[176:177] op_sel_hi:[1,0]
    v_pk_mul_f32 v[212:213], v[192:193], v[176:177] op_sel_hi:[1,0]
    v_pk_mul_f32 v[214:215], v[194:195], v[176:177] op_sel_hi:[1,0]
    v_pk_mul_f32 v[216:217], v[196:197], v[176:177] op_sel_hi:[1,0]
    v_pk_mul_f32 v[218:219], v[198:199], v[176:177] op_sel_hi:[1,0]
    v_pk_fma_f32 v[156:157], v[156:157], v[176:177], v[200:201] op_sel:[0,1,0] op_sel_hi:[1,1,1]
    v_pk_fma_f32 v[158:159], v[158:159], v[176:177], v[202:203] op_sel:[0,1,0] op_sel_hi:[1,1,1]
    v_pk_fma_f32 v[160:161], v[160:161], v[176:177], v[204:205] op_sel:[0,1,0] op_sel_hi:[1,1,1]
    v_pk_fma_f32 v[162:163], v[162:163], v[176:177], v[206:207] op_sel:[0,1,0] op_sel_hi:[1,1,1]
    v_pk_fma_f32 v[164:165], v[164:165], v[176:177], v[208:209] op_sel:[0,1,0] op_sel_hi:[1,1,1]
    v_pk_fma_f32 v[166:167], v[166:167], v[176:177], v[210:211] op_sel:[0,1,0] op_sel_hi:[1,1,1]
    v_pk_fma_f32 v[168:169], v[168:169], v[176:177], v[212:213] op_sel:[0,1,0] op_sel_hi:[1,1,1]
    v_pk_fma_f32 v[170:171], v[170:171], v[176:177], v[214:215] op_sel:[0,1,0] op_sel_hi:[1,1,1]
    v_pk_fma_f32 v[172:173], v[172:173], v[176:177], v[216:217] op_sel:[0,1,0] op_sel_hi:[1,1,1]
    v_pk_fma_f32 v[174:175], v[174:175], v[176:177], v[218:219] op_sel:[0,1,0] op_sel_hi:[1,1,1]
    v_pk_mul_f32 v[200:201], v[156:157], v[156:157]
    v_pk_mul_f32 v[202:203], v[158:159], v[158:159]
    v_pk_mul_f32 v[204:205], v[160:161], v[160:161]
    v_pk_mul_f32 v[206:207], v[162:163], v[162:163]
    v_pk_mul_f32 v[208:209], v[164:165], v[164:165]
    v_pk_mul_f32 v[210:211], v[166:167], v[166:167]
    v_pk_mul_f32 v[212:213], v[168:169], v[168:169]
    v_pk_mul_f32 v[214:215], v[170:171], v[170:171]
    v_pk_mul_f32 v[216:217], v[172:173], v[172:173]
    v_pk_mul_f32 v[218:219], v[174:175], v[174:175]
    v_pk_fma_f32 v[200:201], v[200:201], v[12:13], v[12:13] op_sel:[0,0,1] op_sel_hi:[1,0,1]
    v_pk_fma_f32 v[202:203], v[202:203], v[12:13], v[12:13] op_sel:[0,0,1] op_sel_hi:[1,0,1]
    v_pk_fma_f32 v[204:205], v[204:205], v[12:13], v[12:13] op_sel:[0,0,1] op_sel_hi:[1,0,1]
    v_pk_fma_f32 v[206:207], v[206:207], v[12:13], v[12:13] op_sel:[0,0,1] op_sel_hi:[1,0,1]
    v_pk_fma_f32 v[208:209], v[208:209], v[12:13], v[12:13] op_sel:[0,0,1] op_sel_hi:[1,0,1]
    v_pk_fma_f32 v[210:211], v[210:211], v[12:13], v[12:13] op_sel:[0,0,1] op_sel_hi:[1,0,1]
    v_pk_fma_f32 v[212:213], v[212:213], v[12:13], v[12:13] op_sel:[0,0,1] op_sel_hi:[1,0,1]
    v_pk_fma_f32 v[214:215], v[214:215], v[12:13], v[12:13] op_sel:[0,0,1] op_sel_hi:[1,0,1]
    v_pk_fma_f32 v[216:217], v[216:217], v[12:13], v[12:13] op_sel:[0,0,1] op_sel_hi:[1,0,1]
    v_pk_fma_f32 v[218:219], v[218:219], v[12:13], v[12:13] op_sel:[0,0,1] op_sel_hi:[1,0,1]
    v_pk_mul_f32 v[200:201], v[200:201], v[156:157]
    v_pk_mul_f32 v[202:203], v[202:203], v[158:159]
    v_pk_mul_f32 v[204:205], v[204:205], v[160:161]
    v_pk_mul_f32 v[206:207], v[206:207], v[162:163]
    v_pk_mul_f32 v[208:209], v[208:209], v[164:165]
    v_pk_mul_f32 v[210:211], v[210:211], v[166:167]
    v_pk_mul_f32 v[212:213], v[212:213], v[168:169]
    v_pk_mul_f32 v[214:215], v[214:215], v[170:171]
    v_pk_mul_f32 v[216:217], v[216:217], v[172:173]
    v_pk_mul_f32 v[218:219], v[218:219], v[174:175]
    v_exp_f32 v200, v200
    v_exp_f32 v201, v201
    v_exp_f32 v202, v202
    v_exp_f32 v203, v203
    v_exp_f32 v204, v204
    v_exp_f32 v205, v205
    v_exp_f32 v206, v206
    v_exp_f32 v207, v207
    v_exp_f32 v208, v208
    v_exp_f32 v209, v209
    v_exp_f32 v210, v210
    v_exp_f32 v211, v211
    v_exp_f32 v212, v212
    v_exp_f32 v213, v213
    v_exp_f32 v214, v214
    v_exp_f32 v215, v215
    v_exp_f32 v216, v216
    v_exp_f32 v217, v217
    v_exp_f32 v218, v218
    v_exp_f32 v219, v219
    v_pk_add_f32 v[200:201], v[200:201], 1.0 op_sel_hi:[1,0]
    v_pk_add_f32 v[202:203], v[202:203], 1.0 op_sel_hi:[1,0]
    v_pk_add_f32 v[204:205], v[204:205], 1.0 op_sel_hi:[1,0]
    v_pk_add_f32 v[206:207], v[206:207], 1.0 op_sel_hi:[1,0]
    v_pk_add_f32 v[208:209], v[208:209], 1.0 op_sel_hi:[1,0]
    v_pk_add_f32 v[210:211], v[210:211], 1.0 op_sel_hi:[1,0]
    v_pk_add_f32 v[212:213], v[212:213], 1.0 op_sel_hi:[1,0]
    v_pk_add_f32 v[214:215], v[214:215], 1.0 op_sel_hi:[1,0]
    v_pk_add_f32 v[216:217], v[216:217], 1.0 op_sel_hi:[1,0]
    v_pk_add_f32 v[218:219], v[218:219], 1.0 op_sel_hi:[1,0]
    v_rcp_f32 v200, v200
    v_rcp_f32 v201, v201
    v_rcp_f32 v202, v202
    v_rcp_f32 v203, v203
    v_rcp_f32 v204, v204
    v_rcp_f32 v205, v205
    v_rcp_f32 v206, v206
    v_rcp_f32 v207, v207
    v_rcp_f32 v208, v208
    v_rcp_f32 v209, v209
    v_rcp_f32 v210, v210
    v_rcp_f32 v211, v211
    v_rcp_f32 v212, v212
    v_rcp_f32 v213, v213
    v_rcp_f32 v214, v214
    v_rcp_f32 v215, v215
    v_rcp_f32 v216, v216
    v_rcp_f32 v217, v217
    v_rcp_f32 v218, v218
    v_rcp_f32 v219, v219
    s_nop 0
    v_pk_mul_f32 v[156:157], v[156:157], v[200:201]
    v_pk_mul_f32 v[158:159], v[158:159], v[202:203]
    v_pk_mul_f32 v[160:161], v[160:161], v[204:205]
    v_pk_mul_f32 v[162:163], v[162:163], v[206:207]
    v_pk_mul_f32 v[164:165], v[164:165], v[208:209]
    v_pk_mul_f32 v[166:167], v[166:167], v[210:211]
    v_pk_mul_f32 v[168:169], v[168:169], v[212:213]
    v_pk_mul_f32 v[170:171], v[170:171], v[214:215]
    v_pk_mul_f32 v[172:173], v[172:173], v[216:217]
    v_pk_mul_f32 v[174:175], v[174:175], v[218:219]
    v_cvt_pk_bf16_f32 v156, v156, v157
    v_cvt_pk_bf16_f32 v157, v158, v159
    v_cvt_pk_bf16_f32 v158, v160, v161
    v_cvt_pk_bf16_f32 v159, v162, v163
    v_cvt_pk_bf16_f32 v164, v164, v165
    v_cvt_pk_bf16_f32 v165, v166, v167
    v_cvt_pk_bf16_f32 v166, v168, v169
    v_cvt_pk_bf16_f32 v167, v170, v171
    v_cvt_pk_bf16_f32 v172, v172, v173
    v_cvt_pk_bf16_f32 v173, v174, v175
    s_nop 1
    v_permlane16_swap_b32 v156, v158
    v_permlane16_swap_b32 v157, v159
    v_permlane16_swap_b32 v164, v166
    v_permlane16_swap_b32 v165, v167
    s_mov_b32 s46, s22
    s_lshl_b32 s41, s33, 2
    s_add_u32 s49, s55, s41
    s_cmp_eq_u32 s31, 0
    s_cbranch_scc1 k2_kernel_slow19
    buffer_store_dwordx4 v[156:159], v254, s[12:15], s46 offen offset:0
    buffer_store_dwordx4 v[164:167], v254, s[12:15], s46 offen offset:1024
    buffer_store_dwordx2 v[172:173], v8, s[12:15], s46 offen offset:2048
    s_waitcnt vmcnt(0)
    v_mov_b32 v9, 1
    v_mov_b32 v10, 2304
    s_mov_b64 exec, 1
    buffer_store_dword v9, v10, s[12:15], s49 offen
    s_mov_b64 exec, -1
    s_branch k2_kernel_sent20
k2_kernel_slow19:
    buffer_store_dwordx4 v[156:159], v254, s[12:15], s46 offen offset:0 sc1
    buffer_store_dwordx4 v[164:167], v254, s[12:15], s46 offen offset:1024 sc1
    buffer_store_dwordx2 v[172:173], v8, s[12:15], s46 offen offset:2048 sc1
    s_waitcnt vmcnt(0)
    v_mov_b32 v9, 1
    v_mov_b32 v10, 2304
    s_mov_b64 exec, 1
    buffer_store_dword v9, v10, s[12:15], s49 offen sc1
    s_mov_b64 exec, -1
k2_kernel_sent20:
    s_cmp_eq_u32 s21, 0
    s_cbranch_scc1 k2_kernel_xas23
    v_mov_b32 v9, 3
    v_mov_b32 v10, 0
    s_mov_b64 exec, 1
    s_cmp_eq_u32 s31, 0
    s_cbranch_scc1 k2_kernel_xas21
    buffer_store_dword v9, v10, s[12:15], s21 offen
    s_branch k2_kernel_xas22
k2_kernel_xas21:
    buffer_store_dword v9, v10, s[12:15], s21 offen sc1
k2_kernel_xas22:
    s_mov_b64 exec, -1
k2_kernel_xas23:
    s_sub_u32 s41, s55, s37
    s_lshr_b32 s41, s41, 7
    v_bfe_u32 v7, v1, 3, 2
    v_min_u32 v7, 2, v7
    v_add_u32 v7, s41, v7
    v_subrev_u32 v7, 1, v7
    v_max_i32 v7, 0, v7
    v_min_i32 v7, 15, v7
    v_lshlrev_b32 v7, 7, v7
    v_and_b32 v9, 7, v1
    v_lshl_add_u32 v7, v9, 2, v7
    s_add_u32 s49, s37, 2304
    s_mov_b32 s43, 200000
k2_kernel_poll24:
    buffer_load_dword v9, v7, s[12:15], s49 offen sc1
    s_waitcnt vmcnt(0)
    v_cmp_ne_u32 vcc, 0, v9
    s_sub_u32 s43, s43, 1
    s_cmp_eq_u64 vcc, -1
    s_cbranch_scc1 k2_kernel_go25
    s_cmp_lg_u32 s43, 0
    s_cbranch_scc1 k2_kernel_poll24
k2_kernel_go25:
    s_mul_i32 s41, s33, 2560
    s_sub_u32 s47, s22, s41
    s_mov_b32 s52, s47
    s_add_u32 s41, s52, 0
    buffer_load_dwordx4 v[16:19], v2, s[12:15], s41 offen offset:0 sc1
    s_add_u32 s41, s52, 0
    buffer_load_dwordx4 v[20:23], v2, s[12:15], s41 offen offset:1024 sc1
    s_add_u32 s41, s52, 0
    buffer_load_dwordx4 v[24:27], v2, s[12:15], s41 offen offset:2048 sc1
    s_add_u32 s41, s52, 0
    buffer_load_dwordx4 v[28:31], v2, s[12:15], s41 offen offset:3072 sc1
    s_add_u32 s41, s54, 20480
    s_mov_b32 s48, s41
    s_sub_u32 s41, s55, s37
    s_lshl_b32 s41, s41, 3
    s_add_u32 s46, s41, s36
    s_add_u32 s46, s46, 1581056
    s_barrier
    ds_read_b128 v[96:99], v15 offset:36864
    ds_read_b128 v[100:103], v15 offset:37888
    ds_read_b128 v[104:107], v15 offset:38912
    ds_read_b128 v[108:111], v15 offset:39936
    ds_read_b128 v[112:115], v15 offset:40960
    ds_read_b128 v[116:119], v15 offset:41984
    ds_read_b128 v[120:123], v15 offset:43008
    ds_read_b128 v[124:127], v15 offset:44032
    ds_read_b128 v[128:131], v15 offset:45056
    ds_read_b128 v[132:135], v15 offset:46080
    s_waitcnt vmcnt(3)
    s_waitcnt lgkmcnt(5)
    v_mfma_f32_16x16x32_bf16 v[156:159], v[96:99], v[16:19], 0
    s_add_u32 s41, s52, 4096
    buffer_load_dwordx4 v[32:35], v2, s[12:15], s41 offen offset:0 sc1
    v_mfma_f32_16x16x32_bf16 v[160:163], v[100:103], v[16:19], 0
    ds_read_b128 v[136:139], v15 offset:47104
    v_mfma_f32_16x16x32_bf16 v[164:167], v[104:107], v[16:19], 0
    ds_read_b128 v[140:143], v15 offset:48128
    v_mfma_f32_16x16x32_bf16 v[168:171], v[108:111], v[16:19], 0
    ds_read_b128 v[144:147], v15 offset:49152
    s_add_u32 s41, s52, 4096
    buffer_load_dwordx4 v[36:39], v2, s[12:15], s41 offen offset:1024 sc1
    v_mfma_f32_16x16x32_bf16 v[172:175], v[112:115], v[16:19], 0
    ds_read_b128 v[148:151], v15 offset:50176
    ds_read_b128 v[152:155], v15 offset:51200
    s_waitcnt vmcnt(4)
    s_waitcnt lgkmcnt(5)
    v_mfma_f32_16x16x32_bf16 v[156:159], v[116:119], v[20:23], v[156:159]
    s_add_u32 s41, s52, 4096
    buffer_load_dwordx4 v[40:43], v2, s[12:15], s41 offen offset:2048 sc1
    v_mfma_f32_16x16x32_bf16 v[160:163], v[120:123], v[20:23], v[160:163]
    ds_read_b128 v[96:99], v15 offset:52224
    v_mfma_f32_16x16x32_bf16 v[164:167], v[124:127], v[20:23], v[164:167]
    ds_read_b128 v[100:103], v15 offset:53248
    v_mfma_f32_16x16x32_bf16 v[168:171], v[128:131], v[20:23], v[168:171]
    ds_read_b128 v[104:107], v15 offset:54272
    s_add_u32 s41, s52, 4096
    buffer_load_dwordx4 v[44:47], v2, s[12:15], s41 offen offset:3072 sc1
    v_mfma_f32_16x16x32_bf16 v[172:175], v[132:135], v[20:23], v[172:175]
    ds_read_b128 v[108:111], v15 offset:55296
    ds_read_b128 v[112:115], v15 offset:56320
    s_waitcnt vmcnt(5)
    s_waitcnt lgkmcnt(5)
    v_mfma_f32_16x16x32_bf16 v[156:159], v[136:139], v[24:27], v[156:159]
    s_add_u32 s41, s52, 8192
    buffer_load_dwordx4 v[48:51], v2, s[12:15], s41 offen offset:0 sc1
    v_mfma_f32_16x16x32_bf16 v[160:163], v[140:143], v[24:27], v[160:163]
    ds_read_b128 v[116:119], v15 offset:57344
    v_mfma_f32_16x16x32_bf16 v[164:167], v[144:147], v[24:27], v[164:167]
    ds_read_b128 v[120:123], v15 offset:58368
    v_mfma_f32_16x16x32_bf16 v[168:171], v[148:151], v[24:27], v[168:171]
    ds_read_b128 v[124:127], v15 offset:59392
    s_add_u32 s41, s52, 8192
    buffer_load_dwordx4 v[52:55], v2, s[12:15], s41 offen offset:1024 sc1
    v_mfma_f32_16x16x32_bf16 v[172:175], v[152:155], v[24:27], v[172:175]
    ds_read_b128 v[128:131], v15 offset:60416
    ds_read_b128 v[132:135], v15 offset:61440
    s_waitcnt vmcnt(6)
    s_waitcnt lgkmcnt(5)
    v_mfma_f32_16x16x32_bf16 v[156:159], v[96:99], v[28:31], v[156:159]
    s_add_u32 s41, s52, 8192
    buffer_load_dwordx4 v[56:59], v2, s[12:15], s41 offen offset:2048 sc1
    v_mfma_f32_16x16x32_bf16 v[160:163], v[100:103], v[28:31], v[160:163]
    ds_read_b128 v[136:139], v15 offset:62464
    v_mfma_f32_16x16x32_bf16 v[164:167], v[104:107], v[28:31], v[164:167]
    ds_read_b128 v[140:143], v15 offset:63488
    v_mfma_f32_16x16x32_bf16 v[168:171], v[108:111], v[28:31], v[168:171]
    ds_read_b128 v[144:147], v15 offset:64512
    s_add_u32 s41, s52, 8192
    buffer_load_dwordx4 v[60:63], v2, s[12:15], s41 offen offset:3072 sc1
    v_mfma_f32_16x16x32_bf16 v[172:175], v[112:115], v[28:31], v[172:175]
    ds_read_b128 v[148:151], v11 offset:0
    ds_read_b128 v[152:155], v11 offset:1024
    s_waitcnt vmcnt(7)
    s_waitcnt lgkmcnt(5)
    v_mfma_f32_16x16x32_bf16 v[156:159], v[116:119], v[32:35], v[156:159]
    s_add_u32 s41, s52, 12288
    buffer_load_dwordx4 v[64:67], v2, s[12:15], s41 offen offset:0 sc1
    v_mfma_f32_16x16x32_bf16 v[160:163], v[120:123], v[32:35], v[160:163]
    ds_read_b128 v[96:99], v11 offset:2048
    v_mfma_f32_16x16x32_bf16 v[164:167], v[124:127], v[32:35], v[164:167]
    ds_read_b128 v[100:103], v11 offset:3072
    v_mfma_f32_16x16x32_bf16 v[168:171], v[128:131], v[32:35], v[168:171]
    ds_read_b128 v[104:107], v11 offset:4096
    s_add_u32 s41, s52, 12288
    buffer_load_dwordx4 v[68:71], v2, s[12:15], s41 offen offset:1024 sc1
    v_mfma_f32_16x16x32_bf16 v[172:175], v[132:135], v[32:35], v[172:175]
    ds_read_b128 v[108:111], v11 offset:5120
    ds_read_b128 v[112:115], v11 offset:6144
    s_waitcnt vmcnt(8)
    s_waitcnt lgkmcnt(5)
    v_mfma_f32_16x16x32_bf16 v[156:159], v[136:139], v[36:39], v[156:159]
    s_add_u32 s41, s52, 12288
    buffer_load_dwordx4 v[72:75], v2, s[12:15], s41 offen offset:2048 sc1
    v_mfma_f32_16x16x32_bf16 v[160:163], v[140:143], v[36:39], v[160:163]
    ds_read_b128 v[116:119], v11 offset:7168
    v_mfma_f32_16x16x32_bf16 v[164:167], v[144:147], v[36:39], v[164:167]
    ds_read_b128 v[120:123], v11 offset:8192
    v_mfma_f32_16x16x32_bf16 v[168:171], v[148:151], v[36:39], v[168:171]
    ds_read_b128 v[124:127], v11 offset:9216
    s_add_u32 s41, s52, 12288
    buffer_load_dwordx4 v[76:79], v2, s[12:15], s41 offen offset:3072 sc1
    v_mfma_f32_16x16x32_bf16 v[172:175], v[152:155], v[36:39], v[172:175]
    ds_read_b128 v[128:131], v11 offset:10240
    ds_read_b128 v[132:135], v11 offset:11264
    s_waitcnt vmcnt(9)
    s_waitcnt lgkmcnt(5)
    v_mfma_f32_16x16x32_bf16 v[156:159], v[96:99], v[40:43], v[156:159]
    s_add_u32 s41, s52, 16384
    buffer_load_dwordx4 v[80:83], v2, s[12:15], s41 offen offset:0 sc1
    v_mfma_f32_16x16x32_bf16 v[160:163], v[100:103], v[40:43], v[160:163]
    ds_read_b128 v[136:139], v11 offset:12288
    v_mfma_f32_16x16x32_bf16 v[164:167], v[104:107], v[40:43], v[164:167]
    ds_read_b128 v[140:143], v11 offset:13312
    v_mfma_f32_16x16x32_bf16 v[168:171], v[108:111], v[40:43], v[168:171]
    ds_read_b128 v[144:147], v11 offset:14336
    s_add_u32 s41, s52, 16384
    buffer_load_dwordx4 v[84:87], v2, s[12:15], s41 offen offset:1024 sc1
    v_mfma_f32_16x16x32_bf16 v[172:175], v[112:115], v[40:43], v[172:175]
    ds_read_b128 v[148:151], v11 offset:15360
    ds_read_b128 v[152:155], v11 offset:16384
    s_waitcnt vmcnt(10)
    s_waitcnt lgkmcnt(5)
    v_mfma_f32_16x16x32_bf16 v[156:159], v[116:119], v[44:47], v[156:159]
    s_add_u32 s41, s52, 16384
    buffer_load_dwordx4 v[88:91], v2, s[12:15], s41 offen offset:2048 sc1
    v_mfma_f32_16x16x32_bf16 v[160:163], v[120:123], v[44:47], v[160:163]
    ds_read_b128 v[96:99], v11 offset:17408
    v_mfma_f32_16x16x32_bf16 v[164:167], v[124:127], v[44:47], v[164:167]
    ds_read_b128 v[100:103], v11 offset:18432
    v_mfma_f32_16x16x32_bf16 v[168:171], v[128:131], v[44:47], v[168:171]
    ds_read_b128 v[104:107], v11 offset:19456
    s_add_u32 s41, s52, 16384
    buffer_load_dwordx4 v[92:95], v2, s[12:15], s41 offen offset:3072 sc1
    v_mfma_f32_16x16x32_bf16 v[172:175], v[132:135], v[44:47], v[172:175]
    ds_read_b128 v[108:111], v11 offset:20480
    ds_read_b128 v[112:115], v11 offset:21504
    s_waitcnt vmcnt(11)
    s_waitcnt lgkmcnt(5)
    v_mfma_f32_16x16x32_bf16 v[156:159], v[136:139], v[48:51], v[156:159]
    v_mfma_f32_16x16x32_bf16 v[160:163], v[140:143], v[48:51], v[160:163]
    ds_read_b128 v[116:119], v11 offset:22528
    buffer_load_dwordx4 v[176:179], v254, s[12:15], s48 offen sc1
    buffer_load_dwordx4 v[180:183], v254, s[12:15], s48 offen offset:1024 sc1
    buffer_load_dwordx2 v[184:185], v8, s[12:15], s48 offen offset:2048 sc1
    v_mfma_f32_16x16x32_bf16 v[164:167], v[144:147], v[48:51], v[164:167]
    ds_read_b128 v[120:123], v11 offset:23552
    v_mfma_f32_16x16x32_bf16 v[168:171], v[148:151], v[48:51], v[168:171]
    ds_read_b128 v[124:127], v14 offset:0
    v_mfma_f32_16x16x32_bf16 v[172:175], v[152:155], v[48:51], v[172:175]
    ds_read_b128 v[128:131], v14 offset:1024
    ds_read_b128 v[132:135], v14 offset:2048
    s_waitcnt vmcnt(13)
    s_waitcnt lgkmcnt(5)
    s_barrier
    v_mfma_f32_16x16x32_bf16 v[156:159], v[96:99], v[52:55], v[156:159]
    v_mfma_f32_16x16x32_bf16 v[160:163], v[100:103], v[52:55], v[160:163]
    ds_read_b128 v[136:139], v14 offset:3072
    v_mfma_f32_16x16x32_bf16 v[164:167], v[104:107], v[52:55], v[164:167]
    ds_read_b128 v[140:143], v14 offset:4096
    v_mfma_f32_16x16x32_bf16 v[168:171], v[108:111], v[52:55], v[168:171]
    ds_read_b128 v[144:147], v14 offset:5120
    v_mfma_f32_16x16x32_bf16 v[172:175], v[112:115], v[52:55], v[172:175]
    ds_read_b128 v[148:151], v14 offset:6144
    ds_read_b128 v[152:155], v14 offset:7168
    s_waitcnt vmcnt(12)
    s_waitcnt lgkmcnt(5)
    v_mfma_f32_16x16x32_bf16 v[156:159], v[116:119], v[56:59], v[156:159]
    v_mfma_f32_16x16x32_bf16 v[160:163], v[120:123], v[56:59], v[160:163]
    ds_read_b128 v[96:99], v14 offset:8192
    s_mul_i32 s38, s30, 12288
    s_add_u32 s39, s38, s45
    s_add_u32 s39, s39, 53248
    s_add_u32 s38, s38, 102400
    s_mov_b32 m0, s38
    s_nop 0
    buffer_load_dwordx4 v2, s[12:15], s39 offen offset:0 lds
    v_mfma_f32_16x16x32_bf16 v[164:167], v[124:127], v[56:59], v[164:167]
    ds_read_b128 v[100:103], v14 offset:9216
    v_mfma_f32_16x16x32_bf16 v[168:171], v[128:131], v[56:59], v[168:171]
    ds_read_b128 v[104:107], v14 offset:10240
    v_mfma_f32_16x16x32_bf16 v[172:175], v[132:135], v[56:59], v[172:175]
    ds_read_b128 v[108:111], v14 offset:11264
    ds_read_b128 v[112:115], v14 offset:12288
    s_mov_b32 m0, s38
    s_nop 0
    buffer_load_dwordx4 v2, s[12:15], s39 offen offset:1024 lds
    s_waitcnt vmcnt(13)
    s_waitcnt lgkmcnt(5)
    v_mfma_f32_16x16x32_bf16 v[156:159], v[136:139], v[60:63], v[156:159]
    v_mfma_f32_16x16x32_bf16 v[160:163], v[140:143], v[60:63], v[160:163]
    ds_read_b128 v[116:119], v14 offset:13312
    s_mov_b32 m0, s38
    s_nop 0
    buffer_load_dwordx4 v2, s[12:15], s39 offen offset:2048 lds
    v_mfma_f32_16x16x32_bf16 v[164:167], v[144:147], v[60:63], v[164:167]
    ds_read_b128 v[120:123], v14 offset:14336
    v_mfma_f32_16x16x32_bf16 v[168:171], v[148:151], v[60:63], v[168:171]
    ds_read_b128 v[124:127], v14 offset:15360
    v_mfma_f32_16x16x32_bf16 v[172:175], v[152:155], v[60:63], v[172:175]
    ds_read_b128 v[128:131], v14 offset:16384
    ds_read_b128 v[132:135], v14 offset:17408
    s_mov_b32 m0, s38
    s_nop 0
    buffer_load_dwordx4 v2, s[12:15], s39 offen offset:3072 lds
    s_add_u32 s38, s38, 4096
    s_add_u32 s39, s39, 4096
    s_waitcnt vmcnt(14)
    s_waitcnt lgkmcnt(5)
    v_mfma_f32_16x16x32_bf16 v[156:159], v[96:99], v[64:67], v[156:159]
    v_mfma_f32_16x16x32_bf16 v[160:163], v[100:103], v[64:67], v[160:163]
    ds_read_b128 v[136:139], v14 offset:18432
    s_mov_b32 m0, s38
    s_nop 0
    buffer_load_dwordx4 v2, s[12:15], s39 offen offset:0 lds
    v_mfma_f32_16x16x32_bf16 v[164:167], v[104:107], v[64:67], v[164:167]
    ds_read_b128 v[140:143], v14 offset:19456
    v_mfma_f32_16x16x32_bf16 v[168:171], v[108:111], v[64:67], v[168:171]
    ds_read_b128 v[144:147], v14 offset:20480
    v_mfma_f32_16x16x32_bf16 v[172:175], v[112:115], v[64:67], v[172:175]
    ds_read_b128 v[148:151], v14 offset:21504
    ds_read_b128 v[152:155], v14 offset:22528
    s_mov_b32 m0, s38
    s_nop 0
    buffer_load_dwordx4 v2, s[12:15], s39 offen offset:1024 lds
    s_waitcnt vmcnt(15)
    s_waitcnt lgkmcnt(5)
    v_mfma_f32_16x16x32_bf16 v[156:159], v[116:119], v[68:71], v[156:159]
    v_mfma_f32_16x16x32_bf16 v[160:163], v[120:123], v[68:71], v[160:163]
    ds_read_b128 v[96:99], v14 offset:23552
    s_mov_b32 m0, s38
    s_nop 0
    buffer_load_dwordx4 v2, s[12:15], s39 offen offset:2048 lds
    v_mfma_f32_16x16x32_bf16 v[164:167], v[124:127], v[68:71], v[164:167]
    ds_read_b128 v[100:103], v14 offset:24576
    v_mfma_f32_16x16x32_bf16 v[168:171], v[128:131], v[68:71], v[168:171]
    ds_read_b128 v[104:107], v14 offset:25600
    v_mfma_f32_16x16x32_bf16 v[172:175], v[132:135], v[68:71], v[172:175]
    ds_read_b128 v[108:111], v14 offset:26624
    ds_read_b128 v[112:115], v14 offset:27648
    s_mov_b32 m0, s38
    s_nop 0
    buffer_load_dwordx4 v2, s[12:15], s39 offen offset:3072 lds
    s_add_u32 s38, s38, 4096
    s_add_u32 s39, s39, 4096
    s_waitcnt vmcnt(16)
    s_waitcnt lgkmcnt(5)
    v_mfma_f32_16x16x32_bf16 v[156:159], v[136:139], v[72:75], v[156:159]
    v_mfma_f32_16x16x32_bf16 v[160:163], v[140:143], v[72:75], v[160:163]
    ds_read_b128 v[116:119], v14 offset:28672
    s_mov_b32 m0, s38
    s_nop 0
    buffer_load_dwordx4 v2, s[12:15], s39 offen offset:0 lds
    v_mfma_f32_16x16x32_bf16 v[164:167], v[144:147], v[72:75], v[164:167]
    ds_read_b128 v[120:123], v14 offset:29696
    v_mfma_f32_16x16x32_bf16 v[168:171], v[148:151], v[72:75], v[168:171]
    ds_read_b128 v[124:127], v14 offset:30720
    v_mfma_f32_16x16x32_bf16 v[172:175], v[152:155], v[72:75], v[172:175]
    ds_read_b128 v[128:131], v14 offset:31744
    ds_read_b128 v[132:135], v14 offset:32768
    s_mov_b32 m0, s38
    s_nop 0
    buffer_load_dwordx4 v2, s[12:15], s39 offen offset:1024 lds
    s_waitcnt vmcnt(17)
    s_waitcnt lgkmcnt(5)
    v_mfma_f32_16x16x32_bf16 v[156:159], v[96:99], v[76:79], v[156:159]
    v_mfma_f32_16x16x32_bf16 v[160:163], v[100:103], v[76:79], v[160:163]
    ds_read_b128 v[136:139], v14 offset:33792
    s_mov_b32 m0, s38
    s_nop 0
    buffer_load_dwordx4 v2, s[12:15], s39 offen offset:2048 lds
    v_mfma_f32_16x16x32_bf16 v[164:167], v[104:107], v[76:79], v[164:167]
    ds_read_b128 v[140:143], v14 offset:34816
    v_mfma_f32_16x16x32_bf16 v[168:171], v[108:111], v[76:79], v[168:171]
    ds_read_b128 v[144:147], v14 offset:35840
    v_mfma_f32_16x16x32_bf16 v[172:175], v[112:115], v[76:79], v[172:175]
    ds_read_b128 v[148:151], v14 offset:36864
    ds_read_b128 v[152:155], v14 offset:37888
    s_mov_b32 m0, s38
    s_nop 0
    buffer_load_dwordx4 v2, s[12:15], s39 offen offset:3072 lds
    s_waitcnt vmcnt(18)
    s_waitcnt lgkmcnt(5)
    v_mfma_f32_16x16x32_bf16 v[156:159], v[116:119], v[80:83], v[156:159]
    v_mfma_f32_16x16x32_bf16 v[160:163], v[120:123], v[80:83], v[160:163]
    ds_read_b128 v[96:99], v14 offset:38912
    v_mfma_f32_16x16x32_bf16 v[164:167], v[124:127], v[80:83], v[164:167]
    ds_read_b128 v[100:103], v14 offset:39936
    v_mfma_f32_16x16x32_bf16 v[168:171], v[128:131], v[80:83], v[168:171]
    ds_read_b128 v[104:107], v14 offset:40960
    v_mfma_f32_16x16x32_bf16 v[172:175], v[132:135], v[80:83], v[172:175]
    ds_read_b128 v[108:111], v14 offset:41984
    ds_read_b128 v[112:115], v14 offset:43008
    s_waitcnt vmcnt(17)
    s_waitcnt lgkmcnt(5)
    v_mfma_f32_16x16x32_bf16 v[156:159], v[136:139], v[84:87], v[156:159]
    v_mfma_f32_16x16x32_bf16 v[160:163], v[140:143], v[84:87], v[160:163]
    ds_read_b128 v[116:119], v14 offset:44032
    v_mfma_f32_16x16x32_bf16 v[164:167], v[144:147], v[84:87], v[164:167]
    ds_read_b128 v[120:123], v14 offset:45056
    v_mfma_f32_16x16x32_bf16 v[168:171], v[148:151], v[84:87], v[168:171]
    ds_read_b128 v[124:127], v14 offset:46080
    v_mfma_f32_16x16x32_bf16 v[172:175], v[152:155], v[84:87], v[172:175]
    ds_read_b128 v[128:131], v14 offset:47104
    ds_read_b128 v[132:135], v14 offset:48128
    s_waitcnt vmcnt(16)
    s_waitcnt lgkmcnt(5)
    v_mfma_f32_16x16x32_bf16 v[156:159], v[96:99], v[88:91], v[156:159]
    v_mfma_f32_16x16x32_bf16 v[160:163], v[100:103], v[88:91], v[160:163]
    v_mfma_f32_16x16x32_bf16 v[164:167], v[104:107], v[88:91], v[164:167]
    v_mfma_f32_16x16x32_bf16 v[168:171], v[108:111], v[88:91], v[168:171]
    v_mfma_f32_16x16x32_bf16 v[172:175], v[112:115], v[88:91], v[172:175]
    s_waitcnt vmcnt(15)
    s_waitcnt lgkmcnt(0)
    v_mfma_f32_16x16x32_bf16 v[156:159], v[116:119], v[92:95], v[156:159]
    v_mfma_f32_16x16x32_bf16 v[160:163], v[120:123], v[92:95], v[160:163]
    v_mfma_f32_16x16x32_bf16 v[164:167], v[124:127], v[92:95], v[164:167]
    v_mfma_f32_16x16x32_bf16 v[168:171], v[128:131], v[92:95], v[168:171]
    v_mfma_f32_16x16x32_bf16 v[172:175], v[132:135], v[92:95], v[172:175]
    s_barrier
    s_mul_i32 s38, s30, 1024
    s_add_u32 s39, s38, s45
    s_add_u32 s39, s39, 102400
    s_add_u32 s38, s38, 151552
    s_mov_b32 m0, s38
    s_nop 0
    buffer_load_dwordx4 v2, s[12:15], s39 offen offset:0 lds
    s_mul_i32 s38, s30, 9216
    s_add_u32 s39, s38, s45
    s_add_u32 s39, s39, 106496
    s_add_u32 s38, s38, 0
    s_mov_b32 m0, s38
    s_nop 0
    buffer_load_dwordx4 v2, s[12:15], s39 offen offset:0 lds
    s_mov_b32 m0, s38
    s_nop 0
    buffer_load_dwordx4 v2, s[12:15], s39 offen offset:1024 lds
    s_mov_b32 m0, s38
    s_nop 0
    buffer_load_dwordx4 v2, s[12:15], s39 offen offset:2048 lds
    s_mov_b32 m0, s38
    s_nop 0
    buffer_load_dwordx4 v2, s[12:15], s39 offen offset:3072 lds
    s_add_u32 s38, s38, 4096
    s_add_u32 s39, s39, 4096
    s_mov_b32 m0, s38
    s_nop 0
    buffer_load_dwordx4 v2, s[12:15], s39 offen offset:0 lds
    s_mov_b32 m0, s38
    s_nop 0
    buffer_load_dwordx4 v2, s[12:15], s39 offen offset:1024 lds
    s_mov_b32 m0, s38
    s_nop 0
    buffer_load_dwordx4 v2, s[12:15], s39 offen offset:2048 lds
    s_mov_b32 m0, s38
    s_nop 0
    buffer_load_dwordx4 v2, s[12:15], s39 offen offset:3072 lds
    s_add_u32 s38, s38, 4096
    s_add_u32 s39, s39, 4096
    s_mov_b32 m0, s38
    s_nop 0
    buffer_load_dwordx4 v2, s[12:15], s39 offen offset:0 lds
    v_mov_b32 v196, 0x3f803f80
    v_mov_b32 v198, 0
    v_mov_b32 v199, 0
    s_waitcnt vmcnt(22)
    s_nop 1
    v_permlane16_swap_b32 v176, v178
    v_permlane16_swap_b32 v177, v179
    v_permlane16_swap_b32 v180, v182
    v_permlane16_swap_b32 v181, v183
    s_nop 1
    v_lshlrev_b32 v200, 16, v176
    v_and_b32 v201, 0xffff0000, v176
    v_lshlrev_b32 v202, 16, v177
    v_and_b32 v203, 0xffff0000, v177
    v_lshlrev_b32 v204, 16, v178
    v_and_b32 v205, 0xffff0000, v178
    v_lshlrev_b32 v206, 16, v179
    v_and_b32 v207, 0xffff0000, v179
    v_lshlrev_b32 v208, 16, v180
    v_and_b32 v209, 0xffff0000, v180
    v_lshlrev_b32 v210, 16, v181
    v_and_b32 v211, 0xffff0000, v181
    v_lshlrev_b32 v212, 16, v182
    v_and_b32 v213, 0xffff0000, v182
    v_lshlrev_b32 v214, 16, v183
    v_and_b32 v215, 0xffff0000, v183
    v_lshlrev_b32 v216, 16, v184
    v_and_b32 v217, 0xffff0000, v184
    v_lshlrev_b32 v218, 16, v185
    v_and_b32 v219, 0xffff0000, v185
    v_pk_add_f32 v[156:157], v[156:157], v[200:201]
    v_pk_add_f32 v[158:159], v[158:159], v[202:203]
    v_pk_add_f32 v[160:161], v[160:161], v[204:205]
    v_pk_add_f32 v[162:163], v[162:163], v[206:207]
    v_pk_add_f32 v[164:165], v[164:165], v[208:209]
    v_pk_add_f32 v[166:167], v[166:167], v[210:211]
    v_pk_add_f32 v[168:169], v[168:169], v[212:213]
    v_pk_add_f32 v[170:171], v[170:171], v[214:215]
    v_pk_add_f32 v[172:173], v[172:173], v[216:217]
    v_pk_add_f32 v[174:175], v[174:175], v[218:219]
    v_cvt_pk_bf16_f32 v156, v156, v157
    v_cvt_pk_bf16_f32 v157, v158, v159
    v_cvt_pk_bf16_f32 v158, v160, v161
    v_cvt_pk_bf16_f32 v159, v162, v163
    v_cvt_pk_bf16_f32 v164, v164, v165
    v_cvt_pk_bf16_f32 v165, v166, v167
    v_cvt_pk_bf16_f32 v166, v168, v169
    v_cvt_pk_bf16_f32 v167, v170, v171
    v_cvt_pk_bf16_f32 v172, v172, v173
    v_cvt_pk_bf16_f32 v173, v174, v175
    v_dot2_f32_bf16 v198, v156, v196, v198
    v_dot2_f32_bf16 v199, v156, v156, v199
    v_dot2_f32_bf16 v198, v157, v196, v198
    v_dot2_f32_bf16 v199, v157, v157, v199
    v_dot2_f32_bf16 v198, v158, v196, v198
    v_dot2_f32_bf16 v199, v158, v158, v199
    v_dot2_f32_bf16 v198, v159, v196, v198
    v_dot2_f32_bf16 v199, v159, v159, v199
    v_dot2_f32_bf16 v198, v164, v196, v198
    v_dot2_f32_bf16 v199, v164, v164, v199
    v_dot2_f32_bf16 v198, v165, v196, v198
    v_dot2_f32_bf16 v199, v165, v165, v199
    v_dot2_f32_bf16 v198, v166, v196, v198
    v_dot2_f32_bf16 v199, v166, v166, v199
    v_dot2_f32_bf16 v198, v167, v196, v198
    v_dot2_f32_bf16 v199, v167, v167, v199
    v_dot2_f32_bf16 v198, v172, v196, v198
    v_dot2_f32_bf16 v199, v172, v172, v199
    v_dot2_f32_bf16 v198, v173, v196, v198
    v_dot2_f32_bf16 v199, v173, v173, v199
    s_nop 1
    s_nop 1
    v_permlane16_swap_b32 v156, v158
    v_permlane16_swap_b32 v157, v159
    v_permlane16_swap_b32 v164, v166
    v_permlane16_swap_b32 v165, v167
    s_nop 2
    v_mov_b32 v188, v198
    v_mov_b32 v189, v199
    s_nop 1
    v_permlane32_swap_b32 v188, v198
    v_permlane32_swap_b32 v189, v199
    s_nop 0
    v_add_f32 v198, v198, v188
    v_add_f32 v199, v199, v189
    v_mov_b32 v188, v198
    v_mov_b32 v189, v199
    s_nop 1
    v_permlane16_swap_b32 v188, v198
    v_permlane16_swap_b32 v189, v199
    s_nop 0
    v_add_f32 v198, v198, v188
    v_add_f32 v199, v199, v189
    s_add_u32 s47, s54, 20480
    v_lshlrev_b32 v9, 6, v4
    s_lshl_b32 s41, s33, 3
    s_add_u32 s46, s46, s41
    s_lshl_b32 s41, s33, 2
    s_add_u32 s49, s55, s41
    v_mov_b32 v11, v9
    s_cmp_eq_u32 s31, 0
    s_cbranch_scc1 k2_kernel_slow26
    buffer_store_dwordx4 v[156:159], v254, s[12:15], s47 offen offset:0
    buffer_store_dwordx4 v[164:167], v254, s[12:15], s47 offen offset:1024
    buffer_store_dwordx2 v[172:173], v8, s[12:15], s47 offen offset:2048
    s_mov_b64 exec, 0xffff
    buffer_store_dwordx2 v[198:199], v11, s[12:15], s46 offen
    s_mov_b64 exec, -1
    s_waitcnt vmcnt(0)
    v_mov_b32 v9, 1
    v_mov_b32 v10, 4352
    s_mov_b64 exec, 1
    buffer_store_dword v9, v10, s[12:15], s49 offen
    s_mov_b64 exec, -1
    s_branch k2_kernel_sent27
k2_kernel_slow26:
    buffer_store_dwordx4 v[156:159], v254, s[12:15], s47 offen offset:0 sc1
    buffer_store_dwordx4 v[164:167], v254, s[12:15], s47 offen offset:1024 sc1
    buffer_store_dwordx2 v[172:173], v8, s[12:15], s47 offen offset:2048 sc1
    s_mov_b64 exec, 0xffff
    buffer_store_dwordx2 v[198:199], v11, s[12:15], s46 offen sc1
    s_mov_b64 exec, -1
    s_waitcnt vmcnt(0)
    v_mov_b32 v9, 1
    v_mov_b32 v10, 4352
    s_mov_b64 exec, 1
    buffer_store_dword v9, v10, s[12:15], s49 offen sc1
    s_mov_b64 exec, -1
k2_kernel_sent27:
    s_lshl_b32 s46, s34, 3
    s_lshl_b32 s47, s30, 1
    s_add_u32 s46, s46, s47
    s_lshl_b32 s49, s46, 7
    s_add_u32 s49, s49, 4352
    v_bfe_u32 v7, v1, 3, 1
    v_lshlrev_b32 v7, 7, v7
    v_and_b32 v9, 7, v1
    v_lshl_add_u32 v7, v9, 2, v7
    v_add_u32 v7, s49, v7
    s_sub_u32 s49, s55, s37
    s_add_u32 s49, s49, 128
    v_and_b32 v9, 3, v1
    v_lshlrev_b32 v9, 2, v9
    v_add_u32 v9, s49, v9
    v_and_b32 v10, 16, v1
    v_cmp_ne_u32 vcc, 0, v10
    v_mov_b32 v11, 1
    v_mov_b32 v10, 3
    v_cndmask_b32 v7, v7, v9, vcc
    v_cndmask_b32 v10, v11, v10, vcc
    s_mov_b32 s43, 200000
k2_kernel_poll28:
    buffer_load_dword v9, v7, s[12:15], s37 offen sc1
    s_waitcnt vmcnt(0)
    v_cmp_le_u32 vcc, v10, v9
    s_sub_u32 s43, s43, 1
    s_cmp_eq_u64 vcc, -1
    s_cbranch_scc1 k2_kernel_go29
    s_cmp_lg_u32 s43, 0
    s_cbranch_scc1 k2_kernel_poll28
k2_kernel_go29:
    s_mul_i32 s47, s46, 20480
    s_add_u32 s47, s47, s36
    s_add_u32 s47, s47, 20480
    s_add_u32 s48, s47, 20480
    s_add_u32 s41, s47, 0
    buffer_load_dwordx4 v[72:75], v2, s[12:15], s41 offen offset:0 sc1
    s_add_u32 s41, s48, 0
    buffer_load_dwordx4 v[76:79], v2, s[12:15], s41 offen offset:0 sc1
    s_add_u32 s41, s47, 0
    buffer_load_dwordx4 v[80:83], v2, s[12:15], s41 offen offset:1024 sc1
    s_add_u32 s41, s48, 0
    buffer_load_dwordx4 v[84:87], v2, s[12:15], s41 offen offset:1024 sc1
    s_add_u32 s41, s47, 0
    buffer_load_dwordx4 v[88:91], v2, s[12:15], s41 offen offset:2048 sc1
    s_add_u32 s41, s48, 0
    buffer_load_dwordx4 v[92:95], v2, s[12:15], s41 offen offset:2048 sc1
    v_lshlrev_b32 v9, 6, v4
    v_lshl_add_u32 v9, v3, 4, v9
    s_lshl_b32 s41, s46, 10
    s_add_u32 s41, s41, s36
    s_add_u32 s41, s41, 1581056
    buffer_load_dwordx4 v[216:219], v9, s[12:15], s41 offen offset:0 sc1
    buffer_load_dwordx4 v[220:223], v9, s[12:15], s41 offen offset:1024 sc1
    s_mul_i32 s52, s46, 55296
    s_mul_i32 s41, s35, 3584
    s_add_u32 s52, s52, s41
    s_add_u32 s52, s52, s36
    s_add_u32 s52, s52, 696320
    s_add_u32 s53, s52, 55296
    s_barrier
    v_add_u32 v11, 0x20000, v2
    ds_read_b128 v[160:163], v14 offset:49152
    ds_read_b128 v[164:167], v14 offset:50176
    ds_read_b128 v[168:171], v14 offset:51200
    ds_read_b128 v[172:175], v14 offset:52224
    ds_read_b128 v[176:179], v14 offset:53248
    ds_read_b128 v[180:183], v14 offset:54272
    ds_read_b128 v[184:187], v14 offset:55296
    s_waitcnt vmcnt(6)
    s_waitcnt lgkmcnt(6)
    v_mfma_f32_16x16x32_bf16 v[16:19], v[160:163], v[72:75], 0
    v_mfma_f32_16x16x32_bf16 v[44:47], v[160:163], v[76:79], 0
    ds_read_b128 v[188:191], v14 offset:56320
    s_waitcnt lgkmcnt(6)
    v_mfma_f32_16x16x32_bf16 v[20:23], v[164:167], v[72:75], 0
    v_mfma_f32_16x16x32_bf16 v[48:51], v[164:167], v[76:79], 0
    ds_read_b128 v[192:195], v14 offset:57344
    s_add_u32 s41, s47, 0
    buffer_load_dwordx4 v[96:99], v2, s[12:15], s41 offen offset:3072 sc1
    s_add_u32 s41, s48, 0
    buffer_load_dwordx4 v[100:103], v2, s[12:15], s41 offen offset:3072 sc1
    s_waitcnt lgkmcnt(6)
    v_mfma_f32_16x16x32_bf16 v[24:27], v[168:171], v[72:75], 0
    v_mfma_f32_16x16x32_bf16 v[52:55], v[168:171], v[76:79], 0
    ds_read_b128 v[196:199], v14 offset:58368
    s_waitcnt lgkmcnt(6)
    v_mfma_f32_16x16x32_bf16 v[28:31], v[172:175], v[72:75], 0
    v_mfma_f32_16x16x32_bf16 v[56:59], v[172:175], v[76:79], 0
    ds_read_b128 v[200:203], v14 offset:59392
    s_waitcnt lgkmcnt(6)
    v_mfma_f32_16x16x32_bf16 v[32:35], v[176:179], v[72:75], 0
    v_mfma_f32_16x16x32_bf16 v[60:63], v[176:179], v[76:79], 0
    ds_read_b128 v[204:207], v14 offset:60416
    s_add_u32 s41, s47, 4096
    buffer_load_dwordx4 v[104:107], v2, s[12:15], s41 offen offset:0 sc1
    s_add_u32 s41, s48, 4096
    buffer_load_dwordx4 v[108:111], v2, s[12:15], s41 offen offset:0 sc1
    s_waitcnt lgkmcnt(6)
    v_mfma_f32_16x16x32_bf16 v[36:39], v[180:183], v[72:75], 0
    v_mfma_f32_16x16x32_bf16 v[64:67], v[180:183], v[76:79], 0
    ds_read_b128 v[208:211], v14 offset:61440
    s_waitcnt lgkmcnt(6)
    v_mfma_f32_16x16x32_bf16 v[40:43], v[184:187], v[72:75], 0
    v_mfma_f32_16x16x32_bf16 v[68:71], v[184:187], v[76:79], 0
    ds_read_b128 v[212:215], v14 offset:62464
    s_waitcnt vmcnt(8)
    s_waitcnt lgkmcnt(6)
    v_mfma_f32_16x16x32_bf16 v[16:19], v[188:191], v[80:83], v[16:19]
    v_mfma_f32_16x16x32_bf16 v[44:47], v[188:191], v[84:87], v[44:47]
    ds_read_b128 v[160:163], v14 offset:63488
    s_waitcnt lgkmcnt(6)
    v_mfma_f32_16x16x32_bf16 v[20:23], v[192:195], v[80:83], v[20:23]
    v_mfma_f32_16x16x32_bf16 v[48:51], v[192:195], v[84:87], v[48:51]
    ds_read_b128 v[164:167], v14 offset:64512
    s_add_u32 s41, s47, 4096
    buffer_load_dwordx4 v[112:115], v2, s[12:15], s41 offen offset:1024 sc1
    s_add_u32 s41, s48, 4096
    buffer_load_dwordx4 v[116:119], v2, s[12:15], s41 offen offset:1024 sc1
    s_waitcnt lgkmcnt(6)
    v_mfma_f32_16x16x32_bf16 v[24:27], v[196:199], v[80:83], v[24:27]
    v_mfma_f32_16x16x32_bf16 v[52:55], v[196:199], v[84:87], v[52:55]
    ds_read_b128 v[168:171], v15 offset:0
    buffer_load_dwordx4 a[0:3], v2, s[12:15], s40 offen offset:0
    s_waitcnt lgkmcnt(6)
    v_mfma_f32_16x16x32_bf16 v[28:31], v[200:203], v[80:83], v[28:31]
    v_mfma_f32_16x16x32_bf16 v[56:59], v[200:203], v[84:87], v[56:59]
    ds_read_b128 v[172:175], v15 offset:1024
    buffer_load_dwordx4 a[4:7], v2, s[12:15], s40 offen offset:1024
    s_waitcnt lgkmcnt(6)
    v_mfma_f32_16x16x32_bf16 v[32:35], v[204:207], v[80:83], v[32:35]
    v_mfma_f32_16x16x32_bf16 v[60:63], v[204:207], v[84:87], v[60:63]
    ds_read_b128 v[176:179], v15 offset:2048
    s_add_u32 s41, s47, 4096
    buffer_load_dwordx4 v[120:123], v2, s[12:15], s41 offen offset:2048 sc1
    s_add_u32 s41, s48, 4096
    buffer_load_dwordx4 v[124:127], v2, s[12:15], s41 offen offset:2048 sc1
    s_waitcnt lgkmcnt(6)
    v_mfma_f32_16x16x32_bf16 v[36:39], v[208:211], v[80:83], v[36:39]
    v_mfma_f32_16x16x32_bf16 v[64:67], v[208:211], v[84:87], v[64:67]
    ds_read_b128 v[180:183], v15 offset:3072
    buffer_load_dwordx4 a[8:11], v2, s[12:15], s40 offen offset:2048
    s_waitcnt lgkmcnt(6)
    v_mfma_f32_16x16x32_bf16 v[40:43], v[212:215], v[80:83], v[40:43]
    v_mfma_f32_16x16x32_bf16 v[68:71], v[212:215], v[84:87], v[68:71]
    ds_read_b128 v[184:187], v15 offset:4096
    s_waitcnt vmcnt(13)
    s_waitcnt lgkmcnt(6)
    v_mfma_f32_16x16x32_bf16 v[16:19], v[160:163], v[88:91], v[16:19]
    v_mfma_f32_16x16x32_bf16 v[44:47], v[160:163], v[92:95], v[44:47]
    ds_read_b128 v[188:191], v15 offset:5120
    s_waitcnt lgkmcnt(6)
    v_mfma_f32_16x16x32_bf16 v[20:23], v[164:167], v[88:91], v[20:23]
    v_mfma_f32_16x16x32_bf16 v[48:51], v[164:167], v[92:95], v[48:51]
    ds_read_b128 v[192:195], v15 offset:6144
    s_add_u32 s41, s47, 4096
    buffer_load_dwordx4 v[128:131], v2, s[12:15], s41 offen offset:3072 sc1
    s_add_u32 s41, s48, 4096
    buffer_load_dwordx4 v[132:135], v2, s[12:15], s41 offen offset:3072 sc1
    s_waitcnt lgkmcnt(6)
    v_mfma_f32_16x16x32_bf16 v[24:27], v[168:171], v[88:91], v[24:27]
    v_mfma_f32_16x16x32_bf16 v[52:55], v[168:171], v[92:95], v[52:55]
    ds_read_b128 v[196:199], v15 offset:7168
    buffer_load_dwordx4 a[12:15], v2, s[12:15], s40 offen offset:3072
    s_add_u32 s40, s40, 4096
    s_waitcnt lgkmcnt(6)
    v_mfma_f32_16x16x32_bf16 v[28:31], v[172:175], v[88:91], v[28:31]
    v_mfma_f32_16x16x32_bf16 v[56:59], v[172:175], v[92:95], v[56:59]
    ds_read_b128 v[200:203], v15 offset:8192
    buffer_load_dwordx4 a[16:19], v2, s[12:15], s40 offen offset:0
    s_waitcnt lgkmcnt(6)
    v_mfma_f32_16x16x32_bf16 v[32:35], v[176:179], v[88:91], v[32:35]
    v_mfma_f32_16x16x32_bf16 v[60:63], v[176:179], v[92:95], v[60:63]
    ds_read_b128 v[204:207], v15 offset:9216
    s_add_u32 s41, s47, 8192
    buffer_load_dwordx4 v[136:139], v2, s[12:15], s41 offen offset:0 sc1
    s_add_u32 s41, s48, 8192
    buffer_load_dwordx4 v[140:143], v2, s[12:15], s41 offen offset:0 sc1
    s_waitcnt lgkmcnt(6)
    v_mfma_f32_16x16x32_bf16 v[36:39], v[180:183], v[88:91], v[36:39]
    v_mfma_f32_16x16x32_bf16 v[64:67], v[180:183], v[92:95], v[64:67]
    ds_read_b128 v[208:211], v15 offset:10240
    buffer_load_dwordx4 a[20:23], v2, s[12:15], s40 offen offset:1024
    s_waitcnt lgkmcnt(6)
    v_mfma_f32_16x16x32_bf16 v[40:43], v[184:187], v[88:91], v[40:43]
    v_mfma_f32_16x16x32_bf16 v[68:71], v[184:187], v[92:95], v[68:71]
    ds_read_b128 v[212:215], v15 offset:11264
    s_waitcnt vmcnt(16)
    s_waitcnt lgkmcnt(6)
    v_mfma_f32_16x16x32_bf16 v[16:19], v[188:191], v[96:99], v[16:19]
    v_mfma_f32_16x16x32_bf16 v[44:47], v[188:191], v[100:103], v[44:47]
    ds_read_b128 v[160:163], v15 offset:12288
    s_waitcnt lgkmcnt(6)
    v_mfma_f32_16x16x32_bf16 v[20:23], v[192:195], v[96:99], v[20:23]
    v_mfma_f32_16x16x32_bf16 v[48:51], v[192:195], v[100:103], v[48:51]
    ds_read_b128 v[164:167], v15 offset:13312
    s_add_u32 s41, s47, 8192
    buffer_load_dwordx4 v[144:147], v2, s[12:15], s41 offen offset:1024 sc1
    s_add_u32 s41, s48, 8192
    buffer_load_dwordx4 v[148:151], v2, s[12:15], s41 offen offset:1024 sc1
    s_waitcnt lgkmcnt(6)
    v_mfma_f32_16x16x32_bf16 v[24:27], v[196:199], v[96:99], v[24:27]
    v_mfma_f32_16x16x32_bf16 v[52:55], v[196:199], v[100:103], v[52:55]
    ds_read_b128 v[168:171], v15 offset:14336
    buffer_load_dwordx4 a[24:27], v2, s[12:15], s40 offen offset:2048
    s_waitcnt lgkmcnt(6)
    v_mfma_f32_16x16x32_bf16 v[28:31], v[200:203], v[96:99], v[28:31]
    v_mfma_f32_16x16x32_bf16 v[56:59], v[200:203], v[100:103], v[56:59]
    ds_read_b128 v[172:175], v15 offset:15360
    buffer_load_dwordx4 a[28:31], v2, s[12:15], s40 offen offset:3072
    s_add_u32 s40, s40, 4096
    s_waitcnt lgkmcnt(6)
    v_mfma_f32_16x16x32_bf16 v[32:35], v[204:207], v[96:99], v[32:35]
    v_mfma_f32_16x16x32_bf16 v[60:63], v[204:207], v[100:103], v[60:63]
    ds_read_b128 v[176:179], v15 offset:16384
    s_waitcnt lgkmcnt(6)
    v_mfma_f32_16x16x32_bf16 v[36:39], v[208:211], v[96:99], v[36:39]
    v_mfma_f32_16x16x32_bf16 v[64:67], v[208:211], v[100:103], v[64:67]
    ds_read_b128 v[180:183], v15 offset:17408
    buffer_load_dwordx4 a[32:35], v2, s[12:15], s40 offen offset:0
    s_waitcnt lgkmcnt(6)
    v_mfma_f32_16x16x32_bf16 v[40:43], v[212:215], v[96:99], v[40:43]
    v_mfma_f32_16x16x32_bf16 v[68:71], v[212:215], v[100:103], v[68:71]
    ds_read_b128 v[184:187], v15 offset:18432
    s_waitcnt vmcnt(19)
    s_waitcnt lgkmcnt(6)
    v_mfma_f32_16x16x32_bf16 v[16:19], v[160:163], v[104:107], v[16:19]
    v_mfma_f32_16x16x32_bf16 v[44:47], v[160:163], v[108:111], v[44:47]
    ds_read_b128 v[188:191], v15 offset:19456
    s_waitcnt lgkmcnt(6)
    v_mfma_f32_16x16x32_bf16 v[20:23], v[164:167], v[104:107], v[20:23]
    v_mfma_f32_16x16x32_bf16 v[48:51], v[164:167], v[108:111], v[48:51]
    ds_read_b128 v[192:195], v15 offset:20480
    s_add_u32 s41, s47, 8192
    buffer_load_dwordx4 v[152:155], v2, s[12:15], s41 offen offset:2048 sc1
    s_add_u32 s41, s48, 8192
    buffer_load_dwordx4 v[156:159], v2, s[12:15], s41 offen offset:2048 sc1
    s_waitcnt lgkmcnt(6)
    v_mfma_f32_16x16x32_bf16 v[24:27], v[168:171], v[104:107], v[24:27]
    v_mfma_f32_16x16x32_bf16 v[52:55], v[168:171], v[108:111], v[52:55]
    ds_read_b128 v[196:199], v15 offset:21504
    buffer_load_dwordx4 a[36:39], v2, s[12:15], s40 offen offset:1024
    s_waitcnt lgkmcnt(6)
    v_mfma_f32_16x16x32_bf16 v[28:31], v[172:175], v[104:107], v[28:31]
    v_mfma_f32_16x16x32_bf16 v[56:59], v[172:175], v[108:111], v[56:59]
    ds_read_b128 v[200:203], v15 offset:22528
    buffer_load_dwordx4 a[40:43], v2, s[12:15], s40 offen offset:2048
    s_waitcnt lgkmcnt(6)
    v_mfma_f32_16x16x32_bf16 v[32:35], v[176:179], v[104:107], v[32:35]
    v_mfma_f32_16x16x32_bf16 v[60:63], v[176:179], v[108:111], v[60:63]
    ds_read_b128 v[204:207], v15 offset:23552
    s_waitcnt lgkmcnt(6)
    v_mfma_f32_16x16x32_bf16 v[36:39], v[180:183], v[104:107], v[36:39]
    v_mfma_f32_16x16x32_bf16 v[64:67], v[180:183], v[108:111], v[64:67]
    ds_read_b128 v[208:211], v15 offset:24576
    buffer_load_dwordx4 a[44:47], v2, s[12:15], s40 offen offset:3072
    s_add_u32 s40, s40, 4096
    s_waitcnt lgkmcnt(6)
    v_mfma_f32_16x16x32_bf16 v[40:43], v[184:187], v[104:107], v[40:43]
    v_mfma_f32_16x16x32_bf16 v[68:71], v[184:187], v[108:111], v[68:71]
    ds_read_b128 v[212:215], v15 offset:25600
    s_waitcnt vmcnt(22)
    s_waitcnt lgkmcnt(6)
    v_mfma_f32_16x16x32_bf16 v[16:19], v[188:191], v[112:115], v[16:19]
    v_mfma_f32_16x16x32_bf16 v[44:47], v[188:191], v[116:119], v[44:47]
    ds_read_b128 v[160:163], v15 offset:26624
    v_add_f32 v224, v216, v218
    v_add_f32 v225, v217, v219
    s_waitcnt lgkmcnt(6)
    v_mfma_f32_16x16x32_bf16 v[20:23], v[192:195], v[112:115], v[20:23]
    v_mfma_f32_16x16x32_bf16 v[48:51], v[192:195], v[116:119], v[48:51]
    ds_read_b128 v[164:167], v15 offset:27648
    s_add_u32 s41, s47, 8192
    buffer_load_dwordx4 v[72:75], v2, s[12:15], s41 offen offset:3072 sc1
    s_add_u32 s41, s48, 8192
    buffer_load_dwordx4 v[76:79], v2, s[12:15], s41 offen offset:3072 sc1
    v_mov_b32 v216, v224
    v_mov_b32 v217, v225
    s_waitcnt lgkmcnt(6)
    v_mfma_f32_16x16x32_bf16 v[24:27], v[196:199], v[112:115], v[24:27]
    v_mfma_f32_16x16x32_bf16 v[52:55], v[196:199], v[116:119], v[52:55]
    ds_read_b128 v[168:171], v15 offset:28672
    buffer_load_dwordx4 a[48:51], v2, s[12:15], s40 offen offset:0
    s_nop 1
    v_permlane32_swap_b32 v216, v224
    s_waitcnt lgkmcnt(6)
    v_mfma_f32_16x16x32_bf16 v[28:31], v[200:203], v[112:115], v[28:31]
    v_mfma_f32_16x16x32_bf16 v[56:59], v[200:203], v[116:119], v[56:59]
    ds_read_b128 v[172:175], v15 offset:29696
    buffer_load_dwordx4 a[52:55], v2, s[12:15], s40 offen offset:1024
    v_permlane32_swap_b32 v217, v225
    s_nop 0
    s_waitcnt lgkmcnt(6)
    v_mfma_f32_16x16x32_bf16 v[32:35], v[204:207], v[112:115], v[32:35]
    v_mfma_f32_16x16x32_bf16 v[60:63], v[204:207], v[116:119], v[60:63]
    ds_read_b128 v[176:179], v15 offset:30720
    v_add_f32 v224, v224, v216
    v_add_f32 v225, v225, v217
    s_waitcnt lgkmcnt(6)
    v_mfma_f32_16x16x32_bf16 v[36:39], v[208:211], v[112:115], v[36:39]
    v_mfma_f32_16x16x32_bf16 v[64:67], v[208:211], v[116:119], v[64:67]
    ds_read_b128 v[180:183], v15 offset:31744
    buffer_load_dwordx4 a[56:59], v2, s[12:15], s40 offen offset:2048
    v_mov_b32 v216, v224
    v_mov_b32 v217, v225
    s_waitcnt lgkmcnt(6)
    v_mfma_f32_16x16x32_bf16 v[40:43], v[212:215], v[112:115], v[40:43]
    v_mfma_f32_16x16x32_bf16 v[68:71], v[212:215], v[116:119], v[68:71]
    ds_read_b128 v[184:187], v15 offset:32768
    s_nop 1
    v_permlane16_swap_b32 v216, v224
    s_waitcnt vmcnt(23)
    s_waitcnt lgkmcnt(6)
    v_mfma_f32_16x16x32_bf16 v[16:19], v[160:163], v[120:123], v[16:19]
    v_mfma_f32_16x16x32_bf16 v[44:47], v[160:163], v[124:127], v[44:47]
    ds_read_b128 v[188:191], v15 offset:33792
    v_permlane16_swap_b32 v217, v225
    s_nop 0
    s_waitcnt lgkmcnt(6)
    v_mfma_f32_16x16x32_bf16 v[20:23], v[164:167], v[120:123], v[20:23]
    v_mfma_f32_16x16x32_bf16 v[48:51], v[164:167], v[124:127], v[48:51]
    ds_read_b128 v[192:195], v15 offset:34816
    s_add_u32 s41, s47, 12288
    buffer_load_dwordx4 v[80:83], v2, s[12:15], s41 offen offset:0 sc1
    s_add_u32 s41, s48, 12288
    buffer_load_dwordx4 v[84:87], v2, s[12:15], s41 offen offset:0 sc1
    v_add_f32 v224, v224, v216
    v_add_f32 v225, v225, v217
    s_waitcnt lgkmcnt(6)
    v_mfma_f32_16x16x32_bf16 v[24:27], v[168:171], v[120:123], v[24:27]
    v_mfma_f32_16x16x32_bf16 v[52:55], v[168:171], v[124:127], v[52:55]
    ds_read_b128 v[196:199], v15 offset:35840
    buffer_load_dwordx4 a[60:63], v2, s[12:15], s40 offen offset:3072
    s_add_u32 s40, s40, 4096
    v_mul_f32 v224, 0x3acccccd, v224
    v_mul_f32 v225, 0x3acccccd, v225
    s_waitcnt lgkmcnt(6)
    v_mfma_f32_16x16x32_bf16 v[28:31], v[172:175], v[120:123], v[28:31]
    v_mfma_f32_16x16x32_bf16 v[56:59], v[172:175], v[124:127], v[56:59]
    ds_read_b128 v[200:203], v15 offset:36864
    buffer_load_dwordx4 a[64:67], v2, s[12:15], s40 offen offset:0
    v_fma_f32 v225, -v224, v224, v225
    v_max_f32 v225, 0, v225
    s_waitcnt lgkmcnt(6)
    v_mfma_f32_16x16x32_bf16 v[32:35], v[176:179], v[120:123], v[32:35]
    v_mfma_f32_16x16x32_bf16 v[60:63], v[176:179], v[124:127], v[60:63]
    ds_read_b128 v[204:207], v15 offset:37888
    v_cvt_pk_bf16_f32 v216, v224, v225
    v_lshlrev_b32 v224, 16, v216
    s_waitcnt lgkmcnt(6)
    v_mfma_f32_16x16x32_bf16 v[36:39], v[180:183], v[120:123], v[36:39]
    v_mfma_f32_16x16x32_bf16 v[64:67], v[180:183], v[124:127], v[64:67]
    ds_read_b128 v[208:211], v15 offset:38912
    buffer_load_dwordx4 a[68:71], v2, s[12:15], s40 offen offset:1024
    v_and_b32 v225, 0xffff0000, v216
    v_add_f32 v225, 0x3727c5ac, v225
    s_waitcnt lgkmcnt(6)
    v_mfma_f32_16x16x32_bf16 v[40:43], v[184:187], v[120:123], v[40:43]
    v_mfma_f32_16x16x32_bf16 v[68:71], v[184:187], v[124:127], v[68:71]
    ds_read_b128 v[212:215], v15 offset:39936
    v_cvt_pk_bf16_f32 v216, v225, v225
    v_lshlrev_b32 v225, 16, v216
    s_waitcnt vmcnt(25)
    s_waitcnt lgkmcnt(6)
    v_mfma_f32_16x16x32_bf16 v[16:19], v[188:191], v[128:131], v[16:19]
    v_mfma_f32_16x16x32_bf16 v[44:47], v[188:191], v[132:135], v[44:47]
    ds_read_b128 v[160:163], v15 offset:40960
    v_sqrt_f32 v225, v225
    s_nop 0
    s_waitcnt lgkmcnt(6)
    v_mfma_f32_16x16x32_bf16 v[20:23], v[192:195], v[128:131], v[20:23]
    v_mfma_f32_16x16x32_bf16 v[48:51], v[192:195], v[132:135], v[48:51]
    ds_read_b128 v[164:167], v15 offset:41984
    s_add_u32 s41, s47, 12288
    buffer_load_dwordx4 v[88:91], v2, s[12:15], s41 offen offset:1024 sc1
    s_add_u32 s41, s48, 12288
    buffer_load_dwordx4 v[92:95], v2, s[12:15], s41 offen offset:1024 sc1
    v_cvt_pk_bf16_f32 v216, v225, v225
    v_lshlrev_b32 v225, 16, v216
    s_waitcnt lgkmcnt(6)
    v_mfma_f32_16x16x32_bf16 v[24:27], v[196:199], v[128:131], v[24:27]
    v_mfma_f32_16x16x32_bf16 v[52:55], v[196:199], v[132:135], v[52:55]
    ds_read_b128 v[168:171], v15 offset:43008
    buffer_load_dwordx4 a[72:75], v2, s[12:15], s40 offen offset:2048
    v_rcp_f32 v225, v225
    s_nop 0
    s_waitcnt lgkmcnt(6)
    v_mfma_f32_16x16x32_bf16 v[28:31], v[200:203], v[128:131], v[28:31]
    v_mfma_f32_16x16x32_bf16 v[56:59], v[200:203], v[132:135], v[56:59]
    ds_read_b128 v[172:175], v15 offset:44032
    buffer_load_dwordx4 a[76:79], v2, s[12:15], s40 offen offset:3072
    s_add_u32 s40, s40, 4096
    v_mul_f32 v224, v224, v225
    v_sub_f32 v224, 0, v224
    s_waitcnt lgkmcnt(6)
    v_mfma_f32_16x16x32_bf16 v[32:35], v[204:207], v[128:131], v[32:35]
    v_mfma_f32_16x16x32_bf16 v[60:63], v[204:207], v[132:135], v[60:63]
    ds_read_b128 v[176:179], v15 offset:45056
    v_add_f32 v226, v220, v222
    v_add_f32 v227, v221, v223
    s_waitcnt lgkmcnt(6)
    v_mfma_f32_16x16x32_bf16 v[36:39], v[208:211], v[128:131], v[36:39]
    v_mfma_f32_16x16x32_bf16 v[64:67], v[208:211], v[132:135], v[64:67]
    ds_read_b128 v[180:183], v15 offset:46080
    buffer_load_dwordx4 a[80:83], v2, s[12:15], s40 offen offset:0
    v_mov_b32 v216, v226
    v_mov_b32 v217, v227
    s_waitcnt lgkmcnt(6)
    v_mfma_f32_16x16x32_bf16 v[40:43], v[212:215], v[128:131], v[40:43]
    v_mfma_f32_16x16x32_bf16 v[68:71], v[212:215], v[132:135], v[68:71]
    ds_read_b128 v[184:187], v15 offset:47104
    s_nop 1
    v_permlane32_swap_b32 v216, v226
    s_waitcnt vmcnt(26)
    s_waitcnt lgkmcnt(6)
    v_mfma_f32_16x16x32_bf16 v[16:19], v[160:163], v[136:139], v[16:19]
    v_mfma_f32_16x16x32_bf16 v[44:47], v[160:163], v[140:143], v[44:47]
    ds_read_b128 v[188:191], v15 offset:48128
    v_permlane32_swap_b32 v217, v227
    s_nop 0
    s_waitcnt lgkmcnt(6)
    v_mfma_f32_16x16x32_bf16 v[20:23], v[164:167], v[136:139], v[20:23]
    v_mfma_f32_16x16x32_bf16 v[48:51], v[164:167], v[140:143], v[48:51]
    ds_read_b128 v[192:195], v15 offset:49152
    s_add_u32 s41, s47, 12288
    buffer_load_dwordx4 v[96:99], v2, s[12:15], s41 offen offset:2048 sc1
    s_add_u32 s41, s48, 12288
    buffer_load_dwordx4 v[100:103], v2, s[12:15], s41 offen offset:2048 sc1
    v_add_f32 v226, v226, v216
    v_add_f32 v227, v227, v217
    s_waitcnt lgkmcnt(6)
    v_mfma_f32_16x16x32_bf16 v[24:27], v[168:171], v[136:139], v[24:27]
    v_mfma_f32_16x16x32_bf16 v[52:55], v[168:171], v[140:143], v[52:55]
    ds_read_b128 v[196:199], v15 offset:50176
    buffer_load_dwordx4 a[84:87], v2, s[12:15], s40 offen offset:1024
    v_mov_b32 v216, v226
    v_mov_b32 v217, v227
    s_waitcnt lgkmcnt(6)
    v_mfma_f32_16x16x32_bf16 v[28:31], v[172:175], v[136:139], v[28:31]
    v_mfma_f32_16x16x32_bf16 v[56:59], v[172:175], v[140:143], v[56:59]
    ds_read_b128 v[200:203], v15 offset:51200
    buffer_load_dwordx4 a[88:91], v2, s[12:15], s40 offen offset:2048
    s_nop 1
    v_permlane16_swap_b32 v216, v226
    s_waitcnt lgkmcnt(6)
    v_mfma_f32_16x16x32_bf16 v[32:35], v[176:179], v[136:139], v[32:35]
    v_mfma_f32_16x16x32_bf16 v[60:63], v[176:179], v[140:143], v[60:63]
    ds_read_b128 v[204:207], v15 offset:52224
    v_permlane16_swap_b32 v217, v227
    s_nop 0
    s_waitcnt lgkmcnt(6)
    v_mfma_f32_16x16x32_bf16 v[36:39], v[180:183], v[136:139], v[36:39]
    v_mfma_f32_16x16x32_bf16 v[64:67], v[180:183], v[140:143], v[64:67]
    ds_read_b128 v[208:211], v15 offset:53248
    buffer_load_dwordx4 a[92:95], v2, s[12:15], s40 offen offset:3072
    s_add_u32 s40, s40, 4096
    v_add_f32 v226, v226, v216
    v_add_f32 v227, v227, v217
    s_waitcnt lgkmcnt(6)
    v_mfma_f32_16x16x32_bf16 v[40:43], v[184:187], v[136:139], v[40:43]
    v_mfma_f32_16x16x32_bf16 v[68:71], v[184:187], v[140:143], v[68:71]
    ds_read_b128 v[212:215], v15 offset:54272
    v_mul_f32 v226, 0x3acccccd, v226
    v_mul_f32 v227, 0x3acccccd, v227
    s_waitcnt vmcnt(28)
    s_waitcnt lgkmcnt(6)
    v_mfma_f32_16x16x32_bf16 v[16:19], v[188:191], v[144:147], v[16:19]
    v_mfma_f32_16x16x32_bf16 v[44:47], v[188:191], v[148:151], v[44:47]
    ds_read_b128 v[160:163], v15 offset:55296
    v_fma_f32 v227, -v226, v226, v227
    v_max_f32 v227, 0, v227
    s_waitcnt lgkmcnt(6)
    v_mfma_f32_16x16x32_bf16 v[20:23], v[192:195], v[144:147], v[20:23]
    v_mfma_f32_16x16x32_bf16 v[48:51], v[192:195], v[148:151], v[48:51]
    ds_read_b128 v[164:167], v15 offset:56320
    s_add_u32 s41, s47, 12288
    buffer_load_dwordx4 v[104:107], v2, s[12:15], s41 offen offset:3072 sc1
    s_add_u32 s41, s48, 12288
    buffer_load_dwordx4 v[108:111], v2, s[12:15], s41 offen offset:3072 sc1
    v_cvt_pk_bf16_f32 v216, v226, v227
    v_lshlrev_b32 v226, 16, v216
    s_waitcnt lgkmcnt(6)
    v_mfma_f32_16x16x32_bf16 v[24:27], v[196:199], v[144:147], v[24:27]
    v_mfma_f32_16x16x32_bf16 v[52:55], v[196:199], v[148:151], v[52:55]
    ds_read_b128 v[168:171], v15 offset:57344
    buffer_load_dwordx4 a[96:99], v2, s[12:15], s40 offen offset:0
    v_and_b32 v227, 0xffff0000, v216
    v_add_f32 v227, 0x3727c5ac, v227
    s_waitcnt lgkmcnt(6)
    v_mfma_f32_16x16x32_bf16 v[28:31], v[200:203], v[144:147], v[28:31]
    v_mfma_f32_16x16x32_bf16 v[56:59], v[200:203], v[148:151], v[56:59]
    ds_read_b128 v[172:175], v15 offset:58368
    buffer_load_dwordx4 a[100:103], v2, s[12:15], s40 offen offset:1024
    v_cvt_pk_bf16_f32 v216, v227, v227
    v_lshlrev_b32 v227, 16, v216
    s_waitcnt lgkmcnt(6)
    v_mfma_f32_16x16x32_bf16 v[32:35], v[204:207], v[144:147], v[32:35]
    v_mfma_f32_16x16x32_bf16 v[60:63], v[204:207], v[148:151], v[60:63]
    ds_read_b128 v[176:179], v15 offset:59392
    v_sqrt_f32 v227, v227
    s_nop 0
    s_waitcnt lgkmcnt(6)
    v_mfma_f32_16x16x32_bf16 v[36:39], v[208:211], v[144:147], v[36:39]
    v_mfma_f32_16x16x32_bf16 v[64:67], v[208:211], v[148:151], v[64:67]
    ds_read_b128 v[180:183], v15 offset:60416
    buffer_load_dwordx4 a[104:107], v2, s[12:15], s40 offen offset:2048
    v_cvt_pk_bf16_f32 v216, v227, v227
    v_lshlrev_b32 v227, 16, v216
    s_waitcnt lgkmcnt(6)
    v_mfma_f32_16x16x32_bf16 v[40:43], v[212:215], v[144:147], v[40:43]
    v_mfma_f32_16x16x32_bf16 v[68:71], v[212:215], v[148:151], v[68:71]
    ds_read_b128 v[184:187], v15 offset:61440
    v_rcp_f32 v227, v227
    s_nop 0
    s_waitcnt vmcnt(28)
    s_waitcnt lgkmcnt(6)
    v_mfma_f32_16x16x32_bf16 v[16:19], v[160:163], v[152:155], v[16:19]
    v_mfma_f32_16x16x32_bf16 v[44:47], v[160:163], v[156:159], v[44:47]
    ds_read_b128 v[188:191], v15 offset:62464
    v_mul_f32 v226, v226, v227
    v_sub_f32 v226, 0, v226
    s_waitcnt lgkmcnt(6)
    v_mfma_f32_16x16x32_bf16 v[20:23], v[164:167], v[152:155], v[20:23]
    v_mfma_f32_16x16x32_bf16 v[48:51], v[164:167], v[156:159], v[48:51]
    ds_read_b128 v[192:195], v15 offset:63488
    s_add_u32 s41, s47, 16384
    buffer_load_dwordx4 v[112:115], v2, s[12:15], s41 offen offset:0 sc1
    s_add_u32 s41, s48, 16384
    buffer_load_dwordx4 v[116:119], v2, s[12:15], s41 offen offset:0 sc1
    s_waitcnt lgkmcnt(6)
    v_mfma_f32_16x16x32_bf16 v[24:27], v[168:171], v[152:155], v[24:27]
    v_mfma_f32_16x16x32_bf16 v[52:55], v[168:171], v[156:159], v[52:55]
    ds_read_b128 v[196:199], v15 offset:64512
    buffer_load_dwordx4 a[108:111], v2, s[12:15], s40 offen offset:3072
    s_add_u32 s40, s40, 4096
    s_waitcnt lgkmcnt(6)
    v_mfma_f32_16x16x32_bf16 v[28:31], v[172:175], v[152:155], v[28:31]
    v_mfma_f32_16x16x32_bf16 v[56:59], v[172:175], v[156:159], v[56:59]
    ds_read_b128 v[200:203], v11 offset:0
    buffer_load_dwordx4 a[112:115], v2, s[12:15], s40 offen offset:0
    s_waitcnt lgkmcnt(6)
    v_mfma_f32_16x16x32_bf16 v[32:35], v[176:179], v[152:155], v[32:35]
    v_mfma_f32_16x16x32_bf16 v[60:63], v[176:179], v[156:159], v[60:63]
    ds_read_b128 v[204:207], v11 offset:1024
    s_waitcnt lgkmcnt(6)
    v_mfma_f32_16x16x32_bf16 v[36:39], v[180:183], v[152:155], v[36:39]
    v_mfma_f32_16x16x32_bf16 v[64:67], v[180:183], v[156:159], v[64:67]
    ds_read_b128 v[208:211], v11 offset:2048
    buffer_load_dwordx4 a[116:119], v2, s[12:15], s40 offen offset:1024
    s_waitcnt lgkmcnt(6)
    v_mfma_f32_16x16x32_bf16 v[40:43], v[184:187], v[152:155], v[40:43]
    v_mfma_f32_16x16x32_bf16 v[68:71], v[184:187], v[156:159], v[68:71]
    ds_read_b128 v[212:215], v11 offset:3072
    s_waitcnt vmcnt(28)
    s_waitcnt lgkmcnt(6)
    v_mfma_f32_16x16x32_bf16 v[16:19], v[188:191], v[72:75], v[16:19]
    v_mfma_f32_16x16x32_bf16 v[44:47], v[188:191], v[76:79], v[44:47]
    ds_read_b128 v[160:163], v11 offset:4096
    s_waitcnt lgkmcnt(6)
    v_mfma_f32_16x16x32_bf16 v[20:23], v[192:195], v[72:75], v[20:23]
    v_mfma_f32_16x16x32_bf16 v[48:51], v[192:195], v[76:79], v[48:51]
    ds_read_b128 v[164:167], v11 offset:5120
    s_add_u32 s41, s47, 16384
    buffer_load_dwordx4 v[120:123], v2, s[12:15], s41 offen offset:1024 sc1
    s_add_u32 s41, s48, 16384
    buffer_load_dwordx4 v[124:127], v2, s[12:15], s41 offen offset:1024 sc1
    s_waitcnt lgkmcnt(6)
    v_mfma_f32_16x16x32_bf16 v[24:27], v[196:199], v[72:75], v[24:27]
    v_mfma_f32_16x16x32_bf16 v[52:55], v[196:199], v[76:79], v[52:55]
    ds_read_b128 v[168:171], v11 offset:6144
    buffer_load_dwordx4 a[120:123], v2, s[12:15], s40 offen offset:2048
    s_waitcnt lgkmcnt(6)
    v_mfma_f32_16x16x32_bf16 v[28:31], v[200:203], v[72:75], v[28:31]
    v_mfma_f32_16x16x32_bf16 v[56:59], v[200:203], v[76:79], v[56:59]
    ds_read_b128 v[172:175], v11 offset:7168
    buffer_load_dwordx4 a[124:127], v2, s[12:15], s40 offen offset:3072
    s_add_u32 s40, s40, 4096
    s_waitcnt lgkmcnt(6)
    v_mfma_f32_16x16x32_bf16 v[32:35], v[204:207], v[72:75], v[32:35]
    v_mfma_f32_16x16x32_bf16 v[60:63], v[204:207], v[76:79], v[60:63]
    ds_read_b128 v[176:179], v11 offset:8192
    s_waitcnt lgkmcnt(6)
    v_mfma_f32_16x16x32_bf16 v[36:39], v[208:211], v[72:75], v[36:39]
    v_mfma_f32_16x16x32_bf16 v[64:67], v[208:211], v[76:79], v[64:67]
    ds_read_b128 v[180:183], v11 offset:9216
    buffer_load_dwordx4 a[128:131], v2, s[12:15], s40 offen offset:0
    s_waitcnt lgkmcnt(6)
    v_mfma_f32_16x16x32_bf16 v[40:43], v[212:215], v[72:75], v[40:43]
    v_mfma_f32_16x16x32_bf16 v[68:71], v[212:215], v[76:79], v[68:71]
    ds_read_b128 v[184:187], v11 offset:10240
    s_waitcnt vmcnt(28)
    s_waitcnt lgkmcnt(6)
    v_mfma_f32_16x16x32_bf16 v[16:19], v[160:163], v[80:83], v[16:19]
    v_mfma_f32_16x16x32_bf16 v[44:47], v[160:163], v[84:87], v[44:47]
    ds_read_b128 v[188:191], v11 offset:11264
    s_waitcnt lgkmcnt(6)
    v_mfma_f32_16x16x32_bf16 v[20:23], v[164:167], v[80:83], v[20:23]
    v_mfma_f32_16x16x32_bf16 v[48:51], v[164:167], v[84:87], v[48:51]
    ds_read_b128 v[192:195], v11 offset:12288
    s_add_u32 s41, s47, 16384
    buffer_load_dwordx4 v[128:131], v2, s[12:15], s41 offen offset:2048 sc1
    s_add_u32 s41, s48, 16384
    buffer_load_dwordx4 v[132:135], v2, s[12:15], s41 offen offset:2048 sc1
    s_waitcnt lgkmcnt(6)
    v_mfma_f32_16x16x32_bf16 v[24:27], v[168:171], v[80:83], v[24:27]
    v_mfma_f32_16x16x32_bf16 v[52:55], v[168:171], v[84:87], v[52:55]
    ds_read_b128 v[196:199], v11 offset:13312
    buffer_load_dwordx4 a[132:135], v2, s[12:15], s40 offen offset:1024
    s_waitcnt lgkmcnt(6)
    v_mfma_f32_16x16x32_bf16 v[28:31], v[172:175], v[80:83], v[28:31]
    v_mfma_f32_16x16x32_bf16 v[56:59], v[172:175], v[84:87], v[56:59]
    ds_read_b128 v[200:203], v11 offset:14336
    buffer_load_dwordx4 a[136:139], v2, s[12:15], s40 offen offset:2048
    s_waitcnt lgkmcnt(6)
    v_mfma_f32_16x16x32_bf16 v[32:35], v[176:179], v[80:83], v[32:35]
    v_mfma_f32_16x16x32_bf16 v[60:63], v[176:179], v[84:87], v[60:63]
    ds_read_b128 v[204:207], v11 offset:15360
    s_waitcnt lgkmcnt(6)
    v_mfma_f32_16x16x32_bf16 v[36:39], v[180:183], v[80:83], v[36:39]
    v_mfma_f32_16x16x32_bf16 v[64:67], v[180:183], v[84:87], v[64:67]
    ds_read_b128 v[208:211], v11 offset:16384
    buffer_load_dwordx4 a[140:143], v2, s[12:15], s40 offen offset:3072
    s_add_u32 s40, s40, 4096
    s_waitcnt lgkmcnt(6)
    v_mfma_f32_16x16x32_bf16 v[40:43], v[184:187], v[80:83], v[40:43]
    v_mfma_f32_16x16x32_bf16 v[68:71], v[184:187], v[84:87], v[68:71]
    ds_read_b128 v[212:215], v11 offset:17408
    buffer_load_dwordx4 a[144:147], v2, s[12:15], s40 offen offset:0
    s_waitcnt vmcnt(29)
    s_waitcnt lgkmcnt(6)
    v_mfma_f32_16x16x32_bf16 v[16:19], v[188:191], v[88:91], v[16:19]
    v_mfma_f32_16x16x32_bf16 v[44:47], v[188:191], v[92:95], v[44:47]
    ds_read_b128 v[160:163], v11 offset:18432
    s_waitcnt lgkmcnt(6)
    v_mfma_f32_16x16x32_bf16 v[20:23], v[192:195], v[88:91], v[20:23]
    v_mfma_f32_16x16x32_bf16 v[48:51], v[192:195], v[92:95], v[48:51]
    ds_read_b128 v[164:167], v11 offset:19456
    s_add_u32 s41, s47, 16384
    buffer_load_dwordx4 v[136:139], v2, s[12:15], s41 offen offset:3072 sc1
    s_add_u32 s41, s48, 16384
    buffer_load_dwordx4 v[140:143], v2, s[12:15], s41 offen offset:3072 sc1
    s_waitcnt lgkmcnt(6)
    v_mfma_f32_16x16x32_bf16 v[24:27], v[196:199], v[88:91], v[24:27]
    v_mfma_f32_16x16x32_bf16 v[52:55], v[196:199], v[92:95], v[52:55]
    ds_read_b128 v[168:171], v11 offset:20480
    buffer_load_dwordx4 a[148:151], v2, s[12:15], s40 offen offset:1024
    s_waitcnt lgkmcnt(6)
    v_mfma_f32_16x16x32_bf16 v[28:31], v[200:203], v[88:91], v[28:31]
    v_mfma_f32_16x16x32_bf16 v[56:59], v[200:203], v[92:95], v[56:59]
    ds_read_b128 v[172:175], v11 offset:21504
    buffer_load_dwordx4 a[152:155], v2, s[12:15], s40 offen offset:2048
    s_waitcnt lgkmcnt(6)
    v_mfma_f32_16x16x32_bf16 v[32:35], v[204:207], v[88:91], v[32:35]
    v_mfma_f32_16x16x32_bf16 v[60:63], v[204:207], v[92:95], v[60:63]
    ds_read_b128 v[176:179], v11 offset:22528
    s_waitcnt lgkmcnt(6)
    v_mfma_f32_16x16x32_bf16 v[36:39], v[208:211], v[88:91], v[36:39]
    v_mfma_f32_16x16x32_bf16 v[64:67], v[208:211], v[92:95], v[64:67]
    ds_read_b128 v[180:183], v11 offset:23552
    buffer_load_dwordx4 a[156:159], v2, s[12:15], s40 offen offset:3072
    s_add_u32 s40, s40, 4096
    s_waitcnt lgkmcnt(6)
    v_mfma_f32_16x16x32_bf16 v[40:43], v[212:215], v[88:91], v[40:43]
    v_mfma_f32_16x16x32_bf16 v[68:71], v[212:215], v[92:95], v[68:71]
    ds_read_b128 v[184:187], v14 offset:0
    buffer_load_dwordx4 a[160:163], v2, s[12:15], s40 offen offset:0
    s_add_u32 s48, s54, 368640
    buffer_load_dwordx4 v[228:231], v254, s[12:15], s48 offen sc1
    buffer_load_dwordx4 v[232:235], v254, s[12:15], s48 offen offset:1024 sc1
    buffer_load_dwordx2 v[236:237], v8, s[12:15], s48 offen offset:2048 sc1
    s_waitcnt vmcnt(33)
    s_waitcnt lgkmcnt(6)
    v_mfma_f32_16x16x32_bf16 v[16:19], v[160:163], v[96:99], v[16:19]
    v_mfma_f32_16x16x32_bf16 v[44:47], v[160:163], v[100:103], v[44:47]
    ds_read_b128 v[188:191], v14 offset:1024
    s_waitcnt lgkmcnt(6)
    v_mfma_f32_16x16x32_bf16 v[20:23], v[164:167], v[96:99], v[20:23]
    v_mfma_f32_16x16x32_bf16 v[48:51], v[164:167], v[100:103], v[48:51]
    ds_read_b128 v[192:195], v14 offset:2048
    s_waitcnt lgkmcnt(6)
    v_mfma_f32_16x16x32_bf16 v[24:27], v[168:171], v[96:99], v[24:27]
    v_mfma_f32_16x16x32_bf16 v[52:55], v[168:171], v[100:103], v[52:55]
    ds_read_b128 v[196:199], v14 offset:3072
    buffer_load_dwordx4 a[164:167], v2, s[12:15], s40 offen offset:1024
    s_waitcnt lgkmcnt(6)
    v_mfma_f32_16x16x32_bf16 v[28:31], v[172:175], v[96:99], v[28:31]
    v_mfma_f32_16x16x32_bf16 v[56:59], v[172:175], v[100:103], v[56:59]
    ds_read_b128 v[200:203], v14 offset:4096
    buffer_load_dwordx4 a[168:171], v2, s[12:15], s40 offen offset:2048
    s_waitcnt lgkmcnt(6)
    v_mfma_f32_16x16x32_bf16 v[32:35], v[176:179], v[96:99], v[32:35]
    v_mfma_f32_16x16x32_bf16 v[60:63], v[176:179], v[100:103], v[60:63]
    ds_read_b128 v[204:207], v14 offset:5120
    s_waitcnt lgkmcnt(6)
    v_mfma_f32_16x16x32_bf16 v[36:39], v[180:183], v[96:99], v[36:39]
    v_mfma_f32_16x16x32_bf16 v[64:67], v[180:183], v[100:103], v[64:67]
    ds_read_b128 v[208:211], v14 offset:6144
    buffer_load_dwordx4 a[172:175], v2, s[12:15], s40 offen offset:3072
    s_add_u32 s40, s40, 4096
    s_waitcnt lgkmcnt(6)
    v_mfma_f32_16x16x32_bf16 v[40:43], v[184:187], v[96:99], v[40:43]
    v_mfma_f32_16x16x32_bf16 v[68:71], v[184:187], v[100:103], v[68:71]
    ds_read_b128 v[212:215], v14 offset:7168
    buffer_load_dwordx4 a[176:179], v2, s[12:15], s40 offen offset:0
    s_add_u32 s48, s54, 20480
    buffer_load_dwordx4 v[238:241], v254, s[12:15], s48 offen sc1
    buffer_load_dwordx4 v[242:245], v254, s[12:15], s48 offen offset:1024 sc1
    buffer_load_dwordx2 v[246:247], v8, s[12:15], s48 offen offset:2048 sc1
    s_waitcnt vmcnt(35)
    s_waitcnt lgkmcnt(6)
    v_mfma_f32_16x16x32_bf16 v[16:19], v[188:191], v[104:107], v[16:19]
    v_mfma_f32_16x16x32_bf16 v[44:47], v[188:191], v[108:111], v[44:47]
    ds_read_b128 v[160:163], v14 offset:8192
    s_waitcnt lgkmcnt(6)
    v_mfma_f32_16x16x32_bf16 v[20:23], v[192:195], v[104:107], v[20:23]
    v_mfma_f32_16x16x32_bf16 v[48:51], v[192:195], v[108:111], v[48:51]
    ds_read_b128 v[164:167], v14 offset:9216
    s_waitcnt lgkmcnt(6)
    v_mfma_f32_16x16x32_bf16 v[24:27], v[196:199], v[104:107], v[24:27]
    v_mfma_f32_16x16x32_bf16 v[52:55], v[196:199], v[108:111], v[52:55]
    ds_read_b128 v[168:171], v14 offset:10240
    buffer_load_dwordx4 a[180:183], v2, s[12:15], s40 offen offset:1024
    s_waitcnt lgkmcnt(6)
    v_mfma_f32_16x16x32_bf16 v[28:31], v[200:203], v[104:107], v[28:31]
    v_mfma_f32_16x16x32_bf16 v[56:59], v[200:203], v[108:111], v[56:59]
    ds_read_b128 v[172:175], v14 offset:11264
    buffer_load_dwordx4 a[184:187], v2, s[12:15], s40 offen offset:2048
    s_waitcnt lgkmcnt(6)
    v_mfma_f32_16x16x32_bf16 v[32:35], v[204:207], v[104:107], v[32:35]
    v_mfma_f32_16x16x32_bf16 v[60:63], v[204:207], v[108:111], v[60:63]
    ds_read_b128 v[176:179], v14 offset:12288
    s_waitcnt lgkmcnt(6)
    v_mfma_f32_16x16x32_bf16 v[36:39], v[208:211], v[104:107], v[36:39]
    v_mfma_f32_16x16x32_bf16 v[64:67], v[208:211], v[108:111], v[64:67]
    ds_read_b128 v[180:183], v14 offset:13312
    buffer_load_dwordx4 a[188:191], v2, s[12:15], s40 offen offset:3072
    s_add_u32 s40, s40, 4096
    s_waitcnt lgkmcnt(6)
    v_mfma_f32_16x16x32_bf16 v[40:43], v[212:215], v[104:107], v[40:43]
    v_mfma_f32_16x16x32_bf16 v[68:71], v[212:215], v[108:111], v[68:71]
    ds_read_b128 v[184:187], v14 offset:14336
    buffer_load_dwordx4 a[192:195], v2, s[12:15], s40 offen offset:0
    s_waitcnt vmcnt(34)
    s_waitcnt lgkmcnt(6)
    v_mfma_f32_16x16x32_bf16 v[16:19], v[160:163], v[112:115], v[16:19]
    v_mfma_f32_16x16x32_bf16 v[44:47], v[160:163], v[116:119], v[44:47]
    ds_read_b128 v[188:191], v14 offset:15360
    s_waitcnt lgkmcnt(6)
    v_mfma_f32_16x16x32_bf16 v[20:23], v[164:167], v[112:115], v[20:23]
    v_mfma_f32_16x16x32_bf16 v[48:51], v[164:167], v[116:119], v[48:51]
    ds_read_b128 v[192:195], v14 offset:16384
    s_waitcnt lgkmcnt(6)
    v_mfma_f32_16x16x32_bf16 v[24:27], v[168:171], v[112:115], v[24:27]
    v_mfma_f32_16x16x32_bf16 v[52:55], v[168:171], v[116:119], v[52:55]
    ds_read_b128 v[196:199], v14 offset:17408
    buffer_load_dwordx4 a[196:199], v2, s[12:15], s40 offen offset:1024
    s_waitcnt lgkmcnt(6)
    v_mfma_f32_16x16x32_bf16 v[28:31], v[172:175], v[112:115], v[28:31]
    v_mfma_f32_16x16x32_bf16 v[56:59], v[172:175], v[116:119], v[56:59]
    ds_read_b128 v[200:203], v14 offset:18432
    buffer_load_dwordx4 a[200:203], v2, s[12:15], s40 offen offset:2048
    s_waitcnt lgkmcnt(6)
    v_mfma_f32_16x16x32_bf16 v[32:35], v[176:179], v[112:115], v[32:35]
    v_mfma_f32_16x16x32_bf16 v[60:63], v[176:179], v[116:119], v[60:63]
    ds_read_b128 v[204:207], v14 offset:19456
    s_waitcnt lgkmcnt(6)
    v_mfma_f32_16x16x32_bf16 v[36:39], v[180:183], v[112:115], v[36:39]
    v_mfma_f32_16x16x32_bf16 v[64:67], v[180:183], v[116:119], v[64:67]
    ds_read_b128 v[208:211], v14 offset:20480
    buffer_load_dwordx4 a[204:207], v2, s[12:15], s40 offen offset:3072
    s_add_u32 s40, s40, 4096
    s_waitcnt lgkmcnt(6)
    v_mfma_f32_16x16x32_bf16 v[40:43], v[184:187], v[112:115], v[40:43]
    v_mfma_f32_16x16x32_bf16 v[68:71], v[184:187], v[116:119], v[68:71]
    ds_read_b128 v[212:215], v14 offset:21504
    buffer_load_dwordx4 a[208:211], v2, s[12:15], s40 offen offset:0
    s_waitcnt vmcnt(33)
    s_waitcnt lgkmcnt(6)
    v_mfma_f32_16x16x32_bf16 v[16:19], v[188:191], v[120:123], v[16:19]
    v_mfma_f32_16x16x32_bf16 v[44:47], v[188:191], v[124:127], v[44:47]
    ds_read_b128 v[160:163], v14 offset:22528
    s_waitcnt lgkmcnt(6)
    v_mfma_f32_16x16x32_bf16 v[20:23], v[192:195], v[120:123], v[20:23]
    v_mfma_f32_16x16x32_bf16 v[48:51], v[192:195], v[124:127], v[48:51]
    ds_read_b128 v[164:167], v14 offset:23552
    s_waitcnt lgkmcnt(6)
    v_mfma_f32_16x16x32_bf16 v[24:27], v[196:199], v[120:123], v[24:27]
    v_mfma_f32_16x16x32_bf16 v[52:55], v[196:199], v[124:127], v[52:55]
    ds_read_b128 v[168:171], v14 offset:24576
    buffer_load_dwordx4 a[212:215], v2, s[12:15], s40 offen offset:1024
    s_waitcnt lgkmcnt(6)
    v_mfma_f32_16x16x32_bf16 v[28:31], v[200:203], v[120:123], v[28:31]
    v_mfma_f32_16x16x32_bf16 v[56:59], v[200:203], v[124:127], v[56:59]
    ds_read_b128 v[172:175], v14 offset:25600
    buffer_load_dwordx4 a[216:219], v2, s[12:15], s40 offen offset:2048
    s_waitcnt lgkmcnt(6)
    v_mfma_f32_16x16x32_bf16 v[32:35], v[204:207], v[120:123], v[32:35]
    v_mfma_f32_16x16x32_bf16 v[60:63], v[204:207], v[124:127], v[60:63]
    ds_read_b128 v[176:179], v14 offset:26624
    s_waitcnt lgkmcnt(6)
    v_mfma_f32_16x16x32_bf16 v[36:39], v[208:211], v[120:123], v[36:39]
    v_mfma_f32_16x16x32_bf16 v[64:67], v[208:211], v[124:127], v[64:67]
    ds_read_b128 v[180:183], v14 offset:27648
    buffer_load_dwordx4 a[220:223], v2, s[12:15], s40 offen offset:3072
    s_add_u32 s40, s40, 4096
    s_waitcnt lgkmcnt(6)
    v_mfma_f32_16x16x32_bf16 v[40:43], v[212:215], v[120:123], v[40:43]
    v_mfma_f32_16x16x32_bf16 v[68:71], v[212:215], v[124:127], v[68:71]
    ds_read_b128 v[184:187], v14 offset:28672
    buffer_load_dwordx4 a[224:227], v2, s[12:15], s40 offen offset:0
    s_waitcnt vmcnt(32)
    s_waitcnt lgkmcnt(6)
    v_mfma_f32_16x16x32_bf16 v[16:19], v[160:163], v[128:131], v[16:19]
    v_mfma_f32_16x16x32_bf16 v[44:47], v[160:163], v[132:135], v[44:47]
    ds_read_b128 v[188:191], v14 offset:29696
    s_waitcnt lgkmcnt(6)
    v_mfma_f32_16x16x32_bf16 v[20:23], v[164:167], v[128:131], v[20:23]
    v_mfma_f32_16x16x32_bf16 v[48:51], v[164:167], v[132:135], v[48:51]
    ds_read_b128 v[192:195], v14 offset:30720
    s_waitcnt lgkmcnt(6)
    v_mfma_f32_16x16x32_bf16 v[24:27], v[168:171], v[128:131], v[24:27]
    v_mfma_f32_16x16x32_bf16 v[52:55], v[168:171], v[132:135], v[52:55]
    ds_read_b128 v[196:199], v14 offset:31744
    buffer_load_dwordx4 a[228:231], v2, s[12:15], s40 offen offset:1024
    s_waitcnt lgkmcnt(6)
    v_mfma_f32_16x16x32_bf16 v[28:31], v[172:175], v[128:131], v[28:31]
    v_mfma_f32_16x16x32_bf16 v[56:59], v[172:175], v[132:135], v[56:59]
    ds_read_b128 v[200:203], v14 offset:32768
    buffer_load_dwordx4 a[232:235], v2, s[12:15], s40 offen offset:2048
    s_waitcnt lgkmcnt(6)
    v_mfma_f32_16x16x32_bf16 v[32:35], v[176:179], v[128:131], v[32:35]
    v_mfma_f32_16x16x32_bf16 v[60:63], v[176:179], v[132:135], v[60:63]
    ds_read_b128 v[204:207], v14 offset:33792
    s_waitcnt lgkmcnt(6)
    v_mfma_f32_16x16x32_bf16 v[36:39], v[180:183], v[128:131], v[36:39]
    v_mfma_f32_16x16x32_bf16 v[64:67], v[180:183], v[132:135], v[64:67]
    ds_read_b128 v[208:211], v14 offset:34816
    buffer_load_dwordx4 a[236:239], v2, s[12:15], s40 offen offset:3072
    s_add_u32 s40, s40, 4096
    s_cmp_eq_u32 s30, 3
    s_cselect_b32 s41, 61440, 0
    s_sub_u32 s40, s40, s41
    s_waitcnt lgkmcnt(6)
    v_mfma_f32_16x16x32_bf16 v[40:43], v[184:187], v[128:131], v[40:43]
    v_mfma_f32_16x16x32_bf16 v[68:71], v[184:187], v[132:135], v[68:71]
    ds_read_b128 v[212:215], v14 offset:35840
    buffer_load_dwordx4 a[240:243], v2, s[12:15], s40 offen offset:0
    s_waitcnt vmcnt(30)
    s_waitcnt lgkmcnt(6)
    v_mfma_f32_16x16x32_bf16 v[16:19], v[188:191], v[136:139], v[16:19]
    v_mfma_f32_16x16x32_bf16 v[44:47], v[188:191], v[140:143], v[44:47]
    s_waitcnt lgkmcnt(5)
    v_mfma_f32_16x16x32_bf16 v[20:23], v[192:195], v[136:139], v[20:23]
    v_mfma_f32_16x16x32_bf16 v[48:51], v[192:195], v[140:143], v[48:51]
    s_waitcnt lgkmcnt(4)
    v_mfma_f32_16x16x32_bf16 v[24:27], v[196:199], v[136:139], v[24:27]
    v_mfma_f32_16x16x32_bf16 v[52:55], v[196:199], v[140:143], v[52:55]
    buffer_load_dwordx4 a[244:247], v2, s[12:15], s40 offen offset:1024
    s_waitcnt lgkmcnt(3)
    v_mfma_f32_16x16x32_bf16 v[28:31], v[200:203], v[136:139], v[28:31]
    v_mfma_f32_16x16x32_bf16 v[56:59], v[200:203], v[140:143], v[56:59]
    buffer_load_dwordx4 a[248:251], v2, s[12:15], s40 offen offset:2048
    s_waitcnt lgkmcnt(2)
    v_mfma_f32_16x16x32_bf16 v[32:35], v[204:207], v[136:139], v[32:35]
    v_mfma_f32_16x16x32_bf16 v[60:63], v[204:207], v[140:143], v[60:63]
    s_waitcnt lgkmcnt(1)
    v_mfma_f32_16x16x32_bf16 v[36:39], v[208:211], v[136:139], v[36:39]
    v_mfma_f32_16x16x32_bf16 v[64:67], v[208:211], v[140:143], v[64:67]
    buffer_load_dwordx4 a[252:255], v2, s[12:15], s40 offen offset:3072
    s_add_u32 s40, s40, 4096
    s_waitcnt lgkmcnt(0)
    v_mfma_f32_16x16x32_bf16 v[40:43], v[212:215], v[136:139], v[40:43]
    v_mfma_f32_16x16x32_bf16 v[68:71], v[212:215], v[140:143], v[68:71]
    v_lshlrev_b32 v9, 4, v3
    v_add_u32 v9, 156672, v9
    v_mov_b32 v12, 0xbdd2d3e8
    v_mov_b32 v13, 0xc0135761
    ds_read_b128 v[72:75], v9 offset:0
    ds_read_b128 v[100:103], v9 offset:512
    ds_read_b128 v[76:79], v9 offset:64
    ds_read_b128 v[104:107], v9 offset:576
    ds_read_b128 v[80:83], v9 offset:128
    ds_read_b128 v[108:111], v9 offset:640
    ds_read_b128 v[84:87], v9 offset:192
    ds_read_b128 v[112:115], v9 offset:704
    ds_read_b128 v[88:91], v9 offset:256
    ds_read_b128 v[116:119], v9 offset:768
    ds_read_b128 v[92:95], v9 offset:320
    ds_read_b128 v[120:123], v9 offset:832
    ds_read_b128 v[96:99], v9 offset:384
    ds_read_b128 v[124:127], v9 offset:896
    s_waitcnt lgkmcnt(0)
    v_pk_add_f32 v[72:73], v[72:73], v[100:101]
    v_pk_add_f32 v[74:75], v[74:75], v[102:103]
    v_pk_add_f32 v[76:77], v[76:77], v[104:105]
    v_pk_add_f32 v[78:79], v[78:79], v[106:107]
    v_pk_add_f32 v[80:81], v[80:81], v[108:109]
    v_pk_add_f32 v[82:83], v[82:83], v[110:111]
    v_pk_add_f32 v[84:85], v[84:85], v[112:113]
    v_pk_add_f32 v[86:87], v[86:87], v[114:115]
    v_pk_add_f32 v[88:89], v[88:89], v[116:117]
    v_pk_add_f32 v[90:91], v[90:91], v[118:119]
    v_pk_add_f32 v[92:93], v[92:93], v[120:121]
    v_pk_add_f32 v[94:95], v[94:95], v[122:123]
    v_pk_add_f32 v[96:97], v[96:97], v[124:125]
    v_pk_add_f32 v[98:99], v[98:99], v[126:127]
    s_lshl_b32 s49, s34, 2
    s_add_u32 s49, s49, s30
    s_lshl_b32 s49, s49, 7
    s_add_u32 s49, s49, s37
    s_lshl_b32 s41, s35, 2
    s_add_u32 s49, s49, s41
    v_pk_mul_f32 v[160:161], v[72:73], v[224:225] op_sel_hi:[1,0]
    v_pk_mul_f32 v[162:163], v[74:75], v[224:225] op_sel_hi:[1,0]
    v_pk_mul_f32 v[164:165], v[72:73], v[226:227] op_sel_hi:[1,0]
    v_pk_mul_f32 v[166:167], v[74:75], v[226:227] op_sel_hi:[1,0]
    v_pk_mul_f32 v[168:169], v[76:77], v[224:225] op_sel_hi:[1,0]
    v_pk_mul_f32 v[170:171], v[78:79], v[224:225] op_sel_hi:[1,0]
    v_pk_mul_f32 v[172:173], v[76:77], v[226:227] op_sel_hi:[1,0]
    v_pk_mul_f32 v[174:175], v[78:79], v[226:227] op_sel_hi:[1,0]
    v_pk_fma_f32 v[16:17], v[16:17], v[224:225], v[160:161] op_sel:[0,1,0] op_sel_hi:[1,1,1]
    v_pk_fma_f32 v[18:19], v[18:19], v[224:225], v[162:163] op_sel:[0,1,0] op_sel_hi:[1,1,1]
    v_pk_fma_f32 v[44:45], v[44:45], v[226:227], v[164:165] op_sel:[0,1,0] op_sel_hi:[1,1,1]
    v_pk_fma_f32 v[46:47], v[46:47], v[226:227], v[166:167] op_sel:[0,1,0] op_sel_hi:[1,1,1]
    v_pk_fma_f32 v[20:21], v[20:21], v[224:225], v[168:169] op_sel:[0,1,0] op_sel_hi:[1,1,1]
    v_pk_fma_f32 v[22:23], v[22:23], v[224:225], v[170:171] op_sel:[0,1,0] op_sel_hi:[1,1,1]
    v_pk_fma_f32 v[48:49], v[48:49], v[226:227], v[172:173] op_sel:[0,1,0] op_sel_hi:[1,1,1]
    v_pk_fma_f32 v[50:51], v[50:51], v[226:227], v[174:175] op_sel:[0,1,0] op_sel_hi:[1,1,1]
    v_pk_mul_f32 v[160:161], v[16:17], v[16:17]
    v_pk_mul_f32 v[162:163], v[18:19], v[18:19]
    v_pk_mul_f32 v[164:165], v[44:45], v[44:45]
    v_pk_mul_f32 v[166:167], v[46:47], v[46:47]
    v_pk_mul_f32 v[168:169], v[20:21], v[20:21]
    v_pk_mul_f32 v[170:171], v[22:23], v[22:23]
    v_pk_mul_f32 v[172:173], v[48:49], v[48:49]
    v_pk_mul_f32 v[174:175], v[50:51], v[50:51]
    v_pk_fma_f32 v[160:161], v[160:161], v[12:13], v[12:13] op_sel:[0,0,1] op_sel_hi:[1,0,1]
    v_pk_fma_f32 v[162:163], v[162:163], v[12:13], v[12:13] op_sel:[0,0,1] op_sel_hi:[1,0,1]
    v_pk_fma_f32 v[164:165], v[164:165], v[12:13], v[12:13] op_sel:[0,0,1] op_sel_hi:[1,0,1]
    v_pk_fma_f32 v[166:167], v[166:167], v[12:13], v[12:13] op_sel:[0,0,1] op_sel_hi:[1,0,1]
    v_pk_fma_f32 v[168:169], v[168:169], v[12:13], v[12:13] op_sel:[0,0,1] op_sel_hi:[1,0,1]
    v_pk_fma_f32 v[170:171], v[170:171], v[12:13], v[12:13] op_sel:[0,0,1] op_sel_hi:[1,0,1]
    v_pk_fma_f32 v[172:173], v[172:173], v[12:13], v[12:13] op_sel:[0,0,1] op_sel_hi:[1,0,1]
    v_pk_fma_f32 v[174:175], v[174:175], v[12:13], v[12:13] op_sel:[0,0,1] op_sel_hi:[1,0,1]
    v_pk_mul_f32 v[160:161], v[160:161], v[16:17]
    v_pk_mul_f32 v[162:163], v[162:163], v[18:19]
    v_pk_mul_f32 v[164:165], v[164:165], v[44:45]
    v_pk_mul_f32 v[166:167], v[166:167], v[46:47]
    v_pk_mul_f32 v[168:169], v[168:169], v[20:21]
    v_pk_mul_f32 v[170:171], v[170:171], v[22:23]
    v_pk_mul_f32 v[172:173], v[172:173], v[48:49]
    v_pk_mul_f32 v[174:175], v[174:175], v[50:51]
    v_exp_f32 v160, v160
    v_exp_f32 v161, v161
    v_exp_f32 v162, v162
    v_exp_f32 v163, v163
    v_exp_f32 v164, v164
    v_exp_f32 v165, v165
    v_exp_f32 v166, v166
    v_exp_f32 v167, v167
    v_exp_f32 v168, v168
    v_exp_f32 v169, v169
    v_exp_f32 v170, v170
    v_exp_f32 v171, v171
    v_exp_f32 v172, v172
    v_exp_f32 v173, v173
    v_exp_f32 v174, v174
    v_exp_f32 v175, v175
    v_pk_add_f32 v[160:161], v[160:161], 1.0 op_sel_hi:[1,0]
    v_pk_add_f32 v[162:163], v[162:163], 1.0 op_sel_hi:[1,0]
    v_pk_add_f32 v[164:165], v[164:165], 1.0 op_sel_hi:[1,0]
    v_pk_add_f32 v[166:167], v[166:167], 1.0 op_sel_hi:[1,0]
    v_pk_add_f32 v[168:169], v[168:169], 1.0 op_sel_hi:[1,0]
    v_pk_add_f32 v[170:171], v[170:171], 1.0 op_sel_hi:[1,0]
    v_pk_add_f32 v[172:173], v[172:173], 1.0 op_sel_hi:[1,0]
    v_pk_add_f32 v[174:175], v[174:175], 1.0 op_sel_hi:[1,0]
    v_rcp_f32 v160, v160
    v_rcp_f32 v161, v161
    v_rcp_f32 v162, v162
    v_rcp_f32 v163, v163
    v_rcp_f32 v164, v164
    v_rcp_f32 v165, v165
    v_rcp_f32 v166, v166
    v_rcp_f32 v167, v167
    v_rcp_f32 v168, v168
    v_rcp_f32 v169, v169
    v_rcp_f32 v170, v170
    v_rcp_f32 v171, v171
    v_rcp_f32 v172, v172
    v_rcp_f32 v173, v173
    v_rcp_f32 v174, v174
    v_rcp_f32 v175, v175
    s_nop 0
    v_pk_mul_f32 v[16:17], v[16:17], v[160:161]
    v_pk_mul_f32 v[18:19], v[18:19], v[162:163]
    v_pk_mul_f32 v[44:45], v[44:45], v[164:165]
    v_pk_mul_f32 v[46:47], v[46:47], v[166:167]
    v_pk_mul_f32 v[20:21], v[20:21], v[168:169]
    v_pk_mul_f32 v[22:23], v[22:23], v[170:171]
    v_pk_mul_f32 v[48:49], v[48:49], v[172:173]
    v_pk_mul_f32 v[50:51], v[50:51], v[174:175]
    v_cvt_pk_bf16_f32 v16, v16, v17
    v_cvt_pk_bf16_f32 v17, v18, v19
    v_cvt_pk_bf16_f32 v18, v20, v21
    v_cvt_pk_bf16_f32 v19, v22, v23
    v_cvt_pk_bf16_f32 v44, v44, v45
    v_cvt_pk_bf16_f32 v45, v46, v47
    v_cvt_pk_bf16_f32 v46, v48, v49
    v_cvt_pk_bf16_f32 v47, v50, v51
    s_nop 1
    v_permlane16_swap_b32 v16, v18
    v_permlane16_swap_b32 v17, v19
    v_permlane16_swap_b32 v44, v46
    v_permlane16_swap_b32 v45, v47
    buffer_store_dwordx4 v[16:19], v254, s[12:15], s52 offen offset:0 sc1
    buffer_store_dwordx4 v[44:47], v254, s[12:15], s53 offen offset:0 sc1
k2_kernel_gs30:
    v_pk_mul_f32 v[160:161], v[80:81], v[224:225] op_sel_hi:[1,0]
    v_pk_mul_f32 v[162:163], v[82:83], v[224:225] op_sel_hi:[1,0]
    v_pk_mul_f32 v[164:165], v[80:81], v[226:227] op_sel_hi:[1,0]
    v_pk_mul_f32 v[166:167], v[82:83], v[226:227] op_sel_hi:[1,0]
    v_pk_mul_f32 v[168:169], v[84:85], v[224:225] op_sel_hi:[1,0]
    v_pk_mul_f32 v[170:171], v[86:87], v[224:225] op_sel_hi:[1,0]
    v_pk_mul_f32 v[172:173], v[84:85], v[226:227] op_sel_hi:[1,0]
    v_pk_mul_f32 v[174:175], v[86:87], v[226:227] op_sel_hi:[1,0]
    v_pk_fma_f32 v[24:25], v[24:25], v[224:225], v[160:161] op_sel:[0,1,0] op_sel_hi:[1,1,1]
    v_pk_fma_f32 v[26:27], v[26:27], v[224:225], v[162:163] op_sel:[0,1,0] op_sel_hi:[1,1,1]
    v_pk_fma_f32 v[52:53], v[52:53], v[226:227], v[164:165] op_sel:[0,1,0] op_sel_hi:[1,1,1]
    v_pk_fma_f32 v[54:55], v[54:55], v[226:227], v[166:167] op_sel:[0,1,0] op_sel_hi:[1,1,1]
    v_pk_fma_f32 v[28:29], v[28:29], v[224:225], v[168:169] op_sel:[0,1,0] op_sel_hi:[1,1,1]
    v_pk_fma_f32 v[30:31], v[30:31], v[224:225], v[170:171] op_sel:[0,1,0] op_sel_hi:[1,1,1]
    v_pk_fma_f32 v[56:57], v[56:57], v[226:227], v[172:173] op_sel:[0,1,0] op_sel_hi:[1,1,1]
    v_pk_fma_f32 v[58:59], v[58:59], v[226:227], v[174:175] op_sel:[0,1,0] op_sel_hi:[1,1,1]
    v_pk_mul_f32 v[160:161], v[24:25], v[24:25]
    v_pk_mul_f32 v[162:163], v[26:27], v[26:27]
    v_pk_mul_f32 v[164:165], v[52:53], v[52:53]
    v_pk_mul_f32 v[166:167], v[54:55], v[54:55]
    v_pk_mul_f32 v[168:169], v[28:29], v[28:29]
    v_pk_mul_f32 v[170:171], v[30:31], v[30:31]
    v_pk_mul_f32 v[172:173], v[56:57], v[56:57]
    v_pk_mul_f32 v[174:175], v[58:59], v[58:59]
    v_pk_fma_f32 v[160:161], v[160:161], v[12:13], v[12:13] op_sel:[0,0,1] op_sel_hi:[1,0,1]
    v_pk_fma_f32 v[162:163], v[162:163], v[12:13], v[12:13] op_sel:[0,0,1] op_sel_hi:[1,0,1]
    v_pk_fma_f32 v[164:165], v[164:165], v[12:13], v[12:13] op_sel:[0,0,1] op_sel_hi:[1,0,1]
    v_pk_fma_f32 v[166:167], v[166:167], v[12:13], v[12:13] op_sel:[0,0,1] op_sel_hi:[1,0,1]
    v_pk_fma_f32 v[168:169], v[168:169], v[12:13], v[12:13] op_sel:[0,0,1] op_sel_hi:[1,0,1]
    v_pk_fma_f32 v[170:171], v[170:171], v[12:13], v[12:13] op_sel:[0,0,1] op_sel_hi:[1,0,1]
    v_pk_fma_f32 v[172:173], v[172:173], v[12:13], v[12:13] op_sel:[0,0,1] op_sel_hi:[1,0,1]
    v_pk_fma_f32 v[174:175], v[174:175], v[12:13], v[12:13] op_sel:[0,0,1] op_sel_hi:[1,0,1]
    v_pk_mul_f32 v[160:161], v[160:161], v[24:25]
    v_pk_mul_f32 v[162:163], v[162:163], v[26:27]
    v_pk_mul_f32 v[164:165], v[164:165], v[52:53]
    v_pk_mul_f32 v[166:167], v[166:167], v[54:55]
    v_pk_mul_f32 v[168:169], v[168:169], v[28:29]
    v_pk_mul_f32 v[170:171], v[170:171], v[30:31]
    v_pk_mul_f32 v[172:173], v[172:173], v[56:57]
    v_pk_mul_f32 v[174:175], v[174:175], v[58:59]
    v_exp_f32 v160, v160
    v_exp_f32 v161, v161
    v_exp_f32 v162, v162
    v_exp_f32 v163, v163
    v_exp_f32 v164, v164
    v_exp_f32 v165, v165
    v_exp_f32 v166, v166
    v_exp_f32 v167, v167
    v_exp_f32 v168, v168
    v_exp_f32 v169, v169
    v_exp_f32 v170, v170
    v_exp_f32 v171, v171
    v_exp_f32 v172, v172
    v_exp_f32 v173, v173
    v_exp_f32 v174, v174
    v_exp_f32 v175, v175
    v_pk_add_f32 v[160:161], v[160:161], 1.0 op_sel_hi:[1,0]
    v_pk_add_f32 v[162:163], v[162:163], 1.0 op_sel_hi:[1,0]
    v_pk_add_f32 v[164:165], v[164:165], 1.0 op_sel_hi:[1,0]
    v_pk_add_f32 v[166:167], v[166:167], 1.0 op_sel_hi:[1,0]
    v_pk_add_f32 v[168:169], v[168:169], 1.0 op_sel_hi:[1,0]
    v_pk_add_f32 v[170:171], v[170:171], 1.0 op_sel_hi:[1,0]
    v_pk_add_f32 v[172:173], v[172:173], 1.0 op_sel_hi:[1,0]
    v_pk_add_f32 v[174:175], v[174:175], 1.0 op_sel_hi:[1,0]
    v_rcp_f32 v160, v160
    v_rcp_f32 v161, v161
    v_rcp_f32 v162, v162
    v_rcp_f32 v163, v163
    v_rcp_f32 v164, v164
    v_rcp_f32 v165, v165
    v_rcp_f32 v166, v166
    v_rcp_f32 v167, v167
    v_rcp_f32 v168, v168
    v_rcp_f32 v169, v169
    v_rcp_f32 v170, v170
    v_rcp_f32 v171, v171
    v_rcp_f32 v172, v172
    v_rcp_f32 v173, v173
    v_rcp_f32 v174, v174
    v_rcp_f32 v175, v175
    s_nop 0
    v_pk_mul_f32 v[24:25], v[24:25], v[160:161]
    v_pk_mul_f32 v[26:27], v[26:27], v[162:163]
    v_pk_mul_f32 v[52:53], v[52:53], v[164:165]
    v_pk_mul_f32 v[54:55], v[54:55], v[166:167]
    v_pk_mul_f32 v[28:29], v[28:29], v[168:169]
    v_pk_mul_f32 v[30:31], v[30:31], v[170:171]
    v_pk_mul_f32 v[56:57], v[56:57], v[172:173]
    v_pk_mul_f32 v[58:59], v[58:59], v[174:175]
    v_cvt_pk_bf16_f32 v24, v24, v25
    v_cvt_pk_bf16_f32 v25, v26, v27
    v_cvt_pk_bf16_f32 v26, v28, v29
    v_cvt_pk_bf16_f32 v27, v30, v31
    v_cvt_pk_bf16_f32 v52, v52, v53
    v_cvt_pk_bf16_f32 v53, v54, v55
    v_cvt_pk_bf16_f32 v54, v56, v57
    v_cvt_pk_bf16_f32 v55, v58, v59
    s_nop 1
    v_permlane16_swap_b32 v24, v26
    v_permlane16_swap_b32 v25, v27
    v_permlane16_swap_b32 v52, v54
    v_permlane16_swap_b32 v53, v55
    s_cmp_eq_u32 s35, 15
    s_cselect_b32 s46, 0xffff, -1
    s_mov_b32 exec_lo, s46
    s_mov_b32 exec_hi, s46
    buffer_store_dwordx4 v[24:27], v254, s[12:15], s52 offen offset:1024 sc1
    buffer_store_dwordx4 v[52:55], v254, s[12:15], s53 offen offset:1024 sc1
    s_mov_b64 exec, -1
k2_kernel_gs31:
    v_pk_mul_f32 v[160:161], v[88:89], v[224:225] op_sel_hi:[1,0]
    v_pk_mul_f32 v[162:163], v[90:91], v[224:225] op_sel_hi:[1,0]
    v_pk_mul_f32 v[164:165], v[88:89], v[226:227] op_sel_hi:[1,0]
    v_pk_mul_f32 v[166:167], v[90:91], v[226:227] op_sel_hi:[1,0]
    v_pk_mul_f32 v[168:169], v[92:93], v[224:225] op_sel_hi:[1,0]
    v_pk_mul_f32 v[170:171], v[94:95], v[224:225] op_sel_hi:[1,0]
    v_pk_mul_f32 v[172:173], v[92:93], v[226:227] op_sel_hi:[1,0]
    v_pk_mul_f32 v[174:175], v[94:95], v[226:227] op_sel_hi:[1,0]
    v_pk_fma_f32 v[32:33], v[32:33], v[224:225], v[160:161] op_sel:[0,1,0] op_sel_hi:[1,1,1]
    v_pk_fma_f32 v[34:35], v[34:35], v[224:225], v[162:163] op_sel:[0,1,0] op_sel_hi:[1,1,1]
    v_pk_fma_f32 v[60:61], v[60:61], v[226:227], v[164:165] op_sel:[0,1,0] op_sel_hi:[1,1,1]
    v_pk_fma_f32 v[62:63], v[62:63], v[226:227], v[166:167] op_sel:[0,1,0] op_sel_hi:[1,1,1]
    v_pk_fma_f32 v[36:37], v[36:37], v[224:225], v[168:169] op_sel:[0,1,0] op_sel_hi:[1,1,1]
    v_pk_fma_f32 v[38:39], v[38:39], v[224:225], v[170:171] op_sel:[0,1,0] op_sel_hi:[1,1,1]
    v_pk_fma_f32 v[64:65], v[64:65], v[226:227], v[172:173] op_sel:[0,1,0] op_sel_hi:[1,1,1]
    v_pk_fma_f32 v[66:67], v[66:67], v[226:227], v[174:175] op_sel:[0,1,0] op_sel_hi:[1,1,1]
    v_pk_mul_f32 v[160:161], v[32:33], v[32:33]
    v_pk_mul_f32 v[162:163], v[34:35], v[34:35]
    v_pk_mul_f32 v[164:165], v[60:61], v[60:61]
    v_pk_mul_f32 v[166:167], v[62:63], v[62:63]
    v_pk_mul_f32 v[168:169], v[36:37], v[36:37]
    v_pk_mul_f32 v[170:171], v[38:39], v[38:39]
    v_pk_mul_f32 v[172:173], v[64:65], v[64:65]
    v_pk_mul_f32 v[174:175], v[66:67], v[66:67]
    v_pk_fma_f32 v[160:161], v[160:161], v[12:13], v[12:13] op_sel:[0,0,1] op_sel_hi:[1,0,1]
    v_pk_fma_f32 v[162:163], v[162:163], v[12:13], v[12:13] op_sel:[0,0,1] op_sel_hi:[1,0,1]
    v_pk_fma_f32 v[164:165], v[164:165], v[12:13], v[12:13] op_sel:[0,0,1] op_sel_hi:[1,0,1]
    v_pk_fma_f32 v[166:167], v[166:167], v[12:13], v[12:13] op_sel:[0,0,1] op_sel_hi:[1,0,1]
    v_pk_fma_f32 v[168:169], v[168:169], v[12:13], v[12:13] op_sel:[0,0,1] op_sel_hi:[1,0,1]
    v_pk_fma_f32 v[170:171], v[170:171], v[12:13], v[12:13] op_sel:[0,0,1] op_sel_hi:[1,0,1]
    v_pk_fma_f32 v[172:173], v[172:173], v[12:13], v[12:13] op_sel:[0,0,1] op_sel_hi:[1,0,1]
    v_pk_fma_f32 v[174:175], v[174:175], v[12:13], v[12:13] op_sel:[0,0,1] op_sel_hi:[1,0,1]
    v_pk_mul_f32 v[160:161], v[160:161], v[32:33]
    v_pk_mul_f32 v[162:163], v[162:163], v[34:35]
    v_pk_mul_f32 v[164:165], v[164:165], v[60:61]
    v_pk_mul_f32 v[166:167], v[166:167], v[62:63]
    v_pk_mul_f32 v[168:169], v[168:169], v[36:37]
    v_pk_mul_f32 v[170:171], v[170:171], v[38:39]
    v_pk_mul_f32 v[172:173], v[172:173], v[64:65]
    v_pk_mul_f32 v[174:175], v[174:175], v[66:67]
    v_exp_f32 v160, v160
    v_exp_f32 v161, v161
    v_exp_f32 v162, v162
    v_exp_f32 v163, v163
    v_exp_f32 v164, v164
    v_exp_f32 v165, v165
    v_exp_f32 v166, v166
    v_exp_f32 v167, v167
    v_exp_f32 v168, v168
    v_exp_f32 v169, v169
    v_exp_f32 v170, v170
    v_exp_f32 v171, v171
    v_exp_f32 v172, v172
    v_exp_f32 v173, v173
    v_exp_f32 v174, v174
    v_exp_f32 v175, v175
    v_pk_add_f32 v[160:161], v[160:161], 1.0 op_sel_hi:[1,0]
    v_pk_add_f32 v[162:163], v[162:163], 1.0 op_sel_hi:[1,0]
    v_pk_add_f32 v[164:165], v[164:165], 1.0 op_sel_hi:[1,0]
    v_pk_add_f32 v[166:167], v[166:167], 1.0 op_sel_hi:[1,0]
    v_pk_add_f32 v[168:169], v[168:169], 1.0 op_sel_hi:[1,0]
    v_pk_add_f32 v[170:171], v[170:171], 1.0 op_sel_hi:[1,0]
    v_pk_add_f32 v[172:173], v[172:173], 1.0 op_sel_hi:[1,0]
    v_pk_add_f32 v[174:175], v[174:175], 1.0 op_sel_hi:[1,0]
    v_rcp_f32 v160, v160
    v_rcp_f32 v161, v161
    v_rcp_f32 v162, v162
    v_rcp_f32 v163, v163
    v_rcp_f32 v164, v164
    v_rcp_f32 v165, v165
    v_rcp_f32 v166, v166
    v_rcp_f32 v167, v167
    v_rcp_f32 v168, v168
    v_rcp_f32 v169, v169
    v_rcp_f32 v170, v170
    v_rcp_f32 v171, v171
    v_rcp_f32 v172, v172
    v_rcp_f32 v173, v173
    v_rcp_f32 v174, v174
    v_rcp_f32 v175, v175
    s_nop 0
    v_pk_mul_f32 v[32:33], v[32:33], v[160:161]
    v_pk_mul_f32 v[34:35], v[34:35], v[162:163]
    v_pk_mul_f32 v[60:61], v[60:61], v[164:165]
    v_pk_mul_f32 v[62:63], v[62:63], v[166:167]
    v_pk_mul_f32 v[36:37], v[36:37], v[168:169]
    v_pk_mul_f32 v[38:39], v[38:39], v[170:171]
    v_pk_mul_f32 v[64:65], v[64:65], v[172:173]
    v_pk_mul_f32 v[66:67], v[66:67], v[174:175]
    v_cvt_pk_bf16_f32 v32, v32, v33
    v_cvt_pk_bf16_f32 v33, v34, v35
    v_cvt_pk_bf16_f32 v34, v36, v37
    v_cvt_pk_bf16_f32 v35, v38, v39
    v_cvt_pk_bf16_f32 v60, v60, v61
    v_cvt_pk_bf16_f32 v61, v62, v63
    v_cvt_pk_bf16_f32 v62, v64, v65
    v_cvt_pk_bf16_f32 v63, v66, v67
    s_nop 1
    v_permlane16_swap_b32 v32, v34
    v_permlane16_swap_b32 v33, v35
    v_permlane16_swap_b32 v60, v62
    v_permlane16_swap_b32 v61, v63
    s_cmp_eq_u32 s35, 15
    s_cbranch_scc1 k2_kernel_gs32
    buffer_store_dwordx4 v[32:35], v254, s[12:15], s52 offen offset:2048 sc1
    buffer_store_dwordx4 v[60:63], v254, s[12:15], s53 offen offset:2048 sc1
k2_kernel_gs32:
    v_pk_mul_f32 v[160:161], v[96:97], v[224:225] op_sel_hi:[1,0]
    v_pk_mul_f32 v[162:163], v[98:99], v[224:225] op_sel_hi:[1,0]
    v_pk_mul_f32 v[164:165], v[96:97], v[226:227] op_sel_hi:[1,0]
    v_pk_mul_f32 v[166:167], v[98:99], v[226:227] op_sel_hi:[1,0]
    v_pk_fma_f32 v[40:41], v[40:41], v[224:225], v[160:161] op_sel:[0,1,0] op_sel_hi:[1,1,1]
    v_pk_fma_f32 v[42:43], v[42:43], v[224:225], v[162:163] op_sel:[0,1,0] op_sel_hi:[1,1,1]
    v_pk_fma_f32 v[68:69], v[68:69], v[226:227], v[164:165] op_sel:[0,1,0] op_sel_hi:[1,1,1]
    v_pk_fma_f32 v[70:71], v[70:71], v[226:227], v[166:167] op_sel:[0,1,0] op_sel_hi:[1,1,1]
    v_pk_mul_f32 v[160:161], v[40:41], v[40:41]
    v_pk_mul_f32 v[162:163], v[42:43], v[42:43]
    v_pk_mul_f32 v[164:165], v[68:69], v[68:69]
    v_pk_mul_f32 v[166:167], v[70:71], v[70:71]
    v_pk_fma_f32 v[160:161], v[160:161], v[12:13], v[12:13] op_sel:[0,0,1] op_sel_hi:[1,0,1]
    v_pk_fma_f32 v[162:163], v[162:163], v[12:13], v[12:13] op_sel:[0,0,1] op_sel_hi:[1,0,1]
    v_pk_fma_f32 v[164:165], v[164:165], v[12:13], v[12:13] op_sel:[0,0,1] op_sel_hi:[1,0,1]
    v_pk_fma_f32 v[166:167], v[166:167], v[12:13], v[12:13] op_sel:[0,0,1] op_sel_hi:[1,0,1]
    v_pk_mul_f32 v[160:161], v[160:161], v[40:41]
    v_pk_mul_f32 v[162:163], v[162:163], v[42:43]
    v_pk_mul_f32 v[164:165], v[164:165], v[68:69]
    v_pk_mul_f32 v[166:167], v[166:167], v[70:71]
    v_exp_f32 v160, v160
    v_exp_f32 v161, v161
    v_exp_f32 v162, v162
    v_exp_f32 v163, v163
    v_exp_f32 v164, v164
    v_exp_f32 v165, v165
    v_exp_f32 v166, v166
    v_exp_f32 v167, v167
    v_pk_add_f32 v[160:161], v[160:161], 1.0 op_sel_hi:[1,0]
    v_pk_add_f32 v[162:163], v[162:163], 1.0 op_sel_hi:[1,0]
    v_pk_add_f32 v[164:165], v[164:165], 1.0 op_sel_hi:[1,0]
    v_pk_add_f32 v[166:167], v[166:167], 1.0 op_sel_hi:[1,0]
    v_rcp_f32 v160, v160
    v_rcp_f32 v161, v161
    v_rcp_f32 v162, v162
    v_rcp_f32 v163, v163
    v_rcp_f32 v164, v164
    v_rcp_f32 v165, v165
    v_rcp_f32 v166, v166
    v_rcp_f32 v167, v167
    s_nop 0
    v_pk_mul_f32 v[40:41], v[40:41], v[160:161]
    v_pk_mul_f32 v[42:43], v[42:43], v[162:163]
    v_pk_mul_f32 v[68:69], v[68:69], v[164:165]
    v_pk_mul_f32 v[70:71], v[70:71], v[166:167]
    v_cvt_pk_bf16_f32 v40, v40, v41
    v_cvt_pk_bf16_f32 v41, v42, v43
    v_cvt_pk_bf16_f32 v68, v68, v69
    v_cvt_pk_bf16_f32 v69, v70, v71
    s_cmp_eq_u32 s35, 15
    s_cbranch_scc1 k2_kernel_gs33
    buffer_store_dwordx2 v[40:41], v8, s[12:15], s52 offen offset:3072 sc1
    buffer_store_dwordx2 v[68:69], v8, s[12:15], s53 offen offset:3072 sc1
k2_kernel_gs33:
    s_waitcnt vmcnt(0)
    v_mov_b32 v9, 1
    v_mov_b32 v10, 6400
    s_mov_b64 exec, 1
    s_cmp_eq_u32 s31, 0
    s_cbranch_scc1 k2_kernel_slow34
    buffer_store_dword v9, v10, s[12:15], s49 offen
    s_branch k2_kernel_sent35
k2_kernel_slow34:
    buffer_store_dword v9, v10, s[12:15], s49 offen sc1
k2_kernel_sent35:
    s_mov_b64 exec, -1
    buffer_load_dwordx4 v[192:195], v2, s[12:15], s40 offen offset:0
    buffer_load_dwordx4 v[196:199], v2, s[12:15], s40 offen offset:1024
    buffer_load_dwordx4 v[200:203], v2, s[12:15], s40 offen offset:2048
    buffer_load_dwordx4 v[204:207], v2, s[12:15], s40 offen offset:3072
    s_add_u32 s40, s40, 4096
    buffer_load_dwordx4 v[208:211], v2, s[12:15], s40 offen offset:0
    buffer_load_dwordx4 v[212:215], v2, s[12:15], s40 offen offset:1024
    s_and_b32 s41, s32, 1
    s_lshl_b32 s41, s41, 1
    s_lshl_b32 s49, s34, 2
    s_add_u32 s49, s49, s41
    s_lshl_b32 s49, s49, 7
    s_add_u32 s49, s49, s37
    s_lshl_b32 s41, s30, 4
    s_add_u32 s49, s49, s41
    s_add_u32 s49, s49, 6400
    v_bfe_u32 v7, v1, 2, 1
    v_lshlrev_b32 v7, 7, v7
    v_and_b32 v9, 3, v1
    v_lshl_add_u32 v7, v9, 2, v7
    s_add_u32 s41, s30, 0
    s_and_b32 s41, s41, 3
    s_lshl_b32 s46, s32, 2
    s_add_u32 s41, s41, s46
    s_mul_i32 s41, s41, 55296
    s_mul_i32 s46, s30, 14336
    s_add_u32 s41, s41, s46
    s_add_u32 s41, s41, s36
    s_add_u32 s50, s41, 696320
    s_add_u32 s41, s30, 1
    s_and_b32 s41, s41, 3
    s_lshl_b32 s46, s32, 2
    s_add_u32 s41, s41, s46
    s_mul_i32 s41, s41, 55296
    s_mul_i32 s46, s30, 14336
    s_add_u32 s41, s41, s46
    s_add_u32 s41, s41, s36
    s_add_u32 s51, s41, 696320
    s_add_u32 s41, s30, 2
    s_and_b32 s41, s41, 3
    s_lshl_b32 s46, s32, 2
    s_add_u32 s41, s41, s46
    s_mul_i32 s41, s41, 55296
    s_mul_i32 s46, s30, 14336
    s_add_u32 s41, s41, s46
    s_add_u32 s41, s41, s36
    s_add_u32 s52, s41, 696320
    s_add_u32 s41, s30, 3
    s_and_b32 s41, s41, 3
    s_lshl_b32 s46, s32, 2
    s_add_u32 s41, s41, s46
    s_mul_i32 s41, s41, 55296
    s_mul_i32 s46, s30, 14336
    s_add_u32 s41, s41, s46
    s_add_u32 s41, s41, s36
    s_add_u32 s53, s41, 696320
    s_mov_b32 s43, 200000
k2_kernel_poll36:
    buffer_load_dword v9, v7, s[12:15], s49 offen sc1
    s_waitcnt vmcnt(0)
    v_cmp_ne_u32 vcc, 0, v9
    s_sub_u32 s43, s43, 1
    s_cmp_eq_u64 vcc, -1
    s_cbranch_scc1 k2_kernel_go37
    s_cmp_lg_u32 s43, 0
    s_cbranch_scc1 k2_kernel_poll36
k2_kernel_go37:
    s_add_u32 s41, s50, 0
    buffer_load_dwordx4 v[96:99], v2, s[12:15], s41 offen offset:0 sc1
    s_add_u32 s41, s51, 0
    buffer_load_dwordx4 v[100:103], v2, s[12:15], s41 offen offset:0 sc1
    s_add_u32 s41, s52, 0
    buffer_load_dwordx4 v[104:107], v2, s[12:15], s41 offen offset:0 sc1
    s_add_u32 s41, s53, 0
    buffer_load_dwordx4 v[108:111], v2, s[12:15], s41 offen offset:0 sc1
    s_add_u32 s41, s50, 0
    buffer_load_dwordx4 v[112:115], v2, s[12:15], s41 offen offset:1024 sc1
    s_add_u32 s41, s51, 0
    buffer_load_dwordx4 v[116:119], v2, s[12:15], s41 offen offset:1024 sc1
    s_add_u32 s41, s52, 0
    buffer_load_dwordx4 v[120:123], v2, s[12:15], s41 offen offset:1024 sc1
    s_add_u32 s41, s53, 0
    buffer_load_dwordx4 v[124:127], v2, s[12:15], s41 offen offset:1024 sc1
    s_waitcnt vmcnt(4)
    v_mfma_f32_16x16x32_bf16 v[16:19], a[0:3], v[96:99], 0
    v_mfma_f32_16x16x32_bf16 v[36:39], a[0:3], v[100:103], 0
    v_mfma_f32_16x16x32_bf16 v[56:59], a[0:3], v[104:107], 0
    v_mfma_f32_16x16x32_bf16 v[76:79], a[0:3], v[108:111], 0
    s_add_u32 s41, s50, 0
    buffer_load_dwordx4 v[128:131], v2, s[12:15], s41 offen offset:2048 sc1
    v_mfma_f32_16x16x32_bf16 v[20:23], a[4:7], v[96:99], 0
    v_mfma_f32_16x16x32_bf16 v[40:43], a[4:7], v[100:103], 0
    v_mfma_f32_16x16x32_bf16 v[60:63], a[4:7], v[104:107], 0
    v_mfma_f32_16x16x32_bf16 v[80:83], a[4:7], v[108:111], 0
    s_add_u32 s41, s51, 0
    buffer_load_dwordx4 v[132:135], v2, s[12:15], s41 offen offset:2048 sc1
    s_add_u32 s41, s52, 0
    buffer_load_dwordx4 v[136:139], v2, s[12:15], s41 offen offset:2048 sc1
    v_mfma_f32_16x16x32_bf16 v[24:27], a[8:11], v[96:99], 0
    v_mfma_f32_16x16x32_bf16 v[44:47], a[8:11], v[100:103], 0
    v_mfma_f32_16x16x32_bf16 v[64:67], a[8:11], v[104:107], 0
    v_mfma_f32_16x16x32_bf16 v[84:87], a[8:11], v[108:111], 0
    s_add_u32 s41, s53, 0
    buffer_load_dwordx4 v[140:143], v2, s[12:15], s41 offen offset:2048 sc1
    v_mfma_f32_16x16x32_bf16 v[28:31], a[12:15], v[96:99], 0
    v_mfma_f32_16x16x32_bf16 v[48:51], a[12:15], v[100:103], 0
    v_mfma_f32_16x16x32_bf16 v[68:71], a[12:15], v[104:107], 0
    v_mfma_f32_16x16x32_bf16 v[88:91], a[12:15], v[108:111], 0
    s_add_u32 s41, s50, 0
    buffer_load_dwordx4 v[144:147], v2, s[12:15], s41 offen offset:3072 sc1
    s_add_u32 s41, s51, 0
    buffer_load_dwordx4 v[148:151], v2, s[12:15], s41 offen offset:3072 sc1
    v_mfma_f32_16x16x32_bf16 v[32:35], a[16:19], v[96:99], 0
    v_mfma_f32_16x16x32_bf16 v[52:55], a[16:19], v[100:103], 0
    v_mfma_f32_16x16x32_bf16 v[72:75], a[16:19], v[104:107], 0
    v_mfma_f32_16x16x32_bf16 v[92:95], a[16:19], v[108:111], 0
    s_add_u32 s41, s52, 0
    buffer_load_dwordx4 v[152:155], v2, s[12:15], s41 offen offset:3072 sc1
    s_waitcnt vmcnt(7)
    v_mfma_f32_16x16x32_bf16 v[16:19], a[20:23], v[112:115], v[16:19]
    v_mfma_f32_16x16x32_bf16 v[36:39], a[20:23], v[116:119], v[36:39]
    v_mfma_f32_16x16x32_bf16 v[56:59], a[20:23], v[120:123], v[56:59]
    v_mfma_f32_16x16x32_bf16 v[76:79], a[20:23], v[124:127], v[76:79]
    s_add_u32 s41, s53, 0
    buffer_load_dwordx4 v[156:159], v2, s[12:15], s41 offen offset:3072 sc1
    v_mfma_f32_16x16x32_bf16 v[20:23], a[24:27], v[112:115], v[20:23]
    v_mfma_f32_16x16x32_bf16 v[40:43], a[24:27], v[116:119], v[40:43]
    v_mfma_f32_16x16x32_bf16 v[60:63], a[24:27], v[120:123], v[60:63]
    v_mfma_f32_16x16x32_bf16 v[80:83], a[24:27], v[124:127], v[80:83]
    s_add_u32 s41, s50, 4096
    buffer_load_dwordx4 v[160:163], v2, s[12:15], s41 offen offset:0 sc1
    s_add_u32 s41, s51, 4096
    buffer_load_dwordx4 v[164:167], v2, s[12:15], s41 offen offset:0 sc1
    v_mfma_f32_16x16x32_bf16 v[24:27], a[28:31], v[112:115], v[24:27]
    v_mfma_f32_16x16x32_bf16 v[44:47], a[28:31], v[116:119], v[44:47]
    v_mfma_f32_16x16x32_bf16 v[64:67], a[28:31], v[120:123], v[64:67]
    v_mfma_f32_16x16x32_bf16 v[84:87], a[28:31], v[124:127], v[84:87]
    s_add_u32 s41, s52, 4096
    buffer_load_dwordx4 v[168:171], v2, s[12:15], s41 offen offset:0 sc1
    v_mfma_f32_16x16x32_bf16 v[28:31], a[32:35], v[112:115], v[28:31]
    v_mfma_f32_16x16x32_bf16 v[48:51], a[32:35], v[116:119], v[48:51]
    v_mfma_f32_16x16x32_bf16 v[68:71], a[32:35], v[120:123], v[68:71]
    v_mfma_f32_16x16x32_bf16 v[88:91], a[32:35], v[124:127], v[88:91]
    s_add_u32 s41, s53, 4096
    buffer_load_dwordx4 v[172:175], v2, s[12:15], s41 offen offset:0 sc1
    s_add_u32 s41, s50, 4096
    buffer_load_dwordx4 v[176:179], v2, s[12:15], s41 offen offset:1024 sc1
    v_mfma_f32_16x16x32_bf16 v[32:35], a[36:39], v[112:115], v[32:35]
    v_mfma_f32_16x16x32_bf16 v[52:55], a[36:39], v[116:119], v[52:55]
    v_mfma_f32_16x16x32_bf16 v[72:75], a[36:39], v[120:123], v[72:75]
    v_mfma_f32_16x16x32_bf16 v[92:95], a[36:39], v[124:127], v[92:95]
    s_add_u32 s41, s51, 4096
    buffer_load_dwordx4 v[180:183], v2, s[12:15], s41 offen offset:1024 sc1
    s_waitcnt vmcnt(10)
    v_mfma_f32_16x16x32_bf16 v[16:19], a[40:43], v[128:131], v[16:19]
    v_mfma_f32_16x16x32_bf16 v[36:39], a[40:43], v[132:135], v[36:39]
    v_mfma_f32_16x16x32_bf16 v[56:59], a[40:43], v[136:139], v[56:59]
    v_mfma_f32_16x16x32_bf16 v[76:79], a[40:43], v[140:143], v[76:79]
    s_add_u32 s41, s52, 4096
    buffer_load_dwordx4 v[184:187], v2, s[12:15], s41 offen offset:1024 sc1
    v_mfma_f32_16x16x32_bf16 v[20:23], a[44:47], v[128:131], v[20:23]
    v_mfma_f32_16x16x32_bf16 v[40:43], a[44:47], v[132:135], v[40:43]
    v_mfma_f32_16x16x32_bf16 v[60:63], a[44:47], v[136:139], v[60:63]
    v_mfma_f32_16x16x32_bf16 v[80:83], a[44:47], v[140:143], v[80:83]
    s_add_u32 s41, s53, 4096
    buffer_load_dwordx4 v[188:191], v2, s[12:15], s41 offen offset:1024 sc1
    s_add_u32 s41, s50, 4096
    buffer_load_dwordx4 v[96:99], v2, s[12:15], s41 offen offset:2048 sc1
    v_mfma_f32_16x16x32_bf16 v[24:27], a[48:51], v[128:131], v[24:27]
    v_mfma_f32_16x16x32_bf16 v[44:47], a[48:51], v[132:135], v[44:47]
    v_mfma_f32_16x16x32_bf16 v[64:67], a[48:51], v[136:139], v[64:67]
    v_mfma_f32_16x16x32_bf16 v[84:87], a[48:51], v[140:143], v[84:87]
    s_add_u32 s41, s51, 4096
    buffer_load_dwordx4 v[100:103], v2, s[12:15], s41 offen offset:2048 sc1
    v_mfma_f32_16x16x32_bf16 v[28:31], a[52:55], v[128:131], v[28:31]
    v_mfma_f32_16x16x32_bf16 v[48:51], a[52:55], v[132:135], v[48:51]
    v_mfma_f32_16x16x32_bf16 v[68:71], a[52:55], v[136:139], v[68:71]
    v_mfma_f32_16x16x32_bf16 v[88:91], a[52:55], v[140:143], v[88:91]
    s_add_u32 s41, s52, 4096
    buffer_load_dwordx4 v[104:107], v2, s[12:15], s41 offen offset:2048 sc1
    v_mfma_f32_16x16x32_bf16 v[32:35], a[56:59], v[128:131], v[32:35]
    v_mfma_f32_16x16x32_bf16 v[52:55], a[56:59], v[132:135], v[52:55]
    v_mfma_f32_16x16x32_bf16 v[72:75], a[56:59], v[136:139], v[72:75]
    v_mfma_f32_16x16x32_bf16 v[92:95], a[56:59], v[140:143], v[92:95]
    s_add_u32 s41, s53, 4096
    buffer_load_dwordx4 v[108:111], v2, s[12:15], s41 offen offset:2048 sc1
    s_waitcnt vmcnt(12)
    v_mfma_f32_16x16x32_bf16 v[16:19], a[60:63], v[144:147], v[16:19]
    v_mfma_f32_16x16x32_bf16 v[36:39], a[60:63], v[148:151], v[36:39]
    v_mfma_f32_16x16x32_bf16 v[56:59], a[60:63], v[152:155], v[56:59]
    v_mfma_f32_16x16x32_bf16 v[76:79], a[60:63], v[156:159], v[76:79]
    s_add_u32 s41, s50, 4096
    buffer_load_dwordx4 v[112:115], v2, s[12:15], s41 offen offset:3072 sc1
    v_mfma_f32_16x16x32_bf16 v[20:23], a[64:67], v[144:147], v[20:23]
    v_mfma_f32_16x16x32_bf16 v[40:43], a[64:67], v[148:151], v[40:43]
    v_mfma_f32_16x16x32_bf16 v[60:63], a[64:67], v[152:155], v[60:63]
    v_mfma_f32_16x16x32_bf16 v[80:83], a[64:67], v[156:159], v[80:83]
    s_add_u32 s41, s51, 4096
    buffer_load_dwordx4 v[116:119], v2, s[12:15], s41 offen offset:3072 sc1
    v_mfma_f32_16x16x32_bf16 v[24:27], a[68:71], v[144:147], v[24:27]
    v_mfma_f32_16x16x32_bf16 v[44:47], a[68:71], v[148:151], v[44:47]
    v_mfma_f32_16x16x32_bf16 v[64:67], a[68:71], v[152:155], v[64:67]
    v_mfma_f32_16x16x32_bf16 v[84:87], a[68:71], v[156:159], v[84:87]
    s_add_u32 s41, s52, 4096
    buffer_load_dwordx4 v[120:123], v2, s[12:15], s41 offen offset:3072 sc1
    v_mfma_f32_16x16x32_bf16 v[28:31], a[72:75], v[144:147], v[28:31]
    v_mfma_f32_16x16x32_bf16 v[48:51], a[72:75], v[148:151], v[48:51]
    v_mfma_f32_16x16x32_bf16 v[68:71], a[72:75], v[152:155], v[68:71]
    v_mfma_f32_16x16x32_bf16 v[88:91], a[72:75], v[156:159], v[88:91]
    s_add_u32 s41, s53, 4096
    buffer_load_dwordx4 v[124:127], v2, s[12:15], s41 offen offset:3072 sc1
    v_mfma_f32_16x16x32_bf16 v[32:35], a[76:79], v[144:147], v[32:35]
    v_mfma_f32_16x16x32_bf16 v[52:55], a[76:79], v[148:151], v[52:55]
    v_mfma_f32_16x16x32_bf16 v[72:75], a[76:79], v[152:155], v[72:75]
    v_mfma_f32_16x16x32_bf16 v[92:95], a[76:79], v[156:159], v[92:95]
    s_add_u32 s41, s50, 8192
    buffer_load_dwordx4 v[128:131], v2, s[12:15], s41 offen offset:0 sc1
    s_waitcnt vmcnt(13)
    v_mfma_f32_16x16x32_bf16 v[16:19], a[80:83], v[160:163], v[16:19]
    v_mfma_f32_16x16x32_bf16 v[36:39], a[80:83], v[164:167], v[36:39]
    v_mfma_f32_16x16x32_bf16 v[56:59], a[80:83], v[168:171], v[56:59]
    v_mfma_f32_16x16x32_bf16 v[76:79], a[80:83], v[172:175], v[76:79]
    s_add_u32 s41, s51, 8192
    buffer_load_dwordx4 v[132:135], v2, s[12:15], s41 offen offset:0 sc1
    v_mfma_f32_16x16x32_bf16 v[20:23], a[84:87], v[160:163], v[20:23]
    v_mfma_f32_16x16x32_bf16 v[40:43], a[84:87], v[164:167], v[40:43]
    v_mfma_f32_16x16x32_bf16 v[60:63], a[84:87], v[168:171], v[60:63]
    v_mfma_f32_16x16x32_bf16 v[80:83], a[84:87], v[172:175], v[80:83]
    s_add_u32 s41, s52, 8192
    buffer_load_dwordx4 v[136:139], v2, s[12:15], s41 offen offset:0 sc1
    v_mfma_f32_16x16x32_bf16 v[24:27], a[88:91], v[160:163], v[24:27]
    v_mfma_f32_16x16x32_bf16 v[44:47], a[88:91], v[164:167], v[44:47]
    v_mfma_f32_16x16x32_bf16 v[64:67], a[88:91], v[168:171], v[64:67]
    v_mfma_f32_16x16x32_bf16 v[84:87], a[88:91], v[172:175], v[84:87]
    s_add_u32 s41, s53, 8192
    buffer_load_dwordx4 v[140:143], v2, s[12:15], s41 offen offset:0 sc1
    v_mfma_f32_16x16x32_bf16 v[28:31], a[92:95], v[160:163], v[28:31]
    v_mfma_f32_16x16x32_bf16 v[48:51], a[92:95], v[164:167], v[48:51]
    v_mfma_f32_16x16x32_bf16 v[68:71], a[92:95], v[168:171], v[68:71]
    v_mfma_f32_16x16x32_bf16 v[88:91], a[92:95], v[172:175], v[88:91]
    s_add_u32 s41, s50, 8192
    buffer_load_dwordx4 v[144:147], v2, s[12:15], s41 offen offset:1024 sc1
    v_mfma_f32_16x16x32_bf16 v[32:35], a[96:99], v[160:163], v[32:35]
    v_mfma_f32_16x16x32_bf16 v[52:55], a[96:99], v[164:167], v[52:55]
    v_mfma_f32_16x16x32_bf16 v[72:75], a[96:99], v[168:171], v[72:75]
    v_mfma_f32_16x16x32_bf16 v[92:95], a[96:99], v[172:175], v[92:95]
    s_add_u32 s41, s51, 8192
    buffer_load_dwordx4 v[148:151], v2, s[12:15], s41 offen offset:1024 sc1
    s_waitcnt vmcnt(14)
    v_mfma_f32_16x16x32_bf16 v[16:19], a[100:103], v[176:179], v[16:19]
    v_mfma_f32_16x16x32_bf16 v[36:39], a[100:103], v[180:183], v[36:39]
    v_mfma_f32_16x16x32_bf16 v[56:59], a[100:103], v[184:187], v[56:59]
    v_mfma_f32_16x16x32_bf16 v[76:79], a[100:103], v[188:191], v[76:79]
    s_add_u32 s41, s52, 8192
    buffer_load_dwordx4 v[152:155], v2, s[12:15], s41 offen offset:1024 sc1
    v_mfma_f32_16x16x32_bf16 v[20:23], a[104:107], v[176:179], v[20:23]
    v_mfma_f32_16x16x32_bf16 v[40:43], a[104:107], v[180:183], v[40:43]
    v_mfma_f32_16x16x32_bf16 v[60:63], a[104:107], v[184:187], v[60:63]
    v_mfma_f32_16x16x32_bf16 v[80:83], a[104:107], v[188:191], v[80:83]
    s_add_u32 s41, s53, 8192
    buffer_load_dwordx4 v[156:159], v2, s[12:15], s41 offen offset:1024 sc1
    v_mfma_f32_16x16x32_bf16 v[24:27], a[108:111], v[176:179], v[24:27]
    v_mfma_f32_16x16x32_bf16 v[44:47], a[108:111], v[180:183], v[44:47]
    v_mfma_f32_16x16x32_bf16 v[64:67], a[108:111], v[184:187], v[64:67]
    v_mfma_f32_16x16x32_bf16 v[84:87], a[108:111], v[188:191], v[84:87]
    s_add_u32 s41, s50, 8192
    buffer_load_dwordx4 v[160:163], v2, s[12:15], s41 offen offset:2048 sc1
    v_mfma_f32_16x16x32_bf16 v[28:31], a[112:115], v[176:179], v[28:31]
    v_mfma_f32_16x16x32_bf16 v[48:51], a[112:115], v[180:183], v[48:51]
    v_mfma_f32_16x16x32_bf16 v[68:71], a[112:115], v[184:187], v[68:71]
    v_mfma_f32_16x16x32_bf16 v[88:91], a[112:115], v[188:191], v[88:91]
    s_add_u32 s41, s51, 8192
    buffer_load_dwordx4 v[164:167], v2, s[12:15], s41 offen offset:2048 sc1
    v_mfma_f32_16x16x32_bf16 v[32:35], a[116:119], v[176:179], v[32:35]
    v_mfma_f32_16x16x32_bf16 v[52:55], a[116:119], v[180:183], v[52:55]
    v_mfma_f32_16x16x32_bf16 v[72:75], a[116:119], v[184:187], v[72:75]
    v_mfma_f32_16x16x32_bf16 v[92:95], a[116:119], v[188:191], v[92:95]
    s_add_u32 s41, s52, 8192
    buffer_load_dwordx4 v[168:171], v2, s[12:15], s41 offen offset:2048 sc1
    s_waitcnt vmcnt(15)
    v_mfma_f32_16x16x32_bf16 v[16:19], a[120:123], v[96:99], v[16:19]
    v_mfma_f32_16x16x32_bf16 v[36:39], a[120:123], v[100:103], v[36:39]
    v_mfma_f32_16x16x32_bf16 v[56:59], a[120:123], v[104:107], v[56:59]
    v_mfma_f32_16x16x32_bf16 v[76:79], a[120:123], v[108:111], v[76:79]
    s_add_u32 s41, s53, 8192
    buffer_load_dwordx4 v[172:175], v2, s[12:15], s41 offen offset:2048 sc1
    v_mfma_f32_16x16x32_bf16 v[20:23], a[124:127], v[96:99], v[20:23]
    v_mfma_f32_16x16x32_bf16 v[40:43], a[124:127], v[100:103], v[40:43]
    v_mfma_f32_16x16x32_bf16 v[60:63], a[124:127], v[104:107], v[60:63]
    v_mfma_f32_16x16x32_bf16 v[80:83], a[124:127], v[108:111], v[80:83]
    s_add_u32 s41, s50, 8192
    buffer_load_dwordx4 v[176:179], v2, s[12:15], s41 offen offset:3072 sc1
    v_mfma_f32_16x16x32_bf16 v[24:27], a[128:131], v[96:99], v[24:27]
    v_mfma_f32_16x16x32_bf16 v[44:47], a[128:131], v[100:103], v[44:47]
    v_mfma_f32_16x16x32_bf16 v[64:67], a[128:131], v[104:107], v[64:67]
    v_mfma_f32_16x16x32_bf16 v[84:87], a[128:131], v[108:111], v[84:87]
    s_add_u32 s41, s51, 8192
    buffer_load_dwordx4 v[180:183], v2, s[12:15], s41 offen offset:3072 sc1
    v_mfma_f32_16x16x32_bf16 v[28:31], a[132:135], v[96:99], v[28:31]
    v_mfma_f32_16x16x32_bf16 v[48:51], a[132:135], v[100:103], v[48:51]
    v_mfma_f32_16x16x32_bf16 v[68:71], a[132:135], v[104:107], v[68:71]
    v_mfma_f32_16x16x32_bf16 v[88:91], a[132:135], v[108:111], v[88:91]
    s_add_u32 s41, s52, 8192
    buffer_load_dwordx4 v[184:187], v2, s[12:15], s41 offen offset:3072 sc1
    v_mfma_f32_16x16x32_bf16 v[32:35], a[136:139], v[96:99], v[32:35]
    v_mfma_f32_16x16x32_bf16 v[52:55], a[136:139], v[100:103], v[52:55]
    v_mfma_f32_16x16x32_bf16 v[72:75], a[136:139], v[104:107], v[72:75]
    v_mfma_f32_16x16x32_bf16 v[92:95], a[136:139], v[108:111], v[92:95]
    s_add_u32 s41, s53, 8192
    buffer_load_dwordx4 v[188:191], v2, s[12:15], s41 offen offset:3072 sc1
    s_waitcnt vmcnt(16)
    v_mfma_f32_16x16x32_bf16 v[16:19], a[140:143], v[112:115], v[16:19]
    v_mfma_f32_16x16x32_bf16 v[36:39], a[140:143], v[116:119], v[36:39]
    v_mfma_f32_16x16x32_bf16 v[56:59], a[140:143], v[120:123], v[56:59]
    v_mfma_f32_16x16x32_bf16 v[76:79], a[140:143], v[124:127], v[76:79]
    v_mfma_f32_16x16x32_bf16 v[20:23], a[144:147], v[112:115], v[20:23]
    v_mfma_f32_16x16x32_bf16 v[40:43], a[144:147], v[116:119], v[40:43]
    v_mfma_f32_16x16x32_bf16 v[60:63], a[144:147], v[120:123], v[60:63]
    v_mfma_f32_16x16x32_bf16 v[80:83], a[144:147], v[124:127], v[80:83]
    s_add_u32 s41, s50, 12288
    buffer_load_dwordx4 v[96:99], v2, s[12:15], s41 offen offset:0 sc1
    v_mfma_f32_16x16x32_bf16 v[24:27], a[148:151], v[112:115], v[24:27]
    v_mfma_f32_16x16x32_bf16 v[44:47], a[148:151], v[116:119], v[44:47]
    v_mfma_f32_16x16x32_bf16 v[64:67], a[148:151], v[120:123], v[64:67]
    v_mfma_f32_16x16x32_bf16 v[84:87], a[148:151], v[124:127], v[84:87]
    s_add_u32 s41, s51, 12288
    buffer_load_dwordx4 v[100:103], v2, s[12:15], s41 offen offset:0 sc1
    v_mfma_f32_16x16x32_bf16 v[28:31], a[152:155], v[112:115], v[28:31]
    v_mfma_f32_16x16x32_bf16 v[48:51], a[152:155], v[116:119], v[48:51]
    v_mfma_f32_16x16x32_bf16 v[68:71], a[152:155], v[120:123], v[68:71]
    v_mfma_f32_16x16x32_bf16 v[88:91], a[152:155], v[124:127], v[88:91]
    s_add_u32 s41, s52, 12288
    buffer_load_dwordx4 v[104:107], v2, s[12:15], s41 offen offset:0 sc1
    v_mfma_f32_16x16x32_bf16 v[32:35], a[156:159], v[112:115], v[32:35]
    v_mfma_f32_16x16x32_bf16 v[52:55], a[156:159], v[116:119], v[52:55]
    v_mfma_f32_16x16x32_bf16 v[72:75], a[156:159], v[120:123], v[72:75]
    v_mfma_f32_16x16x32_bf16 v[92:95], a[156:159], v[124:127], v[92:95]
    s_add_u32 s41, s53, 12288
    buffer_load_dwordx4 v[108:111], v2, s[12:15], s41 offen offset:0 sc1
    s_waitcnt vmcnt(16)
    v_mfma_f32_16x16x32_bf16 v[16:19], a[160:163], v[128:131], v[16:19]
    v_mfma_f32_16x16x32_bf16 v[36:39], a[160:163], v[132:135], v[36:39]
    v_mfma_f32_16x16x32_bf16 v[56:59], a[160:163], v[136:139], v[56:59]
    v_mfma_f32_16x16x32_bf16 v[76:79], a[160:163], v[140:143], v[76:79]
    v_mfma_f32_16x16x32_bf16 v[20:23], a[164:167], v[128:131], v[20:23]
    v_mfma_f32_16x16x32_bf16 v[40:43], a[164:167], v[132:135], v[40:43]
    v_mfma_f32_16x16x32_bf16 v[60:63], a[164:167], v[136:139], v[60:63]
    v_mfma_f32_16x16x32_bf16 v[80:83], a[164:167], v[140:143], v[80:83]
    s_add_u32 s41, s50, 12288
    buffer_load_dwordx4 v[112:115], v2, s[12:15], s41 offen offset:1024 sc1
    v_mfma_f32_16x16x32_bf16 v[24:27], a[168:171], v[128:131], v[24:27]
    v_mfma_f32_16x16x32_bf16 v[44:47], a[168:171], v[132:135], v[44:47]
    v_mfma_f32_16x16x32_bf16 v[64:67], a[168:171], v[136:139], v[64:67]
    v_mfma_f32_16x16x32_bf16 v[84:87], a[168:171], v[140:143], v[84:87]
    s_add_u32 s41, s51, 12288
    buffer_load_dwordx4 v[116:119], v2, s[12:15], s41 offen offset:1024 sc1
    v_mfma_f32_16x16x32_bf16 v[28:31], a[172:175], v[128:131], v[28:31]
    v_mfma_f32_16x16x32_bf16 v[48:51], a[172:175], v[132:135], v[48:51]
    v_mfma_f32_16x16x32_bf16 v[68:71], a[172:175], v[136:139], v[68:71]
    v_mfma_f32_16x16x32_bf16 v[88:91], a[172:175], v[140:143], v[88:91]
    s_add_u32 s41, s52, 12288
    buffer_load_dwordx4 v[120:123], v2, s[12:15], s41 offen offset:1024 sc1
    v_mfma_f32_16x16x32_bf16 v[32:35], a[176:179], v[128:131], v[32:35]
    v_mfma_f32_16x16x32_bf16 v[52:55], a[176:179], v[132:135], v[52:55]
    v_mfma_f32_16x16x32_bf16 v[72:75], a[176:179], v[136:139], v[72:75]
    v_mfma_f32_16x16x32_bf16 v[92:95], a[176:179], v[140:143], v[92:95]
    s_add_u32 s41, s53, 12288
    buffer_load_dwordx4 v[124:127], v2, s[12:15], s41 offen offset:1024 sc1
    s_waitcnt vmcnt(16)
    v_mfma_f32_16x16x32_bf16 v[16:19], a[180:183], v[144:147], v[16:19]
    v_mfma_f32_16x16x32_bf16 v[36:39], a[180:183], v[148:151], v[36:39]
    v_mfma_f32_16x16x32_bf16 v[56:59], a[180:183], v[152:155], v[56:59]
    v_mfma_f32_16x16x32_bf16 v[76:79], a[180:183], v[156:159], v[76:79]
    v_mfma_f32_16x16x32_bf16 v[20:23], a[184:187], v[144:147], v[20:23]
    v_mfma_f32_16x16x32_bf16 v[40:43], a[184:187], v[148:151], v[40:43]
    v_mfma_f32_16x16x32_bf16 v[60:63], a[184:187], v[152:155], v[60:63]
    v_mfma_f32_16x16x32_bf16 v[80:83], a[184:187], v[156:159], v[80:83]
    v_mfma_f32_16x16x32_bf16 v[24:27], a[188:191], v[144:147], v[24:27]
    v_mfma_f32_16x16x32_bf16 v[44:47], a[188:191], v[148:151], v[44:47]
    v_mfma_f32_16x16x32_bf16 v[64:67], a[188:191], v[152:155], v[64:67]
    v_mfma_f32_16x16x32_bf16 v[84:87], a[188:191], v[156:159], v[84:87]
    v_mfma_f32_16x16x32_bf16 v[28:31], a[192:195], v[144:147], v[28:31]
    v_mfma_f32_16x16x32_bf16 v[48:51], a[192:195], v[148:151], v[48:51]
    v_mfma_f32_16x16x32_bf16 v[68:71], a[192:195], v[152:155], v[68:71]
    v_mfma_f32_16x16x32_bf16 v[88:91], a[192:195], v[156:159], v[88:91]
    v_mfma_f32_16x16x32_bf16 v[32:35], a[196:199], v[144:147], v[32:35]
    v_mfma_f32_16x16x32_bf16 v[52:55], a[196:199], v[148:151], v[52:55]
    v_mfma_f32_16x16x32_bf16 v[72:75], a[196:199], v[152:155], v[72:75]
    v_mfma_f32_16x16x32_bf16 v[92:95], a[196:199], v[156:159], v[92:95]
    s_waitcnt vmcnt(12)
    v_mfma_f32_16x16x32_bf16 v[16:19], a[200:203], v[160:163], v[16:19]
    v_mfma_f32_16x16x32_bf16 v[36:39], a[200:203], v[164:167], v[36:39]
    v_mfma_f32_16x16x32_bf16 v[56:59], a[200:203], v[168:171], v[56:59]
    v_mfma_f32_16x16x32_bf16 v[76:79], a[200:203], v[172:175], v[76:79]
    v_mfma_f32_16x16x32_bf16 v[20:23], a[204:207], v[160:163], v[20:23]
    v_mfma_f32_16x16x32_bf16 v[40:43], a[204:207], v[164:167], v[40:43]
    v_mfma_f32_16x16x32_bf16 v[60:63], a[204:207], v[168:171], v[60:63]
    v_mfma_f32_16x16x32_bf16 v[80:83], a[204:207], v[172:175], v[80:83]
    v_mfma_f32_16x16x32_bf16 v[24:27], a[208:211], v[160:163], v[24:27]
    v_mfma_f32_16x16x32_bf16 v[44:47], a[208:211], v[164:167], v[44:47]
    v_mfma_f32_16x16x32_bf16 v[64:67], a[208:211], v[168:171], v[64:67]
    v_mfma_f32_16x16x32_bf16 v[84:87], a[208:211], v[172:175], v[84:87]
    v_mfma_f32_16x16x32_bf16 v[28:31], a[212:215], v[160:163], v[28:31]
    v_mfma_f32_16x16x32_bf16 v[48:51], a[212:215], v[164:167], v[48:51]
    v_mfma_f32_16x16x32_bf16 v[68:71], a[212:215], v[168:171], v[68:71]
    v_mfma_f32_16x16x32_bf16 v[88:91], a[212:215], v[172:175], v[88:91]
    v_mfma_f32_16x16x32_bf16 v[32:35], a[216:219], v[160:163], v[32:35]
    v_mfma_f32_16x16x32_bf16 v[52:55], a[216:219], v[164:167], v[52:55]
    v_mfma_f32_16x16x32_bf16 v[72:75], a[216:219], v[168:171], v[72:75]
    v_mfma_f32_16x16x32_bf16 v[92:95], a[216:219], v[172:175], v[92:95]
    s_waitcnt vmcnt(8)
    v_mfma_f32_16x16x32_bf16 v[16:19], a[220:223], v[176:179], v[16:19]
    v_mfma_f32_16x16x32_bf16 v[36:39], a[220:223], v[180:183], v[36:39]
    v_mfma_f32_16x16x32_bf16 v[56:59], a[220:223], v[184:187], v[56:59]
    v_mfma_f32_16x16x32_bf16 v[76:79], a[220:223], v[188:191], v[76:79]
    v_mfma_f32_16x16x32_bf16 v[20:23], a[224:227], v[176:179], v[20:23]
    v_mfma_f32_16x16x32_bf16 v[40:43], a[224:227], v[180:183], v[40:43]
    v_mfma_f32_16x16x32_bf16 v[60:63], a[224:227], v[184:187], v[60:63]
    v_mfma_f32_16x16x32_bf16 v[80:83], a[224:227], v[188:191], v[80:83]
    v_mfma_f32_16x16x32_bf16 v[24:27], a[228:231], v[176:179], v[24:27]
    v_mfma_f32_16x16x32_bf16 v[44:47], a[228:231], v[180:183], v[44:47]
    v_mfma_f32_16x16x32_bf16 v[64:67], a[228:231], v[184:187], v[64:67]
    v_mfma_f32_16x16x32_bf16 v[84:87], a[228:231], v[188:191], v[84:87]
    v_mfma_f32_16x16x32_bf16 v[28:31], a[232:235], v[176:179], v[28:31]
    v_mfma_f32_16x16x32_bf16 v[48:51], a[232:235], v[180:183], v[48:51]
    v_mfma_f32_16x16x32_bf16 v[68:71], a[232:235], v[184:187], v[68:71]
    v_mfma_f32_16x16x32_bf16 v[88:91], a[232:235], v[188:191], v[88:91]
    v_mfma_f32_16x16x32_bf16 v[32:35], a[236:239], v[176:179], v[32:35]
    v_mfma_f32_16x16x32_bf16 v[52:55], a[236:239], v[180:183], v[52:55]
    v_mfma_f32_16x16x32_bf16 v[72:75], a[236:239], v[184:187], v[72:75]
    v_mfma_f32_16x16x32_bf16 v[92:95], a[236:239], v[188:191], v[92:95]
    s_cmp_eq_u32 s30, 3
    s_cbranch_scc1 k2_kernel_k4skip38
    s_waitcnt vmcnt(4)
    v_mfma_f32_16x16x32_bf16 v[16:19], a[240:243], v[96:99], v[16:19]
    v_mfma_f32_16x16x32_bf16 v[36:39], a[240:243], v[100:103], v[36:39]
    v_mfma_f32_16x16x32_bf16 v[56:59], a[240:243], v[104:107], v[56:59]
    v_mfma_f32_16x16x32_bf16 v[76:79], a[240:243], v[108:111], v[76:79]
    v_mfma_f32_16x16x32_bf16 v[20:23], a[244:247], v[96:99], v[20:23]
    v_mfma_f32_16x16x32_bf16 v[40:43], a[244:247], v[100:103], v[40:43]
    v_mfma_f32_16x16x32_bf16 v[60:63], a[244:247], v[104:107], v[60:63]
    v_mfma_f32_16x16x32_bf16 v[80:83], a[244:247], v[108:111], v[80:83]
    v_mfma_f32_16x16x32_bf16 v[24:27], a[248:251], v[96:99], v[24:27]
    v_mfma_f32_16x16x32_bf16 v[44:47], a[248:251], v[100:103], v[44:47]
    v_mfma_f32_16x16x32_bf16 v[64:67], a[248:251], v[104:107], v[64:67]
    v_mfma_f32_16x16x32_bf16 v[84:87], a[248:251], v[108:111], v[84:87]
    v_mfma_f32_16x16x32_bf16 v[28:31], a[252:255], v[96:99], v[28:31]
    v_mfma_f32_16x16x32_bf16 v[48:51], a[252:255], v[100:103], v[48:51]
    v_mfma_f32_16x16x32_bf16 v[68:71], a[252:255], v[104:107], v[68:71]
    v_mfma_f32_16x16x32_bf16 v[88:91], a[252:255], v[108:111], v[88:91]
    v_mfma_f32_16x16x32_bf16 v[32:35], v[192:195], v[96:99], v[32:35]
    v_mfma_f32_16x16x32_bf16 v[52:55], v[192:195], v[100:103], v[52:55]
    v_mfma_f32_16x16x32_bf16 v[72:75], v[192:195], v[104:107], v[72:75]
    v_mfma_f32_16x16x32_bf16 v[92:95], v[192:195], v[108:111], v[92:95]
    s_waitcnt vmcnt(0)
    v_mfma_f32_16x16x32_bf16 v[16:19], v[196:199], v[112:115], v[16:19]
    v_mfma_f32_16x16x32_bf16 v[36:39], v[196:199], v[116:119], v[36:39]
    v_mfma_f32_16x16x32_bf16 v[56:59], v[196:199], v[120:123], v[56:59]
    v_mfma_f32_16x16x32_bf16 v[76:79], v[196:199], v[124:127], v[76:79]
    v_mfma_f32_16x16x32_bf16 v[20:23], v[200:203], v[112:115], v[20:23]
    v_mfma_f32_16x16x32_bf16 v[40:43], v[200:203], v[116:119], v[40:43]
    v_mfma_f32_16x16x32_bf16 v[60:63], v[200:203], v[120:123], v[60:63]
    v_mfma_f32_16x16x32_bf16 v[80:83], v[200:203], v[124:127], v[80:83]
    v_mfma_f32_16x16x32_bf16 v[24:27], v[204:207], v[112:115], v[24:27]
    v_mfma_f32_16x16x32_bf16 v[44:47], v[204:207], v[116:119], v[44:47]
    v_mfma_f32_16x16x32_bf16 v[64:67], v[204:207], v[120:123], v[64:67]
    v_mfma_f32_16x16x32_bf16 v[84:87], v[204:207], v[124:127], v[84:87]
    v_mfma_f32_16x16x32_bf16 v[28:31], v[208:211], v[112:115], v[28:31]
    v_mfma_f32_16x16x32_bf16 v[48:51], v[208:211], v[116:119], v[48:51]
    v_mfma_f32_16x16x32_bf16 v[68:71], v[208:211], v[120:123], v[68:71]
    v_mfma_f32_16x16x32_bf16 v[88:91], v[208:211], v[124:127], v[88:91]
    v_mfma_f32_16x16x32_bf16 v[32:35], v[212:215], v[112:115], v[32:35]
    v_mfma_f32_16x16x32_bf16 v[52:55], v[212:215], v[116:119], v[52:55]
    v_mfma_f32_16x16x32_bf16 v[72:75], v[212:215], v[120:123], v[72:75]
    v_mfma_f32_16x16x32_bf16 v[92:95], v[212:215], v[124:127], v[92:95]
k2_kernel_k4skip38:
    s_waitcnt vmcnt(0)
    s_barrier
    s_add_u32 s41, s30, 1
    s_and_b32 s41, s41, 3
    s_mul_i32 s41, s41, 15360
    s_add_u32 s41, s41, 0
    v_add_u32 v9, s41, v2
    ds_write_b128 v9, v[36:39] offset:0
    ds_write_b128 v9, v[40:43] offset:1024
    ds_write_b128 v9, v[44:47] offset:2048
    ds_write_b128 v9, v[48:51] offset:3072
    ds_write_b128 v9, v[52:55] offset:4096
    s_add_u32 s41, s30, 2
    s_and_b32 s41, s41, 3
    s_mul_i32 s41, s41, 15360
    s_add_u32 s41, s41, 5120
    v_add_u32 v9, s41, v2
    ds_write_b128 v9, v[56:59] offset:0
    ds_write_b128 v9, v[60:63] offset:1024
    ds_write_b128 v9, v[64:67] offset:2048
    ds_write_b128 v9, v[68:71] offset:3072
    ds_write_b128 v9, v[72:75] offset:4096
    s_add_u32 s41, s30, 3
    s_and_b32 s41, s41, 3
    s_mul_i32 s41, s41, 15360
    s_add_u32 s41, s41, 10240
    v_add_u32 v9, s41, v2
    ds_write_b128 v9, v[76:79] offset:0
    ds_write_b128 v9, v[80:83] offset:1024
    ds_write_b128 v9, v[84:87] offset:2048
    ds_write_b128 v9, v[88:91] offset:3072
    ds_write_b128 v9, v[92:95] offset:4096
    v_lshlrev_b32 v10, 4, v3
    v_add_u32 v10, 157696, v10
    ds_read_b128 v[96:99], v10 offset:0
    ds_read_b128 v[100:103], v10 offset:64
    ds_read_b128 v[104:107], v10 offset:128
    ds_read_b128 v[108:111], v10 offset:192
    ds_read_b128 v[112:115], v10 offset:256
    s_mul_i32 s41, s30, 15360
    v_add_u32 v9, s41, v2
    s_waitcnt lgkmcnt(0)
    s_barrier
    ds_read_b128 v[116:119], v9 offset:0
    ds_read_b128 v[120:123], v9 offset:1024
    ds_read_b128 v[124:127], v9 offset:2048
    ds_read_b128 v[128:131], v9 offset:3072
    ds_read_b128 v[132:135], v9 offset:4096
    ds_read_b128 v[136:139], v9 offset:5120
    ds_read_b128 v[140:143], v9 offset:6144
    ds_read_b128 v[144:147], v9 offset:7168
    ds_read_b128 v[148:151], v9 offset:8192
    ds_read_b128 v[152:155], v9 offset:9216
    ds_read_b128 v[156:159], v9 offset:10240
    ds_read_b128 v[160:163], v9 offset:11264
    ds_read_b128 v[164:167], v9 offset:12288
    ds_read_b128 v[168:171], v9 offset:13312
    ds_read_b128 v[172:175], v9 offset:14336
    s_lshl_b32 s46, s32, 2
    s_add_u32 s46, s46, s30
    s_lshl_b32 s46, s46, 4
    s_lshl_b32 s47, s28, 8
    s_add_u32 s46, s46, s47
    v_add_u32 v10, s46, v4
    v_mul_u32_u24 v10, 1280, v10
    v_lshl_add_u32 v10, v3, 3, v10
    s_mul_i32 s47, s33, 160
    s_nop 1
    v_permlane16_swap_b32 v228, v230
    v_permlane16_swap_b32 v229, v231
    v_permlane16_swap_b32 v232, v234
    v_permlane16_swap_b32 v233, v235
    v_permlane16_swap_b32 v238, v240
    v_permlane16_swap_b32 v239, v241
    v_permlane16_swap_b32 v242, v244
    v_permlane16_swap_b32 v243, v245
    s_waitcnt lgkmcnt(0)
    v_pk_add_f32 v[16:17], v[16:17], v[116:117]
    v_pk_add_f32 v[18:19], v[18:19], v[118:119]
    v_pk_add_f32 v[20:21], v[20:21], v[120:121]
    v_pk_add_f32 v[22:23], v[22:23], v[122:123]
    v_pk_add_f32 v[24:25], v[24:25], v[124:125]
    v_pk_add_f32 v[26:27], v[26:27], v[126:127]
    v_pk_add_f32 v[28:29], v[28:29], v[128:129]
    v_pk_add_f32 v[30:31], v[30:31], v[130:131]
    v_pk_add_f32 v[32:33], v[32:33], v[132:133]
    v_pk_add_f32 v[34:35], v[34:35], v[134:135]
    v_pk_add_f32 v[16:17], v[16:17], v[136:137]
    v_pk_add_f32 v[18:19], v[18:19], v[138:139]
    v_pk_add_f32 v[20:21], v[20:21], v[140:141]
    v_pk_add_f32 v[22:23], v[22:23], v[142:143]
    v_pk_add_f32 v[24:25], v[24:25], v[144:145]
    v_pk_add_f32 v[26:27], v[26:27], v[146:147]
    v_pk_add_f32 v[28:29], v[28:29], v[148:149]
    v_pk_add_f32 v[30:31], v[30:31], v[150:151]
    v_pk_add_f32 v[32:33], v[32:33], v[152:153]
    v_pk_add_f32 v[34:35], v[34:35], v[154:155]
    v_pk_add_f32 v[16:17], v[16:17], v[156:157]
    v_pk_add_f32 v[18:19], v[18:19], v[158:159]
    v_pk_add_f32 v[20:21], v[20:21], v[160:161]
    v_pk_add_f32 v[22:23], v[22:23], v[162:163]
    v_pk_add_f32 v[24:25], v[24:25], v[164:165]
    v_pk_add_f32 v[26:27], v[26:27], v[166:167]
    v_pk_add_f32 v[28:29], v[28:29], v[168:169]
    v_pk_add_f32 v[30:31], v[30:31], v[170:171]
    v_pk_add_f32 v[32:33], v[32:33], v[172:173]
    v_pk_add_f32 v[34:35], v[34:35], v[174:175]
    v_lshlrev_b32 v116, 16, v238
    v_and_b32 v117, 0xffff0000, v238
    v_lshlrev_b32 v118, 16, v239
    v_and_b32 v119, 0xffff0000, v239
    v_lshlrev_b32 v136, 16, v228
    v_and_b32 v137, 0xffff0000, v228
    v_lshlrev_b32 v138, 16, v229
    v_and_b32 v139, 0xffff0000, v229
    v_lshlrev_b32 v120, 16, v240
    v_and_b32 v121, 0xffff0000, v240
    v_lshlrev_b32 v122, 16, v241
    v_and_b32 v123, 0xffff0000, v241
    v_lshlrev_b32 v140, 16, v230
    v_and_b32 v141, 0xffff0000, v230
    v_lshlrev_b32 v142, 16, v231
    v_and_b32 v143, 0xffff0000, v231
    v_lshlrev_b32 v124, 16, v242
    v_and_b32 v125, 0xffff0000, v242
    v_lshlrev_b32 v126, 16, v243
    v_and_b32 v127, 0xffff0000, v243
    v_lshlrev_b32 v144, 16, v232
    v_and_b32 v145, 0xffff0000, v232
    v_lshlrev_b32 v146, 16, v233
    v_and_b32 v147, 0xffff0000, v233
    v_lshlrev_b32 v128, 16, v244
    v_and_b32 v129, 0xffff0000, v244
    v_lshlrev_b32 v130, 16, v245
    v_and_b32 v131, 0xffff0000, v245
    v_lshlrev_b32 v148, 16, v234
    v_and_b32 v149, 0xffff0000, v234
    v_lshlrev_b32 v150, 16, v235
    v_and_b32 v151, 0xffff0000, v235
    v_lshlrev_b32 v132, 16, v246
    v_and_b32 v133, 0xffff0000, v246
    v_lshlrev_b32 v134, 16, v247
    v_and_b32 v135, 0xffff0000, v247
    v_lshlrev_b32 v152, 16, v236
    v_and_b32 v153, 0xffff0000, v236
    v_lshlrev_b32 v154, 16, v237
    v_and_b32 v155, 0xffff0000, v237
    v_pk_add_f32 v[16:17], v[16:17], v[116:117]
    v_pk_add_f32 v[18:19], v[18:19], v[118:119]
    v_pk_add_f32 v[20:21], v[20:21], v[120:121]
    v_pk_add_f32 v[22:23], v[22:23], v[122:123]
    v_pk_add_f32 v[24:25], v[24:25], v[124:125]
    v_pk_add_f32 v[26:27], v[26:27], v[126:127]
    v_pk_add_f32 v[28:29], v[28:29], v[128:129]
    v_pk_add_f32 v[30:31], v[30:31], v[130:131]
    v_pk_add_f32 v[32:33], v[32:33], v[132:133]
    v_pk_add_f32 v[34:35], v[34:35], v[134:135]
    v_pk_fma_f32 v[16:17], v[16:17], v[96:97], v[136:137]
    v_pk_fma_f32 v[18:19], v[18:19], v[98:99], v[138:139]
    v_pk_fma_f32 v[20:21], v[20:21], v[100:101], v[140:141]
    v_pk_fma_f32 v[22:23], v[22:23], v[102:103], v[142:143]
    v_pk_fma_f32 v[24:25], v[24:25], v[104:105], v[144:145]
    v_pk_fma_f32 v[26:27], v[26:27], v[106:107], v[146:147]
    v_pk_fma_f32 v[28:29], v[28:29], v[108:109], v[148:149]
    v_pk_fma_f32 v[30:31], v[30:31], v[110:111], v[150:151]
    v_pk_fma_f32 v[32:33], v[32:33], v[112:113], v[152:153]
    v_pk_fma_f32 v[34:35], v[34:35], v[114:115], v[154:155]
    v_cvt_pk_bf16_f32 v16, v16, v17
    v_cvt_pk_bf16_f32 v17, v18, v19
    v_cvt_pk_bf16_f32 v18, v20, v21
    v_cvt_pk_bf16_f32 v19, v22, v23
    v_cvt_pk_bf16_f32 v24, v24, v25
    v_cvt_pk_bf16_f32 v25, v26, v27
    v_cvt_pk_bf16_f32 v26, v28, v29
    v_cvt_pk_bf16_f32 v27, v30, v31
    v_cvt_pk_bf16_f32 v32, v32, v33
    v_cvt_pk_bf16_f32 v33, v34, v35
    s_nop 1
    v_permlane16_swap_b32 v16, v18
    v_permlane16_swap_b32 v17, v19
    v_permlane16_swap_b32 v24, v26
    v_permlane16_swap_b32 v25, v27
    v_and_b32 v9, 1, v3
    v_lshlrev_b32 v9, 5, v9
    v_lshrrev_b32 v11, 1, v3
    v_lshl_add_u32 v9, v11, 4, v9
    v_lshlrev_b32 v11, 3, v3
    v_sub_u32 v11, v10, v11
    v_add_u32 v11, v11, v9
    buffer_store_dwordx4 v[16:19], v11, s[24:27], s47 offen offset:0
    buffer_store_dwordx4 v[24:27], v11, s[24:27], s47 offen offset:64
    buffer_store_dwordx2 v[32:33], v10, s[24:27], s47 offen offset:128
    s_waitcnt vmcnt(0) lgkmcnt(0)
    s_endpgm
k2_end:
    s_endpgm
CODE_END:
    s_endpgm
.section .rodata,"a"
.p2align 6
.amdhsa_kernel k1_kernel
  .amdhsa_next_free_vgpr 256
  .amdhsa_next_free_sgpr 72
  .amdhsa_accum_offset 256
  .amdhsa_group_segment_fixed_size 0
  .amdhsa_kernarg_size 128
  .amdhsa_user_sgpr_count 2
  .amdhsa_user_sgpr_kernarg_segment_ptr 1
  .amdhsa_system_sgpr_workgroup_id_x 1
  .amdhsa_float_denorm_mode_32 3
.end_amdhsa_kernel
.p2align 6
.amdhsa_kernel k2_kernel
  .amdhsa_next_free_vgpr 512
  .amdhsa_next_free_sgpr 102
  .amdhsa_accum_offset 256
  .amdhsa_group_segment_fixed_size 0
  .amdhsa_kernarg_size 128
  .amdhsa_user_sgpr_count 2
  .amdhsa_user_sgpr_kernarg_segment_ptr 1
  .amdhsa_system_sgpr_workgroup_id_x 1
  .amdhsa_float_denorm_mode_32 3
.end_amdhsa_kernel
```

```asm
; @launch kernel=k1_kernel grid=(352,1,1) block=(256,1,1) lds=48128
; @launch kernel=k2_kernel grid=(256,1,1) block=(256,1,1) lds=163840
.amdgcn_target "amdgcn-amd-amdhsa--gfx950"
.text
.globl k1_kernel
.p2align 8
.type k1_kernel,@function
k1_kernel:
    s_cmp_ge_u32 s2, 352
    s_cbranch_scc1 k1_end
    s_load_dwordx4 s[4:7], s[0:1], 32
    s_load_dwordx2 s[10:11], s[0:1], 120
    s_load_dwordx4 s[12:15], s[0:1], 8
    s_load_dwordx2 s[8:9], s[0:1], 24
    v_lshrrev_b32 v2, 6, v0
    v_and_b32 v1, 63, v0
    v_readfirstlane_b32 s20, v2
    s_sub_u32 s54, s2, 160
    s_cmp_ge_u32 s2, 256
    s_cbranch_scc1 k1_side
    s_and_b32 s55, s2, 7
    s_lshr_b32 s56, s2, 3
    s_lshl_b32 s57, s55, 9
    s_add_u32 s57, s57, 9056256
    v_mov_b32 v250, 0
    s_waitcnt lgkmcnt(0)
    s_mov_b32 s28, s10
    s_mov_b32 s29, s11
    s_mov_b32 s30, 268435456
    s_mov_b32 s31, 0x00020000
    s_mov_b32 s16, s12
    s_mov_b32 s17, s13
    s_mov_b32 s18, 2621440
    s_mov_b32 s19, 0x00020000
    s_mov_b32 s40, s14
    s_mov_b32 s41, s15
    s_mov_b32 s42, 2621440
    s_mov_b32 s43, 0x00020000
    s_mov_b32 s44, s8
    s_mov_b32 s45, s9
    s_mov_b32 s46, 5120
    s_mov_b32 s47, 0x00020000
    v_mul_u32_u24 v4, 3277, v0
    v_lshrrev_b32 v4, 16, v4
    v_mul_u32_u24 v5, 20, v4
    v_sub_u32 v5, v0, v5
    s_lshl_b32 s21, s56, 6
    v_lshl_add_u32 v6, v4, 3, s21
    v_mul_u32_u24 v6, 1280, v6
    s_mul_i32 s22, s55, 160
    v_lshl_add_u32 v7, v5, 3, s22
    v_add_u32 v6, v6, v7
    v_subrev_u32 v8, 3840, v6
    v_add_u32 v9, 5120, v6
    s_movk_i32 s23, 160
    v_cmp_gt_u32 vcc, s23, v0
    s_and_saveexec_b64 s[60:61], vcc
    s_cbranch_execz k1_kvld
    buffer_load_dwordx2 v[10:11], v8, s[16:19], 0 offen offset:0
    buffer_load_dwordx2 v[12:13], v8, s[16:19], 0 offen offset:1280
    buffer_load_dwordx2 v[14:15], v8, s[16:19], 0 offen offset:2560
    buffer_load_dwordx2 v[16:17], v6, s[16:19], 0 offen offset:0
    buffer_load_dwordx2 v[18:19], v6, s[16:19], 0 offen offset:1280
    buffer_load_dwordx2 v[20:21], v6, s[16:19], 0 offen offset:2560
    buffer_load_dwordx2 v[22:23], v6, s[16:19], 0 offen offset:3840
    buffer_load_dwordx2 v[24:25], v9, s[16:19], 0 offen offset:0
    buffer_load_dwordx2 v[26:27], v9, s[16:19], 0 offen offset:1280
    buffer_load_dwordx2 v[28:29], v9, s[16:19], 0 offen offset:2560
    buffer_load_dwordx2 v[30:31], v9, s[16:19], 0 offen offset:3840
    v_lshlrev_b32 v150, 2, v7
    buffer_load_dwordx4 v[48:51], v150, s[44:47], 0 offen
    buffer_load_dwordx4 v[52:55], v150, s[44:47], 0 offen offset:16
    buffer_load_dwordx2 v[32:33], v6, s[40:43], 0 offen offset:0
    buffer_load_dwordx2 v[34:35], v6, s[40:43], 0 offen offset:1280
    buffer_load_dwordx2 v[36:37], v6, s[40:43], 0 offen offset:2560
    buffer_load_dwordx2 v[38:39], v6, s[40:43], 0 offen offset:3840
    buffer_load_dwordx2 v[40:41], v9, s[40:43], 0 offen offset:0
    buffer_load_dwordx2 v[42:43], v9, s[40:43], 0 offen offset:1280
    buffer_load_dwordx2 v[44:45], v9, s[40:43], 0 offen offset:2560
    buffer_load_dwordx2 v[46:47], v9, s[40:43], 0 offen offset:3840
k1_kvld:
    s_mov_b64 exec, -1
    buffer_load_dword v251, v250, s[28:31], s57 offen sc1
    v_and_b32 v249, 31, v1
    v_lshlrev_b32 v249, 2, v249
    buffer_load_dword v249, v249, s[28:31], s57 offen offset:256 sc1
    s_getpc_b64 s[62:63]
    s_lshl_b32 s64, s20, 10
    s_add_u32 s65, s64, 0
    v_lshlrev_b32 v247, 4, v1
    v_add_u32 v247, s65, v247
    global_load_dwordx4 v[240:243], v247, s[62:63]
    s_add_u32 s65, s64, 4096
    v_lshlrev_b32 v247, 4, v1
    v_add_u32 v247, s65, v247
    global_load_dwordx4 v[240:243], v247, s[62:63]
    s_mov_b32 s24, s4
    s_mov_b32 s25, s5
    s_mov_b32 s26, 2621440
    s_mov_b32 s27, 0x00020000
    s_cmp_lt_u32 s56, 12
    s_cbranch_scc1 k1_kernel_nc1
    s_mul_i32 s58, s55, 20
    s_add_u32 s58, s58, s56
    s_sub_u32 s58, s58, 12
    s_lshl_b32 s21, s58, 3
    s_add_u32 s22, s6, s21
    s_addc_u32 s23, s7, 0
    s_load_dwordx2 s[32:33], s[22:23], 0
    s_lshl_b32 s21, s58, 2
    s_add_u32 s21, s21, s20
    s_mul_i32 s34, s20, 9472
    v_lshlrev_b32 v3, 4, v1
    s_lshl_b32 s35, s21, 12
    s_add_u32 s36, s34, 256
    s_mov_b32 m0, s36
    s_nop 0
    buffer_load_dwordx4 v3, s[24:27], s35 offen offset:0 lds
    buffer_load_dwordx4 v3, s[24:27], s35 offen offset:1024 lds
    buffer_load_dwordx4 v3, s[24:27], s35 offen offset:2048 lds
    buffer_load_dwordx4 v3, s[24:27], s35 offen offset:3072 lds
k1_kernel_nc1:
    s_mov_b64 exec, s[60:61]
    s_movk_i32 s23, 160
    v_cmp_gt_u32 vcc, s23, v0
    s_and_b64 exec, exec, vcc
    s_cbranch_execz k1_kvskip
    v_sub_u32 v150, 7, v4
    v_and_b32 v151, 7, v5
    v_xor_b32 v150, v150, v151
    v_lshlrev_b32 v150, 4, v150
    v_lshl_add_u32 v150, v5, 9, v150
    v_add_u32 v150, 37888, v150
    s_cmp_lt_u32 s56, 12
    s_cbranch_scc1 k1_w8
    s_waitcnt vmcnt(16)
    s_branch k1_w9
k1_w8:
    s_waitcnt vmcnt(12)
k1_w9:
    v_lshlrev_b32 v56, 16, v48
    v_and_b32 v60, 0xffff0000, v48
    v_lshlrev_b32 v64, 16, v49
    v_and_b32 v68, 0xffff0000, v49
    v_lshlrev_b32 v57, 16, v50
    v_and_b32 v61, 0xffff0000, v50
    v_lshlrev_b32 v65, 16, v51
    v_and_b32 v69, 0xffff0000, v51
    v_lshlrev_b32 v58, 16, v52
    v_and_b32 v62, 0xffff0000, v52
    v_lshlrev_b32 v66, 16, v53
    v_and_b32 v70, 0xffff0000, v53
    v_lshlrev_b32 v59, 16, v54
    v_and_b32 v63, 0xffff0000, v54
    v_lshlrev_b32 v67, 16, v55
    v_and_b32 v71, 0xffff0000, v55
    v_lshlrev_b32 v72, 16, v10
    v_and_b32 v73, 0xffff0000, v10
    v_lshlrev_b32 v74, 16, v11
    v_and_b32 v75, 0xffff0000, v11
    v_lshlrev_b32 v76, 16, v12
    v_and_b32 v77, 0xffff0000, v12
    v_lshlrev_b32 v78, 16, v13
    v_and_b32 v79, 0xffff0000, v13
    v_lshlrev_b32 v80, 16, v14
    v_and_b32 v81, 0xffff0000, v14
    v_lshlrev_b32 v82, 16, v15
    v_and_b32 v83, 0xffff0000, v15
    v_lshlrev_b32 v84, 16, v16
    v_and_b32 v85, 0xffff0000, v16
    v_lshlrev_b32 v86, 16, v17
    v_and_b32 v87, 0xffff0000, v17
    v_lshlrev_b32 v88, 16, v18
    v_and_b32 v89, 0xffff0000, v18
    v_lshlrev_b32 v90, 16, v19
    v_and_b32 v91, 0xffff0000, v19
    v_lshlrev_b32 v92, 16, v20
    v_and_b32 v93, 0xffff0000, v20
    v_lshlrev_b32 v94, 16, v21
    v_and_b32 v95, 0xffff0000, v21
    v_lshlrev_b32 v96, 16, v22
    v_and_b32 v97, 0xffff0000, v22
    v_lshlrev_b32 v98, 16, v23
    v_and_b32 v99, 0xffff0000, v23
    v_lshlrev_b32 v100, 16, v24
    v_and_b32 v101, 0xffff0000, v24
    v_lshlrev_b32 v102, 16, v25
    v_and_b32 v103, 0xffff0000, v25
    v_lshlrev_b32 v104, 16, v26
    v_and_b32 v105, 0xffff0000, v26
    v_lshlrev_b32 v106, 16, v27
    v_and_b32 v107, 0xffff0000, v27
    v_lshlrev_b32 v108, 16, v28
    v_and_b32 v109, 0xffff0000, v28
    v_lshlrev_b32 v110, 16, v29
    v_and_b32 v111, 0xffff0000, v29
    v_lshlrev_b32 v112, 16, v30
    v_and_b32 v113, 0xffff0000, v30
    v_lshlrev_b32 v114, 16, v31
    v_and_b32 v115, 0xffff0000, v31
    v_pk_mul_f32 v[116:117], v[72:73], v[68:69]
    v_pk_mul_f32 v[120:121], v[76:77], v[68:69]
    v_pk_mul_f32 v[124:125], v[80:81], v[68:69]
    v_pk_mul_f32 v[128:129], v[84:85], v[68:69]
    v_pk_mul_f32 v[132:133], v[88:89], v[68:69]
    v_pk_mul_f32 v[136:137], v[92:93], v[68:69]
    v_pk_mul_f32 v[140:141], v[96:97], v[68:69]
    v_pk_mul_f32 v[144:145], v[100:101], v[68:69]
    v_pk_fma_f32 v[116:117], v[76:77], v[64:65], v[116:117]
    v_pk_fma_f32 v[120:121], v[80:81], v[64:65], v[120:121]
    v_pk_fma_f32 v[124:125], v[84:85], v[64:65], v[124:125]
    v_pk_fma_f32 v[128:129], v[88:89], v[64:65], v[128:129]
    v_pk_fma_f32 v[132:133], v[92:93], v[64:65], v[132:133]
    v_pk_fma_f32 v[136:137], v[96:97], v[64:65], v[136:137]
    v_pk_fma_f32 v[140:141], v[100:101], v[64:65], v[140:141]
    v_pk_fma_f32 v[144:145], v[104:105], v[64:65], v[144:145]
    v_pk_fma_f32 v[116:117], v[80:81], v[60:61], v[116:117]
    v_pk_fma_f32 v[120:121], v[84:85], v[60:61], v[120:121]
    v_pk_fma_f32 v[124:125], v[88:89], v[60:61], v[124:125]
    v_pk_fma_f32 v[128:129], v[92:93], v[60:61], v[128:129]
    v_pk_fma_f32 v[132:133], v[96:97], v[60:61], v[132:133]
    v_pk_fma_f32 v[136:137], v[100:101], v[60:61], v[136:137]
    v_pk_fma_f32 v[140:141], v[104:105], v[60:61], v[140:141]
    v_pk_fma_f32 v[144:145], v[108:109], v[60:61], v[144:145]
    v_pk_fma_f32 v[116:117], v[84:85], v[56:57], v[116:117]
    v_pk_fma_f32 v[120:121], v[88:89], v[56:57], v[120:121]
    v_pk_fma_f32 v[124:125], v[92:93], v[56:57], v[124:125]
    v_pk_fma_f32 v[128:129], v[96:97], v[56:57], v[128:129]
    v_pk_fma_f32 v[132:133], v[100:101], v[56:57], v[132:133]
    v_pk_fma_f32 v[136:137], v[104:105], v[56:57], v[136:137]
    v_pk_fma_f32 v[140:141], v[108:109], v[56:57], v[140:141]
    v_pk_fma_f32 v[144:145], v[112:113], v[56:57], v[144:145]
    v_pk_mul_f32 v[118:119], v[74:75], v[70:71]
    v_pk_mul_f32 v[122:123], v[78:79], v[70:71]
    v_pk_mul_f32 v[126:127], v[82:83], v[70:71]
    v_pk_mul_f32 v[130:131], v[86:87], v[70:71]
    v_pk_mul_f32 v[134:135], v[90:91], v[70:71]
    v_pk_mul_f32 v[138:139], v[94:95], v[70:71]
    v_pk_mul_f32 v[142:143], v[98:99], v[70:71]
    v_pk_mul_f32 v[146:147], v[102:103], v[70:71]
    v_pk_fma_f32 v[118:119], v[78:79], v[66:67], v[118:119]
    v_pk_fma_f32 v[122:123], v[82:83], v[66:67], v[122:123]
    v_pk_fma_f32 v[126:127], v[86:87], v[66:67], v[126:127]
    v_pk_fma_f32 v[130:131], v[90:91], v[66:67], v[130:131]
    v_pk_fma_f32 v[134:135], v[94:95], v[66:67], v[134:135]
    v_pk_fma_f32 v[138:139], v[98:99], v[66:67], v[138:139]
    v_pk_fma_f32 v[142:143], v[102:103], v[66:67], v[142:143]
    v_pk_fma_f32 v[146:147], v[106:107], v[66:67], v[146:147]
    v_pk_fma_f32 v[118:119], v[82:83], v[62:63], v[118:119]
    v_pk_fma_f32 v[122:123], v[86:87], v[62:63], v[122:123]
    v_pk_fma_f32 v[126:127], v[90:91], v[62:63], v[126:127]
    v_pk_fma_f32 v[130:131], v[94:95], v[62:63], v[130:131]
    v_pk_fma_f32 v[134:135], v[98:99], v[62:63], v[134:135]
    v_pk_fma_f32 v[138:139], v[102:103], v[62:63], v[138:139]
    v_pk_fma_f32 v[142:143], v[106:107], v[62:63], v[142:143]
    v_pk_fma_f32 v[146:147], v[110:111], v[62:63], v[146:147]
    v_pk_fma_f32 v[118:119], v[86:87], v[58:59], v[118:119]
    v_pk_fma_f32 v[122:123], v[90:91], v[58:59], v[122:123]
    v_pk_fma_f32 v[126:127], v[94:95], v[58:59], v[126:127]
    v_pk_fma_f32 v[130:131], v[98:99], v[58:59], v[130:131]
    v_pk_fma_f32 v[134:135], v[102:103], v[58:59], v[134:135]
    v_pk_fma_f32 v[138:139], v[106:107], v[58:59], v[138:139]
    v_pk_fma_f32 v[142:143], v[110:111], v[58:59], v[142:143]
    v_pk_fma_f32 v[146:147], v[114:115], v[58:59], v[146:147]
    v_cvt_pk_bf16_f32 v154, v116, v117
    v_lshlrev_b32 v116, 16, v154
    v_and_b32 v117, 0xffff0000, v154
    v_cvt_pk_bf16_f32 v155, v118, v119
    v_lshlrev_b32 v118, 16, v155
    v_and_b32 v119, 0xffff0000, v155
    v_cvt_pk_bf16_f32 v156, v120, v121
    v_lshlrev_b32 v120, 16, v156
    v_and_b32 v121, 0xffff0000, v156
    v_cvt_pk_bf16_f32 v157, v122, v123
    v_lshlrev_b32 v122, 16, v157
    v_and_b32 v123, 0xffff0000, v157
    v_cvt_pk_bf16_f32 v158, v124, v125
    v_lshlrev_b32 v124, 16, v158
    v_and_b32 v125, 0xffff0000, v158
    v_cvt_pk_bf16_f32 v159, v126, v127
    v_lshlrev_b32 v126, 16, v159
    v_and_b32 v127, 0xffff0000, v159
    v_cvt_pk_bf16_f32 v160, v128, v129
    v_lshlrev_b32 v128, 16, v160
    v_and_b32 v129, 0xffff0000, v160
    v_cvt_pk_bf16_f32 v161, v130, v131
    v_lshlrev_b32 v130, 16, v161
    v_and_b32 v131, 0xffff0000, v161
    v_cvt_pk_bf16_f32 v154, v132, v133
    v_lshlrev_b32 v132, 16, v154
    v_and_b32 v133, 0xffff0000, v154
    v_cvt_pk_bf16_f32 v155, v134, v135
    v_lshlrev_b32 v134, 16, v155
    v_and_b32 v135, 0xffff0000, v155
    v_cvt_pk_bf16_f32 v156, v136, v137
    v_lshlrev_b32 v136, 16, v156
    v_and_b32 v137, 0xffff0000, v156
    v_cvt_pk_bf16_f32 v157, v138, v139
    v_lshlrev_b32 v138, 16, v157
    v_and_b32 v139, 0xffff0000, v157
    v_cvt_pk_bf16_f32 v158, v140, v141
    v_lshlrev_b32 v140, 16, v158
    v_and_b32 v141, 0xffff0000, v158
    v_cvt_pk_bf16_f32 v159, v142, v143
    v_lshlrev_b32 v142, 16, v159
    v_and_b32 v143, 0xffff0000, v159
    v_cvt_pk_bf16_f32 v160, v144, v145
    v_lshlrev_b32 v144, 16, v160
    v_and_b32 v145, 0xffff0000, v160
    v_cvt_pk_bf16_f32 v161, v146, v147
    v_lshlrev_b32 v146, 16, v161
    v_and_b32 v147, 0xffff0000, v161
    s_cmp_lt_u32 s56, 12
    s_cbranch_scc1 k1_w0
    s_waitcnt vmcnt(8)
    s_branch k1_w1
k1_w0:
    s_waitcnt vmcnt(4)
k1_w1:
    v_lshlrev_b32 v72, 16, v32
    v_and_b32 v73, 0xffff0000, v32
    v_lshlrev_b32 v74, 16, v33
    v_and_b32 v75, 0xffff0000, v33
    v_lshlrev_b32 v76, 16, v34
    v_and_b32 v77, 0xffff0000, v34
    v_lshlrev_b32 v78, 16, v35
    v_and_b32 v79, 0xffff0000, v35
    v_lshlrev_b32 v80, 16, v36
    v_and_b32 v81, 0xffff0000, v36
    v_lshlrev_b32 v82, 16, v37
    v_and_b32 v83, 0xffff0000, v37
    v_lshlrev_b32 v84, 16, v38
    v_and_b32 v85, 0xffff0000, v38
    v_lshlrev_b32 v86, 16, v39
    v_and_b32 v87, 0xffff0000, v39
    v_lshlrev_b32 v88, 16, v40
    v_and_b32 v89, 0xffff0000, v40
    v_lshlrev_b32 v90, 16, v41
    v_and_b32 v91, 0xffff0000, v41
    v_lshlrev_b32 v92, 16, v42
    v_and_b32 v93, 0xffff0000, v42
    v_lshlrev_b32 v94, 16, v43
    v_and_b32 v95, 0xffff0000, v43
    v_lshlrev_b32 v96, 16, v44
    v_and_b32 v97, 0xffff0000, v44
    v_lshlrev_b32 v98, 16, v45
    v_and_b32 v99, 0xffff0000, v45
    v_lshlrev_b32 v100, 16, v46
    v_and_b32 v101, 0xffff0000, v46
    v_lshlrev_b32 v102, 16, v47
    v_and_b32 v103, 0xffff0000, v47
    v_pk_mul_f32 v[116:117], v[116:117], v[72:73]
    v_pk_mul_f32 v[118:119], v[118:119], v[74:75]
    v_pk_mul_f32 v[120:121], v[120:121], v[76:77]
    v_pk_mul_f32 v[122:123], v[122:123], v[78:79]
    v_pk_mul_f32 v[124:125], v[124:125], v[80:81]
    v_pk_mul_f32 v[126:127], v[126:127], v[82:83]
    v_pk_mul_f32 v[128:129], v[128:129], v[84:85]
    v_pk_mul_f32 v[130:131], v[130:131], v[86:87]
    v_pk_mul_f32 v[132:133], v[132:133], v[88:89]
    v_pk_mul_f32 v[134:135], v[134:135], v[90:91]
    v_pk_mul_f32 v[136:137], v[136:137], v[92:93]
    v_pk_mul_f32 v[138:139], v[138:139], v[94:95]
    v_pk_mul_f32 v[140:141], v[140:141], v[96:97]
    v_pk_mul_f32 v[142:143], v[142:143], v[98:99]
    v_pk_mul_f32 v[144:145], v[144:145], v[100:101]
    v_pk_mul_f32 v[146:147], v[146:147], v[102:103]
    v_cvt_pk_bf16_f32 v10, v144, v140
    v_cvt_pk_bf16_f32 v11, v136, v132
    v_cvt_pk_bf16_f32 v12, v128, v124
    v_cvt_pk_bf16_f32 v13, v120, v116
    v_cvt_pk_bf16_f32 v14, v145, v141
    v_cvt_pk_bf16_f32 v15, v137, v133
    v_cvt_pk_bf16_f32 v16, v129, v125
    v_cvt_pk_bf16_f32 v17, v121, v117
    v_cvt_pk_bf16_f32 v18, v146, v142
    v_cvt_pk_bf16_f32 v19, v138, v134
    v_cvt_pk_bf16_f32 v20, v130, v126
    v_cvt_pk_bf16_f32 v21, v122, v118
    v_cvt_pk_bf16_f32 v22, v147, v143
    v_cvt_pk_bf16_f32 v23, v139, v135
    v_cvt_pk_bf16_f32 v24, v131, v127
    v_cvt_pk_bf16_f32 v25, v123, v119
    ds_write_b128 v150, v[10:13] offset:0
    ds_write_b128 v150, v[14:17] offset:128
    ds_write_b128 v150, v[18:21] offset:256
    ds_write_b128 v150, v[22:25] offset:384
k1_kvskip:
    s_mov_b64 exec, -1
    v_lshrrev_b32 v151, 3, v0
    v_and_b32 v152, 7, v0
    v_lshrrev_b32 v153, 2, v151
    v_and_b32 v153, 7, v153
    v_xor_b32 v153, v153, v152
    v_lshlrev_b32 v153, 4, v153
    v_lshl_add_u32 v153, v151, 7, v153
    v_add_u32 v153, 37888, v153
    v_mul_u32_u24 v151, 4224, v151
    v_lshl_add_u32 v154, v152, 4, v151
    s_mul_i32 s36, s55, 337920
    s_add_u32 s36, s36, 0
    s_lshl_b32 s37, s56, 7
    s_sub_u32 s38, 3968, s37
    s_add_u32 s38, s38, s36
    s_waitcnt lgkmcnt(0)
    s_barrier
    ds_read_b128 v[32:35], v153 offset:0
    ds_read_b128 v[36:39], v153 offset:4096
    ds_read_b128 v[40:43], v153 offset:8192
    s_waitcnt lgkmcnt(2)
    buffer_store_dwordx4 v[32:35], v154, s[28:31], s38 offen sc1
    s_add_u32 s38, s38, 135168
    s_waitcnt lgkmcnt(1)
    buffer_store_dwordx4 v[36:39], v154, s[28:31], s38 offen sc1
    s_add_u32 s38, s38, 135168
    s_movk_i32 s23, 128
    v_cmp_gt_u32 vcc, s23, v0
    s_and_saveexec_b64 s[60:61], vcc
    s_cbranch_execz k1_st2skip
    s_waitcnt lgkmcnt(0)
    buffer_store_dwordx4 v[40:43], v154, s[28:31], s38 offen sc1
    s_add_u32 s38, s38, 135168
k1_st2skip:
    s_mov_b64 exec, -1
    s_cmp_lg_u32 s56, 0
    s_cbranch_scc1 k1_kernel_L2
    v_mov_b32 v44, 0
    v_mov_b32 v45, 0
    v_mov_b32 v46, 0
    v_mov_b32 v47, 0
    s_add_u32 s36, s36, 4096
    buffer_store_dwordx4 v[44:47], v154, s[28:31], s36 offen sc1
    s_add_u32 s36, s36, 135168
    buffer_store_dwordx4 v[44:47], v154, s[28:31], s36 offen sc1
    s_add_u32 s36, s36, 135168
    s_movk_i32 s23, 128
    v_cmp_gt_u32 vcc, s23, v0
    s_and_b64 exec, exec, vcc
    s_cbranch_execz k1_kernel_L2
    buffer_store_dwordx4 v[44:47], v154, s[28:31], s36 offen sc1
    s_add_u32 s36, s36, 135168
k1_kernel_L2:
    s_mov_b64 exec, -1
    s_waitcnt vmcnt(0)
    v_add_u32 v251, 1, v251
    s_barrier
    s_cmp_lg_u32 s20, 0
    s_cbranch_scc1 k1_kernel_kf3
    s_lshl_b32 s23, s56, 2
    s_add_u32 s23, s23, s57
    s_mov_b64 exec, 1
    buffer_store_dword v251, v250, s[28:31], s23 offen offset:256
    buffer_store_dword v251, v250, s[28:31], s23 offen offset:128 sc1
    s_mov_b64 exec, -1
k1_kernel_kf3:
    s_lshl_b32 s54, s56, 3
    s_add_u32 s54, s54, s55
    s_cmp_lt_u32 s56, 12
    s_cbranch_scc1 k1_side2
    s_mov_b32 s2, s58
    s_setprio 3
    s_lshl_b32 s21, s2, 2
    s_add_u32 s21, s21, s20
    s_mul_i32 s34, s20, 9472
    v_lshlrev_b32 v3, 4, v1
    s_mul_i32 s37, s21, 4224
    s_add_u32 s37, s37, 0
    v_lshrrev_b32 v4, 3, v0
    v_mul_u32_u24 v4, 20480, v4
    s_lshr_b32 s38, s2, 1
    s_and_b32 s38, s38, 7
    v_and_b32 v5, 7, v0
    v_xor_b32 v5, s38, v5
    v_lshl_add_u32 v4, v5, 4, v4
    s_lshl_b32 s38, s2, 7
    v_add_u32 v20, 0, v1
    v_mul_u32_u24 v21, 3856, v20
    v_lshrrev_b32 v21, 16, v21
    v_mul_u32_u24 v22, 17, v21
    v_sub_u32 v22, v20, v22
    v_lshlrev_b32 v22, 4, v22
    v_lshlrev_b32 v21, 8, v21
    v_sub_u32 v22, v22, v21
    v_add_u32 v23, 3840, v22
    v_add_u32 v20, 64, v1
    v_mul_u32_u24 v21, 3856, v20
    v_lshrrev_b32 v21, 16, v21
    v_mul_u32_u24 v22, 17, v21
    v_sub_u32 v22, v20, v22
    v_lshlrev_b32 v22, 4, v22
    v_lshlrev_b32 v21, 8, v21
    v_sub_u32 v22, v22, v21
    v_add_u32 v24, 3840, v22
    v_add_u32 v20, 128, v1
    v_mul_u32_u24 v21, 3856, v20
    v_lshrrev_b32 v21, 16, v21
    v_mul_u32_u24 v22, 17, v21
    v_sub_u32 v22, v20, v22
    v_lshlrev_b32 v22, 4, v22
    v_lshlrev_b32 v21, 8, v21
    v_sub_u32 v22, v22, v21
    v_add_u32 v25, 3840, v22
    v_add_u32 v20, 192, v1
    v_mul_u32_u24 v21, 3856, v20
    v_lshrrev_b32 v21, 16, v21
    v_mul_u32_u24 v22, 17, v21
    v_sub_u32 v22, v20, v22
    v_lshlrev_b32 v22, 4, v22
    v_lshlrev_b32 v21, 8, v21
    v_sub_u32 v22, v22, v21
    v_add_u32 v26, 3840, v22
    v_add_u32 v20, 256, v1
    v_mul_u32_u24 v21, 3856, v20
    v_lshrrev_b32 v21, 16, v21
    v_mul_u32_u24 v22, 17, v21
    v_sub_u32 v22, v20, v22
    v_lshlrev_b32 v22, 4, v22
    v_lshlrev_b32 v21, 8, v21
    v_sub_u32 v22, v22, v21
    v_add_u32 v27, 3840, v22
    v_lshl_add_u32 v5, v1, 2, s34
    v_mov_b32 v6, 0
    ds_write_b32 v5, v6
    v_and_b32 v7, 15, v1
    v_bfe_u32 v8, v1, 4, 1
    v_lshrrev_b32 v9, 5, v1
    v_mul_u32_u24 v10, 272, v7
    v_lshl_add_u32 v10, v9, 4, v10
    v_add_u32 v10, s34, v10
    v_add_u32 v10, 4356, v10
    v_lshlrev_b32 v11, 2, v8
    v_sub_u32 v10, v10, v11
    v_and_b32 v12, 7, v1
    v_mul_u32_u24 v13, 272, v12
    v_lshl_add_u32 v13, v9, 4, v13
    v_add_u32 v13, s34, v13
    v_add_u32 v13, 4356, v13
    v_sub_u32 v13, v13, v11
    v_bfe_u32 v11, v1, 3, 1
    v_lshlrev_b32 v11, 4, v11
    v_sub_u32 v11, 16, v11
    v_and_b32 v14, 31, v1
    v_lshlrev_b32 v14, 3, v14
    v_lshl_add_u32 v14, v9, 4, v14
    v_add_u32 v14, s34, v14
    v_add_u32 v14, 8, v14
    v_cmp_ne_u32 vcc, 0, v12
    v_mov_b32 v16, 0
    s_nop 1
    v_cndmask_b32 v15, v16, -1, vcc
    s_waitcnt lgkmcnt(0)
    ds_read_b64 v[176:177], v14 offset:1792
    ds_read_b64 v[178:179], v14 offset:1800
    ds_read_b64 v[180:181], v14 offset:1824
    ds_read_b64 v[182:183], v14 offset:1832
    ds_read_b64 v[184:185], v14 offset:1856
    ds_read_b64 v[186:187], v14 offset:1864
    ds_read_b64 v[188:189], v14 offset:1888
    ds_read_b64 v[190:191], v14 offset:1896
    ds_read_b64 v[192:193], v14 offset:1920
    ds_read_b64 v[194:195], v14 offset:1928
    ds_read_b64 v[196:197], v14 offset:1952
    ds_read_b64 v[198:199], v14 offset:1960
    ds_read_b64 v[200:201], v14 offset:1984
    ds_read_b64 v[202:203], v14 offset:1992
    ds_read_b64 v[204:205], v14 offset:2016
    ds_read_b64 v[206:207], v14 offset:2024
    s_cmp_lg_u32 s20, 0
    s_cbranch_scc1 k1_kernel_kw4
    v_and_b32 v40, 31, v1
    v_lshlrev_b32 v40, 2, v40
    s_mov_b32 s23, 200000
    s_mov_b64 s[60:61], 0
k1_kernel_kp5:
    buffer_load_dword v41, v40, s[28:31], s57 offen offset:256 sc1
    s_waitcnt vmcnt(0)
    v_cmp_eq_u32 vcc, v251, v41
    s_sub_u32 s23, s23, 1
    s_or_b64 s[60:61], s[60:61], vcc
    s_cmp_eq_u64 s[60:61], -1
    s_cbranch_scc1 k1_kernel_kd6
    s_and_b32 s21, s23, 3
    s_cmp_lg_u32 s21, 0
    s_cbranch_scc1 k1_kernel_kq8
    buffer_load_dword v41, v40, s[28:31], s57 offen offset:128 sc1
    s_waitcnt vmcnt(0)
    v_cmp_eq_u32 vcc, v251, v41
    s_nop 1
    s_or_b64 s[60:61], s[60:61], vcc
    s_cmp_eq_u64 s[60:61], -1
    s_cbranch_scc1 k1_kernel_kd6
k1_kernel_kq8:
    s_sleep 2
    s_cmp_lg_u32 s23, 0
    s_cbranch_scc1 k1_kernel_kp5
k1_kernel_kd6:
    s_cmp_lg_u32 s56, 12
    s_cbranch_scc1 k1_kernel_kw4
    s_mov_b64 exec, 1
    buffer_store_dword v251, v250, s[28:31], s57 offen sc1
    s_mov_b64 exec, -1
k1_kernel_kw4:
    s_barrier
    s_add_u32 s36, s34, 4352
    s_mov_b32 m0, s36
    s_nop 0
    buffer_load_dwordx4 v23, s[28:31], s37 offen sc1 lds
    s_add_u32 s36, s34, 5376
    s_mov_b32 m0, s36
    s_nop 0
    buffer_load_dwordx4 v24, s[28:31], s37 offen sc1 lds
    s_add_u32 s36, s34, 6400
    s_mov_b32 m0, s36
    s_nop 0
    buffer_load_dwordx4 v25, s[28:31], s37 offen sc1 lds
    s_add_u32 s36, s34, 7424
    s_mov_b32 m0, s36
    s_nop 0
    buffer_load_dwordx4 v26, s[28:31], s37 offen sc1 lds
    s_add_u32 s36, s34, 8448
    s_mov_b32 m0, s36
    s_mov_b64 exec, 0xffff
    buffer_load_dwordx4 v27, s[28:31], s37 offen sc1 lds
    s_mov_b64 exec, -1
    s_waitcnt vmcnt(0) lgkmcnt(0)
    ds_read2_b32 v[64:65], v10 offset0:0 offset1:1
    ds_read2_b32 v[66:67], v10 offset0:2 offset1:3
    ds_read2_b32 v[68:69], v10 offset0:8 offset1:9
    ds_read2_b32 v[70:71], v10 offset0:10 offset1:11
    ds_read2_b32 v[72:73], v10 offset0:16 offset1:17
    ds_read2_b32 v[74:75], v10 offset0:18 offset1:19
    ds_read2_b32 v[76:77], v10 offset0:24 offset1:25
    ds_read2_b32 v[78:79], v10 offset0:26 offset1:27
    ds_read2_b32 v[80:81], v10 offset0:32 offset1:33
    ds_read2_b32 v[82:83], v10 offset0:34 offset1:35
    ds_read2_b32 v[84:85], v10 offset0:40 offset1:41
    ds_read2_b32 v[86:87], v10 offset0:42 offset1:43
    ds_read2_b32 v[88:89], v10 offset0:48 offset1:49
    ds_read2_b32 v[90:91], v10 offset0:50 offset1:51
    ds_read2_b32 v[92:93], v10 offset0:56 offset1:57
    ds_read2_b32 v[94:95], v10 offset0:58 offset1:59
    s_waitcnt lgkmcnt(0)
    v_mfma_f32_32x32x16_bf16 v[144:159], v[176:179], v[64:67], 0
    ds_read_b32 v16, v10 offset:16
    ds_read_b32 v17, v10 offset:48
    ds_read_b32 v18, v10 offset:80
    ds_read_b32 v19, v10 offset:112
    ds_read_b32 v20, v10 offset:144
    ds_read_b32 v21, v10 offset:176
    ds_read_b32 v22, v10 offset:208
    ds_read_b32 v23, v10 offset:240
    ds_read2_b32 v[96:97], v13 offset0:0 offset1:1
    ds_read2_b32 v[98:99], v13 offset0:2 offset1:3
    ds_read_b32 v24, v13 offset:16
    ds_read2_b32 v[100:101], v13 offset0:8 offset1:9
    ds_read2_b32 v[102:103], v13 offset0:10 offset1:11
    ds_read_b32 v25, v13 offset:48
    ds_read2_b32 v[104:105], v13 offset0:16 offset1:17
    ds_read2_b32 v[106:107], v13 offset0:18 offset1:19
    v_mfma_f32_32x32x16_bf16 v[144:159], v[180:183], v[68:71], v[144:159]
    ds_read_b32 v26, v13 offset:80
    ds_read2_b32 v[108:109], v13 offset0:24 offset1:25
    ds_read2_b32 v[110:111], v13 offset0:26 offset1:27
    ds_read_b32 v27, v13 offset:112
    ds_read2_b32 v[112:113], v13 offset0:32 offset1:33
    ds_read2_b32 v[114:115], v13 offset0:34 offset1:35
    ds_read_b32 v28, v13 offset:144
    ds_read2_b32 v[116:117], v13 offset0:40 offset1:41
    ds_read2_b32 v[118:119], v13 offset0:42 offset1:43
    ds_read_b32 v29, v13 offset:176
    ds_read2_b32 v[120:121], v13 offset0:48 offset1:49
    ds_read2_b32 v[122:123], v13 offset0:50 offset1:51
    ds_read_b32 v30, v13 offset:208
    ds_read2_b32 v[124:125], v13 offset0:56 offset1:57
    ds_read2_b32 v[126:127], v13 offset0:58 offset1:59
    ds_read_b32 v31, v13 offset:240
    v_mfma_f32_32x32x16_bf16 v[144:159], v[184:187], v[72:75], v[144:159]
    s_waitcnt lgkmcnt(15)
    s_waitcnt lgkmcnt(0)
    v_alignbit_b32 v32, v65, v64, 16
    v_alignbit_b32 v33, v66, v65, 16
    v_alignbit_b32 v34, v67, v66, 16
    v_alignbit_b32 v35, v16, v67, 16
    v_mfma_f32_32x32x16_bf16 v[144:159], v[188:191], v[76:79], v[144:159]
    v_alignbit_b32 v36, v69, v68, 16
    v_alignbit_b32 v37, v70, v69, 16
    v_alignbit_b32 v38, v71, v70, 16
    v_alignbit_b32 v39, v17, v71, 16
    v_alignbit_b32 v40, v73, v72, 16
    v_alignbit_b32 v41, v74, v73, 16
    v_mfma_f32_32x32x16_bf16 v[144:159], v[192:195], v[80:83], v[144:159]
    v_alignbit_b32 v42, v75, v74, 16
    v_alignbit_b32 v43, v18, v75, 16
    v_alignbit_b32 v44, v77, v76, 16
    v_alignbit_b32 v45, v78, v77, 16
    v_alignbit_b32 v46, v79, v78, 16
    v_alignbit_b32 v47, v19, v79, 16
    v_mfma_f32_32x32x16_bf16 v[144:159], v[196:199], v[84:87], v[144:159]
    v_alignbit_b32 v48, v81, v80, 16
    v_alignbit_b32 v49, v82, v81, 16
    v_alignbit_b32 v50, v83, v82, 16
    v_alignbit_b32 v51, v20, v83, 16
    v_alignbit_b32 v52, v85, v84, 16
    v_alignbit_b32 v53, v86, v85, 16
    v_mfma_f32_32x32x16_bf16 v[144:159], v[200:203], v[88:91], v[144:159]
    v_alignbit_b32 v54, v87, v86, 16
    v_alignbit_b32 v55, v21, v87, 16
    v_alignbit_b32 v56, v89, v88, 16
    v_alignbit_b32 v57, v90, v89, 16
    v_alignbit_b32 v58, v91, v90, 16
    v_alignbit_b32 v59, v22, v91, 16
    v_mfma_f32_32x32x16_bf16 v[144:159], v[204:207], v[92:95], v[144:159]
    v_alignbit_b32 v60, v93, v92, 16
    v_alignbit_b32 v61, v94, v93, 16
    v_alignbit_b32 v62, v95, v94, 16
    v_alignbit_b32 v63, v23, v95, 16
    s_nop 0
    v_mfma_f32_32x32x16_bf16 v[128:143], v[176:179], v[32:35], 0
    ds_read_b64 v[208:209], v14 offset:3840
    ds_read_b64 v[210:211], v14 offset:3848
    s_nop 2
    v_mfma_f32_32x32x16_bf16 v[128:143], v[180:183], v[36:39], v[128:143]
    ds_read_b64 v[212:213], v14 offset:3872
    ds_read_b64 v[214:215], v14 offset:3880
    s_nop 2
    v_mfma_f32_32x32x16_bf16 v[128:143], v[184:187], v[40:43], v[128:143]
    ds_read_b64 v[216:217], v14 offset:3904
    ds_read_b64 v[218:219], v14 offset:3912
    v_alignbit_b32 v96, v97, v96, v11
    v_alignbit_b32 v97, v98, v97, v11
    v_alignbit_b32 v98, v99, v98, v11
    v_alignbit_b32 v99, v24, v99, v11
    v_alignbit_b32 v100, v101, v100, v11
    v_alignbit_b32 v101, v102, v101, v11
    v_alignbit_b32 v102, v103, v102, v11
    v_alignbit_b32 v103, v25, v103, v11
    v_alignbit_b32 v104, v105, v104, v11
    v_mfma_f32_32x32x16_bf16 v[128:143], v[188:191], v[44:47], v[128:143]
    ds_read_b64 v[220:221], v14 offset:3936
    ds_read_b64 v[222:223], v14 offset:3944
    v_alignbit_b32 v105, v106, v105, v11
    v_alignbit_b32 v106, v107, v106, v11
    v_alignbit_b32 v107, v26, v107, v11
    v_alignbit_b32 v108, v109, v108, v11
    v_alignbit_b32 v109, v110, v109, v11
    v_alignbit_b32 v110, v111, v110, v11
    v_alignbit_b32 v111, v27, v111, v11
    v_mov_b32_dpp v144, v144 row_shr:1 row_mask:0xf bank_mask:0xf bound_ctrl:0
    v_mfma_f32_32x32x16_bf16 v[128:143], v[192:195], v[48:51], v[128:143]
    ds_read_b64 v[224:225], v14 offset:3968
    ds_read_b64 v[226:227], v14 offset:3976
    v_mov_b32_dpp v145, v145 row_shr:1 row_mask:0xf bank_mask:0xf bound_ctrl:0
    v_mov_b32_dpp v146, v146 row_shr:1 row_mask:0xf bank_mask:0xf bound_ctrl:0
    v_mov_b32_dpp v147, v147 row_shr:1 row_mask:0xf bank_mask:0xf bound_ctrl:0
    v_mov_b32_dpp v148, v148 row_shr:1 row_mask:0xf bank_mask:0xf bound_ctrl:0
    v_mov_b32_dpp v149, v149 row_shr:1 row_mask:0xf bank_mask:0xf bound_ctrl:0
    v_mov_b32_dpp v150, v150 row_shr:1 row_mask:0xf bank_mask:0xf bound_ctrl:0
    v_mov_b32_dpp v151, v151 row_shr:1 row_mask:0xf bank_mask:0xf bound_ctrl:0
    v_mov_b32_dpp v152, v152 row_shr:1 row_mask:0xf bank_mask:0xf bound_ctrl:0
    v_mfma_f32_32x32x16_bf16 v[128:143], v[196:199], v[52:55], v[128:143]
    ds_read_b64 v[228:229], v14 offset:4000
    ds_read_b64 v[230:231], v14 offset:4008
    v_mov_b32_dpp v153, v153 row_shr:1 row_mask:0xf bank_mask:0xf bound_ctrl:0
    v_mov_b32_dpp v154, v154 row_shr:1 row_mask:0xf bank_mask:0xf bound_ctrl:0
    v_mov_b32_dpp v155, v155 row_shr:1 row_mask:0xf bank_mask:0xf bound_ctrl:0
    v_mov_b32_dpp v156, v156 row_shr:1 row_mask:0xf bank_mask:0xf bound_ctrl:0
    v_mov_b32_dpp v157, v157 row_shr:1 row_mask:0xf bank_mask:0xf bound_ctrl:0
    v_mov_b32_dpp v158, v158 row_shr:1 row_mask:0xf bank_mask:0xf bound_ctrl:0
    v_mov_b32_dpp v159, v159 row_shr:1 row_mask:0xf bank_mask:0xf bound_ctrl:0
    v_alignbit_b32 v112, v113, v112, v11
    v_mfma_f32_32x32x16_bf16 v[128:143], v[200:203], v[56:59], v[128:143]
    ds_read_b64 v[232:233], v14 offset:4032
    ds_read_b64 v[234:235], v14 offset:4040
    v_alignbit_b32 v113, v114, v113, v11
    v_alignbit_b32 v114, v115, v114, v11
    v_alignbit_b32 v115, v28, v115, v11
    v_alignbit_b32 v116, v117, v116, v11
    v_alignbit_b32 v117, v118, v117, v11
    v_alignbit_b32 v118, v119, v118, v11
    v_alignbit_b32 v119, v29, v119, v11
    v_alignbit_b32 v120, v121, v120, v11
    v_mfma_f32_32x32x16_bf16 v[128:143], v[204:207], v[60:63], v[128:143]
    ds_read_b64 v[236:237], v14 offset:4064
    ds_read_b64 v[238:239], v14 offset:4072
    v_alignbit_b32 v121, v122, v121, v11
    v_alignbit_b32 v122, v123, v122, v11
    v_alignbit_b32 v123, v30, v123, v11
    v_alignbit_b32 v124, v125, v124, v11
    v_alignbit_b32 v125, v126, v125, v11
    v_alignbit_b32 v126, v127, v126, v11
    v_alignbit_b32 v127, v31, v127, v11
    s_nop 0
    s_waitcnt lgkmcnt(0)
    v_mfma_f32_32x32x16_bf16 v[160:175], v[208:211], v[96:99], 0
    ds_read_b64 v[176:177], v14 offset:1536
    ds_read_b64 v[178:179], v14 offset:1544
    ds_read_b64 v[180:181], v14 offset:1568
    ds_read_b64 v[182:183], v14 offset:1576
    s_nop 0
    v_mfma_f32_32x32x16_bf16 v[160:175], v[212:215], v[100:103], v[160:175]
    ds_read_b64 v[184:185], v14 offset:1600
    ds_read_b64 v[186:187], v14 offset:1608
    ds_read_b64 v[188:189], v14 offset:1632
    s_nop 1
    v_mfma_f32_32x32x16_bf16 v[160:175], v[216:219], v[104:107], v[160:175]
    ds_read_b64 v[190:191], v14 offset:1640
    ds_read_b64 v[192:193], v14 offset:1664
    ds_read_b64 v[194:195], v14 offset:1672
    v_mov_b32_dpp v128, v128 row_shr:1 row_mask:0xf bank_mask:0xf bound_ctrl:0
    v_mov_b32_dpp v129, v129 row_shr:1 row_mask:0xf bank_mask:0xf bound_ctrl:0
    v_mov_b32_dpp v130, v130 row_shr:1 row_mask:0xf bank_mask:0xf bound_ctrl:0
    v_mfma_f32_32x32x16_bf16 v[160:175], v[220:223], v[108:111], v[160:175]
    ds_read_b64 v[196:197], v14 offset:1696
    ds_read_b64 v[198:199], v14 offset:1704
    ds_read_b64 v[200:201], v14 offset:1728
    v_mov_b32_dpp v131, v131 row_shr:1 row_mask:0xf bank_mask:0xf bound_ctrl:0
    v_mov_b32_dpp v132, v132 row_shr:1 row_mask:0xf bank_mask:0xf bound_ctrl:0
    v_mov_b32_dpp v133, v133 row_shr:1 row_mask:0xf bank_mask:0xf bound_ctrl:0
    v_mfma_f32_32x32x16_bf16 v[160:175], v[224:227], v[112:115], v[160:175]
    ds_read_b64 v[202:203], v14 offset:1736
    ds_read_b64 v[204:205], v14 offset:1760
    ds_read_b64 v[206:207], v14 offset:1768
    v_mov_b32_dpp v134, v134 row_shr:1 row_mask:0xf bank_mask:0xf bound_ctrl:0
    v_mov_b32_dpp v135, v135 row_shr:1 row_mask:0xf bank_mask:0xf bound_ctrl:0
    v_mov_b32_dpp v136, v136 row_shr:1 row_mask:0xf bank_mask:0xf bound_ctrl:0
    v_mfma_f32_32x32x16_bf16 v[160:175], v[228:231], v[116:119], v[160:175]
    v_mov_b32_dpp v137, v137 row_shr:1 row_mask:0xf bank_mask:0xf bound_ctrl:0
    v_mov_b32_dpp v138, v138 row_shr:1 row_mask:0xf bank_mask:0xf bound_ctrl:0
    v_mov_b32_dpp v139, v139 row_shr:1 row_mask:0xf bank_mask:0xf bound_ctrl:0
    v_mfma_f32_32x32x16_bf16 v[160:175], v[232:235], v[120:123], v[160:175]
    v_mov_b32_dpp v140, v140 row_shr:1 row_mask:0xf bank_mask:0xf bound_ctrl:0
    v_mov_b32_dpp v141, v141 row_shr:1 row_mask:0xf bank_mask:0xf bound_ctrl:0
    v_mfma_f32_32x32x16_bf16 v[160:175], v[236:239], v[124:127], v[160:175]
    v_mov_b32_dpp v142, v142 row_shr:1 row_mask:0xf bank_mask:0xf bound_ctrl:0
    v_mov_b32_dpp v143, v143 row_shr:1 row_mask:0xf bank_mask:0xf bound_ctrl:0
    s_waitcnt lgkmcnt(0)
    v_mfma_f32_32x32x16_bf16 v[144:159], v[176:179], v[64:67], v[144:159]
    ds_read_b64 v[208:209], v14 offset:3584
    ds_read_b64 v[210:211], v14 offset:3592
    s_nop 2
    v_mfma_f32_32x32x16_bf16 v[144:159], v[180:183], v[68:71], v[144:159]
    ds_read_b64 v[212:213], v14 offset:3616
    ds_read_b64 v[214:215], v14 offset:3624
    s_nop 2
    v_mfma_f32_32x32x16_bf16 v[144:159], v[184:187], v[72:75], v[144:159]
    ds_read_b64 v[216:217], v14 offset:3648
    ds_read_b64 v[218:219], v14 offset:3656
    v_and_b32_dpp v160, v160, v15 row_shr:1 row_mask:0xf bank_mask:0xf bound_ctrl:0
    v_and_b32_dpp v161, v161, v15 row_shr:1 row_mask:0xf bank_mask:0xf bound_ctrl:0
    v_and_b32_dpp v162, v162, v15 row_shr:1 row_mask:0xf bank_mask:0xf bound_ctrl:0
    v_mfma_f32_32x32x16_bf16 v[144:159], v[188:191], v[76:79], v[144:159]
    ds_read_b64 v[220:221], v14 offset:3680
    ds_read_b64 v[222:223], v14 offset:3688
    v_and_b32_dpp v163, v163, v15 row_shr:1 row_mask:0xf bank_mask:0xf bound_ctrl:0
    v_and_b32_dpp v164, v164, v15 row_shr:1 row_mask:0xf bank_mask:0xf bound_ctrl:0
    v_and_b32_dpp v165, v165, v15 row_shr:1 row_mask:0xf bank_mask:0xf bound_ctrl:0
    v_mfma_f32_32x32x16_bf16 v[144:159], v[192:195], v[80:83], v[144:159]
    ds_read_b64 v[224:225], v14 offset:3712
    ds_read_b64 v[226:227], v14 offset:3720
    v_and_b32_dpp v166, v166, v15 row_shr:1 row_mask:0xf bank_mask:0xf bound_ctrl:0
    v_and_b32_dpp v167, v167, v15 row_shr:1 row_mask:0xf bank_mask:0xf bound_ctrl:0
    v_and_b32_dpp v168, v168, v15 row_shr:1 row_mask:0xf bank_mask:0xf bound_ctrl:0
    v_mfma_f32_32x32x16_bf16 v[144:159], v[196:199], v[84:87], v[144:159]
    ds_read_b64 v[228:229], v14 offset:3744
    ds_read_b64 v[230:231], v14 offset:3752
    v_and_b32_dpp v169, v169, v15 row_shr:1 row_mask:0xf bank_mask:0xf bound_ctrl:0
    v_and_b32_dpp v170, v170, v15 row_shr:1 row_mask:0xf bank_mask:0xf bound_ctrl:0
    v_and_b32_dpp v171, v171, v15 row_shr:1 row_mask:0xf bank_mask:0xf bound_ctrl:0
    v_mfma_f32_32x32x16_bf16 v[144:159], v[200:203], v[88:91], v[144:159]
    ds_read_b64 v[232:233], v14 offset:3776
    ds_read_b64 v[234:235], v14 offset:3784
    v_and_b32_dpp v172, v172, v15 row_shr:1 row_mask:0xf bank_mask:0xf bound_ctrl:0
    v_and_b32_dpp v173, v173, v15 row_shr:1 row_mask:0xf bank_mask:0xf bound_ctrl:0
    v_mfma_f32_32x32x16_bf16 v[144:159], v[204:207], v[92:95], v[144:159]
    ds_read_b64 v[236:237], v14 offset:3808
    ds_read_b64 v[238:239], v14 offset:3816
    v_and_b32_dpp v174, v174, v15 row_shr:1 row_mask:0xf bank_mask:0xf bound_ctrl:0
    v_and_b32_dpp v175, v175, v15 row_shr:1 row_mask:0xf bank_mask:0xf bound_ctrl:0
    v_mfma_f32_32x32x16_bf16 v[128:143], v[176:179], v[32:35], v[128:143]
    s_nop 4
    v_mfma_f32_32x32x16_bf16 v[128:143], v[180:183], v[36:39], v[128:143]
    s_nop 4
    v_mfma_f32_32x32x16_bf16 v[128:143], v[184:187], v[40:43], v[128:143]
    v_mov_b32_dpp v144, v144 row_shr:1 row_mask:0xf bank_mask:0xf bound_ctrl:0
    v_mov_b32_dpp v145, v145 row_shr:1 row_mask:0xf bank_mask:0xf bound_ctrl:0
    v_mov_b32_dpp v146, v146 row_shr:1 row_mask:0xf bank_mask:0xf bound_ctrl:0
    v_mfma_f32_32x32x16_bf16 v[128:143], v[188:191], v[44:47], v[128:143]
    v_mov_b32_dpp v147, v147 row_shr:1 row_mask:0xf bank_mask:0xf bound_ctrl:0
    v_mov_b32_dpp v148, v148 row_shr:1 row_mask:0xf bank_mask:0xf bound_ctrl:0
    v_mov_b32_dpp v149, v149 row_shr:1 row_mask:0xf bank_mask:0xf bound_ctrl:0
    v_mfma_f32_32x32x16_bf16 v[128:143], v[192:195], v[48:51], v[128:143]
    v_mov_b32_dpp v150, v150 row_shr:1 row_mask:0xf bank_mask:0xf bound_ctrl:0
    v_mov_b32_dpp v151, v151 row_shr:1 row_mask:0xf bank_mask:0xf bound_ctrl:0
    v_mov_b32_dpp v152, v152 row_shr:1 row_mask:0xf bank_mask:0xf bound_ctrl:0
    v_mfma_f32_32x32x16_bf16 v[128:143], v[196:199], v[52:55], v[128:143]
    v_mov_b32_dpp v153, v153 row_shr:1 row_mask:0xf bank_mask:0xf bound_ctrl:0
    v_mov_b32_dpp v154, v154 row_shr:1 row_mask:0xf bank_mask:0xf bound_ctrl:0
    v_mov_b32_dpp v155, v155 row_shr:1 row_mask:0xf bank_mask:0xf bound_ctrl:0
    v_mfma_f32_32x32x16_bf16 v[128:143], v[200:203], v[56:59], v[128:143]
    v_mov_b32_dpp v156, v156 row_shr:1 row_mask:0xf bank_mask:0xf bound_ctrl:0
    v_mov_b32_dpp v157, v157 row_shr:1 row_mask:0xf bank_mask:0xf bound_ctrl:0
    v_mfma_f32_32x32x16_bf16 v[128:143], v[204:207], v[60:63], v[128:143]
    v_mov_b32_dpp v158, v158 row_shr:1 row_mask:0xf bank_mask:0xf bound_ctrl:0
    v_mov_b32_dpp v159, v159 row_shr:1 row_mask:0xf bank_mask:0xf bound_ctrl:0
    s_waitcnt lgkmcnt(0)
    v_mfma_f32_32x32x16_bf16 v[160:175], v[208:211], v[96:99], v[160:175]
    ds_read_b64 v[176:177], v14 offset:1280
    ds_read_b64 v[178:179], v14 offset:1288
    ds_read_b64 v[180:181], v14 offset:1312
    ds_read_b64 v[182:183], v14 offset:1320
    s_nop 0
    v_mfma_f32_32x32x16_bf16 v[160:175], v[212:215], v[100:103], v[160:175]
    ds_read_b64 v[184:185], v14 offset:1344
    ds_read_b64 v[186:187], v14 offset:1352
    ds_read_b64 v[188:189], v14 offset:1376
    s_nop 1
    v_mfma_f32_32x32x16_bf16 v[160:175], v[216:219], v[104:107], v[160:175]
    ds_read_b64 v[190:191], v14 offset:1384
    ds_read_b64 v[192:193], v14 offset:1408
    ds_read_b64 v[194:195], v14 offset:1416
    v_mov_b32_dpp v128, v128 row_shr:1 row_mask:0xf bank_mask:0xf bound_ctrl:0
    v_mov_b32_dpp v129, v129 row_shr:1 row_mask:0xf bank_mask:0xf bound_ctrl:0
    v_mov_b32_dpp v130, v130 row_shr:1 row_mask:0xf bank_mask:0xf bound_ctrl:0
    v_mfma_f32_32x32x16_bf16 v[160:175], v[220:223], v[108:111], v[160:175]
    ds_read_b64 v[196:197], v14 offset:1440
    ds_read_b64 v[198:199], v14 offset:1448
    ds_read_b64 v[200:201], v14 offset:1472
    v_mov_b32_dpp v131, v131 row_shr:1 row_mask:0xf bank_mask:0xf bound_ctrl:0
    v_mov_b32_dpp v132, v132 row_shr:1 row_mask:0xf bank_mask:0xf bound_ctrl:0
    v_mov_b32_dpp v133, v133 row_shr:1 row_mask:0xf bank_mask:0xf bound_ctrl:0
    v_mfma_f32_32x32x16_bf16 v[160:175], v[224:227], v[112:115], v[160:175]
    ds_read_b64 v[202:203], v14 offset:1480
    ds_read_b64 v[204:205], v14 offset:1504
    ds_read_b64 v[206:207], v14 offset:1512
    v_mov_b32_dpp v134, v134 row_shr:1 row_mask:0xf bank_mask:0xf bound_ctrl:0
    v_mov_b32_dpp v135, v135 row_shr:1 row_mask:0xf bank_mask:0xf bound_ctrl:0
    v_mov_b32_dpp v136, v136 row_shr:1 row_mask:0xf bank_mask:0xf bound_ctrl:0
    v_mfma_f32_32x32x16_bf16 v[160:175], v[228:231], v[116:119], v[160:175]
    v_mov_b32_dpp v137, v137 row_shr:1 row_mask:0xf bank_mask:0xf bound_ctrl:0
    v_mov_b32_dpp v138, v138 row_shr:1 row_mask:0xf bank_mask:0xf bound_ctrl:0
    v_mov_b32_dpp v139, v139 row_shr:1 row_mask:0xf bank_mask:0xf bound_ctrl:0
    v_mfma_f32_32x32x16_bf16 v[160:175], v[232:235], v[120:123], v[160:175]
    v_mov_b32_dpp v140, v140 row_shr:1 row_mask:0xf bank_mask:0xf bound_ctrl:0
    v_mov_b32_dpp v141, v141 row_shr:1 row_mask:0xf bank_mask:0xf bound_ctrl:0
    v_mfma_f32_32x32x16_bf16 v[160:175], v[236:239], v[124:127], v[160:175]
    v_mov_b32_dpp v142, v142 row_shr:1 row_mask:0xf bank_mask:0xf bound_ctrl:0
    v_mov_b32_dpp v143, v143 row_shr:1 row_mask:0xf bank_mask:0xf bound_ctrl:0
    s_waitcnt lgkmcnt(0)
    v_mfma_f32_32x32x16_bf16 v[144:159], v[176:179], v[64:67], v[144:159]
    ds_read_b64 v[208:209], v14 offset:3328
    ds_read_b64 v[210:211], v14 offset:3336
    s_nop 2
    v_mfma_f32_32x32x16_bf16 v[144:159], v[180:183], v[68:71], v[144:159]
    ds_read_b64 v[212:213], v14 offset:3360
    ds_read_b64 v[214:215], v14 offset:3368
    s_nop 2
    v_mfma_f32_32x32x16_bf16 v[144:159], v[184:187], v[72:75], v[144:159]
    ds_read_b64 v[216:217], v14 offset:3392
    ds_read_b64 v[218:219], v14 offset:3400
    v_and_b32_dpp v160, v160, v15 row_shr:1 row_mask:0xf bank_mask:0xf bound_ctrl:0
    v_and_b32_dpp v161, v161, v15 row_shr:1 row_mask:0xf bank_mask:0xf bound_ctrl:0
    v_and_b32_dpp v162, v162, v15 row_shr:1 row_mask:0xf bank_mask:0xf bound_ctrl:0
    v_mfma_f32_32x32x16_bf16 v[144:159], v[188:191], v[76:79], v[144:159]
    ds_read_b64 v[220:221], v14 offset:3424
    ds_read_b64 v[222:223], v14 offset:3432
    v_and_b32_dpp v163, v163, v15 row_shr:1 row_mask:0xf bank_mask:0xf bound_ctrl:0
    v_and_b32_dpp v164, v164, v15 row_shr:1 row_mask:0xf bank_mask:0xf bound_ctrl:0
    v_and_b32_dpp v165, v165, v15 row_shr:1 row_mask:0xf bank_mask:0xf bound_ctrl:0
    v_mfma_f32_32x32x16_bf16 v[144:159], v[192:195], v[80:83], v[144:159]
    ds_read_b64 v[224:225], v14 offset:3456
    ds_read_b64 v[226:227], v14 offset:3464
    v_and_b32_dpp v166, v166, v15 row_shr:1 row_mask:0xf bank_mask:0xf bound_ctrl:0
    v_and_b32_dpp v167, v167, v15 row_shr:1 row_mask:0xf bank_mask:0xf bound_ctrl:0
    v_and_b32_dpp v168, v168, v15 row_shr:1 row_mask:0xf bank_mask:0xf bound_ctrl:0
    v_mfma_f32_32x32x16_bf16 v[144:159], v[196:199], v[84:87], v[144:159]
    ds_read_b64 v[228:229], v14 offset:3488
    ds_read_b64 v[230:231], v14 offset:3496
    v_and_b32_dpp v169, v169, v15 row_shr:1 row_mask:0xf bank_mask:0xf bound_ctrl:0
    v_and_b32_dpp v170, v170, v15 row_shr:1 row_mask:0xf bank_mask:0xf bound_ctrl:0
    v_and_b32_dpp v171, v171, v15 row_shr:1 row_mask:0xf bank_mask:0xf bound_ctrl:0
    v_mfma_f32_32x32x16_bf16 v[144:159], v[200:203], v[88:91], v[144:159]
    ds_read_b64 v[232:233], v14 offset:3520
    ds_read_b64 v[234:235], v14 offset:3528
    v_and_b32_dpp v172, v172, v15 row_shr:1 row_mask:0xf bank_mask:0xf bound_ctrl:0
    v_and_b32_dpp v173, v173, v15 row_shr:1 row_mask:0xf bank_mask:0xf bound_ctrl:0
    v_mfma_f32_32x32x16_bf16 v[144:159], v[204:207], v[92:95], v[144:159]
    ds_read_b64 v[236:237], v14 offset:3552
    ds_read_b64 v[238:239], v14 offset:3560
    v_and_b32_dpp v174, v174, v15 row_shr:1 row_mask:0xf bank_mask:0xf bound_ctrl:0
    v_and_b32_dpp v175, v175, v15 row_shr:1 row_mask:0xf bank_mask:0xf bound_ctrl:0
    v_mfma_f32_32x32x16_bf16 v[128:143], v[176:179], v[32:35], v[128:143]
    v_and_b32 v19, 31, v1
    s_nop 3
    v_mfma_f32_32x32x16_bf16 v[128:143], v[180:183], v[36:39], v[128:143]
    s_mov_b32 s50, 400384
    s_nop 3
    v_mfma_f32_32x32x16_bf16 v[128:143], v[184:187], v[40:43], v[128:143]
    v_mul_lo_u32 v19, v19, s50
    v_mov_b32_dpp v144, v144 row_shr:1 row_mask:0xf bank_mask:0xf bound_ctrl:0
    v_mov_b32_dpp v145, v145 row_shr:1 row_mask:0xf bank_mask:0xf bound_ctrl:0
    v_mov_b32_dpp v146, v146 row_shr:1 row_mask:0xf bank_mask:0xf bound_ctrl:0
    v_mfma_f32_32x32x16_bf16 v[128:143], v[188:191], v[44:47], v[128:143]
    s_mov_b32 s50, 9060352
    v_mov_b32_dpp v147, v147 row_shr:1 row_mask:0xf bank_mask:0xf bound_ctrl:0
    v_mov_b32_dpp v148, v148 row_shr:1 row_mask:0xf bank_mask:0xf bound_ctrl:0
    v_mov_b32_dpp v149, v149 row_shr:1 row_mask:0xf bank_mask:0xf bound_ctrl:0
    v_mfma_f32_32x32x16_bf16 v[128:143], v[192:195], v[48:51], v[128:143]
    buffer_load_dword v28, v19, s[28:31], s50 offen
    v_mov_b32_dpp v150, v150 row_shr:1 row_mask:0xf bank_mask:0xf bound_ctrl:0
    v_mov_b32_dpp v151, v151 row_shr:1 row_mask:0xf bank_mask:0xf bound_ctrl:0
    v_mov_b32_dpp v152, v152 row_shr:1 row_mask:0xf bank_mask:0xf bound_ctrl:0
    v_mfma_f32_32x32x16_bf16 v[128:143], v[196:199], v[52:55], v[128:143]
    v_mov_b32_dpp v153, v153 row_shr:1 row_mask:0xf bank_mask:0xf bound_ctrl:0
    v_mov_b32_dpp v154, v154 row_shr:1 row_mask:0xf bank_mask:0xf bound_ctrl:0
    v_mov_b32_dpp v155, v155 row_shr:1 row_mask:0xf bank_mask:0xf bound_ctrl:0
    v_mfma_f32_32x32x16_bf16 v[128:143], v[200:203], v[56:59], v[128:143]
    v_mov_b32_dpp v156, v156 row_shr:1 row_mask:0xf bank_mask:0xf bound_ctrl:0
    v_mov_b32_dpp v157, v157 row_shr:1 row_mask:0xf bank_mask:0xf bound_ctrl:0
    v_mfma_f32_32x32x16_bf16 v[128:143], v[204:207], v[60:63], v[128:143]
    v_mov_b32_dpp v158, v158 row_shr:1 row_mask:0xf bank_mask:0xf bound_ctrl:0
    v_mov_b32_dpp v159, v159 row_shr:1 row_mask:0xf bank_mask:0xf bound_ctrl:0
    s_waitcnt lgkmcnt(0)
    v_mfma_f32_32x32x16_bf16 v[160:175], v[208:211], v[96:99], v[160:175]
    ds_read_b64 v[176:177], v14 offset:1024
    ds_read_b64 v[178:179], v14 offset:1032
    ds_read_b64 v[180:181], v14 offset:1056
    ds_read_b64 v[182:183], v14 offset:1064
    s_nop 0
    v_mfma_f32_32x32x16_bf16 v[160:175], v[212:215], v[100:103], v[160:175]
    ds_read_b64 v[184:185], v14 offset:1088
    ds_read_b64 v[186:187], v14 offset:1096
    ds_read_b64 v[188:189], v14 offset:1120
    s_nop 1
    v_mfma_f32_32x32x16_bf16 v[160:175], v[216:219], v[104:107], v[160:175]
    ds_read_b64 v[190:191], v14 offset:1128
    ds_read_b64 v[192:193], v14 offset:1152
    ds_read_b64 v[194:195], v14 offset:1160
    v_mov_b32_dpp v128, v128 row_shr:1 row_mask:0xf bank_mask:0xf bound_ctrl:0
    v_mov_b32_dpp v129, v129 row_shr:1 row_mask:0xf bank_mask:0xf bound_ctrl:0
    v_mov_b32_dpp v130, v130 row_shr:1 row_mask:0xf bank_mask:0xf bound_ctrl:0
    v_mfma_f32_32x32x16_bf16 v[160:175], v[220:223], v[108:111], v[160:175]
    ds_read_b64 v[196:197], v14 offset:1184
    ds_read_b64 v[198:199], v14 offset:1192
    ds_read_b64 v[200:201], v14 offset:1216
    v_mov_b32_dpp v131, v131 row_shr:1 row_mask:0xf bank_mask:0xf bound_ctrl:0
    v_mov_b32_dpp v132, v132 row_shr:1 row_mask:0xf bank_mask:0xf bound_ctrl:0
    v_mov_b32_dpp v133, v133 row_shr:1 row_mask:0xf bank_mask:0xf bound_ctrl:0
    v_mfma_f32_32x32x16_bf16 v[160:175], v[224:227], v[112:115], v[160:175]
    ds_read_b64 v[202:203], v14 offset:1224
    ds_read_b64 v[204:205], v14 offset:1248
    ds_read_b64 v[206:207], v14 offset:1256
    v_mov_b32_dpp v134, v134 row_shr:1 row_mask:0xf bank_mask:0xf bound_ctrl:0
    v_mov_b32_dpp v135, v135 row_shr:1 row_mask:0xf bank_mask:0xf bound_ctrl:0
    v_mov_b32_dpp v136, v136 row_shr:1 row_mask:0xf bank_mask:0xf bound_ctrl:0
    v_mfma_f32_32x32x16_bf16 v[160:175], v[228:231], v[116:119], v[160:175]
    v_mov_b32_dpp v137, v137 row_shr:1 row_mask:0xf bank_mask:0xf bound_ctrl:0
    v_mov_b32_dpp v138, v138 row_shr:1 row_mask:0xf bank_mask:0xf bound_ctrl:0
    v_mov_b32_dpp v139, v139 row_shr:1 row_mask:0xf bank_mask:0xf bound_ctrl:0
    v_mfma_f32_32x32x16_bf16 v[160:175], v[232:235], v[120:123], v[160:175]
    v_mov_b32_dpp v140, v140 row_shr:1 row_mask:0xf bank_mask:0xf bound_ctrl:0
    v_mov_b32_dpp v141, v141 row_shr:1 row_mask:0xf bank_mask:0xf bound_ctrl:0
    v_mfma_f32_32x32x16_bf16 v[160:175], v[236:239], v[124:127], v[160:175]
    v_mov_b32_dpp v142, v142 row_shr:1 row_mask:0xf bank_mask:0xf bound_ctrl:0
    v_mov_b32_dpp v143, v143 row_shr:1 row_mask:0xf bank_mask:0xf bound_ctrl:0
    s_waitcnt lgkmcnt(0)
    v_mfma_f32_32x32x16_bf16 v[144:159], v[176:179], v[64:67], v[144:159]
    ds_read_b64 v[208:209], v14 offset:3072
    ds_read_b64 v[210:211], v14 offset:3080
    s_nop 2
    v_mfma_f32_32x32x16_bf16 v[144:159], v[180:183], v[68:71], v[144:159]
    ds_read_b64 v[212:213], v14 offset:3104
    ds_read_b64 v[214:215], v14 offset:3112
    s_nop 2
    v_mfma_f32_32x32x16_bf16 v[144:159], v[184:187], v[72:75], v[144:159]
    ds_read_b64 v[216:217], v14 offset:3136
    ds_read_b64 v[218:219], v14 offset:3144
    v_and_b32_dpp v160, v160, v15 row_shr:1 row_mask:0xf bank_mask:0xf bound_ctrl:0
    v_and_b32_dpp v161, v161, v15 row_shr:1 row_mask:0xf bank_mask:0xf bound_ctrl:0
    v_and_b32_dpp v162, v162, v15 row_shr:1 row_mask:0xf bank_mask:0xf bound_ctrl:0
    v_mfma_f32_32x32x16_bf16 v[144:159], v[188:191], v[76:79], v[144:159]
    ds_read_b64 v[220:221], v14 offset:3168
    ds_read_b64 v[222:223], v14 offset:3176
    v_and_b32_dpp v163, v163, v15 row_shr:1 row_mask:0xf bank_mask:0xf bound_ctrl:0
    v_and_b32_dpp v164, v164, v15 row_shr:1 row_mask:0xf bank_mask:0xf bound_ctrl:0
    v_and_b32_dpp v165, v165, v15 row_shr:1 row_mask:0xf bank_mask:0xf bound_ctrl:0
    v_mfma_f32_32x32x16_bf16 v[144:159], v[192:195], v[80:83], v[144:159]
    ds_read_b64 v[224:225], v14 offset:3200
    ds_read_b64 v[226:227], v14 offset:3208
    v_and_b32_dpp v166, v166, v15 row_shr:1 row_mask:0xf bank_mask:0xf bound_ctrl:0
    v_and_b32_dpp v167, v167, v15 row_shr:1 row_mask:0xf bank_mask:0xf bound_ctrl:0
    v_and_b32_dpp v168, v168, v15 row_shr:1 row_mask:0xf bank_mask:0xf bound_ctrl:0
    v_mfma_f32_32x32x16_bf16 v[144:159], v[196:199], v[84:87], v[144:159]
    ds_read_b64 v[228:229], v14 offset:3232
    ds_read_b64 v[230:231], v14 offset:3240
    v_and_b32_dpp v169, v169, v15 row_shr:1 row_mask:0xf bank_mask:0xf bound_ctrl:0
    v_and_b32_dpp v170, v170, v15 row_shr:1 row_mask:0xf bank_mask:0xf bound_ctrl:0
    v_and_b32_dpp v171, v171, v15 row_shr:1 row_mask:0xf bank_mask:0xf bound_ctrl:0
    v_mfma_f32_32x32x16_bf16 v[144:159], v[200:203], v[88:91], v[144:159]
    ds_read_b64 v[232:233], v14 offset:3264
    ds_read_b64 v[234:235], v14 offset:3272
    v_and_b32_dpp v172, v172, v15 row_shr:1 row_mask:0xf bank_mask:0xf bound_ctrl:0
    v_and_b32_dpp v173, v173, v15 row_shr:1 row_mask:0xf bank_mask:0xf bound_ctrl:0
    v_mfma_f32_32x32x16_bf16 v[144:159], v[204:207], v[92:95], v[144:159]
    ds_read_b64 v[236:237], v14 offset:3296
    ds_read_b64 v[238:239], v14 offset:3304
    v_and_b32_dpp v174, v174, v15 row_shr:1 row_mask:0xf bank_mask:0xf bound_ctrl:0
    v_and_b32_dpp v175, v175, v15 row_shr:1 row_mask:0xf bank_mask:0xf bound_ctrl:0
    v_mfma_f32_32x32x16_bf16 v[128:143], v[176:179], v[32:35], v[128:143]
    s_nop 4
    v_mfma_f32_32x32x16_bf16 v[128:143], v[180:183], v[36:39], v[128:143]
    s_nop 4
    v_mfma_f32_32x32x16_bf16 v[128:143], v[184:187], v[40:43], v[128:143]
    v_mov_b32_dpp v144, v144 row_shr:1 row_mask:0xf bank_mask:0xf bound_ctrl:0
    v_mov_b32_dpp v145, v145 row_shr:1 row_mask:0xf bank_mask:0xf bound_ctrl:0
    v_mov_b32_dpp v146, v146 row_shr:1 row_mask:0xf bank_mask:0xf bound_ctrl:0
    v_mfma_f32_32x32x16_bf16 v[128:143], v[188:191], v[44:47], v[128:143]
    v_mov_b32_dpp v147, v147 row_shr:1 row_mask:0xf bank_mask:0xf bound_ctrl:0
    v_mov_b32_dpp v148, v148 row_shr:1 row_mask:0xf bank_mask:0xf bound_ctrl:0
    v_mov_b32_dpp v149, v149 row_shr:1 row_mask:0xf bank_mask:0xf bound_ctrl:0
    v_mfma_f32_32x32x16_bf16 v[128:143], v[192:195], v[48:51], v[128:143]
    v_mov_b32_dpp v150, v150 row_shr:1 row_mask:0xf bank_mask:0xf bound_ctrl:0
    v_mov_b32_dpp v151, v151 row_shr:1 row_mask:0xf bank_mask:0xf bound_ctrl:0
    v_mov_b32_dpp v152, v152 row_shr:1 row_mask:0xf bank_mask:0xf bound_ctrl:0
    v_mfma_f32_32x32x16_bf16 v[128:143], v[196:199], v[52:55], v[128:143]
    v_mov_b32_dpp v153, v153 row_shr:1 row_mask:0xf bank_mask:0xf bound_ctrl:0
    v_mov_b32_dpp v154, v154 row_shr:1 row_mask:0xf bank_mask:0xf bound_ctrl:0
    v_mov_b32_dpp v155, v155 row_shr:1 row_mask:0xf bank_mask:0xf bound_ctrl:0
    v_mfma_f32_32x32x16_bf16 v[128:143], v[200:203], v[56:59], v[128:143]
    v_mov_b32_dpp v156, v156 row_shr:1 row_mask:0xf bank_mask:0xf bound_ctrl:0
    v_mov_b32_dpp v157, v157 row_shr:1 row_mask:0xf bank_mask:0xf bound_ctrl:0
    v_mfma_f32_32x32x16_bf16 v[128:143], v[204:207], v[60:63], v[128:143]
    v_mov_b32_dpp v158, v158 row_shr:1 row_mask:0xf bank_mask:0xf bound_ctrl:0
    v_mov_b32_dpp v159, v159 row_shr:1 row_mask:0xf bank_mask:0xf bound_ctrl:0
    s_waitcnt lgkmcnt(0)
    v_mfma_f32_32x32x16_bf16 v[160:175], v[208:211], v[96:99], v[160:175]
    ds_read_b64 v[176:177], v14 offset:768
    ds_read_b64 v[178:179], v14 offset:776
    ds_read_b64 v[180:181], v14 offset:800
    ds_read_b64 v[182:183], v14 offset:808
    s_nop 0
    v_mfma_f32_32x32x16_bf16 v[160:175], v[212:215], v[100:103], v[160:175]
    ds_read_b64 v[184:185], v14 offset:832
    ds_read_b64 v[186:187], v14 offset:840
    ds_read_b64 v[188:189], v14 offset:864
    s_nop 1
    v_mfma_f32_32x32x16_bf16 v[160:175], v[216:219], v[104:107], v[160:175]
    ds_read_b64 v[190:191], v14 offset:872
    ds_read_b64 v[192:193], v14 offset:896
    ds_read_b64 v[194:195], v14 offset:904
    v_mov_b32_dpp v128, v128 row_shr:1 row_mask:0xf bank_mask:0xf bound_ctrl:0
    v_mov_b32_dpp v129, v129 row_shr:1 row_mask:0xf bank_mask:0xf bound_ctrl:0
    v_mov_b32_dpp v130, v130 row_shr:1 row_mask:0xf bank_mask:0xf bound_ctrl:0
    v_mfma_f32_32x32x16_bf16 v[160:175], v[220:223], v[108:111], v[160:175]
    ds_read_b64 v[196:197], v14 offset:928
    ds_read_b64 v[198:199], v14 offset:936
    ds_read_b64 v[200:201], v14 offset:960
    v_mov_b32_dpp v131, v131 row_shr:1 row_mask:0xf bank_mask:0xf bound_ctrl:0
    v_mov_b32_dpp v132, v132 row_shr:1 row_mask:0xf bank_mask:0xf bound_ctrl:0
    v_mov_b32_dpp v133, v133 row_shr:1 row_mask:0xf bank_mask:0xf bound_ctrl:0
    v_mfma_f32_32x32x16_bf16 v[160:175], v[224:227], v[112:115], v[160:175]
    ds_read_b64 v[202:203], v14 offset:968
    ds_read_b64 v[204:205], v14 offset:992
    ds_read_b64 v[206:207], v14 offset:1000
    v_mov_b32_dpp v134, v134 row_shr:1 row_mask:0xf bank_mask:0xf bound_ctrl:0
    v_mov_b32_dpp v135, v135 row_shr:1 row_mask:0xf bank_mask:0xf bound_ctrl:0
    v_mov_b32_dpp v136, v136 row_shr:1 row_mask:0xf bank_mask:0xf bound_ctrl:0
    v_mfma_f32_32x32x16_bf16 v[160:175], v[228:231], v[116:119], v[160:175]
    v_mov_b32_dpp v137, v137 row_shr:1 row_mask:0xf bank_mask:0xf bound_ctrl:0
    v_mov_b32_dpp v138, v138 row_shr:1 row_mask:0xf bank_mask:0xf bound_ctrl:0
    v_mov_b32_dpp v139, v139 row_shr:1 row_mask:0xf bank_mask:0xf bound_ctrl:0
    v_mfma_f32_32x32x16_bf16 v[160:175], v[232:235], v[120:123], v[160:175]
    v_mov_b32_dpp v140, v140 row_shr:1 row_mask:0xf bank_mask:0xf bound_ctrl:0
    v_mov_b32_dpp v141, v141 row_shr:1 row_mask:0xf bank_mask:0xf bound_ctrl:0
    v_mfma_f32_32x32x16_bf16 v[160:175], v[236:239], v[124:127], v[160:175]
    v_mov_b32_dpp v142, v142 row_shr:1 row_mask:0xf bank_mask:0xf bound_ctrl:0
    v_mov_b32_dpp v143, v143 row_shr:1 row_mask:0xf bank_mask:0xf bound_ctrl:0
    s_waitcnt lgkmcnt(0)
    v_mfma_f32_32x32x16_bf16 v[144:159], v[176:179], v[64:67], v[144:159]
    ds_read_b64 v[208:209], v14 offset:2816
    ds_read_b64 v[210:211], v14 offset:2824
    s_nop 2
    v_mfma_f32_32x32x16_bf16 v[144:159], v[180:183], v[68:71], v[144:159]
    ds_read_b64 v[212:213], v14 offset:2848
    ds_read_b64 v[214:215], v14 offset:2856
    s_nop 2
    v_mfma_f32_32x32x16_bf16 v[144:159], v[184:187], v[72:75], v[144:159]
    ds_read_b64 v[216:217], v14 offset:2880
    ds_read_b64 v[218:219], v14 offset:2888
    v_and_b32_dpp v160, v160, v15 row_shr:1 row_mask:0xf bank_mask:0xf bound_ctrl:0
    v_and_b32_dpp v161, v161, v15 row_shr:1 row_mask:0xf bank_mask:0xf bound_ctrl:0
    v_and_b32_dpp v162, v162, v15 row_shr:1 row_mask:0xf bank_mask:0xf bound_ctrl:0
    v_mfma_f32_32x32x16_bf16 v[144:159], v[188:191], v[76:79], v[144:159]
    ds_read_b64 v[220:221], v14 offset:2912
    ds_read_b64 v[222:223], v14 offset:2920
    v_and_b32_dpp v163, v163, v15 row_shr:1 row_mask:0xf bank_mask:0xf bound_ctrl:0
    v_and_b32_dpp v164, v164, v15 row_shr:1 row_mask:0xf bank_mask:0xf bound_ctrl:0
    v_and_b32_dpp v165, v165, v15 row_shr:1 row_mask:0xf bank_mask:0xf bound_ctrl:0
    v_mfma_f32_32x32x16_bf16 v[144:159], v[192:195], v[80:83], v[144:159]
    ds_read_b64 v[224:225], v14 offset:2944
    ds_read_b64 v[226:227], v14 offset:2952
    v_and_b32_dpp v166, v166, v15 row_shr:1 row_mask:0xf bank_mask:0xf bound_ctrl:0
    v_and_b32_dpp v167, v167, v15 row_shr:1 row_mask:0xf bank_mask:0xf bound_ctrl:0
    v_and_b32_dpp v168, v168, v15 row_shr:1 row_mask:0xf bank_mask:0xf bound_ctrl:0
    v_mfma_f32_32x32x16_bf16 v[144:159], v[196:199], v[84:87], v[144:159]
    ds_read_b64 v[228:229], v14 offset:2976
    ds_read_b64 v[230:231], v14 offset:2984
    v_and_b32_dpp v169, v169, v15 row_shr:1 row_mask:0xf bank_mask:0xf bound_ctrl:0
    v_and_b32_dpp v170, v170, v15 row_shr:1 row_mask:0xf bank_mask:0xf bound_ctrl:0
    v_and_b32_dpp v171, v171, v15 row_shr:1 row_mask:0xf bank_mask:0xf bound_ctrl:0
    v_mfma_f32_32x32x16_bf16 v[144:159], v[200:203], v[88:91], v[144:159]
    ds_read_b64 v[232:233], v14 offset:3008
    ds_read_b64 v[234:235], v14 offset:3016
    v_and_b32_dpp v172, v172, v15 row_shr:1 row_mask:0xf bank_mask:0xf bound_ctrl:0
    v_and_b32_dpp v173, v173, v15 row_shr:1 row_mask:0xf bank_mask:0xf bound_ctrl:0
    v_mfma_f32_32x32x16_bf16 v[144:159], v[204:207], v[92:95], v[144:159]
    ds_read_b64 v[236:237], v14 offset:3040
    ds_read_b64 v[238:239], v14 offset:3048
    v_and_b32_dpp v174, v174, v15 row_shr:1 row_mask:0xf bank_mask:0xf bound_ctrl:0
    v_and_b32_dpp v175, v175, v15 row_shr:1 row_mask:0xf bank_mask:0xf bound_ctrl:0
    v_mfma_f32_32x32x16_bf16 v[128:143], v[176:179], v[32:35], v[128:143]
    s_nop 4
    v_mfma_f32_32x32x16_bf16 v[128:143], v[180:183], v[36:39], v[128:143]
    s_nop 4
    v_mfma_f32_32x32x16_bf16 v[128:143], v[184:187], v[40:43], v[128:143]
    v_mov_b32_dpp v144, v144 row_shr:1 row_mask:0xf bank_mask:0xf bound_ctrl:0
    v_mov_b32_dpp v145, v145 row_shr:1 row_mask:0xf bank_mask:0xf bound_ctrl:0
    v_mov_b32_dpp v146, v146 row_shr:1 row_mask:0xf bank_mask:0xf bound_ctrl:0
    v_mfma_f32_32x32x16_bf16 v[128:143], v[188:191], v[44:47], v[128:143]
    v_mov_b32_dpp v147, v147 row_shr:1 row_mask:0xf bank_mask:0xf bound_ctrl:0
    v_mov_b32_dpp v148, v148 row_shr:1 row_mask:0xf bank_mask:0xf bound_ctrl:0
    v_mov_b32_dpp v149, v149 row_shr:1 row_mask:0xf bank_mask:0xf bound_ctrl:0
    v_mfma_f32_32x32x16_bf16 v[128:143], v[192:195], v[48:51], v[128:143]
    v_mov_b32_dpp v150, v150 row_shr:1 row_mask:0xf bank_mask:0xf bound_ctrl:0
    v_mov_b32_dpp v151, v151 row_shr:1 row_mask:0xf bank_mask:0xf bound_ctrl:0
    v_mov_b32_dpp v152, v152 row_shr:1 row_mask:0xf bank_mask:0xf bound_ctrl:0
    v_mfma_f32_32x32x16_bf16 v[128:143], v[196:199], v[52:55], v[128:143]
    v_mov_b32_dpp v153, v153 row_shr:1 row_mask:0xf bank_mask:0xf bound_ctrl:0
    v_mov_b32_dpp v154, v154 row_shr:1 row_mask:0xf bank_mask:0xf bound_ctrl:0
    v_mov_b32_dpp v155, v155 row_shr:1 row_mask:0xf bank_mask:0xf bound_ctrl:0
    v_mfma_f32_32x32x16_bf16 v[128:143], v[200:203], v[56:59], v[128:143]
    v_mov_b32_dpp v156, v156 row_shr:1 row_mask:0xf bank_mask:0xf bound_ctrl:0
    v_mov_b32_dpp v157, v157 row_shr:1 row_mask:0xf bank_mask:0xf bound_ctrl:0
    v_mfma_f32_32x32x16_bf16 v[128:143], v[204:207], v[60:63], v[128:143]
    v_mov_b32_dpp v158, v158 row_shr:1 row_mask:0xf bank_mask:0xf bound_ctrl:0
    v_mov_b32_dpp v159, v159 row_shr:1 row_mask:0xf bank_mask:0xf bound_ctrl:0
    s_waitcnt lgkmcnt(0)
    v_mfma_f32_32x32x16_bf16 v[160:175], v[208:211], v[96:99], v[160:175]
    ds_read_b64 v[176:177], v14 offset:512
    ds_read_b64 v[178:179], v14 offset:520
    ds_read_b64 v[180:181], v14 offset:544
    ds_read_b64 v[182:183], v14 offset:552
    s_nop 0
    v_mfma_f32_32x32x16_bf16 v[160:175], v[212:215], v[100:103], v[160:175]
    ds_read_b64 v[184:185], v14 offset:576
    ds_read_b64 v[186:187], v14 offset:584
    ds_read_b64 v[188:189], v14 offset:608
    s_nop 1
    v_mfma_f32_32x32x16_bf16 v[160:175], v[216:219], v[104:107], v[160:175]
    ds_read_b64 v[190:191], v14 offset:616
    ds_read_b64 v[192:193], v14 offset:640
    ds_read_b64 v[194:195], v14 offset:648
    v_mov_b32_dpp v128, v128 row_shr:1 row_mask:0xf bank_mask:0xf bound_ctrl:0
    v_mov_b32_dpp v129, v129 row_shr:1 row_mask:0xf bank_mask:0xf bound_ctrl:0
    v_mov_b32_dpp v130, v130 row_shr:1 row_mask:0xf bank_mask:0xf bound_ctrl:0
    v_mfma_f32_32x32x16_bf16 v[160:175], v[220:223], v[108:111], v[160:175]
    ds_read_b64 v[196:197], v14 offset:672
    ds_read_b64 v[198:199], v14 offset:680
    ds_read_b64 v[200:201], v14 offset:704
    v_mov_b32_dpp v131, v131 row_shr:1 row_mask:0xf bank_mask:0xf bound_ctrl:0
    v_mov_b32_dpp v132, v132 row_shr:1 row_mask:0xf bank_mask:0xf bound_ctrl:0
    v_mov_b32_dpp v133, v133 row_shr:1 row_mask:0xf bank_mask:0xf bound_ctrl:0
    v_mfma_f32_32x32x16_bf16 v[160:175], v[224:227], v[112:115], v[160:175]
    ds_read_b64 v[202:203], v14 offset:712
    ds_read_b64 v[204:205], v14 offset:736
    ds_read_b64 v[206:207], v14 offset:744
    v_mov_b32_dpp v134, v134 row_shr:1 row_mask:0xf bank_mask:0xf bound_ctrl:0
    v_mov_b32_dpp v135, v135 row_shr:1 row_mask:0xf bank_mask:0xf bound_ctrl:0
    v_mov_b32_dpp v136, v136 row_shr:1 row_mask:0xf bank_mask:0xf bound_ctrl:0
    v_mfma_f32_32x32x16_bf16 v[160:175], v[228:231], v[116:119], v[160:175]
    v_mov_b32_dpp v137, v137 row_shr:1 row_mask:0xf bank_mask:0xf bound_ctrl:0
    v_mov_b32_dpp v138, v138 row_shr:1 row_mask:0xf bank_mask:0xf bound_ctrl:0
    v_mov_b32_dpp v139, v139 row_shr:1 row_mask:0xf bank_mask:0xf bound_ctrl:0
    v_mfma_f32_32x32x16_bf16 v[160:175], v[232:235], v[120:123], v[160:175]
    v_mov_b32_dpp v140, v140 row_shr:1 row_mask:0xf bank_mask:0xf bound_ctrl:0
    v_mov_b32_dpp v141, v141 row_shr:1 row_mask:0xf bank_mask:0xf bound_ctrl:0
    v_mfma_f32_32x32x16_bf16 v[160:175], v[236:239], v[124:127], v[160:175]
    v_mov_b32_dpp v142, v142 row_shr:1 row_mask:0xf bank_mask:0xf bound_ctrl:0
    v_mov_b32_dpp v143, v143 row_shr:1 row_mask:0xf bank_mask:0xf bound_ctrl:0
    s_waitcnt lgkmcnt(0)
    v_mfma_f32_32x32x16_bf16 v[144:159], v[176:179], v[64:67], v[144:159]
    ds_read_b64 v[208:209], v14 offset:2560
    ds_read_b64 v[210:211], v14 offset:2568
    s_nop 2
    v_mfma_f32_32x32x16_bf16 v[144:159], v[180:183], v[68:71], v[144:159]
    ds_read_b64 v[212:213], v14 offset:2592
    ds_read_b64 v[214:215], v14 offset:2600
    s_nop 2
    v_mfma_f32_32x32x16_bf16 v[144:159], v[184:187], v[72:75], v[144:159]
    ds_read_b64 v[216:217], v14 offset:2624
    ds_read_b64 v[218:219], v14 offset:2632
    v_and_b32_dpp v160, v160, v15 row_shr:1 row_mask:0xf bank_mask:0xf bound_ctrl:0
    v_and_b32_dpp v161, v161, v15 row_shr:1 row_mask:0xf bank_mask:0xf bound_ctrl:0
    v_and_b32_dpp v162, v162, v15 row_shr:1 row_mask:0xf bank_mask:0xf bound_ctrl:0
    v_mfma_f32_32x32x16_bf16 v[144:159], v[188:191], v[76:79], v[144:159]
    ds_read_b64 v[220:221], v14 offset:2656
    ds_read_b64 v[222:223], v14 offset:2664
    v_and_b32_dpp v163, v163, v15 row_shr:1 row_mask:0xf bank_mask:0xf bound_ctrl:0
    v_and_b32_dpp v164, v164, v15 row_shr:1 row_mask:0xf bank_mask:0xf bound_ctrl:0
    v_and_b32_dpp v165, v165, v15 row_shr:1 row_mask:0xf bank_mask:0xf bound_ctrl:0
    v_mfma_f32_32x32x16_bf16 v[144:159], v[192:195], v[80:83], v[144:159]
    ds_read_b64 v[224:225], v14 offset:2688
    ds_read_b64 v[226:227], v14 offset:2696
    v_and_b32_dpp v166, v166, v15 row_shr:1 row_mask:0xf bank_mask:0xf bound_ctrl:0
    v_and_b32_dpp v167, v167, v15 row_shr:1 row_mask:0xf bank_mask:0xf bound_ctrl:0
    v_and_b32_dpp v168, v168, v15 row_shr:1 row_mask:0xf bank_mask:0xf bound_ctrl:0
    v_mfma_f32_32x32x16_bf16 v[144:159], v[196:199], v[84:87], v[144:159]
    ds_read_b64 v[228:229], v14 offset:2720
    ds_read_b64 v[230:231], v14 offset:2728
    v_and_b32_dpp v169, v169, v15 row_shr:1 row_mask:0xf bank_mask:0xf bound_ctrl:0
    v_and_b32_dpp v170, v170, v15 row_shr:1 row_mask:0xf bank_mask:0xf bound_ctrl:0
    v_and_b32_dpp v171, v171, v15 row_shr:1 row_mask:0xf bank_mask:0xf bound_ctrl:0
    v_mfma_f32_32x32x16_bf16 v[144:159], v[200:203], v[88:91], v[144:159]
    ds_read_b64 v[232:233], v14 offset:2752
    ds_read_b64 v[234:235], v14 offset:2760
    v_and_b32_dpp v172, v172, v15 row_shr:1 row_mask:0xf bank_mask:0xf bound_ctrl:0
    v_and_b32_dpp v173, v173, v15 row_shr:1 row_mask:0xf bank_mask:0xf bound_ctrl:0
    v_mfma_f32_32x32x16_bf16 v[144:159], v[204:207], v[92:95], v[144:159]
    ds_read_b64 v[236:237], v14 offset:2784
    ds_read_b64 v[238:239], v14 offset:2792
    v_and_b32_dpp v174, v174, v15 row_shr:1 row_mask:0xf bank_mask:0xf bound_ctrl:0
    v_and_b32_dpp v175, v175, v15 row_shr:1 row_mask:0xf bank_mask:0xf bound_ctrl:0
    v_mfma_f32_32x32x16_bf16 v[128:143], v[176:179], v[32:35], v[128:143]
    s_nop 4
    v_mfma_f32_32x32x16_bf16 v[128:143], v[180:183], v[36:39], v[128:143]
    s_nop 4
    v_mfma_f32_32x32x16_bf16 v[128:143], v[184:187], v[40:43], v[128:143]
    v_mov_b32_dpp v144, v144 row_shr:1 row_mask:0xf bank_mask:0xf bound_ctrl:0
    v_mov_b32_dpp v145, v145 row_shr:1 row_mask:0xf bank_mask:0xf bound_ctrl:0
    v_mov_b32_dpp v146, v146 row_shr:1 row_mask:0xf bank_mask:0xf bound_ctrl:0
    v_mfma_f32_32x32x16_bf16 v[128:143], v[188:191], v[44:47], v[128:143]
    v_mov_b32_dpp v147, v147 row_shr:1 row_mask:0xf bank_mask:0xf bound_ctrl:0
    v_mov_b32_dpp v148, v148 row_shr:1 row_mask:0xf bank_mask:0xf bound_ctrl:0
    v_mov_b32_dpp v149, v149 row_shr:1 row_mask:0xf bank_mask:0xf bound_ctrl:0
    v_mfma_f32_32x32x16_bf16 v[128:143], v[192:195], v[48:51], v[128:143]
    v_mov_b32_dpp v150, v150 row_shr:1 row_mask:0xf bank_mask:0xf bound_ctrl:0
    v_mov_b32_dpp v151, v151 row_shr:1 row_mask:0xf bank_mask:0xf bound_ctrl:0
    v_mov_b32_dpp v152, v152 row_shr:1 row_mask:0xf bank_mask:0xf bound_ctrl:0
    v_mfma_f32_32x32x16_bf16 v[128:143], v[196:199], v[52:55], v[128:143]
    v_mov_b32_dpp v153, v153 row_shr:1 row_mask:0xf bank_mask:0xf bound_ctrl:0
    v_mov_b32_dpp v154, v154 row_shr:1 row_mask:0xf bank_mask:0xf bound_ctrl:0
    v_mov_b32_dpp v155, v155 row_shr:1 row_mask:0xf bank_mask:0xf bound_ctrl:0
    v_mfma_f32_32x32x16_bf16 v[128:143], v[200:203], v[56:59], v[128:143]
    v_mov_b32_dpp v156, v156 row_shr:1 row_mask:0xf bank_mask:0xf bound_ctrl:0
    v_mov_b32_dpp v157, v157 row_shr:1 row_mask:0xf bank_mask:0xf bound_ctrl:0
    v_mfma_f32_32x32x16_bf16 v[128:143], v[204:207], v[60:63], v[128:143]
    v_mov_b32_dpp v158, v158 row_shr:1 row_mask:0xf bank_mask:0xf bound_ctrl:0
    v_mov_b32_dpp v159, v159 row_shr:1 row_mask:0xf bank_mask:0xf bound_ctrl:0
    s_waitcnt lgkmcnt(0)
    v_mfma_f32_32x32x16_bf16 v[160:175], v[208:211], v[96:99], v[160:175]
    ds_read_b64 v[176:177], v14 offset:256
    ds_read_b64 v[178:179], v14 offset:264
    ds_read_b64 v[180:181], v14 offset:288
    ds_read_b64 v[182:183], v14 offset:296
    s_nop 0
    v_mfma_f32_32x32x16_bf16 v[160:175], v[212:215], v[100:103], v[160:175]
    ds_read_b64 v[184:185], v14 offset:320
    ds_read_b64 v[186:187], v14 offset:328
    ds_read_b64 v[188:189], v14 offset:352
    s_nop 1
    v_mfma_f32_32x32x16_bf16 v[160:175], v[216:219], v[104:107], v[160:175]
    ds_read_b64 v[190:191], v14 offset:360
    ds_read_b64 v[192:193], v14 offset:384
    ds_read_b64 v[194:195], v14 offset:392
    v_mov_b32_dpp v128, v128 row_shr:1 row_mask:0xf bank_mask:0xf bound_ctrl:0
    v_mov_b32_dpp v129, v129 row_shr:1 row_mask:0xf bank_mask:0xf bound_ctrl:0
    v_mov_b32_dpp v130, v130 row_shr:1 row_mask:0xf bank_mask:0xf bound_ctrl:0
    v_mfma_f32_32x32x16_bf16 v[160:175], v[220:223], v[108:111], v[160:175]
    ds_read_b64 v[196:197], v14 offset:416
    ds_read_b64 v[198:199], v14 offset:424
    ds_read_b64 v[200:201], v14 offset:448
    v_mov_b32_dpp v131, v131 row_shr:1 row_mask:0xf bank_mask:0xf bound_ctrl:0
    v_mov_b32_dpp v132, v132 row_shr:1 row_mask:0xf bank_mask:0xf bound_ctrl:0
    v_mov_b32_dpp v133, v133 row_shr:1 row_mask:0xf bank_mask:0xf bound_ctrl:0
    v_mfma_f32_32x32x16_bf16 v[160:175], v[224:227], v[112:115], v[160:175]
    ds_read_b64 v[202:203], v14 offset:456
    ds_read_b64 v[204:205], v14 offset:480
    ds_read_b64 v[206:207], v14 offset:488
    v_mov_b32_dpp v134, v134 row_shr:1 row_mask:0xf bank_mask:0xf bound_ctrl:0
    v_mov_b32_dpp v135, v135 row_shr:1 row_mask:0xf bank_mask:0xf bound_ctrl:0
    v_mov_b32_dpp v136, v136 row_shr:1 row_mask:0xf bank_mask:0xf bound_ctrl:0
    v_mfma_f32_32x32x16_bf16 v[160:175], v[228:231], v[116:119], v[160:175]
    v_mov_b32_dpp v137, v137 row_shr:1 row_mask:0xf bank_mask:0xf bound_ctrl:0
    v_mov_b32_dpp v138, v138 row_shr:1 row_mask:0xf bank_mask:0xf bound_ctrl:0
    v_mov_b32_dpp v139, v139 row_shr:1 row_mask:0xf bank_mask:0xf bound_ctrl:0
    v_mfma_f32_32x32x16_bf16 v[160:175], v[232:235], v[120:123], v[160:175]
    v_mov_b32_dpp v140, v140 row_shr:1 row_mask:0xf bank_mask:0xf bound_ctrl:0
    v_mov_b32_dpp v141, v141 row_shr:1 row_mask:0xf bank_mask:0xf bound_ctrl:0
    v_mfma_f32_32x32x16_bf16 v[160:175], v[236:239], v[124:127], v[160:175]
    v_mov_b32_dpp v142, v142 row_shr:1 row_mask:0xf bank_mask:0xf bound_ctrl:0
    v_mov_b32_dpp v143, v143 row_shr:1 row_mask:0xf bank_mask:0xf bound_ctrl:0
    s_waitcnt lgkmcnt(0)
    v_mfma_f32_32x32x16_bf16 v[144:159], v[176:179], v[64:67], v[144:159]
    ds_read_b64 v[208:209], v14 offset:2304
    ds_read_b64 v[210:211], v14 offset:2312
    s_nop 2
    v_mfma_f32_32x32x16_bf16 v[144:159], v[180:183], v[68:71], v[144:159]
    ds_read_b64 v[212:213], v14 offset:2336
    ds_read_b64 v[214:215], v14 offset:2344
    s_nop 2
    v_mfma_f32_32x32x16_bf16 v[144:159], v[184:187], v[72:75], v[144:159]
    ds_read_b64 v[216:217], v14 offset:2368
    ds_read_b64 v[218:219], v14 offset:2376
    v_and_b32_dpp v160, v160, v15 row_shr:1 row_mask:0xf bank_mask:0xf bound_ctrl:0
    v_and_b32_dpp v161, v161, v15 row_shr:1 row_mask:0xf bank_mask:0xf bound_ctrl:0
    v_and_b32_dpp v162, v162, v15 row_shr:1 row_mask:0xf bank_mask:0xf bound_ctrl:0
    v_mfma_f32_32x32x16_bf16 v[144:159], v[188:191], v[76:79], v[144:159]
    ds_read_b64 v[220:221], v14 offset:2400
    ds_read_b64 v[222:223], v14 offset:2408
    v_and_b32_dpp v163, v163, v15 row_shr:1 row_mask:0xf bank_mask:0xf bound_ctrl:0
    v_and_b32_dpp v164, v164, v15 row_shr:1 row_mask:0xf bank_mask:0xf bound_ctrl:0
    v_and_b32_dpp v165, v165, v15 row_shr:1 row_mask:0xf bank_mask:0xf bound_ctrl:0
    v_mfma_f32_32x32x16_bf16 v[144:159], v[192:195], v[80:83], v[144:159]
    ds_read_b64 v[224:225], v14 offset:2432
    ds_read_b64 v[226:227], v14 offset:2440
    v_and_b32_dpp v166, v166, v15 row_shr:1 row_mask:0xf bank_mask:0xf bound_ctrl:0
    v_and_b32_dpp v167, v167, v15 row_shr:1 row_mask:0xf bank_mask:0xf bound_ctrl:0
    v_and_b32_dpp v168, v168, v15 row_shr:1 row_mask:0xf bank_mask:0xf bound_ctrl:0
    v_mfma_f32_32x32x16_bf16 v[144:159], v[196:199], v[84:87], v[144:159]
    ds_read_b64 v[228:229], v14 offset:2464
    ds_read_b64 v[230:231], v14 offset:2472
    v_and_b32_dpp v169, v169, v15 row_shr:1 row_mask:0xf bank_mask:0xf bound_ctrl:0
    v_and_b32_dpp v170, v170, v15 row_shr:1 row_mask:0xf bank_mask:0xf bound_ctrl:0
    v_and_b32_dpp v171, v171, v15 row_shr:1 row_mask:0xf bank_mask:0xf bound_ctrl:0
    v_mfma_f32_32x32x16_bf16 v[144:159], v[200:203], v[88:91], v[144:159]
    ds_read_b64 v[232:233], v14 offset:2496
    ds_read_b64 v[234:235], v14 offset:2504
    v_and_b32_dpp v172, v172, v15 row_shr:1 row_mask:0xf bank_mask:0xf bound_ctrl:0
    v_and_b32_dpp v173, v173, v15 row_shr:1 row_mask:0xf bank_mask:0xf bound_ctrl:0
    v_mfma_f32_32x32x16_bf16 v[144:159], v[204:207], v[92:95], v[144:159]
    ds_read_b64 v[236:237], v14 offset:2528
    ds_read_b64 v[238:239], v14 offset:2536
    v_and_b32_dpp v174, v174, v15 row_shr:1 row_mask:0xf bank_mask:0xf bound_ctrl:0
    v_and_b32_dpp v175, v175, v15 row_shr:1 row_mask:0xf bank_mask:0xf bound_ctrl:0
    v_mfma_f32_32x32x16_bf16 v[128:143], v[176:179], v[32:35], v[128:143]
    s_nop 4
    v_mfma_f32_32x32x16_bf16 v[128:143], v[180:183], v[36:39], v[128:143]
    s_nop 4
    v_mfma_f32_32x32x16_bf16 v[128:143], v[184:187], v[40:43], v[128:143]
    v_mov_b32_dpp v144, v144 row_shr:1 row_mask:0xf bank_mask:0xf bound_ctrl:0
    v_mov_b32_dpp v145, v145 row_shr:1 row_mask:0xf bank_mask:0xf bound_ctrl:0
    v_mov_b32_dpp v146, v146 row_shr:1 row_mask:0xf bank_mask:0xf bound_ctrl:0
    v_mfma_f32_32x32x16_bf16 v[128:143], v[188:191], v[44:47], v[128:143]
    v_mov_b32_dpp v147, v147 row_shr:1 row_mask:0xf bank_mask:0xf bound_ctrl:0
    v_mov_b32_dpp v148, v148 row_shr:1 row_mask:0xf bank_mask:0xf bound_ctrl:0
    v_mov_b32_dpp v149, v149 row_shr:1 row_mask:0xf bank_mask:0xf bound_ctrl:0
    v_mfma_f32_32x32x16_bf16 v[128:143], v[192:195], v[48:51], v[128:143]
    v_mov_b32_dpp v150, v150 row_shr:1 row_mask:0xf bank_mask:0xf bound_ctrl:0
    v_mov_b32_dpp v151, v151 row_shr:1 row_mask:0xf bank_mask:0xf bound_ctrl:0
    v_mov_b32_dpp v152, v152 row_shr:1 row_mask:0xf bank_mask:0xf bound_ctrl:0
    v_mfma_f32_32x32x16_bf16 v[128:143], v[196:199], v[52:55], v[128:143]
    v_mov_b32_dpp v153, v153 row_shr:1 row_mask:0xf bank_mask:0xf bound_ctrl:0
    v_mov_b32_dpp v154, v154 row_shr:1 row_mask:0xf bank_mask:0xf bound_ctrl:0
    v_mov_b32_dpp v155, v155 row_shr:1 row_mask:0xf bank_mask:0xf bound_ctrl:0
    v_mfma_f32_32x32x16_bf16 v[128:143], v[200:203], v[56:59], v[128:143]
    v_mov_b32_dpp v156, v156 row_shr:1 row_mask:0xf bank_mask:0xf bound_ctrl:0
    v_mov_b32_dpp v157, v157 row_shr:1 row_mask:0xf bank_mask:0xf bound_ctrl:0
    v_mfma_f32_32x32x16_bf16 v[128:143], v[204:207], v[60:63], v[128:143]
    v_mov_b32_dpp v158, v158 row_shr:1 row_mask:0xf bank_mask:0xf bound_ctrl:0
    v_mov_b32_dpp v159, v159 row_shr:1 row_mask:0xf bank_mask:0xf bound_ctrl:0
    s_waitcnt lgkmcnt(0)
    v_mfma_f32_32x32x16_bf16 v[160:175], v[208:211], v[96:99], v[160:175]
    ds_read_b64 v[176:177], v14 offset:0
    ds_read_b64 v[178:179], v14 offset:8
    ds_read_b64 v[180:181], v14 offset:32
    ds_read_b64 v[182:183], v14 offset:40
    s_nop 0
    v_mfma_f32_32x32x16_bf16 v[160:175], v[212:215], v[100:103], v[160:175]
    ds_read_b64 v[184:185], v14 offset:64
    ds_read_b64 v[186:187], v14 offset:72
    ds_read_b64 v[188:189], v14 offset:96
    s_nop 1
    v_mfma_f32_32x32x16_bf16 v[160:175], v[216:219], v[104:107], v[160:175]
    ds_read_b64 v[190:191], v14 offset:104
    ds_read_b64 v[192:193], v14 offset:128
    ds_read_b64 v[194:195], v14 offset:136
    v_mov_b32_dpp v128, v128 row_shr:1 row_mask:0xf bank_mask:0xf bound_ctrl:0
    v_mov_b32_dpp v129, v129 row_shr:1 row_mask:0xf bank_mask:0xf bound_ctrl:0
    v_mov_b32_dpp v130, v130 row_shr:1 row_mask:0xf bank_mask:0xf bound_ctrl:0
    v_mfma_f32_32x32x16_bf16 v[160:175], v[220:223], v[108:111], v[160:175]
    ds_read_b64 v[196:197], v14 offset:160
    ds_read_b64 v[198:199], v14 offset:168
    ds_read_b64 v[200:201], v14 offset:192
    v_mov_b32_dpp v131, v131 row_shr:1 row_mask:0xf bank_mask:0xf bound_ctrl:0
    v_mov_b32_dpp v132, v132 row_shr:1 row_mask:0xf bank_mask:0xf bound_ctrl:0
    v_mov_b32_dpp v133, v133 row_shr:1 row_mask:0xf bank_mask:0xf bound_ctrl:0
    v_mfma_f32_32x32x16_bf16 v[160:175], v[224:227], v[112:115], v[160:175]
    ds_read_b64 v[202:203], v14 offset:200
    ds_read_b64 v[204:205], v14 offset:224
    ds_read_b64 v[206:207], v14 offset:232
    v_mov_b32_dpp v134, v134 row_shr:1 row_mask:0xf bank_mask:0xf bound_ctrl:0
    v_mov_b32_dpp v135, v135 row_shr:1 row_mask:0xf bank_mask:0xf bound_ctrl:0
    v_mov_b32_dpp v136, v136 row_shr:1 row_mask:0xf bank_mask:0xf bound_ctrl:0
    v_mfma_f32_32x32x16_bf16 v[160:175], v[228:231], v[116:119], v[160:175]
    v_mov_b32_dpp v137, v137 row_shr:1 row_mask:0xf bank_mask:0xf bound_ctrl:0
    v_mov_b32_dpp v138, v138 row_shr:1 row_mask:0xf bank_mask:0xf bound_ctrl:0
    v_mov_b32_dpp v139, v139 row_shr:1 row_mask:0xf bank_mask:0xf bound_ctrl:0
    v_mfma_f32_32x32x16_bf16 v[160:175], v[232:235], v[120:123], v[160:175]
    v_mov_b32_dpp v140, v140 row_shr:1 row_mask:0xf bank_mask:0xf bound_ctrl:0
    v_mov_b32_dpp v141, v141 row_shr:1 row_mask:0xf bank_mask:0xf bound_ctrl:0
    v_mfma_f32_32x32x16_bf16 v[160:175], v[236:239], v[124:127], v[160:175]
    v_mov_b32_dpp v142, v142 row_shr:1 row_mask:0xf bank_mask:0xf bound_ctrl:0
    v_mov_b32_dpp v143, v143 row_shr:1 row_mask:0xf bank_mask:0xf bound_ctrl:0
    s_waitcnt lgkmcnt(0)
    v_mfma_f32_32x32x16_bf16 v[144:159], v[176:179], v[64:67], v[144:159]
    ds_read_b64 v[208:209], v14 offset:2048
    ds_read_b64 v[210:211], v14 offset:2056
    s_nop 2
    v_mfma_f32_32x32x16_bf16 v[144:159], v[180:183], v[68:71], v[144:159]
    ds_read_b64 v[212:213], v14 offset:2080
    ds_read_b64 v[214:215], v14 offset:2088
    s_nop 2
    v_mfma_f32_32x32x16_bf16 v[144:159], v[184:187], v[72:75], v[144:159]
    ds_read_b64 v[216:217], v14 offset:2112
    ds_read_b64 v[218:219], v14 offset:2120
    v_and_b32_dpp v160, v160, v15 row_shr:1 row_mask:0xf bank_mask:0xf bound_ctrl:0
    v_and_b32_dpp v161, v161, v15 row_shr:1 row_mask:0xf bank_mask:0xf bound_ctrl:0
    v_and_b32_dpp v162, v162, v15 row_shr:1 row_mask:0xf bank_mask:0xf bound_ctrl:0
    v_mfma_f32_32x32x16_bf16 v[144:159], v[188:191], v[76:79], v[144:159]
    ds_read_b64 v[220:221], v14 offset:2144
    ds_read_b64 v[222:223], v14 offset:2152
    v_and_b32_dpp v163, v163, v15 row_shr:1 row_mask:0xf bank_mask:0xf bound_ctrl:0
    v_and_b32_dpp v164, v164, v15 row_shr:1 row_mask:0xf bank_mask:0xf bound_ctrl:0
    v_and_b32_dpp v165, v165, v15 row_shr:1 row_mask:0xf bank_mask:0xf bound_ctrl:0
    v_mfma_f32_32x32x16_bf16 v[144:159], v[192:195], v[80:83], v[144:159]
    ds_read_b64 v[224:225], v14 offset:2176
    ds_read_b64 v[226:227], v14 offset:2184
    v_and_b32_dpp v166, v166, v15 row_shr:1 row_mask:0xf bank_mask:0xf bound_ctrl:0
    v_and_b32_dpp v167, v167, v15 row_shr:1 row_mask:0xf bank_mask:0xf bound_ctrl:0
    v_and_b32_dpp v168, v168, v15 row_shr:1 row_mask:0xf bank_mask:0xf bound_ctrl:0
    v_mfma_f32_32x32x16_bf16 v[144:159], v[196:199], v[84:87], v[144:159]
    ds_read_b64 v[228:229], v14 offset:2208
    ds_read_b64 v[230:231], v14 offset:2216
    v_and_b32_dpp v169, v169, v15 row_shr:1 row_mask:0xf bank_mask:0xf bound_ctrl:0
    v_and_b32_dpp v170, v170, v15 row_shr:1 row_mask:0xf bank_mask:0xf bound_ctrl:0
    v_and_b32_dpp v171, v171, v15 row_shr:1 row_mask:0xf bank_mask:0xf bound_ctrl:0
    v_mfma_f32_32x32x16_bf16 v[144:159], v[200:203], v[88:91], v[144:159]
    ds_read_b64 v[232:233], v14 offset:2240
    ds_read_b64 v[234:235], v14 offset:2248
    v_and_b32_dpp v172, v172, v15 row_shr:1 row_mask:0xf bank_mask:0xf bound_ctrl:0
    v_and_b32_dpp v173, v173, v15 row_shr:1 row_mask:0xf bank_mask:0xf bound_ctrl:0
    v_mfma_f32_32x32x16_bf16 v[144:159], v[204:207], v[92:95], v[144:159]
    ds_read_b64 v[236:237], v14 offset:2272
    ds_read_b64 v[238:239], v14 offset:2280
    v_and_b32_dpp v174, v174, v15 row_shr:1 row_mask:0xf bank_mask:0xf bound_ctrl:0
    v_and_b32_dpp v175, v175, v15 row_shr:1 row_mask:0xf bank_mask:0xf bound_ctrl:0
    v_mfma_f32_32x32x16_bf16 v[128:143], v[176:179], v[32:35], v[128:143]
    v_mfma_f32_32x32x16_bf16 v[128:143], v[180:183], v[36:39], v[128:143]
    v_mfma_f32_32x32x16_bf16 v[128:143], v[184:187], v[40:43], v[128:143]
    v_mul_u32_u24 v16, 272, v7
    v_add_u32 v16, s34, v16
    v_add_u32 v16, 4388, v16
    v_lshlrev_b32 v17, 2, v8
    v_sub_u32 v16, v16, v17
    v_lshlrev_b32 v17, 5, v9
    v_sub_u32 v16, v16, v17
    v_mfma_f32_32x32x16_bf16 v[128:143], v[188:191], v[44:47], v[128:143]
    ds_read_b32 v64, v16 offset:216
    ds_read_b32 v65, v16 offset:208
    ds_read_b32 v66, v16 offset:200
    ds_read_b32 v67, v16 offset:192
    ds_read_b32 v68, v16 offset:152
    ds_read_b32 v69, v16 offset:144
    v_mfma_f32_32x32x16_bf16 v[128:143], v[192:195], v[48:51], v[128:143]
    ds_read_b32 v70, v16 offset:136
    ds_read_b32 v71, v16 offset:128
    ds_read_b32 v72, v16 offset:88
    ds_read_b32 v73, v16 offset:80
    ds_read_b32 v74, v16 offset:72
    ds_read_b32 v75, v16 offset:64
    v_mfma_f32_32x32x16_bf16 v[128:143], v[196:199], v[52:55], v[128:143]
    ds_read_b32 v76, v16 offset:24
    ds_read_b32 v77, v16 offset:16
    ds_read_b32 v78, v16 offset:8
    ds_read_b32 v79, v16 offset:0
    s_lshr_b32 s44, s20, 1
    s_and_b32 s45, s20, 1
    v_mfma_f32_32x32x16_bf16 v[128:143], v[200:203], v[56:59], v[128:143]
    s_cmp_eq_u32 s44, 1
    s_cselect_b32 s44, s33, s32
    s_lshl_b32 s46, s44, 16
    s_and_b32 s47, s44, 0xffff0000
    s_cmp_eq_u32 s45, 1
    s_cselect_b32 s44, s47, s46
    v_mfma_f32_32x32x16_bf16 v[128:143], v[204:207], v[60:63], v[128:143]
    v_mul_u32_u24 v18, 264, v7
    v_lshl_add_u32 v18, v9, 5, v18
    v_lshl_add_u32 v18, v8, 2, v18
    v_add_u32 v18, s34, v18
    v_mul_u32_u24 v17, 264, v2
    v_lshl_add_u32 v17, v1, 2, v17
    s_waitcnt lgkmcnt(0)
    v_mfma_f32_32x32x16_bf16 v[160:175], v[208:211], v[96:99], v[160:175]
    v_mfma_f32_32x32x16_bf16 v[160:175], v[212:215], v[100:103], v[160:175]
    v_mfma_f32_32x32x16_bf16 v[160:175], v[216:219], v[104:107], v[160:175]
    v_and_b32 v80, 0xffff0000, v64
    v_lshlrev_b32 v64, 16, v64
    v_and_b32 v81, 0xffff0000, v65
    v_lshlrev_b32 v65, 16, v65
    v_and_b32 v82, 0xffff0000, v66
    v_lshlrev_b32 v66, 16, v66
    v_mfma_f32_32x32x16_bf16 v[160:175], v[220:223], v[108:111], v[160:175]
    v_and_b32 v83, 0xffff0000, v67
    v_lshlrev_b32 v67, 16, v67
    v_and_b32 v84, 0xffff0000, v68
    v_lshlrev_b32 v68, 16, v68
    v_and_b32 v85, 0xffff0000, v69
    v_lshlrev_b32 v69, 16, v69
    v_mfma_f32_32x32x16_bf16 v[160:175], v[224:227], v[112:115], v[160:175]
    v_and_b32 v86, 0xffff0000, v70
    v_lshlrev_b32 v70, 16, v70
    v_and_b32 v87, 0xffff0000, v71
    v_lshlrev_b32 v71, 16, v71
    v_and_b32 v88, 0xffff0000, v72
    v_mfma_f32_32x32x16_bf16 v[160:175], v[228:231], v[116:119], v[160:175]
    v_lshlrev_b32 v72, 16, v72
    v_and_b32 v89, 0xffff0000, v73
    v_lshlrev_b32 v73, 16, v73
    v_and_b32 v90, 0xffff0000, v74
    v_lshlrev_b32 v74, 16, v74
    v_mfma_f32_32x32x16_bf16 v[160:175], v[232:235], v[120:123], v[160:175]
    v_and_b32 v91, 0xffff0000, v75
    v_lshlrev_b32 v75, 16, v75
    v_and_b32 v92, 0xffff0000, v76
    v_lshlrev_b32 v76, 16, v76
    v_and_b32 v93, 0xffff0000, v77
    v_mfma_f32_32x32x16_bf16 v[160:175], v[236:239], v[124:127], v[160:175]
    v_lshlrev_b32 v77, 16, v77
    v_and_b32 v94, 0xffff0000, v78
    v_lshlrev_b32 v78, 16, v78
    v_and_b32 v95, 0xffff0000, v79
    v_lshlrev_b32 v79, 16, v79
    s_mov_b32 s48, 0x05040100
    s_mov_b32 s49, 0x07060302
    s_nop 11
    v_add_f32_dpp v128, v160, v128 row_shr:8 row_mask:0xf bank_mask:0xf bound_ctrl:0
    v_add_f32_dpp v129, v161, v129 row_shr:8 row_mask:0xf bank_mask:0xf bound_ctrl:0
    v_add_f32_dpp v130, v162, v130 row_shr:8 row_mask:0xf bank_mask:0xf bound_ctrl:0
    v_add_f32_dpp v131, v163, v131 row_shr:8 row_mask:0xf bank_mask:0xf bound_ctrl:0
    v_add_f32_dpp v132, v164, v132 row_shr:8 row_mask:0xf bank_mask:0xf bound_ctrl:0
    v_add_f32_dpp v133, v165, v133 row_shr:8 row_mask:0xf bank_mask:0xf bound_ctrl:0
    v_add_f32_dpp v134, v166, v134 row_shr:8 row_mask:0xf bank_mask:0xf bound_ctrl:0
    v_add_f32_dpp v135, v167, v135 row_shr:8 row_mask:0xf bank_mask:0xf bound_ctrl:0
    v_add_f32_dpp v136, v168, v136 row_shr:8 row_mask:0xf bank_mask:0xf bound_ctrl:0
    v_add_f32_dpp v137, v169, v137 row_shr:8 row_mask:0xf bank_mask:0xf bound_ctrl:0
    v_add_f32_dpp v138, v170, v138 row_shr:8 row_mask:0xf bank_mask:0xf bound_ctrl:0
    v_add_f32_dpp v139, v171, v139 row_shr:8 row_mask:0xf bank_mask:0xf bound_ctrl:0
    v_add_f32_dpp v140, v172, v140 row_shr:8 row_mask:0xf bank_mask:0xf bound_ctrl:0
    v_add_f32_dpp v141, v173, v141 row_shr:8 row_mask:0xf bank_mask:0xf bound_ctrl:0
    v_add_f32_dpp v142, v174, v142 row_shr:8 row_mask:0xf bank_mask:0xf bound_ctrl:0
    v_add_f32_dpp v143, v175, v143 row_shr:8 row_mask:0xf bank_mask:0xf bound_ctrl:0
    s_mov_b32 s42, 0xff00ff00
    s_mov_b32 s43, 0xff00ff00
    s_mov_b64 exec, s[42:43]
    v_add_f32 v144, v160, v144
    v_add_f32 v145, v161, v145
    v_add_f32 v146, v162, v146
    v_add_f32 v147, v163, v147
    v_add_f32 v148, v164, v148
    v_add_f32 v149, v165, v149
    v_add_f32 v150, v166, v150
    v_add_f32 v151, v167, v151
    v_add_f32 v152, v168, v152
    v_add_f32 v153, v169, v153
    v_add_f32 v154, v170, v154
    v_add_f32 v155, v171, v155
    v_add_f32 v156, v172, v156
    v_add_f32 v157, v173, v157
    v_add_f32 v158, v174, v158
    v_add_f32 v159, v175, v159
    s_mov_b64 exec, -1
    v_fma_f32 v128, v80, s44, v128
    v_fma_f32 v144, v64, s44, v144
    v_fma_f32 v129, v81, s44, v129
    v_fma_f32 v145, v65, s44, v145
    v_fma_f32 v130, v82, s44, v130
    v_fma_f32 v146, v66, s44, v146
    v_fma_f32 v131, v83, s44, v131
    v_fma_f32 v147, v67, s44, v147
    v_fma_f32 v132, v84, s44, v132
    v_fma_f32 v148, v68, s44, v148
    v_fma_f32 v133, v85, s44, v133
    v_fma_f32 v149, v69, s44, v149
    v_fma_f32 v134, v86, s44, v134
    v_fma_f32 v150, v70, s44, v150
    v_fma_f32 v135, v87, s44, v135
    v_fma_f32 v151, v71, s44, v151
    v_fma_f32 v136, v88, s44, v136
    v_fma_f32 v152, v72, s44, v152
    v_fma_f32 v137, v89, s44, v137
    v_fma_f32 v153, v73, s44, v153
    v_fma_f32 v138, v90, s44, v138
    v_fma_f32 v154, v74, s44, v154
    v_fma_f32 v139, v91, s44, v139
    v_fma_f32 v155, v75, s44, v155
    v_fma_f32 v140, v92, s44, v140
    v_fma_f32 v156, v76, s44, v156
    v_fma_f32 v141, v93, s44, v141
    v_fma_f32 v157, v77, s44, v157
    v_fma_f32 v142, v94, s44, v142
    v_fma_f32 v158, v78, s44, v158
    v_fma_f32 v143, v95, s44, v143
    v_fma_f32 v159, v79, s44, v159
    v_cvt_pk_bf16_f32 v32, v128, v144
    v_cvt_pk_bf16_f32 v33, v129, v145
    v_cvt_pk_bf16_f32 v34, v130, v146
    v_cvt_pk_bf16_f32 v35, v131, v147
    v_cvt_pk_bf16_f32 v36, v132, v148
    v_cvt_pk_bf16_f32 v37, v133, v149
    v_cvt_pk_bf16_f32 v38, v134, v150
    v_cvt_pk_bf16_f32 v39, v135, v151
    v_cvt_pk_bf16_f32 v40, v136, v152
    v_cvt_pk_bf16_f32 v41, v137, v153
    v_cvt_pk_bf16_f32 v42, v138, v154
    v_cvt_pk_bf16_f32 v43, v139, v155
    v_cvt_pk_bf16_f32 v44, v140, v156
    v_cvt_pk_bf16_f32 v45, v141, v157
    v_cvt_pk_bf16_f32 v46, v142, v158
    v_cvt_pk_bf16_f32 v47, v143, v159
    ds_write_b32 v18, v32 offset:0
    ds_write_b32 v18, v33 offset:8
    ds_write_b32 v18, v34 offset:16
    ds_write_b32 v18, v35 offset:24
    ds_write_b32 v18, v36 offset:64
    ds_write_b32 v18, v37 offset:72
    ds_write_b32 v18, v38 offset:80
    ds_write_b32 v18, v39 offset:88
    ds_write_b32 v18, v40 offset:128
    ds_write_b32 v18, v41 offset:136
    ds_write_b32 v18, v42 offset:144
    ds_write_b32 v18, v43 offset:152
    ds_write_b32 v18, v44 offset:192
    ds_write_b32 v18, v45 offset:200
    ds_write_b32 v18, v46 offset:208
    ds_write_b32 v18, v47 offset:216
    s_waitcnt lgkmcnt(0)
    s_barrier
    ds_read_b32 v48, v17 offset:0
    ds_read_b32 v49, v17 offset:9472
    ds_read_b32 v50, v17 offset:18944
    ds_read_b32 v51, v17 offset:28416
    ds_read_b32 v52, v17 offset:1056
    ds_read_b32 v53, v17 offset:10528
    ds_read_b32 v54, v17 offset:20000
    ds_read_b32 v55, v17 offset:29472
    ds_read_b32 v56, v17 offset:2112
    ds_read_b32 v57, v17 offset:11584
    ds_read_b32 v58, v17 offset:21056
    ds_read_b32 v59, v17 offset:30528
    ds_read_b32 v60, v17 offset:3168
    ds_read_b32 v61, v17 offset:12640
    ds_read_b32 v62, v17 offset:22112
    ds_read_b32 v63, v17 offset:31584
    s_waitcnt lgkmcnt(0)
    v_perm_b32 v96, v49, v48, s48
    v_perm_b32 v98, v49, v48, s49
    v_perm_b32 v97, v51, v50, s48
    v_perm_b32 v99, v51, v50, s49
    v_perm_b32 v100, v53, v52, s48
    v_perm_b32 v102, v53, v52, s49
    v_perm_b32 v101, v55, v54, s48
    v_perm_b32 v103, v55, v54, s49
    v_perm_b32 v104, v57, v56, s48
    v_perm_b32 v106, v57, v56, s49
    v_perm_b32 v105, v59, v58, s48
    v_perm_b32 v107, v59, v58, s49
    v_perm_b32 v108, v61, v60, s48
    v_perm_b32 v110, v61, v60, s49
    v_perm_b32 v109, v63, v62, s48
    v_perm_b32 v111, v63, v62, s49
    v_lshrrev_b32 v20, 3, v0
    v_lshrrev_b32 v21, 4, v20
    v_and_b32 v22, 15, v20
    v_mul_u32_u24 v23, 20480, v20
    v_sub_u32 v23, v4, v23
    s_mov_b32 s40, 1601536
    v_mul_lo_u32 v24, v21, s40
    v_add_u32 v24, v24, v23
    v_add_u32 v25, 1, v22
    v_mul_u32_u24 v25, 20480, v25
    v_add_u32 v25, v25, v24
    v_cmp_eq_u32 s[42:43], 15, v22
    v_cmp_eq_u32 s[44:45], 0, v22
    v_add_u32 v26, 3203072, v24
    v_add_u32 v27, 348160, v24
    v_cndmask_b32 v26, v27, v26, s[42:43]
    v_cmp_ne_u32 vcc, 0, v20
    s_and_b64 s[46:47], s[44:45], vcc
    s_or_b64 s[46:47], s[46:47], s[42:43]
    v_cmp_ne_u32 vcc, 31, v20
    s_and_b64 s[52:53], s[42:43], vcc
    s_or_b64 s[52:53], s[52:53], s[44:45]
    s_or_b64 s[44:45], s[44:45], s[42:43]
    s_add_u32 s39, s38, 9060352
    buffer_store_dwordx4 v[96:99], v25, s[28:31], s39 offen sc1
    s_mov_b64 exec, s[46:47]
    s_cbranch_execz k1_kernel_halo9
    s_sub_u32 s41, s39, 1601536
    buffer_store_dwordx4 v[96:99], v26, s[28:31], s41 offen sc1
k1_kernel_halo9:
    s_mov_b64 exec, -1
    s_add_u32 s39, s39, 3203072
    buffer_store_dwordx4 v[100:103], v25, s[28:31], s39 offen sc1
    s_mov_b64 exec, s[44:45]
    s_cbranch_execz k1_kernel_halo10
    s_sub_u32 s41, s39, 1601536
    buffer_store_dwordx4 v[100:103], v26, s[28:31], s41 offen sc1
k1_kernel_halo10:
    s_mov_b64 exec, -1
    s_add_u32 s39, s39, 3203072
    buffer_store_dwordx4 v[104:107], v25, s[28:31], s39 offen sc1
    s_mov_b64 exec, s[44:45]
    s_cbranch_execz k1_kernel_halo11
    s_sub_u32 s41, s39, 1601536
    buffer_store_dwordx4 v[104:107], v26, s[28:31], s41 offen sc1
k1_kernel_halo11:
    s_mov_b64 exec, -1
    s_add_u32 s39, s39, 3203072
    buffer_store_dwordx4 v[108:111], v25, s[28:31], s39 offen sc1
    s_mov_b64 exec, s[52:53]
    s_cbranch_execz k1_kernel_halo12
    s_sub_u32 s41, s39, 1601536
    buffer_store_dwordx4 v[108:111], v26, s[28:31], s41 offen sc1
k1_kernel_halo12:
    s_mov_b64 exec, -1
    s_add_u32 s39, s39, 3203072
    s_waitcnt vmcnt(0)
    s_endpgm
k1_side:
    s_cmp_ge_u32 s54, 188
    s_cbranch_scc1 k1_end
    s_cmp_lt_u32 s54, 128
    s_cbranch_scc1 k1_kernel_mp13
    s_getpc_b64 s[62:63]
k1_pcm:
    s_add_u32 s62, s62, k1_modf-k1_pcm
    s_addc_u32 s63, s63, 0
    s_lshl_b32 s64, s20, 10
    v_lshlrev_b32 v247, 4, v1
    v_add_u32 v247, s64, v247
    global_load_dwordx4 v[240:243], v247, s[62:63]
k1_kernel_mp13:
    s_cmp_lt_u32 s54, 128
    s_cbranch_scc1 k1_kernel_sx14
    s_mov_b32 s61, s54
    s_cmp_lg_u32 s20, 0
    s_cbranch_scc1 k1_kernel_sw16
    s_and_b32 s55, s2, 7
    s_lshl_b32 s57, s55, 9
    s_add_u32 s57, s57, 9056256
    v_mov_b32 v250, 0
    v_and_b32 v248, 31, v0
    v_lshlrev_b32 v248, 2, v248
    s_waitcnt lgkmcnt(0)
    s_mov_b32 s28, s10
    s_mov_b32 s29, s11
    s_mov_b32 s30, 268435456
    s_mov_b32 s31, 0x00020000
    buffer_load_dword v251, v250, s[28:31], s57 offen sc1
    s_mov_b32 s23, 1
    s_waitcnt vmcnt(0)
    v_add_u32 v251, 1, v251
k1_kernel_sw15:
    buffer_load_dword v249, v248, s[28:31], s57 offen offset:256 sc1
    s_waitcnt vmcnt(0)
    v_cmp_eq_u32 vcc, v251, v249
    s_sub_u32 s23, s23, 1
    s_cmp_eq_u64 vcc, -1
    s_cbranch_scc1 k1_kernel_sw16
    s_sleep 16
    s_cmp_lg_u32 s23, 0
    s_cbranch_scc1 k1_kernel_sw15
k1_kernel_sw16:
    s_barrier
    s_mov_b32 s54, s61
k1_kernel_sx14:
    s_cmp_lt_u32 s54, 128
    s_cbranch_scc1 k1_pf
    s_branch k1_mod0
k1_side2:
    s_load_dwordx2 s[10:11], s[0:1], 120
    s_load_dwordx8 s[12:19], s[0:1], 56
    v_lshrrev_b32 v2, 6, v0
    v_and_b32 v1, 63, v0
    v_readfirstlane_b32 s20, v2
    s_waitcnt lgkmcnt(0)
    s_mov_b32 s28, s10
    s_mov_b32 s29, s11
    s_mov_b32 s30, 268435456
    s_mov_b32 s31, 0x00020000
    s_sub_u32 s21, s54, 0
    v_lshrrev_b32 v3, 3, v0
    v_and_b32 v4, 7, v0
    v_mul_u32_u24 v5, 144, v3
    v_lshl_add_u32 v5, v4, 4, v5
    v_and_b32 v6, 15, v1
    v_lshrrev_b32 v7, 4, v1
    v_lshrrev_b32 v8, 2, v6
    v_lshl_add_u32 v8, v7, 3, v8
    v_mul_u32_u24 v8, 144, v8
    v_and_b32 v9, 3, v6
    v_lshl_add_u32 v8, v9, 3, v8
    s_lshl_b32 s22, s20, 5
    v_add_u32 v8, s22, v8
    v_lshlrev_b32 v9, 4, v1
    s_cmp_lt_u32 s21, 10
    s_cbranch_scc1 k1_kernel_pk17
    s_cmp_lt_u32 s21, 20
    s_cbranch_scc1 k1_kernel_pk18
    s_cmp_lt_u32 s21, 48
    s_cbranch_scc1 k1_kernel_pk19
    s_cmp_lt_u32 s21, 78
    s_cbranch_scc1 k1_kernel_pk20
    s_branch k1_kernel_pke21
k1_kernel_pk17:
    s_mov_b32 s24, s12
    s_mov_b32 s25, s13
    s_mov_b32 s26, 819200
    s_mov_b32 s27, 0x00020000
    s_sub_u32 s32, s21, 0
    s_mul_i32 s33, s32, 52429
    s_lshr_b32 s33, s33, 18
    s_mul_i32 s34, s33, 5
    s_sub_u32 s34, s32, s34
    s_lshl_b32 s34, s34, 1
    v_mul_u32_u24 v10, 1280, v3
    v_lshl_add_u32 v10, v4, 4, v10
    s_mul_i32 s35, s33, 409600
    s_lshl_b32 s36, s34, 7
    s_add_u32 s35, s35, s36
    buffer_load_dwordx4 v[32:35], v10, s[24:27], s35 offen offset:0
    s_add_u32 s35, s35, 40960
    buffer_load_dwordx4 v[36:39], v10, s[24:27], s35 offen offset:0
    s_add_u32 s35, s35, 40960
    buffer_load_dwordx4 v[40:43], v10, s[24:27], s35 offen offset:0
    s_add_u32 s35, s35, 40960
    buffer_load_dwordx4 v[44:47], v10, s[24:27], s35 offen offset:0
    s_add_u32 s35, s35, 40960
    buffer_load_dwordx4 v[48:51], v10, s[24:27], s35 offen offset:0
    s_add_u32 s35, s35, 40960
    buffer_load_dwordx4 v[52:55], v10, s[24:27], s35 offen offset:0
    s_add_u32 s35, s35, 40960
    buffer_load_dwordx4 v[56:59], v10, s[24:27], s35 offen offset:0
    s_add_u32 s35, s35, 40960
    buffer_load_dwordx4 v[60:63], v10, s[24:27], s35 offen offset:0
    s_add_u32 s35, s35, 40960
    buffer_load_dwordx4 v[64:67], v10, s[24:27], s35 offen offset:0
    s_add_u32 s35, s35, 40960
    buffer_load_dwordx4 v[68:71], v10, s[24:27], s35 offen offset:0
    s_sub_u32 s35, s35, 368640
    buffer_load_dwordx4 v[72:75], v10, s[24:27], s35 offen offset:128
    s_add_u32 s35, s35, 40960
    buffer_load_dwordx4 v[76:79], v10, s[24:27], s35 offen offset:128
    s_add_u32 s35, s35, 40960
    buffer_load_dwordx4 v[80:83], v10, s[24:27], s35 offen offset:128
    s_add_u32 s35, s35, 40960
    buffer_load_dwordx4 v[84:87], v10, s[24:27], s35 offen offset:128
    s_add_u32 s35, s35, 40960
    buffer_load_dwordx4 v[88:91], v10, s[24:27], s35 offen offset:128
    s_add_u32 s35, s35, 40960
    buffer_load_dwordx4 v[92:95], v10, s[24:27], s35 offen offset:128
    s_add_u32 s35, s35, 40960
    buffer_load_dwordx4 v[96:99], v10, s[24:27], s35 offen offset:128
    s_add_u32 s35, s35, 40960
    buffer_load_dwordx4 v[100:103], v10, s[24:27], s35 offen offset:128
    s_add_u32 s35, s35, 40960
    buffer_load_dwordx4 v[104:107], v10, s[24:27], s35 offen offset:128
    s_add_u32 s35, s35, 40960
    buffer_load_dwordx4 v[108:111], v10, s[24:27], s35 offen offset:128
    s_lshl_b32 s36, s34, 2
    s_add_u32 s36, s36, s20
    s_mul_i32 s38, s36, 52429
    s_lshr_b32 s38, s38, 18
    s_mul_i32 s39, s38, 5
    s_sub_u32 s39, s36, s39
    s_mul_i32 s37, s38, 100
    s_mul_i32 s40, s33, 50
    s_add_u32 s37, s37, s40
    s_add_u32 s37, s37, s39
    s_lshl_b32 s37, s37, 10
    s_add_u32 s37, s37, 2764800
    s_waitcnt vmcnt(19)
    ds_write_b128 v5, v[32:35] offset:0
    s_waitcnt vmcnt(18)
    ds_write_b128 v5, v[36:39] offset:4608
    s_waitcnt vmcnt(17)
    ds_write_b128 v5, v[40:43] offset:9216
    s_waitcnt vmcnt(16)
    ds_write_b128 v5, v[44:47] offset:13824
    s_waitcnt vmcnt(15)
    ds_write_b128 v5, v[48:51] offset:18432
    s_waitcnt vmcnt(14)
    ds_write_b128 v5, v[52:55] offset:23040
    s_waitcnt vmcnt(13)
    ds_write_b128 v5, v[56:59] offset:27648
    s_waitcnt vmcnt(12)
    ds_write_b128 v5, v[60:63] offset:32256
    s_waitcnt vmcnt(11)
    ds_write_b128 v5, v[64:67] offset:36864
    s_waitcnt vmcnt(10)
    ds_write_b128 v5, v[68:71] offset:41472
    s_waitcnt lgkmcnt(0)
    s_barrier
    ds_read_b64_tr_b16 v[32:33], v8 offset:0
    ds_read_b64_tr_b16 v[34:35], v8 offset:576
    ds_read_b64_tr_b16 v[36:37], v8 offset:4608
    ds_read_b64_tr_b16 v[38:39], v8 offset:5184
    ds_read_b64_tr_b16 v[40:41], v8 offset:9216
    ds_read_b64_tr_b16 v[42:43], v8 offset:9792
    ds_read_b64_tr_b16 v[44:45], v8 offset:13824
    ds_read_b64_tr_b16 v[46:47], v8 offset:14400
    ds_read_b64_tr_b16 v[48:49], v8 offset:18432
    ds_read_b64_tr_b16 v[50:51], v8 offset:19008
    ds_read_b64_tr_b16 v[52:53], v8 offset:23040
    ds_read_b64_tr_b16 v[54:55], v8 offset:23616
    ds_read_b64_tr_b16 v[56:57], v8 offset:27648
    ds_read_b64_tr_b16 v[58:59], v8 offset:28224
    ds_read_b64_tr_b16 v[60:61], v8 offset:32256
    ds_read_b64_tr_b16 v[62:63], v8 offset:32832
    ds_read_b64_tr_b16 v[64:65], v8 offset:36864
    ds_read_b64_tr_b16 v[66:67], v8 offset:37440
    ds_read_b64_tr_b16 v[68:69], v8 offset:41472
    ds_read_b64_tr_b16 v[70:71], v8 offset:42048
    v_mov_b32 v12, 0
    v_mov_b32 v13, 0x3f803f80
    s_waitcnt lgkmcnt(15)
    s_add_u32 s38, s37, 0
    buffer_store_dwordx4 v[32:35], v9, s[28:31], s38 offen sc1
    v_dot2_f32_bf16 v12, v32, v13, v12
    v_dot2_f32_bf16 v12, v33, v13, v12
    v_dot2_f32_bf16 v12, v34, v13, v12
    v_dot2_f32_bf16 v12, v35, v13, v12
    s_waitcnt lgkmcnt(15)
    s_add_u32 s38, s37, 5120
    buffer_store_dwordx4 v[36:39], v9, s[28:31], s38 offen sc1
    v_dot2_f32_bf16 v12, v36, v13, v12
    v_dot2_f32_bf16 v12, v37, v13, v12
    v_dot2_f32_bf16 v12, v38, v13, v12
    v_dot2_f32_bf16 v12, v39, v13, v12
    s_waitcnt lgkmcnt(14)
    s_add_u32 s38, s37, 10240
    buffer_store_dwordx4 v[40:43], v9, s[28:31], s38 offen sc1
    v_dot2_f32_bf16 v12, v40, v13, v12
    v_dot2_f32_bf16 v12, v41, v13, v12
    v_dot2_f32_bf16 v12, v42, v13, v12
    v_dot2_f32_bf16 v12, v43, v13, v12
    s_waitcnt lgkmcnt(12)
    s_add_u32 s38, s37, 15360
    buffer_store_dwordx4 v[44:47], v9, s[28:31], s38 offen sc1
    v_dot2_f32_bf16 v12, v44, v13, v12
    v_dot2_f32_bf16 v12, v45, v13, v12
    v_dot2_f32_bf16 v12, v46, v13, v12
    v_dot2_f32_bf16 v12, v47, v13, v12
    s_waitcnt lgkmcnt(10)
    s_add_u32 s38, s37, 20480
    buffer_store_dwordx4 v[48:51], v9, s[28:31], s38 offen sc1
    v_dot2_f32_bf16 v12, v48, v13, v12
    v_dot2_f32_bf16 v12, v49, v13, v12
    v_dot2_f32_bf16 v12, v50, v13, v12
    v_dot2_f32_bf16 v12, v51, v13, v12
    s_waitcnt lgkmcnt(8)
    s_add_u32 s38, s37, 25600
    buffer_store_dwordx4 v[52:55], v9, s[28:31], s38 offen sc1
    v_dot2_f32_bf16 v12, v52, v13, v12
    v_dot2_f32_bf16 v12, v53, v13, v12
    v_dot2_f32_bf16 v12, v54, v13, v12
    v_dot2_f32_bf16 v12, v55, v13, v12
    s_waitcnt lgkmcnt(6)
    s_add_u32 s38, s37, 30720
    buffer_store_dwordx4 v[56:59], v9, s[28:31], s38 offen sc1
    v_dot2_f32_bf16 v12, v56, v13, v12
    v_dot2_f32_bf16 v12, v57, v13, v12
    v_dot2_f32_bf16 v12, v58, v13, v12
    v_dot2_f32_bf16 v12, v59, v13, v12
    s_waitcnt lgkmcnt(4)
    s_add_u32 s38, s37, 35840
    buffer_store_dwordx4 v[60:63], v9, s[28:31], s38 offen sc1
    v_dot2_f32_bf16 v12, v60, v13, v12
    v_dot2_f32_bf16 v12, v61, v13, v12
    v_dot2_f32_bf16 v12, v62, v13, v12
    v_dot2_f32_bf16 v12, v63, v13, v12
    s_waitcnt lgkmcnt(2)
    s_add_u32 s38, s37, 40960
    buffer_store_dwordx4 v[64:67], v9, s[28:31], s38 offen sc1
    v_dot2_f32_bf16 v12, v64, v13, v12
    v_dot2_f32_bf16 v12, v65, v13, v12
    v_dot2_f32_bf16 v12, v66, v13, v12
    v_dot2_f32_bf16 v12, v67, v13, v12
    s_waitcnt lgkmcnt(0)
    s_add_u32 s38, s37, 46080
    buffer_store_dwordx4 v[68:71], v9, s[28:31], s38 offen sc1
    v_dot2_f32_bf16 v12, v68, v13, v12
    v_dot2_f32_bf16 v12, v69, v13, v12
    v_dot2_f32_bf16 v12, v70, v13, v12
    v_dot2_f32_bf16 v12, v71, v13, v12
    s_nop 2
    v_mov_b32 v13, v12
    s_nop 1
    v_permlane32_swap_b32 v13, v12
    v_add_f32 v12, v12, v13
    v_mov_b32 v13, v12
    s_nop 1
    v_permlane16_swap_b32 v13, v12
    v_add_f32 v12, v12, v13
    s_mul_i32 s38, s33, 7168
    s_lshl_b32 s39, s36, 6
    s_add_u32 s38, s38, s39
    s_add_u32 s38, s38, 2748416
    v_lshlrev_b32 v14, 2, v1
    v_cmp_gt_u32 vcc, 16, v1
    s_and_saveexec_b64 s[40:41], vcc
    buffer_store_dword v12, v14, s[28:31], s38 offen sc1
    s_mov_b64 exec, -1
    s_add_u32 s34, s34, 1
    s_barrier
    s_lshl_b32 s36, s34, 2
    s_add_u32 s36, s36, s20
    s_mul_i32 s38, s36, 52429
    s_lshr_b32 s38, s38, 18
    s_mul_i32 s39, s38, 5
    s_sub_u32 s39, s36, s39
    s_mul_i32 s37, s38, 100
    s_mul_i32 s40, s33, 50
    s_add_u32 s37, s37, s40
    s_add_u32 s37, s37, s39
    s_lshl_b32 s37, s37, 10
    s_add_u32 s37, s37, 2764800
    s_waitcnt vmcnt(20)
    ds_write_b128 v5, v[72:75] offset:0
    s_waitcnt vmcnt(19)
    ds_write_b128 v5, v[76:79] offset:4608
    s_waitcnt vmcnt(18)
    ds_write_b128 v5, v[80:83] offset:9216
    s_waitcnt vmcnt(17)
    ds_write_b128 v5, v[84:87] offset:13824
    s_waitcnt vmcnt(16)
    ds_write_b128 v5, v[88:91] offset:18432
    s_waitcnt vmcnt(15)
    ds_write_b128 v5, v[92:95] offset:23040
    s_waitcnt vmcnt(14)
    ds_write_b128 v5, v[96:99] offset:27648
    s_waitcnt vmcnt(13)
    ds_write_b128 v5, v[100:103] offset:32256
    s_waitcnt vmcnt(12)
    ds_write_b128 v5, v[104:107] offset:36864
    s_waitcnt vmcnt(11)
    ds_write_b128 v5, v[108:111] offset:41472
    s_waitcnt lgkmcnt(0)
    s_barrier
    ds_read_b64_tr_b16 v[72:73], v8 offset:0
    ds_read_b64_tr_b16 v[74:75], v8 offset:576
    ds_read_b64_tr_b16 v[76:77], v8 offset:4608
    ds_read_b64_tr_b16 v[78:79], v8 offset:5184
    ds_read_b64_tr_b16 v[80:81], v8 offset:9216
    ds_read_b64_tr_b16 v[82:83], v8 offset:9792
    ds_read_b64_tr_b16 v[84:85], v8 offset:13824
    ds_read_b64_tr_b16 v[86:87], v8 offset:14400
    ds_read_b64_tr_b16 v[88:89], v8 offset:18432
    ds_read_b64_tr_b16 v[90:91], v8 offset:19008
    ds_read_b64_tr_b16 v[92:93], v8 offset:23040
    ds_read_b64_tr_b16 v[94:95], v8 offset:23616
    ds_read_b64_tr_b16 v[96:97], v8 offset:27648
    ds_read_b64_tr_b16 v[98:99], v8 offset:28224
    ds_read_b64_tr_b16 v[100:101], v8 offset:32256
    ds_read_b64_tr_b16 v[102:103], v8 offset:32832
    ds_read_b64_tr_b16 v[104:105], v8 offset:36864
    ds_read_b64_tr_b16 v[106:107], v8 offset:37440
    ds_read_b64_tr_b16 v[108:109], v8 offset:41472
    ds_read_b64_tr_b16 v[110:111], v8 offset:42048
    v_mov_b32 v12, 0
    v_mov_b32 v13, 0x3f803f80
    s_waitcnt lgkmcnt(15)
    s_add_u32 s38, s37, 0
    buffer_store_dwordx4 v[72:75], v9, s[28:31], s38 offen sc1
    v_dot2_f32_bf16 v12, v72, v13, v12
    v_dot2_f32_bf16 v12, v73, v13, v12
    v_dot2_f32_bf16 v12, v74, v13, v12
    v_dot2_f32_bf16 v12, v75, v13, v12
    s_waitcnt lgkmcnt(15)
    s_add_u32 s38, s37, 5120
    buffer_store_dwordx4 v[76:79], v9, s[28:31], s38 offen sc1
    v_dot2_f32_bf16 v12, v76, v13, v12
    v_dot2_f32_bf16 v12, v77, v13, v12
    v_dot2_f32_bf16 v12, v78, v13, v12
    v_dot2_f32_bf16 v12, v79, v13, v12
    s_waitcnt lgkmcnt(14)
    s_add_u32 s38, s37, 10240
    buffer_store_dwordx4 v[80:83], v9, s[28:31], s38 offen sc1
    v_dot2_f32_bf16 v12, v80, v13, v12
    v_dot2_f32_bf16 v12, v81, v13, v12
    v_dot2_f32_bf16 v12, v82, v13, v12
    v_dot2_f32_bf16 v12, v83, v13, v12
    s_waitcnt lgkmcnt(12)
    s_add_u32 s38, s37, 15360
    buffer_store_dwordx4 v[84:87], v9, s[28:31], s38 offen sc1
    v_dot2_f32_bf16 v12, v84, v13, v12
    v_dot2_f32_bf16 v12, v85, v13, v12
    v_dot2_f32_bf16 v12, v86, v13, v12
    v_dot2_f32_bf16 v12, v87, v13, v12
    s_waitcnt lgkmcnt(10)
    s_add_u32 s38, s37, 20480
    buffer_store_dwordx4 v[88:91], v9, s[28:31], s38 offen sc1
    v_dot2_f32_bf16 v12, v88, v13, v12
    v_dot2_f32_bf16 v12, v89, v13, v12
    v_dot2_f32_bf16 v12, v90, v13, v12
    v_dot2_f32_bf16 v12, v91, v13, v12
    s_waitcnt lgkmcnt(8)
    s_add_u32 s38, s37, 25600
    buffer_store_dwordx4 v[92:95], v9, s[28:31], s38 offen sc1
    v_dot2_f32_bf16 v12, v92, v13, v12
    v_dot2_f32_bf16 v12, v93, v13, v12
    v_dot2_f32_bf16 v12, v94, v13, v12
    v_dot2_f32_bf16 v12, v95, v13, v12
    s_waitcnt lgkmcnt(6)
    s_add_u32 s38, s37, 30720
    buffer_store_dwordx4 v[96:99], v9, s[28:31], s38 offen sc1
    v_dot2_f32_bf16 v12, v96, v13, v12
    v_dot2_f32_bf16 v12, v97, v13, v12
    v_dot2_f32_bf16 v12, v98, v13, v12
    v_dot2_f32_bf16 v12, v99, v13, v12
    s_waitcnt lgkmcnt(4)
    s_add_u32 s38, s37, 35840
    buffer_store_dwordx4 v[100:103], v9, s[28:31], s38 offen sc1
    v_dot2_f32_bf16 v12, v100, v13, v12
    v_dot2_f32_bf16 v12, v101, v13, v12
    v_dot2_f32_bf16 v12, v102, v13, v12
    v_dot2_f32_bf16 v12, v103, v13, v12
    s_waitcnt lgkmcnt(2)
    s_add_u32 s38, s37, 40960
    buffer_store_dwordx4 v[104:107], v9, s[28:31], s38 offen sc1
    v_dot2_f32_bf16 v12, v104, v13, v12
    v_dot2_f32_bf16 v12, v105, v13, v12
    v_dot2_f32_bf16 v12, v106, v13, v12
    v_dot2_f32_bf16 v12, v107, v13, v12
    s_waitcnt lgkmcnt(0)
    s_add_u32 s38, s37, 46080
    buffer_store_dwordx4 v[108:111], v9, s[28:31], s38 offen sc1
    v_dot2_f32_bf16 v12, v108, v13, v12
    v_dot2_f32_bf16 v12, v109, v13, v12
    v_dot2_f32_bf16 v12, v110, v13, v12
    v_dot2_f32_bf16 v12, v111, v13, v12
    s_nop 2
    v_mov_b32 v13, v12
    s_nop 1
    v_permlane32_swap_b32 v13, v12
    v_add_f32 v12, v12, v13
    v_mov_b32 v13, v12
    s_nop 1
    v_permlane16_swap_b32 v13, v12
    v_add_f32 v12, v12, v13
    s_mul_i32 s38, s33, 7168
    s_lshl_b32 s39, s36, 6
    s_add_u32 s38, s38, s39
    s_add_u32 s38, s38, 2748416
    v_lshlrev_b32 v14, 2, v1
    v_cmp_gt_u32 vcc, 16, v1
    s_and_saveexec_b64 s[40:41], vcc
    buffer_store_dword v12, v14, s[28:31], s38 offen sc1
    s_mov_b64 exec, -1
    s_endpgm
k1_kernel_pk18:
    s_mov_b32 s24, s14
    s_mov_b32 s25, s15
    s_mov_b32 s26, 819200
    s_mov_b32 s27, 0x00020000
    s_sub_u32 s32, s21, 10
    s_mul_i32 s33, s32, 52429
    s_lshr_b32 s33, s33, 18
    s_mul_i32 s34, s33, 5
    s_sub_u32 s34, s32, s34
    s_lshl_b32 s34, s34, 1
    v_mul_u32_u24 v10, 1280, v3
    v_lshl_add_u32 v10, v4, 4, v10
    s_mul_i32 s35, s33, 409600
    s_lshl_b32 s36, s34, 7
    s_add_u32 s35, s35, s36
    buffer_load_dwordx4 v[32:35], v10, s[24:27], s35 offen offset:0
    s_add_u32 s35, s35, 40960
    buffer_load_dwordx4 v[36:39], v10, s[24:27], s35 offen offset:0
    s_add_u32 s35, s35, 40960
    buffer_load_dwordx4 v[40:43], v10, s[24:27], s35 offen offset:0
    s_add_u32 s35, s35, 40960
    buffer_load_dwordx4 v[44:47], v10, s[24:27], s35 offen offset:0
    s_add_u32 s35, s35, 40960
    buffer_load_dwordx4 v[48:51], v10, s[24:27], s35 offen offset:0
    s_add_u32 s35, s35, 40960
    buffer_load_dwordx4 v[52:55], v10, s[24:27], s35 offen offset:0
    s_add_u32 s35, s35, 40960
    buffer_load_dwordx4 v[56:59], v10, s[24:27], s35 offen offset:0
    s_add_u32 s35, s35, 40960
    buffer_load_dwordx4 v[60:63], v10, s[24:27], s35 offen offset:0
    s_add_u32 s35, s35, 40960
    buffer_load_dwordx4 v[64:67], v10, s[24:27], s35 offen offset:0
    s_add_u32 s35, s35, 40960
    buffer_load_dwordx4 v[68:71], v10, s[24:27], s35 offen offset:0
    s_sub_u32 s35, s35, 368640
    buffer_load_dwordx4 v[72:75], v10, s[24:27], s35 offen offset:128
    s_add_u32 s35, s35, 40960
    buffer_load_dwordx4 v[76:79], v10, s[24:27], s35 offen offset:128
    s_add_u32 s35, s35, 40960
    buffer_load_dwordx4 v[80:83], v10, s[24:27], s35 offen offset:128
    s_add_u32 s35, s35, 40960
    buffer_load_dwordx4 v[84:87], v10, s[24:27], s35 offen offset:128
    s_add_u32 s35, s35, 40960
    buffer_load_dwordx4 v[88:91], v10, s[24:27], s35 offen offset:128
    s_add_u32 s35, s35, 40960
    buffer_load_dwordx4 v[92:95], v10, s[24:27], s35 offen offset:128
    s_add_u32 s35, s35, 40960
    buffer_load_dwordx4 v[96:99], v10, s[24:27], s35 offen offset:128
    s_add_u32 s35, s35, 40960
    buffer_load_dwordx4 v[100:103], v10, s[24:27], s35 offen offset:128
    s_add_u32 s35, s35, 40960
    buffer_load_dwordx4 v[104:107], v10, s[24:27], s35 offen offset:128
    s_add_u32 s35, s35, 40960
    buffer_load_dwordx4 v[108:111], v10, s[24:27], s35 offen offset:128
    s_lshl_b32 s36, s34, 2
    s_add_u32 s36, s36, s20
    s_mul_i32 s38, s36, 52429
    s_lshr_b32 s38, s38, 18
    s_mul_i32 s39, s38, 5
    s_sub_u32 s39, s36, s39
    s_mul_i32 s37, s38, 100
    s_mul_i32 s40, s33, 50
    s_add_u32 s37, s37, s40
    s_add_u32 s37, s37, s39
    s_lshl_b32 s37, s37, 10
    s_add_u32 s37, s37, 3584000
    s_waitcnt vmcnt(19)
    ds_write_b128 v5, v[32:35] offset:0
    s_waitcnt vmcnt(18)
    ds_write_b128 v5, v[36:39] offset:4608
    s_waitcnt vmcnt(17)
    ds_write_b128 v5, v[40:43] offset:9216
    s_waitcnt vmcnt(16)
    ds_write_b128 v5, v[44:47] offset:13824
    s_waitcnt vmcnt(15)
    ds_write_b128 v5, v[48:51] offset:18432
    s_waitcnt vmcnt(14)
    ds_write_b128 v5, v[52:55] offset:23040
    s_waitcnt vmcnt(13)
    ds_write_b128 v5, v[56:59] offset:27648
    s_waitcnt vmcnt(12)
    ds_write_b128 v5, v[60:63] offset:32256
    s_waitcnt vmcnt(11)
    ds_write_b128 v5, v[64:67] offset:36864
    s_waitcnt vmcnt(10)
    ds_write_b128 v5, v[68:71] offset:41472
    s_waitcnt lgkmcnt(0)
    s_barrier
    ds_read_b64_tr_b16 v[32:33], v8 offset:0
    ds_read_b64_tr_b16 v[34:35], v8 offset:576
    ds_read_b64_tr_b16 v[36:37], v8 offset:4608
    ds_read_b64_tr_b16 v[38:39], v8 offset:5184
    ds_read_b64_tr_b16 v[40:41], v8 offset:9216
    ds_read_b64_tr_b16 v[42:43], v8 offset:9792
    ds_read_b64_tr_b16 v[44:45], v8 offset:13824
    ds_read_b64_tr_b16 v[46:47], v8 offset:14400
    ds_read_b64_tr_b16 v[48:49], v8 offset:18432
    ds_read_b64_tr_b16 v[50:51], v8 offset:19008
    ds_read_b64_tr_b16 v[52:53], v8 offset:23040
    ds_read_b64_tr_b16 v[54:55], v8 offset:23616
    ds_read_b64_tr_b16 v[56:57], v8 offset:27648
    ds_read_b64_tr_b16 v[58:59], v8 offset:28224
    ds_read_b64_tr_b16 v[60:61], v8 offset:32256
    ds_read_b64_tr_b16 v[62:63], v8 offset:32832
    ds_read_b64_tr_b16 v[64:65], v8 offset:36864
    ds_read_b64_tr_b16 v[66:67], v8 offset:37440
    ds_read_b64_tr_b16 v[68:69], v8 offset:41472
    ds_read_b64_tr_b16 v[70:71], v8 offset:42048
    s_waitcnt lgkmcnt(15)
    s_add_u32 s38, s37, 0
    buffer_store_dwordx4 v[32:35], v9, s[28:31], s38 offen sc1
    s_waitcnt lgkmcnt(15)
    s_add_u32 s38, s37, 5120
    buffer_store_dwordx4 v[36:39], v9, s[28:31], s38 offen sc1
    s_waitcnt lgkmcnt(14)
    s_add_u32 s38, s37, 10240
    buffer_store_dwordx4 v[40:43], v9, s[28:31], s38 offen sc1
    s_waitcnt lgkmcnt(12)
    s_add_u32 s38, s37, 15360
    buffer_store_dwordx4 v[44:47], v9, s[28:31], s38 offen sc1
    s_waitcnt lgkmcnt(10)
    s_add_u32 s38, s37, 20480
    buffer_store_dwordx4 v[48:51], v9, s[28:31], s38 offen sc1
    s_waitcnt lgkmcnt(8)
    s_add_u32 s38, s37, 25600
    buffer_store_dwordx4 v[52:55], v9, s[28:31], s38 offen sc1
    s_waitcnt lgkmcnt(6)
    s_add_u32 s38, s37, 30720
    buffer_store_dwordx4 v[56:59], v9, s[28:31], s38 offen sc1
    s_waitcnt lgkmcnt(4)
    s_add_u32 s38, s37, 35840
    buffer_store_dwordx4 v[60:63], v9, s[28:31], s38 offen sc1
    s_waitcnt lgkmcnt(2)
    s_add_u32 s38, s37, 40960
    buffer_store_dwordx4 v[64:67], v9, s[28:31], s38 offen sc1
    s_waitcnt lgkmcnt(0)
    s_add_u32 s38, s37, 46080
    buffer_store_dwordx4 v[68:71], v9, s[28:31], s38 offen sc1
    s_add_u32 s34, s34, 1
    s_barrier
    s_lshl_b32 s36, s34, 2
    s_add_u32 s36, s36, s20
    s_mul_i32 s38, s36, 52429
    s_lshr_b32 s38, s38, 18
    s_mul_i32 s39, s38, 5
    s_sub_u32 s39, s36, s39
    s_mul_i32 s37, s38, 100
    s_mul_i32 s40, s33, 50
    s_add_u32 s37, s37, s40
    s_add_u32 s37, s37, s39
    s_lshl_b32 s37, s37, 10
    s_add_u32 s37, s37, 3584000
    s_waitcnt vmcnt(19)
    ds_write_b128 v5, v[72:75] offset:0
    s_waitcnt vmcnt(18)
    ds_write_b128 v5, v[76:79] offset:4608
    s_waitcnt vmcnt(17)
    ds_write_b128 v5, v[80:83] offset:9216
    s_waitcnt vmcnt(16)
    ds_write_b128 v5, v[84:87] offset:13824
    s_waitcnt vmcnt(15)
    ds_write_b128 v5, v[88:91] offset:18432
    s_waitcnt vmcnt(14)
    ds_write_b128 v5, v[92:95] offset:23040
    s_waitcnt vmcnt(13)
    ds_write_b128 v5, v[96:99] offset:27648
    s_waitcnt vmcnt(12)
    ds_write_b128 v5, v[100:103] offset:32256
    s_waitcnt vmcnt(11)
    ds_write_b128 v5, v[104:107] offset:36864
    s_waitcnt vmcnt(10)
    ds_write_b128 v5, v[108:111] offset:41472
    s_waitcnt lgkmcnt(0)
    s_barrier
    ds_read_b64_tr_b16 v[72:73], v8 offset:0
    ds_read_b64_tr_b16 v[74:75], v8 offset:576
    ds_read_b64_tr_b16 v[76:77], v8 offset:4608
    ds_read_b64_tr_b16 v[78:79], v8 offset:5184
    ds_read_b64_tr_b16 v[80:81], v8 offset:9216
    ds_read_b64_tr_b16 v[82:83], v8 offset:9792
    ds_read_b64_tr_b16 v[84:85], v8 offset:13824
    ds_read_b64_tr_b16 v[86:87], v8 offset:14400
    ds_read_b64_tr_b16 v[88:89], v8 offset:18432
    ds_read_b64_tr_b16 v[90:91], v8 offset:19008
    ds_read_b64_tr_b16 v[92:93], v8 offset:23040
    ds_read_b64_tr_b16 v[94:95], v8 offset:23616
    ds_read_b64_tr_b16 v[96:97], v8 offset:27648
    ds_read_b64_tr_b16 v[98:99], v8 offset:28224
    ds_read_b64_tr_b16 v[100:101], v8 offset:32256
    ds_read_b64_tr_b16 v[102:103], v8 offset:32832
    ds_read_b64_tr_b16 v[104:105], v8 offset:36864
    ds_read_b64_tr_b16 v[106:107], v8 offset:37440
    ds_read_b64_tr_b16 v[108:109], v8 offset:41472
    ds_read_b64_tr_b16 v[110:111], v8 offset:42048
    s_waitcnt lgkmcnt(15)
    s_add_u32 s38, s37, 0
    buffer_store_dwordx4 v[72:75], v9, s[28:31], s38 offen sc1
    s_waitcnt lgkmcnt(15)
    s_add_u32 s38, s37, 5120
    buffer_store_dwordx4 v[76:79], v9, s[28:31], s38 offen sc1
    s_waitcnt lgkmcnt(14)
    s_add_u32 s38, s37, 10240
    buffer_store_dwordx4 v[80:83], v9, s[28:31], s38 offen sc1
    s_waitcnt lgkmcnt(12)
    s_add_u32 s38, s37, 15360
    buffer_store_dwordx4 v[84:87], v9, s[28:31], s38 offen sc1
    s_waitcnt lgkmcnt(10)
    s_add_u32 s38, s37, 20480
    buffer_store_dwordx4 v[88:91], v9, s[28:31], s38 offen sc1
    s_waitcnt lgkmcnt(8)
    s_add_u32 s38, s37, 25600
    buffer_store_dwordx4 v[92:95], v9, s[28:31], s38 offen sc1
    s_waitcnt lgkmcnt(6)
    s_add_u32 s38, s37, 30720
    buffer_store_dwordx4 v[96:99], v9, s[28:31], s38 offen sc1
    s_waitcnt lgkmcnt(4)
    s_add_u32 s38, s37, 35840
    buffer_store_dwordx4 v[100:103], v9, s[28:31], s38 offen sc1
    s_waitcnt lgkmcnt(2)
    s_add_u32 s38, s37, 40960
    buffer_store_dwordx4 v[104:107], v9, s[28:31], s38 offen sc1
    s_waitcnt lgkmcnt(0)
    s_add_u32 s38, s37, 46080
    buffer_store_dwordx4 v[108:111], v9, s[28:31], s38 offen sc1
    s_endpgm
k1_kernel_pk19:
    s_mov_b32 s24, s16
    s_mov_b32 s25, s17
    s_mov_b32 s26, 2211840
    s_mov_b32 s27, 0x00020000
    s_sub_u32 s32, s21, 20
    s_mul_i32 s33, s32, 4682
    s_lshr_b32 s33, s33, 16
    s_mul_i32 s34, s33, 14
    s_sub_u32 s34, s32, s34
    s_lshl_b32 s34, s34, 1
    v_mul_u32_u24 v10, 3456, v3
    v_lshl_add_u32 v10, v4, 4, v10
    s_mul_i32 s35, s33, 1105920
    s_lshl_b32 s36, s34, 7
    s_add_u32 s35, s35, s36
    buffer_load_dwordx4 v[32:35], v10, s[24:27], s35 offen offset:0
    s_add_u32 s35, s35, 110592
    buffer_load_dwordx4 v[36:39], v10, s[24:27], s35 offen offset:0
    s_add_u32 s35, s35, 110592
    buffer_load_dwordx4 v[40:43], v10, s[24:27], s35 offen offset:0
    s_add_u32 s35, s35, 110592
    buffer_load_dwordx4 v[44:47], v10, s[24:27], s35 offen offset:0
    s_add_u32 s35, s35, 110592
    buffer_load_dwordx4 v[48:51], v10, s[24:27], s35 offen offset:0
    s_add_u32 s35, s35, 110592
    buffer_load_dwordx4 v[52:55], v10, s[24:27], s35 offen offset:0
    s_add_u32 s35, s35, 110592
    buffer_load_dwordx4 v[56:59], v10, s[24:27], s35 offen offset:0
    s_add_u32 s35, s35, 110592
    buffer_load_dwordx4 v[60:63], v10, s[24:27], s35 offen offset:0
    s_add_u32 s35, s35, 110592
    buffer_load_dwordx4 v[64:67], v10, s[24:27], s35 offen offset:0
    s_add_u32 s35, s35, 110592
    buffer_load_dwordx4 v[68:71], v10, s[24:27], s35 offen offset:0
    s_sub_u32 s35, s35, 995328
    buffer_load_dwordx4 v[72:75], v10, s[24:27], s35 offen offset:128
    s_add_u32 s35, s35, 110592
    buffer_load_dwordx4 v[76:79], v10, s[24:27], s35 offen offset:128
    s_add_u32 s35, s35, 110592
    buffer_load_dwordx4 v[80:83], v10, s[24:27], s35 offen offset:128
    s_add_u32 s35, s35, 110592
    buffer_load_dwordx4 v[84:87], v10, s[24:27], s35 offen offset:128
    s_add_u32 s35, s35, 110592
    buffer_load_dwordx4 v[88:91], v10, s[24:27], s35 offen offset:128
    s_add_u32 s35, s35, 110592
    buffer_load_dwordx4 v[92:95], v10, s[24:27], s35 offen offset:128
    s_add_u32 s35, s35, 110592
    buffer_load_dwordx4 v[96:99], v10, s[24:27], s35 offen offset:128
    s_add_u32 s35, s35, 110592
    buffer_load_dwordx4 v[100:103], v10, s[24:27], s35 offen offset:128
    s_add_u32 s35, s35, 110592
    buffer_load_dwordx4 v[104:107], v10, s[24:27], s35 offen offset:128
    s_add_u32 s35, s35, 110592
    buffer_load_dwordx4 v[108:111], v10, s[24:27], s35 offen offset:128
    s_lshl_b32 s36, s34, 2
    s_add_u32 s36, s36, s20
    s_mul_i32 s38, s36, 9363
    s_lshr_b32 s38, s38, 16
    s_mul_i32 s39, s38, 7
    s_sub_u32 s39, s36, s39
    s_mul_i32 s37, s38, 140
    s_mul_i32 s40, s33, 70
    s_add_u32 s37, s37, s40
    s_add_u32 s37, s37, s39
    s_lshl_b32 s37, s37, 10
    s_add_u32 s37, s37, 4403200
    s_waitcnt vmcnt(19)
    ds_write_b128 v5, v[32:35] offset:0
    s_waitcnt vmcnt(18)
    ds_write_b128 v5, v[36:39] offset:4608
    s_waitcnt vmcnt(17)
    ds_write_b128 v5, v[40:43] offset:9216
    s_waitcnt vmcnt(16)
    ds_write_b128 v5, v[44:47] offset:13824
    s_waitcnt vmcnt(15)
    ds_write_b128 v5, v[48:51] offset:18432
    s_waitcnt vmcnt(14)
    ds_write_b128 v5, v[52:55] offset:23040
    s_waitcnt vmcnt(13)
    ds_write_b128 v5, v[56:59] offset:27648
    s_waitcnt vmcnt(12)
    ds_write_b128 v5, v[60:63] offset:32256
    s_waitcnt vmcnt(11)
    ds_write_b128 v5, v[64:67] offset:36864
    s_waitcnt vmcnt(10)
    ds_write_b128 v5, v[68:71] offset:41472
    s_waitcnt lgkmcnt(0)
    s_barrier
    ds_read_b64_tr_b16 v[32:33], v8 offset:0
    ds_read_b64_tr_b16 v[34:35], v8 offset:576
    ds_read_b64_tr_b16 v[36:37], v8 offset:4608
    ds_read_b64_tr_b16 v[38:39], v8 offset:5184
    ds_read_b64_tr_b16 v[40:41], v8 offset:9216
    ds_read_b64_tr_b16 v[42:43], v8 offset:9792
    ds_read_b64_tr_b16 v[44:45], v8 offset:13824
    ds_read_b64_tr_b16 v[46:47], v8 offset:14400
    ds_read_b64_tr_b16 v[48:49], v8 offset:18432
    ds_read_b64_tr_b16 v[50:51], v8 offset:19008
    ds_read_b64_tr_b16 v[52:53], v8 offset:23040
    ds_read_b64_tr_b16 v[54:55], v8 offset:23616
    ds_read_b64_tr_b16 v[56:57], v8 offset:27648
    ds_read_b64_tr_b16 v[58:59], v8 offset:28224
    ds_read_b64_tr_b16 v[60:61], v8 offset:32256
    ds_read_b64_tr_b16 v[62:63], v8 offset:32832
    ds_read_b64_tr_b16 v[64:65], v8 offset:36864
    ds_read_b64_tr_b16 v[66:67], v8 offset:37440
    ds_read_b64_tr_b16 v[68:69], v8 offset:41472
    ds_read_b64_tr_b16 v[70:71], v8 offset:42048
    v_mov_b32 v12, 0
    v_mov_b32 v13, 0x3f803f80
    s_waitcnt lgkmcnt(15)
    s_add_u32 s38, s37, 0
    buffer_store_dwordx4 v[32:35], v9, s[28:31], s38 offen sc1
    v_dot2_f32_bf16 v12, v32, v13, v12
    v_dot2_f32_bf16 v12, v33, v13, v12
    v_dot2_f32_bf16 v12, v34, v13, v12
    v_dot2_f32_bf16 v12, v35, v13, v12
    s_waitcnt lgkmcnt(15)
    s_add_u32 s38, s37, 7168
    buffer_store_dwordx4 v[36:39], v9, s[28:31], s38 offen sc1
    v_dot2_f32_bf16 v12, v36, v13, v12
    v_dot2_f32_bf16 v12, v37, v13, v12
    v_dot2_f32_bf16 v12, v38, v13, v12
    v_dot2_f32_bf16 v12, v39, v13, v12
    s_waitcnt lgkmcnt(14)
    s_add_u32 s38, s37, 14336
    buffer_store_dwordx4 v[40:43], v9, s[28:31], s38 offen sc1
    v_dot2_f32_bf16 v12, v40, v13, v12
    v_dot2_f32_bf16 v12, v41, v13, v12
    v_dot2_f32_bf16 v12, v42, v13, v12
    v_dot2_f32_bf16 v12, v43, v13, v12
    s_waitcnt lgkmcnt(12)
    s_add_u32 s38, s37, 21504
    buffer_store_dwordx4 v[44:47], v9, s[28:31], s38 offen sc1
    v_dot2_f32_bf16 v12, v44, v13, v12
    v_dot2_f32_bf16 v12, v45, v13, v12
    v_dot2_f32_bf16 v12, v46, v13, v12
    v_dot2_f32_bf16 v12, v47, v13, v12
    s_waitcnt lgkmcnt(10)
    s_add_u32 s38, s37, 28672
    buffer_store_dwordx4 v[48:51], v9, s[28:31], s38 offen sc1
    v_dot2_f32_bf16 v12, v48, v13, v12
    v_dot2_f32_bf16 v12, v49, v13, v12
    v_dot2_f32_bf16 v12, v50, v13, v12
    v_dot2_f32_bf16 v12, v51, v13, v12
    s_waitcnt lgkmcnt(8)
    s_add_u32 s38, s37, 35840
    buffer_store_dwordx4 v[52:55], v9, s[28:31], s38 offen sc1
    v_dot2_f32_bf16 v12, v52, v13, v12
    v_dot2_f32_bf16 v12, v53, v13, v12
    v_dot2_f32_bf16 v12, v54, v13, v12
    v_dot2_f32_bf16 v12, v55, v13, v12
    s_waitcnt lgkmcnt(6)
    s_add_u32 s38, s37, 43008
    buffer_store_dwordx4 v[56:59], v9, s[28:31], s38 offen sc1
    v_dot2_f32_bf16 v12, v56, v13, v12
    v_dot2_f32_bf16 v12, v57, v13, v12
    v_dot2_f32_bf16 v12, v58, v13, v12
    v_dot2_f32_bf16 v12, v59, v13, v12
    s_waitcnt lgkmcnt(4)
    s_add_u32 s38, s37, 50176
    buffer_store_dwordx4 v[60:63], v9, s[28:31], s38 offen sc1
    v_dot2_f32_bf16 v12, v60, v13, v12
    v_dot2_f32_bf16 v12, v61, v13, v12
    v_dot2_f32_bf16 v12, v62, v13, v12
    v_dot2_f32_bf16 v12, v63, v13, v12
    s_waitcnt lgkmcnt(2)
    s_add_u32 s38, s37, 57344
    buffer_store_dwordx4 v[64:67], v9, s[28:31], s38 offen sc1
    v_dot2_f32_bf16 v12, v64, v13, v12
    v_dot2_f32_bf16 v12, v65, v13, v12
    v_dot2_f32_bf16 v12, v66, v13, v12
    v_dot2_f32_bf16 v12, v67, v13, v12
    s_waitcnt lgkmcnt(0)
    s_add_u32 s38, s37, 64512
    buffer_store_dwordx4 v[68:71], v9, s[28:31], s38 offen sc1
    v_dot2_f32_bf16 v12, v68, v13, v12
    v_dot2_f32_bf16 v12, v69, v13, v12
    v_dot2_f32_bf16 v12, v70, v13, v12
    v_dot2_f32_bf16 v12, v71, v13, v12
    s_nop 2
    v_mov_b32 v13, v12
    s_nop 1
    v_permlane32_swap_b32 v13, v12
    v_add_f32 v12, v12, v13
    v_mov_b32 v13, v12
    s_nop 1
    v_permlane16_swap_b32 v13, v12
    v_add_f32 v12, v12, v13
    s_mul_i32 s38, s33, 7168
    s_lshl_b32 s39, s36, 6
    s_add_u32 s38, s38, s39
    s_add_u32 s38, s38, 2732032
    v_lshlrev_b32 v14, 2, v1
    v_cmp_gt_u32 vcc, 16, v1
    s_and_saveexec_b64 s[40:41], vcc
    buffer_store_dword v12, v14, s[28:31], s38 offen sc1
    s_mov_b64 exec, -1
    s_add_u32 s34, s34, 1
    s_barrier
    s_lshl_b32 s36, s34, 2
    s_add_u32 s36, s36, s20
    s_mul_i32 s38, s36, 9363
    s_lshr_b32 s38, s38, 16
    s_mul_i32 s39, s38, 7
    s_sub_u32 s39, s36, s39
    s_mul_i32 s37, s38, 140
    s_mul_i32 s40, s33, 70
    s_add_u32 s37, s37, s40
    s_add_u32 s37, s37, s39
    s_lshl_b32 s37, s37, 10
    s_add_u32 s37, s37, 4403200
    s_waitcnt vmcnt(20)
    ds_write_b128 v5, v[72:75] offset:0
    s_waitcnt vmcnt(19)
    ds_write_b128 v5, v[76:79] offset:4608
    s_waitcnt vmcnt(18)
    ds_write_b128 v5, v[80:83] offset:9216
    s_waitcnt vmcnt(17)
    ds_write_b128 v5, v[84:87] offset:13824
    s_waitcnt vmcnt(16)
    ds_write_b128 v5, v[88:91] offset:18432
    s_waitcnt vmcnt(15)
    ds_write_b128 v5, v[92:95] offset:23040
    s_waitcnt vmcnt(14)
    ds_write_b128 v5, v[96:99] offset:27648
    s_waitcnt vmcnt(13)
    ds_write_b128 v5, v[100:103] offset:32256
    s_waitcnt vmcnt(12)
    ds_write_b128 v5, v[104:107] offset:36864
    s_waitcnt vmcnt(11)
    ds_write_b128 v5, v[108:111] offset:41472
    s_waitcnt lgkmcnt(0)
    s_barrier
    ds_read_b64_tr_b16 v[72:73], v8 offset:0
    ds_read_b64_tr_b16 v[74:75], v8 offset:576
    ds_read_b64_tr_b16 v[76:77], v8 offset:4608
    ds_read_b64_tr_b16 v[78:79], v8 offset:5184
    ds_read_b64_tr_b16 v[80:81], v8 offset:9216
    ds_read_b64_tr_b16 v[82:83], v8 offset:9792
    ds_read_b64_tr_b16 v[84:85], v8 offset:13824
    ds_read_b64_tr_b16 v[86:87], v8 offset:14400
    ds_read_b64_tr_b16 v[88:89], v8 offset:18432
    ds_read_b64_tr_b16 v[90:91], v8 offset:19008
    ds_read_b64_tr_b16 v[92:93], v8 offset:23040
    ds_read_b64_tr_b16 v[94:95], v8 offset:23616
    ds_read_b64_tr_b16 v[96:97], v8 offset:27648
    ds_read_b64_tr_b16 v[98:99], v8 offset:28224
    ds_read_b64_tr_b16 v[100:101], v8 offset:32256
    ds_read_b64_tr_b16 v[102:103], v8 offset:32832
    ds_read_b64_tr_b16 v[104:105], v8 offset:36864
    ds_read_b64_tr_b16 v[106:107], v8 offset:37440
    ds_read_b64_tr_b16 v[108:109], v8 offset:41472
    ds_read_b64_tr_b16 v[110:111], v8 offset:42048
    v_mov_b32 v12, 0
    v_mov_b32 v13, 0x3f803f80
    s_waitcnt lgkmcnt(15)
    s_add_u32 s38, s37, 0
    buffer_store_dwordx4 v[72:75], v9, s[28:31], s38 offen sc1
    v_dot2_f32_bf16 v12, v72, v13, v12
    v_dot2_f32_bf16 v12, v73, v13, v12
    v_dot2_f32_bf16 v12, v74, v13, v12
    v_dot2_f32_bf16 v12, v75, v13, v12
    s_waitcnt lgkmcnt(15)
    s_add_u32 s38, s37, 7168
    buffer_store_dwordx4 v[76:79], v9, s[28:31], s38 offen sc1
    v_dot2_f32_bf16 v12, v76, v13, v12
    v_dot2_f32_bf16 v12, v77, v13, v12
    v_dot2_f32_bf16 v12, v78, v13, v12
    v_dot2_f32_bf16 v12, v79, v13, v12
    s_waitcnt lgkmcnt(14)
    s_add_u32 s38, s37, 14336
    buffer_store_dwordx4 v[80:83], v9, s[28:31], s38 offen sc1
    v_dot2_f32_bf16 v12, v80, v13, v12
    v_dot2_f32_bf16 v12, v81, v13, v12
    v_dot2_f32_bf16 v12, v82, v13, v12
    v_dot2_f32_bf16 v12, v83, v13, v12
    s_waitcnt lgkmcnt(12)
    s_add_u32 s38, s37, 21504
    buffer_store_dwordx4 v[84:87], v9, s[28:31], s38 offen sc1
    v_dot2_f32_bf16 v12, v84, v13, v12
    v_dot2_f32_bf16 v12, v85, v13, v12
    v_dot2_f32_bf16 v12, v86, v13, v12
    v_dot2_f32_bf16 v12, v87, v13, v12
    s_waitcnt lgkmcnt(10)
    s_add_u32 s38, s37, 28672
    buffer_store_dwordx4 v[88:91], v9, s[28:31], s38 offen sc1
    v_dot2_f32_bf16 v12, v88, v13, v12
    v_dot2_f32_bf16 v12, v89, v13, v12
    v_dot2_f32_bf16 v12, v90, v13, v12
    v_dot2_f32_bf16 v12, v91, v13, v12
    s_waitcnt lgkmcnt(8)
    s_add_u32 s38, s37, 35840
    buffer_store_dwordx4 v[92:95], v9, s[28:31], s38 offen sc1
    v_dot2_f32_bf16 v12, v92, v13, v12
    v_dot2_f32_bf16 v12, v93, v13, v12
    v_dot2_f32_bf16 v12, v94, v13, v12
    v_dot2_f32_bf16 v12, v95, v13, v12
    s_waitcnt lgkmcnt(6)
    s_add_u32 s38, s37, 43008
    buffer_store_dwordx4 v[96:99], v9, s[28:31], s38 offen sc1
    v_dot2_f32_bf16 v12, v96, v13, v12
    v_dot2_f32_bf16 v12, v97, v13, v12
    v_dot2_f32_bf16 v12, v98, v13, v12
    v_dot2_f32_bf16 v12, v99, v13, v12
    s_waitcnt lgkmcnt(4)
    s_add_u32 s38, s37, 50176
    buffer_store_dwordx4 v[100:103], v9, s[28:31], s38 offen sc1
    v_dot2_f32_bf16 v12, v100, v13, v12
    v_dot2_f32_bf16 v12, v101, v13, v12
    v_dot2_f32_bf16 v12, v102, v13, v12
    v_dot2_f32_bf16 v12, v103, v13, v12
    s_waitcnt lgkmcnt(2)
    s_add_u32 s38, s37, 57344
    buffer_store_dwordx4 v[104:107], v9, s[28:31], s38 offen sc1
    v_dot2_f32_bf16 v12, v104, v13, v12
    v_dot2_f32_bf16 v12, v105, v13, v12
    v_dot2_f32_bf16 v12, v106, v13, v12
    v_dot2_f32_bf16 v12, v107, v13, v12
    s_waitcnt lgkmcnt(0)
    s_add_u32 s38, s37, 64512
    buffer_store_dwordx4 v[108:111], v9, s[28:31], s38 offen sc1
    v_dot2_f32_bf16 v12, v108, v13, v12
    v_dot2_f32_bf16 v12, v109, v13, v12
    v_dot2_f32_bf16 v12, v110, v13, v12
    v_dot2_f32_bf16 v12, v111, v13, v12
    s_nop 2
    v_mov_b32 v13, v12
    s_nop 1
    v_permlane32_swap_b32 v13, v12
    v_add_f32 v12, v12, v13
    v_mov_b32 v13, v12
    s_nop 1
    v_permlane16_swap_b32 v13, v12
    v_add_f32 v12, v12, v13
    s_mul_i32 s38, s33, 7168
    s_lshl_b32 s39, s36, 6
    s_add_u32 s38, s38, s39
    s_add_u32 s38, s38, 2732032
    v_lshlrev_b32 v14, 2, v1
    v_cmp_gt_u32 vcc, 16, v1
    s_and_saveexec_b64 s[40:41], vcc
    buffer_store_dword v12, v14, s[28:31], s38 offen sc1
    s_mov_b64 exec, -1
    s_endpgm
k1_kernel_pk20:
    s_mov_b32 s24, s18
    s_mov_b32 s25, s19
    s_mov_b32 s26, 2211840
    s_mov_b32 s27, 0x00020000
    s_sub_u32 s32, s21, 48
    s_mul_i32 s33, s32, 52429
    s_lshr_b32 s33, s33, 18
    s_mul_i32 s34, s33, 5
    s_sub_u32 s34, s32, s34
    s_lshl_b32 s34, s34, 1
    v_mul_u32_u24 v10, 1280, v3
    v_lshl_add_u32 v10, v4, 4, v10
    s_mul_i32 s35, s33, 368640
    s_lshl_b32 s36, s34, 7
    s_add_u32 s35, s35, s36
    buffer_load_dwordx4 v[32:35], v10, s[24:27], s35 offen offset:0
    s_add_u32 s35, s35, 40960
    buffer_load_dwordx4 v[36:39], v10, s[24:27], s35 offen offset:0
    s_add_u32 s35, s35, 40960
    buffer_load_dwordx4 v[40:43], v10, s[24:27], s35 offen offset:0
    s_add_u32 s35, s35, 40960
    buffer_load_dwordx4 v[44:47], v10, s[24:27], s35 offen offset:0
    s_add_u32 s35, s35, 40960
    buffer_load_dwordx4 v[48:51], v10, s[24:27], s35 offen offset:0
    s_add_u32 s35, s35, 40960
    buffer_load_dwordx4 v[52:55], v10, s[24:27], s35 offen offset:0
    s_add_u32 s35, s35, 40960
    buffer_load_dwordx4 v[56:59], v10, s[24:27], s35 offen offset:0
    s_add_u32 s35, s35, 40960
    buffer_load_dwordx4 v[60:63], v10, s[24:27], s35 offen offset:0
    s_add_u32 s35, s35, 40960
    buffer_load_dwordx4 v[64:67], v10, s[24:27], s35 offen offset:0
    s_sub_u32 s35, s35, 327680
    buffer_load_dwordx4 v[72:75], v10, s[24:27], s35 offen offset:128
    s_add_u32 s35, s35, 40960
    buffer_load_dwordx4 v[76:79], v10, s[24:27], s35 offen offset:128
    s_add_u32 s35, s35, 40960
    buffer_load_dwordx4 v[80:83], v10, s[24:27], s35 offen offset:128
    s_add_u32 s35, s35, 40960
    buffer_load_dwordx4 v[84:87], v10, s[24:27], s35 offen offset:128
    s_add_u32 s35, s35, 40960
    buffer_load_dwordx4 v[88:91], v10, s[24:27], s35 offen offset:128
    s_add_u32 s35, s35, 40960
    buffer_load_dwordx4 v[92:95], v10, s[24:27], s35 offen offset:128
    s_add_u32 s35, s35, 40960
    buffer_load_dwordx4 v[96:99], v10, s[24:27], s35 offen offset:128
    s_add_u32 s35, s35, 40960
    buffer_load_dwordx4 v[100:103], v10, s[24:27], s35 offen offset:128
    s_add_u32 s35, s35, 40960
    buffer_load_dwordx4 v[104:107], v10, s[24:27], s35 offen offset:128
    s_lshl_b32 s36, s34, 2
    s_add_u32 s36, s36, s20
    s_mul_i32 s38, s36, 52429
    s_lshr_b32 s38, s38, 18
    s_mul_i32 s39, s38, 5
    s_sub_u32 s39, s36, s39
    s_mul_i32 s37, s38, 280
    s_mul_i32 s40, s33, 45
    s_add_u32 s37, s37, s40
    s_add_u32 s37, s37, s39
    s_lshl_b32 s37, s37, 10
    s_add_u32 s37, s37, 6696960
    s_waitcnt vmcnt(17)
    ds_write_b128 v5, v[32:35] offset:0
    s_waitcnt vmcnt(16)
    ds_write_b128 v5, v[36:39] offset:4608
    s_waitcnt vmcnt(15)
    ds_write_b128 v5, v[40:43] offset:9216
    s_waitcnt vmcnt(14)
    ds_write_b128 v5, v[44:47] offset:13824
    s_waitcnt vmcnt(13)
    ds_write_b128 v5, v[48:51] offset:18432
    s_waitcnt vmcnt(12)
    ds_write_b128 v5, v[52:55] offset:23040
    s_waitcnt vmcnt(11)
    ds_write_b128 v5, v[56:59] offset:27648
    s_waitcnt vmcnt(10)
    ds_write_b128 v5, v[60:63] offset:32256
    s_waitcnt vmcnt(9)
    ds_write_b128 v5, v[64:67] offset:36864
    s_waitcnt lgkmcnt(0)
    s_barrier
    ds_read_b64_tr_b16 v[32:33], v8 offset:0
    ds_read_b64_tr_b16 v[34:35], v8 offset:576
    ds_read_b64_tr_b16 v[36:37], v8 offset:4608
    ds_read_b64_tr_b16 v[38:39], v8 offset:5184
    ds_read_b64_tr_b16 v[40:41], v8 offset:9216
    ds_read_b64_tr_b16 v[42:43], v8 offset:9792
    ds_read_b64_tr_b16 v[44:45], v8 offset:13824
    ds_read_b64_tr_b16 v[46:47], v8 offset:14400
    ds_read_b64_tr_b16 v[48:49], v8 offset:18432
    ds_read_b64_tr_b16 v[50:51], v8 offset:19008
    ds_read_b64_tr_b16 v[52:53], v8 offset:23040
    ds_read_b64_tr_b16 v[54:55], v8 offset:23616
    ds_read_b64_tr_b16 v[56:57], v8 offset:27648
    ds_read_b64_tr_b16 v[58:59], v8 offset:28224
    ds_read_b64_tr_b16 v[60:61], v8 offset:32256
    ds_read_b64_tr_b16 v[62:63], v8 offset:32832
    ds_read_b64_tr_b16 v[64:65], v8 offset:36864
    ds_read_b64_tr_b16 v[66:67], v8 offset:37440
    s_waitcnt lgkmcnt(15)
    s_add_u32 s38, s37, 0
    buffer_store_dwordx4 v[32:35], v9, s[28:31], s38 offen sc1
    s_waitcnt lgkmcnt(14)
    s_add_u32 s38, s37, 5120
    buffer_store_dwordx4 v[36:39], v9, s[28:31], s38 offen sc1
    s_waitcnt lgkmcnt(12)
    s_add_u32 s38, s37, 10240
    buffer_store_dwordx4 v[40:43], v9, s[28:31], s38 offen sc1
    s_waitcnt lgkmcnt(10)
    s_add_u32 s38, s37, 15360
    buffer_store_dwordx4 v[44:47], v9, s[28:31], s38 offen sc1
    s_waitcnt lgkmcnt(8)
    s_add_u32 s38, s37, 20480
    buffer_store_dwordx4 v[48:51], v9, s[28:31], s38 offen sc1
    s_waitcnt lgkmcnt(6)
    s_add_u32 s38, s37, 25600
    buffer_store_dwordx4 v[52:55], v9, s[28:31], s38 offen sc1
    s_waitcnt lgkmcnt(4)
    s_add_u32 s38, s37, 30720
    buffer_store_dwordx4 v[56:59], v9, s[28:31], s38 offen sc1
    s_waitcnt lgkmcnt(2)
    s_add_u32 s38, s37, 35840
    buffer_store_dwordx4 v[60:63], v9, s[28:31], s38 offen sc1
    s_waitcnt lgkmcnt(0)
    s_add_u32 s38, s37, 40960
    buffer_store_dwordx4 v[64:67], v9, s[28:31], s38 offen sc1
    s_add_u32 s34, s34, 1
    s_barrier
    s_lshl_b32 s36, s34, 2
    s_add_u32 s36, s36, s20
    s_mul_i32 s38, s36, 52429
    s_lshr_b32 s38, s38, 18
    s_mul_i32 s39, s38, 5
    s_sub_u32 s39, s36, s39
    s_mul_i32 s37, s38, 280
    s_mul_i32 s40, s33, 45
    s_add_u32 s37, s37, s40
    s_add_u32 s37, s37, s39
    s_lshl_b32 s37, s37, 10
    s_add_u32 s37, s37, 6696960
    s_waitcnt vmcnt(17)
    ds_write_b128 v5, v[72:75] offset:0
    s_waitcnt vmcnt(16)
    ds_write_b128 v5, v[76:79] offset:4608
    s_waitcnt vmcnt(15)
    ds_write_b128 v5, v[80:83] offset:9216
    s_waitcnt vmcnt(14)
    ds_write_b128 v5, v[84:87] offset:13824
    s_waitcnt vmcnt(13)
    ds_write_b128 v5, v[88:91] offset:18432
    s_waitcnt vmcnt(12)
    ds_write_b128 v5, v[92:95] offset:23040
    s_waitcnt vmcnt(11)
    ds_write_b128 v5, v[96:99] offset:27648
    s_waitcnt vmcnt(10)
    ds_write_b128 v5, v[100:103] offset:32256
    s_waitcnt vmcnt(9)
    ds_write_b128 v5, v[104:107] offset:36864
    s_waitcnt lgkmcnt(0)
    s_barrier
    ds_read_b64_tr_b16 v[72:73], v8 offset:0
    ds_read_b64_tr_b16 v[74:75], v8 offset:576
    ds_read_b64_tr_b16 v[76:77], v8 offset:4608
    ds_read_b64_tr_b16 v[78:79], v8 offset:5184
    ds_read_b64_tr_b16 v[80:81], v8 offset:9216
    ds_read_b64_tr_b16 v[82:83], v8 offset:9792
    ds_read_b64_tr_b16 v[84:85], v8 offset:13824
    ds_read_b64_tr_b16 v[86:87], v8 offset:14400
    ds_read_b64_tr_b16 v[88:89], v8 offset:18432
    ds_read_b64_tr_b16 v[90:91], v8 offset:19008
    ds_read_b64_tr_b16 v[92:93], v8 offset:23040
    ds_read_b64_tr_b16 v[94:95], v8 offset:23616
    ds_read_b64_tr_b16 v[96:97], v8 offset:27648
    ds_read_b64_tr_b16 v[98:99], v8 offset:28224
    ds_read_b64_tr_b16 v[100:101], v8 offset:32256
    ds_read_b64_tr_b16 v[102:103], v8 offset:32832
    ds_read_b64_tr_b16 v[104:105], v8 offset:36864
    ds_read_b64_tr_b16 v[106:107], v8 offset:37440
    s_waitcnt lgkmcnt(15)
    s_add_u32 s38, s37, 0
    buffer_store_dwordx4 v[72:75], v9, s[28:31], s38 offen sc1
    s_waitcnt lgkmcnt(14)
    s_add_u32 s38, s37, 5120
    buffer_store_dwordx4 v[76:79], v9, s[28:31], s38 offen sc1
    s_waitcnt lgkmcnt(12)
    s_add_u32 s38, s37, 10240
    buffer_store_dwordx4 v[80:83], v9, s[28:31], s38 offen sc1
    s_waitcnt lgkmcnt(10)
    s_add_u32 s38, s37, 15360
    buffer_store_dwordx4 v[84:87], v9, s[28:31], s38 offen sc1
    s_waitcnt lgkmcnt(8)
    s_add_u32 s38, s37, 20480
    buffer_store_dwordx4 v[88:91], v9, s[28:31], s38 offen sc1
    s_waitcnt lgkmcnt(6)
    s_add_u32 s38, s37, 25600
    buffer_store_dwordx4 v[92:95], v9, s[28:31], s38 offen sc1
    s_waitcnt lgkmcnt(4)
    s_add_u32 s38, s37, 30720
    buffer_store_dwordx4 v[96:99], v9, s[28:31], s38 offen sc1
    s_waitcnt lgkmcnt(2)
    s_add_u32 s38, s37, 35840
    buffer_store_dwordx4 v[100:103], v9, s[28:31], s38 offen sc1
    s_waitcnt lgkmcnt(0)
    s_add_u32 s38, s37, 40960
    buffer_store_dwordx4 v[104:107], v9, s[28:31], s38 offen sc1
    s_endpgm
k1_kernel_pke21:
    s_endpgm
k1_mod0:
    s_sub_u32 s54, s54, 128
    s_waitcnt lgkmcnt(0)
    s_mov_b32 s28, s10
    s_mov_b32 s29, s11
    s_mov_b32 s30, 268435456
    s_mov_b32 s31, 0x00020000
k1_modf:
    s_load_dwordx4 s[12:15], s[0:1], 88
    s_mov_b32 s32, s54
    v_and_b32 v3, 7, v0
    v_lshrrev_b32 v4, 3, v0
    v_lshlrev_b32 v5, 1, v4
    v_mul_u32_u24 v6, 7680, v4
    s_lshl_b32 s36, s32, 7
    v_lshl_add_u32 v7, v3, 4, s36
    v_add_u32 v6, v6, v7
    s_waitcnt lgkmcnt(0)
    s_mov_b32 s16, s12
    s_mov_b32 s17, s13
    s_mov_b32 s18, 1280
    s_mov_b32 s19, 0x00020000
    s_mov_b32 s20, s14
    s_mov_b32 s21, s15
    s_mov_b32 s22, 4915200
    s_mov_b32 s23, 0x00020000
    buffer_load_ushort v10, v5, s[16:19], 0 offen offset:0
    buffer_load_ushort v11, v5, s[16:19], 0 offen offset:64
    buffer_load_ushort v12, v5, s[16:19], 0 offen offset:128
    buffer_load_ushort v13, v5, s[16:19], 0 offen offset:192
    buffer_load_ushort v14, v5, s[16:19], 0 offen offset:256
    buffer_load_ushort v15, v5, s[16:19], 0 offen offset:320
    buffer_load_ushort v16, v5, s[16:19], 0 offen offset:384
    buffer_load_ushort v17, v5, s[16:19], 0 offen offset:448
    buffer_load_ushort v18, v5, s[16:19], 0 offen offset:512
    buffer_load_ushort v19, v5, s[16:19], 0 offen offset:576
    buffer_load_ushort v20, v5, s[16:19], 0 offen offset:640
    buffer_load_ushort v21, v5, s[16:19], 0 offen offset:704
    buffer_load_ushort v22, v5, s[16:19], 0 offen offset:768
    buffer_load_ushort v23, v5, s[16:19], 0 offen offset:832
    buffer_load_ushort v24, v5, s[16:19], 0 offen offset:896
    buffer_load_ushort v25, v5, s[16:19], 0 offen offset:960
    buffer_load_ushort v26, v5, s[16:19], 0 offen offset:1024
    buffer_load_ushort v27, v5, s[16:19], 0 offen offset:1088
    buffer_load_ushort v28, v5, s[16:19], 0 offen offset:1152
    buffer_load_ushort v29, v5, s[16:19], 0 offen offset:1216
    s_mov_b32 s37, 0
    buffer_load_dwordx4 v[32:35], v6, s[20:23], s37 offen
    s_mov_b32 s37, 245760
    buffer_load_dwordx4 v[36:39], v6, s[20:23], s37 offen
    s_mov_b32 s37, 491520
    buffer_load_dwordx4 v[40:43], v6, s[20:23], s37 offen
    s_mov_b32 s37, 737280
    buffer_load_dwordx4 v[44:47], v6, s[20:23], s37 offen
    s_mov_b32 s37, 983040
    buffer_load_dwordx4 v[48:51], v6, s[20:23], s37 offen
    s_mov_b32 s37, 1228800
    buffer_load_dwordx4 v[52:55], v6, s[20:23], s37 offen
    s_mov_b32 s37, 1474560
    buffer_load_dwordx4 v[56:59], v6, s[20:23], s37 offen
    s_mov_b32 s37, 1720320
    buffer_load_dwordx4 v[60:63], v6, s[20:23], s37 offen
    s_mov_b32 s37, 1966080
    buffer_load_dwordx4 v[64:67], v6, s[20:23], s37 offen
    s_mov_b32 s37, 2211840
    buffer_load_dwordx4 v[68:71], v6, s[20:23], s37 offen
    s_mov_b32 s37, 2457600
    buffer_load_dwordx4 v[72:75], v6, s[20:23], s37 offen
    s_mov_b32 s37, 2703360
    buffer_load_dwordx4 v[76:79], v6, s[20:23], s37 offen
    s_mov_b32 s37, 2949120
    buffer_load_dwordx4 v[80:83], v6, s[20:23], s37 offen
    s_mov_b32 s37, 3194880
    buffer_load_dwordx4 v[84:87], v6, s[20:23], s37 offen
    s_mov_b32 s37, 3440640
    buffer_load_dwordx4 v[88:91], v6, s[20:23], s37 offen
    s_mov_b32 s37, 3686400
    buffer_load_dwordx4 v[92:95], v6, s[20:23], s37 offen
    s_mov_b32 s37, 3932160
    buffer_load_dwordx4 v[96:99], v6, s[20:23], s37 offen
    s_mov_b32 s37, 4177920
    buffer_load_dwordx4 v[100:103], v6, s[20:23], s37 offen
    s_mov_b32 s37, 4423680
    buffer_load_dwordx4 v[104:107], v6, s[20:23], s37 offen
    s_mov_b32 s37, 4669440
    buffer_load_dwordx4 v[108:111], v6, s[20:23], s37 offen
    s_waitcnt vmcnt(20)
    v_lshlrev_b32 v10, 16, v10
    v_mul_f32 v120, 0xbfb8aa3b, v10
    v_exp_f32 v120, v120
    v_lshlrev_b32 v11, 16, v11
    v_mul_f32 v121, 0xbfb8aa3b, v11
    v_exp_f32 v121, v121
    v_lshlrev_b32 v12, 16, v12
    v_mul_f32 v122, 0xbfb8aa3b, v12
    v_exp_f32 v122, v122
    v_lshlrev_b32 v13, 16, v13
    v_mul_f32 v123, 0xbfb8aa3b, v13
    v_exp_f32 v123, v123
    v_lshlrev_b32 v14, 16, v14
    v_mul_f32 v124, 0xbfb8aa3b, v14
    v_exp_f32 v124, v124
    v_lshlrev_b32 v15, 16, v15
    v_mul_f32 v125, 0xbfb8aa3b, v15
    v_exp_f32 v125, v125
    v_lshlrev_b32 v16, 16, v16
    v_mul_f32 v126, 0xbfb8aa3b, v16
    v_exp_f32 v126, v126
    v_lshlrev_b32 v17, 16, v17
    v_mul_f32 v127, 0xbfb8aa3b, v17
    v_exp_f32 v127, v127
    v_lshlrev_b32 v18, 16, v18
    v_mul_f32 v128, 0xbfb8aa3b, v18
    v_exp_f32 v128, v128
    v_lshlrev_b32 v19, 16, v19
    v_mul_f32 v129, 0xbfb8aa3b, v19
    v_exp_f32 v129, v129
    v_lshlrev_b32 v20, 16, v20
    v_mul_f32 v130, 0xbfb8aa3b, v20
    v_exp_f32 v130, v130
    v_lshlrev_b32 v21, 16, v21
    v_mul_f32 v131, 0xbfb8aa3b, v21
    v_exp_f32 v131, v131
    v_lshlrev_b32 v22, 16, v22
    v_mul_f32 v132, 0xbfb8aa3b, v22
    v_exp_f32 v132, v132
    v_lshlrev_b32 v23, 16, v23
    v_mul_f32 v133, 0xbfb8aa3b, v23
    v_exp_f32 v133, v133
    v_lshlrev_b32 v24, 16, v24
    v_mul_f32 v134, 0xbfb8aa3b, v24
    v_exp_f32 v134, v134
    v_lshlrev_b32 v25, 16, v25
    v_mul_f32 v135, 0xbfb8aa3b, v25
    v_exp_f32 v135, v135
    v_lshlrev_b32 v26, 16, v26
    v_mul_f32 v136, 0xbfb8aa3b, v26
    v_exp_f32 v136, v136
    v_lshlrev_b32 v27, 16, v27
    v_mul_f32 v137, 0xbfb8aa3b, v27
    v_exp_f32 v137, v137
    v_lshlrev_b32 v28, 16, v28
    v_mul_f32 v138, 0xbfb8aa3b, v28
    v_exp_f32 v138, v138
    v_lshlrev_b32 v29, 16, v29
    v_mul_f32 v139, 0xbfb8aa3b, v29
    v_exp_f32 v139, v139
    v_add_f32 v120, 1.0, v120
    v_rcp_f32 v120, v120
    v_add_f32 v121, 1.0, v121
    v_rcp_f32 v121, v121
    v_add_f32 v122, 1.0, v122
    v_rcp_f32 v122, v122
    v_add_f32 v123, 1.0, v123
    v_rcp_f32 v123, v123
    v_add_f32 v124, 1.0, v124
    v_rcp_f32 v124, v124
    v_add_f32 v125, 1.0, v125
    v_rcp_f32 v125, v125
    v_add_f32 v126, 1.0, v126
    v_rcp_f32 v126, v126
    v_add_f32 v127, 1.0, v127
    v_rcp_f32 v127, v127
    v_add_f32 v128, 1.0, v128
    v_rcp_f32 v128, v128
    v_add_f32 v129, 1.0, v129
    v_rcp_f32 v129, v129
    v_add_f32 v130, 1.0, v130
    v_rcp_f32 v130, v130
    v_add_f32 v131, 1.0, v131
    v_rcp_f32 v131, v131
    v_add_f32 v132, 1.0, v132
    v_rcp_f32 v132, v132
    v_add_f32 v133, 1.0, v133
    v_rcp_f32 v133, v133
    v_add_f32 v134, 1.0, v134
    v_rcp_f32 v134, v134
    v_add_f32 v135, 1.0, v135
    v_rcp_f32 v135, v135
    v_add_f32 v136, 1.0, v136
    v_rcp_f32 v136, v136
    v_add_f32 v137, 1.0, v137
    v_rcp_f32 v137, v137
    v_add_f32 v138, 1.0, v138
    v_rcp_f32 v138, v138
    v_add_f32 v139, 1.0, v139
    v_rcp_f32 v139, v139
    s_nop 0
    v_mul_f32 v10, v10, v120
    v_mul_f32 v11, v11, v121
    v_mul_f32 v12, v12, v122
    v_mul_f32 v13, v13, v123
    v_mul_f32 v14, v14, v124
    v_mul_f32 v15, v15, v125
    v_mul_f32 v16, v16, v126
    v_mul_f32 v17, v17, v127
    v_mul_f32 v18, v18, v128
    v_mul_f32 v19, v19, v129
    v_mul_f32 v20, v20, v130
    v_mul_f32 v21, v21, v131
    v_mul_f32 v22, v22, v132
    v_mul_f32 v23, v23, v133
    v_mul_f32 v24, v24, v134
    v_mul_f32 v25, v25, v135
    v_mul_f32 v26, v26, v136
    v_mul_f32 v27, v27, v137
    v_mul_f32 v28, v28, v138
    v_mul_f32 v29, v29, v139
    v_cvt_pk_bf16_f32 v120, v10, v11
    v_lshlrev_b32 v10, 16, v120
    v_and_b32 v11, 0xffff0000, v120
    v_cvt_pk_bf16_f32 v120, v12, v13
    v_lshlrev_b32 v12, 16, v120
    v_and_b32 v13, 0xffff0000, v120
    v_cvt_pk_bf16_f32 v120, v14, v15
    v_lshlrev_b32 v14, 16, v120
    v_and_b32 v15, 0xffff0000, v120
    v_cvt_pk_bf16_f32 v120, v16, v17
    v_lshlrev_b32 v16, 16, v120
    v_and_b32 v17, 0xffff0000, v120
    v_cvt_pk_bf16_f32 v120, v18, v19
    v_lshlrev_b32 v18, 16, v120
    v_and_b32 v19, 0xffff0000, v120
    v_cvt_pk_bf16_f32 v120, v20, v21
    v_lshlrev_b32 v20, 16, v120
    v_and_b32 v21, 0xffff0000, v120
    v_cvt_pk_bf16_f32 v120, v22, v23
    v_lshlrev_b32 v22, 16, v120
    v_and_b32 v23, 0xffff0000, v120
    v_cvt_pk_bf16_f32 v120, v24, v25
    v_lshlrev_b32 v24, 16, v120
    v_and_b32 v25, 0xffff0000, v120
    v_cvt_pk_bf16_f32 v120, v26, v27
    v_lshlrev_b32 v26, 16, v120
    v_and_b32 v27, 0xffff0000, v120
    v_cvt_pk_bf16_f32 v120, v28, v29
    v_lshlrev_b32 v28, 16, v120
    v_and_b32 v29, 0xffff0000, v120
    v_mov_b32 v112, 0
    v_mov_b32 v113, 0
    v_mov_b32 v114, 0
    v_mov_b32 v115, 0
    v_mov_b32 v116, 0
    v_mov_b32 v117, 0
    v_mov_b32 v118, 0
    v_mov_b32 v119, 0
    s_waitcnt vmcnt(19)
    v_lshlrev_b32 v120, 16, v32
    v_and_b32 v121, 0xffff0000, v32
    v_lshlrev_b32 v122, 16, v33
    v_and_b32 v123, 0xffff0000, v33
    v_lshlrev_b32 v124, 16, v34
    v_and_b32 v125, 0xffff0000, v34
    v_lshlrev_b32 v126, 16, v35
    v_and_b32 v127, 0xffff0000, v35
    v_pk_fma_f32 v[112:113], v[120:121], v[10:11], v[112:113] op_sel:[0,0,0] op_sel_hi:[1,0,1]
    v_pk_fma_f32 v[114:115], v[122:123], v[10:11], v[114:115] op_sel:[0,0,0] op_sel_hi:[1,0,1]
    v_pk_fma_f32 v[116:117], v[124:125], v[10:11], v[116:117] op_sel:[0,0,0] op_sel_hi:[1,0,1]
    v_pk_fma_f32 v[118:119], v[126:127], v[10:11], v[118:119] op_sel:[0,0,0] op_sel_hi:[1,0,1]
    s_waitcnt vmcnt(18)
    v_lshlrev_b32 v120, 16, v36
    v_and_b32 v121, 0xffff0000, v36
    v_lshlrev_b32 v122, 16, v37
    v_and_b32 v123, 0xffff0000, v37
    v_lshlrev_b32 v124, 16, v38
    v_and_b32 v125, 0xffff0000, v38
    v_lshlrev_b32 v126, 16, v39
    v_and_b32 v127, 0xffff0000, v39
    v_pk_fma_f32 v[112:113], v[120:121], v[10:11], v[112:113] op_sel:[0,1,0] op_sel_hi:[1,1,1]
    v_pk_fma_f32 v[114:115], v[122:123], v[10:11], v[114:115] op_sel:[0,1,0] op_sel_hi:[1,1,1]
    v_pk_fma_f32 v[116:117], v[124:125], v[10:11], v[116:117] op_sel:[0,1,0] op_sel_hi:[1,1,1]
    v_pk_fma_f32 v[118:119], v[126:127], v[10:11], v[118:119] op_sel:[0,1,0] op_sel_hi:[1,1,1]
    s_waitcnt vmcnt(17)
    v_lshlrev_b32 v120, 16, v40
    v_and_b32 v121, 0xffff0000, v40
    v_lshlrev_b32 v122, 16, v41
    v_and_b32 v123, 0xffff0000, v41
    v_lshlrev_b32 v124, 16, v42
    v_and_b32 v125, 0xffff0000, v42
    v_lshlrev_b32 v126, 16, v43
    v_and_b32 v127, 0xffff0000, v43
    v_pk_fma_f32 v[112:113], v[120:121], v[12:13], v[112:113] op_sel:[0,0,0] op_sel_hi:[1,0,1]
    v_pk_fma_f32 v[114:115], v[122:123], v[12:13], v[114:115] op_sel:[0,0,0] op_sel_hi:[1,0,1]
    v_pk_fma_f32 v[116:117], v[124:125], v[12:13], v[116:117] op_sel:[0,0,0] op_sel_hi:[1,0,1]
    v_pk_fma_f32 v[118:119], v[126:127], v[12:13], v[118:119] op_sel:[0,0,0] op_sel_hi:[1,0,1]
    s_waitcnt vmcnt(16)
    v_lshlrev_b32 v120, 16, v44
    v_and_b32 v121, 0xffff0000, v44
    v_lshlrev_b32 v122, 16, v45
    v_and_b32 v123, 0xffff0000, v45
    v_lshlrev_b32 v124, 16, v46
    v_and_b32 v125, 0xffff0000, v46
    v_lshlrev_b32 v126, 16, v47
    v_and_b32 v127, 0xffff0000, v47
    v_pk_fma_f32 v[112:113], v[120:121], v[12:13], v[112:113] op_sel:[0,1,0] op_sel_hi:[1,1,1]
    v_pk_fma_f32 v[114:115], v[122:123], v[12:13], v[114:115] op_sel:[0,1,0] op_sel_hi:[1,1,1]
    v_pk_fma_f32 v[116:117], v[124:125], v[12:13], v[116:117] op_sel:[0,1,0] op_sel_hi:[1,1,1]
    v_pk_fma_f32 v[118:119], v[126:127], v[12:13], v[118:119] op_sel:[0,1,0] op_sel_hi:[1,1,1]
    s_waitcnt vmcnt(15)
    v_lshlrev_b32 v120, 16, v48
    v_and_b32 v121, 0xffff0000, v48
    v_lshlrev_b32 v122, 16, v49
    v_and_b32 v123, 0xffff0000, v49
    v_lshlrev_b32 v124, 16, v50
    v_and_b32 v125, 0xffff0000, v50
    v_lshlrev_b32 v126, 16, v51
    v_and_b32 v127, 0xffff0000, v51
    v_pk_fma_f32 v[112:113], v[120:121], v[14:15], v[112:113] op_sel:[0,0,0] op_sel_hi:[1,0,1]
    v_pk_fma_f32 v[114:115], v[122:123], v[14:15], v[114:115] op_sel:[0,0,0] op_sel_hi:[1,0,1]
    v_pk_fma_f32 v[116:117], v[124:125], v[14:15], v[116:117] op_sel:[0,0,0] op_sel_hi:[1,0,1]
    v_pk_fma_f32 v[118:119], v[126:127], v[14:15], v[118:119] op_sel:[0,0,0] op_sel_hi:[1,0,1]
    s_waitcnt vmcnt(14)
    v_lshlrev_b32 v120, 16, v52
    v_and_b32 v121, 0xffff0000, v52
    v_lshlrev_b32 v122, 16, v53
    v_and_b32 v123, 0xffff0000, v53
    v_lshlrev_b32 v124, 16, v54
    v_and_b32 v125, 0xffff0000, v54
    v_lshlrev_b32 v126, 16, v55
    v_and_b32 v127, 0xffff0000, v55
    v_pk_fma_f32 v[112:113], v[120:121], v[14:15], v[112:113] op_sel:[0,1,0] op_sel_hi:[1,1,1]
    v_pk_fma_f32 v[114:115], v[122:123], v[14:15], v[114:115] op_sel:[0,1,0] op_sel_hi:[1,1,1]
    v_pk_fma_f32 v[116:117], v[124:125], v[14:15], v[116:117] op_sel:[0,1,0] op_sel_hi:[1,1,1]
    v_pk_fma_f32 v[118:119], v[126:127], v[14:15], v[118:119] op_sel:[0,1,0] op_sel_hi:[1,1,1]
    s_waitcnt vmcnt(13)
    v_lshlrev_b32 v120, 16, v56
    v_and_b32 v121, 0xffff0000, v56
    v_lshlrev_b32 v122, 16, v57
    v_and_b32 v123, 0xffff0000, v57
    v_lshlrev_b32 v124, 16, v58
    v_and_b32 v125, 0xffff0000, v58
    v_lshlrev_b32 v126, 16, v59
    v_and_b32 v127, 0xffff0000, v59
    v_pk_fma_f32 v[112:113], v[120:121], v[16:17], v[112:113] op_sel:[0,0,0] op_sel_hi:[1,0,1]
    v_pk_fma_f32 v[114:115], v[122:123], v[16:17], v[114:115] op_sel:[0,0,0] op_sel_hi:[1,0,1]
    v_pk_fma_f32 v[116:117], v[124:125], v[16:17], v[116:117] op_sel:[0,0,0] op_sel_hi:[1,0,1]
    v_pk_fma_f32 v[118:119], v[126:127], v[16:17], v[118:119] op_sel:[0,0,0] op_sel_hi:[1,0,1]
    s_waitcnt vmcnt(12)
    v_lshlrev_b32 v120, 16, v60
    v_and_b32 v121, 0xffff0000, v60
    v_lshlrev_b32 v122, 16, v61
    v_and_b32 v123, 0xffff0000, v61
    v_lshlrev_b32 v124, 16, v62
    v_and_b32 v125, 0xffff0000, v62
    v_lshlrev_b32 v126, 16, v63
    v_and_b32 v127, 0xffff0000, v63
    v_pk_fma_f32 v[112:113], v[120:121], v[16:17], v[112:113] op_sel:[0,1,0] op_sel_hi:[1,1,1]
    v_pk_fma_f32 v[114:115], v[122:123], v[16:17], v[114:115] op_sel:[0,1,0] op_sel_hi:[1,1,1]
    v_pk_fma_f32 v[116:117], v[124:125], v[16:17], v[116:117] op_sel:[0,1,0] op_sel_hi:[1,1,1]
    v_pk_fma_f32 v[118:119], v[126:127], v[16:17], v[118:119] op_sel:[0,1,0] op_sel_hi:[1,1,1]
    s_waitcnt vmcnt(11)
    v_lshlrev_b32 v120, 16, v64
    v_and_b32 v121, 0xffff0000, v64
    v_lshlrev_b32 v122, 16, v65
    v_and_b32 v123, 0xffff0000, v65
    v_lshlrev_b32 v124, 16, v66
    v_and_b32 v125, 0xffff0000, v66
    v_lshlrev_b32 v126, 16, v67
    v_and_b32 v127, 0xffff0000, v67
    v_pk_fma_f32 v[112:113], v[120:121], v[18:19], v[112:113] op_sel:[0,0,0] op_sel_hi:[1,0,1]
    v_pk_fma_f32 v[114:115], v[122:123], v[18:19], v[114:115] op_sel:[0,0,0] op_sel_hi:[1,0,1]
    v_pk_fma_f32 v[116:117], v[124:125], v[18:19], v[116:117] op_sel:[0,0,0] op_sel_hi:[1,0,1]
    v_pk_fma_f32 v[118:119], v[126:127], v[18:19], v[118:119] op_sel:[0,0,0] op_sel_hi:[1,0,1]
    s_waitcnt vmcnt(10)
    v_lshlrev_b32 v120, 16, v68
    v_and_b32 v121, 0xffff0000, v68
    v_lshlrev_b32 v122, 16, v69
    v_and_b32 v123, 0xffff0000, v69
    v_lshlrev_b32 v124, 16, v70
    v_and_b32 v125, 0xffff0000, v70
    v_lshlrev_b32 v126, 16, v71
    v_and_b32 v127, 0xffff0000, v71
    v_pk_fma_f32 v[112:113], v[120:121], v[18:19], v[112:113] op_sel:[0,1,0] op_sel_hi:[1,1,1]
    v_pk_fma_f32 v[114:115], v[122:123], v[18:19], v[114:115] op_sel:[0,1,0] op_sel_hi:[1,1,1]
    v_pk_fma_f32 v[116:117], v[124:125], v[18:19], v[116:117] op_sel:[0,1,0] op_sel_hi:[1,1,1]
    v_pk_fma_f32 v[118:119], v[126:127], v[18:19], v[118:119] op_sel:[0,1,0] op_sel_hi:[1,1,1]
    s_waitcnt vmcnt(9)
    v_lshlrev_b32 v120, 16, v72
    v_and_b32 v121, 0xffff0000, v72
    v_lshlrev_b32 v122, 16, v73
    v_and_b32 v123, 0xffff0000, v73
    v_lshlrev_b32 v124, 16, v74
    v_and_b32 v125, 0xffff0000, v74
    v_lshlrev_b32 v126, 16, v75
    v_and_b32 v127, 0xffff0000, v75
    v_pk_fma_f32 v[112:113], v[120:121], v[20:21], v[112:113] op_sel:[0,0,0] op_sel_hi:[1,0,1]
    v_pk_fma_f32 v[114:115], v[122:123], v[20:21], v[114:115] op_sel:[0,0,0] op_sel_hi:[1,0,1]
    v_pk_fma_f32 v[116:117], v[124:125], v[20:21], v[116:117] op_sel:[0,0,0] op_sel_hi:[1,0,1]
    v_pk_fma_f32 v[118:119], v[126:127], v[20:21], v[118:119] op_sel:[0,0,0] op_sel_hi:[1,0,1]
    s_waitcnt vmcnt(8)
    v_lshlrev_b32 v120, 16, v76
    v_and_b32 v121, 0xffff0000, v76
    v_lshlrev_b32 v122, 16, v77
    v_and_b32 v123, 0xffff0000, v77
    v_lshlrev_b32 v124, 16, v78
    v_and_b32 v125, 0xffff0000, v78
    v_lshlrev_b32 v126, 16, v79
    v_and_b32 v127, 0xffff0000, v79
    v_pk_fma_f32 v[112:113], v[120:121], v[20:21], v[112:113] op_sel:[0,1,0] op_sel_hi:[1,1,1]
    v_pk_fma_f32 v[114:115], v[122:123], v[20:21], v[114:115] op_sel:[0,1,0] op_sel_hi:[1,1,1]
    v_pk_fma_f32 v[116:117], v[124:125], v[20:21], v[116:117] op_sel:[0,1,0] op_sel_hi:[1,1,1]
    v_pk_fma_f32 v[118:119], v[126:127], v[20:21], v[118:119] op_sel:[0,1,0] op_sel_hi:[1,1,1]
    s_waitcnt vmcnt(7)
    v_lshlrev_b32 v120, 16, v80
    v_and_b32 v121, 0xffff0000, v80
    v_lshlrev_b32 v122, 16, v81
    v_and_b32 v123, 0xffff0000, v81
    v_lshlrev_b32 v124, 16, v82
    v_and_b32 v125, 0xffff0000, v82
    v_lshlrev_b32 v126, 16, v83
    v_and_b32 v127, 0xffff0000, v83
    v_pk_fma_f32 v[112:113], v[120:121], v[22:23], v[112:113] op_sel:[0,0,0] op_sel_hi:[1,0,1]
    v_pk_fma_f32 v[114:115], v[122:123], v[22:23], v[114:115] op_sel:[0,0,0] op_sel_hi:[1,0,1]
    v_pk_fma_f32 v[116:117], v[124:125], v[22:23], v[116:117] op_sel:[0,0,0] op_sel_hi:[1,0,1]
    v_pk_fma_f32 v[118:119], v[126:127], v[22:23], v[118:119] op_sel:[0,0,0] op_sel_hi:[1,0,1]
    s_waitcnt vmcnt(6)
    v_lshlrev_b32 v120, 16, v84
    v_and_b32 v121, 0xffff0000, v84
    v_lshlrev_b32 v122, 16, v85
    v_and_b32 v123, 0xffff0000, v85
    v_lshlrev_b32 v124, 16, v86
    v_and_b32 v125, 0xffff0000, v86
    v_lshlrev_b32 v126, 16, v87
    v_and_b32 v127, 0xffff0000, v87
    v_pk_fma_f32 v[112:113], v[120:121], v[22:23], v[112:113] op_sel:[0,1,0] op_sel_hi:[1,1,1]
    v_pk_fma_f32 v[114:115], v[122:123], v[22:23], v[114:115] op_sel:[0,1,0] op_sel_hi:[1,1,1]
    v_pk_fma_f32 v[116:117], v[124:125], v[22:23], v[116:117] op_sel:[0,1,0] op_sel_hi:[1,1,1]
    v_pk_fma_f32 v[118:119], v[126:127], v[22:23], v[118:119] op_sel:[0,1,0] op_sel_hi:[1,1,1]
    s_waitcnt vmcnt(5)
    v_lshlrev_b32 v120, 16, v88
    v_and_b32 v121, 0xffff0000, v88
    v_lshlrev_b32 v122, 16, v89
    v_and_b32 v123, 0xffff0000, v89
    v_lshlrev_b32 v124, 16, v90
    v_and_b32 v125, 0xffff0000, v90
    v_lshlrev_b32 v126, 16, v91
    v_and_b32 v127, 0xffff0000, v91
    v_pk_fma_f32 v[112:113], v[120:121], v[24:25], v[112:113] op_sel:[0,0,0] op_sel_hi:[1,0,1]
    v_pk_fma_f32 v[114:115], v[122:123], v[24:25], v[114:115] op_sel:[0,0,0] op_sel_hi:[1,0,1]
    v_pk_fma_f32 v[116:117], v[124:125], v[24:25], v[116:117] op_sel:[0,0,0] op_sel_hi:[1,0,1]
    v_pk_fma_f32 v[118:119], v[126:127], v[24:25], v[118:119] op_sel:[0,0,0] op_sel_hi:[1,0,1]
    s_waitcnt vmcnt(4)
    v_lshlrev_b32 v120, 16, v92
    v_and_b32 v121, 0xffff0000, v92
    v_lshlrev_b32 v122, 16, v93
    v_and_b32 v123, 0xffff0000, v93
    v_lshlrev_b32 v124, 16, v94
    v_and_b32 v125, 0xffff0000, v94
    v_lshlrev_b32 v126, 16, v95
    v_and_b32 v127, 0xffff0000, v95
    v_pk_fma_f32 v[112:113], v[120:121], v[24:25], v[112:113] op_sel:[0,1,0] op_sel_hi:[1,1,1]
    v_pk_fma_f32 v[114:115], v[122:123], v[24:25], v[114:115] op_sel:[0,1,0] op_sel_hi:[1,1,1]
    v_pk_fma_f32 v[116:117], v[124:125], v[24:25], v[116:117] op_sel:[0,1,0] op_sel_hi:[1,1,1]
    v_pk_fma_f32 v[118:119], v[126:127], v[24:25], v[118:119] op_sel:[0,1,0] op_sel_hi:[1,1,1]
    s_waitcnt vmcnt(3)
    v_lshlrev_b32 v120, 16, v96
    v_and_b32 v121, 0xffff0000, v96
    v_lshlrev_b32 v122, 16, v97
    v_and_b32 v123, 0xffff0000, v97
    v_lshlrev_b32 v124, 16, v98
    v_and_b32 v125, 0xffff0000, v98
    v_lshlrev_b32 v126, 16, v99
    v_and_b32 v127, 0xffff0000, v99
    v_pk_fma_f32 v[112:113], v[120:121], v[26:27], v[112:113] op_sel:[0,0,0] op_sel_hi:[1,0,1]
    v_pk_fma_f32 v[114:115], v[122:123], v[26:27], v[114:115] op_sel:[0,0,0] op_sel_hi:[1,0,1]
    v_pk_fma_f32 v[116:117], v[124:125], v[26:27], v[116:117] op_sel:[0,0,0] op_sel_hi:[1,0,1]
    v_pk_fma_f32 v[118:119], v[126:127], v[26:27], v[118:119] op_sel:[0,0,0] op_sel_hi:[1,0,1]
    s_waitcnt vmcnt(2)
    v_lshlrev_b32 v120, 16, v100
    v_and_b32 v121, 0xffff0000, v100
    v_lshlrev_b32 v122, 16, v101
    v_and_b32 v123, 0xffff0000, v101
    v_lshlrev_b32 v124, 16, v102
    v_and_b32 v125, 0xffff0000, v102
    v_lshlrev_b32 v126, 16, v103
    v_and_b32 v127, 0xffff0000, v103
    v_pk_fma_f32 v[112:113], v[120:121], v[26:27], v[112:113] op_sel:[0,1,0] op_sel_hi:[1,1,1]
    v_pk_fma_f32 v[114:115], v[122:123], v[26:27], v[114:115] op_sel:[0,1,0] op_sel_hi:[1,1,1]
    v_pk_fma_f32 v[116:117], v[124:125], v[26:27], v[116:117] op_sel:[0,1,0] op_sel_hi:[1,1,1]
    v_pk_fma_f32 v[118:119], v[126:127], v[26:27], v[118:119] op_sel:[0,1,0] op_sel_hi:[1,1,1]
    s_waitcnt vmcnt(1)
    v_lshlrev_b32 v120, 16, v104
    v_and_b32 v121, 0xffff0000, v104
    v_lshlrev_b32 v122, 16, v105
    v_and_b32 v123, 0xffff0000, v105
    v_lshlrev_b32 v124, 16, v106
    v_and_b32 v125, 0xffff0000, v106
    v_lshlrev_b32 v126, 16, v107
    v_and_b32 v127, 0xffff0000, v107
    v_pk_fma_f32 v[112:113], v[120:121], v[28:29], v[112:113] op_sel:[0,0,0] op_sel_hi:[1,0,1]
    v_pk_fma_f32 v[114:115], v[122:123], v[28:29], v[114:115] op_sel:[0,0,0] op_sel_hi:[1,0,1]
    v_pk_fma_f32 v[116:117], v[124:125], v[28:29], v[116:117] op_sel:[0,0,0] op_sel_hi:[1,0,1]
    v_pk_fma_f32 v[118:119], v[126:127], v[28:29], v[118:119] op_sel:[0,0,0] op_sel_hi:[1,0,1]
    s_waitcnt vmcnt(0)
    v_lshlrev_b32 v120, 16, v108
    v_and_b32 v121, 0xffff0000, v108
    v_lshlrev_b32 v122, 16, v109
    v_and_b32 v123, 0xffff0000, v109
    v_lshlrev_b32 v124, 16, v110
    v_and_b32 v125, 0xffff0000, v110
    v_lshlrev_b32 v126, 16, v111
    v_and_b32 v127, 0xffff0000, v111
    v_pk_fma_f32 v[112:113], v[120:121], v[28:29], v[112:113] op_sel:[0,1,0] op_sel_hi:[1,1,1]
    v_pk_fma_f32 v[114:115], v[122:123], v[28:29], v[114:115] op_sel:[0,1,0] op_sel_hi:[1,1,1]
    v_pk_fma_f32 v[116:117], v[124:125], v[28:29], v[116:117] op_sel:[0,1,0] op_sel_hi:[1,1,1]
    v_pk_fma_f32 v[118:119], v[126:127], v[28:29], v[118:119] op_sel:[0,1,0] op_sel_hi:[1,1,1]
    v_lshlrev_b32 v7, 5, v0
    ds_write_b128 v7, v[112:115]
    ds_write_b128 v7, v[116:119] offset:16
    s_waitcnt lgkmcnt(0)
    s_barrier
    v_cmp_gt_u32 vcc, 64, v0
    s_and_saveexec_b64 s[42:43], vcc
    s_cbranch_execz k1_end
    v_lshlrev_b32 v7, 2, v0
    ds_read_b32 v32, v7 offset:0
    ds_read_b32 v33, v7 offset:256
    ds_read_b32 v34, v7 offset:512
    ds_read_b32 v35, v7 offset:768
    ds_read_b32 v36, v7 offset:1024
    ds_read_b32 v37, v7 offset:1280
    ds_read_b32 v38, v7 offset:1536
    ds_read_b32 v39, v7 offset:1792
    ds_read_b32 v40, v7 offset:2048
    ds_read_b32 v41, v7 offset:2304
    ds_read_b32 v42, v7 offset:2560
    ds_read_b32 v43, v7 offset:2816
    ds_read_b32 v44, v7 offset:3072
    ds_read_b32 v45, v7 offset:3328
    ds_read_b32 v46, v7 offset:3584
    ds_read_b32 v47, v7 offset:3840
    ds_read_b32 v48, v7 offset:4096
    ds_read_b32 v49, v7 offset:4352
    ds_read_b32 v50, v7 offset:4608
    ds_read_b32 v51, v7 offset:4864
    ds_read_b32 v52, v7 offset:5120
    ds_read_b32 v53, v7 offset:5376
    ds_read_b32 v54, v7 offset:5632
    ds_read_b32 v55, v7 offset:5888
    ds_read_b32 v56, v7 offset:6144
    ds_read_b32 v57, v7 offset:6400
    ds_read_b32 v58, v7 offset:6656
    ds_read_b32 v59, v7 offset:6912
    ds_read_b32 v60, v7 offset:7168
    ds_read_b32 v61, v7 offset:7424
    ds_read_b32 v62, v7 offset:7680
    ds_read_b32 v63, v7 offset:7936
    s_waitcnt lgkmcnt(0)
    v_add_f32 v32, v32, v48
    v_add_f32 v33, v33, v49
    v_add_f32 v34, v34, v50
    v_add_f32 v35, v35, v51
    v_add_f32 v36, v36, v52
    v_add_f32 v37, v37, v53
    v_add_f32 v38, v38, v54
    v_add_f32 v39, v39, v55
    v_add_f32 v40, v40, v56
    v_add_f32 v41, v41, v57
    v_add_f32 v42, v42, v58
    v_add_f32 v43, v43, v59
    v_add_f32 v44, v44, v60
    v_add_f32 v45, v45, v61
    v_add_f32 v46, v46, v62
    v_add_f32 v47, v47, v63
    v_add_f32 v32, v32, v40
    v_add_f32 v33, v33, v41
    v_add_f32 v34, v34, v42
    v_add_f32 v35, v35, v43
    v_add_f32 v36, v36, v44
    v_add_f32 v37, v37, v45
    v_add_f32 v38, v38, v46
    v_add_f32 v39, v39, v47
    v_add_f32 v32, v32, v36
    v_add_f32 v33, v33, v37
    v_add_f32 v34, v34, v38
    v_add_f32 v35, v35, v39
    v_add_f32 v32, v32, v34
    v_add_f32 v33, v33, v35
    v_add_f32 v32, v32, v33
    s_movk_i32 s22, 640
    v_cvt_pk_bf16_f32 v32, v32, v32
    v_lshlrev_b32 v32, 16, v32
    v_add_f32 v33, 1.0, v32
    v_cvt_pk_bf16_f32 v33, v33, v33
    v_lshlrev_b32 v33, 16, v33
    s_lshl_b32 s33, s32, 6
    v_add_u32 v34, s33, v0
    v_subrev_u32 v35, 640, v34
    v_cmp_gt_u32 vcc, 640, v35
    v_subrev_u32 v35, 2560, v34
    v_cmp_gt_u32 s[40:41], s22, v35
    s_or_b64 vcc, vcc, s[40:41]
    v_cndmask_b32 v32, v32, v33, vcc
    s_lshl_b32 s21, s32, 8
    s_add_u32 s21, s21, 2711552
    buffer_store_dword v32, v7, s[28:31], s21 offen sc1
k1_end:
    s_endpgm
k1_pf:
    s_waitcnt lgkmcnt(0)
    s_load_dwordx2 s[4:5], s[0:1], 0
    v_lshlrev_b32 v3, 7, v1
    v_lshlrev_b32 v1, 4, v1
    s_sub_u32 s24, s54, 96
    s_lshr_b32 s24, s24, 3
    s_lshl_b32 s24, s24, 2
    s_add_u32 s24, s24, s20
    s_and_b32 s22, s2, 7
    s_mul_i32 s21, s24, 20480
    s_mul_i32 s23, s22, 327680
    s_add_u32 s21, s21, s23
    s_waitcnt lgkmcnt(0)
    s_mov_b32 s16, s4
    s_mov_b32 s17, s5
    s_mov_b32 s18, 2621440
    s_mov_b32 s19, 0x00020000
    s_mov_b32 s28, s10
    s_mov_b32 s29, s11
    s_mov_b32 s30, 268435456
    s_mov_b32 s31, 0x00020000
    s_sub_u32 s36, s54, 96
    s_cmp_ge_u32 s36, 16
    s_cbranch_scc1 k1_kernel_zf22
    s_lshl_b32 s36, s36, 12
    s_add_u32 s36, s36, 8990720
    v_lshlrev_b32 v5, 4, v0
    v_mov_b32 v60, 0
    v_mov_b32 v61, 0
    v_mov_b32 v62, 0
    v_mov_b32 v63, 0
    buffer_store_dwordx4 v[60:63], v5, s[28:31], s36 offen sc1
k1_kernel_zf22:
    s_sub_u32 s36, s54, 96
    s_lshr_b32 s36, s36, 3
    s_mul_i32 s36, s36, 5120
    s_and_b32 s37, s2, 7
    s_mul_i32 s37, s37, 1601536
    s_add_u32 s36, s36, s37
    s_add_u32 s36, s36, 10641408
    v_lshlrev_b32 v5, 4, v0
    v_mov_b32 v60, 0
    v_mov_b32 v61, 0
    v_mov_b32 v62, 0
    v_mov_b32 v63, 0
    buffer_store_dwordx4 v[60:63], v5, s[28:31], s36 offen sc1
    s_add_u32 s36, s36, 4096
    s_cmp_lg_u32 s20, 0
    s_cbranch_scc1 k1_zst
    buffer_store_dwordx4 v[60:63], v5, s[28:31], s36 offen sc1
k1_zst:
    s_and_b32 s37, s2, 7
    s_cmp_eq_u32 s37, 0
    s_cselect_b32 s38, 9060352, 0
    s_cmp_eq_u32 s37, 7
    s_cselect_b32 s38, 20619264, s38
    s_cmp_eq_u32 s38, 0
    s_cbranch_scc1 k1_zht
    s_sub_u32 s36, s54, 96
    s_lshr_b32 s36, s36, 3
    s_mul_i32 s36, s36, 5120
    s_add_u32 s36, s36, s38
    buffer_store_dwordx4 v[60:63], v5, s[28:31], s36 offen sc1
    s_add_u32 s36, s36, 4096
    s_cmp_lg_u32 s20, 0
    s_cbranch_scc1 k1_zht
    buffer_store_dwordx4 v[60:63], v5, s[28:31], s36 offen sc1
k1_zht:
    s_getpc_b64 s[40:41]
k1_pcref:
    s_sub_u32 s40, s40, k1_pcref-k1_kernel
    s_subb_u32 s41, s41, 0
    s_lshl_b32 s42, s24, 12
    s_add_u32 s43, s42, 0
    s_min_u32 s43, s43, (CODE_END-k1_kernel-1020)&0xfffffff0
    v_add_u32 v6, s43, v1
    global_load_dwordx4 v[64:67], v6, s[40:41]
    s_add_u32 s43, s42, 1024
    s_min_u32 s43, s43, (CODE_END-k1_kernel-1020)&0xfffffff0
    v_add_u32 v6, s43, v1
    global_load_dwordx4 v[68:71], v6, s[40:41]
    s_add_u32 s43, s42, 2048
    s_min_u32 s43, s43, (CODE_END-k1_kernel-1020)&0xfffffff0
    v_add_u32 v6, s43, v1
    global_load_dwordx4 v[72:75], v6, s[40:41]
    s_add_u32 s43, s42, 3072
    s_min_u32 s43, s43, (CODE_END-k1_kernel-1020)&0xfffffff0
    v_add_u32 v6, s43, v1
    global_load_dwordx4 v[76:79], v6, s[40:41]
    s_mov_b32 s61, s21
    s_mov_b32 s62, s24
    s_waitcnt vmcnt(0)
    s_cmp_lg_u32 s20, 0
    s_cbranch_scc1 k1_kernel_sw24
    s_and_b32 s55, s2, 7
    s_lshl_b32 s57, s55, 9
    s_add_u32 s57, s57, 9056256
    v_mov_b32 v250, 0
    v_and_b32 v248, 31, v0
    v_lshlrev_b32 v248, 2, v248
    s_waitcnt lgkmcnt(0)
    s_mov_b32 s28, s10
    s_mov_b32 s29, s11
    s_mov_b32 s30, 268435456
    s_mov_b32 s31, 0x00020000
    buffer_load_dword v251, v250, s[28:31], s57 offen sc1
    s_mov_b32 s23, 1
    s_waitcnt vmcnt(0)
    v_add_u32 v251, 1, v251
k1_kernel_sw23:
    buffer_load_dword v249, v248, s[28:31], s57 offen offset:256 sc1
    s_waitcnt vmcnt(0)
    v_cmp_eq_u32 vcc, v251, v249
    s_sub_u32 s23, s23, 1
    s_cmp_eq_u64 vcc, -1
    s_cbranch_scc1 k1_kernel_sw24
    s_sleep 16
    s_cmp_lg_u32 s23, 0
    s_cbranch_scc1 k1_kernel_sw23
k1_kernel_sw24:
    s_barrier
    s_mov_b32 s21, s61
    s_mov_b32 s24, s62
    s_mov_b32 s28, s10
    s_mov_b32 s29, s11
    s_mov_b32 s30, 268435456
    s_mov_b32 s31, 0x00020000
    buffer_load_dwordx4 v[8:11], v1, s[16:19], s21 offen offset:0
    buffer_load_dwordx4 v[12:15], v1, s[16:19], s21 offen offset:1024
    buffer_load_dwordx4 v[16:19], v1, s[16:19], s21 offen offset:2048
    buffer_load_dwordx4 v[20:23], v1, s[16:19], s21 offen offset:3072
    s_add_u32 s21, s21, 4096
    buffer_load_dwordx4 v[24:27], v1, s[16:19], s21 offen offset:0
    buffer_load_dwordx4 v[28:31], v1, s[16:19], s21 offen offset:1024
    buffer_load_dwordx4 v[32:35], v1, s[16:19], s21 offen offset:2048
    buffer_load_dwordx4 v[36:39], v1, s[16:19], s21 offen offset:3072
    s_add_u32 s21, s21, 4096
    buffer_load_dwordx4 v[40:43], v1, s[16:19], s21 offen offset:0
    buffer_load_dwordx4 v[44:47], v1, s[16:19], s21 offen offset:1024
    buffer_load_dwordx4 v[8:11], v1, s[16:19], s21 offen offset:2048
    buffer_load_dwordx4 v[12:15], v1, s[16:19], s21 offen offset:3072
    s_add_u32 s21, s21, 4096
    buffer_load_dwordx4 v[16:19], v1, s[16:19], s21 offen offset:0
    buffer_load_dwordx4 v[20:23], v1, s[16:19], s21 offen offset:1024
    buffer_load_dwordx4 v[24:27], v1, s[16:19], s21 offen offset:2048
    buffer_load_dwordx4 v[28:31], v1, s[16:19], s21 offen offset:3072
    s_add_u32 s21, s21, 4096
    buffer_load_dwordx4 v[32:35], v1, s[16:19], s21 offen offset:0
    buffer_load_dwordx4 v[36:39], v1, s[16:19], s21 offen offset:1024
    buffer_load_dwordx4 v[40:43], v1, s[16:19], s21 offen offset:2048
    buffer_load_dwordx4 v[44:47], v1, s[16:19], s21 offen offset:3072
    s_add_u32 s21, s21, 4096
    s_mul_i32 s22, s22, 1601536
    s_add_u32 s22, s22, 9060352
    s_waitcnt vmcnt(0)
    s_endpgm
.globl k2_kernel
.p2align 8
.type k2_kernel,@function
k2_kernel:
    s_cmp_ge_u32 s2, 256
    s_cbranch_scc1 k2_end
    s_load_dwordx2 s[4:5], s[0:1], 0
    s_load_dwordx2 s[6:7], s[0:1], 104
    s_load_dwordx2 s[8:9], s[0:1], 120
    s_getreg_b32 s42, hwreg(HW_REG_XCC_ID, 0, 4)
    v_lshrrev_b32 v2, 6, v0
    v_and_b32 v1, 63, v0
    v_readfirstlane_b32 s30, v2
    s_and_b32 s28, s2, 7
    s_lshr_b32 s29, s2, 3
    s_lshr_b32 s32, s29, 3
    s_and_b32 s33, s29, 7
    s_lshr_b32 s34, s29, 4
    s_and_b32 s35, s29, 15
    s_mul_i32 s36, s28, 1601536
    s_add_u32 s36, s36, 9060352
    s_lshl_b32 s37, s28, 13
    s_add_u32 s37, s37, 8990720
    s_add_u32 s42, s42, 1
    s_mov_b32 s31, 0
    v_lshlrev_b32 v2, 4, v1
    v_lshrrev_b32 v3, 4, v1
    v_and_b32 v4, 15, v1
    v_lshrrev_b32 v8, 1, v3
    v_lshl_add_u32 v8, v8, 4, v4
    v_and_b32 v9, 1, v3
    v_lshl_add_u32 v8, v8, 1, v9
    v_lshlrev_b32 v8, 3, v8
    v_lshlrev_b32 v5, 7, v1
    v_and_b32 v9, 1, v3
    v_lshlrev_b32 v9, 1, v9
    v_lshrrev_b32 v10, 1, v3
    v_or_b32 v9, v9, v10
    v_lshlrev_b32 v9, 8, v9
    v_lshl_add_u32 v254, v4, 4, v9
    s_waitcnt lgkmcnt(0)
    s_mov_b32 s12, s8
    s_mov_b32 s13, s9
    s_mov_b32 s14, 268435456
    s_mov_b32 s15, 0x00020000
    s_mov_b32 s16, s4
    s_mov_b32 s17, s5
    s_mov_b32 s18, 2621440
    s_mov_b32 s19, 0x00020000
    s_mov_b32 s24, s6
    s_mov_b32 s25, s7
    s_mov_b32 s26, 2621440
    s_mov_b32 s27, 0x00020000
    s_cmp_lg_u32 s30, 0
    s_cbranch_scc1 k2_kernel_L1
    s_lshl_b32 s41, s29, 2
    s_add_u32 s41, s41, s37
    v_mov_b32 v9, s42
    v_mov_b32 v10, 7424
    s_mov_b64 exec, 1
    buffer_store_dword v9, v10, s[12:15], s41 offen sc1
    s_mov_b64 exec, -1
k2_kernel_L1:
    s_mul_i32 s44, s33, 102400
    s_mul_i32 s45, s35, 143360
    s_add_u32 s45, s45, 4403200
    s_mul_i32 s40, s33, 286720
    s_mul_i32 s41, s30, 71680
    s_add_u32 s40, s40, s41
    s_add_u32 s40, s40, 6696960
    s_lshl_b32 s46, s32, 2
    s_add_u32 s46, s46, s30
    s_mul_i32 s47, s46, 20480
    s_mul_i32 s41, s33, 2560
    s_add_u32 s47, s47, s41
    s_add_u32 s54, s47, s36
    s_lshl_b32 s55, s46, 7
    s_add_u32 s55, s55, s37
    s_mul_i32 s22, s28, 327680
    s_add_u32 s22, s22, s47
    s_add_u32 s22, s22, 0
    s_mul_i32 s38, s30, 25600
    s_add_u32 s39, s38, s44
    s_add_u32 s39, s39, 2764800
    s_add_u32 s38, s38, 0
    s_cmp_ge_u32 s29, 18
    s_cbranch_scc1 k2_kernel_nob02
    s_lshl_b32 s46, s28, 8
    s_lshl_b32 s47, s29, 4
    s_add_u32 s46, s46, s47
    s_sub_u32 s46, s46, 16
    s_lshl_b32 s47, s30, 2
    s_add_u32 s47, s47, s46
    v_add_u32 v11, s47, v3
    s_movk_i32 s48, 1280
    v_mul_lo_u32 v6, v11, s48
    v_lshl_add_u32 v6, v4, 4, v6
    buffer_load_dwordx4 v[16:19], v6, s[16:19], 0 offen offset:0
    buffer_load_dwordx4 v[20:23], v6, s[16:19], 0 offen offset:256
    buffer_load_dwordx4 v[24:27], v6, s[16:19], 0 offen offset:512
    buffer_load_dwordx4 v[28:31], v6, s[16:19], 0 offen offset:768
    buffer_load_dwordx4 v[32:35], v6, s[16:19], 0 offen offset:1024
    s_mul_i32 s47, s29, 20480
    s_mul_i32 s48, s30, 5120
    s_add_u32 s47, s47, s48
    s_add_u32 s47, s47, s36
    v_add_u32 v12, s47, v2
    s_add_u32 s48, s48, 135168
    s_mov_b32 m0, s48
    s_nop 0
    buffer_load_dwordx4 v12, s[12:15], 0 offen offset:0 lds
    buffer_load_dwordx4 v12, s[12:15], 0 offen offset:1024 lds
    buffer_load_dwordx4 v12, s[12:15], 0 offen offset:2048 lds
    buffer_load_dwordx4 v12, s[12:15], 0 offen offset:3072 lds
    s_add_u32 s48, s48, 4096
    s_mov_b32 m0, s48
    s_movk_i32 s47, 4096
    buffer_load_dwordx4 v12, s[12:15], s47 offen lds
    s_lshl_b32 s47, s30, 12
    s_add_u32 s48, s47, 118784
    s_add_u32 s41, s47, 0
    s_min_u32 s41, s41, 14336
    s_add_u32 s41, s41, 2711552
    s_add_u32 m0, s48, 0
    s_nop 0
    buffer_load_dwordx4 v2, s[12:15], s41 offen lds
    s_add_u32 s41, s47, 1024
    s_min_u32 s41, s41, 14336
    s_add_u32 s41, s41, 2711552
    s_add_u32 m0, s48, 1024
    s_nop 0
    buffer_load_dwordx4 v2, s[12:15], s41 offen lds
    s_add_u32 s41, s47, 2048
    s_min_u32 s41, s41, 14336
    s_add_u32 s41, s41, 2711552
    s_add_u32 m0, s48, 2048
    s_nop 0
    buffer_load_dwordx4 v2, s[12:15], s41 offen lds
    s_add_u32 s41, s47, 3072
    s_min_u32 s41, s41, 14336
    s_add_u32 s41, s41, 2711552
    s_add_u32 m0, s48, 3072
    s_nop 0
    buffer_load_dwordx4 v2, s[12:15], s41 offen lds
    v_lshl_add_u32 v15, s30, 2, v3
    v_lshrrev_b32 v7, 1, v15
    v_and_b32 v9, 7, v4
    v_xor_b32 v7, v7, v9
    v_and_b32 v9, 1, v15
    v_lshl_add_u32 v7, v7, 1, v9
    v_lshlrev_b32 v7, 3, v7
    v_lshl_add_u32 v7, v4, 8, v7
    v_add_u32 v7, 135168, v7
    v_lshlrev_b32 v10, 5, v4
    v_add_u32 v10, 118784, v10
    v_lshrrev_b32 v12, 2, v4
    v_and_b32 v13, 3, v4
    v_lshl_add_u32 v13, v13, 4, v15
    v_lshlrev_b32 v13, 4, v13
    v_lshl_add_u32 v6, v12, 10, v13
    s_movk_i32 s48, 2048
    v_cmp_gt_u32 s[50:51], s48, v11
    v_mov_b32 v120, 0
    v_mov_b32 v121, 0
    v_mov_b32 v124, 0
    v_mov_b32 v125, 0
    v_mov_b32 v126, 0x3f803f80
    s_waitcnt vmcnt(9)
    v_dot2_f32_bf16 v120, v16, v126, v120
    v_dot2_f32_bf16 v121, v16, v16, v121
    v_lshlrev_b32 v56, 16, v16
    v_and_b32 v57, 0xffff0000, v16
    v_dot2_f32_bf16 v120, v17, v126, v120
    v_dot2_f32_bf16 v121, v17, v17, v121
    v_lshlrev_b32 v58, 16, v17
    v_and_b32 v59, 0xffff0000, v17
    v_dot2_f32_bf16 v120, v18, v126, v120
    v_dot2_f32_bf16 v121, v18, v18, v121
    v_lshlrev_b32 v60, 16, v18
    v_and_b32 v61, 0xffff0000, v18
    s_cmp_eq_u32 s30, 1
    s_cbranch_scc1 k2_kernel_sm4
    s_cmp_ge_u32 s30, 2
    s_cbranch_scc1 k2_kernel_sm5
    s_mul_i32 s41, s33, 320
    s_add_u32 s41, s41, 2748416
    s_mov_b32 m0, 155648
    s_mov_b64 exec, 0xfffff
    buffer_load_dwordx4 v2, s[12:15], s41 offen lds
    s_add_u32 s41, s41, 7168
    s_mov_b32 m0, 156160
    s_nop 0
    buffer_load_dwordx4 v2, s[12:15], s41 offen lds
    s_branch k2_kernel_sm6
k2_kernel_sm4:
    s_mul_i32 s41, s35, 448
    s_add_u32 s41, s41, 2732032
    s_mov_b32 m0, 156672
    s_mov_b64 exec, 0xfffffff
    buffer_load_dwordx4 v2, s[12:15], s41 offen lds
    s_add_u32 s41, s41, 7168
    s_mov_b32 m0, 157184
    s_nop 0
    buffer_load_dwordx4 v2, s[12:15], s41 offen lds
    s_branch k2_kernel_sm6
k2_kernel_sm5:
    s_mul_i32 s41, s33, 320
    s_add_u32 s41, s41, 2724352
    s_mov_b32 m0, 157696
    s_mov_b64 exec, 0xfffff
    buffer_load_dwordx4 v2, s[12:15], s41 offen lds
k2_kernel_sm6:
    s_mov_b64 exec, -1
    v_dot2_f32_bf16 v120, v19, v126, v120
    v_dot2_f32_bf16 v121, v19, v19, v121
    v_lshlrev_b32 v62, 16, v19
    v_and_b32 v63, 0xffff0000, v19
    v_dot2_f32_bf16 v120, v20, v126, v120
    v_dot2_f32_bf16 v121, v20, v20, v121
    v_lshlrev_b32 v64, 16, v20
    v_and_b32 v65, 0xffff0000, v20
    s_mov_b32 m0, s38
    s_nop 0
    buffer_load_dwordx4 v2, s[12:15], s39 offen offset:0 lds
    v_dot2_f32_bf16 v120, v21, v126, v120
    v_dot2_f32_bf16 v121, v21, v21, v121
    v_lshlrev_b32 v66, 16, v21
    v_and_b32 v67, 0xffff0000, v21
    v_dot2_f32_bf16 v120, v22, v126, v120
    v_dot2_f32_bf16 v121, v22, v22, v121
    v_lshlrev_b32 v68, 16, v22
    v_and_b32 v69, 0xffff0000, v22
    s_mov_b32 m0, s38
    s_nop 0
    buffer_load_dwordx4 v2, s[12:15], s39 offen offset:1024 lds
    v_dot2_f32_bf16 v120, v23, v126, v120
    v_dot2_f32_bf16 v121, v23, v23, v121
    v_lshlrev_b32 v70, 16, v23
    v_and_b32 v71, 0xffff0000, v23
    v_dot2_f32_bf16 v120, v24, v126, v120
    v_dot2_f32_bf16 v121, v24, v24, v121
    v_lshlrev_b32 v72, 16, v24
    v_and_b32 v73, 0xffff0000, v24
    s_mov_b32 m0, s38
    s_nop 0
    buffer_load_dwordx4 v2, s[12:15], s39 offen offset:2048 lds
    v_dot2_f32_bf16 v120, v25, v126, v120
    v_dot2_f32_bf16 v121, v25, v25, v121
    v_lshlrev_b32 v74, 16, v25
    v_and_b32 v75, 0xffff0000, v25
    v_dot2_f32_bf16 v120, v26, v126, v120
    v_dot2_f32_bf16 v121, v26, v26, v121
    v_lshlrev_b32 v76, 16, v26
    v_and_b32 v77, 0xffff0000, v26
    s_mov_b32 m0, s38
    s_nop 0
    buffer_load_dwordx4 v2, s[12:15], s39 offen offset:3072 lds
    s_add_u32 s38, s38, 4096
    s_add_u32 s39, s39, 4096
    v_dot2_f32_bf16 v120, v27, v126, v120
    v_dot2_f32_bf16 v121, v27, v27, v121
    v_lshlrev_b32 v78, 16, v27
    v_and_b32 v79, 0xffff0000, v27
    v_dot2_f32_bf16 v120, v28, v126, v120
    v_dot2_f32_bf16 v121, v28, v28, v121
    v_lshlrev_b32 v80, 16, v28
    v_and_b32 v81, 0xffff0000, v28
    s_mov_b32 m0, s38
    s_nop 0
    buffer_load_dwordx4 v2, s[12:15], s39 offen offset:0 lds
    v_dot2_f32_bf16 v120, v29, v126, v120
    v_dot2_f32_bf16 v121, v29, v29, v121
    v_lshlrev_b32 v82, 16, v29
    v_and_b32 v83, 0xffff0000, v29
    v_dot2_f32_bf16 v120, v30, v126, v120
    v_dot2_f32_bf16 v121, v30, v30, v121
    v_lshlrev_b32 v84, 16, v30
    v_and_b32 v85, 0xffff0000, v30
    s_mov_b32 m0, s38
    s_nop 0
    buffer_load_dwordx4 v2, s[12:15], s39 offen offset:1024 lds
    v_dot2_f32_bf16 v120, v31, v126, v120
    v_dot2_f32_bf16 v121, v31, v31, v121
    v_lshlrev_b32 v86, 16, v31
    v_and_b32 v87, 0xffff0000, v31
    v_dot2_f32_bf16 v120, v32, v126, v120
    v_dot2_f32_bf16 v121, v32, v32, v121
    v_lshlrev_b32 v88, 16, v32
    v_and_b32 v89, 0xffff0000, v32
    s_mov_b32 m0, s38
    s_nop 0
    buffer_load_dwordx4 v2, s[12:15], s39 offen offset:2048 lds
    v_dot2_f32_bf16 v120, v33, v126, v120
    v_dot2_f32_bf16 v121, v33, v33, v121
    v_lshlrev_b32 v90, 16, v33
    v_and_b32 v91, 0xffff0000, v33
    v_dot2_f32_bf16 v120, v34, v126, v120
    v_dot2_f32_bf16 v121, v34, v34, v121
    v_lshlrev_b32 v92, 16, v34
    v_and_b32 v93, 0xffff0000, v34
    s_mov_b32 m0, s38
    s_nop 0
    buffer_load_dwordx4 v2, s[12:15], s39 offen offset:3072 lds
    s_add_u32 s38, s38, 4096
    s_add_u32 s39, s39, 4096
    v_dot2_f32_bf16 v120, v35, v126, v120
    v_dot2_f32_bf16 v121, v35, v35, v121
    v_lshlrev_b32 v94, 16, v35
    v_and_b32 v95, 0xffff0000, v35
    s_nop 1
    s_nop 0
    v_add_f32_dpp v120, v120, v120 quad_perm:[1,0,3,2] row_mask:0xf bank_mask:0xf
    v_add_f32_dpp v121, v121, v121 quad_perm:[1,0,3,2] row_mask:0xf bank_mask:0xf
    s_nop 0
    v_add_f32_dpp v120, v120, v120 quad_perm:[2,3,0,1] row_mask:0xf bank_mask:0xf
    v_add_f32_dpp v121, v121, v121 quad_perm:[2,3,0,1] row_mask:0xf bank_mask:0xf
    s_nop 0
    v_add_f32_dpp v120, v120, v120 row_half_mirror row_mask:0xf bank_mask:0xf
    v_add_f32_dpp v121, v121, v121 row_half_mirror row_mask:0xf bank_mask:0xf
    s_nop 0
    v_add_f32_dpp v120, v120, v120 row_mirror row_mask:0xf bank_mask:0xf
    v_add_f32_dpp v121, v121, v121 row_mirror row_mask:0xf bank_mask:0xf
    v_mul_f32 v120, 0x3acccccd, v120
    v_mul_f32 v121, 0x3acccccd, v121
    v_fma_f32 v121, -v120, v120, v121
    v_max_f32 v121, 0, v121
    v_cvt_pk_bf16_f32 v122, v120, v121
    v_lshlrev_b32 v120, 16, v122
    v_and_b32 v121, 0xffff0000, v122
    v_add_f32 v121, 0x3727c5ac, v121
    v_cvt_pk_bf16_f32 v122, v121, v121
    v_lshlrev_b32 v121, 16, v122
    v_sqrt_f32 v121, v121
    s_nop 0
    v_cvt_pk_bf16_f32 v122, v121, v121
    v_lshlrev_b32 v121, 16, v122
    v_rcp_f32 v121, v121
    s_nop 0
    v_mul_f32 v120, v120, v121
    v_sub_f32 v120, 0, v120
    s_waitcnt vmcnt(9)
    s_barrier
    ds_read_b64 v[36:37], v7 offset:0
    ds_read_b64 v[38:39], v7 offset:128
    ds_read_b64 v[40:41], v7 offset:4096
    ds_read_b64 v[42:43], v7 offset:4224
    ds_read_b64 v[44:45], v7 offset:8192
    ds_read_b64 v[46:47], v7 offset:8320
    ds_read_b64 v[48:49], v7 offset:12288
    ds_read_b64 v[50:51], v7 offset:12416
    ds_read_b64 v[52:53], v7 offset:16384
    ds_read_b64 v[54:55], v7 offset:16512
    ds_read_b128 v[96:99], v10 offset:2560
    ds_read_b128 v[100:103], v10 offset:2576
    ds_read_b128 v[104:107], v10 offset:0
    ds_read_b128 v[108:111], v10 offset:16
    ds_read_b128 v[112:115], v10 offset:5120
    ds_read_b128 v[116:119], v10 offset:5136
    ds_read_b128 v[160:163], v10 offset:3072
    ds_read_b128 v[164:167], v10 offset:3088
    ds_read_b128 v[168:171], v10 offset:512
    ds_read_b128 v[172:175], v10 offset:528
    ds_read_b128 v[176:179], v10 offset:5632
    ds_read_b128 v[180:183], v10 offset:5648
    s_waitcnt lgkmcnt(6)
    v_lshlrev_b32 v152, 16, v36
    v_and_b32 v153, 0xffff0000, v36
    v_lshlrev_b32 v154, 16, v37
    v_and_b32 v155, 0xffff0000, v37
    v_lshlrev_b32 v156, 16, v38
    v_and_b32 v157, 0xffff0000, v38
    v_lshlrev_b32 v158, 16, v39
    v_and_b32 v159, 0xffff0000, v39
    v_pk_fma_f32 v[144:145], v[56:57], v[120:121], v[120:121] op_sel:[0,1,0] op_sel_hi:[1,1,0]
    v_pk_fma_f32 v[146:147], v[58:59], v[120:121], v[120:121] op_sel:[0,1,0] op_sel_hi:[1,1,0]
    v_pk_fma_f32 v[148:149], v[60:61], v[120:121], v[120:121] op_sel:[0,1,0] op_sel_hi:[1,1,0]
    v_pk_fma_f32 v[150:151], v[62:63], v[120:121], v[120:121] op_sel:[0,1,0] op_sel_hi:[1,1,0]
    v_pk_fma_f32 v[144:145], v[144:145], v[96:97], v[104:105]
    v_pk_fma_f32 v[146:147], v[146:147], v[98:99], v[106:107]
    v_pk_fma_f32 v[148:149], v[148:149], v[100:101], v[108:109]
    v_pk_fma_f32 v[150:151], v[150:151], v[102:103], v[110:111]
    v_pk_mul_f32 v[144:145], v[144:145], v[152:153]
    v_pk_mul_f32 v[146:147], v[146:147], v[154:155]
    v_pk_mul_f32 v[148:149], v[148:149], v[156:157]
    v_pk_mul_f32 v[150:151], v[150:151], v[158:159]
    v_pk_fma_f32 v[56:57], v[112:113], v[144:145], v[56:57]
    v_pk_fma_f32 v[58:59], v[114:115], v[146:147], v[58:59]
    v_pk_fma_f32 v[60:61], v[116:117], v[148:149], v[60:61]
    v_pk_fma_f32 v[62:63], v[118:119], v[150:151], v[62:63]
    v_cvt_pk_bf16_f32 v16, v56, v57
    v_cvt_pk_bf16_f32 v17, v58, v59
    v_cvt_pk_bf16_f32 v18, v60, v61
    v_cvt_pk_bf16_f32 v19, v62, v63
    v_dot2_f32_bf16 v124, v16, v126, v124
    v_dot2_f32_bf16 v125, v16, v16, v125
    v_dot2_f32_bf16 v124, v17, v126, v124
    v_dot2_f32_bf16 v125, v17, v17, v125
    v_dot2_f32_bf16 v124, v18, v126, v124
    v_dot2_f32_bf16 v125, v18, v18, v125
    v_dot2_f32_bf16 v124, v19, v126, v124
    v_dot2_f32_bf16 v125, v19, v19, v125
    ds_read_b128 v[96:99], v10 offset:3584
    ds_read_b128 v[100:103], v10 offset:3600
    ds_read_b128 v[104:107], v10 offset:1024
    ds_read_b128 v[108:111], v10 offset:1040
    ds_read_b128 v[112:115], v10 offset:6144
    ds_read_b128 v[116:119], v10 offset:6160
    s_waitcnt lgkmcnt(6)
    v_lshlrev_b32 v152, 16, v40
    v_and_b32 v153, 0xffff0000, v40
    v_lshlrev_b32 v154, 16, v41
    v_and_b32 v155, 0xffff0000, v41
    v_lshlrev_b32 v156, 16, v42
    v_and_b32 v157, 0xffff0000, v42
    v_lshlrev_b32 v158, 16, v43
    v_and_b32 v159, 0xffff0000, v43
    v_pk_fma_f32 v[144:145], v[64:65], v[120:121], v[120:121] op_sel:[0,1,0] op_sel_hi:[1,1,0]
    v_pk_fma_f32 v[146:147], v[66:67], v[120:121], v[120:121] op_sel:[0,1,0] op_sel_hi:[1,1,0]
    v_pk_fma_f32 v[148:149], v[68:69], v[120:121], v[120:121] op_sel:[0,1,0] op_sel_hi:[1,1,0]
    v_pk_fma_f32 v[150:151], v[70:71], v[120:121], v[120:121] op_sel:[0,1,0] op_sel_hi:[1,1,0]
    v_pk_fma_f32 v[144:145], v[144:145], v[160:161], v[168:169]
    v_pk_fma_f32 v[146:147], v[146:147], v[162:163], v[170:171]
    v_pk_fma_f32 v[148:149], v[148:149], v[164:165], v[172:173]
    v_pk_fma_f32 v[150:151], v[150:151], v[166:167], v[174:175]
    v_pk_mul_f32 v[144:145], v[144:145], v[152:153]
    v_pk_mul_f32 v[146:147], v[146:147], v[154:155]
    v_pk_mul_f32 v[148:149], v[148:149], v[156:157]
    v_pk_mul_f32 v[150:151], v[150:151], v[158:159]
    v_pk_fma_f32 v[64:65], v[176:177], v[144:145], v[64:65]
    v_pk_fma_f32 v[66:67], v[178:179], v[146:147], v[66:67]
    v_pk_fma_f32 v[68:69], v[180:181], v[148:149], v[68:69]
    v_pk_fma_f32 v[70:71], v[182:183], v[150:151], v[70:71]
    v_cvt_pk_bf16_f32 v20, v64, v65
    v_cvt_pk_bf16_f32 v21, v66, v67
    v_cvt_pk_bf16_f32 v22, v68, v69
    v_cvt_pk_bf16_f32 v23, v70, v71
    v_dot2_f32_bf16 v124, v20, v126, v124
    v_dot2_f32_bf16 v125, v20, v20, v125
    v_dot2_f32_bf16 v124, v21, v126, v124
    v_dot2_f32_bf16 v125, v21, v21, v125
    v_dot2_f32_bf16 v124, v22, v126, v124
    v_dot2_f32_bf16 v125, v22, v22, v125
    v_dot2_f32_bf16 v124, v23, v126, v124
    v_dot2_f32_bf16 v125, v23, v23, v125
    ds_read_b128 v[160:163], v10 offset:4096
    ds_read_b128 v[164:167], v10 offset:4112
    ds_read_b128 v[168:171], v10 offset:1536
    ds_read_b128 v[172:175], v10 offset:1552
    ds_read_b128 v[176:179], v10 offset:6656
    ds_read_b128 v[180:183], v10 offset:6672
    s_waitcnt lgkmcnt(6)
    v_lshlrev_b32 v152, 16, v44
    v_and_b32 v153, 0xffff0000, v44
    v_lshlrev_b32 v154, 16, v45
    v_and_b32 v155, 0xffff0000, v45
    v_lshlrev_b32 v156, 16, v46
    v_and_b32 v157, 0xffff0000, v46
    v_lshlrev_b32 v158, 16, v47
    v_and_b32 v159, 0xffff0000, v47
    v_pk_fma_f32 v[144:145], v[72:73], v[120:121], v[120:121] op_sel:[0,1,0] op_sel_hi:[1,1,0]
    v_pk_fma_f32 v[146:147], v[74:75], v[120:121], v[120:121] op_sel:[0,1,0] op_sel_hi:[1,1,0]
    v_pk_fma_f32 v[148:149], v[76:77], v[120:121], v[120:121] op_sel:[0,1,0] op_sel_hi:[1,1,0]
    v_pk_fma_f32 v[150:151], v[78:79], v[120:121], v[120:121] op_sel:[0,1,0] op_sel_hi:[1,1,0]
    v_pk_fma_f32 v[144:145], v[144:145], v[96:97], v[104:105]
    v_pk_fma_f32 v[146:147], v[146:147], v[98:99], v[106:107]
    v_pk_fma_f32 v[148:149], v[148:149], v[100:101], v[108:109]
    v_pk_fma_f32 v[150:151], v[150:151], v[102:103], v[110:111]
    v_pk_mul_f32 v[144:145], v[144:145], v[152:153]
    v_pk_mul_f32 v[146:147], v[146:147], v[154:155]
    v_pk_mul_f32 v[148:149], v[148:149], v[156:157]
    v_pk_mul_f32 v[150:151], v[150:151], v[158:159]
    v_pk_fma_f32 v[72:73], v[112:113], v[144:145], v[72:73]
    v_pk_fma_f32 v[74:75], v[114:115], v[146:147], v[74:75]
    v_pk_fma_f32 v[76:77], v[116:117], v[148:149], v[76:77]
    v_pk_fma_f32 v[78:79], v[118:119], v[150:151], v[78:79]
    v_cvt_pk_bf16_f32 v24, v72, v73
    v_cvt_pk_bf16_f32 v25, v74, v75
    v_cvt_pk_bf16_f32 v26, v76, v77
    v_cvt_pk_bf16_f32 v27, v78, v79
    v_dot2_f32_bf16 v124, v24, v126, v124
    v_dot2_f32_bf16 v125, v24, v24, v125
    v_dot2_f32_bf16 v124, v25, v126, v124
    v_dot2_f32_bf16 v125, v25, v25, v125
    v_dot2_f32_bf16 v124, v26, v126, v124
    v_dot2_f32_bf16 v125, v26, v26, v125
    v_dot2_f32_bf16 v124, v27, v126, v124
    v_dot2_f32_bf16 v125, v27, v27, v125
    ds_read_b128 v[96:99], v10 offset:4608
    ds_read_b128 v[100:103], v10 offset:4624
    ds_read_b128 v[104:107], v10 offset:2048
    ds_read_b128 v[108:111], v10 offset:2064
    ds_read_b128 v[112:115], v10 offset:7168
    ds_read_b128 v[116:119], v10 offset:7184
    s_waitcnt lgkmcnt(6)
    v_lshlrev_b32 v152, 16, v48
    v_and_b32 v153, 0xffff0000, v48
    v_lshlrev_b32 v154, 16, v49
    v_and_b32 v155, 0xffff0000, v49
    v_lshlrev_b32 v156, 16, v50
    v_and_b32 v157, 0xffff0000, v50
    v_lshlrev_b32 v158, 16, v51
    v_and_b32 v159, 0xffff0000, v51
    v_pk_fma_f32 v[144:145], v[80:81], v[120:121], v[120:121] op_sel:[0,1,0] op_sel_hi:[1,1,0]
    v_pk_fma_f32 v[146:147], v[82:83], v[120:121], v[120:121] op_sel:[0,1,0] op_sel_hi:[1,1,0]
    v_pk_fma_f32 v[148:149], v[84:85], v[120:121], v[120:121] op_sel:[0,1,0] op_sel_hi:[1,1,0]
    v_pk_fma_f32 v[150:151], v[86:87], v[120:121], v[120:121] op_sel:[0,1,0] op_sel_hi:[1,1,0]
    v_pk_fma_f32 v[144:145], v[144:145], v[160:161], v[168:169]
    v_pk_fma_f32 v[146:147], v[146:147], v[162:163], v[170:171]
    v_pk_fma_f32 v[148:149], v[148:149], v[164:165], v[172:173]
    v_pk_fma_f32 v[150:151], v[150:151], v[166:167], v[174:175]
    v_pk_mul_f32 v[144:145], v[144:145], v[152:153]
    v_pk_mul_f32 v[146:147], v[146:147], v[154:155]
    v_pk_mul_f32 v[148:149], v[148:149], v[156:157]
    v_pk_mul_f32 v[150:151], v[150:151], v[158:159]
    v_pk_fma_f32 v[80:81], v[176:177], v[144:145], v[80:81]
    v_pk_fma_f32 v[82:83], v[178:179], v[146:147], v[82:83]
    v_pk_fma_f32 v[84:85], v[180:181], v[148:149], v[84:85]
    v_pk_fma_f32 v[86:87], v[182:183], v[150:151], v[86:87]
    v_cvt_pk_bf16_f32 v28, v80, v81
    v_cvt_pk_bf16_f32 v29, v82, v83
    v_cvt_pk_bf16_f32 v30, v84, v85
    v_cvt_pk_bf16_f32 v31, v86, v87
    v_dot2_f32_bf16 v124, v28, v126, v124
    v_dot2_f32_bf16 v125, v28, v28, v125
    v_dot2_f32_bf16 v124, v29, v126, v124
    v_dot2_f32_bf16 v125, v29, v29, v125
    v_dot2_f32_bf16 v124, v30, v126, v124
    v_dot2_f32_bf16 v125, v30, v30, v125
    v_dot2_f32_bf16 v124, v31, v126, v124
    v_dot2_f32_bf16 v125, v31, v31, v125
    s_waitcnt lgkmcnt(0)
    v_lshlrev_b32 v152, 16, v52
    v_and_b32 v153, 0xffff0000, v52
    v_lshlrev_b32 v154, 16, v53
    v_and_b32 v155, 0xffff0000, v53
    v_lshlrev_b32 v156, 16, v54
    v_and_b32 v157, 0xffff0000, v54
    v_lshlrev_b32 v158, 16, v55
    v_and_b32 v159, 0xffff0000, v55
    v_pk_fma_f32 v[144:145], v[88:89], v[120:121], v[120:121] op_sel:[0,1,0] op_sel_hi:[1,1,0]
    v_pk_fma_f32 v[146:147], v[90:91], v[120:121], v[120:121] op_sel:[0,1,0] op_sel_hi:[1,1,0]
    v_pk_fma_f32 v[148:149], v[92:93], v[120:121], v[120:121] op_sel:[0,1,0] op_sel_hi:[1,1,0]
    v_pk_fma_f32 v[150:151], v[94:95], v[120:121], v[120:121] op_sel:[0,1,0] op_sel_hi:[1,1,0]
    v_pk_fma_f32 v[144:145], v[144:145], v[96:97], v[104:105]
    v_pk_fma_f32 v[146:147], v[146:147], v[98:99], v[106:107]
    v_pk_fma_f32 v[148:149], v[148:149], v[100:101], v[108:109]
    v_pk_fma_f32 v[150:151], v[150:151], v[102:103], v[110:111]
    v_pk_mul_f32 v[144:145], v[144:145], v[152:153]
    v_pk_mul_f32 v[146:147], v[146:147], v[154:155]
    v_pk_mul_f32 v[148:149], v[148:149], v[156:157]
    v_pk_mul_f32 v[150:151], v[150:151], v[158:159]
    v_pk_fma_f32 v[88:89], v[112:113], v[144:145], v[88:89]
    v_pk_fma_f32 v[90:91], v[114:115], v[146:147], v[90:91]
    v_pk_fma_f32 v[92:93], v[116:117], v[148:149], v[92:93]
    v_pk_fma_f32 v[94:95], v[118:119], v[150:151], v[94:95]
    v_cvt_pk_bf16_f32 v32, v88, v89
    v_cvt_pk_bf16_f32 v33, v90, v91
    v_cvt_pk_bf16_f32 v34, v92, v93
    v_cvt_pk_bf16_f32 v35, v94, v95
    v_dot2_f32_bf16 v124, v32, v126, v124
    v_dot2_f32_bf16 v125, v32, v32, v125
    v_dot2_f32_bf16 v124, v33, v126, v124
    v_dot2_f32_bf16 v125, v33, v33, v125
    v_dot2_f32_bf16 v124, v34, v126, v124
    v_dot2_f32_bf16 v125, v34, v34, v125
    v_dot2_f32_bf16 v124, v35, v126, v124
    v_dot2_f32_bf16 v125, v35, v35, v125
    v_and_b32 v191, 31, v1
    v_lshlrev_b32 v191, 2, v191
    s_add_u32 s41, s37, 7424
    buffer_load_dword v190, v191, s[12:15], s41 offen sc1
    ds_read_b128 v[96:99], v10 offset:10240
    ds_read_b128 v[100:103], v10 offset:10256
    ds_read_b128 v[104:107], v10 offset:7680
    ds_read_b128 v[108:111], v10 offset:7696
    s_nop 1
    s_nop 0
    v_add_f32_dpp v124, v124, v124 quad_perm:[1,0,3,2] row_mask:0xf bank_mask:0xf
    v_add_f32_dpp v125, v125, v125 quad_perm:[1,0,3,2] row_mask:0xf bank_mask:0xf
    s_nop 0
    v_add_f32_dpp v124, v124, v124 quad_perm:[2,3,0,1] row_mask:0xf bank_mask:0xf
    v_add_f32_dpp v125, v125, v125 quad_perm:[2,3,0,1] row_mask:0xf bank_mask:0xf
    s_nop 0
    v_add_f32_dpp v124, v124, v124 row_half_mirror row_mask:0xf bank_mask:0xf
    v_add_f32_dpp v125, v125, v125 row_half_mirror row_mask:0xf bank_mask:0xf
    s_nop 0
    v_add_f32_dpp v124, v124, v124 row_mirror row_mask:0xf bank_mask:0xf
    v_add_f32_dpp v125, v125, v125 row_mirror row_mask:0xf bank_mask:0xf
    v_mul_f32 v124, 0x3acccccd, v124
    v_mul_f32 v125, 0x3acccccd, v125
    v_fma_f32 v125, -v124, v124, v125
    v_max_f32 v125, 0, v125
    v_cvt_pk_bf16_f32 v122, v124, v125
    v_lshlrev_b32 v124, 16, v122
    v_and_b32 v125, 0xffff0000, v122
    v_add_f32 v125, 0x3727c5ac, v125
    v_cvt_pk_bf16_f32 v122, v125, v125
    v_lshlrev_b32 v125, 16, v122
    v_sqrt_f32 v125, v125
    s_nop 0
    v_cvt_pk_bf16_f32 v122, v125, v125
    v_lshlrev_b32 v125, 16, v122
    v_rcp_f32 v125, v125
    s_nop 0
    v_mul_f32 v124, v124, v125
    v_sub_f32 v124, 0, v124
    v_mov_b32 v120, 0
    v_mov_b32 v121, 0
    ds_read_b128 v[160:163], v10 offset:10752
    ds_read_b128 v[164:167], v10 offset:10768
    ds_read_b128 v[168:171], v10 offset:8192
    ds_read_b128 v[172:175], v10 offset:8208
    s_waitcnt lgkmcnt(4)
    v_pk_fma_f32 v[56:57], v[56:57], v[124:125], v[124:125] op_sel:[0,1,0] op_sel_hi:[1,1,0]
    v_pk_fma_f32 v[58:59], v[58:59], v[124:125], v[124:125] op_sel:[0,1,0] op_sel_hi:[1,1,0]
    v_pk_fma_f32 v[60:61], v[60:61], v[124:125], v[124:125] op_sel:[0,1,0] op_sel_hi:[1,1,0]
    v_pk_fma_f32 v[62:63], v[62:63], v[124:125], v[124:125] op_sel:[0,1,0] op_sel_hi:[1,1,0]
    v_pk_fma_f32 v[56:57], v[56:57], v[96:97], v[104:105]
    v_pk_fma_f32 v[58:59], v[58:59], v[98:99], v[106:107]
    v_pk_fma_f32 v[60:61], v[60:61], v[100:101], v[108:109]
    v_pk_fma_f32 v[62:63], v[62:63], v[102:103], v[110:111]
    v_cvt_pk_bf16_f32 v36, v56, v57
    v_cvt_pk_bf16_f32 v37, v58, v59
    v_cvt_pk_bf16_f32 v38, v60, v61
    v_cvt_pk_bf16_f32 v39, v62, v63
    v_dot2_f32_bf16 v120, v36, v126, v120
    v_dot2_f32_bf16 v121, v36, v36, v121
    v_dot2_f32_bf16 v120, v37, v126, v120
    v_dot2_f32_bf16 v121, v37, v37, v121
    v_dot2_f32_bf16 v120, v38, v126, v120
    v_dot2_f32_bf16 v121, v38, v38, v121
    v_dot2_f32_bf16 v120, v39, v126, v120
    v_dot2_f32_bf16 v121, v39, v39, v121
    ds_read_b128 v[96:99], v10 offset:11264
    ds_read_b128 v[100:103], v10 offset:11280
    ds_read_b128 v[104:107], v10 offset:8704
    ds_read_b128 v[108:111], v10 offset:8720
    s_waitcnt lgkmcnt(4)
    v_pk_fma_f32 v[64:65], v[64:65], v[124:125], v[124:125] op_sel:[0,1,0] op_sel_hi:[1,1,0]
    v_pk_fma_f32 v[66:67], v[66:67], v[124:125], v[124:125] op_sel:[0,1,0] op_sel_hi:[1,1,0]
    v_pk_fma_f32 v[68:69], v[68:69], v[124:125], v[124:125] op_sel:[0,1,0] op_sel_hi:[1,1,0]
    v_pk_fma_f32 v[70:71], v[70:71], v[124:125], v[124:125] op_sel:[0,1,0] op_sel_hi:[1,1,0]
    v_pk_fma_f32 v[64:65], v[64:65], v[160:161], v[168:169]
    v_pk_fma_f32 v[66:67], v[66:67], v[162:163], v[170:171]
    v_pk_fma_f32 v[68:69], v[68:69], v[164:165], v[172:173]
    v_pk_fma_f32 v[70:71], v[70:71], v[166:167], v[174:175]
    v_cvt_pk_bf16_f32 v40, v64, v65
    v_cvt_pk_bf16_f32 v41, v66, v67
    v_cvt_pk_bf16_f32 v42, v68, v69
    v_cvt_pk_bf16_f32 v43, v70, v71
    v_dot2_f32_bf16 v120, v40, v126, v120
    v_dot2_f32_bf16 v121, v40, v40, v121
    v_dot2_f32_bf16 v120, v41, v126, v120
    v_dot2_f32_bf16 v121, v41, v41, v121
    v_dot2_f32_bf16 v120, v42, v126, v120
    v_dot2_f32_bf16 v121, v42, v42, v121
    v_dot2_f32_bf16 v120, v43, v126, v120
    v_dot2_f32_bf16 v121, v43, v43, v121
    ds_read_b128 v[160:163], v10 offset:11776
    ds_read_b128 v[164:167], v10 offset:11792
    ds_read_b128 v[168:171], v10 offset:9216
    ds_read_b128 v[172:175], v10 offset:9232
    s_waitcnt lgkmcnt(4)
    v_pk_fma_f32 v[72:73], v[72:73], v[124:125], v[124:125] op_sel:[0,1,0] op_sel_hi:[1,1,0]
    v_pk_fma_f32 v[74:75], v[74:75], v[124:125], v[124:125] op_sel:[0,1,0] op_sel_hi:[1,1,0]
    v_pk_fma_f32 v[76:77], v[76:77], v[124:125], v[124:125] op_sel:[0,1,0] op_sel_hi:[1,1,0]
    v_pk_fma_f32 v[78:79], v[78:79], v[124:125], v[124:125] op_sel:[0,1,0] op_sel_hi:[1,1,0]
    v_pk_fma_f32 v[72:73], v[72:73], v[96:97], v[104:105]
    v_pk_fma_f32 v[74:75], v[74:75], v[98:99], v[106:107]
    v_pk_fma_f32 v[76:77], v[76:77], v[100:101], v[108:109]
    v_pk_fma_f32 v[78:79], v[78:79], v[102:103], v[110:111]
    v_cvt_pk_bf16_f32 v44, v72, v73
    v_cvt_pk_bf16_f32 v45, v74, v75
    v_cvt_pk_bf16_f32 v46, v76, v77
    v_cvt_pk_bf16_f32 v47, v78, v79
    v_dot2_f32_bf16 v120, v44, v126, v120
    v_dot2_f32_bf16 v121, v44, v44, v121
    v_dot2_f32_bf16 v120, v45, v126, v120
    v_dot2_f32_bf16 v121, v45, v45, v121
    v_dot2_f32_bf16 v120, v46, v126, v120
    v_dot2_f32_bf16 v121, v46, v46, v121
    v_dot2_f32_bf16 v120, v47, v126, v120
    v_dot2_f32_bf16 v121, v47, v47, v121
    ds_read_b128 v[96:99], v10 offset:12288
    ds_read_b128 v[100:103], v10 offset:12304
    ds_read_b128 v[104:107], v10 offset:9728
    ds_read_b128 v[108:111], v10 offset:9744
    s_waitcnt lgkmcnt(4)
    v_pk_fma_f32 v[80:81], v[80:81], v[124:125], v[124:125] op_sel:[0,1,0] op_sel_hi:[1,1,0]
    v_pk_fma_f32 v[82:83], v[82:83], v[124:125], v[124:125] op_sel:[0,1,0] op_sel_hi:[1,1,0]
    v_pk_fma_f32 v[84:85], v[84:85], v[124:125], v[124:125] op_sel:[0,1,0] op_sel_hi:[1,1,0]
    v_pk_fma_f32 v[86:87], v[86:87], v[124:125], v[124:125] op_sel:[0,1,0] op_sel_hi:[1,1,0]
    v_pk_fma_f32 v[80:81], v[80:81], v[160:161], v[168:169]
    v_pk_fma_f32 v[82:83], v[82:83], v[162:163], v[170:171]
    v_pk_fma_f32 v[84:85], v[84:85], v[164:165], v[172:173]
    v_pk_fma_f32 v[86:87], v[86:87], v[166:167], v[174:175]
    v_cvt_pk_bf16_f32 v48, v80, v81
    v_cvt_pk_bf16_f32 v49, v82, v83
    v_cvt_pk_bf16_f32 v50, v84, v85
    v_cvt_pk_bf16_f32 v51, v86, v87
    v_dot2_f32_bf16 v120, v48, v126, v120
    v_dot2_f32_bf16 v121, v48, v48, v121
    v_dot2_f32_bf16 v120, v49, v126, v120
    v_dot2_f32_bf16 v121, v49, v49, v121
    v_dot2_f32_bf16 v120, v50, v126, v120
    v_dot2_f32_bf16 v121, v50, v50, v121
    v_dot2_f32_bf16 v120, v51, v126, v120
    v_dot2_f32_bf16 v121, v51, v51, v121
    s_waitcnt lgkmcnt(0)
    v_pk_fma_f32 v[88:89], v[88:89], v[124:125], v[124:125] op_sel:[0,1,0] op_sel_hi:[1,1,0]
    v_pk_fma_f32 v[90:91], v[90:91], v[124:125], v[124:125] op_sel:[0,1,0] op_sel_hi:[1,1,0]
    v_pk_fma_f32 v[92:93], v[92:93], v[124:125], v[124:125] op_sel:[0,1,0] op_sel_hi:[1,1,0]
    v_pk_fma_f32 v[94:95], v[94:95], v[124:125], v[124:125] op_sel:[0,1,0] op_sel_hi:[1,1,0]
    v_pk_fma_f32 v[88:89], v[88:89], v[96:97], v[104:105]
    v_pk_fma_f32 v[90:91], v[90:91], v[98:99], v[106:107]
    v_pk_fma_f32 v[92:93], v[92:93], v[100:101], v[108:109]
    v_pk_fma_f32 v[94:95], v[94:95], v[102:103], v[110:111]
    v_cvt_pk_bf16_f32 v52, v88, v89
    v_cvt_pk_bf16_f32 v53, v90, v91
    v_cvt_pk_bf16_f32 v54, v92, v93
    v_cvt_pk_bf16_f32 v55, v94, v95
    v_dot2_f32_bf16 v120, v52, v126, v120
    v_dot2_f32_bf16 v121, v52, v52, v121
    v_dot2_f32_bf16 v120, v53, v126, v120
    v_dot2_f32_bf16 v121, v53, v53, v121
    v_dot2_f32_bf16 v120, v54, v126, v120
    v_dot2_f32_bf16 v121, v54, v54, v121
    v_dot2_f32_bf16 v120, v55, v126, v120
    v_dot2_f32_bf16 v121, v55, v55, v121
    s_nop 1
    s_nop 0
    v_add_f32_dpp v120, v120, v120 quad_perm:[1,0,3,2] row_mask:0xf bank_mask:0xf
    v_add_f32_dpp v121, v121, v121 quad_perm:[1,0,3,2] row_mask:0xf bank_mask:0xf
    s_nop 0
    v_add_f32_dpp v120, v120, v120 quad_perm:[2,3,0,1] row_mask:0xf bank_mask:0xf
    v_add_f32_dpp v121, v121, v121 quad_perm:[2,3,0,1] row_mask:0xf bank_mask:0xf
    s_nop 0
    v_add_f32_dpp v120, v120, v120 row_half_mirror row_mask:0xf bank_mask:0xf
    v_add_f32_dpp v121, v121, v121 row_half_mirror row_mask:0xf bank_mask:0xf
    s_nop 0
    v_add_f32_dpp v120, v120, v120 row_mirror row_mask:0xf bank_mask:0xf
    v_add_f32_dpp v121, v121, v121 row_mirror row_mask:0xf bank_mask:0xf
    v_mul_f32 v120, 0x3acccccd, v120
    v_mul_f32 v121, 0x3acccccd, v121
    v_fma_f32 v121, -v120, v120, v121
    v_max_f32 v121, 0, v121
    v_cvt_pk_bf16_f32 v122, v120, v121
    v_lshlrev_b32 v120, 16, v122
    v_and_b32 v121, 0xffff0000, v122
    v_add_f32 v121, 0x3727c5ac, v121
    v_cvt_pk_bf16_f32 v122, v121, v121
    v_lshlrev_b32 v121, 16, v122
    v_sqrt_f32 v121, v121
    s_nop 0
    v_cvt_pk_bf16_f32 v122, v121, v121
    v_lshlrev_b32 v121, 16, v122
    v_rcp_f32 v121, v121
    s_nop 0
    v_mul_f32 v120, v120, v121
    v_sub_f32 v120, 0, v120
    v_cndmask_b32 v120, 0, v120, s[50:51]
    v_cndmask_b32 v121, 0, v121, s[50:51]
    s_mul_i32 s46, s29, 20480
    s_add_u32 s46, s46, s36
    s_add_u32 s47, s46, 348160
    s_lshl_b32 s48, s29, 7
    s_add_u32 s48, s48, s36
    s_add_u32 s48, s48, 1597440
    v_lshlrev_b32 v12, 3, v15
    s_lshl_b32 s49, s29, 7
    s_add_u32 s49, s49, s37
    s_lshl_b32 s41, s30, 2
    s_add_u32 s49, s49, s41
    s_waitcnt vmcnt(0)
    s_mov_b32 s43, 200000
k2_kernel_xp7:
    v_cmp_ne_u32 vcc, 0, v190
    s_sub_u32 s43, s43, 1
    s_cmp_eq_u64 vcc, -1
    s_cbranch_scc1 k2_kernel_xd8
    s_cmp_eq_u32 s43, 0
    s_cbranch_scc1 k2_kernel_xd8
    s_add_u32 s41, s37, 7424
    buffer_load_dword v190, v191, s[12:15], s41 offen sc1
    s_waitcnt vmcnt(0)
    s_branch k2_kernel_xp7
k2_kernel_xd8:
    v_cmp_eq_u32 vcc, s42, v190
    s_nop 1
    s_cmp_eq_u64 vcc, -1
    s_cselect_b32 s31, 1, 0
    s_barrier
    v_and_b32 v9, 7, v4
    v_xor_b32 v9, v15, v9
    v_and_b32 v10, 3, v4
    v_lshl_add_u32 v9, v10, 4, v9
    v_lshrrev_b32 v10, 2, v4
    v_lshl_add_u32 v9, v10, 6, v9
    v_lshlrev_b32 v9, 4, v9
    v_add_u32 v9, 114688, v9
    ds_write_b128 v9, v[36:39] offset:0
    ds_write_b128 v9, v[16:19] offset:20480
    ds_write_b128 v9, v[40:43] offset:4096
    ds_write_b128 v9, v[20:23] offset:24576
    ds_write_b128 v9, v[44:47] offset:8192
    ds_write_b128 v9, v[24:27] offset:28672
    ds_write_b128 v9, v[48:51] offset:12288
    ds_write_b128 v9, v[28:31] offset:32768
    ds_write_b128 v9, v[52:55] offset:16384
    ds_write_b128 v9, v[32:35] offset:36864
    v_xor_b32 v9, v4, v3
    v_xor_b32 v10, 4, v9
    v_lshl_add_u32 v9, v3, 4, v9
    v_lshl_add_u32 v10, v3, 4, v10
    s_mul_i32 s41, s30, 5120
    s_add_u32 s41, s41, 114688
    v_lshl_add_u32 v9, v9, 4, s41
    v_lshl_add_u32 v10, v10, 4, s41
    s_cmp_eq_u32 s30, 1
    s_cselect_b32 s41, 1, 0
    s_cmp_eq_u32 s30, 3
    s_cselect_b32 s41, 1, s41
    s_cmp_eq_u32 s41, 1
    v_mov_b32 v11, v9
    s_cbranch_scc0 k2_noswap
    v_mov_b32 v9, v10
    v_mov_b32 v10, v11
k2_noswap:
    s_mul_i32 s41, s30, 5120
    s_add_u32 s46, s46, s41
    s_add_u32 s47, s47, s41
    s_waitcnt lgkmcnt(0)
    s_barrier
    ds_read_b128 v[36:39], v9 offset:0
    ds_read_b128 v[40:43], v10 offset:1024
    ds_read_b128 v[44:47], v9 offset:2048
    ds_read_b128 v[48:51], v10 offset:3072
    ds_read_b128 v[52:55], v9 offset:4096
    ds_read_b128 v[220:223], v9 offset:20480
    ds_read_b128 v[224:227], v10 offset:21504
    ds_read_b128 v[228:231], v9 offset:22528
    ds_read_b128 v[232:235], v10 offset:23552
    ds_read_b128 v[236:239], v9 offset:24576
    s_add_u32 s52, s46, 4096
    s_sub_u32 s41, s29, 1
    s_cmp_lt_u32 s41, 16
    s_cselect_b32 s20, s47, 0x90000000
    s_cmp_eq_u32 s31, 0
    s_cbranch_scc1 k2_kernel_slow9
    s_waitcnt lgkmcnt(9)
    buffer_store_dwordx4 v[36:39], v2, s[12:15], s46 offen offset:0
    s_waitcnt lgkmcnt(8)
    buffer_store_dwordx4 v[40:43], v2, s[12:15], s46 offen offset:1024
    s_waitcnt lgkmcnt(7)
    buffer_store_dwordx4 v[44:47], v2, s[12:15], s46 offen offset:2048
    s_waitcnt lgkmcnt(6)
    buffer_store_dwordx4 v[48:51], v2, s[12:15], s46 offen offset:3072
    s_waitcnt lgkmcnt(5)
    buffer_store_dwordx4 v[52:55], v2, s[12:15], s52 offen offset:0
    v_cmp_eq_u32 vcc, 0, v4
    s_and_saveexec_b64 s[50:51], vcc
    buffer_store_dwordx2 v[120:121], v12, s[12:15], s48 offen
    s_mov_b64 exec, -1
    s_waitcnt vmcnt(0)
    v_mov_b32 v9, 1
    v_mov_b32 v10, 0
    s_mov_b64 exec, 1
    buffer_store_dword v9, v10, s[12:15], s49 offen
    s_mov_b64 exec, -1
    s_branch k2_kernel_sent10
k2_kernel_slow9:
    s_waitcnt lgkmcnt(9)
    buffer_store_dwordx4 v[36:39], v2, s[12:15], s46 offen offset:0 sc1
    s_waitcnt lgkmcnt(8)
    buffer_store_dwordx4 v[40:43], v2, s[12:15], s46 offen offset:1024 sc1
    s_waitcnt lgkmcnt(7)
    buffer_store_dwordx4 v[44:47], v2, s[12:15], s46 offen offset:2048 sc1
    s_waitcnt lgkmcnt(6)
    buffer_store_dwordx4 v[48:51], v2, s[12:15], s46 offen offset:3072 sc1
    s_waitcnt lgkmcnt(5)
    buffer_store_dwordx4 v[52:55], v2, s[12:15], s52 offen offset:0 sc1
    v_cmp_eq_u32 vcc, 0, v4
    s_and_saveexec_b64 s[50:51], vcc
    buffer_store_dwordx2 v[120:121], v12, s[12:15], s48 offen sc1
    s_mov_b64 exec, -1
    s_waitcnt vmcnt(0)
    v_mov_b32 v9, 1
    v_mov_b32 v10, 0
    s_mov_b64 exec, 1
    buffer_store_dword v9, v10, s[12:15], s49 offen sc1
    s_mov_b64 exec, -1
k2_kernel_sent10:
    s_mov_b32 s21, s49
    s_mov_b32 m0, s38
    s_nop 0
    buffer_load_dwordx4 v2, s[12:15], s39 offen offset:0 lds
    s_mov_b32 m0, s38
    s_nop 0
    buffer_load_dwordx4 v2, s[12:15], s39 offen offset:1024 lds
    s_mov_b32 m0, s38
    s_nop 0
    buffer_load_dwordx4 v2, s[12:15], s39 offen offset:2048 lds
    s_mov_b32 m0, s38
    s_nop 0
    buffer_load_dwordx4 v2, s[12:15], s39 offen offset:3072 lds
    s_add_u32 s38, s38, 4096
    s_add_u32 s39, s39, 4096
    s_mov_b32 m0, s38
    s_nop 0
    buffer_load_dwordx4 v2, s[12:15], s39 offen offset:0 lds
    s_mov_b32 m0, s38
    s_nop 0
    buffer_load_dwordx4 v2, s[12:15], s39 offen offset:1024 lds
    s_mov_b32 m0, s38
    s_nop 0
    buffer_load_dwordx4 v2, s[12:15], s39 offen offset:2048 lds
    s_mov_b32 m0, s38
    s_nop 0
    buffer_load_dwordx4 v2, s[12:15], s39 offen offset:3072 lds
    s_add_u32 s38, s38, 4096
    s_add_u32 s39, s39, 4096
    s_mov_b32 m0, s38
    s_nop 0
    buffer_load_dwordx4 v2, s[12:15], s39 offen offset:0 lds
    s_mov_b32 m0, s38
    s_nop 0
    buffer_load_dwordx4 v2, s[12:15], s39 offen offset:1024 lds
    s_mov_b32 m0, s38
    s_nop 0
    buffer_load_dwordx4 v2, s[12:15], s39 offen offset:2048 lds
    s_mov_b32 m0, s38
    s_nop 0
    buffer_load_dwordx4 v2, s[12:15], s39 offen offset:3072 lds
    s_add_u32 s38, s38, 4096
    s_add_u32 s39, s39, 4096
    s_mov_b32 m0, s38
    s_nop 0
    buffer_load_dwordx4 v2, s[12:15], s39 offen offset:0 lds
    s_mov_b32 m0, s38
    s_nop 0
    buffer_load_dwordx4 v2, s[12:15], s39 offen offset:1024 lds
    s_mov_b32 m0, s38
    s_nop 0
    buffer_load_dwordx4 v2, s[12:15], s39 offen offset:2048 lds
    s_mov_b32 m0, s38
    s_nop 0
    buffer_load_dwordx4 v2, s[12:15], s39 offen offset:3072 lds
    s_add_u32 s38, s38, 4096
    s_add_u32 s39, s39, 4096
    s_mov_b32 m0, s38
    s_nop 0
    buffer_load_dwordx4 v2, s[12:15], s39 offen offset:0 lds
    s_branch k2_kernel_join03
k2_kernel_nob02:
    s_getpc_b64 s[46:47]
k2_pcref:
    s_sub_u32 s46, s46, k2_pcref-k2_kernel
    s_subb_u32 s47, s47, 0
    s_sub_u32 s48, s29, 18
    s_lshl_b32 s48, s48, 2
    s_add_u32 s48, s48, s30
    s_lshl_b32 s48, s48, 10
    s_min_u32 s48, s48, (CODE_END-k2_kernel-1020)&0xfffffff0
    v_add_u32 v104, s48, v2
    global_load_dwordx4 v[108:111], v104, s[46:47]
    s_mov_b32 s21, 0
    s_mov_b32 s20, 0x90000000
    s_mul_i32 s38, s30, 25600
    s_add_u32 s39, s38, s44
    s_add_u32 s39, s39, 2764800
    v_and_b32 v191, 31, v1
    v_lshlrev_b32 v191, 2, v191
    s_add_u32 s41, s37, 7424
    buffer_load_dword v190, v191, s[12:15], s41 offen sc1
    s_waitcnt vmcnt(0)
    s_mov_b32 s43, 200000
k2_kernel_xp11:
    v_cmp_ne_u32 vcc, 0, v190
    s_sub_u32 s43, s43, 1
    s_cmp_eq_u64 vcc, -1
    s_cbranch_scc1 k2_kernel_xd12
    s_cmp_eq_u32 s43, 0
    s_cbranch_scc1 k2_kernel_xd12
    s_add_u32 s41, s37, 7424
    buffer_load_dword v190, v191, s[12:15], s41 offen sc1
    s_waitcnt vmcnt(0)
    s_branch k2_kernel_xp11
k2_kernel_xd12:
    v_cmp_eq_u32 vcc, s42, v190
    s_nop 1
    s_cmp_eq_u64 vcc, -1
    s_cselect_b32 s31, 1, 0
    s_cmp_eq_u32 s30, 1
    s_cbranch_scc1 k2_kernel_sm13
    s_cmp_ge_u32 s30, 2
    s_cbranch_scc1 k2_kernel_sm14
    s_mul_i32 s41, s33, 320
    s_add_u32 s41, s41, 2748416
    s_mov_b32 m0, 155648
    s_mov_b64 exec, 0xfffff
    buffer_load_dwordx4 v2, s[12:15], s41 offen lds
    s_add_u32 s41, s41, 7168
    s_mov_b32 m0, 156160
    s_nop 0
    buffer_load_dwordx4 v2, s[12:15], s41 offen lds
    s_branch k2_kernel_sm15
k2_kernel_sm13:
    s_mul_i32 s41, s35, 448
    s_add_u32 s41, s41, 2732032
    s_mov_b32 m0, 156672
    s_mov_b64 exec, 0xfffffff
    buffer_load_dwordx4 v2, s[12:15], s41 offen lds
    s_add_u32 s41, s41, 7168
    s_mov_b32 m0, 157184
    s_nop 0
    buffer_load_dwordx4 v2, s[12:15], s41 offen lds
    s_branch k2_kernel_sm15
k2_kernel_sm14:
    s_mul_i32 s41, s33, 320
    s_add_u32 s41, s41, 2724352
    s_mov_b32 m0, 157696
    s_mov_b64 exec, 0xfffff
    buffer_load_dwordx4 v2, s[12:15], s41 offen lds
k2_kernel_sm15:
    s_mov_b64 exec, -1
    s_mov_b32 m0, s38
    s_nop 0
    buffer_load_dwordx4 v2, s[12:15], s39 offen offset:0 lds
    s_mov_b32 m0, s38
    s_nop 0
    buffer_load_dwordx4 v2, s[12:15], s39 offen offset:1024 lds
    s_mov_b32 m0, s38
    s_nop 0
    buffer_load_dwordx4 v2, s[12:15], s39 offen offset:2048 lds
    s_mov_b32 m0, s38
    s_nop 0
    buffer_load_dwordx4 v2, s[12:15], s39 offen offset:3072 lds
    s_add_u32 s38, s38, 4096
    s_add_u32 s39, s39, 4096
    s_mov_b32 m0, s38
    s_nop 0
    buffer_load_dwordx4 v2, s[12:15], s39 offen offset:0 lds
    s_mov_b32 m0, s38
    s_nop 0
    buffer_load_dwordx4 v2, s[12:15], s39 offen offset:1024 lds
    s_mov_b32 m0, s38
    s_nop 0
    buffer_load_dwordx4 v2, s[12:15], s39 offen offset:2048 lds
    s_mov_b32 m0, s38
    s_nop 0
    buffer_load_dwordx4 v2, s[12:15], s39 offen offset:3072 lds
    s_add_u32 s38, s38, 4096
    s_add_u32 s39, s39, 4096
    s_mov_b32 m0, s38
    s_nop 0
    buffer_load_dwordx4 v2, s[12:15], s39 offen offset:0 lds
    s_mov_b32 m0, s38
    s_nop 0
    buffer_load_dwordx4 v2, s[12:15], s39 offen offset:1024 lds
    s_mov_b32 m0, s38
    s_nop 0
    buffer_load_dwordx4 v2, s[12:15], s39 offen offset:2048 lds
    s_mov_b32 m0, s38
    s_nop 0
    buffer_load_dwordx4 v2, s[12:15], s39 offen offset:3072 lds
    s_add_u32 s38, s38, 4096
    s_add_u32 s39, s39, 4096
    s_mov_b32 m0, s38
    s_nop 0
    buffer_load_dwordx4 v2, s[12:15], s39 offen offset:0 lds
    s_mov_b32 m0, s38
    s_nop 0
    buffer_load_dwordx4 v2, s[12:15], s39 offen offset:1024 lds
    s_mov_b32 m0, s38
    s_nop 0
    buffer_load_dwordx4 v2, s[12:15], s39 offen offset:2048 lds
    s_mov_b32 m0, s38
    s_nop 0
    buffer_load_dwordx4 v2, s[12:15], s39 offen offset:3072 lds
    s_add_u32 s38, s38, 4096
    s_add_u32 s39, s39, 4096
    s_mov_b32 m0, s38
    s_nop 0
    buffer_load_dwordx4 v2, s[12:15], s39 offen offset:0 lds
    s_mov_b32 m0, s38
    s_nop 0
    buffer_load_dwordx4 v2, s[12:15], s39 offen offset:1024 lds
    s_mov_b32 m0, s38
    s_nop 0
    buffer_load_dwordx4 v2, s[12:15], s39 offen offset:2048 lds
    s_mov_b32 m0, s38
    s_nop 0
    buffer_load_dwordx4 v2, s[12:15], s39 offen offset:3072 lds
    s_add_u32 s38, s38, 4096
    s_add_u32 s39, s39, 4096
    s_mov_b32 m0, s38
    s_nop 0
    buffer_load_dwordx4 v2, s[12:15], s39 offen offset:0 lds
    s_mov_b32 m0, s38
    s_nop 0
    buffer_load_dwordx4 v2, s[12:15], s39 offen offset:1024 lds
    s_mov_b32 m0, s38
    s_nop 0
    buffer_load_dwordx4 v2, s[12:15], s39 offen offset:2048 lds
    s_mov_b32 m0, s38
    s_nop 0
    buffer_load_dwordx4 v2, s[12:15], s39 offen offset:3072 lds
    s_add_u32 s38, s38, 4096
    s_add_u32 s39, s39, 4096
    s_mov_b32 m0, s38
    s_nop 0
    buffer_load_dwordx4 v2, s[12:15], s39 offen offset:0 lds
    s_mul_i32 s47, s28, 327680
    s_lshl_b32 s48, s29, 13
    s_add_u32 s47, s47, s48
    v_mov_b32 v101, 0
    s_mov_b64 exec, 1
    buffer_load_dword v102, v101, s[24:27], s47 offen
    s_mov_b64 exec, -1
    s_cmp_eq_u32 s31, 0
    s_cbranch_scc1 k2_kernel_nt16
    s_sub_u32 s47, s29, 18
    s_lshl_b32 s47, s47, 2
    s_add_u32 s47, s47, s30
    s_mul_i32 s48, s47, 6144
    s_min_u32 s48, s48, 321536
    s_mul_i32 s49, s28, 327680
    s_add_u32 s48, s48, s49
    s_add_u32 s48, s48, 0
    buffer_load_dwordx4 v[64:67], v2, s[12:15], s48 offen offset:0
    buffer_load_dwordx4 v[68:71], v2, s[12:15], s48 offen offset:1024
    buffer_load_dwordx4 v[72:75], v2, s[12:15], s48 offen offset:2048
    buffer_load_dwordx4 v[76:79], v2, s[12:15], s48 offen offset:3072
    s_add_u32 s48, s48, 4096
    buffer_load_dwordx4 v[80:83], v2, s[12:15], s48 offen offset:0
    buffer_load_dwordx4 v[84:87], v2, s[12:15], s48 offen offset:1024
    s_mul_i32 s48, s47, 384
    s_min_u32 s48, s48, 20096
    s_add_u32 s48, s48, s36
    s_add_u32 s48, s48, 1581056
    s_mov_b64 exec, 7
    buffer_load_dword v100, v5, s[12:15], s48 offen
    s_mov_b64 exec, -1
k2_kernel_nt16:
k2_kernel_join03:
    s_lshl_b32 s46, s32, 2
    s_add_u32 s46, s46, s30
    s_lshr_b32 s47, s33, 1
    s_and_b32 s48, s47, 1
    s_lshr_b32 s47, s47, 1
    s_add_u32 s47, s47, 1
    s_sub_u32 s49, 0, s47
    s_cmp_eq_u32 s48, 1
    s_cselect_b32 s47, s47, s49
    s_lshl_b32 s49, s46, 4
    s_add_u32 s49, s49, 16
    s_add_u32 s49, s49, s47
    v_add_u32 v9, s49, v4
    v_lshrrev_b32 v10, 4, v9
    v_mul_u32_u24 v6, 20480, v10
    v_and_b32 v10, 15, v9
    v_lshl_add_u32 v10, v3, 4, v10
    v_lshl_add_u32 v6, v10, 4, v6
    v_lshlrev_b32 v13, 3, v9
    s_add_u32 s49, s46, s48
    s_lshl_b32 s49, s49, 7
    s_add_u32 s49, s49, s37
    v_bfe_u32 v7, v1, 2, 1
    v_lshlrev_b32 v7, 7, v7
    v_and_b32 v9, 3, v1
    v_lshl_add_u32 v7, v9, 2, v7
    s_mov_b32 s43, 200000
k2_kernel_poll17:
    buffer_load_dword v9, v7, s[12:15], s49 offen sc1
    s_waitcnt vmcnt(0)
    v_cmp_ne_u32 vcc, 0, v9
    s_sub_u32 s43, s43, 1
    s_cmp_eq_u64 vcc, -1
    s_cbranch_scc1 k2_kernel_go18
    s_cmp_lg_u32 s43, 0
    s_cbranch_scc1 k2_kernel_poll17
k2_kernel_go18:
    s_add_u32 s41, s36, 0
    buffer_load_dwordx4 v[16:19], v6, s[12:15], s41 offen offset:0 sc1
    s_add_u32 s41, s36, 0
    buffer_load_dwordx4 v[20:23], v6, s[12:15], s41 offen offset:1024 sc1
    s_add_u32 s41, s36, 0
    buffer_load_dwordx4 v[24:27], v6, s[12:15], s41 offen offset:2048 sc1
    s_add_u32 s41, s36, 0
    buffer_load_dwordx4 v[28:31], v6, s[12:15], s41 offen offset:3072 sc1
    s_add_u32 s41, s36, 1597440
    buffer_load_dwordx2 v[176:177], v13, s[12:15], s41 offen sc1
    v_mov_b32 v14, v2
    v_add_u32 v15, 0x10000, v2
    v_add_u32 v11, 0x20000, v2
    s_barrier
    s_mul_i32 s38, s30, 13312
    s_add_u32 s39, s38, s44
    s_add_u32 s39, s39, 3584000
    s_add_u32 s38, s38, 102400
    ds_read_b128 v[96:99], v14 offset:0
    ds_read_b128 v[100:103], v14 offset:1024
    ds_read_b128 v[104:107], v14 offset:2048
    ds_read_b128 v[108:111], v14 offset:3072
    ds_read_b128 v[112:115], v14 offset:4096
    ds_read_b128 v[116:119], v14 offset:5120
    ds_read_b128 v[120:123], v14 offset:6144
    ds_read_b128 v[124:127], v14 offset:7168
    ds_read_b128 v[128:131], v14 offset:8192
    ds_read_b128 v[132:135], v14 offset:9216
    s_waitcnt vmcnt(4)
    s_waitcnt lgkmcnt(5)
    v_mfma_f32_16x16x32_bf16 v[156:159], v[96:99], v[16:19], 0
    s_add_u32 s41, s36, 4096
    buffer_load_dwordx4 v[32:35], v6, s[12:15], s41 offen offset:0 sc1
    v_mfma_f32_16x16x32_bf16 v[160:163], v[100:103], v[16:19], 0
    ds_read_b128 v[136:139], v14 offset:10240
    v_mfma_f32_16x16x32_bf16 v[164:167], v[104:107], v[16:19], 0
    ds_read_b128 v[140:143], v14 offset:11264
    v_mfma_f32_16x16x32_bf16 v[168:171], v[108:111], v[16:19], 0
    ds_read_b128 v[144:147], v14 offset:12288
    s_add_u32 s41, s36, 4096
    buffer_load_dwordx4 v[36:39], v6, s[12:15], s41 offen offset:1024 sc1
    v_mfma_f32_16x16x32_bf16 v[172:175], v[112:115], v[16:19], 0
    ds_read_b128 v[148:151], v14 offset:13312
    ds_read_b128 v[152:155], v14 offset:14336
    s_waitcnt vmcnt(5)
    s_waitcnt lgkmcnt(5)
    v_mfma_f32_16x16x32_bf16 v[156:159], v[116:119], v[20:23], v[156:159]
    s_add_u32 s41, s36, 4096
    buffer_load_dwordx4 v[40:43], v6, s[12:15], s41 offen offset:2048 sc1
    v_mfma_f32_16x16x32_bf16 v[160:163], v[120:123], v[20:23], v[160:163]
    ds_read_b128 v[96:99], v14 offset:15360
    v_mfma_f32_16x16x32_bf16 v[164:167], v[124:127], v[20:23], v[164:167]
    ds_read_b128 v[100:103], v14 offset:16384
    v_mfma_f32_16x16x32_bf16 v[168:171], v[128:131], v[20:23], v[168:171]
    ds_read_b128 v[104:107], v14 offset:17408
    s_add_u32 s41, s36, 4096
    buffer_load_dwordx4 v[44:47], v6, s[12:15], s41 offen offset:3072 sc1
    v_mfma_f32_16x16x32_bf16 v[172:175], v[132:135], v[20:23], v[172:175]
    ds_read_b128 v[108:111], v14 offset:18432
    ds_read_b128 v[112:115], v14 offset:19456
    s_waitcnt vmcnt(6)
    s_waitcnt lgkmcnt(5)
    v_mfma_f32_16x16x32_bf16 v[156:159], v[136:139], v[24:27], v[156:159]
    s_add_u32 s41, s36, 8192
    buffer_load_dwordx4 v[48:51], v6, s[12:15], s41 offen offset:0 sc1
    v_mfma_f32_16x16x32_bf16 v[160:163], v[140:143], v[24:27], v[160:163]
    ds_read_b128 v[116:119], v14 offset:20480
    v_mfma_f32_16x16x32_bf16 v[164:167], v[144:147], v[24:27], v[164:167]
    ds_read_b128 v[120:123], v14 offset:21504
    v_mfma_f32_16x16x32_bf16 v[168:171], v[148:151], v[24:27], v[168:171]
    ds_read_b128 v[124:127], v14 offset:22528
    s_add_u32 s41, s36, 8192
    buffer_load_dwordx4 v[52:55], v6, s[12:15], s41 offen offset:1024 sc1
    v_mfma_f32_16x16x32_bf16 v[172:175], v[152:155], v[24:27], v[172:175]
    ds_read_b128 v[128:131], v14 offset:23552
    ds_read_b128 v[132:135], v14 offset:24576
    s_waitcnt vmcnt(7)
    s_waitcnt lgkmcnt(5)
    v_mfma_f32_16x16x32_bf16 v[156:159], v[96:99], v[28:31], v[156:159]
    s_add_u32 s41, s36, 8192
    buffer_load_dwordx4 v[56:59], v6, s[12:15], s41 offen offset:2048 sc1
    v_mfma_f32_16x16x32_bf16 v[160:163], v[100:103], v[28:31], v[160:163]
    ds_read_b128 v[136:139], v14 offset:25600
    v_mfma_f32_16x16x32_bf16 v[164:167], v[104:107], v[28:31], v[164:167]
    ds_read_b128 v[140:143], v14 offset:26624
    v_mfma_f32_16x16x32_bf16 v[168:171], v[108:111], v[28:31], v[168:171]
    ds_read_b128 v[144:147], v14 offset:27648
    s_add_u32 s41, s36, 8192
    buffer_load_dwordx4 v[60:63], v6, s[12:15], s41 offen offset:3072 sc1
    v_mfma_f32_16x16x32_bf16 v[172:175], v[112:115], v[28:31], v[172:175]
    ds_read_b128 v[148:151], v14 offset:28672
    ds_read_b128 v[152:155], v14 offset:29696
    s_waitcnt vmcnt(7)
    s_waitcnt lgkmcnt(5)
    v_mfma_f32_16x16x32_bf16 v[156:159], v[116:119], v[32:35], v[156:159]
    s_add_u32 s41, s36, 12288
    buffer_load_dwordx4 v[64:67], v6, s[12:15], s41 offen offset:0 sc1
    v_mfma_f32_16x16x32_bf16 v[160:163], v[120:123], v[32:35], v[160:163]
    ds_read_b128 v[96:99], v14 offset:30720
    v_mfma_f32_16x16x32_bf16 v[164:167], v[124:127], v[32:35], v[164:167]
    ds_read_b128 v[100:103], v14 offset:31744
    v_mfma_f32_16x16x32_bf16 v[168:171], v[128:131], v[32:35], v[168:171]
    ds_read_b128 v[104:107], v14 offset:32768
    s_add_u32 s41, s36, 12288
    buffer_load_dwordx4 v[68:71], v6, s[12:15], s41 offen offset:1024 sc1
    v_mfma_f32_16x16x32_bf16 v[172:175], v[132:135], v[32:35], v[172:175]
    ds_read_b128 v[108:111], v14 offset:33792
    ds_read_b128 v[112:115], v14 offset:34816
    s_waitcnt vmcnt(8)
    s_waitcnt lgkmcnt(5)
    v_mfma_f32_16x16x32_bf16 v[156:159], v[136:139], v[36:39], v[156:159]
    s_add_u32 s41, s36, 12288
    buffer_load_dwordx4 v[72:75], v6, s[12:15], s41 offen offset:2048 sc1
    v_mfma_f32_16x16x32_bf16 v[160:163], v[140:143], v[36:39], v[160:163]
    ds_read_b128 v[116:119], v14 offset:35840
    v_mfma_f32_16x16x32_bf16 v[164:167], v[144:147], v[36:39], v[164:167]
    ds_read_b128 v[120:123], v14 offset:36864
    v_mfma_f32_16x16x32_bf16 v[168:171], v[148:151], v[36:39], v[168:171]
    ds_read_b128 v[124:127], v14 offset:37888
    s_add_u32 s41, s36, 12288
    buffer_load_dwordx4 v[76:79], v6, s[12:15], s41 offen offset:3072 sc1
    v_mfma_f32_16x16x32_bf16 v[172:175], v[152:155], v[36:39], v[172:175]
    ds_read_b128 v[128:131], v14 offset:38912
    ds_read_b128 v[132:135], v14 offset:39936
    s_waitcnt vmcnt(9)
    s_waitcnt lgkmcnt(5)
    v_mfma_f32_16x16x32_bf16 v[156:159], v[96:99], v[40:43], v[156:159]
    s_add_u32 s41, s36, 16384
    buffer_load_dwordx4 v[80:83], v6, s[12:15], s41 offen offset:0 sc1
    v_mfma_f32_16x16x32_bf16 v[160:163], v[100:103], v[40:43], v[160:163]
    ds_read_b128 v[136:139], v14 offset:40960
    v_mfma_f32_16x16x32_bf16 v[164:167], v[104:107], v[40:43], v[164:167]
    ds_read_b128 v[140:143], v14 offset:41984
    v_mfma_f32_16x16x32_bf16 v[168:171], v[108:111], v[40:43], v[168:171]
    ds_read_b128 v[144:147], v14 offset:43008
    s_add_u32 s41, s36, 16384
    buffer_load_dwordx4 v[84:87], v6, s[12:15], s41 offen offset:1024 sc1
    v_mfma_f32_16x16x32_bf16 v[172:175], v[112:115], v[40:43], v[172:175]
    ds_read_b128 v[148:151], v14 offset:44032
    ds_read_b128 v[152:155], v14 offset:45056
    s_waitcnt vmcnt(10)
    s_waitcnt lgkmcnt(5)
    v_mfma_f32_16x16x32_bf16 v[156:159], v[116:119], v[44:47], v[156:159]
    s_add_u32 s41, s36, 16384
    buffer_load_dwordx4 v[88:91], v6, s[12:15], s41 offen offset:2048 sc1
    v_mfma_f32_16x16x32_bf16 v[160:163], v[120:123], v[44:47], v[160:163]
    ds_read_b128 v[96:99], v14 offset:46080
    v_mfma_f32_16x16x32_bf16 v[164:167], v[124:127], v[44:47], v[164:167]
    ds_read_b128 v[100:103], v14 offset:47104
    v_mfma_f32_16x16x32_bf16 v[168:171], v[128:131], v[44:47], v[168:171]
    ds_read_b128 v[104:107], v14 offset:48128
    s_add_u32 s41, s36, 16384
    buffer_load_dwordx4 v[92:95], v6, s[12:15], s41 offen offset:3072 sc1
    v_mfma_f32_16x16x32_bf16 v[172:175], v[132:135], v[44:47], v[172:175]
    ds_read_b128 v[108:111], v14 offset:49152
    ds_read_b128 v[112:115], v14 offset:50176
    s_waitcnt vmcnt(11)
    s_waitcnt lgkmcnt(5)
    v_mfma_f32_16x16x32_bf16 v[156:159], v[136:139], v[48:51], v[156:159]
    v_mfma_f32_16x16x32_bf16 v[160:163], v[140:143], v[48:51], v[160:163]
    ds_read_b128 v[116:119], v14 offset:51200
    s_mov_b32 m0, s38
    s_nop 0
    buffer_load_dwordx4 v2, s[12:15], s39 offen offset:0 lds
    v_mfma_f32_16x16x32_bf16 v[164:167], v[144:147], v[48:51], v[164:167]
    ds_read_b128 v[120:123], v14 offset:52224
    v_mfma_f32_16x16x32_bf16 v[168:171], v[148:151], v[48:51], v[168:171]
    ds_read_b128 v[124:127], v14 offset:53248
    v_mfma_f32_16x16x32_bf16 v[172:175], v[152:155], v[48:51], v[172:175]
    ds_read_b128 v[128:131], v14 offset:54272
    ds_read_b128 v[132:135], v14 offset:55296
    s_add_u32 s41, s20, 0
    buffer_store_dwordx4 v[220:223], v2, s[12:15], s41 offen sc1
    s_waitcnt vmcnt(12)
    s_waitcnt lgkmcnt(5)
    s_barrier
    v_mfma_f32_16x16x32_bf16 v[156:159], v[96:99], v[52:55], v[156:159]
    v_mfma_f32_16x16x32_bf16 v[160:163], v[100:103], v[52:55], v[160:163]
    ds_read_b128 v[136:139], v14 offset:56320
    s_mov_b32 m0, s38
    s_nop 0
    buffer_load_dwordx4 v2, s[12:15], s39 offen offset:1024 lds
    v_mfma_f32_16x16x32_bf16 v[164:167], v[104:107], v[52:55], v[164:167]
    ds_read_b128 v[140:143], v14 offset:57344
    v_mfma_f32_16x16x32_bf16 v[168:171], v[108:111], v[52:55], v[168:171]
    ds_read_b128 v[144:147], v14 offset:58368
    v_mfma_f32_16x16x32_bf16 v[172:175], v[112:115], v[52:55], v[172:175]
    ds_read_b128 v[148:151], v14 offset:59392
    ds_read_b128 v[152:155], v14 offset:60416
    s_add_u32 s41, s20, 1024
    buffer_store_dwordx4 v[224:227], v2, s[12:15], s41 offen sc1
    s_waitcnt vmcnt(13)
    s_waitcnt lgkmcnt(5)
    v_mfma_f32_16x16x32_bf16 v[156:159], v[116:119], v[56:59], v[156:159]
    v_mfma_f32_16x16x32_bf16 v[160:163], v[120:123], v[56:59], v[160:163]
    ds_read_b128 v[96:99], v14 offset:61440
    s_mov_b32 m0, s38
    s_nop 0
    buffer_load_dwordx4 v2, s[12:15], s39 offen offset:2048 lds
    v_mfma_f32_16x16x32_bf16 v[164:167], v[124:127], v[56:59], v[164:167]
    ds_read_b128 v[100:103], v14 offset:62464
    v_mfma_f32_16x16x32_bf16 v[168:171], v[128:131], v[56:59], v[168:171]
    ds_read_b128 v[104:107], v14 offset:63488
    v_mfma_f32_16x16x32_bf16 v[172:175], v[132:135], v[56:59], v[172:175]
    ds_read_b128 v[108:111], v14 offset:64512
    ds_read_b128 v[112:115], v15 offset:0
    s_add_u32 s41, s20, 2048
    buffer_store_dwordx4 v[228:231], v2, s[12:15], s41 offen sc1
    s_waitcnt vmcnt(14)
    s_waitcnt lgkmcnt(5)
    v_mfma_f32_16x16x32_bf16 v[156:159], v[136:139], v[60:63], v[156:159]
    v_mfma_f32_16x16x32_bf16 v[160:163], v[140:143], v[60:63], v[160:163]
    ds_read_b128 v[116:119], v15 offset:1024
    s_mov_b32 m0, s38
    s_nop 0
    buffer_load_dwordx4 v2, s[12:15], s39 offen offset:3072 lds
    s_add_u32 s38, s38, 4096
    s_add_u32 s39, s39, 4096
    v_mfma_f32_16x16x32_bf16 v[164:167], v[144:147], v[60:63], v[164:167]
    ds_read_b128 v[120:123], v15 offset:2048
    v_mfma_f32_16x16x32_bf16 v[168:171], v[148:151], v[60:63], v[168:171]
    ds_read_b128 v[124:127], v15 offset:3072
    v_mfma_f32_16x16x32_bf16 v[172:175], v[152:155], v[60:63], v[172:175]
    ds_read_b128 v[128:131], v15 offset:4096
    ds_read_b128 v[132:135], v15 offset:5120
    s_add_u32 s41, s20, 3072
    buffer_store_dwordx4 v[232:235], v2, s[12:15], s41 offen sc1
    s_waitcnt vmcnt(15)
    s_waitcnt lgkmcnt(5)
    v_mfma_f32_16x16x32_bf16 v[156:159], v[96:99], v[64:67], v[156:159]
    v_mfma_f32_16x16x32_bf16 v[160:163], v[100:103], v[64:67], v[160:163]
    ds_read_b128 v[136:139], v15 offset:6144
    s_mov_b32 m0, s38
    s_nop 0
    buffer_load_dwordx4 v2, s[12:15], s39 offen offset:0 lds
    v_mfma_f32_16x16x32_bf16 v[164:167], v[104:107], v[64:67], v[164:167]
    ds_read_b128 v[140:143], v15 offset:7168
    v_mfma_f32_16x16x32_bf16 v[168:171], v[108:111], v[64:67], v[168:171]
    ds_read_b128 v[144:147], v15 offset:8192
    v_mfma_f32_16x16x32_bf16 v[172:175], v[112:115], v[64:67], v[172:175]
    ds_read_b128 v[148:151], v15 offset:9216
    ds_read_b128 v[152:155], v15 offset:10240
    s_add_u32 s41, s20, 4096
    buffer_store_dwordx4 v[236:239], v2, s[12:15], s41 offen sc1
    s_waitcnt vmcnt(16)
    s_waitcnt lgkmcnt(5)
    v_mfma_f32_16x16x32_bf16 v[156:159], v[116:119], v[68:71], v[156:159]
    v_mfma_f32_16x16x32_bf16 v[160:163], v[120:123], v[68:71], v[160:163]
    ds_read_b128 v[96:99], v15 offset:11264
    s_mov_b32 m0, s38
    s_nop 0
    buffer_load_dwordx4 v2, s[12:15], s39 offen offset:1024 lds
    v_mfma_f32_16x16x32_bf16 v[164:167], v[124:127], v[68:71], v[164:167]
    ds_read_b128 v[100:103], v15 offset:12288
    v_mfma_f32_16x16x32_bf16 v[168:171], v[128:131], v[68:71], v[168:171]
    ds_read_b128 v[104:107], v15 offset:13312
    v_mfma_f32_16x16x32_bf16 v[172:175], v[132:135], v[68:71], v[172:175]
    ds_read_b128 v[108:111], v15 offset:14336
    ds_read_b128 v[112:115], v15 offset:15360
    s_mov_b32 m0, s38
    s_nop 0
    buffer_load_dwordx4 v2, s[12:15], s39 offen offset:2048 lds
    s_waitcnt vmcnt(17)
    s_waitcnt lgkmcnt(5)
    v_mfma_f32_16x16x32_bf16 v[156:159], v[136:139], v[72:75], v[156:159]
    v_mfma_f32_16x16x32_bf16 v[160:163], v[140:143], v[72:75], v[160:163]
    ds_read_b128 v[116:119], v15 offset:16384
    s_mov_b32 m0, s38
    s_nop 0
    buffer_load_dwordx4 v2, s[12:15], s39 offen offset:3072 lds
    s_add_u32 s38, s38, 4096
    s_add_u32 s39, s39, 4096
    v_mfma_f32_16x16x32_bf16 v[164:167], v[144:147], v[72:75], v[164:167]
    ds_read_b128 v[120:123], v15 offset:17408
    v_mfma_f32_16x16x32_bf16 v[168:171], v[148:151], v[72:75], v[168:171]
    ds_read_b128 v[124:127], v15 offset:18432
    v_mfma_f32_16x16x32_bf16 v[172:175], v[152:155], v[72:75], v[172:175]
    ds_read_b128 v[128:131], v15 offset:19456
    ds_read_b128 v[132:135], v15 offset:20480
    s_mov_b32 m0, s38
    s_nop 0
    buffer_load_dwordx4 v2, s[12:15], s39 offen offset:0 lds
    s_waitcnt vmcnt(18)
    s_waitcnt lgkmcnt(5)
    v_mfma_f32_16x16x32_bf16 v[156:159], v[96:99], v[76:79], v[156:159]
    v_mfma_f32_16x16x32_bf16 v[160:163], v[100:103], v[76:79], v[160:163]
    ds_read_b128 v[136:139], v15 offset:21504
    s_mov_b32 m0, s38
    s_nop 0
    buffer_load_dwordx4 v2, s[12:15], s39 offen offset:1024 lds
    v_mfma_f32_16x16x32_bf16 v[164:167], v[104:107], v[76:79], v[164:167]
    ds_read_b128 v[140:143], v15 offset:22528
    v_mfma_f32_16x16x32_bf16 v[168:171], v[108:111], v[76:79], v[168:171]
    ds_read_b128 v[144:147], v15 offset:23552
    v_mfma_f32_16x16x32_bf16 v[172:175], v[112:115], v[76:79], v[172:175]
    ds_read_b128 v[148:151], v15 offset:24576
    ds_read_b128 v[152:155], v15 offset:25600
    s_mov_b32 m0, s38
    s_nop 0
    buffer_load_dwordx4 v2, s[12:15], s39 offen offset:2048 lds
    s_waitcnt vmcnt(19)
    s_waitcnt lgkmcnt(5)
    v_mfma_f32_16x16x32_bf16 v[156:159], v[116:119], v[80:83], v[156:159]
    v_mfma_f32_16x16x32_bf16 v[160:163], v[120:123], v[80:83], v[160:163]
    ds_read_b128 v[96:99], v15 offset:26624
    s_mov_b32 m0, s38
    s_nop 0
    buffer_load_dwordx4 v2, s[12:15], s39 offen offset:3072 lds
    s_add_u32 s38, s38, 4096
    s_add_u32 s39, s39, 4096
    v_mfma_f32_16x16x32_bf16 v[164:167], v[124:127], v[80:83], v[164:167]
    ds_read_b128 v[100:103], v15 offset:27648
    v_mfma_f32_16x16x32_bf16 v[168:171], v[128:131], v[80:83], v[168:171]
    ds_read_b128 v[104:107], v15 offset:28672
    v_mfma_f32_16x16x32_bf16 v[172:175], v[132:135], v[80:83], v[172:175]
    ds_read_b128 v[108:111], v15 offset:29696
    ds_read_b128 v[112:115], v15 offset:30720
    s_mov_b32 m0, s38
    s_nop 0
    buffer_load_dwordx4 v2, s[12:15], s39 offen offset:0 lds
    s_waitcnt vmcnt(20)
    s_waitcnt lgkmcnt(5)
    v_mfma_f32_16x16x32_bf16 v[156:159], v[136:139], v[84:87], v[156:159]
    v_mfma_f32_16x16x32_bf16 v[160:163], v[140:143], v[84:87], v[160:163]
    ds_read_b128 v[116:119], v15 offset:31744
    s_mul_i32 s38, s30, 12288
    s_add_u32 s39, s38, s44
    s_add_u32 s39, s39, 3637248
    s_add_u32 s38, s38, 0
    s_mov_b32 m0, s38
    s_nop 0
    buffer_load_dwordx4 v2, s[12:15], s39 offen offset:0 lds
    v_mfma_f32_16x16x32_bf16 v[164:167], v[144:147], v[84:87], v[164:167]
    ds_read_b128 v[120:123], v15 offset:32768
    v_mfma_f32_16x16x32_bf16 v[168:171], v[148:151], v[84:87], v[168:171]
    ds_read_b128 v[124:127], v15 offset:33792
    v_mfma_f32_16x16x32_bf16 v[172:175], v[152:155], v[84:87], v[172:175]
    ds_read_b128 v[128:131], v15 offset:34816
    ds_read_b128 v[132:135], v15 offset:35840
    s_mov_b32 m0, s38
    s_nop 0
    buffer_load_dwordx4 v2, s[12:15], s39 offen offset:1024 lds
    s_waitcnt vmcnt(21)
    s_waitcnt lgkmcnt(5)
    v_mfma_f32_16x16x32_bf16 v[156:159], v[96:99], v[88:91], v[156:159]
    v_mfma_f32_16x16x32_bf16 v[160:163], v[100:103], v[88:91], v[160:163]
    s_mov_b32 m0, s38
    s_nop 0
    buffer_load_dwordx4 v2, s[12:15], s39 offen offset:2048 lds
    v_mfma_f32_16x16x32_bf16 v[164:167], v[104:107], v[88:91], v[164:167]
    v_mfma_f32_16x16x32_bf16 v[168:171], v[108:111], v[88:91], v[168:171]
    v_mfma_f32_16x16x32_bf16 v[172:175], v[112:115], v[88:91], v[172:175]
    s_mov_b32 m0, s38
    s_nop 0
    buffer_load_dwordx4 v2, s[12:15], s39 offen offset:3072 lds
    s_add_u32 s38, s38, 4096
    s_add_u32 s39, s39, 4096
    s_waitcnt vmcnt(22)
    s_waitcnt lgkmcnt(0)
    v_mfma_f32_16x16x32_bf16 v[156:159], v[116:119], v[92:95], v[156:159]
    v_mfma_f32_16x16x32_bf16 v[160:163], v[120:123], v[92:95], v[160:163]
    s_mov_b32 m0, s38
    s_nop 0
    buffer_load_dwordx4 v2, s[12:15], s39 offen offset:0 lds
    v_mfma_f32_16x16x32_bf16 v[164:167], v[124:127], v[92:95], v[164:167]
    v_mfma_f32_16x16x32_bf16 v[168:171], v[128:131], v[92:95], v[168:171]
    v_mfma_f32_16x16x32_bf16 v[172:175], v[132:135], v[92:95], v[172:175]
    s_mov_b32 m0, s38
    s_nop 0
    buffer_load_dwordx4 v2, s[12:15], s39 offen offset:1024 lds
    s_barrier
    s_mov_b32 m0, s38
    s_nop 0
    buffer_load_dwordx4 v2, s[12:15], s39 offen offset:2048 lds
    s_mov_b32 m0, s38
    s_nop 0
    buffer_load_dwordx4 v2, s[12:15], s39 offen offset:3072 lds
    s_add_u32 s38, s38, 4096
    s_add_u32 s39, s39, 4096
    s_mov_b32 m0, s38
    s_nop 0
    buffer_load_dwordx4 v2, s[12:15], s39 offen offset:0 lds
    s_mov_b32 m0, s38
    s_nop 0
    buffer_load_dwordx4 v2, s[12:15], s39 offen offset:1024 lds
    s_mov_b32 m0, s38
    s_nop 0
    buffer_load_dwordx4 v2, s[12:15], s39 offen offset:2048 lds
    s_mov_b32 m0, s38
    s_nop 0
    buffer_load_dwordx4 v2, s[12:15], s39 offen offset:3072 lds
    s_mul_i32 s38, s30, 13312
    s_add_u32 s39, s38, s45
    s_add_u32 s39, s39, 0
    s_add_u32 s38, s38, 49152
    s_mov_b32 m0, s38
    s_nop 0
    buffer_load_dwordx4 v2, s[12:15], s39 offen offset:0 lds
    s_mov_b32 m0, s38
    s_nop 0
    buffer_load_dwordx4 v2, s[12:15], s39 offen offset:1024 lds
    s_mov_b32 m0, s38
    s_nop 0
    buffer_load_dwordx4 v2, s[12:15], s39 offen offset:2048 lds
    s_mov_b32 m0, s38
    s_nop 0
    buffer_load_dwordx4 v2, s[12:15], s39 offen offset:3072 lds
    s_add_u32 s38, s38, 4096
    s_add_u32 s39, s39, 4096
    s_mov_b32 m0, s38
    s_nop 0
    buffer_load_dwordx4 v2, s[12:15], s39 offen offset:0 lds
    s_mov_b32 m0, s38
    s_nop 0
    buffer_load_dwordx4 v2, s[12:15], s39 offen offset:1024 lds
    s_mov_b32 m0, s38
    s_nop 0
    buffer_load_dwordx4 v2, s[12:15], s39 offen offset:2048 lds
    s_mov_b32 m0, s38
    s_nop 0
    buffer_load_dwordx4 v2, s[12:15], s39 offen offset:3072 lds
    s_add_u32 s38, s38, 4096
    s_add_u32 s39, s39, 4096
    s_mov_b32 m0, s38
    s_nop 0
    buffer_load_dwordx4 v2, s[12:15], s39 offen offset:0 lds
    s_mov_b32 m0, s38
    s_nop 0
    buffer_load_dwordx4 v2, s[12:15], s39 offen offset:1024 lds
    s_mov_b32 m0, s38
    s_nop 0
    buffer_load_dwordx4 v2, s[12:15], s39 offen offset:2048 lds
    s_mov_b32 m0, s38
    s_nop 0
    buffer_load_dwordx4 v2, s[12:15], s39 offen offset:3072 lds
    s_add_u32 s38, s38, 4096
    s_add_u32 s39, s39, 4096
    s_mov_b32 m0, s38
    s_nop 0
    buffer_load_dwordx4 v2, s[12:15], s39 offen offset:0 lds
    v_lshlrev_b32 v9, 4, v3
    v_add_u32 v9, 155648, v9
    v_mov_b32 v12, 0xbdd2d3e8
    v_mov_b32 v13, 0xc0135761
    ds_read_b128 v[180:183], v9 offset:0
    ds_read_b128 v[200:203], v9 offset:512
    ds_read_b128 v[184:187], v9 offset:64
    ds_read_b128 v[204:207], v9 offset:576
    ds_read_b128 v[188:191], v9 offset:128
    ds_read_b128 v[208:211], v9 offset:640
    ds_read_b128 v[192:195], v9 offset:192
    ds_read_b128 v[212:215], v9 offset:704
    ds_read_b128 v[196:199], v9 offset:256
    ds_read_b128 v[216:219], v9 offset:768
    s_waitcnt lgkmcnt(0)
    v_pk_add_f32 v[180:181], v[180:181], v[200:201]
    v_pk_add_f32 v[182:183], v[182:183], v[202:203]
    v_pk_add_f32 v[184:185], v[184:185], v[204:205]
    v_pk_add_f32 v[186:187], v[186:187], v[206:207]
    v_pk_add_f32 v[188:189], v[188:189], v[208:209]
    v_pk_add_f32 v[190:191], v[190:191], v[210:211]
    v_pk_add_f32 v[192:193], v[192:193], v[212:213]
    v_pk_add_f32 v[194:195], v[194:195], v[214:215]
    v_pk_add_f32 v[196:197], v[196:197], v[216:217]
    v_pk_add_f32 v[198:199], v[198:199], v[218:219]
    v_pk_mul_f32 v[200:201], v[180:181], v[176:177] op_sel_hi:[1,0]
    v_pk_mul_f32 v[202:203], v[182:183], v[176:177] op_sel_hi:[1,0]
    v_pk_mul_f32 v[204:205], v[184:185], v[176:177] op_sel_hi:[1,0]
    v_pk_mul_f32 v[206:207], v[186:187], v[176:177] op_sel_hi:[1,0]
    v_pk_mul_f32 v[208:209], v[188:189], v[176:177] op_sel_hi:[1,0]
    v_pk_mul_f32 v[210:211], v[190:191], v[176:177] op_sel_hi:[1,0]
    v_pk_mul_f32 v[212:213], v[192:193], v[176:177] op_sel_hi:[1,0]
    v_pk_mul_f32 v[214:215], v[194:195], v[176:177] op_sel_hi:[1,0]
    v_pk_mul_f32 v[216:217], v[196:197], v[176:177] op_sel_hi:[1,0]
    v_pk_mul_f32 v[218:219], v[198:199], v[176:177] op_sel_hi:[1,0]
    v_pk_fma_f32 v[156:157], v[156:157], v[176:177], v[200:201] op_sel:[0,1,0] op_sel_hi:[1,1,1]
    v_pk_fma_f32 v[158:159], v[158:159], v[176:177], v[202:203] op_sel:[0,1,0] op_sel_hi:[1,1,1]
    v_pk_fma_f32 v[160:161], v[160:161], v[176:177], v[204:205] op_sel:[0,1,0] op_sel_hi:[1,1,1]
    v_pk_fma_f32 v[162:163], v[162:163], v[176:177], v[206:207] op_sel:[0,1,0] op_sel_hi:[1,1,1]
    v_pk_fma_f32 v[164:165], v[164:165], v[176:177], v[208:209] op_sel:[0,1,0] op_sel_hi:[1,1,1]
    v_pk_fma_f32 v[166:167], v[166:167], v[176:177], v[210:211] op_sel:[0,1,0] op_sel_hi:[1,1,1]
    v_pk_fma_f32 v[168:169], v[168:169], v[176:177], v[212:213] op_sel:[0,1,0] op_sel_hi:[1,1,1]
    v_pk_fma_f32 v[170:171], v[170:171], v[176:177], v[214:215] op_sel:[0,1,0] op_sel_hi:[1,1,1]
    v_pk_fma_f32 v[172:173], v[172:173], v[176:177], v[216:217] op_sel:[0,1,0] op_sel_hi:[1,1,1]
    v_pk_fma_f32 v[174:175], v[174:175], v[176:177], v[218:219] op_sel:[0,1,0] op_sel_hi:[1,1,1]
    v_pk_mul_f32 v[200:201], v[156:157], v[156:157]
    v_pk_mul_f32 v[202:203], v[158:159], v[158:159]
    v_pk_mul_f32 v[204:205], v[160:161], v[160:161]
    v_pk_mul_f32 v[206:207], v[162:163], v[162:163]
    v_pk_mul_f32 v[208:209], v[164:165], v[164:165]
    v_pk_mul_f32 v[210:211], v[166:167], v[166:167]
    v_pk_mul_f32 v[212:213], v[168:169], v[168:169]
    v_pk_mul_f32 v[214:215], v[170:171], v[170:171]
    v_pk_mul_f32 v[216:217], v[172:173], v[172:173]
    v_pk_mul_f32 v[218:219], v[174:175], v[174:175]
    v_pk_fma_f32 v[200:201], v[200:201], v[12:13], v[12:13] op_sel:[0,0,1] op_sel_hi:[1,0,1]
    v_pk_fma_f32 v[202:203], v[202:203], v[12:13], v[12:13] op_sel:[0,0,1] op_sel_hi:[1,0,1]
    v_pk_fma_f32 v[204:205], v[204:205], v[12:13], v[12:13] op_sel:[0,0,1] op_sel_hi:[1,0,1]
    v_pk_fma_f32 v[206:207], v[206:207], v[12:13], v[12:13] op_sel:[0,0,1] op_sel_hi:[1,0,1]
    v_pk_fma_f32 v[208:209], v[208:209], v[12:13], v[12:13] op_sel:[0,0,1] op_sel_hi:[1,0,1]
    v_pk_fma_f32 v[210:211], v[210:211], v[12:13], v[12:13] op_sel:[0,0,1] op_sel_hi:[1,0,1]
    v_pk_fma_f32 v[212:213], v[212:213], v[12:13], v[12:13] op_sel:[0,0,1] op_sel_hi:[1,0,1]
    v_pk_fma_f32 v[214:215], v[214:215], v[12:13], v[12:13] op_sel:[0,0,1] op_sel_hi:[1,0,1]
    v_pk_fma_f32 v[216:217], v[216:217], v[12:13], v[12:13] op_sel:[0,0,1] op_sel_hi:[1,0,1]
    v_pk_fma_f32 v[218:219], v[218:219], v[12:13], v[12:13] op_sel:[0,0,1] op_sel_hi:[1,0,1]
    v_pk_mul_f32 v[200:201], v[200:201], v[156:157]
    v_pk_mul_f32 v[202:203], v[202:203], v[158:159]
    v_pk_mul_f32 v[204:205], v[204:205], v[160:161]
    v_pk_mul_f32 v[206:207], v[206:207], v[162:163]
    v_pk_mul_f32 v[208:209], v[208:209], v[164:165]
    v_pk_mul_f32 v[210:211], v[210:211], v[166:167]
    v_pk_mul_f32 v[212:213], v[212:213], v[168:169]
    v_pk_mul_f32 v[214:215], v[214:215], v[170:171]
    v_pk_mul_f32 v[216:217], v[216:217], v[172:173]
    v_pk_mul_f32 v[218:219], v[218:219], v[174:175]
    v_exp_f32 v200, v200
    v_exp_f32 v201, v201
    v_exp_f32 v202, v202
    v_exp_f32 v203, v203
    v_exp_f32 v204, v204
    v_exp_f32 v205, v205
    v_exp_f32 v206, v206
    v_exp_f32 v207, v207
    v_exp_f32 v208, v208
    v_exp_f32 v209, v209
    v_exp_f32 v210, v210
    v_exp_f32 v211, v211
    v_exp_f32 v212, v212
    v_exp_f32 v213, v213
    v_exp_f32 v214, v214
    v_exp_f32 v215, v215
    v_exp_f32 v216, v216
    v_exp_f32 v217, v217
    v_exp_f32 v218, v218
    v_exp_f32 v219, v219
    v_pk_add_f32 v[200:201], v[200:201], 1.0 op_sel_hi:[1,0]
    v_pk_add_f32 v[202:203], v[202:203], 1.0 op_sel_hi:[1,0]
    v_pk_add_f32 v[204:205], v[204:205], 1.0 op_sel_hi:[1,0]
    v_pk_add_f32 v[206:207], v[206:207], 1.0 op_sel_hi:[1,0]
    v_pk_add_f32 v[208:209], v[208:209], 1.0 op_sel_hi:[1,0]
    v_pk_add_f32 v[210:211], v[210:211], 1.0 op_sel_hi:[1,0]
    v_pk_add_f32 v[212:213], v[212:213], 1.0 op_sel_hi:[1,0]
    v_pk_add_f32 v[214:215], v[214:215], 1.0 op_sel_hi:[1,0]
    v_pk_add_f32 v[216:217], v[216:217], 1.0 op_sel_hi:[1,0]
    v_pk_add_f32 v[218:219], v[218:219], 1.0 op_sel_hi:[1,0]
    v_rcp_f32 v200, v200
    v_rcp_f32 v201, v201
    v_rcp_f32 v202, v202
    v_rcp_f32 v203, v203
    v_rcp_f32 v204, v204
    v_rcp_f32 v205, v205
    v_rcp_f32 v206, v206
    v_rcp_f32 v207, v207
    v_rcp_f32 v208, v208
    v_rcp_f32 v209, v209
    v_rcp_f32 v210, v210
    v_rcp_f32 v211, v211
    v_rcp_f32 v212, v212
    v_rcp_f32 v213, v213
    v_rcp_f32 v214, v214
    v_rcp_f32 v215, v215
    v_rcp_f32 v216, v216
    v_rcp_f32 v217, v217
    v_rcp_f32 v218, v218
    v_rcp_f32 v219, v219
    s_nop 0
    v_pk_mul_f32 v[156:157], v[156:157], v[200:201]
    v_pk_mul_f32 v[158:159], v[158:159], v[202:203]
    v_pk_mul_f32 v[160:161], v[160:161], v[204:205]
    v_pk_mul_f32 v[162:163], v[162:163], v[206:207]
    v_pk_mul_f32 v[164:165], v[164:165], v[208:209]
    v_pk_mul_f32 v[166:167], v[166:167], v[210:211]
    v_pk_mul_f32 v[168:169], v[168:169], v[212:213]
    v_pk_mul_f32 v[170:171], v[170:171], v[214:215]
    v_pk_mul_f32 v[172:173], v[172:173], v[216:217]
    v_pk_mul_f32 v[174:175], v[174:175], v[218:219]
    v_cvt_pk_bf16_f32 v156, v156, v157
    v_cvt_pk_bf16_f32 v157, v158, v159
    v_cvt_pk_bf16_f32 v158, v160, v161
    v_cvt_pk_bf16_f32 v159, v162, v163
    v_cvt_pk_bf16_f32 v164, v164, v165
    v_cvt_pk_bf16_f32 v165, v166, v167
    v_cvt_pk_bf16_f32 v166, v168, v169
    v_cvt_pk_bf16_f32 v167, v170, v171
    v_cvt_pk_bf16_f32 v172, v172, v173
    v_cvt_pk_bf16_f32 v173, v174, v175
    s_nop 1
    v_permlane16_swap_b32 v156, v158
    v_permlane16_swap_b32 v157, v159
    v_permlane16_swap_b32 v164, v166
    v_permlane16_swap_b32 v165, v167
    s_mov_b32 s46, s22
    s_lshl_b32 s41, s33, 2
    s_add_u32 s49, s55, s41
    s_cmp_eq_u32 s31, 0
    s_cbranch_scc1 k2_kernel_slow19
    buffer_store_dwordx4 v[156:159], v254, s[12:15], s46 offen offset:0
    buffer_store_dwordx4 v[164:167], v254, s[12:15], s46 offen offset:1024
    buffer_store_dwordx2 v[172:173], v8, s[12:15], s46 offen offset:2048
    s_waitcnt vmcnt(0)
    v_mov_b32 v9, 1
    v_mov_b32 v10, 2304
    s_mov_b64 exec, 1
    buffer_store_dword v9, v10, s[12:15], s49 offen
    s_mov_b64 exec, -1
    s_branch k2_kernel_sent20
k2_kernel_slow19:
    buffer_store_dwordx4 v[156:159], v254, s[12:15], s46 offen offset:0 sc1
    buffer_store_dwordx4 v[164:167], v254, s[12:15], s46 offen offset:1024 sc1
    buffer_store_dwordx2 v[172:173], v8, s[12:15], s46 offen offset:2048 sc1
    s_waitcnt vmcnt(0)
    v_mov_b32 v9, 1
    v_mov_b32 v10, 2304
    s_mov_b64 exec, 1
    buffer_store_dword v9, v10, s[12:15], s49 offen sc1
    s_mov_b64 exec, -1
k2_kernel_sent20:
    s_cmp_eq_u32 s21, 0
    s_cbranch_scc1 k2_kernel_xas23
    v_mov_b32 v9, 3
    v_mov_b32 v10, 0
    s_mov_b64 exec, 1
    s_cmp_eq_u32 s31, 0
    s_cbranch_scc1 k2_kernel_xas21
    buffer_store_dword v9, v10, s[12:15], s21 offen
    s_branch k2_kernel_xas22
k2_kernel_xas21:
    buffer_store_dword v9, v10, s[12:15], s21 offen sc1
k2_kernel_xas22:
    s_mov_b64 exec, -1
k2_kernel_xas23:
    s_sub_u32 s41, s55, s37
    s_lshr_b32 s41, s41, 7
    v_bfe_u32 v7, v1, 3, 2
    v_min_u32 v7, 2, v7
    v_add_u32 v7, s41, v7
    v_subrev_u32 v7, 1, v7
    v_max_i32 v7, 0, v7
    v_min_i32 v7, 15, v7
    v_lshlrev_b32 v7, 7, v7
    v_and_b32 v9, 7, v1
    v_lshl_add_u32 v7, v9, 2, v7
    s_add_u32 s49, s37, 2304
    s_mov_b32 s43, 200000
k2_kernel_poll24:
    buffer_load_dword v9, v7, s[12:15], s49 offen sc1
    s_waitcnt vmcnt(0)
    v_cmp_ne_u32 vcc, 0, v9
    s_sub_u32 s43, s43, 1
    s_cmp_eq_u64 vcc, -1
    s_cbranch_scc1 k2_kernel_go25
    s_cmp_lg_u32 s43, 0
    s_cbranch_scc1 k2_kernel_poll24
k2_kernel_go25:
    s_mul_i32 s41, s33, 2560
    s_sub_u32 s47, s22, s41
    s_mov_b32 s52, s47
    s_add_u32 s41, s52, 0
    buffer_load_dwordx4 v[16:19], v2, s[12:15], s41 offen offset:0 sc1
    s_add_u32 s41, s52, 0
    buffer_load_dwordx4 v[20:23], v2, s[12:15], s41 offen offset:1024 sc1
    s_add_u32 s41, s52, 0
    buffer_load_dwordx4 v[24:27], v2, s[12:15], s41 offen offset:2048 sc1
    s_add_u32 s41, s52, 0
    buffer_load_dwordx4 v[28:31], v2, s[12:15], s41 offen offset:3072 sc1
    s_add_u32 s41, s54, 20480
    s_mov_b32 s48, s41
    s_sub_u32 s41, s55, s37
    s_lshl_b32 s41, s41, 3
    s_add_u32 s46, s41, s36
    s_add_u32 s46, s46, 1581056
    s_barrier
    ds_read_b128 v[96:99], v15 offset:36864
    ds_read_b128 v[100:103], v15 offset:37888
    ds_read_b128 v[104:107], v15 offset:38912
    ds_read_b128 v[108:111], v15 offset:39936
    ds_read_b128 v[112:115], v15 offset:40960
    ds_read_b128 v[116:119], v15 offset:41984
    ds_read_b128 v[120:123], v15 offset:43008
    ds_read_b128 v[124:127], v15 offset:44032
    ds_read_b128 v[128:131], v15 offset:45056
    ds_read_b128 v[132:135], v15 offset:46080
    s_waitcnt vmcnt(3)
    s_waitcnt lgkmcnt(5)
    v_mfma_f32_16x16x32_bf16 v[156:159], v[96:99], v[16:19], 0
    s_add_u32 s41, s52, 4096
    buffer_load_dwordx4 v[32:35], v2, s[12:15], s41 offen offset:0 sc1
    v_mfma_f32_16x16x32_bf16 v[160:163], v[100:103], v[16:19], 0
    ds_read_b128 v[136:139], v15 offset:47104
    v_mfma_f32_16x16x32_bf16 v[164:167], v[104:107], v[16:19], 0
    ds_read_b128 v[140:143], v15 offset:48128
    v_mfma_f32_16x16x32_bf16 v[168:171], v[108:111], v[16:19], 0
    ds_read_b128 v[144:147], v15 offset:49152
    s_add_u32 s41, s52, 4096
    buffer_load_dwordx4 v[36:39], v2, s[12:15], s41 offen offset:1024 sc1
    v_mfma_f32_16x16x32_bf16 v[172:175], v[112:115], v[16:19], 0
    ds_read_b128 v[148:151], v15 offset:50176
    ds_read_b128 v[152:155], v15 offset:51200
    s_waitcnt vmcnt(4)
    s_waitcnt lgkmcnt(5)
    v_mfma_f32_16x16x32_bf16 v[156:159], v[116:119], v[20:23], v[156:159]
    s_add_u32 s41, s52, 4096
    buffer_load_dwordx4 v[40:43], v2, s[12:15], s41 offen offset:2048 sc1
    v_mfma_f32_16x16x32_bf16 v[160:163], v[120:123], v[20:23], v[160:163]
    ds_read_b128 v[96:99], v15 offset:52224
    v_mfma_f32_16x16x32_bf16 v[164:167], v[124:127], v[20:23], v[164:167]
    ds_read_b128 v[100:103], v15 offset:53248
    v_mfma_f32_16x16x32_bf16 v[168:171], v[128:131], v[20:23], v[168:171]
    ds_read_b128 v[104:107], v15 offset:54272
    s_add_u32 s41, s52, 4096
    buffer_load_dwordx4 v[44:47], v2, s[12:15], s41 offen offset:3072 sc1
    v_mfma_f32_16x16x32_bf16 v[172:175], v[132:135], v[20:23], v[172:175]
    ds_read_b128 v[108:111], v15 offset:55296
    ds_read_b128 v[112:115], v15 offset:56320
    s_waitcnt vmcnt(5)
    s_waitcnt lgkmcnt(5)
    v_mfma_f32_16x16x32_bf16 v[156:159], v[136:139], v[24:27], v[156:159]
    s_add_u32 s41, s52, 8192
    buffer_load_dwordx4 v[48:51], v2, s[12:15], s41 offen offset:0 sc1
    v_mfma_f32_16x16x32_bf16 v[160:163], v[140:143], v[24:27], v[160:163]
    ds_read_b128 v[116:119], v15 offset:57344
    v_mfma_f32_16x16x32_bf16 v[164:167], v[144:147], v[24:27], v[164:167]
    ds_read_b128 v[120:123], v15 offset:58368
    v_mfma_f32_16x16x32_bf16 v[168:171], v[148:151], v[24:27], v[168:171]
    ds_read_b128 v[124:127], v15 offset:59392
    s_add_u32 s41, s52, 8192
    buffer_load_dwordx4 v[52:55], v2, s[12:15], s41 offen offset:1024 sc1
    v_mfma_f32_16x16x32_bf16 v[172:175], v[152:155], v[24:27], v[172:175]
    ds_read_b128 v[128:131], v15 offset:60416
    ds_read_b128 v[132:135], v15 offset:61440
    s_waitcnt vmcnt(6)
    s_waitcnt lgkmcnt(5)
    v_mfma_f32_16x16x32_bf16 v[156:159], v[96:99], v[28:31], v[156:159]
    s_add_u32 s41, s52, 8192
    buffer_load_dwordx4 v[56:59], v2, s[12:15], s41 offen offset:2048 sc1
    v_mfma_f32_16x16x32_bf16 v[160:163], v[100:103], v[28:31], v[160:163]
    ds_read_b128 v[136:139], v15 offset:62464
    v_mfma_f32_16x16x32_bf16 v[164:167], v[104:107], v[28:31], v[164:167]
    ds_read_b128 v[140:143], v15 offset:63488
    v_mfma_f32_16x16x32_bf16 v[168:171], v[108:111], v[28:31], v[168:171]
    ds_read_b128 v[144:147], v15 offset:64512
    s_add_u32 s41, s52, 8192
    buffer_load_dwordx4 v[60:63], v2, s[12:15], s41 offen offset:3072 sc1
    v_mfma_f32_16x16x32_bf16 v[172:175], v[112:115], v[28:31], v[172:175]
    ds_read_b128 v[148:151], v11 offset:0
    ds_read_b128 v[152:155], v11 offset:1024
    s_waitcnt vmcnt(7)
    s_waitcnt lgkmcnt(5)
    v_mfma_f32_16x16x32_bf16 v[156:159], v[116:119], v[32:35], v[156:159]
    s_add_u32 s41, s52, 12288
    buffer_load_dwordx4 v[64:67], v2, s[12:15], s41 offen offset:0 sc1
    v_mfma_f32_16x16x32_bf16 v[160:163], v[120:123], v[32:35], v[160:163]
    ds_read_b128 v[96:99], v11 offset:2048
    v_mfma_f32_16x16x32_bf16 v[164:167], v[124:127], v[32:35], v[164:167]
    ds_read_b128 v[100:103], v11 offset:3072
    v_mfma_f32_16x16x32_bf16 v[168:171], v[128:131], v[32:35], v[168:171]
    ds_read_b128 v[104:107], v11 offset:4096
    s_add_u32 s41, s52, 12288
    buffer_load_dwordx4 v[68:71], v2, s[12:15], s41 offen offset:1024 sc1
    v_mfma_f32_16x16x32_bf16 v[172:175], v[132:135], v[32:35], v[172:175]
    ds_read_b128 v[108:111], v11 offset:5120
    ds_read_b128 v[112:115], v11 offset:6144
    s_waitcnt vmcnt(8)
    s_waitcnt lgkmcnt(5)
    v_mfma_f32_16x16x32_bf16 v[156:159], v[136:139], v[36:39], v[156:159]
    s_add_u32 s41, s52, 12288
    buffer_load_dwordx4 v[72:75], v2, s[12:15], s41 offen offset:2048 sc1
    v_mfma_f32_16x16x32_bf16 v[160:163], v[140:143], v[36:39], v[160:163]
    ds_read_b128 v[116:119], v11 offset:7168
    v_mfma_f32_16x16x32_bf16 v[164:167], v[144:147], v[36:39], v[164:167]
    ds_read_b128 v[120:123], v11 offset:8192
    v_mfma_f32_16x16x32_bf16 v[168:171], v[148:151], v[36:39], v[168:171]
    ds_read_b128 v[124:127], v11 offset:9216
    s_add_u32 s41, s52, 12288
    buffer_load_dwordx4 v[76:79], v2, s[12:15], s41 offen offset:3072 sc1
    v_mfma_f32_16x16x32_bf16 v[172:175], v[152:155], v[36:39], v[172:175]
    ds_read_b128 v[128:131], v11 offset:10240
    ds_read_b128 v[132:135], v11 offset:11264
    s_waitcnt vmcnt(9)
    s_waitcnt lgkmcnt(5)
    v_mfma_f32_16x16x32_bf16 v[156:159], v[96:99], v[40:43], v[156:159]
    s_add_u32 s41, s52, 16384
    buffer_load_dwordx4 v[80:83], v2, s[12:15], s41 offen offset:0 sc1
    v_mfma_f32_16x16x32_bf16 v[160:163], v[100:103], v[40:43], v[160:163]
    ds_read_b128 v[136:139], v11 offset:12288
    v_mfma_f32_16x16x32_bf16 v[164:167], v[104:107], v[40:43], v[164:167]
    ds_read_b128 v[140:143], v11 offset:13312
    v_mfma_f32_16x16x32_bf16 v[168:171], v[108:111], v[40:43], v[168:171]
    ds_read_b128 v[144:147], v11 offset:14336
    s_add_u32 s41, s52, 16384
    buffer_load_dwordx4 v[84:87], v2, s[12:15], s41 offen offset:1024 sc1
    v_mfma_f32_16x16x32_bf16 v[172:175], v[112:115], v[40:43], v[172:175]
    ds_read_b128 v[148:151], v11 offset:15360
    ds_read_b128 v[152:155], v11 offset:16384
    s_waitcnt vmcnt(10)
    s_waitcnt lgkmcnt(5)
    v_mfma_f32_16x16x32_bf16 v[156:159], v[116:119], v[44:47], v[156:159]
    s_add_u32 s41, s52, 16384
    buffer_load_dwordx4 v[88:91], v2, s[12:15], s41 offen offset:2048 sc1
    v_mfma_f32_16x16x32_bf16 v[160:163], v[120:123], v[44:47], v[160:163]
    ds_read_b128 v[96:99], v11 offset:17408
    v_mfma_f32_16x16x32_bf16 v[164:167], v[124:127], v[44:47], v[164:167]
    ds_read_b128 v[100:103], v11 offset:18432
    v_mfma_f32_16x16x32_bf16 v[168:171], v[128:131], v[44:47], v[168:171]
    ds_read_b128 v[104:107], v11 offset:19456
    s_add_u32 s41, s52, 16384
    buffer_load_dwordx4 v[92:95], v2, s[12:15], s41 offen offset:3072 sc1
    v_mfma_f32_16x16x32_bf16 v[172:175], v[132:135], v[44:47], v[172:175]
    ds_read_b128 v[108:111], v11 offset:20480
    ds_read_b128 v[112:115], v11 offset:21504
    s_waitcnt vmcnt(11)
    s_waitcnt lgkmcnt(5)
    v_mfma_f32_16x16x32_bf16 v[156:159], v[136:139], v[48:51], v[156:159]
    v_mfma_f32_16x16x32_bf16 v[160:163], v[140:143], v[48:51], v[160:163]
    ds_read_b128 v[116:119], v11 offset:22528
    buffer_load_dwordx4 v[176:179], v254, s[12:15], s48 offen sc1
    buffer_load_dwordx4 v[180:183], v254, s[12:15], s48 offen offset:1024 sc1
    buffer_load_dwordx2 v[184:185], v8, s[12:15], s48 offen offset:2048 sc1
    v_mfma_f32_16x16x32_bf16 v[164:167], v[144:147], v[48:51], v[164:167]
    ds_read_b128 v[120:123], v11 offset:23552
    v_mfma_f32_16x16x32_bf16 v[168:171], v[148:151], v[48:51], v[168:171]
    ds_read_b128 v[124:127], v14 offset:0
    v_mfma_f32_16x16x32_bf16 v[172:175], v[152:155], v[48:51], v[172:175]
    ds_read_b128 v[128:131], v14 offset:1024
    ds_read_b128 v[132:135], v14 offset:2048
    s_waitcnt vmcnt(13)
    s_waitcnt lgkmcnt(5)
    s_barrier
    v_mfma_f32_16x16x32_bf16 v[156:159], v[96:99], v[52:55], v[156:159]
    v_mfma_f32_16x16x32_bf16 v[160:163], v[100:103], v[52:55], v[160:163]
    ds_read_b128 v[136:139], v14 offset:3072
    v_mfma_f32_16x16x32_bf16 v[164:167], v[104:107], v[52:55], v[164:167]
    ds_read_b128 v[140:143], v14 offset:4096
    v_mfma_f32_16x16x32_bf16 v[168:171], v[108:111], v[52:55], v[168:171]
    ds_read_b128 v[144:147], v14 offset:5120
    v_mfma_f32_16x16x32_bf16 v[172:175], v[112:115], v[52:55], v[172:175]
    ds_read_b128 v[148:151], v14 offset:6144
    ds_read_b128 v[152:155], v14 offset:7168
    s_waitcnt vmcnt(12)
    s_waitcnt lgkmcnt(5)
    v_mfma_f32_16x16x32_bf16 v[156:159], v[116:119], v[56:59], v[156:159]
    v_mfma_f32_16x16x32_bf16 v[160:163], v[120:123], v[56:59], v[160:163]
    ds_read_b128 v[96:99], v14 offset:8192
    s_mul_i32 s38, s30, 12288
    s_add_u32 s39, s38, s45
    s_add_u32 s39, s39, 53248
    s_add_u32 s38, s38, 102400
    s_mov_b32 m0, s38
    s_nop 0
    buffer_load_dwordx4 v2, s[12:15], s39 offen offset:0 lds
    v_mfma_f32_16x16x32_bf16 v[164:167], v[124:127], v[56:59], v[164:167]
    ds_read_b128 v[100:103], v14 offset:9216
    v_mfma_f32_16x16x32_bf16 v[168:171], v[128:131], v[56:59], v[168:171]
    ds_read_b128 v[104:107], v14 offset:10240
    v_mfma_f32_16x16x32_bf16 v[172:175], v[132:135], v[56:59], v[172:175]
    ds_read_b128 v[108:111], v14 offset:11264
    ds_read_b128 v[112:115], v14 offset:12288
    s_mov_b32 m0, s38
    s_nop 0
    buffer_load_dwordx4 v2, s[12:15], s39 offen offset:1024 lds
    s_waitcnt vmcnt(13)
    s_waitcnt lgkmcnt(5)
    v_mfma_f32_16x16x32_bf16 v[156:159], v[136:139], v[60:63], v[156:159]
    v_mfma_f32_16x16x32_bf16 v[160:163], v[140:143], v[60:63], v[160:163]
    ds_read_b128 v[116:119], v14 offset:13312
    s_mov_b32 m0, s38
    s_nop 0
    buffer_load_dwordx4 v2, s[12:15], s39 offen offset:2048 lds
    v_mfma_f32_16x16x32_bf16 v[164:167], v[144:147], v[60:63], v[164:167]
    ds_read_b128 v[120:123], v14 offset:14336
    v_mfma_f32_16x16x32_bf16 v[168:171], v[148:151], v[60:63], v[168:171]
    ds_read_b128 v[124:127], v14 offset:15360
    v_mfma_f32_16x16x32_bf16 v[172:175], v[152:155], v[60:63], v[172:175]
    ds_read_b128 v[128:131], v14 offset:16384
    ds_read_b128 v[132:135], v14 offset:17408
    s_mov_b32 m0, s38
    s_nop 0
    buffer_load_dwordx4 v2, s[12:15], s39 offen offset:3072 lds
    s_add_u32 s38, s38, 4096
    s_add_u32 s39, s39, 4096
    s_waitcnt vmcnt(14)
    s_waitcnt lgkmcnt(5)
    v_mfma_f32_16x16x32_bf16 v[156:159], v[96:99], v[64:67], v[156:159]
    v_mfma_f32_16x16x32_bf16 v[160:163], v[100:103], v[64:67], v[160:163]
    ds_read_b128 v[136:139], v14 offset:18432
    s_mov_b32 m0, s38
    s_nop 0
    buffer_load_dwordx4 v2, s[12:15], s39 offen offset:0 lds
    v_mfma_f32_16x16x32_bf16 v[164:167], v[104:107], v[64:67], v[164:167]
    ds_read_b128 v[140:143], v14 offset:19456
    v_mfma_f32_16x16x32_bf16 v[168:171], v[108:111], v[64:67], v[168:171]
    ds_read_b128 v[144:147], v14 offset:20480
    v_mfma_f32_16x16x32_bf16 v[172:175], v[112:115], v[64:67], v[172:175]
    ds_read_b128 v[148:151], v14 offset:21504
    ds_read_b128 v[152:155], v14 offset:22528
    s_mov_b32 m0, s38
    s_nop 0
    buffer_load_dwordx4 v2, s[12:15], s39 offen offset:1024 lds
    s_waitcnt vmcnt(15)
    s_waitcnt lgkmcnt(5)
    v_mfma_f32_16x16x32_bf16 v[156:159], v[116:119], v[68:71], v[156:159]
    v_mfma_f32_16x16x32_bf16 v[160:163], v[120:123], v[68:71], v[160:163]
    ds_read_b128 v[96:99], v14 offset:23552
    s_mov_b32 m0, s38
    s_nop 0
    buffer_load_dwordx4 v2, s[12:15], s39 offen offset:2048 lds
    v_mfma_f32_16x16x32_bf16 v[164:167], v[124:127], v[68:71], v[164:167]
    ds_read_b128 v[100:103], v14 offset:24576
    v_mfma_f32_16x16x32_bf16 v[168:171], v[128:131], v[68:71], v[168:171]
    ds_read_b128 v[104:107], v14 offset:25600
    v_mfma_f32_16x16x32_bf16 v[172:175], v[132:135], v[68:71], v[172:175]
    ds_read_b128 v[108:111], v14 offset:26624
    ds_read_b128 v[112:115], v14 offset:27648
    s_mov_b32 m0, s38
    s_nop 0
    buffer_load_dwordx4 v2, s[12:15], s39 offen offset:3072 lds
    s_add_u32 s38, s38, 4096
    s_add_u32 s39, s39, 4096
    s_waitcnt vmcnt(16)
    s_waitcnt lgkmcnt(5)
    v_mfma_f32_16x16x32_bf16 v[156:159], v[136:139], v[72:75], v[156:159]
    v_mfma_f32_16x16x32_bf16 v[160:163], v[140:143], v[72:75], v[160:163]
    ds_read_b128 v[116:119], v14 offset:28672
    s_mov_b32 m0, s38
    s_nop 0
    buffer_load_dwordx4 v2, s[12:15], s39 offen offset:0 lds
    v_mfma_f32_16x16x32_bf16 v[164:167], v[144:147], v[72:75], v[164:167]
    ds_read_b128 v[120:123], v14 offset:29696
    v_mfma_f32_16x16x32_bf16 v[168:171], v[148:151], v[72:75], v[168:171]
    ds_read_b128 v[124:127], v14 offset:30720
    v_mfma_f32_16x16x32_bf16 v[172:175], v[152:155], v[72:75], v[172:175]
    ds_read_b128 v[128:131], v14 offset:31744
    ds_read_b128 v[132:135], v14 offset:32768
    s_mov_b32 m0, s38
    s_nop 0
    buffer_load_dwordx4 v2, s[12:15], s39 offen offset:1024 lds
    s_waitcnt vmcnt(17)
    s_waitcnt lgkmcnt(5)
    v_mfma_f32_16x16x32_bf16 v[156:159], v[96:99], v[76:79], v[156:159]
    v_mfma_f32_16x16x32_bf16 v[160:163], v[100:103], v[76:79], v[160:163]
    ds_read_b128 v[136:139], v14 offset:33792
    s_mov_b32 m0, s38
    s_nop 0
    buffer_load_dwordx4 v2, s[12:15], s39 offen offset:2048 lds
    v_mfma_f32_16x16x32_bf16 v[164:167], v[104:107], v[76:79], v[164:167]
    ds_read_b128 v[140:143], v14 offset:34816
    v_mfma_f32_16x16x32_bf16 v[168:171], v[108:111], v[76:79], v[168:171]
    ds_read_b128 v[144:147], v14 offset:35840
    v_mfma_f32_16x16x32_bf16 v[172:175], v[112:115], v[76:79], v[172:175]
    ds_read_b128 v[148:151], v14 offset:36864
    ds_read_b128 v[152:155], v14 offset:37888
    s_mov_b32 m0, s38
    s_nop 0
    buffer_load_dwordx4 v2, s[12:15], s39 offen offset:3072 lds
    s_waitcnt vmcnt(18)
    s_waitcnt lgkmcnt(5)
    v_mfma_f32_16x16x32_bf16 v[156:159], v[116:119], v[80:83], v[156:159]
    v_mfma_f32_16x16x32_bf16 v[160:163], v[120:123], v[80:83], v[160:163]
    ds_read_b128 v[96:99], v14 offset:38912
    v_mfma_f32_16x16x32_bf16 v[164:167], v[124:127], v[80:83], v[164:167]
    ds_read_b128 v[100:103], v14 offset:39936
    v_mfma_f32_16x16x32_bf16 v[168:171], v[128:131], v[80:83], v[168:171]
    ds_read_b128 v[104:107], v14 offset:40960
    v_mfma_f32_16x16x32_bf16 v[172:175], v[132:135], v[80:83], v[172:175]
    ds_read_b128 v[108:111], v14 offset:41984
    ds_read_b128 v[112:115], v14 offset:43008
    s_waitcnt vmcnt(17)
    s_waitcnt lgkmcnt(5)
    v_mfma_f32_16x16x32_bf16 v[156:159], v[136:139], v[84:87], v[156:159]
    v_mfma_f32_16x16x32_bf16 v[160:163], v[140:143], v[84:87], v[160:163]
    ds_read_b128 v[116:119], v14 offset:44032
    v_mfma_f32_16x16x32_bf16 v[164:167], v[144:147], v[84:87], v[164:167]
    ds_read_b128 v[120:123], v14 offset:45056
    v_mfma_f32_16x16x32_bf16 v[168:171], v[148:151], v[84:87], v[168:171]
    ds_read_b128 v[124:127], v14 offset:46080
    v_mfma_f32_16x16x32_bf16 v[172:175], v[152:155], v[84:87], v[172:175]
    ds_read_b128 v[128:131], v14 offset:47104
    ds_read_b128 v[132:135], v14 offset:48128
    s_waitcnt vmcnt(16)
    s_waitcnt lgkmcnt(5)
    v_mfma_f32_16x16x32_bf16 v[156:159], v[96:99], v[88:91], v[156:159]
    v_mfma_f32_16x16x32_bf16 v[160:163], v[100:103], v[88:91], v[160:163]
    v_mfma_f32_16x16x32_bf16 v[164:167], v[104:107], v[88:91], v[164:167]
    v_mfma_f32_16x16x32_bf16 v[168:171], v[108:111], v[88:91], v[168:171]
    v_mfma_f32_16x16x32_bf16 v[172:175], v[112:115], v[88:91], v[172:175]
    s_waitcnt vmcnt(15)
    s_waitcnt lgkmcnt(0)
    v_mfma_f32_16x16x32_bf16 v[156:159], v[116:119], v[92:95], v[156:159]
    v_mfma_f32_16x16x32_bf16 v[160:163], v[120:123], v[92:95], v[160:163]
    v_mfma_f32_16x16x32_bf16 v[164:167], v[124:127], v[92:95], v[164:167]
    v_mfma_f32_16x16x32_bf16 v[168:171], v[128:131], v[92:95], v[168:171]
    v_mfma_f32_16x16x32_bf16 v[172:175], v[132:135], v[92:95], v[172:175]
    s_barrier
    s_mul_i32 s38, s30, 1024
    s_add_u32 s39, s38, s45
    s_add_u32 s39, s39, 102400
    s_add_u32 s38, s38, 151552
    s_mov_b32 m0, s38
    s_nop 0
    buffer_load_dwordx4 v2, s[12:15], s39 offen offset:0 lds
    s_mul_i32 s38, s30, 9216
    s_add_u32 s39, s38, s45
    s_add_u32 s39, s39, 106496
    s_add_u32 s38, s38, 0
    s_mov_b32 m0, s38
    s_nop 0
    buffer_load_dwordx4 v2, s[12:15], s39 offen offset:0 lds
    s_mov_b32 m0, s38
    s_nop 0
    buffer_load_dwordx4 v2, s[12:15], s39 offen offset:1024 lds
    s_mov_b32 m0, s38
    s_nop 0
    buffer_load_dwordx4 v2, s[12:15], s39 offen offset:2048 lds
    s_mov_b32 m0, s38
    s_nop 0
    buffer_load_dwordx4 v2, s[12:15], s39 offen offset:3072 lds
    s_add_u32 s38, s38, 4096
    s_add_u32 s39, s39, 4096
    s_mov_b32 m0, s38
    s_nop 0
    buffer_load_dwordx4 v2, s[12:15], s39 offen offset:0 lds
    s_mov_b32 m0, s38
    s_nop 0
    buffer_load_dwordx4 v2, s[12:15], s39 offen offset:1024 lds
    s_mov_b32 m0, s38
    s_nop 0
    buffer_load_dwordx4 v2, s[12:15], s39 offen offset:2048 lds
    s_mov_b32 m0, s38
    s_nop 0
    buffer_load_dwordx4 v2, s[12:15], s39 offen offset:3072 lds
    s_add_u32 s38, s38, 4096
    s_add_u32 s39, s39, 4096
    s_mov_b32 m0, s38
    s_nop 0
    buffer_load_dwordx4 v2, s[12:15], s39 offen offset:0 lds
    v_mov_b32 v196, 0x3f803f80
    v_mov_b32 v198, 0
    v_mov_b32 v199, 0
    s_waitcnt vmcnt(22)
    s_nop 1
    v_permlane16_swap_b32 v176, v178
    v_permlane16_swap_b32 v177, v179
    v_permlane16_swap_b32 v180, v182
    v_permlane16_swap_b32 v181, v183
    s_nop 1
    v_lshlrev_b32 v200, 16, v176
    v_and_b32 v201, 0xffff0000, v176
    v_lshlrev_b32 v202, 16, v177
    v_and_b32 v203, 0xffff0000, v177
    v_lshlrev_b32 v204, 16, v178
    v_and_b32 v205, 0xffff0000, v178
    v_lshlrev_b32 v206, 16, v179
    v_and_b32 v207, 0xffff0000, v179
    v_lshlrev_b32 v208, 16, v180
    v_and_b32 v209, 0xffff0000, v180
    v_lshlrev_b32 v210, 16, v181
    v_and_b32 v211, 0xffff0000, v181
    v_lshlrev_b32 v212, 16, v182
    v_and_b32 v213, 0xffff0000, v182
    v_lshlrev_b32 v214, 16, v183
    v_and_b32 v215, 0xffff0000, v183
    v_lshlrev_b32 v216, 16, v184
    v_and_b32 v217, 0xffff0000, v184
    v_lshlrev_b32 v218, 16, v185
    v_and_b32 v219, 0xffff0000, v185
    v_pk_add_f32 v[156:157], v[156:157], v[200:201]
    v_pk_add_f32 v[158:159], v[158:159], v[202:203]
    v_pk_add_f32 v[160:161], v[160:161], v[204:205]
    v_pk_add_f32 v[162:163], v[162:163], v[206:207]
    v_pk_add_f32 v[164:165], v[164:165], v[208:209]
    v_pk_add_f32 v[166:167], v[166:167], v[210:211]
    v_pk_add_f32 v[168:169], v[168:169], v[212:213]
    v_pk_add_f32 v[170:171], v[170:171], v[214:215]
    v_pk_add_f32 v[172:173], v[172:173], v[216:217]
    v_pk_add_f32 v[174:175], v[174:175], v[218:219]
    v_cvt_pk_bf16_f32 v156, v156, v157
    v_cvt_pk_bf16_f32 v157, v158, v159
    v_cvt_pk_bf16_f32 v158, v160, v161
    v_cvt_pk_bf16_f32 v159, v162, v163
    v_cvt_pk_bf16_f32 v164, v164, v165
    v_cvt_pk_bf16_f32 v165, v166, v167
    v_cvt_pk_bf16_f32 v166, v168, v169
    v_cvt_pk_bf16_f32 v167, v170, v171
    v_cvt_pk_bf16_f32 v172, v172, v173
    v_cvt_pk_bf16_f32 v173, v174, v175
    v_dot2_f32_bf16 v198, v156, v196, v198
    v_dot2_f32_bf16 v199, v156, v156, v199
    v_dot2_f32_bf16 v198, v157, v196, v198
    v_dot2_f32_bf16 v199, v157, v157, v199
    v_dot2_f32_bf16 v198, v158, v196, v198
    v_dot2_f32_bf16 v199, v158, v158, v199
    v_dot2_f32_bf16 v198, v159, v196, v198
    v_dot2_f32_bf16 v199, v159, v159, v199
    v_dot2_f32_bf16 v198, v164, v196, v198
    v_dot2_f32_bf16 v199, v164, v164, v199
    v_dot2_f32_bf16 v198, v165, v196, v198
    v_dot2_f32_bf16 v199, v165, v165, v199
    v_dot2_f32_bf16 v198, v166, v196, v198
    v_dot2_f32_bf16 v199, v166, v166, v199
    v_dot2_f32_bf16 v198, v167, v196, v198
    v_dot2_f32_bf16 v199, v167, v167, v199
    v_dot2_f32_bf16 v198, v172, v196, v198
    v_dot2_f32_bf16 v199, v172, v172, v199
    v_dot2_f32_bf16 v198, v173, v196, v198
    v_dot2_f32_bf16 v199, v173, v173, v199
    s_nop 1
    s_nop 1
    v_permlane16_swap_b32 v156, v158
    v_permlane16_swap_b32 v157, v159
    v_permlane16_swap_b32 v164, v166
    v_permlane16_swap_b32 v165, v167
    s_nop 2
    v_mov_b32 v188, v198
    v_mov_b32 v189, v199
    s_nop 1
    v_permlane32_swap_b32 v188, v198
    v_permlane32_swap_b32 v189, v199
    s_nop 0
    v_add_f32 v198, v198, v188
    v_add_f32 v199, v199, v189
    v_mov_b32 v188, v198
    v_mov_b32 v189, v199
    s_nop 1
    v_permlane16_swap_b32 v188, v198
    v_permlane16_swap_b32 v189, v199
    s_nop 0
    v_add_f32 v198, v198, v188
    v_add_f32 v199, v199, v189
    s_add_u32 s47, s54, 20480
    v_lshlrev_b32 v9, 6, v4
    s_lshl_b32 s41, s33, 3
    s_add_u32 s46, s46, s41
    s_lshl_b32 s41, s33, 2
    s_add_u32 s49, s55, s41
    v_mov_b32 v11, v9
    s_cmp_eq_u32 s31, 0
    s_cbranch_scc1 k2_kernel_slow26
    buffer_store_dwordx4 v[156:159], v254, s[12:15], s47 offen offset:0
    buffer_store_dwordx4 v[164:167], v254, s[12:15], s47 offen offset:1024
    buffer_store_dwordx2 v[172:173], v8, s[12:15], s47 offen offset:2048
    s_mov_b64 exec, 0xffff
    buffer_store_dwordx2 v[198:199], v11, s[12:15], s46 offen
    s_mov_b64 exec, -1
    s_waitcnt vmcnt(0)
    v_mov_b32 v9, 1
    v_mov_b32 v10, 4352
    s_mov_b64 exec, 1
    buffer_store_dword v9, v10, s[12:15], s49 offen
    s_mov_b64 exec, -1
    s_branch k2_kernel_sent27
k2_kernel_slow26:
    buffer_store_dwordx4 v[156:159], v254, s[12:15], s47 offen offset:0 sc1
    buffer_store_dwordx4 v[164:167], v254, s[12:15], s47 offen offset:1024 sc1
    buffer_store_dwordx2 v[172:173], v8, s[12:15], s47 offen offset:2048 sc1
    s_mov_b64 exec, 0xffff
    buffer_store_dwordx2 v[198:199], v11, s[12:15], s46 offen sc1
    s_mov_b64 exec, -1
    s_waitcnt vmcnt(0)
    v_mov_b32 v9, 1
    v_mov_b32 v10, 4352
    s_mov_b64 exec, 1
    buffer_store_dword v9, v10, s[12:15], s49 offen sc1
    s_mov_b64 exec, -1
k2_kernel_sent27:
    s_lshl_b32 s46, s34, 3
    s_lshl_b32 s47, s30, 1
    s_add_u32 s46, s46, s47
    s_lshl_b32 s49, s46, 7
    s_add_u32 s49, s49, 4352
    v_bfe_u32 v7, v1, 3, 1
    v_lshlrev_b32 v7, 7, v7
    v_and_b32 v9, 7, v1
    v_lshl_add_u32 v7, v9, 2, v7
    v_add_u32 v7, s49, v7
    s_sub_u32 s49, s55, s37
    s_add_u32 s49, s49, 128
    v_and_b32 v9, 3, v1
    v_lshlrev_b32 v9, 2, v9
    v_add_u32 v9, s49, v9
    v_and_b32 v10, 16, v1
    v_cmp_ne_u32 vcc, 0, v10
    v_mov_b32 v11, 1
    v_mov_b32 v10, 3
    v_cndmask_b32 v7, v7, v9, vcc
    v_cndmask_b32 v10, v11, v10, vcc
    s_mov_b32 s43, 200000
k2_kernel_poll28:
    buffer_load_dword v9, v7, s[12:15], s37 offen sc1
    s_waitcnt vmcnt(0)
    v_cmp_le_u32 vcc, v10, v9
    s_sub_u32 s43, s43, 1
    s_cmp_eq_u64 vcc, -1
    s_cbranch_scc1 k2_kernel_go29
    s_cmp_lg_u32 s43, 0
    s_cbranch_scc1 k2_kernel_poll28
k2_kernel_go29:
    s_mul_i32 s47, s46, 20480
    s_add_u32 s47, s47, s36
    s_add_u32 s47, s47, 20480
    s_add_u32 s48, s47, 20480
    s_add_u32 s41, s47, 0
    buffer_load_dwordx4 v[72:75], v2, s[12:15], s41 offen offset:0 sc1
    s_add_u32 s41, s48, 0
    buffer_load_dwordx4 v[76:79], v2, s[12:15], s41 offen offset:0 sc1
    s_add_u32 s41, s47, 0
    buffer_load_dwordx4 v[80:83], v2, s[12:15], s41 offen offset:1024 sc1
    s_add_u32 s41, s48, 0
    buffer_load_dwordx4 v[84:87], v2, s[12:15], s41 offen offset:1024 sc1
    s_add_u32 s41, s47, 0
    buffer_load_dwordx4 v[88:91], v2, s[12:15], s41 offen offset:2048 sc1
    s_add_u32 s41, s48, 0
    buffer_load_dwordx4 v[92:95], v2, s[12:15], s41 offen offset:2048 sc1
    v_lshlrev_b32 v9, 6, v4
    v_lshl_add_u32 v9, v3, 4, v9
    s_lshl_b32 s41, s46, 10
    s_add_u32 s41, s41, s36
    s_add_u32 s41, s41, 1581056
    buffer_load_dwordx4 v[216:219], v9, s[12:15], s41 offen offset:0 sc1
    buffer_load_dwordx4 v[220:223], v9, s[12:15], s41 offen offset:1024 sc1
    s_mul_i32 s52, s46, 55296
    s_mul_i32 s41, s35, 3584
    s_add_u32 s52, s52, s41
    s_add_u32 s52, s52, s36
    s_add_u32 s52, s52, 696320
    s_add_u32 s53, s52, 55296
    s_barrier
    v_add_u32 v11, 0x20000, v2
    ds_read_b128 v[160:163], v14 offset:49152
    ds_read_b128 v[164:167], v14 offset:50176
    ds_read_b128 v[168:171], v14 offset:51200
    ds_read_b128 v[172:175], v14 offset:52224
    ds_read_b128 v[176:179], v14 offset:53248
    ds_read_b128 v[180:183], v14 offset:54272
    ds_read_b128 v[184:187], v14 offset:55296
    s_waitcnt vmcnt(6)
    s_waitcnt lgkmcnt(6)
    v_mfma_f32_16x16x32_bf16 v[16:19], v[160:163], v[72:75], 0
    v_mfma_f32_16x16x32_bf16 v[44:47], v[160:163], v[76:79], 0
    ds_read_b128 v[188:191], v14 offset:56320
    s_waitcnt lgkmcnt(6)
    v_mfma_f32_16x16x32_bf16 v[20:23], v[164:167], v[72:75], 0
    v_mfma_f32_16x16x32_bf16 v[48:51], v[164:167], v[76:79], 0
    ds_read_b128 v[192:195], v14 offset:57344
    s_add_u32 s41, s47, 0
    buffer_load_dwordx4 v[96:99], v2, s[12:15], s41 offen offset:3072 sc1
    s_add_u32 s41, s48, 0
    buffer_load_dwordx4 v[100:103], v2, s[12:15], s41 offen offset:3072 sc1
    s_waitcnt lgkmcnt(6)
    v_mfma_f32_16x16x32_bf16 v[24:27], v[168:171], v[72:75], 0
    v_mfma_f32_16x16x32_bf16 v[52:55], v[168:171], v[76:79], 0
    ds_read_b128 v[196:199], v14 offset:58368
    s_waitcnt lgkmcnt(6)
    v_mfma_f32_16x16x32_bf16 v[28:31], v[172:175], v[72:75], 0
    v_mfma_f32_16x16x32_bf16 v[56:59], v[172:175], v[76:79], 0
    ds_read_b128 v[200:203], v14 offset:59392
    s_waitcnt lgkmcnt(6)
    v_mfma_f32_16x16x32_bf16 v[32:35], v[176:179], v[72:75], 0
    v_mfma_f32_16x16x32_bf16 v[60:63], v[176:179], v[76:79], 0
    ds_read_b128 v[204:207], v14 offset:60416
    s_add_u32 s41, s47, 4096
    buffer_load_dwordx4 v[104:107], v2, s[12:15], s41 offen offset:0 sc1
    s_add_u32 s41, s48, 4096
    buffer_load_dwordx4 v[108:111], v2, s[12:15], s41 offen offset:0 sc1
    s_waitcnt lgkmcnt(6)
    v_mfma_f32_16x16x32_bf16 v[36:39], v[180:183], v[72:75], 0
    v_mfma_f32_16x16x32_bf16 v[64:67], v[180:183], v[76:79], 0
    ds_read_b128 v[208:211], v14 offset:61440
    s_waitcnt lgkmcnt(6)
    v_mfma_f32_16x16x32_bf16 v[40:43], v[184:187], v[72:75], 0
    v_mfma_f32_16x16x32_bf16 v[68:71], v[184:187], v[76:79], 0
    ds_read_b128 v[212:215], v14 offset:62464
    s_waitcnt vmcnt(8)
    s_waitcnt lgkmcnt(6)
    v_mfma_f32_16x16x32_bf16 v[16:19], v[188:191], v[80:83], v[16:19]
    v_mfma_f32_16x16x32_bf16 v[44:47], v[188:191], v[84:87], v[44:47]
    ds_read_b128 v[160:163], v14 offset:63488
    s_waitcnt lgkmcnt(6)
    v_mfma_f32_16x16x32_bf16 v[20:23], v[192:195], v[80:83], v[20:23]
    v_mfma_f32_16x16x32_bf16 v[48:51], v[192:195], v[84:87], v[48:51]
    ds_read_b128 v[164:167], v14 offset:64512
    s_add_u32 s41, s47, 4096
    buffer_load_dwordx4 v[112:115], v2, s[12:15], s41 offen offset:1024 sc1
    s_add_u32 s41, s48, 4096
    buffer_load_dwordx4 v[116:119], v2, s[12:15], s41 offen offset:1024 sc1
    s_waitcnt lgkmcnt(6)
    v_mfma_f32_16x16x32_bf16 v[24:27], v[196:199], v[80:83], v[24:27]
    v_mfma_f32_16x16x32_bf16 v[52:55], v[196:199], v[84:87], v[52:55]
    ds_read_b128 v[168:171], v15 offset:0
    buffer_load_dwordx4 a[0:3], v2, s[12:15], s40 offen offset:0
    s_waitcnt lgkmcnt(6)
    v_mfma_f32_16x16x32_bf16 v[28:31], v[200:203], v[80:83], v[28:31]
    v_mfma_f32_16x16x32_bf16 v[56:59], v[200:203], v[84:87], v[56:59]
    ds_read_b128 v[172:175], v15 offset:1024
    buffer_load_dwordx4 a[4:7], v2, s[12:15], s40 offen offset:1024
    s_waitcnt lgkmcnt(6)
    v_mfma_f32_16x16x32_bf16 v[32:35], v[204:207], v[80:83], v[32:35]
    v_mfma_f32_16x16x32_bf16 v[60:63], v[204:207], v[84:87], v[60:63]
    ds_read_b128 v[176:179], v15 offset:2048
    s_add_u32 s41, s47, 4096
    buffer_load_dwordx4 v[120:123], v2, s[12:15], s41 offen offset:2048 sc1
    s_add_u32 s41, s48, 4096
    buffer_load_dwordx4 v[124:127], v2, s[12:15], s41 offen offset:2048 sc1
    s_waitcnt lgkmcnt(6)
    v_mfma_f32_16x16x32_bf16 v[36:39], v[208:211], v[80:83], v[36:39]
    v_mfma_f32_16x16x32_bf16 v[64:67], v[208:211], v[84:87], v[64:67]
    ds_read_b128 v[180:183], v15 offset:3072
    buffer_load_dwordx4 a[8:11], v2, s[12:15], s40 offen offset:2048
    s_waitcnt lgkmcnt(6)
    v_mfma_f32_16x16x32_bf16 v[40:43], v[212:215], v[80:83], v[40:43]
    v_mfma_f32_16x16x32_bf16 v[68:71], v[212:215], v[84:87], v[68:71]
    ds_read_b128 v[184:187], v15 offset:4096
    s_waitcnt vmcnt(13)
    s_waitcnt lgkmcnt(6)
    v_mfma_f32_16x16x32_bf16 v[16:19], v[160:163], v[88:91], v[16:19]
    v_mfma_f32_16x16x32_bf16 v[44:47], v[160:163], v[92:95], v[44:47]
    ds_read_b128 v[188:191], v15 offset:5120
    s_waitcnt lgkmcnt(6)
    v_mfma_f32_16x16x32_bf16 v[20:23], v[164:167], v[88:91], v[20:23]
    v_mfma_f32_16x16x32_bf16 v[48:51], v[164:167], v[92:95], v[48:51]
    ds_read_b128 v[192:195], v15 offset:6144
    s_add_u32 s41, s47, 4096
    buffer_load_dwordx4 v[128:131], v2, s[12:15], s41 offen offset:3072 sc1
    s_add_u32 s41, s48, 4096
    buffer_load_dwordx4 v[132:135], v2, s[12:15], s41 offen offset:3072 sc1
    s_waitcnt lgkmcnt(6)
    v_mfma_f32_16x16x32_bf16 v[24:27], v[168:171], v[88:91], v[24:27]
    v_mfma_f32_16x16x32_bf16 v[52:55], v[168:171], v[92:95], v[52:55]
    ds_read_b128 v[196:199], v15 offset:7168
    buffer_load_dwordx4 a[12:15], v2, s[12:15], s40 offen offset:3072
    s_add_u32 s40, s40, 4096
    s_waitcnt lgkmcnt(6)
    v_mfma_f32_16x16x32_bf16 v[28:31], v[172:175], v[88:91], v[28:31]
    v_mfma_f32_16x16x32_bf16 v[56:59], v[172:175], v[92:95], v[56:59]
    ds_read_b128 v[200:203], v15 offset:8192
    buffer_load_dwordx4 a[16:19], v2, s[12:15], s40 offen offset:0
    s_waitcnt lgkmcnt(6)
    v_mfma_f32_16x16x32_bf16 v[32:35], v[176:179], v[88:91], v[32:35]
    v_mfma_f32_16x16x32_bf16 v[60:63], v[176:179], v[92:95], v[60:63]
    ds_read_b128 v[204:207], v15 offset:9216
    s_add_u32 s41, s47, 8192
    buffer_load_dwordx4 v[136:139], v2, s[12:15], s41 offen offset:0 sc1
    s_add_u32 s41, s48, 8192
    buffer_load_dwordx4 v[140:143], v2, s[12:15], s41 offen offset:0 sc1
    s_waitcnt lgkmcnt(6)
    v_mfma_f32_16x16x32_bf16 v[36:39], v[180:183], v[88:91], v[36:39]
    v_mfma_f32_16x16x32_bf16 v[64:67], v[180:183], v[92:95], v[64:67]
    ds_read_b128 v[208:211], v15 offset:10240
    buffer_load_dwordx4 a[20:23], v2, s[12:15], s40 offen offset:1024
    s_waitcnt lgkmcnt(6)
    v_mfma_f32_16x16x32_bf16 v[40:43], v[184:187], v[88:91], v[40:43]
    v_mfma_f32_16x16x32_bf16 v[68:71], v[184:187], v[92:95], v[68:71]
    ds_read_b128 v[212:215], v15 offset:11264
    s_waitcnt vmcnt(16)
    s_waitcnt lgkmcnt(6)
    v_mfma_f32_16x16x32_bf16 v[16:19], v[188:191], v[96:99], v[16:19]
    v_mfma_f32_16x16x32_bf16 v[44:47], v[188:191], v[100:103], v[44:47]
    ds_read_b128 v[160:163], v15 offset:12288
    s_waitcnt lgkmcnt(6)
    v_mfma_f32_16x16x32_bf16 v[20:23], v[192:195], v[96:99], v[20:23]
    v_mfma_f32_16x16x32_bf16 v[48:51], v[192:195], v[100:103], v[48:51]
    ds_read_b128 v[164:167], v15 offset:13312
    s_add_u32 s41, s47, 8192
    buffer_load_dwordx4 v[144:147], v2, s[12:15], s41 offen offset:1024 sc1
    s_add_u32 s41, s48, 8192
    buffer_load_dwordx4 v[148:151], v2, s[12:15], s41 offen offset:1024 sc1
    s_waitcnt lgkmcnt(6)
    v_mfma_f32_16x16x32_bf16 v[24:27], v[196:199], v[96:99], v[24:27]
    v_mfma_f32_16x16x32_bf16 v[52:55], v[196:199], v[100:103], v[52:55]
    ds_read_b128 v[168:171], v15 offset:14336
    buffer_load_dwordx4 a[24:27], v2, s[12:15], s40 offen offset:2048
    s_waitcnt lgkmcnt(6)
    v_mfma_f32_16x16x32_bf16 v[28:31], v[200:203], v[96:99], v[28:31]
    v_mfma_f32_16x16x32_bf16 v[56:59], v[200:203], v[100:103], v[56:59]
    ds_read_b128 v[172:175], v15 offset:15360
    buffer_load_dwordx4 a[28:31], v2, s[12:15], s40 offen offset:3072
    s_add_u32 s40, s40, 4096
    s_waitcnt lgkmcnt(6)
    v_mfma_f32_16x16x32_bf16 v[32:35], v[204:207], v[96:99], v[32:35]
    v_mfma_f32_16x16x32_bf16 v[60:63], v[204:207], v[100:103], v[60:63]
    ds_read_b128 v[176:179], v15 offset:16384
    s_waitcnt lgkmcnt(6)
    v_mfma_f32_16x16x32_bf16 v[36:39], v[208:211], v[96:99], v[36:39]
    v_mfma_f32_16x16x32_bf16 v[64:67], v[208:211], v[100:103], v[64:67]
    ds_read_b128 v[180:183], v15 offset:17408
    buffer_load_dwordx4 a[32:35], v2, s[12:15], s40 offen offset:0
    s_waitcnt lgkmcnt(6)
    v_mfma_f32_16x16x32_bf16 v[40:43], v[212:215], v[96:99], v[40:43]
    v_mfma_f32_16x16x32_bf16 v[68:71], v[212:215], v[100:103], v[68:71]
    ds_read_b128 v[184:187], v15 offset:18432
    s_waitcnt vmcnt(19)
    s_waitcnt lgkmcnt(6)
    v_mfma_f32_16x16x32_bf16 v[16:19], v[160:163], v[104:107], v[16:19]
    v_mfma_f32_16x16x32_bf16 v[44:47], v[160:163], v[108:111], v[44:47]
    ds_read_b128 v[188:191], v15 offset:19456
    s_waitcnt lgkmcnt(6)
    v_mfma_f32_16x16x32_bf16 v[20:23], v[164:167], v[104:107], v[20:23]
    v_mfma_f32_16x16x32_bf16 v[48:51], v[164:167], v[108:111], v[48:51]
    ds_read_b128 v[192:195], v15 offset:20480
    s_add_u32 s41, s47, 8192
    buffer_load_dwordx4 v[152:155], v2, s[12:15], s41 offen offset:2048 sc1
    s_add_u32 s41, s48, 8192
    buffer_load_dwordx4 v[156:159], v2, s[12:15], s41 offen offset:2048 sc1
    s_waitcnt lgkmcnt(6)
    v_mfma_f32_16x16x32_bf16 v[24:27], v[168:171], v[104:107], v[24:27]
    v_mfma_f32_16x16x32_bf16 v[52:55], v[168:171], v[108:111], v[52:55]
    ds_read_b128 v[196:199], v15 offset:21504
    buffer_load_dwordx4 a[36:39], v2, s[12:15], s40 offen offset:1024
    s_waitcnt lgkmcnt(6)
    v_mfma_f32_16x16x32_bf16 v[28:31], v[172:175], v[104:107], v[28:31]
    v_mfma_f32_16x16x32_bf16 v[56:59], v[172:175], v[108:111], v[56:59]
    ds_read_b128 v[200:203], v15 offset:22528
    buffer_load_dwordx4 a[40:43], v2, s[12:15], s40 offen offset:2048
    s_waitcnt lgkmcnt(6)
    v_mfma_f32_16x16x32_bf16 v[32:35], v[176:179], v[104:107], v[32:35]
    v_mfma_f32_16x16x32_bf16 v[60:63], v[176:179], v[108:111], v[60:63]
    ds_read_b128 v[204:207], v15 offset:23552
    s_waitcnt lgkmcnt(6)
    v_mfma_f32_16x16x32_bf16 v[36:39], v[180:183], v[104:107], v[36:39]
    v_mfma_f32_16x16x32_bf16 v[64:67], v[180:183], v[108:111], v[64:67]
    ds_read_b128 v[208:211], v15 offset:24576
    buffer_load_dwordx4 a[44:47], v2, s[12:15], s40 offen offset:3072
    s_add_u32 s40, s40, 4096
    s_waitcnt lgkmcnt(6)
    v_mfma_f32_16x16x32_bf16 v[40:43], v[184:187], v[104:107], v[40:43]
    v_mfma_f32_16x16x32_bf16 v[68:71], v[184:187], v[108:111], v[68:71]
    ds_read_b128 v[212:215], v15 offset:25600
    s_waitcnt vmcnt(22)
    s_waitcnt lgkmcnt(6)
    v_mfma_f32_16x16x32_bf16 v[16:19], v[188:191], v[112:115], v[16:19]
    v_mfma_f32_16x16x32_bf16 v[44:47], v[188:191], v[116:119], v[44:47]
    ds_read_b128 v[160:163], v15 offset:26624
    v_add_f32 v224, v216, v218
    v_add_f32 v225, v217, v219
    s_waitcnt lgkmcnt(6)
    v_mfma_f32_16x16x32_bf16 v[20:23], v[192:195], v[112:115], v[20:23]
    v_mfma_f32_16x16x32_bf16 v[48:51], v[192:195], v[116:119], v[48:51]
    ds_read_b128 v[164:167], v15 offset:27648
    s_add_u32 s41, s47, 8192
    buffer_load_dwordx4 v[72:75], v2, s[12:15], s41 offen offset:3072 sc1
    s_add_u32 s41, s48, 8192
    buffer_load_dwordx4 v[76:79], v2, s[12:15], s41 offen offset:3072 sc1
    v_mov_b32 v216, v224
    v_mov_b32 v217, v225
    s_waitcnt lgkmcnt(6)
    v_mfma_f32_16x16x32_bf16 v[24:27], v[196:199], v[112:115], v[24:27]
    v_mfma_f32_16x16x32_bf16 v[52:55], v[196:199], v[116:119], v[52:55]
    ds_read_b128 v[168:171], v15 offset:28672
    buffer_load_dwordx4 a[48:51], v2, s[12:15], s40 offen offset:0
    s_nop 1
    v_permlane32_swap_b32 v216, v224
    s_waitcnt lgkmcnt(6)
    v_mfma_f32_16x16x32_bf16 v[28:31], v[200:203], v[112:115], v[28:31]
    v_mfma_f32_16x16x32_bf16 v[56:59], v[200:203], v[116:119], v[56:59]
    ds_read_b128 v[172:175], v15 offset:29696
    buffer_load_dwordx4 a[52:55], v2, s[12:15], s40 offen offset:1024
    v_permlane32_swap_b32 v217, v225
    s_nop 0
    s_waitcnt lgkmcnt(6)
    v_mfma_f32_16x16x32_bf16 v[32:35], v[204:207], v[112:115], v[32:35]
    v_mfma_f32_16x16x32_bf16 v[60:63], v[204:207], v[116:119], v[60:63]
    ds_read_b128 v[176:179], v15 offset:30720
    v_add_f32 v224, v224, v216
    v_add_f32 v225, v225, v217
    s_waitcnt lgkmcnt(6)
    v_mfma_f32_16x16x32_bf16 v[36:39], v[208:211], v[112:115], v[36:39]
    v_mfma_f32_16x16x32_bf16 v[64:67], v[208:211], v[116:119], v[64:67]
    ds_read_b128 v[180:183], v15 offset:31744
    buffer_load_dwordx4 a[56:59], v2, s[12:15], s40 offen offset:2048
    v_mov_b32 v216, v224
    v_mov_b32 v217, v225
    s_waitcnt lgkmcnt(6)
    v_mfma_f32_16x16x32_bf16 v[40:43], v[212:215], v[112:115], v[40:43]
    v_mfma_f32_16x16x32_bf16 v[68:71], v[212:215], v[116:119], v[68:71]
    ds_read_b128 v[184:187], v15 offset:32768
    s_nop 1
    v_permlane16_swap_b32 v216, v224
    s_waitcnt vmcnt(23)
    s_waitcnt lgkmcnt(6)
    v_mfma_f32_16x16x32_bf16 v[16:19], v[160:163], v[120:123], v[16:19]
    v_mfma_f32_16x16x32_bf16 v[44:47], v[160:163], v[124:127], v[44:47]
    ds_read_b128 v[188:191], v15 offset:33792
    v_permlane16_swap_b32 v217, v225
    s_nop 0
    s_waitcnt lgkmcnt(6)
    v_mfma_f32_16x16x32_bf16 v[20:23], v[164:167], v[120:123], v[20:23]
    v_mfma_f32_16x16x32_bf16 v[48:51], v[164:167], v[124:127], v[48:51]
    ds_read_b128 v[192:195], v15 offset:34816
    s_add_u32 s41, s47, 12288
    buffer_load_dwordx4 v[80:83], v2, s[12:15], s41 offen offset:0 sc1
    s_add_u32 s41, s48, 12288
    buffer_load_dwordx4 v[84:87], v2, s[12:15], s41 offen offset:0 sc1
    v_add_f32 v224, v224, v216
    v_add_f32 v225, v225, v217
    s_waitcnt lgkmcnt(6)
    v_mfma_f32_16x16x32_bf16 v[24:27], v[168:171], v[120:123], v[24:27]
    v_mfma_f32_16x16x32_bf16 v[52:55], v[168:171], v[124:127], v[52:55]
    ds_read_b128 v[196:199], v15 offset:35840
    buffer_load_dwordx4 a[60:63], v2, s[12:15], s40 offen offset:3072
    s_add_u32 s40, s40, 4096
    v_mul_f32 v224, 0x3acccccd, v224
    v_mul_f32 v225, 0x3acccccd, v225
    s_waitcnt lgkmcnt(6)
    v_mfma_f32_16x16x32_bf16 v[28:31], v[172:175], v[120:123], v[28:31]
    v_mfma_f32_16x16x32_bf16 v[56:59], v[172:175], v[124:127], v[56:59]
    ds_read_b128 v[200:203], v15 offset:36864
    buffer_load_dwordx4 a[64:67], v2, s[12:15], s40 offen offset:0
    v_fma_f32 v225, -v224, v224, v225
    v_max_f32 v225, 0, v225
    s_waitcnt lgkmcnt(6)
    v_mfma_f32_16x16x32_bf16 v[32:35], v[176:179], v[120:123], v[32:35]
    v_mfma_f32_16x16x32_bf16 v[60:63], v[176:179], v[124:127], v[60:63]
    ds_read_b128 v[204:207], v15 offset:37888
    v_cvt_pk_bf16_f32 v216, v224, v225
    v_lshlrev_b32 v224, 16, v216
    s_waitcnt lgkmcnt(6)
    v_mfma_f32_16x16x32_bf16 v[36:39], v[180:183], v[120:123], v[36:39]
    v_mfma_f32_16x16x32_bf16 v[64:67], v[180:183], v[124:127], v[64:67]
    ds_read_b128 v[208:211], v15 offset:38912
    buffer_load_dwordx4 a[68:71], v2, s[12:15], s40 offen offset:1024
    v_and_b32 v225, 0xffff0000, v216
    v_add_f32 v225, 0x3727c5ac, v225
    s_waitcnt lgkmcnt(6)
    v_mfma_f32_16x16x32_bf16 v[40:43], v[184:187], v[120:123], v[40:43]
    v_mfma_f32_16x16x32_bf16 v[68:71], v[184:187], v[124:127], v[68:71]
    ds_read_b128 v[212:215], v15 offset:39936
    v_cvt_pk_bf16_f32 v216, v225, v225
    v_lshlrev_b32 v225, 16, v216
    s_waitcnt vmcnt(25)
    s_waitcnt lgkmcnt(6)
    v_mfma_f32_16x16x32_bf16 v[16:19], v[188:191], v[128:131], v[16:19]
    v_mfma_f32_16x16x32_bf16 v[44:47], v[188:191], v[132:135], v[44:47]
    ds_read_b128 v[160:163], v15 offset:40960
    v_sqrt_f32 v225, v225
    s_nop 0
    s_waitcnt lgkmcnt(6)
    v_mfma_f32_16x16x32_bf16 v[20:23], v[192:195], v[128:131], v[20:23]
    v_mfma_f32_16x16x32_bf16 v[48:51], v[192:195], v[132:135], v[48:51]
    ds_read_b128 v[164:167], v15 offset:41984
    s_add_u32 s41, s47, 12288
    buffer_load_dwordx4 v[88:91], v2, s[12:15], s41 offen offset:1024 sc1
    s_add_u32 s41, s48, 12288
    buffer_load_dwordx4 v[92:95], v2, s[12:15], s41 offen offset:1024 sc1
    v_cvt_pk_bf16_f32 v216, v225, v225
    v_lshlrev_b32 v225, 16, v216
    s_waitcnt lgkmcnt(6)
    v_mfma_f32_16x16x32_bf16 v[24:27], v[196:199], v[128:131], v[24:27]
    v_mfma_f32_16x16x32_bf16 v[52:55], v[196:199], v[132:135], v[52:55]
    ds_read_b128 v[168:171], v15 offset:43008
    buffer_load_dwordx4 a[72:75], v2, s[12:15], s40 offen offset:2048
    v_rcp_f32 v225, v225
    s_nop 0
    s_waitcnt lgkmcnt(6)
    v_mfma_f32_16x16x32_bf16 v[28:31], v[200:203], v[128:131], v[28:31]
    v_mfma_f32_16x16x32_bf16 v[56:59], v[200:203], v[132:135], v[56:59]
    ds_read_b128 v[172:175], v15 offset:44032
    buffer_load_dwordx4 a[76:79], v2, s[12:15], s40 offen offset:3072
    s_add_u32 s40, s40, 4096
    v_mul_f32 v224, v224, v225
    v_sub_f32 v224, 0, v224
    s_waitcnt lgkmcnt(6)
    v_mfma_f32_16x16x32_bf16 v[32:35], v[204:207], v[128:131], v[32:35]
    v_mfma_f32_16x16x32_bf16 v[60:63], v[204:207], v[132:135], v[60:63]
    ds_read_b128 v[176:179], v15 offset:45056
    v_add_f32 v226, v220, v222
    v_add_f32 v227, v221, v223
    s_waitcnt lgkmcnt(6)
    v_mfma_f32_16x16x32_bf16 v[36:39], v[208:211], v[128:131], v[36:39]
    v_mfma_f32_16x16x32_bf16 v[64:67], v[208:211], v[132:135], v[64:67]
    ds_read_b128 v[180:183], v15 offset:46080
    buffer_load_dwordx4 a[80:83], v2, s[12:15], s40 offen offset:0
    v_mov_b32 v216, v226
    v_mov_b32 v217, v227
    s_waitcnt lgkmcnt(6)
    v_mfma_f32_16x16x32_bf16 v[40:43], v[212:215], v[128:131], v[40:43]
    v_mfma_f32_16x16x32_bf16 v[68:71], v[212:215], v[132:135], v[68:71]
    ds_read_b128 v[184:187], v15 offset:47104
    s_nop 1
    v_permlane32_swap_b32 v216, v226
    s_waitcnt vmcnt(26)
    s_waitcnt lgkmcnt(6)
    v_mfma_f32_16x16x32_bf16 v[16:19], v[160:163], v[136:139], v[16:19]
    v_mfma_f32_16x16x32_bf16 v[44:47], v[160:163], v[140:143], v[44:47]
    ds_read_b128 v[188:191], v15 offset:48128
    v_permlane32_swap_b32 v217, v227
    s_nop 0
    s_waitcnt lgkmcnt(6)
    v_mfma_f32_16x16x32_bf16 v[20:23], v[164:167], v[136:139], v[20:23]
    v_mfma_f32_16x16x32_bf16 v[48:51], v[164:167], v[140:143], v[48:51]
    ds_read_b128 v[192:195], v15 offset:49152
    s_add_u32 s41, s47, 12288
    buffer_load_dwordx4 v[96:99], v2, s[12:15], s41 offen offset:2048 sc1
    s_add_u32 s41, s48, 12288
    buffer_load_dwordx4 v[100:103], v2, s[12:15], s41 offen offset:2048 sc1
    v_add_f32 v226, v226, v216
    v_add_f32 v227, v227, v217
    s_waitcnt lgkmcnt(6)
    v_mfma_f32_16x16x32_bf16 v[24:27], v[168:171], v[136:139], v[24:27]
    v_mfma_f32_16x16x32_bf16 v[52:55], v[168:171], v[140:143], v[52:55]
    ds_read_b128 v[196:199], v15 offset:50176
    buffer_load_dwordx4 a[84:87], v2, s[12:15], s40 offen offset:1024
    v_mov_b32 v216, v226
    v_mov_b32 v217, v227
    s_waitcnt lgkmcnt(6)
    v_mfma_f32_16x16x32_bf16 v[28:31], v[172:175], v[136:139], v[28:31]
    v_mfma_f32_16x16x32_bf16 v[56:59], v[172:175], v[140:143], v[56:59]
    ds_read_b128 v[200:203], v15 offset:51200
    buffer_load_dwordx4 a[88:91], v2, s[12:15], s40 offen offset:2048
    s_nop 1
    v_permlane16_swap_b32 v216, v226
    s_waitcnt lgkmcnt(6)
    v_mfma_f32_16x16x32_bf16 v[32:35], v[176:179], v[136:139], v[32:35]
    v_mfma_f32_16x16x32_bf16 v[60:63], v[176:179], v[140:143], v[60:63]
    ds_read_b128 v[204:207], v15 offset:52224
    v_permlane16_swap_b32 v217, v227
    s_nop 0
    s_waitcnt lgkmcnt(6)
    v_mfma_f32_16x16x32_bf16 v[36:39], v[180:183], v[136:139], v[36:39]
    v_mfma_f32_16x16x32_bf16 v[64:67], v[180:183], v[140:143], v[64:67]
    ds_read_b128 v[208:211], v15 offset:53248
    buffer_load_dwordx4 a[92:95], v2, s[12:15], s40 offen offset:3072
    s_add_u32 s40, s40, 4096
    v_add_f32 v226, v226, v216
    v_add_f32 v227, v227, v217
    s_waitcnt lgkmcnt(6)
    v_mfma_f32_16x16x32_bf16 v[40:43], v[184:187], v[136:139], v[40:43]
    v_mfma_f32_16x16x32_bf16 v[68:71], v[184:187], v[140:143], v[68:71]
    ds_read_b128 v[212:215], v15 offset:54272
    v_mul_f32 v226, 0x3acccccd, v226
    v_mul_f32 v227, 0x3acccccd, v227
    s_waitcnt vmcnt(28)
    s_waitcnt lgkmcnt(6)
    v_mfma_f32_16x16x32_bf16 v[16:19], v[188:191], v[144:147], v[16:19]
    v_mfma_f32_16x16x32_bf16 v[44:47], v[188:191], v[148:151], v[44:47]
    ds_read_b128 v[160:163], v15 offset:55296
    v_fma_f32 v227, -v226, v226, v227
    v_max_f32 v227, 0, v227
    s_waitcnt lgkmcnt(6)
    v_mfma_f32_16x16x32_bf16 v[20:23], v[192:195], v[144:147], v[20:23]
    v_mfma_f32_16x16x32_bf16 v[48:51], v[192:195], v[148:151], v[48:51]
    ds_read_b128 v[164:167], v15 offset:56320
    s_add_u32 s41, s47, 12288
    buffer_load_dwordx4 v[104:107], v2, s[12:15], s41 offen offset:3072 sc1
    s_add_u32 s41, s48, 12288
    buffer_load_dwordx4 v[108:111], v2, s[12:15], s41 offen offset:3072 sc1
    v_cvt_pk_bf16_f32 v216, v226, v227
    v_lshlrev_b32 v226, 16, v216
    s_waitcnt lgkmcnt(6)
    v_mfma_f32_16x16x32_bf16 v[24:27], v[196:199], v[144:147], v[24:27]
    v_mfma_f32_16x16x32_bf16 v[52:55], v[196:199], v[148:151], v[52:55]
    ds_read_b128 v[168:171], v15 offset:57344
    buffer_load_dwordx4 a[96:99], v2, s[12:15], s40 offen offset:0
    v_and_b32 v227, 0xffff0000, v216
    v_add_f32 v227, 0x3727c5ac, v227
    s_waitcnt lgkmcnt(6)
    v_mfma_f32_16x16x32_bf16 v[28:31], v[200:203], v[144:147], v[28:31]
    v_mfma_f32_16x16x32_bf16 v[56:59], v[200:203], v[148:151], v[56:59]
    ds_read_b128 v[172:175], v15 offset:58368
    buffer_load_dwordx4 a[100:103], v2, s[12:15], s40 offen offset:1024
    v_cvt_pk_bf16_f32 v216, v227, v227
    v_lshlrev_b32 v227, 16, v216
    s_waitcnt lgkmcnt(6)
    v_mfma_f32_16x16x32_bf16 v[32:35], v[204:207], v[144:147], v[32:35]
    v_mfma_f32_16x16x32_bf16 v[60:63], v[204:207], v[148:151], v[60:63]
    ds_read_b128 v[176:179], v15 offset:59392
    v_sqrt_f32 v227, v227
    s_nop 0
    s_waitcnt lgkmcnt(6)
    v_mfma_f32_16x16x32_bf16 v[36:39], v[208:211], v[144:147], v[36:39]
    v_mfma_f32_16x16x32_bf16 v[64:67], v[208:211], v[148:151], v[64:67]
    ds_read_b128 v[180:183], v15 offset:60416
    buffer_load_dwordx4 a[104:107], v2, s[12:15], s40 offen offset:2048
    v_cvt_pk_bf16_f32 v216, v227, v227
    v_lshlrev_b32 v227, 16, v216
    s_waitcnt lgkmcnt(6)
    v_mfma_f32_16x16x32_bf16 v[40:43], v[212:215], v[144:147], v[40:43]
    v_mfma_f32_16x16x32_bf16 v[68:71], v[212:215], v[148:151], v[68:71]
    ds_read_b128 v[184:187], v15 offset:61440
    v_rcp_f32 v227, v227
    s_nop 0
    s_waitcnt vmcnt(28)
    s_waitcnt lgkmcnt(6)
    v_mfma_f32_16x16x32_bf16 v[16:19], v[160:163], v[152:155], v[16:19]
    v_mfma_f32_16x16x32_bf16 v[44:47], v[160:163], v[156:159], v[44:47]
    ds_read_b128 v[188:191], v15 offset:62464
    v_mul_f32 v226, v226, v227
    v_sub_f32 v226, 0, v226
    s_waitcnt lgkmcnt(6)
    v_mfma_f32_16x16x32_bf16 v[20:23], v[164:167], v[152:155], v[20:23]
    v_mfma_f32_16x16x32_bf16 v[48:51], v[164:167], v[156:159], v[48:51]
    ds_read_b128 v[192:195], v15 offset:63488
    s_add_u32 s41, s47, 16384
    buffer_load_dwordx4 v[112:115], v2, s[12:15], s41 offen offset:0 sc1
    s_add_u32 s41, s48, 16384
    buffer_load_dwordx4 v[116:119], v2, s[12:15], s41 offen offset:0 sc1
    s_waitcnt lgkmcnt(6)
    v_mfma_f32_16x16x32_bf16 v[24:27], v[168:171], v[152:155], v[24:27]
    v_mfma_f32_16x16x32_bf16 v[52:55], v[168:171], v[156:159], v[52:55]
    ds_read_b128 v[196:199], v15 offset:64512
    buffer_load_dwordx4 a[108:111], v2, s[12:15], s40 offen offset:3072
    s_add_u32 s40, s40, 4096
    s_waitcnt lgkmcnt(6)
    v_mfma_f32_16x16x32_bf16 v[28:31], v[172:175], v[152:155], v[28:31]
    v_mfma_f32_16x16x32_bf16 v[56:59], v[172:175], v[156:159], v[56:59]
    ds_read_b128 v[200:203], v11 offset:0
    buffer_load_dwordx4 a[112:115], v2, s[12:15], s40 offen offset:0
    s_waitcnt lgkmcnt(6)
    v_mfma_f32_16x16x32_bf16 v[32:35], v[176:179], v[152:155], v[32:35]
    v_mfma_f32_16x16x32_bf16 v[60:63], v[176:179], v[156:159], v[60:63]
    ds_read_b128 v[204:207], v11 offset:1024
    s_waitcnt lgkmcnt(6)
    v_mfma_f32_16x16x32_bf16 v[36:39], v[180:183], v[152:155], v[36:39]
    v_mfma_f32_16x16x32_bf16 v[64:67], v[180:183], v[156:159], v[64:67]
    ds_read_b128 v[208:211], v11 offset:2048
    buffer_load_dwordx4 a[116:119], v2, s[12:15], s40 offen offset:1024
    s_waitcnt lgkmcnt(6)
    v_mfma_f32_16x16x32_bf16 v[40:43], v[184:187], v[152:155], v[40:43]
    v_mfma_f32_16x16x32_bf16 v[68:71], v[184:187], v[156:159], v[68:71]
    ds_read_b128 v[212:215], v11 offset:3072
    s_waitcnt vmcnt(28)
    s_waitcnt lgkmcnt(6)
    v_mfma_f32_16x16x32_bf16 v[16:19], v[188:191], v[72:75], v[16:19]
    v_mfma_f32_16x16x32_bf16 v[44:47], v[188:191], v[76:79], v[44:47]
    ds_read_b128 v[160:163], v11 offset:4096
    s_waitcnt lgkmcnt(6)
    v_mfma_f32_16x16x32_bf16 v[20:23], v[192:195], v[72:75], v[20:23]
    v_mfma_f32_16x16x32_bf16 v[48:51], v[192:195], v[76:79], v[48:51]
    ds_read_b128 v[164:167], v11 offset:5120
    s_add_u32 s41, s47, 16384
    buffer_load_dwordx4 v[120:123], v2, s[12:15], s41 offen offset:1024 sc1
    s_add_u32 s41, s48, 16384
    buffer_load_dwordx4 v[124:127], v2, s[12:15], s41 offen offset:1024 sc1
    s_waitcnt lgkmcnt(6)
    v_mfma_f32_16x16x32_bf16 v[24:27], v[196:199], v[72:75], v[24:27]
    v_mfma_f32_16x16x32_bf16 v[52:55], v[196:199], v[76:79], v[52:55]
    ds_read_b128 v[168:171], v11 offset:6144
    buffer_load_dwordx4 a[120:123], v2, s[12:15], s40 offen offset:2048
    s_waitcnt lgkmcnt(6)
    v_mfma_f32_16x16x32_bf16 v[28:31], v[200:203], v[72:75], v[28:31]
    v_mfma_f32_16x16x32_bf16 v[56:59], v[200:203], v[76:79], v[56:59]
    ds_read_b128 v[172:175], v11 offset:7168
    buffer_load_dwordx4 a[124:127], v2, s[12:15], s40 offen offset:3072
    s_add_u32 s40, s40, 4096
    s_waitcnt lgkmcnt(6)
    v_mfma_f32_16x16x32_bf16 v[32:35], v[204:207], v[72:75], v[32:35]
    v_mfma_f32_16x16x32_bf16 v[60:63], v[204:207], v[76:79], v[60:63]
    ds_read_b128 v[176:179], v11 offset:8192
    s_waitcnt lgkmcnt(6)
    v_mfma_f32_16x16x32_bf16 v[36:39], v[208:211], v[72:75], v[36:39]
    v_mfma_f32_16x16x32_bf16 v[64:67], v[208:211], v[76:79], v[64:67]
    ds_read_b128 v[180:183], v11 offset:9216
    buffer_load_dwordx4 a[128:131], v2, s[12:15], s40 offen offset:0
    s_waitcnt lgkmcnt(6)
    v_mfma_f32_16x16x32_bf16 v[40:43], v[212:215], v[72:75], v[40:43]
    v_mfma_f32_16x16x32_bf16 v[68:71], v[212:215], v[76:79], v[68:71]
    ds_read_b128 v[184:187], v11 offset:10240
    s_waitcnt vmcnt(28)
    s_waitcnt lgkmcnt(6)
    v_mfma_f32_16x16x32_bf16 v[16:19], v[160:163], v[80:83], v[16:19]
    v_mfma_f32_16x16x32_bf16 v[44:47], v[160:163], v[84:87], v[44:47]
    ds_read_b128 v[188:191], v11 offset:11264
    s_waitcnt lgkmcnt(6)
    v_mfma_f32_16x16x32_bf16 v[20:23], v[164:167], v[80:83], v[20:23]
    v_mfma_f32_16x16x32_bf16 v[48:51], v[164:167], v[84:87], v[48:51]
    ds_read_b128 v[192:195], v11 offset:12288
    s_add_u32 s41, s47, 16384
    buffer_load_dwordx4 v[128:131], v2, s[12:15], s41 offen offset:2048 sc1
    s_add_u32 s41, s48, 16384
    buffer_load_dwordx4 v[132:135], v2, s[12:15], s41 offen offset:2048 sc1
    s_waitcnt lgkmcnt(6)
    v_mfma_f32_16x16x32_bf16 v[24:27], v[168:171], v[80:83], v[24:27]
    v_mfma_f32_16x16x32_bf16 v[52:55], v[168:171], v[84:87], v[52:55]
    ds_read_b128 v[196:199], v11 offset:13312
    buffer_load_dwordx4 a[132:135], v2, s[12:15], s40 offen offset:1024
    s_waitcnt lgkmcnt(6)
    v_mfma_f32_16x16x32_bf16 v[28:31], v[172:175], v[80:83], v[28:31]
    v_mfma_f32_16x16x32_bf16 v[56:59], v[172:175], v[84:87], v[56:59]
    ds_read_b128 v[200:203], v11 offset:14336
    buffer_load_dwordx4 a[136:139], v2, s[12:15], s40 offen offset:2048
    s_waitcnt lgkmcnt(6)
    v_mfma_f32_16x16x32_bf16 v[32:35], v[176:179], v[80:83], v[32:35]
    v_mfma_f32_16x16x32_bf16 v[60:63], v[176:179], v[84:87], v[60:63]
    ds_read_b128 v[204:207], v11 offset:15360
    s_waitcnt lgkmcnt(6)
    v_mfma_f32_16x16x32_bf16 v[36:39], v[180:183], v[80:83], v[36:39]
    v_mfma_f32_16x16x32_bf16 v[64:67], v[180:183], v[84:87], v[64:67]
    ds_read_b128 v[208:211], v11 offset:16384
    buffer_load_dwordx4 a[140:143], v2, s[12:15], s40 offen offset:3072
    s_add_u32 s40, s40, 4096
    s_waitcnt lgkmcnt(6)
    v_mfma_f32_16x16x32_bf16 v[40:43], v[184:187], v[80:83], v[40:43]
    v_mfma_f32_16x16x32_bf16 v[68:71], v[184:187], v[84:87], v[68:71]
    ds_read_b128 v[212:215], v11 offset:17408
    buffer_load_dwordx4 a[144:147], v2, s[12:15], s40 offen offset:0
    s_waitcnt vmcnt(29)
    s_waitcnt lgkmcnt(6)
    v_mfma_f32_16x16x32_bf16 v[16:19], v[188:191], v[88:91], v[16:19]
    v_mfma_f32_16x16x32_bf16 v[44:47], v[188:191], v[92:95], v[44:47]
    ds_read_b128 v[160:163], v11 offset:18432
    s_waitcnt lgkmcnt(6)
    v_mfma_f32_16x16x32_bf16 v[20:23], v[192:195], v[88:91], v[20:23]
    v_mfma_f32_16x16x32_bf16 v[48:51], v[192:195], v[92:95], v[48:51]
    ds_read_b128 v[164:167], v11 offset:19456
    s_add_u32 s41, s47, 16384
    buffer_load_dwordx4 v[136:139], v2, s[12:15], s41 offen offset:3072 sc1
    s_add_u32 s41, s48, 16384
    buffer_load_dwordx4 v[140:143], v2, s[12:15], s41 offen offset:3072 sc1
    s_waitcnt lgkmcnt(6)
    v_mfma_f32_16x16x32_bf16 v[24:27], v[196:199], v[88:91], v[24:27]
    v_mfma_f32_16x16x32_bf16 v[52:55], v[196:199], v[92:95], v[52:55]
    ds_read_b128 v[168:171], v11 offset:20480
    buffer_load_dwordx4 a[148:151], v2, s[12:15], s40 offen offset:1024
    s_waitcnt lgkmcnt(6)
    v_mfma_f32_16x16x32_bf16 v[28:31], v[200:203], v[88:91], v[28:31]
    v_mfma_f32_16x16x32_bf16 v[56:59], v[200:203], v[92:95], v[56:59]
    ds_read_b128 v[172:175], v11 offset:21504
    buffer_load_dwordx4 a[152:155], v2, s[12:15], s40 offen offset:2048
    s_waitcnt lgkmcnt(6)
    v_mfma_f32_16x16x32_bf16 v[32:35], v[204:207], v[88:91], v[32:35]
    v_mfma_f32_16x16x32_bf16 v[60:63], v[204:207], v[92:95], v[60:63]
    ds_read_b128 v[176:179], v11 offset:22528
    s_waitcnt lgkmcnt(6)
    v_mfma_f32_16x16x32_bf16 v[36:39], v[208:211], v[88:91], v[36:39]
    v_mfma_f32_16x16x32_bf16 v[64:67], v[208:211], v[92:95], v[64:67]
    ds_read_b128 v[180:183], v11 offset:23552
    buffer_load_dwordx4 a[156:159], v2, s[12:15], s40 offen offset:3072
    s_add_u32 s40, s40, 4096
    s_waitcnt lgkmcnt(6)
    v_mfma_f32_16x16x32_bf16 v[40:43], v[212:215], v[88:91], v[40:43]
    v_mfma_f32_16x16x32_bf16 v[68:71], v[212:215], v[92:95], v[68:71]
    ds_read_b128 v[184:187], v14 offset:0
    buffer_load_dwordx4 a[160:163], v2, s[12:15], s40 offen offset:0
    s_add_u32 s48, s54, 368640
    buffer_load_dwordx4 v[228:231], v254, s[12:15], s48 offen sc1
    buffer_load_dwordx4 v[232:235], v254, s[12:15], s48 offen offset:1024 sc1
    buffer_load_dwordx2 v[236:237], v8, s[12:15], s48 offen offset:2048 sc1
    s_waitcnt vmcnt(33)
    s_waitcnt lgkmcnt(6)
    v_mfma_f32_16x16x32_bf16 v[16:19], v[160:163], v[96:99], v[16:19]
    v_mfma_f32_16x16x32_bf16 v[44:47], v[160:163], v[100:103], v[44:47]
    ds_read_b128 v[188:191], v14 offset:1024
    s_waitcnt lgkmcnt(6)
    v_mfma_f32_16x16x32_bf16 v[20:23], v[164:167], v[96:99], v[20:23]
    v_mfma_f32_16x16x32_bf16 v[48:51], v[164:167], v[100:103], v[48:51]
    ds_read_b128 v[192:195], v14 offset:2048
    s_waitcnt lgkmcnt(6)
    v_mfma_f32_16x16x32_bf16 v[24:27], v[168:171], v[96:99], v[24:27]
    v_mfma_f32_16x16x32_bf16 v[52:55], v[168:171], v[100:103], v[52:55]
    ds_read_b128 v[196:199], v14 offset:3072
    buffer_load_dwordx4 a[164:167], v2, s[12:15], s40 offen offset:1024
    s_waitcnt lgkmcnt(6)
    v_mfma_f32_16x16x32_bf16 v[28:31], v[172:175], v[96:99], v[28:31]
    v_mfma_f32_16x16x32_bf16 v[56:59], v[172:175], v[100:103], v[56:59]
    ds_read_b128 v[200:203], v14 offset:4096
    buffer_load_dwordx4 a[168:171], v2, s[12:15], s40 offen offset:2048
    s_waitcnt lgkmcnt(6)
    v_mfma_f32_16x16x32_bf16 v[32:35], v[176:179], v[96:99], v[32:35]
    v_mfma_f32_16x16x32_bf16 v[60:63], v[176:179], v[100:103], v[60:63]
    ds_read_b128 v[204:207], v14 offset:5120
    s_waitcnt lgkmcnt(6)
    v_mfma_f32_16x16x32_bf16 v[36:39], v[180:183], v[96:99], v[36:39]
    v_mfma_f32_16x16x32_bf16 v[64:67], v[180:183], v[100:103], v[64:67]
    ds_read_b128 v[208:211], v14 offset:6144
    buffer_load_dwordx4 a[172:175], v2, s[12:15], s40 offen offset:3072
    s_add_u32 s40, s40, 4096
    s_waitcnt lgkmcnt(6)
    v_mfma_f32_16x16x32_bf16 v[40:43], v[184:187], v[96:99], v[40:43]
    v_mfma_f32_16x16x32_bf16 v[68:71], v[184:187], v[100:103], v[68:71]
    ds_read_b128 v[212:215], v14 offset:7168
    buffer_load_dwordx4 a[176:179], v2, s[12:15], s40 offen offset:0
    s_add_u32 s48, s54, 20480
    buffer_load_dwordx4 v[238:241], v254, s[12:15], s48 offen sc1
    buffer_load_dwordx4 v[242:245], v254, s[12:15], s48 offen offset:1024 sc1
    buffer_load_dwordx2 v[246:247], v8, s[12:15], s48 offen offset:2048 sc1
    s_waitcnt vmcnt(35)
    s_waitcnt lgkmcnt(6)
    v_mfma_f32_16x16x32_bf16 v[16:19], v[188:191], v[104:107], v[16:19]
    v_mfma_f32_16x16x32_bf16 v[44:47], v[188:191], v[108:111], v[44:47]
    ds_read_b128 v[160:163], v14 offset:8192
    s_waitcnt lgkmcnt(6)
    v_mfma_f32_16x16x32_bf16 v[20:23], v[192:195], v[104:107], v[20:23]
    v_mfma_f32_16x16x32_bf16 v[48:51], v[192:195], v[108:111], v[48:51]
    ds_read_b128 v[164:167], v14 offset:9216
    s_waitcnt lgkmcnt(6)
    v_mfma_f32_16x16x32_bf16 v[24:27], v[196:199], v[104:107], v[24:27]
    v_mfma_f32_16x16x32_bf16 v[52:55], v[196:199], v[108:111], v[52:55]
    ds_read_b128 v[168:171], v14 offset:10240
    buffer_load_dwordx4 a[180:183], v2, s[12:15], s40 offen offset:1024
    s_waitcnt lgkmcnt(6)
    v_mfma_f32_16x16x32_bf16 v[28:31], v[200:203], v[104:107], v[28:31]
    v_mfma_f32_16x16x32_bf16 v[56:59], v[200:203], v[108:111], v[56:59]
    ds_read_b128 v[172:175], v14 offset:11264
    buffer_load_dwordx4 a[184:187], v2, s[12:15], s40 offen offset:2048
    s_waitcnt lgkmcnt(6)
    v_mfma_f32_16x16x32_bf16 v[32:35], v[204:207], v[104:107], v[32:35]
    v_mfma_f32_16x16x32_bf16 v[60:63], v[204:207], v[108:111], v[60:63]
    ds_read_b128 v[176:179], v14 offset:12288
    s_waitcnt lgkmcnt(6)
    v_mfma_f32_16x16x32_bf16 v[36:39], v[208:211], v[104:107], v[36:39]
    v_mfma_f32_16x16x32_bf16 v[64:67], v[208:211], v[108:111], v[64:67]
    ds_read_b128 v[180:183], v14 offset:13312
    buffer_load_dwordx4 a[188:191], v2, s[12:15], s40 offen offset:3072
    s_add_u32 s40, s40, 4096
    s_waitcnt lgkmcnt(6)
    v_mfma_f32_16x16x32_bf16 v[40:43], v[212:215], v[104:107], v[40:43]
    v_mfma_f32_16x16x32_bf16 v[68:71], v[212:215], v[108:111], v[68:71]
    ds_read_b128 v[184:187], v14 offset:14336
    buffer_load_dwordx4 a[192:195], v2, s[12:15], s40 offen offset:0
    s_waitcnt vmcnt(34)
    s_waitcnt lgkmcnt(6)
    v_mfma_f32_16x16x32_bf16 v[16:19], v[160:163], v[112:115], v[16:19]
    v_mfma_f32_16x16x32_bf16 v[44:47], v[160:163], v[116:119], v[44:47]
    ds_read_b128 v[188:191], v14 offset:15360
    s_waitcnt lgkmcnt(6)
    v_mfma_f32_16x16x32_bf16 v[20:23], v[164:167], v[112:115], v[20:23]
    v_mfma_f32_16x16x32_bf16 v[48:51], v[164:167], v[116:119], v[48:51]
    ds_read_b128 v[192:195], v14 offset:16384
    s_waitcnt lgkmcnt(6)
    v_mfma_f32_16x16x32_bf16 v[24:27], v[168:171], v[112:115], v[24:27]
    v_mfma_f32_16x16x32_bf16 v[52:55], v[168:171], v[116:119], v[52:55]
    ds_read_b128 v[196:199], v14 offset:17408
    buffer_load_dwordx4 a[196:199], v2, s[12:15], s40 offen offset:1024
    s_waitcnt lgkmcnt(6)
    v_mfma_f32_16x16x32_bf16 v[28:31], v[172:175], v[112:115], v[28:31]
    v_mfma_f32_16x16x32_bf16 v[56:59], v[172:175], v[116:119], v[56:59]
    ds_read_b128 v[200:203], v14 offset:18432
    buffer_load_dwordx4 a[200:203], v2, s[12:15], s40 offen offset:2048
    s_waitcnt lgkmcnt(6)
    v_mfma_f32_16x16x32_bf16 v[32:35], v[176:179], v[112:115], v[32:35]
    v_mfma_f32_16x16x32_bf16 v[60:63], v[176:179], v[116:119], v[60:63]
    ds_read_b128 v[204:207], v14 offset:19456
    s_waitcnt lgkmcnt(6)
    v_mfma_f32_16x16x32_bf16 v[36:39], v[180:183], v[112:115], v[36:39]
    v_mfma_f32_16x16x32_bf16 v[64:67], v[180:183], v[116:119], v[64:67]
    ds_read_b128 v[208:211], v14 offset:20480
    buffer_load_dwordx4 a[204:207], v2, s[12:15], s40 offen offset:3072
    s_add_u32 s40, s40, 4096
    s_waitcnt lgkmcnt(6)
    v_mfma_f32_16x16x32_bf16 v[40:43], v[184:187], v[112:115], v[40:43]
    v_mfma_f32_16x16x32_bf16 v[68:71], v[184:187], v[116:119], v[68:71]
    ds_read_b128 v[212:215], v14 offset:21504
    buffer_load_dwordx4 a[208:211], v2, s[12:15], s40 offen offset:0
    s_waitcnt vmcnt(33)
    s_waitcnt lgkmcnt(6)
    v_mfma_f32_16x16x32_bf16 v[16:19], v[188:191], v[120:123], v[16:19]
    v_mfma_f32_16x16x32_bf16 v[44:47], v[188:191], v[124:127], v[44:47]
    ds_read_b128 v[160:163], v14 offset:22528
    s_waitcnt lgkmcnt(6)
    v_mfma_f32_16x16x32_bf16 v[20:23], v[192:195], v[120:123], v[20:23]
    v_mfma_f32_16x16x32_bf16 v[48:51], v[192:195], v[124:127], v[48:51]
    ds_read_b128 v[164:167], v14 offset:23552
    s_waitcnt lgkmcnt(6)
    v_mfma_f32_16x16x32_bf16 v[24:27], v[196:199], v[120:123], v[24:27]
    v_mfma_f32_16x16x32_bf16 v[52:55], v[196:199], v[124:127], v[52:55]
    ds_read_b128 v[168:171], v14 offset:24576
    buffer_load_dwordx4 a[212:215], v2, s[12:15], s40 offen offset:1024
    s_waitcnt lgkmcnt(6)
    v_mfma_f32_16x16x32_bf16 v[28:31], v[200:203], v[120:123], v[28:31]
    v_mfma_f32_16x16x32_bf16 v[56:59], v[200:203], v[124:127], v[56:59]
    ds_read_b128 v[172:175], v14 offset:25600
    buffer_load_dwordx4 a[216:219], v2, s[12:15], s40 offen offset:2048
    s_waitcnt lgkmcnt(6)
    v_mfma_f32_16x16x32_bf16 v[32:35], v[204:207], v[120:123], v[32:35]
    v_mfma_f32_16x16x32_bf16 v[60:63], v[204:207], v[124:127], v[60:63]
    ds_read_b128 v[176:179], v14 offset:26624
    s_waitcnt lgkmcnt(6)
    v_mfma_f32_16x16x32_bf16 v[36:39], v[208:211], v[120:123], v[36:39]
    v_mfma_f32_16x16x32_bf16 v[64:67], v[208:211], v[124:127], v[64:67]
    ds_read_b128 v[180:183], v14 offset:27648
    buffer_load_dwordx4 a[220:223], v2, s[12:15], s40 offen offset:3072
    s_add_u32 s40, s40, 4096
    s_waitcnt lgkmcnt(6)
    v_mfma_f32_16x16x32_bf16 v[40:43], v[212:215], v[120:123], v[40:43]
    v_mfma_f32_16x16x32_bf16 v[68:71], v[212:215], v[124:127], v[68:71]
    ds_read_b128 v[184:187], v14 offset:28672
    buffer_load_dwordx4 a[224:227], v2, s[12:15], s40 offen offset:0
    s_waitcnt vmcnt(32)
    s_waitcnt lgkmcnt(6)
    v_mfma_f32_16x16x32_bf16 v[16:19], v[160:163], v[128:131], v[16:19]
    v_mfma_f32_16x16x32_bf16 v[44:47], v[160:163], v[132:135], v[44:47]
    ds_read_b128 v[188:191], v14 offset:29696
    s_waitcnt lgkmcnt(6)
    v_mfma_f32_16x16x32_bf16 v[20:23], v[164:167], v[128:131], v[20:23]
    v_mfma_f32_16x16x32_bf16 v[48:51], v[164:167], v[132:135], v[48:51]
    ds_read_b128 v[192:195], v14 offset:30720
    s_waitcnt lgkmcnt(6)
    v_mfma_f32_16x16x32_bf16 v[24:27], v[168:171], v[128:131], v[24:27]
    v_mfma_f32_16x16x32_bf16 v[52:55], v[168:171], v[132:135], v[52:55]
    ds_read_b128 v[196:199], v14 offset:31744
    buffer_load_dwordx4 a[228:231], v2, s[12:15], s40 offen offset:1024
    s_waitcnt lgkmcnt(6)
    v_mfma_f32_16x16x32_bf16 v[28:31], v[172:175], v[128:131], v[28:31]
    v_mfma_f32_16x16x32_bf16 v[56:59], v[172:175], v[132:135], v[56:59]
    ds_read_b128 v[200:203], v14 offset:32768
    buffer_load_dwordx4 a[232:235], v2, s[12:15], s40 offen offset:2048
    s_waitcnt lgkmcnt(6)
    v_mfma_f32_16x16x32_bf16 v[32:35], v[176:179], v[128:131], v[32:35]
    v_mfma_f32_16x16x32_bf16 v[60:63], v[176:179], v[132:135], v[60:63]
    ds_read_b128 v[204:207], v14 offset:33792
    s_waitcnt lgkmcnt(6)
    v_mfma_f32_16x16x32_bf16 v[36:39], v[180:183], v[128:131], v[36:39]
    v_mfma_f32_16x16x32_bf16 v[64:67], v[180:183], v[132:135], v[64:67]
    ds_read_b128 v[208:211], v14 offset:34816
    buffer_load_dwordx4 a[236:239], v2, s[12:15], s40 offen offset:3072
    s_add_u32 s40, s40, 4096
    s_cmp_eq_u32 s30, 3
    s_cselect_b32 s41, 61440, 0
    s_sub_u32 s40, s40, s41
    s_waitcnt lgkmcnt(6)
    v_mfma_f32_16x16x32_bf16 v[40:43], v[184:187], v[128:131], v[40:43]
    v_mfma_f32_16x16x32_bf16 v[68:71], v[184:187], v[132:135], v[68:71]
    ds_read_b128 v[212:215], v14 offset:35840
    buffer_load_dwordx4 a[240:243], v2, s[12:15], s40 offen offset:0
    s_waitcnt vmcnt(30)
    s_waitcnt lgkmcnt(6)
    v_mfma_f32_16x16x32_bf16 v[16:19], v[188:191], v[136:139], v[16:19]
    v_mfma_f32_16x16x32_bf16 v[44:47], v[188:191], v[140:143], v[44:47]
    s_waitcnt lgkmcnt(5)
    v_mfma_f32_16x16x32_bf16 v[20:23], v[192:195], v[136:139], v[20:23]
    v_mfma_f32_16x16x32_bf16 v[48:51], v[192:195], v[140:143], v[48:51]
    s_waitcnt lgkmcnt(4)
    v_mfma_f32_16x16x32_bf16 v[24:27], v[196:199], v[136:139], v[24:27]
    v_mfma_f32_16x16x32_bf16 v[52:55], v[196:199], v[140:143], v[52:55]
    buffer_load_dwordx4 a[244:247], v2, s[12:15], s40 offen offset:1024
    s_waitcnt lgkmcnt(3)
    v_mfma_f32_16x16x32_bf16 v[28:31], v[200:203], v[136:139], v[28:31]
    v_mfma_f32_16x16x32_bf16 v[56:59], v[200:203], v[140:143], v[56:59]
    buffer_load_dwordx4 a[248:251], v2, s[12:15], s40 offen offset:2048
    s_waitcnt lgkmcnt(2)
    v_mfma_f32_16x16x32_bf16 v[32:35], v[204:207], v[136:139], v[32:35]
    v_mfma_f32_16x16x32_bf16 v[60:63], v[204:207], v[140:143], v[60:63]
    s_waitcnt lgkmcnt(1)
    v_mfma_f32_16x16x32_bf16 v[36:39], v[208:211], v[136:139], v[36:39]
    v_mfma_f32_16x16x32_bf16 v[64:67], v[208:211], v[140:143], v[64:67]
    buffer_load_dwordx4 a[252:255], v2, s[12:15], s40 offen offset:3072
    s_add_u32 s40, s40, 4096
    s_waitcnt lgkmcnt(0)
    v_mfma_f32_16x16x32_bf16 v[40:43], v[212:215], v[136:139], v[40:43]
    v_mfma_f32_16x16x32_bf16 v[68:71], v[212:215], v[140:143], v[68:71]
    v_lshlrev_b32 v9, 4, v3
    v_add_u32 v9, 156672, v9
    v_mov_b32 v12, 0xbdd2d3e8
    v_mov_b32 v13, 0xc0135761
    ds_read_b128 v[72:75], v9 offset:0
    ds_read_b128 v[100:103], v9 offset:512
    ds_read_b128 v[76:79], v9 offset:64
    ds_read_b128 v[104:107], v9 offset:576
    ds_read_b128 v[80:83], v9 offset:128
    ds_read_b128 v[108:111], v9 offset:640
    ds_read_b128 v[84:87], v9 offset:192
    ds_read_b128 v[112:115], v9 offset:704
    ds_read_b128 v[88:91], v9 offset:256
    ds_read_b128 v[116:119], v9 offset:768
    ds_read_b128 v[92:95], v9 offset:320
    ds_read_b128 v[120:123], v9 offset:832
    ds_read_b128 v[96:99], v9 offset:384
    ds_read_b128 v[124:127], v9 offset:896
    s_waitcnt lgkmcnt(0)
    v_pk_add_f32 v[72:73], v[72:73], v[100:101]
    v_pk_add_f32 v[74:75], v[74:75], v[102:103]
    v_pk_add_f32 v[76:77], v[76:77], v[104:105]
    v_pk_add_f32 v[78:79], v[78:79], v[106:107]
    v_pk_add_f32 v[80:81], v[80:81], v[108:109]
    v_pk_add_f32 v[82:83], v[82:83], v[110:111]
    v_pk_add_f32 v[84:85], v[84:85], v[112:113]
    v_pk_add_f32 v[86:87], v[86:87], v[114:115]
    v_pk_add_f32 v[88:89], v[88:89], v[116:117]
    v_pk_add_f32 v[90:91], v[90:91], v[118:119]
    v_pk_add_f32 v[92:93], v[92:93], v[120:121]
    v_pk_add_f32 v[94:95], v[94:95], v[122:123]
    v_pk_add_f32 v[96:97], v[96:97], v[124:125]
    v_pk_add_f32 v[98:99], v[98:99], v[126:127]
    s_lshl_b32 s49, s34, 2
    s_add_u32 s49, s49, s30
    s_lshl_b32 s49, s49, 7
    s_add_u32 s49, s49, s37
    s_lshl_b32 s41, s35, 2
    s_add_u32 s49, s49, s41
    v_pk_mul_f32 v[160:161], v[72:73], v[224:225] op_sel_hi:[1,0]
    v_pk_mul_f32 v[162:163], v[74:75], v[224:225] op_sel_hi:[1,0]
    v_pk_mul_f32 v[164:165], v[72:73], v[226:227] op_sel_hi:[1,0]
    v_pk_mul_f32 v[166:167], v[74:75], v[226:227] op_sel_hi:[1,0]
    v_pk_mul_f32 v[168:169], v[76:77], v[224:225] op_sel_hi:[1,0]
    v_pk_mul_f32 v[170:171], v[78:79], v[224:225] op_sel_hi:[1,0]
    v_pk_mul_f32 v[172:173], v[76:77], v[226:227] op_sel_hi:[1,0]
    v_pk_mul_f32 v[174:175], v[78:79], v[226:227] op_sel_hi:[1,0]
    v_pk_fma_f32 v[16:17], v[16:17], v[224:225], v[160:161] op_sel:[0,1,0] op_sel_hi:[1,1,1]
    v_pk_fma_f32 v[18:19], v[18:19], v[224:225], v[162:163] op_sel:[0,1,0] op_sel_hi:[1,1,1]
    v_pk_fma_f32 v[44:45], v[44:45], v[226:227], v[164:165] op_sel:[0,1,0] op_sel_hi:[1,1,1]
    v_pk_fma_f32 v[46:47], v[46:47], v[226:227], v[166:167] op_sel:[0,1,0] op_sel_hi:[1,1,1]
    v_pk_fma_f32 v[20:21], v[20:21], v[224:225], v[168:169] op_sel:[0,1,0] op_sel_hi:[1,1,1]
    v_pk_fma_f32 v[22:23], v[22:23], v[224:225], v[170:171] op_sel:[0,1,0] op_sel_hi:[1,1,1]
    v_pk_fma_f32 v[48:49], v[48:49], v[226:227], v[172:173] op_sel:[0,1,0] op_sel_hi:[1,1,1]
    v_pk_fma_f32 v[50:51], v[50:51], v[226:227], v[174:175] op_sel:[0,1,0] op_sel_hi:[1,1,1]
    v_pk_mul_f32 v[160:161], v[16:17], v[16:17]
    v_pk_mul_f32 v[162:163], v[18:19], v[18:19]
    v_pk_mul_f32 v[164:165], v[44:45], v[44:45]
    v_pk_mul_f32 v[166:167], v[46:47], v[46:47]
    v_pk_mul_f32 v[168:169], v[20:21], v[20:21]
    v_pk_mul_f32 v[170:171], v[22:23], v[22:23]
    v_pk_mul_f32 v[172:173], v[48:49], v[48:49]
    v_pk_mul_f32 v[174:175], v[50:51], v[50:51]
    v_pk_fma_f32 v[160:161], v[160:161], v[12:13], v[12:13] op_sel:[0,0,1] op_sel_hi:[1,0,1]
    v_pk_fma_f32 v[162:163], v[162:163], v[12:13], v[12:13] op_sel:[0,0,1] op_sel_hi:[1,0,1]
    v_pk_fma_f32 v[164:165], v[164:165], v[12:13], v[12:13] op_sel:[0,0,1] op_sel_hi:[1,0,1]
    v_pk_fma_f32 v[166:167], v[166:167], v[12:13], v[12:13] op_sel:[0,0,1] op_sel_hi:[1,0,1]
    v_pk_fma_f32 v[168:169], v[168:169], v[12:13], v[12:13] op_sel:[0,0,1] op_sel_hi:[1,0,1]
    v_pk_fma_f32 v[170:171], v[170:171], v[12:13], v[12:13] op_sel:[0,0,1] op_sel_hi:[1,0,1]
    v_pk_fma_f32 v[172:173], v[172:173], v[12:13], v[12:13] op_sel:[0,0,1] op_sel_hi:[1,0,1]
    v_pk_fma_f32 v[174:175], v[174:175], v[12:13], v[12:13] op_sel:[0,0,1] op_sel_hi:[1,0,1]
    v_pk_mul_f32 v[160:161], v[160:161], v[16:17]
    v_pk_mul_f32 v[162:163], v[162:163], v[18:19]
    v_pk_mul_f32 v[164:165], v[164:165], v[44:45]
    v_pk_mul_f32 v[166:167], v[166:167], v[46:47]
    v_pk_mul_f32 v[168:169], v[168:169], v[20:21]
    v_pk_mul_f32 v[170:171], v[170:171], v[22:23]
    v_pk_mul_f32 v[172:173], v[172:173], v[48:49]
    v_pk_mul_f32 v[174:175], v[174:175], v[50:51]
    v_exp_f32 v160, v160
    v_exp_f32 v161, v161
    v_exp_f32 v162, v162
    v_exp_f32 v163, v163
    v_exp_f32 v164, v164
    v_exp_f32 v165, v165
    v_exp_f32 v166, v166
    v_exp_f32 v167, v167
    v_exp_f32 v168, v168
    v_exp_f32 v169, v169
    v_exp_f32 v170, v170
    v_exp_f32 v171, v171
    v_exp_f32 v172, v172
    v_exp_f32 v173, v173
    v_exp_f32 v174, v174
    v_exp_f32 v175, v175
    v_pk_add_f32 v[160:161], v[160:161], 1.0 op_sel_hi:[1,0]
    v_pk_add_f32 v[162:163], v[162:163], 1.0 op_sel_hi:[1,0]
    v_pk_add_f32 v[164:165], v[164:165], 1.0 op_sel_hi:[1,0]
    v_pk_add_f32 v[166:167], v[166:167], 1.0 op_sel_hi:[1,0]
    v_pk_add_f32 v[168:169], v[168:169], 1.0 op_sel_hi:[1,0]
    v_pk_add_f32 v[170:171], v[170:171], 1.0 op_sel_hi:[1,0]
    v_pk_add_f32 v[172:173], v[172:173], 1.0 op_sel_hi:[1,0]
    v_pk_add_f32 v[174:175], v[174:175], 1.0 op_sel_hi:[1,0]
    v_rcp_f32 v160, v160
    v_rcp_f32 v161, v161
    v_rcp_f32 v162, v162
    v_rcp_f32 v163, v163
    v_rcp_f32 v164, v164
    v_rcp_f32 v165, v165
    v_rcp_f32 v166, v166
    v_rcp_f32 v167, v167
    v_rcp_f32 v168, v168
    v_rcp_f32 v169, v169
    v_rcp_f32 v170, v170
    v_rcp_f32 v171, v171
    v_rcp_f32 v172, v172
    v_rcp_f32 v173, v173
    v_rcp_f32 v174, v174
    v_rcp_f32 v175, v175
    s_nop 0
    v_pk_mul_f32 v[16:17], v[16:17], v[160:161]
    v_pk_mul_f32 v[18:19], v[18:19], v[162:163]
    v_pk_mul_f32 v[44:45], v[44:45], v[164:165]
    v_pk_mul_f32 v[46:47], v[46:47], v[166:167]
    v_pk_mul_f32 v[20:21], v[20:21], v[168:169]
    v_pk_mul_f32 v[22:23], v[22:23], v[170:171]
    v_pk_mul_f32 v[48:49], v[48:49], v[172:173]
    v_pk_mul_f32 v[50:51], v[50:51], v[174:175]
    v_cvt_pk_bf16_f32 v16, v16, v17
    v_cvt_pk_bf16_f32 v17, v18, v19
    v_cvt_pk_bf16_f32 v18, v20, v21
    v_cvt_pk_bf16_f32 v19, v22, v23
    v_cvt_pk_bf16_f32 v44, v44, v45
    v_cvt_pk_bf16_f32 v45, v46, v47
    v_cvt_pk_bf16_f32 v46, v48, v49
    v_cvt_pk_bf16_f32 v47, v50, v51
    s_nop 1
    v_permlane16_swap_b32 v16, v18
    v_permlane16_swap_b32 v17, v19
    v_permlane16_swap_b32 v44, v46
    v_permlane16_swap_b32 v45, v47
    buffer_store_dwordx4 v[16:19], v254, s[12:15], s52 offen offset:0 sc1
    buffer_store_dwordx4 v[44:47], v254, s[12:15], s53 offen offset:0 sc1
k2_kernel_gs30:
    v_pk_mul_f32 v[160:161], v[80:81], v[224:225] op_sel_hi:[1,0]
    v_pk_mul_f32 v[162:163], v[82:83], v[224:225] op_sel_hi:[1,0]
    v_pk_mul_f32 v[164:165], v[80:81], v[226:227] op_sel_hi:[1,0]
    v_pk_mul_f32 v[166:167], v[82:83], v[226:227] op_sel_hi:[1,0]
    v_pk_mul_f32 v[168:169], v[84:85], v[224:225] op_sel_hi:[1,0]
    v_pk_mul_f32 v[170:171], v[86:87], v[224:225] op_sel_hi:[1,0]
    v_pk_mul_f32 v[172:173], v[84:85], v[226:227] op_sel_hi:[1,0]
    v_pk_mul_f32 v[174:175], v[86:87], v[226:227] op_sel_hi:[1,0]
    v_pk_fma_f32 v[24:25], v[24:25], v[224:225], v[160:161] op_sel:[0,1,0] op_sel_hi:[1,1,1]
    v_pk_fma_f32 v[26:27], v[26:27], v[224:225], v[162:163] op_sel:[0,1,0] op_sel_hi:[1,1,1]
    v_pk_fma_f32 v[52:53], v[52:53], v[226:227], v[164:165] op_sel:[0,1,0] op_sel_hi:[1,1,1]
    v_pk_fma_f32 v[54:55], v[54:55], v[226:227], v[166:167] op_sel:[0,1,0] op_sel_hi:[1,1,1]
    v_pk_fma_f32 v[28:29], v[28:29], v[224:225], v[168:169] op_sel:[0,1,0] op_sel_hi:[1,1,1]
    v_pk_fma_f32 v[30:31], v[30:31], v[224:225], v[170:171] op_sel:[0,1,0] op_sel_hi:[1,1,1]
    v_pk_fma_f32 v[56:57], v[56:57], v[226:227], v[172:173] op_sel:[0,1,0] op_sel_hi:[1,1,1]
    v_pk_fma_f32 v[58:59], v[58:59], v[226:227], v[174:175] op_sel:[0,1,0] op_sel_hi:[1,1,1]
    v_pk_mul_f32 v[160:161], v[24:25], v[24:25]
    v_pk_mul_f32 v[162:163], v[26:27], v[26:27]
    v_pk_mul_f32 v[164:165], v[52:53], v[52:53]
    v_pk_mul_f32 v[166:167], v[54:55], v[54:55]
    v_pk_mul_f32 v[168:169], v[28:29], v[28:29]
    v_pk_mul_f32 v[170:171], v[30:31], v[30:31]
    v_pk_mul_f32 v[172:173], v[56:57], v[56:57]
    v_pk_mul_f32 v[174:175], v[58:59], v[58:59]
    v_pk_fma_f32 v[160:161], v[160:161], v[12:13], v[12:13] op_sel:[0,0,1] op_sel_hi:[1,0,1]
    v_pk_fma_f32 v[162:163], v[162:163], v[12:13], v[12:13] op_sel:[0,0,1] op_sel_hi:[1,0,1]
    v_pk_fma_f32 v[164:165], v[164:165], v[12:13], v[12:13] op_sel:[0,0,1] op_sel_hi:[1,0,1]
    v_pk_fma_f32 v[166:167], v[166:167], v[12:13], v[12:13] op_sel:[0,0,1] op_sel_hi:[1,0,1]
    v_pk_fma_f32 v[168:169], v[168:169], v[12:13], v[12:13] op_sel:[0,0,1] op_sel_hi:[1,0,1]
    v_pk_fma_f32 v[170:171], v[170:171], v[12:13], v[12:13] op_sel:[0,0,1] op_sel_hi:[1,0,1]
    v_pk_fma_f32 v[172:173], v[172:173], v[12:13], v[12:13] op_sel:[0,0,1] op_sel_hi:[1,0,1]
    v_pk_fma_f32 v[174:175], v[174:175], v[12:13], v[12:13] op_sel:[0,0,1] op_sel_hi:[1,0,1]
    v_pk_mul_f32 v[160:161], v[160:161], v[24:25]
    v_pk_mul_f32 v[162:163], v[162:163], v[26:27]
    v_pk_mul_f32 v[164:165], v[164:165], v[52:53]
    v_pk_mul_f32 v[166:167], v[166:167], v[54:55]
    v_pk_mul_f32 v[168:169], v[168:169], v[28:29]
    v_pk_mul_f32 v[170:171], v[170:171], v[30:31]
    v_pk_mul_f32 v[172:173], v[172:173], v[56:57]
    v_pk_mul_f32 v[174:175], v[174:175], v[58:59]
    v_exp_f32 v160, v160
    v_exp_f32 v161, v161
    v_exp_f32 v162, v162
    v_exp_f32 v163, v163
    v_exp_f32 v164, v164
    v_exp_f32 v165, v165
    v_exp_f32 v166, v166
    v_exp_f32 v167, v167
    v_exp_f32 v168, v168
    v_exp_f32 v169, v169
    v_exp_f32 v170, v170
    v_exp_f32 v171, v171
    v_exp_f32 v172, v172
    v_exp_f32 v173, v173
    v_exp_f32 v174, v174
    v_exp_f32 v175, v175
    v_pk_add_f32 v[160:161], v[160:161], 1.0 op_sel_hi:[1,0]
    v_pk_add_f32 v[162:163], v[162:163], 1.0 op_sel_hi:[1,0]
    v_pk_add_f32 v[164:165], v[164:165], 1.0 op_sel_hi:[1,0]
    v_pk_add_f32 v[166:167], v[166:167], 1.0 op_sel_hi:[1,0]
    v_pk_add_f32 v[168:169], v[168:169], 1.0 op_sel_hi:[1,0]
    v_pk_add_f32 v[170:171], v[170:171], 1.0 op_sel_hi:[1,0]
    v_pk_add_f32 v[172:173], v[172:173], 1.0 op_sel_hi:[1,0]
    v_pk_add_f32 v[174:175], v[174:175], 1.0 op_sel_hi:[1,0]
    v_rcp_f32 v160, v160
    v_rcp_f32 v161, v161
    v_rcp_f32 v162, v162
    v_rcp_f32 v163, v163
    v_rcp_f32 v164, v164
    v_rcp_f32 v165, v165
    v_rcp_f32 v166, v166
    v_rcp_f32 v167, v167
    v_rcp_f32 v168, v168
    v_rcp_f32 v169, v169
    v_rcp_f32 v170, v170
    v_rcp_f32 v171, v171
    v_rcp_f32 v172, v172
    v_rcp_f32 v173, v173
    v_rcp_f32 v174, v174
    v_rcp_f32 v175, v175
    s_nop 0
    v_pk_mul_f32 v[24:25], v[24:25], v[160:161]
    v_pk_mul_f32 v[26:27], v[26:27], v[162:163]
    v_pk_mul_f32 v[52:53], v[52:53], v[164:165]
    v_pk_mul_f32 v[54:55], v[54:55], v[166:167]
    v_pk_mul_f32 v[28:29], v[28:29], v[168:169]
    v_pk_mul_f32 v[30:31], v[30:31], v[170:171]
    v_pk_mul_f32 v[56:57], v[56:57], v[172:173]
    v_pk_mul_f32 v[58:59], v[58:59], v[174:175]
    v_cvt_pk_bf16_f32 v24, v24, v25
    v_cvt_pk_bf16_f32 v25, v26, v27
    v_cvt_pk_bf16_f32 v26, v28, v29
    v_cvt_pk_bf16_f32 v27, v30, v31
    v_cvt_pk_bf16_f32 v52, v52, v53
    v_cvt_pk_bf16_f32 v53, v54, v55
    v_cvt_pk_bf16_f32 v54, v56, v57
    v_cvt_pk_bf16_f32 v55, v58, v59
    s_nop 1
    v_permlane16_swap_b32 v24, v26
    v_permlane16_swap_b32 v25, v27
    v_permlane16_swap_b32 v52, v54
    v_permlane16_swap_b32 v53, v55
    s_cmp_eq_u32 s35, 15
    s_cselect_b32 s46, 0xffff, -1
    s_mov_b32 exec_lo, s46
    s_mov_b32 exec_hi, s46
    buffer_store_dwordx4 v[24:27], v254, s[12:15], s52 offen offset:1024 sc1
    buffer_store_dwordx4 v[52:55], v254, s[12:15], s53 offen offset:1024 sc1
    s_mov_b64 exec, -1
k2_kernel_gs31:
    v_pk_mul_f32 v[160:161], v[88:89], v[224:225] op_sel_hi:[1,0]
    v_pk_mul_f32 v[162:163], v[90:91], v[224:225] op_sel_hi:[1,0]
    v_pk_mul_f32 v[164:165], v[88:89], v[226:227] op_sel_hi:[1,0]
    v_pk_mul_f32 v[166:167], v[90:91], v[226:227] op_sel_hi:[1,0]
    v_pk_mul_f32 v[168:169], v[92:93], v[224:225] op_sel_hi:[1,0]
    v_pk_mul_f32 v[170:171], v[94:95], v[224:225] op_sel_hi:[1,0]
    v_pk_mul_f32 v[172:173], v[92:93], v[226:227] op_sel_hi:[1,0]
    v_pk_mul_f32 v[174:175], v[94:95], v[226:227] op_sel_hi:[1,0]
    v_pk_fma_f32 v[32:33], v[32:33], v[224:225], v[160:161] op_sel:[0,1,0] op_sel_hi:[1,1,1]
    v_pk_fma_f32 v[34:35], v[34:35], v[224:225], v[162:163] op_sel:[0,1,0] op_sel_hi:[1,1,1]
    v_pk_fma_f32 v[60:61], v[60:61], v[226:227], v[164:165] op_sel:[0,1,0] op_sel_hi:[1,1,1]
    v_pk_fma_f32 v[62:63], v[62:63], v[226:227], v[166:167] op_sel:[0,1,0] op_sel_hi:[1,1,1]
    v_pk_fma_f32 v[36:37], v[36:37], v[224:225], v[168:169] op_sel:[0,1,0] op_sel_hi:[1,1,1]
    v_pk_fma_f32 v[38:39], v[38:39], v[224:225], v[170:171] op_sel:[0,1,0] op_sel_hi:[1,1,1]
    v_pk_fma_f32 v[64:65], v[64:65], v[226:227], v[172:173] op_sel:[0,1,0] op_sel_hi:[1,1,1]
    v_pk_fma_f32 v[66:67], v[66:67], v[226:227], v[174:175] op_sel:[0,1,0] op_sel_hi:[1,1,1]
    v_pk_mul_f32 v[160:161], v[32:33], v[32:33]
    v_pk_mul_f32 v[162:163], v[34:35], v[34:35]
    v_pk_mul_f32 v[164:165], v[60:61], v[60:61]
    v_pk_mul_f32 v[166:167], v[62:63], v[62:63]
    v_pk_mul_f32 v[168:169], v[36:37], v[36:37]
    v_pk_mul_f32 v[170:171], v[38:39], v[38:39]
    v_pk_mul_f32 v[172:173], v[64:65], v[64:65]
    v_pk_mul_f32 v[174:175], v[66:67], v[66:67]
    v_pk_fma_f32 v[160:161], v[160:161], v[12:13], v[12:13] op_sel:[0,0,1] op_sel_hi:[1,0,1]
    v_pk_fma_f32 v[162:163], v[162:163], v[12:13], v[12:13] op_sel:[0,0,1] op_sel_hi:[1,0,1]
    v_pk_fma_f32 v[164:165], v[164:165], v[12:13], v[12:13] op_sel:[0,0,1] op_sel_hi:[1,0,1]
    v_pk_fma_f32 v[166:167], v[166:167], v[12:13], v[12:13] op_sel:[0,0,1] op_sel_hi:[1,0,1]
    v_pk_fma_f32 v[168:169], v[168:169], v[12:13], v[12:13] op_sel:[0,0,1] op_sel_hi:[1,0,1]
    v_pk_fma_f32 v[170:171], v[170:171], v[12:13], v[12:13] op_sel:[0,0,1] op_sel_hi:[1,0,1]
    v_pk_fma_f32 v[172:173], v[172:173], v[12:13], v[12:13] op_sel:[0,0,1] op_sel_hi:[1,0,1]
    v_pk_fma_f32 v[174:175], v[174:175], v[12:13], v[12:13] op_sel:[0,0,1] op_sel_hi:[1,0,1]
    v_pk_mul_f32 v[160:161], v[160:161], v[32:33]
    v_pk_mul_f32 v[162:163], v[162:163], v[34:35]
    v_pk_mul_f32 v[164:165], v[164:165], v[60:61]
    v_pk_mul_f32 v[166:167], v[166:167], v[62:63]
    v_pk_mul_f32 v[168:169], v[168:169], v[36:37]
    v_pk_mul_f32 v[170:171], v[170:171], v[38:39]
    v_pk_mul_f32 v[172:173], v[172:173], v[64:65]
    v_pk_mul_f32 v[174:175], v[174:175], v[66:67]
    v_exp_f32 v160, v160
    v_exp_f32 v161, v161
    v_exp_f32 v162, v162
    v_exp_f32 v163, v163
    v_exp_f32 v164, v164
    v_exp_f32 v165, v165
    v_exp_f32 v166, v166
    v_exp_f32 v167, v167
    v_exp_f32 v168, v168
    v_exp_f32 v169, v169
    v_exp_f32 v170, v170
    v_exp_f32 v171, v171
    v_exp_f32 v172, v172
    v_exp_f32 v173, v173
    v_exp_f32 v174, v174
    v_exp_f32 v175, v175
    v_pk_add_f32 v[160:161], v[160:161], 1.0 op_sel_hi:[1,0]
    v_pk_add_f32 v[162:163], v[162:163], 1.0 op_sel_hi:[1,0]
    v_pk_add_f32 v[164:165], v[164:165], 1.0 op_sel_hi:[1,0]
    v_pk_add_f32 v[166:167], v[166:167], 1.0 op_sel_hi:[1,0]
    v_pk_add_f32 v[168:169], v[168:169], 1.0 op_sel_hi:[1,0]
    v_pk_add_f32 v[170:171], v[170:171], 1.0 op_sel_hi:[1,0]
    v_pk_add_f32 v[172:173], v[172:173], 1.0 op_sel_hi:[1,0]
    v_pk_add_f32 v[174:175], v[174:175], 1.0 op_sel_hi:[1,0]
    v_rcp_f32 v160, v160
    v_rcp_f32 v161, v161
    v_rcp_f32 v162, v162
    v_rcp_f32 v163, v163
    v_rcp_f32 v164, v164
    v_rcp_f32 v165, v165
    v_rcp_f32 v166, v166
    v_rcp_f32 v167, v167
    v_rcp_f32 v168, v168
    v_rcp_f32 v169, v169
    v_rcp_f32 v170, v170
    v_rcp_f32 v171, v171
    v_rcp_f32 v172, v172
    v_rcp_f32 v173, v173
    v_rcp_f32 v174, v174
    v_rcp_f32 v175, v175
    s_nop 0
    v_pk_mul_f32 v[32:33], v[32:33], v[160:161]
    v_pk_mul_f32 v[34:35], v[34:35], v[162:163]
    v_pk_mul_f32 v[60:61], v[60:61], v[164:165]
    v_pk_mul_f32 v[62:63], v[62:63], v[166:167]
    v_pk_mul_f32 v[36:37], v[36:37], v[168:169]
    v_pk_mul_f32 v[38:39], v[38:39], v[170:171]
    v_pk_mul_f32 v[64:65], v[64:65], v[172:173]
    v_pk_mul_f32 v[66:67], v[66:67], v[174:175]
    v_cvt_pk_bf16_f32 v32, v32, v33
    v_cvt_pk_bf16_f32 v33, v34, v35
    v_cvt_pk_bf16_f32 v34, v36, v37
    v_cvt_pk_bf16_f32 v35, v38, v39
    v_cvt_pk_bf16_f32 v60, v60, v61
    v_cvt_pk_bf16_f32 v61, v62, v63
    v_cvt_pk_bf16_f32 v62, v64, v65
    v_cvt_pk_bf16_f32 v63, v66, v67
    s_nop 1
    v_permlane16_swap_b32 v32, v34
    v_permlane16_swap_b32 v33, v35
    v_permlane16_swap_b32 v60, v62
    v_permlane16_swap_b32 v61, v63
    s_cmp_eq_u32 s35, 15
    s_cbranch_scc1 k2_kernel_gs32
    buffer_store_dwordx4 v[32:35], v254, s[12:15], s52 offen offset:2048 sc1
    buffer_store_dwordx4 v[60:63], v254, s[12:15], s53 offen offset:2048 sc1
k2_kernel_gs32:
    v_pk_mul_f32 v[160:161], v[96:97], v[224:225] op_sel_hi:[1,0]
    v_pk_mul_f32 v[162:163], v[98:99], v[224:225] op_sel_hi:[1,0]
    v_pk_mul_f32 v[164:165], v[96:97], v[226:227] op_sel_hi:[1,0]
    v_pk_mul_f32 v[166:167], v[98:99], v[226:227] op_sel_hi:[1,0]
    v_pk_fma_f32 v[40:41], v[40:41], v[224:225], v[160:161] op_sel:[0,1,0] op_sel_hi:[1,1,1]
    v_pk_fma_f32 v[42:43], v[42:43], v[224:225], v[162:163] op_sel:[0,1,0] op_sel_hi:[1,1,1]
    v_pk_fma_f32 v[68:69], v[68:69], v[226:227], v[164:165] op_sel:[0,1,0] op_sel_hi:[1,1,1]
    v_pk_fma_f32 v[70:71], v[70:71], v[226:227], v[166:167] op_sel:[0,1,0] op_sel_hi:[1,1,1]
    v_pk_mul_f32 v[160:161], v[40:41], v[40:41]
    v_pk_mul_f32 v[162:163], v[42:43], v[42:43]
    v_pk_mul_f32 v[164:165], v[68:69], v[68:69]
    v_pk_mul_f32 v[166:167], v[70:71], v[70:71]
    v_pk_fma_f32 v[160:161], v[160:161], v[12:13], v[12:13] op_sel:[0,0,1] op_sel_hi:[1,0,1]
    v_pk_fma_f32 v[162:163], v[162:163], v[12:13], v[12:13] op_sel:[0,0,1] op_sel_hi:[1,0,1]
    v_pk_fma_f32 v[164:165], v[164:165], v[12:13], v[12:13] op_sel:[0,0,1] op_sel_hi:[1,0,1]
    v_pk_fma_f32 v[166:167], v[166:167], v[12:13], v[12:13] op_sel:[0,0,1] op_sel_hi:[1,0,1]
    v_pk_mul_f32 v[160:161], v[160:161], v[40:41]
    v_pk_mul_f32 v[162:163], v[162:163], v[42:43]
    v_pk_mul_f32 v[164:165], v[164:165], v[68:69]
    v_pk_mul_f32 v[166:167], v[166:167], v[70:71]
    v_exp_f32 v160, v160
    v_exp_f32 v161, v161
    v_exp_f32 v162, v162
    v_exp_f32 v163, v163
    v_exp_f32 v164, v164
    v_exp_f32 v165, v165
    v_exp_f32 v166, v166
    v_exp_f32 v167, v167
    v_pk_add_f32 v[160:161], v[160:161], 1.0 op_sel_hi:[1,0]
    v_pk_add_f32 v[162:163], v[162:163], 1.0 op_sel_hi:[1,0]
    v_pk_add_f32 v[164:165], v[164:165], 1.0 op_sel_hi:[1,0]
    v_pk_add_f32 v[166:167], v[166:167], 1.0 op_sel_hi:[1,0]
    v_rcp_f32 v160, v160
    v_rcp_f32 v161, v161
    v_rcp_f32 v162, v162
    v_rcp_f32 v163, v163
    v_rcp_f32 v164, v164
    v_rcp_f32 v165, v165
    v_rcp_f32 v166, v166
    v_rcp_f32 v167, v167
    s_nop 0
    v_pk_mul_f32 v[40:41], v[40:41], v[160:161]
    v_pk_mul_f32 v[42:43], v[42:43], v[162:163]
    v_pk_mul_f32 v[68:69], v[68:69], v[164:165]
    v_pk_mul_f32 v[70:71], v[70:71], v[166:167]
    v_cvt_pk_bf16_f32 v40, v40, v41
    v_cvt_pk_bf16_f32 v41, v42, v43
    v_cvt_pk_bf16_f32 v68, v68, v69
    v_cvt_pk_bf16_f32 v69, v70, v71
    s_cmp_eq_u32 s35, 15
    s_cbranch_scc1 k2_kernel_gs33
    buffer_store_dwordx2 v[40:41], v8, s[12:15], s52 offen offset:3072 sc1
    buffer_store_dwordx2 v[68:69], v8, s[12:15], s53 offen offset:3072 sc1
k2_kernel_gs33:
    s_waitcnt vmcnt(0)
    v_mov_b32 v9, 1
    v_mov_b32 v10, 6400
    s_mov_b64 exec, 1
    s_cmp_eq_u32 s31, 0
    s_cbranch_scc1 k2_kernel_slow34
    buffer_store_dword v9, v10, s[12:15], s49 offen
    s_branch k2_kernel_sent35
k2_kernel_slow34:
    buffer_store_dword v9, v10, s[12:15], s49 offen sc1
k2_kernel_sent35:
    s_mov_b64 exec, -1
    buffer_load_dwordx4 v[192:195], v2, s[12:15], s40 offen offset:0
    buffer_load_dwordx4 v[196:199], v2, s[12:15], s40 offen offset:1024
    buffer_load_dwordx4 v[200:203], v2, s[12:15], s40 offen offset:2048
    buffer_load_dwordx4 v[204:207], v2, s[12:15], s40 offen offset:3072
    s_add_u32 s40, s40, 4096
    buffer_load_dwordx4 v[208:211], v2, s[12:15], s40 offen offset:0
    buffer_load_dwordx4 v[212:215], v2, s[12:15], s40 offen offset:1024
    s_and_b32 s41, s32, 1
    s_lshl_b32 s41, s41, 1
    s_lshl_b32 s49, s34, 2
    s_add_u32 s49, s49, s41
    s_lshl_b32 s49, s49, 7
    s_add_u32 s49, s49, s37
    s_lshl_b32 s41, s30, 4
    s_add_u32 s49, s49, s41
    s_add_u32 s49, s49, 6400
    v_bfe_u32 v7, v1, 2, 1
    v_lshlrev_b32 v7, 7, v7
    v_and_b32 v9, 3, v1
    v_lshl_add_u32 v7, v9, 2, v7
    s_add_u32 s41, s30, 0
    s_and_b32 s41, s41, 3
    s_lshl_b32 s46, s32, 2
    s_add_u32 s41, s41, s46
    s_mul_i32 s41, s41, 55296
    s_mul_i32 s46, s30, 14336
    s_add_u32 s41, s41, s46
    s_add_u32 s41, s41, s36
    s_add_u32 s50, s41, 696320
    s_add_u32 s41, s30, 1
    s_and_b32 s41, s41, 3
    s_lshl_b32 s46, s32, 2
    s_add_u32 s41, s41, s46
    s_mul_i32 s41, s41, 55296
    s_mul_i32 s46, s30, 14336
    s_add_u32 s41, s41, s46
    s_add_u32 s41, s41, s36
    s_add_u32 s51, s41, 696320
    s_add_u32 s41, s30, 2
    s_and_b32 s41, s41, 3
    s_lshl_b32 s46, s32, 2
    s_add_u32 s41, s41, s46
    s_mul_i32 s41, s41, 55296
    s_mul_i32 s46, s30, 14336
    s_add_u32 s41, s41, s46
    s_add_u32 s41, s41, s36
    s_add_u32 s52, s41, 696320
    s_add_u32 s41, s30, 3
    s_and_b32 s41, s41, 3
    s_lshl_b32 s46, s32, 2
    s_add_u32 s41, s41, s46
    s_mul_i32 s41, s41, 55296
    s_mul_i32 s46, s30, 14336
    s_add_u32 s41, s41, s46
    s_add_u32 s41, s41, s36
    s_add_u32 s53, s41, 696320
    s_mov_b32 s43, 200000
k2_kernel_poll36:
    buffer_load_dword v9, v7, s[12:15], s49 offen sc1
    s_waitcnt vmcnt(0)
    v_cmp_ne_u32 vcc, 0, v9
    s_sub_u32 s43, s43, 1
    s_cmp_eq_u64 vcc, -1
    s_cbranch_scc1 k2_kernel_go37
    s_cmp_lg_u32 s43, 0
    s_cbranch_scc1 k2_kernel_poll36
k2_kernel_go37:
    s_add_u32 s41, s50, 0
    buffer_load_dwordx4 v[96:99], v2, s[12:15], s41 offen offset:0 sc1
    s_add_u32 s41, s51, 0
    buffer_load_dwordx4 v[100:103], v2, s[12:15], s41 offen offset:0 sc1
    s_add_u32 s41, s52, 0
    buffer_load_dwordx4 v[104:107], v2, s[12:15], s41 offen offset:0 sc1
    s_add_u32 s41, s53, 0
    buffer_load_dwordx4 v[108:111], v2, s[12:15], s41 offen offset:0 sc1
    s_add_u32 s41, s50, 0
    buffer_load_dwordx4 v[112:115], v2, s[12:15], s41 offen offset:1024 sc1
    s_add_u32 s41, s51, 0
    buffer_load_dwordx4 v[116:119], v2, s[12:15], s41 offen offset:1024 sc1
    s_add_u32 s41, s52, 0
    buffer_load_dwordx4 v[120:123], v2, s[12:15], s41 offen offset:1024 sc1
    s_add_u32 s41, s53, 0
    buffer_load_dwordx4 v[124:127], v2, s[12:15], s41 offen offset:1024 sc1
    s_waitcnt vmcnt(4)
    v_mfma_f32_16x16x32_bf16 v[16:19], a[0:3], v[96:99], 0
    v_mfma_f32_16x16x32_bf16 v[36:39], a[0:3], v[100:103], 0
    v_mfma_f32_16x16x32_bf16 v[56:59], a[0:3], v[104:107], 0
    v_mfma_f32_16x16x32_bf16 v[76:79], a[0:3], v[108:111], 0
    s_add_u32 s41, s50, 0
    buffer_load_dwordx4 v[128:131], v2, s[12:15], s41 offen offset:2048 sc1
    v_mfma_f32_16x16x32_bf16 v[20:23], a[4:7], v[96:99], 0
    v_mfma_f32_16x16x32_bf16 v[40:43], a[4:7], v[100:103], 0
    v_mfma_f32_16x16x32_bf16 v[60:63], a[4:7], v[104:107], 0
    v_mfma_f32_16x16x32_bf16 v[80:83], a[4:7], v[108:111], 0
    s_add_u32 s41, s51, 0
    buffer_load_dwordx4 v[132:135], v2, s[12:15], s41 offen offset:2048 sc1
    s_add_u32 s41, s52, 0
    buffer_load_dwordx4 v[136:139], v2, s[12:15], s41 offen offset:2048 sc1
    v_mfma_f32_16x16x32_bf16 v[24:27], a[8:11], v[96:99], 0
    v_mfma_f32_16x16x32_bf16 v[44:47], a[8:11], v[100:103], 0
    v_mfma_f32_16x16x32_bf16 v[64:67], a[8:11], v[104:107], 0
    v_mfma_f32_16x16x32_bf16 v[84:87], a[8:11], v[108:111], 0
    s_add_u32 s41, s53, 0
    buffer_load_dwordx4 v[140:143], v2, s[12:15], s41 offen offset:2048 sc1
    v_mfma_f32_16x16x32_bf16 v[28:31], a[12:15], v[96:99], 0
    v_mfma_f32_16x16x32_bf16 v[48:51], a[12:15], v[100:103], 0
    v_mfma_f32_16x16x32_bf16 v[68:71], a[12:15], v[104:107], 0
    v_mfma_f32_16x16x32_bf16 v[88:91], a[12:15], v[108:111], 0
    s_add_u32 s41, s50, 0
    buffer_load_dwordx4 v[144:147], v2, s[12:15], s41 offen offset:3072 sc1
    s_add_u32 s41, s51, 0
    buffer_load_dwordx4 v[148:151], v2, s[12:15], s41 offen offset:3072 sc1
    v_mfma_f32_16x16x32_bf16 v[32:35], a[16:19], v[96:99], 0
    v_mfma_f32_16x16x32_bf16 v[52:55], a[16:19], v[100:103], 0
    v_mfma_f32_16x16x32_bf16 v[72:75], a[16:19], v[104:107], 0
    v_mfma_f32_16x16x32_bf16 v[92:95], a[16:19], v[108:111], 0
    s_add_u32 s41, s52, 0
    buffer_load_dwordx4 v[152:155], v2, s[12:15], s41 offen offset:3072 sc1
    s_waitcnt vmcnt(7)
    v_mfma_f32_16x16x32_bf16 v[16:19], a[20:23], v[112:115], v[16:19]
    v_mfma_f32_16x16x32_bf16 v[36:39], a[20:23], v[116:119], v[36:39]
    v_mfma_f32_16x16x32_bf16 v[56:59], a[20:23], v[120:123], v[56:59]
    v_mfma_f32_16x16x32_bf16 v[76:79], a[20:23], v[124:127], v[76:79]
    s_add_u32 s41, s53, 0
    buffer_load_dwordx4 v[156:159], v2, s[12:15], s41 offen offset:3072 sc1
    v_mfma_f32_16x16x32_bf16 v[20:23], a[24:27], v[112:115], v[20:23]
    v_mfma_f32_16x16x32_bf16 v[40:43], a[24:27], v[116:119], v[40:43]
    v_mfma_f32_16x16x32_bf16 v[60:63], a[24:27], v[120:123], v[60:63]
    v_mfma_f32_16x16x32_bf16 v[80:83], a[24:27], v[124:127], v[80:83]
    s_add_u32 s41, s50, 4096
    buffer_load_dwordx4 v[160:163], v2, s[12:15], s41 offen offset:0 sc1
    s_add_u32 s41, s51, 4096
    buffer_load_dwordx4 v[164:167], v2, s[12:15], s41 offen offset:0 sc1
    v_mfma_f32_16x16x32_bf16 v[24:27], a[28:31], v[112:115], v[24:27]
    v_mfma_f32_16x16x32_bf16 v[44:47], a[28:31], v[116:119], v[44:47]
    v_mfma_f32_16x16x32_bf16 v[64:67], a[28:31], v[120:123], v[64:67]
    v_mfma_f32_16x16x32_bf16 v[84:87], a[28:31], v[124:127], v[84:87]
    s_add_u32 s41, s52, 4096
    buffer_load_dwordx4 v[168:171], v2, s[12:15], s41 offen offset:0 sc1
    v_mfma_f32_16x16x32_bf16 v[28:31], a[32:35], v[112:115], v[28:31]
    v_mfma_f32_16x16x32_bf16 v[48:51], a[32:35], v[116:119], v[48:51]
    v_mfma_f32_16x16x32_bf16 v[68:71], a[32:35], v[120:123], v[68:71]
    v_mfma_f32_16x16x32_bf16 v[88:91], a[32:35], v[124:127], v[88:91]
    s_add_u32 s41, s53, 4096
    buffer_load_dwordx4 v[172:175], v2, s[12:15], s41 offen offset:0 sc1
    s_add_u32 s41, s50, 4096
    buffer_load_dwordx4 v[176:179], v2, s[12:15], s41 offen offset:1024 sc1
    v_mfma_f32_16x16x32_bf16 v[32:35], a[36:39], v[112:115], v[32:35]
    v_mfma_f32_16x16x32_bf16 v[52:55], a[36:39], v[116:119], v[52:55]
    v_mfma_f32_16x16x32_bf16 v[72:75], a[36:39], v[120:123], v[72:75]
    v_mfma_f32_16x16x32_bf16 v[92:95], a[36:39], v[124:127], v[92:95]
    s_add_u32 s41, s51, 4096
    buffer_load_dwordx4 v[180:183], v2, s[12:15], s41 offen offset:1024 sc1
    s_waitcnt vmcnt(10)
    v_mfma_f32_16x16x32_bf16 v[16:19], a[40:43], v[128:131], v[16:19]
    v_mfma_f32_16x16x32_bf16 v[36:39], a[40:43], v[132:135], v[36:39]
    v_mfma_f32_16x16x32_bf16 v[56:59], a[40:43], v[136:139], v[56:59]
    v_mfma_f32_16x16x32_bf16 v[76:79], a[40:43], v[140:143], v[76:79]
    s_add_u32 s41, s52, 4096
    buffer_load_dwordx4 v[184:187], v2, s[12:15], s41 offen offset:1024 sc1
    v_mfma_f32_16x16x32_bf16 v[20:23], a[44:47], v[128:131], v[20:23]
    v_mfma_f32_16x16x32_bf16 v[40:43], a[44:47], v[132:135], v[40:43]
    v_mfma_f32_16x16x32_bf16 v[60:63], a[44:47], v[136:139], v[60:63]
    v_mfma_f32_16x16x32_bf16 v[80:83], a[44:47], v[140:143], v[80:83]
    s_add_u32 s41, s53, 4096
    buffer_load_dwordx4 v[188:191], v2, s[12:15], s41 offen offset:1024 sc1
    s_add_u32 s41, s50, 4096
    buffer_load_dwordx4 v[96:99], v2, s[12:15], s41 offen offset:2048 sc1
    v_mfma_f32_16x16x32_bf16 v[24:27], a[48:51], v[128:131], v[24:27]
    v_mfma_f32_16x16x32_bf16 v[44:47], a[48:51], v[132:135], v[44:47]
    v_mfma_f32_16x16x32_bf16 v[64:67], a[48:51], v[136:139], v[64:67]
    v_mfma_f32_16x16x32_bf16 v[84:87], a[48:51], v[140:143], v[84:87]
    s_add_u32 s41, s51, 4096
    buffer_load_dwordx4 v[100:103], v2, s[12:15], s41 offen offset:2048 sc1
    v_mfma_f32_16x16x32_bf16 v[28:31], a[52:55], v[128:131], v[28:31]
    v_mfma_f32_16x16x32_bf16 v[48:51], a[52:55], v[132:135], v[48:51]
    v_mfma_f32_16x16x32_bf16 v[68:71], a[52:55], v[136:139], v[68:71]
    v_mfma_f32_16x16x32_bf16 v[88:91], a[52:55], v[140:143], v[88:91]
    s_add_u32 s41, s52, 4096
    buffer_load_dwordx4 v[104:107], v2, s[12:15], s41 offen offset:2048 sc1
    v_mfma_f32_16x16x32_bf16 v[32:35], a[56:59], v[128:131], v[32:35]
    v_mfma_f32_16x16x32_bf16 v[52:55], a[56:59], v[132:135], v[52:55]
    v_mfma_f32_16x16x32_bf16 v[72:75], a[56:59], v[136:139], v[72:75]
    v_mfma_f32_16x16x32_bf16 v[92:95], a[56:59], v[140:143], v[92:95]
    s_add_u32 s41, s53, 4096
    buffer_load_dwordx4 v[108:111], v2, s[12:15], s41 offen offset:2048 sc1
    s_waitcnt vmcnt(12)
    v_mfma_f32_16x16x32_bf16 v[16:19], a[60:63], v[144:147], v[16:19]
    v_mfma_f32_16x16x32_bf16 v[36:39], a[60:63], v[148:151], v[36:39]
    v_mfma_f32_16x16x32_bf16 v[56:59], a[60:63], v[152:155], v[56:59]
    v_mfma_f32_16x16x32_bf16 v[76:79], a[60:63], v[156:159], v[76:79]
    s_add_u32 s41, s50, 4096
    buffer_load_dwordx4 v[112:115], v2, s[12:15], s41 offen offset:3072 sc1
    v_mfma_f32_16x16x32_bf16 v[20:23], a[64:67], v[144:147], v[20:23]
    v_mfma_f32_16x16x32_bf16 v[40:43], a[64:67], v[148:151], v[40:43]
    v_mfma_f32_16x16x32_bf16 v[60:63], a[64:67], v[152:155], v[60:63]
    v_mfma_f32_16x16x32_bf16 v[80:83], a[64:67], v[156:159], v[80:83]
    s_add_u32 s41, s51, 4096
    buffer_load_dwordx4 v[116:119], v2, s[12:15], s41 offen offset:3072 sc1
    v_mfma_f32_16x16x32_bf16 v[24:27], a[68:71], v[144:147], v[24:27]
    v_mfma_f32_16x16x32_bf16 v[44:47], a[68:71], v[148:151], v[44:47]
    v_mfma_f32_16x16x32_bf16 v[64:67], a[68:71], v[152:155], v[64:67]
    v_mfma_f32_16x16x32_bf16 v[84:87], a[68:71], v[156:159], v[84:87]
    s_add_u32 s41, s52, 4096
    buffer_load_dwordx4 v[120:123], v2, s[12:15], s41 offen offset:3072 sc1
    v_mfma_f32_16x16x32_bf16 v[28:31], a[72:75], v[144:147], v[28:31]
    v_mfma_f32_16x16x32_bf16 v[48:51], a[72:75], v[148:151], v[48:51]
    v_mfma_f32_16x16x32_bf16 v[68:71], a[72:75], v[152:155], v[68:71]
    v_mfma_f32_16x16x32_bf16 v[88:91], a[72:75], v[156:159], v[88:91]
    s_add_u32 s41, s53, 4096
    buffer_load_dwordx4 v[124:127], v2, s[12:15], s41 offen offset:3072 sc1
    v_mfma_f32_16x16x32_bf16 v[32:35], a[76:79], v[144:147], v[32:35]
    v_mfma_f32_16x16x32_bf16 v[52:55], a[76:79], v[148:151], v[52:55]
    v_mfma_f32_16x16x32_bf16 v[72:75], a[76:79], v[152:155], v[72:75]
    v_mfma_f32_16x16x32_bf16 v[92:95], a[76:79], v[156:159], v[92:95]
    s_add_u32 s41, s50, 8192
    buffer_load_dwordx4 v[128:131], v2, s[12:15], s41 offen offset:0 sc1
    s_waitcnt vmcnt(13)
    v_mfma_f32_16x16x32_bf16 v[16:19], a[80:83], v[160:163], v[16:19]
    v_mfma_f32_16x16x32_bf16 v[36:39], a[80:83], v[164:167], v[36:39]
    v_mfma_f32_16x16x32_bf16 v[56:59], a[80:83], v[168:171], v[56:59]
    v_mfma_f32_16x16x32_bf16 v[76:79], a[80:83], v[172:175], v[76:79]
    s_add_u32 s41, s51, 8192
    buffer_load_dwordx4 v[132:135], v2, s[12:15], s41 offen offset:0 sc1
    v_mfma_f32_16x16x32_bf16 v[20:23], a[84:87], v[160:163], v[20:23]
    v_mfma_f32_16x16x32_bf16 v[40:43], a[84:87], v[164:167], v[40:43]
    v_mfma_f32_16x16x32_bf16 v[60:63], a[84:87], v[168:171], v[60:63]
    v_mfma_f32_16x16x32_bf16 v[80:83], a[84:87], v[172:175], v[80:83]
    s_add_u32 s41, s52, 8192
    buffer_load_dwordx4 v[136:139], v2, s[12:15], s41 offen offset:0 sc1
    v_mfma_f32_16x16x32_bf16 v[24:27], a[88:91], v[160:163], v[24:27]
    v_mfma_f32_16x16x32_bf16 v[44:47], a[88:91], v[164:167], v[44:47]
    v_mfma_f32_16x16x32_bf16 v[64:67], a[88:91], v[168:171], v[64:67]
    v_mfma_f32_16x16x32_bf16 v[84:87], a[88:91], v[172:175], v[84:87]
    s_add_u32 s41, s53, 8192
    buffer_load_dwordx4 v[140:143], v2, s[12:15], s41 offen offset:0 sc1
    v_mfma_f32_16x16x32_bf16 v[28:31], a[92:95], v[160:163], v[28:31]
    v_mfma_f32_16x16x32_bf16 v[48:51], a[92:95], v[164:167], v[48:51]
    v_mfma_f32_16x16x32_bf16 v[68:71], a[92:95], v[168:171], v[68:71]
    v_mfma_f32_16x16x32_bf16 v[88:91], a[92:95], v[172:175], v[88:91]
    s_add_u32 s41, s50, 8192
    buffer_load_dwordx4 v[144:147], v2, s[12:15], s41 offen offset:1024 sc1
    v_mfma_f32_16x16x32_bf16 v[32:35], a[96:99], v[160:163], v[32:35]
    v_mfma_f32_16x16x32_bf16 v[52:55], a[96:99], v[164:167], v[52:55]
    v_mfma_f32_16x16x32_bf16 v[72:75], a[96:99], v[168:171], v[72:75]
    v_mfma_f32_16x16x32_bf16 v[92:95], a[96:99], v[172:175], v[92:95]
    s_add_u32 s41, s51, 8192
    buffer_load_dwordx4 v[148:151], v2, s[12:15], s41 offen offset:1024 sc1
    s_waitcnt vmcnt(14)
    v_mfma_f32_16x16x32_bf16 v[16:19], a[100:103], v[176:179], v[16:19]
    v_mfma_f32_16x16x32_bf16 v[36:39], a[100:103], v[180:183], v[36:39]
    v_mfma_f32_16x16x32_bf16 v[56:59], a[100:103], v[184:187], v[56:59]
    v_mfma_f32_16x16x32_bf16 v[76:79], a[100:103], v[188:191], v[76:79]
    s_add_u32 s41, s52, 8192
    buffer_load_dwordx4 v[152:155], v2, s[12:15], s41 offen offset:1024 sc1
    v_mfma_f32_16x16x32_bf16 v[20:23], a[104:107], v[176:179], v[20:23]
    v_mfma_f32_16x16x32_bf16 v[40:43], a[104:107], v[180:183], v[40:43]
    v_mfma_f32_16x16x32_bf16 v[60:63], a[104:107], v[184:187], v[60:63]
    v_mfma_f32_16x16x32_bf16 v[80:83], a[104:107], v[188:191], v[80:83]
    s_add_u32 s41, s53, 8192
    buffer_load_dwordx4 v[156:159], v2, s[12:15], s41 offen offset:1024 sc1
    v_mfma_f32_16x16x32_bf16 v[24:27], a[108:111], v[176:179], v[24:27]
    v_mfma_f32_16x16x32_bf16 v[44:47], a[108:111], v[180:183], v[44:47]
    v_mfma_f32_16x16x32_bf16 v[64:67], a[108:111], v[184:187], v[64:67]
    v_mfma_f32_16x16x32_bf16 v[84:87], a[108:111], v[188:191], v[84:87]
    s_add_u32 s41, s50, 8192
    buffer_load_dwordx4 v[160:163], v2, s[12:15], s41 offen offset:2048 sc1
    v_mfma_f32_16x16x32_bf16 v[28:31], a[112:115], v[176:179], v[28:31]
    v_mfma_f32_16x16x32_bf16 v[48:51], a[112:115], v[180:183], v[48:51]
    v_mfma_f32_16x16x32_bf16 v[68:71], a[112:115], v[184:187], v[68:71]
    v_mfma_f32_16x16x32_bf16 v[88:91], a[112:115], v[188:191], v[88:91]
    s_add_u32 s41, s51, 8192
    buffer_load_dwordx4 v[164:167], v2, s[12:15], s41 offen offset:2048 sc1
    v_mfma_f32_16x16x32_bf16 v[32:35], a[116:119], v[176:179], v[32:35]
    v_mfma_f32_16x16x32_bf16 v[52:55], a[116:119], v[180:183], v[52:55]
    v_mfma_f32_16x16x32_bf16 v[72:75], a[116:119], v[184:187], v[72:75]
    v_mfma_f32_16x16x32_bf16 v[92:95], a[116:119], v[188:191], v[92:95]
    s_add_u32 s41, s52, 8192
    buffer_load_dwordx4 v[168:171], v2, s[12:15], s41 offen offset:2048 sc1
    s_waitcnt vmcnt(15)
    v_mfma_f32_16x16x32_bf16 v[16:19], a[120:123], v[96:99], v[16:19]
    v_mfma_f32_16x16x32_bf16 v[36:39], a[120:123], v[100:103], v[36:39]
    v_mfma_f32_16x16x32_bf16 v[56:59], a[120:123], v[104:107], v[56:59]
    v_mfma_f32_16x16x32_bf16 v[76:79], a[120:123], v[108:111], v[76:79]
    s_add_u32 s41, s53, 8192
    buffer_load_dwordx4 v[172:175], v2, s[12:15], s41 offen offset:2048 sc1
    v_mfma_f32_16x16x32_bf16 v[20:23], a[124:127], v[96:99], v[20:23]
    v_mfma_f32_16x16x32_bf16 v[40:43], a[124:127], v[100:103], v[40:43]
    v_mfma_f32_16x16x32_bf16 v[60:63], a[124:127], v[104:107], v[60:63]
    v_mfma_f32_16x16x32_bf16 v[80:83], a[124:127], v[108:111], v[80:83]
    s_add_u32 s41, s50, 8192
    buffer_load_dwordx4 v[176:179], v2, s[12:15], s41 offen offset:3072 sc1
    v_mfma_f32_16x16x32_bf16 v[24:27], a[128:131], v[96:99], v[24:27]
    v_mfma_f32_16x16x32_bf16 v[44:47], a[128:131], v[100:103], v[44:47]
    v_mfma_f32_16x16x32_bf16 v[64:67], a[128:131], v[104:107], v[64:67]
    v_mfma_f32_16x16x32_bf16 v[84:87], a[128:131], v[108:111], v[84:87]
    s_add_u32 s41, s51, 8192
    buffer_load_dwordx4 v[180:183], v2, s[12:15], s41 offen offset:3072 sc1
    v_mfma_f32_16x16x32_bf16 v[28:31], a[132:135], v[96:99], v[28:31]
    v_mfma_f32_16x16x32_bf16 v[48:51], a[132:135], v[100:103], v[48:51]
    v_mfma_f32_16x16x32_bf16 v[68:71], a[132:135], v[104:107], v[68:71]
    v_mfma_f32_16x16x32_bf16 v[88:91], a[132:135], v[108:111], v[88:91]
    s_add_u32 s41, s52, 8192
    buffer_load_dwordx4 v[184:187], v2, s[12:15], s41 offen offset:3072 sc1
    v_mfma_f32_16x16x32_bf16 v[32:35], a[136:139], v[96:99], v[32:35]
    v_mfma_f32_16x16x32_bf16 v[52:55], a[136:139], v[100:103], v[52:55]
    v_mfma_f32_16x16x32_bf16 v[72:75], a[136:139], v[104:107], v[72:75]
    v_mfma_f32_16x16x32_bf16 v[92:95], a[136:139], v[108:111], v[92:95]
    s_add_u32 s41, s53, 8192
    buffer_load_dwordx4 v[188:191], v2, s[12:15], s41 offen offset:3072 sc1
    s_waitcnt vmcnt(16)
    v_mfma_f32_16x16x32_bf16 v[16:19], a[140:143], v[112:115], v[16:19]
    v_mfma_f32_16x16x32_bf16 v[36:39], a[140:143], v[116:119], v[36:39]
    v_mfma_f32_16x16x32_bf16 v[56:59], a[140:143], v[120:123], v[56:59]
    v_mfma_f32_16x16x32_bf16 v[76:79], a[140:143], v[124:127], v[76:79]
    v_mfma_f32_16x16x32_bf16 v[20:23], a[144:147], v[112:115], v[20:23]
    v_mfma_f32_16x16x32_bf16 v[40:43], a[144:147], v[116:119], v[40:43]
    v_mfma_f32_16x16x32_bf16 v[60:63], a[144:147], v[120:123], v[60:63]
    v_mfma_f32_16x16x32_bf16 v[80:83], a[144:147], v[124:127], v[80:83]
    s_add_u32 s41, s50, 12288
    buffer_load_dwordx4 v[96:99], v2, s[12:15], s41 offen offset:0 sc1
    v_mfma_f32_16x16x32_bf16 v[24:27], a[148:151], v[112:115], v[24:27]
    v_mfma_f32_16x16x32_bf16 v[44:47], a[148:151], v[116:119], v[44:47]
    v_mfma_f32_16x16x32_bf16 v[64:67], a[148:151], v[120:123], v[64:67]
    v_mfma_f32_16x16x32_bf16 v[84:87], a[148:151], v[124:127], v[84:87]
    s_add_u32 s41, s51, 12288
    buffer_load_dwordx4 v[100:103], v2, s[12:15], s41 offen offset:0 sc1
    v_mfma_f32_16x16x32_bf16 v[28:31], a[152:155], v[112:115], v[28:31]
    v_mfma_f32_16x16x32_bf16 v[48:51], a[152:155], v[116:119], v[48:51]
    v_mfma_f32_16x16x32_bf16 v[68:71], a[152:155], v[120:123], v[68:71]
    v_mfma_f32_16x16x32_bf16 v[88:91], a[152:155], v[124:127], v[88:91]
    s_add_u32 s41, s52, 12288
    buffer_load_dwordx4 v[104:107], v2, s[12:15], s41 offen offset:0 sc1
    v_mfma_f32_16x16x32_bf16 v[32:35], a[156:159], v[112:115], v[32:35]
    v_mfma_f32_16x16x32_bf16 v[52:55], a[156:159], v[116:119], v[52:55]
    v_mfma_f32_16x16x32_bf16 v[72:75], a[156:159], v[120:123], v[72:75]
    v_mfma_f32_16x16x32_bf16 v[92:95], a[156:159], v[124:127], v[92:95]
    s_add_u32 s41, s53, 12288
    buffer_load_dwordx4 v[108:111], v2, s[12:15], s41 offen offset:0 sc1
    s_waitcnt vmcnt(16)
    v_mfma_f32_16x16x32_bf16 v[16:19], a[160:163], v[128:131], v[16:19]
    v_mfma_f32_16x16x32_bf16 v[36:39], a[160:163], v[132:135], v[36:39]
    v_mfma_f32_16x16x32_bf16 v[56:59], a[160:163], v[136:139], v[56:59]
    v_mfma_f32_16x16x32_bf16 v[76:79], a[160:163], v[140:143], v[76:79]
    v_mfma_f32_16x16x32_bf16 v[20:23], a[164:167], v[128:131], v[20:23]
    v_mfma_f32_16x16x32_bf16 v[40:43], a[164:167], v[132:135], v[40:43]
    v_mfma_f32_16x16x32_bf16 v[60:63], a[164:167], v[136:139], v[60:63]
    v_mfma_f32_16x16x32_bf16 v[80:83], a[164:167], v[140:143], v[80:83]
    s_add_u32 s41, s50, 12288
    buffer_load_dwordx4 v[112:115], v2, s[12:15], s41 offen offset:1024 sc1
    v_mfma_f32_16x16x32_bf16 v[24:27], a[168:171], v[128:131], v[24:27]
    v_mfma_f32_16x16x32_bf16 v[44:47], a[168:171], v[132:135], v[44:47]
    v_mfma_f32_16x16x32_bf16 v[64:67], a[168:171], v[136:139], v[64:67]
    v_mfma_f32_16x16x32_bf16 v[84:87], a[168:171], v[140:143], v[84:87]
    s_add_u32 s41, s51, 12288
    buffer_load_dwordx4 v[116:119], v2, s[12:15], s41 offen offset:1024 sc1
    v_mfma_f32_16x16x32_bf16 v[28:31], a[172:175], v[128:131], v[28:31]
    v_mfma_f32_16x16x32_bf16 v[48:51], a[172:175], v[132:135], v[48:51]
    v_mfma_f32_16x16x32_bf16 v[68:71], a[172:175], v[136:139], v[68:71]
    v_mfma_f32_16x16x32_bf16 v[88:91], a[172:175], v[140:143], v[88:91]
    s_add_u32 s41, s52, 12288
    buffer_load_dwordx4 v[120:123], v2, s[12:15], s41 offen offset:1024 sc1
    v_mfma_f32_16x16x32_bf16 v[32:35], a[176:179], v[128:131], v[32:35]
    v_mfma_f32_16x16x32_bf16 v[52:55], a[176:179], v[132:135], v[52:55]
    v_mfma_f32_16x16x32_bf16 v[72:75], a[176:179], v[136:139], v[72:75]
    v_mfma_f32_16x16x32_bf16 v[92:95], a[176:179], v[140:143], v[92:95]
    s_add_u32 s41, s53, 12288
    buffer_load_dwordx4 v[124:127], v2, s[12:15], s41 offen offset:1024 sc1
    s_waitcnt vmcnt(16)
    v_mfma_f32_16x16x32_bf16 v[16:19], a[180:183], v[144:147], v[16:19]
    v_mfma_f32_16x16x32_bf16 v[36:39], a[180:183], v[148:151], v[36:39]
    v_mfma_f32_16x16x32_bf16 v[56:59], a[180:183], v[152:155], v[56:59]
    v_mfma_f32_16x16x32_bf16 v[76:79], a[180:183], v[156:159], v[76:79]
    v_mfma_f32_16x16x32_bf16 v[20:23], a[184:187], v[144:147], v[20:23]
    v_mfma_f32_16x16x32_bf16 v[40:43], a[184:187], v[148:151], v[40:43]
    v_mfma_f32_16x16x32_bf16 v[60:63], a[184:187], v[152:155], v[60:63]
    v_mfma_f32_16x16x32_bf16 v[80:83], a[184:187], v[156:159], v[80:83]
    v_mfma_f32_16x16x32_bf16 v[24:27], a[188:191], v[144:147], v[24:27]
    v_mfma_f32_16x16x32_bf16 v[44:47], a[188:191], v[148:151], v[44:47]
    v_mfma_f32_16x16x32_bf16 v[64:67], a[188:191], v[152:155], v[64:67]
    v_mfma_f32_16x16x32_bf16 v[84:87], a[188:191], v[156:159], v[84:87]
    v_mfma_f32_16x16x32_bf16 v[28:31], a[192:195], v[144:147], v[28:31]
    v_mfma_f32_16x16x32_bf16 v[48:51], a[192:195], v[148:151], v[48:51]
    v_mfma_f32_16x16x32_bf16 v[68:71], a[192:195], v[152:155], v[68:71]
    v_mfma_f32_16x16x32_bf16 v[88:91], a[192:195], v[156:159], v[88:91]
    v_mfma_f32_16x16x32_bf16 v[32:35], a[196:199], v[144:147], v[32:35]
    v_mfma_f32_16x16x32_bf16 v[52:55], a[196:199], v[148:151], v[52:55]
    v_mfma_f32_16x16x32_bf16 v[72:75], a[196:199], v[152:155], v[72:75]
    v_mfma_f32_16x16x32_bf16 v[92:95], a[196:199], v[156:159], v[92:95]
    s_waitcnt vmcnt(12)
    v_mfma_f32_16x16x32_bf16 v[16:19], a[200:203], v[160:163], v[16:19]
    v_mfma_f32_16x16x32_bf16 v[36:39], a[200:203], v[164:167], v[36:39]
    v_mfma_f32_16x16x32_bf16 v[56:59], a[200:203], v[168:171], v[56:59]
    v_mfma_f32_16x16x32_bf16 v[76:79], a[200:203], v[172:175], v[76:79]
    v_mfma_f32_16x16x32_bf16 v[20:23], a[204:207], v[160:163], v[20:23]
    v_mfma_f32_16x16x32_bf16 v[40:43], a[204:207], v[164:167], v[40:43]
    v_mfma_f32_16x16x32_bf16 v[60:63], a[204:207], v[168:171], v[60:63]
    v_mfma_f32_16x16x32_bf16 v[80:83], a[204:207], v[172:175], v[80:83]
    v_mfma_f32_16x16x32_bf16 v[24:27], a[208:211], v[160:163], v[24:27]
    v_mfma_f32_16x16x32_bf16 v[44:47], a[208:211], v[164:167], v[44:47]
    v_mfma_f32_16x16x32_bf16 v[64:67], a[208:211], v[168:171], v[64:67]
    v_mfma_f32_16x16x32_bf16 v[84:87], a[208:211], v[172:175], v[84:87]
    v_mfma_f32_16x16x32_bf16 v[28:31], a[212:215], v[160:163], v[28:31]
    v_mfma_f32_16x16x32_bf16 v[48:51], a[212:215], v[164:167], v[48:51]
    v_mfma_f32_16x16x32_bf16 v[68:71], a[212:215], v[168:171], v[68:71]
    v_mfma_f32_16x16x32_bf16 v[88:91], a[212:215], v[172:175], v[88:91]
    v_mfma_f32_16x16x32_bf16 v[32:35], a[216:219], v[160:163], v[32:35]
    v_mfma_f32_16x16x32_bf16 v[52:55], a[216:219], v[164:167], v[52:55]
    v_mfma_f32_16x16x32_bf16 v[72:75], a[216:219], v[168:171], v[72:75]
    v_mfma_f32_16x16x32_bf16 v[92:95], a[216:219], v[172:175], v[92:95]
    s_waitcnt vmcnt(8)
    v_mfma_f32_16x16x32_bf16 v[16:19], a[220:223], v[176:179], v[16:19]
    v_mfma_f32_16x16x32_bf16 v[36:39], a[220:223], v[180:183], v[36:39]
    v_mfma_f32_16x16x32_bf16 v[56:59], a[220:223], v[184:187], v[56:59]
    v_mfma_f32_16x16x32_bf16 v[76:79], a[220:223], v[188:191], v[76:79]
    v_mfma_f32_16x16x32_bf16 v[20:23], a[224:227], v[176:179], v[20:23]
    v_mfma_f32_16x16x32_bf16 v[40:43], a[224:227], v[180:183], v[40:43]
    v_mfma_f32_16x16x32_bf16 v[60:63], a[224:227], v[184:187], v[60:63]
    v_mfma_f32_16x16x32_bf16 v[80:83], a[224:227], v[188:191], v[80:83]
    v_mfma_f32_16x16x32_bf16 v[24:27], a[228:231], v[176:179], v[24:27]
    v_mfma_f32_16x16x32_bf16 v[44:47], a[228:231], v[180:183], v[44:47]
    v_mfma_f32_16x16x32_bf16 v[64:67], a[228:231], v[184:187], v[64:67]
    v_mfma_f32_16x16x32_bf16 v[84:87], a[228:231], v[188:191], v[84:87]
    v_mfma_f32_16x16x32_bf16 v[28:31], a[232:235], v[176:179], v[28:31]
    v_mfma_f32_16x16x32_bf16 v[48:51], a[232:235], v[180:183], v[48:51]
    v_mfma_f32_16x16x32_bf16 v[68:71], a[232:235], v[184:187], v[68:71]
    v_mfma_f32_16x16x32_bf16 v[88:91], a[232:235], v[188:191], v[88:91]
    v_mfma_f32_16x16x32_bf16 v[32:35], a[236:239], v[176:179], v[32:35]
    v_mfma_f32_16x16x32_bf16 v[52:55], a[236:239], v[180:183], v[52:55]
    v_mfma_f32_16x16x32_bf16 v[72:75], a[236:239], v[184:187], v[72:75]
    v_mfma_f32_16x16x32_bf16 v[92:95], a[236:239], v[188:191], v[92:95]
    s_cmp_eq_u32 s30, 3
    s_cbranch_scc1 k2_kernel_k4skip38
    s_waitcnt vmcnt(4)
    v_mfma_f32_16x16x32_bf16 v[16:19], a[240:243], v[96:99], v[16:19]
    v_mfma_f32_16x16x32_bf16 v[36:39], a[240:243], v[100:103], v[36:39]
    v_mfma_f32_16x16x32_bf16 v[56:59], a[240:243], v[104:107], v[56:59]
    v_mfma_f32_16x16x32_bf16 v[76:79], a[240:243], v[108:111], v[76:79]
    v_mfma_f32_16x16x32_bf16 v[20:23], a[244:247], v[96:99], v[20:23]
    v_mfma_f32_16x16x32_bf16 v[40:43], a[244:247], v[100:103], v[40:43]
    v_mfma_f32_16x16x32_bf16 v[60:63], a[244:247], v[104:107], v[60:63]
    v_mfma_f32_16x16x32_bf16 v[80:83], a[244:247], v[108:111], v[80:83]
    v_mfma_f32_16x16x32_bf16 v[24:27], a[248:251], v[96:99], v[24:27]
    v_mfma_f32_16x16x32_bf16 v[44:47], a[248:251], v[100:103], v[44:47]
    v_mfma_f32_16x16x32_bf16 v[64:67], a[248:251], v[104:107], v[64:67]
    v_mfma_f32_16x16x32_bf16 v[84:87], a[248:251], v[108:111], v[84:87]
    v_mfma_f32_16x16x32_bf16 v[28:31], a[252:255], v[96:99], v[28:31]
    v_mfma_f32_16x16x32_bf16 v[48:51], a[252:255], v[100:103], v[48:51]
    v_mfma_f32_16x16x32_bf16 v[68:71], a[252:255], v[104:107], v[68:71]
    v_mfma_f32_16x16x32_bf16 v[88:91], a[252:255], v[108:111], v[88:91]
    v_mfma_f32_16x16x32_bf16 v[32:35], v[192:195], v[96:99], v[32:35]
    v_mfma_f32_16x16x32_bf16 v[52:55], v[192:195], v[100:103], v[52:55]
    v_mfma_f32_16x16x32_bf16 v[72:75], v[192:195], v[104:107], v[72:75]
    v_mfma_f32_16x16x32_bf16 v[92:95], v[192:195], v[108:111], v[92:95]
    s_waitcnt vmcnt(0)
    v_mfma_f32_16x16x32_bf16 v[16:19], v[196:199], v[112:115], v[16:19]
    v_mfma_f32_16x16x32_bf16 v[36:39], v[196:199], v[116:119], v[36:39]
    v_mfma_f32_16x16x32_bf16 v[56:59], v[196:199], v[120:123], v[56:59]
    v_mfma_f32_16x16x32_bf16 v[76:79], v[196:199], v[124:127], v[76:79]
    v_mfma_f32_16x16x32_bf16 v[20:23], v[200:203], v[112:115], v[20:23]
    v_mfma_f32_16x16x32_bf16 v[40:43], v[200:203], v[116:119], v[40:43]
    v_mfma_f32_16x16x32_bf16 v[60:63], v[200:203], v[120:123], v[60:63]
    v_mfma_f32_16x16x32_bf16 v[80:83], v[200:203], v[124:127], v[80:83]
    v_mfma_f32_16x16x32_bf16 v[24:27], v[204:207], v[112:115], v[24:27]
    v_mfma_f32_16x16x32_bf16 v[44:47], v[204:207], v[116:119], v[44:47]
    v_mfma_f32_16x16x32_bf16 v[64:67], v[204:207], v[120:123], v[64:67]
    v_mfma_f32_16x16x32_bf16 v[84:87], v[204:207], v[124:127], v[84:87]
    v_mfma_f32_16x16x32_bf16 v[28:31], v[208:211], v[112:115], v[28:31]
    v_mfma_f32_16x16x32_bf16 v[48:51], v[208:211], v[116:119], v[48:51]
    v_mfma_f32_16x16x32_bf16 v[68:71], v[208:211], v[120:123], v[68:71]
    v_mfma_f32_16x16x32_bf16 v[88:91], v[208:211], v[124:127], v[88:91]
    v_mfma_f32_16x16x32_bf16 v[32:35], v[212:215], v[112:115], v[32:35]
    v_mfma_f32_16x16x32_bf16 v[52:55], v[212:215], v[116:119], v[52:55]
    v_mfma_f32_16x16x32_bf16 v[72:75], v[212:215], v[120:123], v[72:75]
    v_mfma_f32_16x16x32_bf16 v[92:95], v[212:215], v[124:127], v[92:95]
k2_kernel_k4skip38:
    s_waitcnt vmcnt(0)
    s_barrier
    s_add_u32 s41, s30, 1
    s_and_b32 s41, s41, 3
    s_mul_i32 s41, s41, 15360
    s_add_u32 s41, s41, 0
    v_add_u32 v9, s41, v2
    ds_write_b128 v9, v[36:39] offset:0
    ds_write_b128 v9, v[40:43] offset:1024
    ds_write_b128 v9, v[44:47] offset:2048
    ds_write_b128 v9, v[48:51] offset:3072
    ds_write_b128 v9, v[52:55] offset:4096
    s_add_u32 s41, s30, 2
    s_and_b32 s41, s41, 3
    s_mul_i32 s41, s41, 15360
    s_add_u32 s41, s41, 5120
    v_add_u32 v9, s41, v2
    ds_write_b128 v9, v[56:59] offset:0
    ds_write_b128 v9, v[60:63] offset:1024
    ds_write_b128 v9, v[64:67] offset:2048
    ds_write_b128 v9, v[68:71] offset:3072
    ds_write_b128 v9, v[72:75] offset:4096
    s_add_u32 s41, s30, 3
    s_and_b32 s41, s41, 3
    s_mul_i32 s41, s41, 15360
    s_add_u32 s41, s41, 10240
    v_add_u32 v9, s41, v2
    ds_write_b128 v9, v[76:79] offset:0
    ds_write_b128 v9, v[80:83] offset:1024
    ds_write_b128 v9, v[84:87] offset:2048
    ds_write_b128 v9, v[88:91] offset:3072
    ds_write_b128 v9, v[92:95] offset:4096
    v_lshlrev_b32 v10, 4, v3
    v_add_u32 v10, 157696, v10
    ds_read_b128 v[96:99], v10 offset:0
    ds_read_b128 v[100:103], v10 offset:64
    ds_read_b128 v[104:107], v10 offset:128
    ds_read_b128 v[108:111], v10 offset:192
    ds_read_b128 v[112:115], v10 offset:256
    s_mul_i32 s41, s30, 15360
    v_add_u32 v9, s41, v2
    s_waitcnt lgkmcnt(0)
    s_barrier
    ds_read_b128 v[116:119], v9 offset:0
    ds_read_b128 v[120:123], v9 offset:1024
    ds_read_b128 v[124:127], v9 offset:2048
    ds_read_b128 v[128:131], v9 offset:3072
    ds_read_b128 v[132:135], v9 offset:4096
    ds_read_b128 v[136:139], v9 offset:5120
    ds_read_b128 v[140:143], v9 offset:6144
    ds_read_b128 v[144:147], v9 offset:7168
    ds_read_b128 v[148:151], v9 offset:8192
    ds_read_b128 v[152:155], v9 offset:9216
    ds_read_b128 v[156:159], v9 offset:10240
    ds_read_b128 v[160:163], v9 offset:11264
    ds_read_b128 v[164:167], v9 offset:12288
    ds_read_b128 v[168:171], v9 offset:13312
    ds_read_b128 v[172:175], v9 offset:14336
    s_lshl_b32 s46, s32, 2
    s_add_u32 s46, s46, s30
    s_lshl_b32 s46, s46, 4
    s_lshl_b32 s47, s28, 8
    s_add_u32 s46, s46, s47
    v_add_u32 v10, s46, v4
    v_mul_u32_u24 v10, 1280, v10
    v_lshl_add_u32 v10, v3, 3, v10
    s_mul_i32 s47, s33, 160
    s_nop 1
    v_permlane16_swap_b32 v228, v230
    v_permlane16_swap_b32 v229, v231
    v_permlane16_swap_b32 v232, v234
    v_permlane16_swap_b32 v233, v235
    v_permlane16_swap_b32 v238, v240
    v_permlane16_swap_b32 v239, v241
    v_permlane16_swap_b32 v242, v244
    v_permlane16_swap_b32 v243, v245
    s_waitcnt lgkmcnt(0)
    v_pk_add_f32 v[16:17], v[16:17], v[116:117]
    v_pk_add_f32 v[18:19], v[18:19], v[118:119]
    v_pk_add_f32 v[20:21], v[20:21], v[120:121]
    v_pk_add_f32 v[22:23], v[22:23], v[122:123]
    v_pk_add_f32 v[24:25], v[24:25], v[124:125]
    v_pk_add_f32 v[26:27], v[26:27], v[126:127]
    v_pk_add_f32 v[28:29], v[28:29], v[128:129]
    v_pk_add_f32 v[30:31], v[30:31], v[130:131]
    v_pk_add_f32 v[32:33], v[32:33], v[132:133]
    v_pk_add_f32 v[34:35], v[34:35], v[134:135]
    v_pk_add_f32 v[16:17], v[16:17], v[136:137]
    v_pk_add_f32 v[18:19], v[18:19], v[138:139]
    v_pk_add_f32 v[20:21], v[20:21], v[140:141]
    v_pk_add_f32 v[22:23], v[22:23], v[142:143]
    v_pk_add_f32 v[24:25], v[24:25], v[144:145]
    v_pk_add_f32 v[26:27], v[26:27], v[146:147]
    v_pk_add_f32 v[28:29], v[28:29], v[148:149]
    v_pk_add_f32 v[30:31], v[30:31], v[150:151]
    v_pk_add_f32 v[32:33], v[32:33], v[152:153]
    v_pk_add_f32 v[34:35], v[34:35], v[154:155]
    v_pk_add_f32 v[16:17], v[16:17], v[156:157]
    v_pk_add_f32 v[18:19], v[18:19], v[158:159]
    v_pk_add_f32 v[20:21], v[20:21], v[160:161]
    v_pk_add_f32 v[22:23], v[22:23], v[162:163]
    v_pk_add_f32 v[24:25], v[24:25], v[164:165]
    v_pk_add_f32 v[26:27], v[26:27], v[166:167]
    v_pk_add_f32 v[28:29], v[28:29], v[168:169]
    v_pk_add_f32 v[30:31], v[30:31], v[170:171]
    v_pk_add_f32 v[32:33], v[32:33], v[172:173]
    v_pk_add_f32 v[34:35], v[34:35], v[174:175]
    v_lshlrev_b32 v116, 16, v238
    v_and_b32 v117, 0xffff0000, v238
    v_lshlrev_b32 v118, 16, v239
    v_and_b32 v119, 0xffff0000, v239
    v_lshlrev_b32 v136, 16, v228
    v_and_b32 v137, 0xffff0000, v228
    v_lshlrev_b32 v138, 16, v229
    v_and_b32 v139, 0xffff0000, v229
    v_lshlrev_b32 v120, 16, v240
    v_and_b32 v121, 0xffff0000, v240
    v_lshlrev_b32 v122, 16, v241
    v_and_b32 v123, 0xffff0000, v241
    v_lshlrev_b32 v140, 16, v230
    v_and_b32 v141, 0xffff0000, v230
    v_lshlrev_b32 v142, 16, v231
    v_and_b32 v143, 0xffff0000, v231
    v_lshlrev_b32 v124, 16, v242
    v_and_b32 v125, 0xffff0000, v242
    v_lshlrev_b32 v126, 16, v243
    v_and_b32 v127, 0xffff0000, v243
    v_lshlrev_b32 v144, 16, v232
    v_and_b32 v145, 0xffff0000, v232
    v_lshlrev_b32 v146, 16, v233
    v_and_b32 v147, 0xffff0000, v233
    v_lshlrev_b32 v128, 16, v244
    v_and_b32 v129, 0xffff0000, v244
    v_lshlrev_b32 v130, 16, v245
    v_and_b32 v131, 0xffff0000, v245
    v_lshlrev_b32 v148, 16, v234
    v_and_b32 v149, 0xffff0000, v234
    v_lshlrev_b32 v150, 16, v235
    v_and_b32 v151, 0xffff0000, v235
    v_lshlrev_b32 v132, 16, v246
    v_and_b32 v133, 0xffff0000, v246
    v_lshlrev_b32 v134, 16, v247
    v_and_b32 v135, 0xffff0000, v247
    v_lshlrev_b32 v152, 16, v236
    v_and_b32 v153, 0xffff0000, v236
    v_lshlrev_b32 v154, 16, v237
    v_and_b32 v155, 0xffff0000, v237
    v_pk_add_f32 v[16:17], v[16:17], v[116:117]
    v_pk_add_f32 v[18:19], v[18:19], v[118:119]
    v_pk_add_f32 v[20:21], v[20:21], v[120:121]
    v_pk_add_f32 v[22:23], v[22:23], v[122:123]
    v_pk_add_f32 v[24:25], v[24:25], v[124:125]
    v_pk_add_f32 v[26:27], v[26:27], v[126:127]
    v_pk_add_f32 v[28:29], v[28:29], v[128:129]
    v_pk_add_f32 v[30:31], v[30:31], v[130:131]
    v_pk_add_f32 v[32:33], v[32:33], v[132:133]
    v_pk_add_f32 v[34:35], v[34:35], v[134:135]
    v_pk_fma_f32 v[16:17], v[16:17], v[96:97], v[136:137]
    v_pk_fma_f32 v[18:19], v[18:19], v[98:99], v[138:139]
    v_pk_fma_f32 v[20:21], v[20:21], v[100:101], v[140:141]
    v_pk_fma_f32 v[22:23], v[22:23], v[102:103], v[142:143]
    v_pk_fma_f32 v[24:25], v[24:25], v[104:105], v[144:145]
    v_pk_fma_f32 v[26:27], v[26:27], v[106:107], v[146:147]
    v_pk_fma_f32 v[28:29], v[28:29], v[108:109], v[148:149]
    v_pk_fma_f32 v[30:31], v[30:31], v[110:111], v[150:151]
    v_pk_fma_f32 v[32:33], v[32:33], v[112:113], v[152:153]
    v_pk_fma_f32 v[34:35], v[34:35], v[114:115], v[154:155]
    v_cvt_pk_bf16_f32 v16, v16, v17
    v_cvt_pk_bf16_f32 v17, v18, v19
    v_cvt_pk_bf16_f32 v18, v20, v21
    v_cvt_pk_bf16_f32 v19, v22, v23
    v_cvt_pk_bf16_f32 v24, v24, v25
    v_cvt_pk_bf16_f32 v25, v26, v27
    v_cvt_pk_bf16_f32 v26, v28, v29
    v_cvt_pk_bf16_f32 v27, v30, v31
    v_cvt_pk_bf16_f32 v32, v32, v33
    v_cvt_pk_bf16_f32 v33, v34, v35
    s_nop 1
    v_permlane16_swap_b32 v16, v18
    v_permlane16_swap_b32 v17, v19
    v_permlane16_swap_b32 v24, v26
    v_permlane16_swap_b32 v25, v27
    v_and_b32 v9, 1, v3
    v_lshlrev_b32 v9, 5, v9
    v_lshrrev_b32 v11, 1, v3
    v_lshl_add_u32 v9, v11, 4, v9
    v_lshlrev_b32 v11, 3, v3
    v_sub_u32 v11, v10, v11
    v_add_u32 v11, v11, v9
    buffer_store_dwordx4 v[16:19], v11, s[24:27], s47 offen offset:0
    buffer_store_dwordx4 v[24:27], v11, s[24:27], s47 offen offset:64
    buffer_store_dwordx2 v[32:33], v10, s[24:27], s47 offen offset:128
    s_waitcnt vmcnt(0) lgkmcnt(0)
    s_endpgm
k2_end:
    s_endpgm
CODE_END:
    s_endpgm
.section .rodata,"a"
.p2align 6
.amdhsa_kernel k1_kernel
  .amdhsa_next_free_vgpr 256
  .amdhsa_next_free_sgpr 72
  .amdhsa_accum_offset 256
  .amdhsa_group_segment_fixed_size 0
  .amdhsa_kernarg_size 128
  .amdhsa_user_sgpr_count 2
  .amdhsa_user_sgpr_kernarg_segment_ptr 1
  .amdhsa_system_sgpr_workgroup_id_x 1
  .amdhsa_float_denorm_mode_32 3
.end_amdhsa_kernel
.p2align 6
.amdhsa_kernel k2_kernel
  .amdhsa_next_free_vgpr 512
  .amdhsa_next_free_sgpr 102
  .amdhsa_accum_offset 256
  .amdhsa_group_segment_fixed_size 0
  .amdhsa_kernarg_size 128
  .amdhsa_user_sgpr_count 2
  .amdhsa_user_sgpr_kernarg_segment_ptr 1
  .amdhsa_system_sgpr_workgroup_id_x 1
  .amdhsa_float_denorm_mode_32 3
.end_amdhsa_kernel
```
